```python
import torch

def _softmax(x, axis=-1):
    return torch.softmax(x, dim=axis)
def _gelu(x):
    return torch.nn.functional.gelu(x, approximate="tanh")
def _silu(x):
    return torch.nn.functional.silu(x)
def _sigmoid(x):
    return torch.sigmoid(x)
def _layernorm(x, axis=-1, eps=1e-5):
    m = x.mean(dim=axis, keepdim=True)
    v = x.var(dim=axis, keepdim=True, unbiased=False)
    return (x - m) / torch.sqrt(v + eps)
def _scatter_add(tgt, idx, src, axis=0):
    return tgt.clone().index_add_(axis, idx, src)
def _segment_sum(src, seg, n):
    out = torch.zeros((n,) + src.shape[1:], dtype=src.dtype)
    return out.index_add_(0, seg, src)
def _pad(x, pw):
    flat = tuple(v for pair in reversed(pw) for v in pair)
    return torch.nn.functional.pad(x, flat)

kernel_name = 'parallel_sum__grouped_kv_mqa__dense_activation_silu__prompt'

def setup_inputs():

    _w = (lambda a: (lambda t: t.to(torch.bfloat16) if t.is_floating_point() else t)(torch.as_tensor(a)))
    def _A_setup():
        B, S, D, H = 1, 2048, 576, 32
        Dh = D // H
        return {
            "x": _w((lambda *s: torch.randn(*s, dtype=torch.bfloat16) * 0.05)(B, S, D)),
            "wq": _w((lambda *s: torch.randn(*s, dtype=torch.bfloat16) * 0.05)(D, H * Dh)),
            "wk": _w((lambda *s: torch.randn(*s, dtype=torch.bfloat16) * 0.05)(D, Dh)),
            "wv": _w((lambda *s: torch.randn(*s, dtype=torch.bfloat16) * 0.05)(D, Dh)),
            "wo": _w((lambda *s: torch.randn(*s, dtype=torch.bfloat16) * 0.05)(H * Dh, D)),
        }
    _A_in = _A_setup()

    def _B_setup():
        B, S, D, F = 1, 2048, 576, 4608
        return {
            "x": _w((lambda *s: torch.randn(*s, dtype=torch.bfloat16) * 0.05)(B, S, D)),
            "w1": _w((lambda *s: torch.randn(*s, dtype=torch.bfloat16) * 1.6)(D, F) * (D ** -0.5)),
            "w2": _w((lambda *s: torch.randn(*s, dtype=torch.bfloat16) * 0.2)(F, D) * (F ** -0.5)),
        }
    _B_in = _B_setup()

    return {
        "A_x": _A_in["x"],
        "A_wq": _A_in["wq"],
        "A_wk": _A_in["wk"],
        "A_wv": _A_in["wv"],
        "A_wo": _A_in["wo"],
        "B_x": _B_in["x"],
        "B_w1": _B_in["w1"],
        "B_w2": _B_in["w2"],
    }

def reference(A_x, A_wq, A_wk, A_wv, A_wo, B_x, B_w1, B_w2):
    def _A_ref(x, wq, wk, wv, wo):
        B, S, D = x.shape
        H = 32
        Dh = D // H
        q = (lambda x, *d: x.permute(*d))((x @ wq).reshape(B, S, H, Dh), 0, 2, 1, 3)
        k = x @ wk
        v = x @ wv
        scores = torch.einsum("bhqd,bkd->bhqk", q, k) * (Dh ** -0.5)
        p = _softmax(scores, axis=-1)
        o = torch.einsum("bhqk,bkd->bhqd", p, v)
        return (lambda x, *d: x.permute(*d))(o, 0, 2, 1, 3).reshape(B, S, H * Dh) @ wo

    def _B_ref(x, w1, w2):
        h = torch.einsum("bsd,df->bsf", x, w1)
        h = _silu(h)
        out = torch.einsum("bsf,fd->bsd", h, w2)
        return out

    x = A_x
    xn = _layernorm(x, axis=-1)
    return x + _A_ref(xn, A_wq, A_wk, A_wv, A_wo) + _B_ref(xn, B_w1, B_w2)
```

```asm
; @launch grid=(256,1,1) block=(256,1,1) lds=163840
.amdgcn_target "amdgcn-amd-amdhsa--gfx950"
.text
.globl parallel_sum__grouped_kv_mqa__dense_activation_silu__prompt_kernel
.p2align 8
.type parallel_sum__grouped_kv_mqa__dense_activation_silu__prompt_kernel,@function
parallel_sum__grouped_kv_mqa__dense_activation_silu__prompt_kernel:
 s_cmp_ge_u32 s2, 256
 s_cbranch_scc1 L_exit
 s_load_dwordx16 s[4:19], s[0:1], 0
 s_load_dwordx4 s[20:23], s[0:1], 64
 s_load_dwordx2 s[24:25], s[0:1], 80
 v_lshrrev_b32 v1, 6, v0
 v_and_b32 v255, 63, v0
 v_readfirstlane_b32 s63, v1
 s_and_b32 s67, s2, 7
 s_lshr_b32 s68, s2, 3
 s_and_b32 s62, s68, 1
 s_lshr_b32 s68, s68, 1
 s_cmp_lg_u32 s63, 3
 s_cbranch_scc1 L_ncp0
 s_cmp_ge_u32 s68, 2
 s_cbranch_scc1 L_ncp0
 s_getpc_b64 s[70:71]
L_pc0:
 s_mul_i32 s69, s62, L_att-L_pc0
 v_lshl_add_u32 v1, v255, 7, s69
 v_mov_b32 v3, s71
 v_add_co_u32 v2, vcc, s70, v1
 s_nop 1
 v_addc_co_u32 v3, vcc, 0, v3, vcc
 global_load_dword v150, v[2:3], off
L_ncp0:
 s_and_b32 s60, s67, 3
 s_lshl_b32 s60, s60, 2
 s_and_b32 s69, s68, 3
 s_add_u32 s60, s60, s69
 s_and_b32 s61, s67, 4
 s_lshr_b32 s69, s68, 2
 s_add_u32 s61, s61, s69
 s_lshr_b32 s74, s2, 3
 s_lshl_b32 s64, s63, 10
 s_lshl_b32 s67, s60, 7
 s_lshl_b32 s68, s63, 5
 s_add_u32 s67, s67, s68
 s_mul_i32 s66, s67, 1152
 s_mul_i32 s72, s63, 36864
 v_mov_b32 v148, v0
 v_lshrrev_b32 v1, 3, v255
 v_mul_u32_u24 v1, 1152, v1
 v_lshrrev_b32 v2, 4, v255
 v_and_b32 v3, 7, v255
 v_xor_b32 v3, v3, v2
 v_lshl_add_u32 v144, v3, 4, v1
 v_xor_b32 v145, 64, v144
 s_lshl_b32 s69, s69, 1
 s_add_u32 s69, s69, s62
 s_mul_i32 s69, s69, 18432
 s_mul_i32 s67, s60, 147456
 s_add_u32 s69, s69, s67
 v_lshlrev_b32 v4, 7, v0
 s_waitcnt lgkmcnt(0)
 s_mov_b32 s28, s4
 s_mov_b32 s29, s5
 s_mov_b32 s30, 2359296
 s_mov_b32 s31, 0x20000
 v_cmp_gt_u32 vcc, 144, v0
 s_nop 0
 s_and_saveexec_b64 s[70:71], vcc
 s_cbranch_execz L_nxpf
 buffer_load_dword v5, v4, s[28:31], s69 offen
L_nxpf:
 s_mov_b64 exec, -1
 s_mov_b32 s79, s72
 s_add_u32 m0, s79, 0
 s_add_u32 s65, s66, 0
 buffer_load_dwordx4 v144, s[28:31], s65 offen lds
 s_add_u32 m0, s79, 1024
 s_add_u32 s65, s66, 9216
 buffer_load_dwordx4 v145, s[28:31], s65 offen lds
 s_add_u32 m0, s79, 2048
 s_add_u32 s65, s66, 18432
 buffer_load_dwordx4 v144, s[28:31], s65 offen lds
 s_add_u32 m0, s79, 3072
 s_add_u32 s65, s66, 27648
 buffer_load_dwordx4 v145, s[28:31], s65 offen lds
 s_add_u32 m0, s79, 4096
 s_add_u32 s65, s66, 128
 buffer_load_dwordx4 v144, s[28:31], s65 offen lds
 s_mov_b32 s56, s24
 s_mov_b32 s57, s25
 s_mov_b32 s58, 67108864
 s_mov_b32 s59, 0x20000
 s_lshl_b32 s3, s60, 13
 s_add_u32 s3, s3, 25165824
 s_xor_b32 s67, s61, 0
 s_or_b32 s67, s67, s62
 s_cbranch_scc1 L_nzero
 v_lshlrev_b32 v1, 4, v148
 v_mov_b32 v8, 0
 v_mov_b32 v9, 0
 v_mov_b32 v10, 0
 v_mov_b32 v11, 0
 buffer_store_dwordx4 v[8:11], v1, s[56:59], s3 offen sc1
 v_add_u32 v1, 4096, v1
 buffer_store_dwordx4 v[8:11], v1, s[56:59], s3 offen sc1
L_nzero:
 s_add_u32 m0, s79, 5120
 s_add_u32 s65, s66, 9344
 buffer_load_dwordx4 v145, s[28:31], s65 offen lds
 s_getpc_b64 s[70:71]
L_pc:
 s_mul_i32 s67, s74, (L_codeend-L_pc+4095)/4096*128
 v_lshl_add_u32 v1, v255, 7, s67
 v_min_u32 v1, L_codeend-L_pc-16, v1
 v_mov_b32 v3, s71
 v_add_co_u32 v2, vcc, s70, v1
 s_nop 1
 v_addc_co_u32 v3, vcc, 0, v3, vcc
 s_add_u32 m0, s79, 6144
 s_add_u32 s65, s66, 18560
 buffer_load_dwordx4 v144, s[28:31], s65 offen lds
 s_cmp_lg_u32 s63, 2
 s_cbranch_scc1 L_ncpf
 s_mov_b32 exec_hi, 0
 global_load_dword v149, v[2:3], off
 s_mov_b64 exec, -1
L_ncpf:
 s_mov_b32 s52, s22
 s_mov_b32 s53, s23
 s_mov_b32 s54, 256
 s_mov_b32 s55, 0x20000
 s_mov_b32 s76, 0x3f80
 s_mov_b32 s77, 0x3f800000
 s_mov_b32 s78, 0x3f803f80
 s_add_u32 m0, s79, 7168
 s_add_u32 s65, s66, 27776
 buffer_load_dwordx4 v145, s[28:31], s65 offen lds
 s_mov_b32 s97, 0xffff0000
 v_and_b32 v1, 15, v255
 v_lshrrev_b32 v2, 3, v1
 v_lshlrev_b32 v2, 10, v2
 v_and_b32 v3, 7, v1
 v_lshl_add_u32 v2, v3, 7, v2
 v_lshrrev_b32 v1, 1, v1
 v_lshrrev_b32 v3, 4, v255
 v_xor_b32 v1, v1, v3
 v_lshl_add_u32 v2, v1, 4, v2
 v_add_u32 v146, s72, v2
 v_xor_b32 v147, 64, v146
 s_lshl_b32 s72, s61, 7
 s_cmp_eq_u32 s62, 1
 s_cbranch_scc1 L_att
 s_add_u32 m0, s79, 8192
 s_add_u32 s65, s66, 256
 buffer_load_dwordx4 v144, s[28:31], s65 offen lds
 s_mul_i32 s67, s61, 1152
 s_add_u32 s32, s16, s67
 s_addc_u32 s33, s17, 0
 s_mov_b32 s34, 5308416
 s_mov_b32 s35, 0x20000
 s_sub_u32 s34, s34, s67
 s_cmp_lt_u32 s61, 4
 s_cselect_b32 s44, s8, s10
 s_cselect_b32 s45, s9, s11
 s_mov_b32 s46, 20736
 s_mov_b32 s47, 0x20000
 s_add_u32 m0, s79, 9216
 s_add_u32 s65, s66, 9472
 buffer_load_dwordx4 v145, s[28:31], s65 offen lds
 v_bfe_u32 v224, v255, 2, 3
 v_lshl_add_u32 v225, s63, 3, v224
 v_mul_u32_u24 v248, 9216, v225
 v_lshrrev_b32 v226, 5, v255
 v_lshl_add_u32 v248, v226, 6, v248
 v_and_b32 v226, 3, v255
 v_lshl_add_u32 v248, v226, 4, v248
 s_and_b32 s67, s63, 1
 s_lshl_b32 s67, s67, 5
 v_xor_b32 v248, s67, v248
 s_add_u32 m0, s79, 10240
 s_add_u32 s65, s66, 18688
 buffer_load_dwordx4 v144, s[28:31], s65 offen lds
 v_bfe_u32 v226, v255, 2, 2
 v_lshlrev_b32 v236, 6, v226
 v_and_b32 v226, 3, v255
 v_lshl_add_u32 v236, v226, 3, v236
 v_bfe_u32 v226, v255, 4, 1
 v_lshl_add_u32 v236, v226, 5, v236
 v_lshrrev_b32 v226, 4, v255
 v_lshl_add_u32 v236, v226, 10, v236
 v_xor_b32 v237, 32, v236
 v_add_u32 v238, 49152, v236
 v_add_u32 v239, 49152, v237
 s_add_u32 m0, s79, 11264
 s_add_u32 s65, s66, 27904
 buffer_load_dwordx4 v145, s[28:31], s65 offen lds
 v_add_u32 v240, 98304, v236
 v_add_u32 v241, 98304, v237
 s_lshl_b32 s67, s60, 2
 s_lshr_b32 s69, s61, 1
 s_and_b32 s68, s61, 1
 s_add_u32 s69, s69, s68
 s_add_u32 s69, s69, s67
 s_cmp_lg_u32 s63, 0
 s_cselect_b32 s69, 1024, s69
 s_cselect_b32 s68, 0, 64
 s_add_u32 m0, s79, 12288
 s_add_u32 s65, s66, 384
 buffer_load_dwordx4 v144, s[28:31], s65 offen lds
 v_lshl_add_u32 v251, v255, 8, s69
 v_lshlrev_b32 v204, 7, v255
 v_add_u32 v204, 167936, v204
 v_mov_b32 v205, 67108864
 v_cmp_gt_u32 vcc, s68, v255
 s_nop 1
 v_cndmask_b32 v204, v205, v204, vcc
 s_mov_b32 s14, s67
 v_mov_b32 v252, 1
 v_lshrrev_b32 v225, 4, v255
 v_lshrrev_b32 v226, 5, v255
 s_add_u32 m0, s79, 13312
 s_add_u32 s65, s66, 9600
 buffer_load_dwordx4 v145, s[28:31], s65 offen lds
 v_xor_b32 v226, v225, v226
 v_lshlrev_b32 v226, 4, v226
 v_xor_b32 v226, v146, v226
 v_and_b32 v225, 1, v225
 v_lshl_add_u32 v226, v225, 3, v226
 s_lshl_b32 s67, s61, 12
 v_add_u32 v228, s67, v226
 v_xor_b32 v229, 32, v228
 v_xor_b32 v230, 64, v228
 v_xor_b32 v231, 96, v228
 s_and_b32 s67, s60, 3
 s_add_u32 m0, s79, 14336
 s_add_u32 s65, s66, 18816
 buffer_load_dwordx4 v144, s[28:31], s65 offen lds
 s_lshl_b32 s67, s67, 2
 s_add_u32 s67, s67, s63
 s_mul_i32 s67, s67, 48
 s_add_u32 s67, s67, 384
 v_add_u32 v225, s67, v255
 v_mul_u32_u24 v232, 9216, v225
 v_cmp_lt_u32 vcc, 575, v225
 v_subrev_u32 v225, 5308288, v232
 s_nop 0
 v_cndmask_b32 v232, v232, v225, vcc
 v_cmp_gt_u32 vcc, 48, v255
 s_add_u32 m0, s79, 15360
 s_add_u32 s65, s66, 28032
 buffer_load_dwordx4 v145, s[28:31], s65 offen lds
 v_mov_b32 v225, 0x40000000
 v_cndmask_b32 v232, v225, v232, vcc
 s_and_b32 s67, s60, 3
 s_lshl_b32 s67, s67, 2
 s_add_u32 s67, s67, s63
 s_mul_i32 s67, s67, 36
 v_add_u32 v234, s67, v255
 v_mul_u32_u24 v234, 9216, v234
 v_cmp_gt_u32 vcc, 36, v255
 s_nop 1
 v_cndmask_b32 v234, v225, v234, vcc
 s_and_b32 s67, s60, 3
 s_mul_i32 s67, s67, 41
 v_add_u32 v225, s67, v255
 v_lshlrev_b32 v225, 7, v225
 v_lshrrev_b32 v224, 2, v255
 v_mul_u32_u24 v224, 36, v224
 v_lshrrev_b32 v226, 5, v255
 v_lshlrev_b32 v226, 1, v226
 v_xor_b32 v226, v226, v255
 v_and_b32 v226, 3, v226
 v_lshl_add_u32 v254, v226, 4, v224
 v_lshrrev_b32 v226, 4, v255
 v_bfe_u32 v224, v255, 2, 2
 v_lshl_add_u32 v224, v226, 3, v224
 v_lshlrev_b32 v224, 6, v224
 v_and_b32 v226, 1, v226
 v_lshl_add_u32 v224, v226, 5, v224
 s_and_b32 s67, s61, 1
 s_cselect_b32 s68, 0, 3
 s_mul_i32 s67, s67, 4128
 v_and_b32 v226, s68, v255
 v_lshl_add_u32 v224, v226, 3, v224
 v_xor_b32 v233, s67, v224
 v_mov_b32 v184, s78
 v_mov_b32 v185, s78
 v_mov_b32 v186, s78
 v_mov_b32 v187, s78
 s_and_b32 s67, s61, 2
 s_cbranch_scc1 L_ffn_nokv1
 s_cmp_lg_u32 s63, 3
 s_cbranch_scc1 L_ffn_nokv1
 buffer_load_dword a248, v225, s[44:47], 0 offen
L_ffn_nokv1:
 s_waitcnt vmcnt(12)
 s_add_u32 m0, s79, 16384
 s_add_u32 s65, s66, 512
 buffer_load_dwordx4 v144, s[28:31], s65 offen lds
 s_add_u32 m0, s79, 17408
 s_add_u32 s65, s66, 9728
 buffer_load_dwordx4 v145, s[28:31], s65 offen lds
 s_add_u32 m0, s79, 18432
 s_add_u32 s65, s66, 18944
 buffer_load_dwordx4 v144, s[28:31], s65 offen lds
 s_add_u32 m0, s79, 19456
 s_add_u32 s65, s66, 28160
 buffer_load_dwordx4 v145, s[28:31], s65 offen lds
 ds_read_b128 v[0:3], v146 offset:0
 ds_read_b128 v[4:7], v146 offset:2048
 ds_read_b128 v[8:11], v147 offset:0
 ds_read_b128 v[12:15], v147 offset:2048
 s_waitcnt vmcnt(12)
 s_add_u32 m0, s79, 20480
 s_add_u32 s65, s66, 640
 buffer_load_dwordx4 v144, s[28:31], s65 offen lds
 s_add_u32 m0, s79, 21504
 s_add_u32 s65, s66, 9856
 buffer_load_dwordx4 v145, s[28:31], s65 offen lds
 s_add_u32 m0, s79, 22528
 s_add_u32 s65, s66, 19072
 buffer_load_dwordx4 v144, s[28:31], s65 offen lds
 s_add_u32 m0, s79, 23552
 s_add_u32 s65, s66, 28288
 buffer_load_dwordx4 v145, s[28:31], s65 offen lds
 ds_read_b128 v[16:19], v146 offset:4096
 ds_read_b128 v[20:23], v146 offset:6144
 ds_read_b128 v[24:27], v147 offset:4096
 ds_read_b128 v[28:31], v147 offset:6144
 s_waitcnt lgkmcnt(4)
 v_dot2_f32_bf16 v208, v0, s78, 0
 v_dot2_f32_bf16 v210, v0, v0, 0
 v_dot2_f32_bf16 v209, v4, s78, 0
 v_dot2_f32_bf16 v211, v4, v4, 0
 v_dot2_f32_bf16 v208, v1, s78, v208
 v_dot2_f32_bf16 v210, v1, v1, v210
 v_dot2_f32_bf16 v209, v5, s78, v209
 v_dot2_f32_bf16 v211, v5, v5, v211
 v_dot2_f32_bf16 v208, v2, s78, v208
 v_dot2_f32_bf16 v210, v2, v2, v210
 v_dot2_f32_bf16 v209, v6, s78, v209
 v_dot2_f32_bf16 v211, v6, v6, v211
 v_dot2_f32_bf16 v208, v3, s78, v208
 v_dot2_f32_bf16 v210, v3, v3, v210
 v_dot2_f32_bf16 v209, v7, s78, v209
 v_dot2_f32_bf16 v211, v7, v7, v211
 v_dot2_f32_bf16 v208, v8, s78, v208
 v_dot2_f32_bf16 v210, v8, v8, v210
 v_dot2_f32_bf16 v209, v12, s78, v209
 v_dot2_f32_bf16 v211, v12, v12, v211
 v_dot2_f32_bf16 v208, v9, s78, v208
 v_dot2_f32_bf16 v210, v9, v9, v210
 v_dot2_f32_bf16 v209, v13, s78, v209
 v_dot2_f32_bf16 v211, v13, v13, v211
 v_dot2_f32_bf16 v208, v10, s78, v208
 v_dot2_f32_bf16 v210, v10, v10, v210
 v_dot2_f32_bf16 v209, v14, s78, v209
 v_dot2_f32_bf16 v211, v14, v14, v211
 v_dot2_f32_bf16 v208, v11, s78, v208
 v_dot2_f32_bf16 v210, v11, v11, v210
 v_dot2_f32_bf16 v209, v15, s78, v209
 v_dot2_f32_bf16 v211, v15, v15, v211
 s_waitcnt vmcnt(12)
 s_add_u32 m0, s79, 24576
 s_add_u32 s65, s66, 768
 buffer_load_dwordx4 v144, s[28:31], s65 offen lds
 s_add_u32 m0, s79, 25600
 s_add_u32 s65, s66, 9984
 buffer_load_dwordx4 v145, s[28:31], s65 offen lds
 s_add_u32 m0, s79, 26624
 s_add_u32 s65, s66, 19200
 buffer_load_dwordx4 v144, s[28:31], s65 offen lds
 s_add_u32 m0, s79, 27648
 s_add_u32 s65, s66, 28416
 buffer_load_dwordx4 v145, s[28:31], s65 offen lds
 ds_read_b128 v[32:35], v146 offset:8192
 ds_read_b128 v[36:39], v146 offset:10240
 ds_read_b128 v[40:43], v147 offset:8192
 ds_read_b128 v[44:47], v147 offset:10240
 s_waitcnt lgkmcnt(4)
 v_dot2_f32_bf16 v208, v16, s78, v208
 v_dot2_f32_bf16 v210, v16, v16, v210
 v_dot2_f32_bf16 v209, v20, s78, v209
 v_dot2_f32_bf16 v211, v20, v20, v211
 v_dot2_f32_bf16 v208, v17, s78, v208
 v_dot2_f32_bf16 v210, v17, v17, v210
 v_dot2_f32_bf16 v209, v21, s78, v209
 v_dot2_f32_bf16 v211, v21, v21, v211
 v_dot2_f32_bf16 v208, v18, s78, v208
 v_dot2_f32_bf16 v210, v18, v18, v210
 v_dot2_f32_bf16 v209, v22, s78, v209
 v_dot2_f32_bf16 v211, v22, v22, v211
 v_dot2_f32_bf16 v208, v19, s78, v208
 v_dot2_f32_bf16 v210, v19, v19, v210
 v_dot2_f32_bf16 v209, v23, s78, v209
 v_dot2_f32_bf16 v211, v23, v23, v211
 v_dot2_f32_bf16 v208, v24, s78, v208
 v_dot2_f32_bf16 v210, v24, v24, v210
 v_dot2_f32_bf16 v209, v28, s78, v209
 v_dot2_f32_bf16 v211, v28, v28, v211
 v_dot2_f32_bf16 v208, v25, s78, v208
 v_dot2_f32_bf16 v210, v25, v25, v210
 v_dot2_f32_bf16 v209, v29, s78, v209
 v_dot2_f32_bf16 v211, v29, v29, v211
 v_dot2_f32_bf16 v208, v26, s78, v208
 v_dot2_f32_bf16 v210, v26, v26, v210
 v_dot2_f32_bf16 v209, v30, s78, v209
 v_dot2_f32_bf16 v211, v30, v30, v211
 v_dot2_f32_bf16 v208, v27, s78, v208
 v_dot2_f32_bf16 v210, v27, v27, v210
 v_dot2_f32_bf16 v209, v31, s78, v209
 v_dot2_f32_bf16 v211, v31, v31, v211
 s_waitcnt vmcnt(12)
 s_add_u32 m0, s79, 28672
 s_add_u32 s65, s66, 896
 buffer_load_dwordx4 v144, s[28:31], s65 offen lds
 s_add_u32 m0, s79, 29696
 s_add_u32 s65, s66, 10112
 buffer_load_dwordx4 v145, s[28:31], s65 offen lds
 s_add_u32 m0, s79, 30720
 s_add_u32 s65, s66, 19328
 buffer_load_dwordx4 v144, s[28:31], s65 offen lds
 s_add_u32 m0, s79, 31744
 s_add_u32 s65, s66, 28544
 buffer_load_dwordx4 v145, s[28:31], s65 offen lds
 ds_read_b128 v[48:51], v146 offset:12288
 ds_read_b128 v[52:55], v146 offset:14336
 ds_read_b128 v[56:59], v147 offset:12288
 ds_read_b128 v[60:63], v147 offset:14336
 s_waitcnt lgkmcnt(4)
 v_dot2_f32_bf16 v208, v32, s78, v208
 v_dot2_f32_bf16 v210, v32, v32, v210
 v_dot2_f32_bf16 v209, v36, s78, v209
 v_dot2_f32_bf16 v211, v36, v36, v211
 v_dot2_f32_bf16 v208, v33, s78, v208
 v_dot2_f32_bf16 v210, v33, v33, v210
 v_dot2_f32_bf16 v209, v37, s78, v209
 v_dot2_f32_bf16 v211, v37, v37, v211
 v_dot2_f32_bf16 v208, v34, s78, v208
 v_dot2_f32_bf16 v210, v34, v34, v210
 v_dot2_f32_bf16 v209, v38, s78, v209
 v_dot2_f32_bf16 v211, v38, v38, v211
 v_dot2_f32_bf16 v208, v35, s78, v208
 v_dot2_f32_bf16 v210, v35, v35, v210
 v_dot2_f32_bf16 v209, v39, s78, v209
 v_dot2_f32_bf16 v211, v39, v39, v211
 v_dot2_f32_bf16 v208, v40, s78, v208
 v_dot2_f32_bf16 v210, v40, v40, v210
 v_dot2_f32_bf16 v209, v44, s78, v209
 v_dot2_f32_bf16 v211, v44, v44, v211
 v_dot2_f32_bf16 v208, v41, s78, v208
 v_dot2_f32_bf16 v210, v41, v41, v210
 v_dot2_f32_bf16 v209, v45, s78, v209
 v_dot2_f32_bf16 v211, v45, v45, v211
 v_dot2_f32_bf16 v208, v42, s78, v208
 v_dot2_f32_bf16 v210, v42, v42, v210
 v_dot2_f32_bf16 v209, v46, s78, v209
 v_dot2_f32_bf16 v211, v46, v46, v211
 v_dot2_f32_bf16 v208, v43, s78, v208
 v_dot2_f32_bf16 v210, v43, v43, v210
 v_dot2_f32_bf16 v209, v47, s78, v209
 v_dot2_f32_bf16 v211, v47, v47, v211
 s_waitcnt vmcnt(12)
 s_add_u32 m0, s79, 32768
 s_add_u32 s65, s66, 1024
 buffer_load_dwordx4 v144, s[28:31], s65 offen lds
 s_add_u32 m0, s79, 33792
 s_add_u32 s65, s66, 10240
 buffer_load_dwordx4 v145, s[28:31], s65 offen lds
 s_add_u32 m0, s79, 34816
 s_add_u32 s65, s66, 19456
 buffer_load_dwordx4 v144, s[28:31], s65 offen lds
 s_add_u32 m0, s79, 35840
 s_add_u32 s65, s66, 28672
 buffer_load_dwordx4 v145, s[28:31], s65 offen lds
 ds_read_b128 v[64:67], v146 offset:16384
 ds_read_b128 v[68:71], v146 offset:18432
 ds_read_b128 v[72:75], v147 offset:16384
 ds_read_b128 v[76:79], v147 offset:18432
 s_waitcnt lgkmcnt(4)
 v_dot2_f32_bf16 v208, v48, s78, v208
 v_dot2_f32_bf16 v210, v48, v48, v210
 v_dot2_f32_bf16 v209, v52, s78, v209
 v_dot2_f32_bf16 v211, v52, v52, v211
 v_dot2_f32_bf16 v208, v49, s78, v208
 v_dot2_f32_bf16 v210, v49, v49, v210
 v_dot2_f32_bf16 v209, v53, s78, v209
 v_dot2_f32_bf16 v211, v53, v53, v211
 v_dot2_f32_bf16 v208, v50, s78, v208
 v_dot2_f32_bf16 v210, v50, v50, v210
 v_dot2_f32_bf16 v209, v54, s78, v209
 v_dot2_f32_bf16 v211, v54, v54, v211
 v_dot2_f32_bf16 v208, v51, s78, v208
 v_dot2_f32_bf16 v210, v51, v51, v210
 v_dot2_f32_bf16 v209, v55, s78, v209
 v_dot2_f32_bf16 v211, v55, v55, v211
 v_dot2_f32_bf16 v208, v56, s78, v208
 v_dot2_f32_bf16 v210, v56, v56, v210
 v_dot2_f32_bf16 v209, v60, s78, v209
 v_dot2_f32_bf16 v211, v60, v60, v211
 v_dot2_f32_bf16 v208, v57, s78, v208
 v_dot2_f32_bf16 v210, v57, v57, v210
 v_dot2_f32_bf16 v209, v61, s78, v209
 v_dot2_f32_bf16 v211, v61, v61, v211
 v_dot2_f32_bf16 v208, v58, s78, v208
 v_dot2_f32_bf16 v210, v58, v58, v210
 v_dot2_f32_bf16 v209, v62, s78, v209
 v_dot2_f32_bf16 v211, v62, v62, v211
 v_dot2_f32_bf16 v208, v59, s78, v208
 v_dot2_f32_bf16 v210, v59, v59, v210
 v_dot2_f32_bf16 v209, v63, s78, v209
 v_dot2_f32_bf16 v211, v63, v63, v211
 s_waitcnt vmcnt(12)
 ds_read_b128 v[80:83], v146 offset:20480
 ds_read_b128 v[84:87], v146 offset:22528
 ds_read_b128 v[88:91], v147 offset:20480
 ds_read_b128 v[92:95], v147 offset:22528
 s_waitcnt lgkmcnt(4)
 v_dot2_f32_bf16 v208, v64, s78, v208
 v_dot2_f32_bf16 v210, v64, v64, v210
 v_dot2_f32_bf16 v209, v68, s78, v209
 v_dot2_f32_bf16 v211, v68, v68, v211
 v_dot2_f32_bf16 v208, v65, s78, v208
 v_dot2_f32_bf16 v210, v65, v65, v210
 v_dot2_f32_bf16 v209, v69, s78, v209
 v_dot2_f32_bf16 v211, v69, v69, v211
 v_dot2_f32_bf16 v208, v66, s78, v208
 v_dot2_f32_bf16 v210, v66, v66, v210
 v_dot2_f32_bf16 v209, v70, s78, v209
 v_dot2_f32_bf16 v211, v70, v70, v211
 v_dot2_f32_bf16 v208, v67, s78, v208
 v_dot2_f32_bf16 v210, v67, v67, v210
 v_dot2_f32_bf16 v209, v71, s78, v209
 v_dot2_f32_bf16 v211, v71, v71, v211
 v_dot2_f32_bf16 v208, v72, s78, v208
 v_dot2_f32_bf16 v210, v72, v72, v210
 v_dot2_f32_bf16 v209, v76, s78, v209
 v_dot2_f32_bf16 v211, v76, v76, v211
 v_dot2_f32_bf16 v208, v73, s78, v208
 v_dot2_f32_bf16 v210, v73, v73, v210
 v_dot2_f32_bf16 v209, v77, s78, v209
 v_dot2_f32_bf16 v211, v77, v77, v211
 v_dot2_f32_bf16 v208, v74, s78, v208
 v_dot2_f32_bf16 v210, v74, v74, v210
 v_dot2_f32_bf16 v209, v78, s78, v209
 v_dot2_f32_bf16 v211, v78, v78, v211
 v_dot2_f32_bf16 v208, v75, s78, v208
 v_dot2_f32_bf16 v210, v75, v75, v210
 v_dot2_f32_bf16 v209, v79, s78, v209
 v_dot2_f32_bf16 v211, v79, v79, v211
 s_and_b32 s67, s61, 2
 s_cbranch_scc1 L_ffn_nokv2
 s_and_b32 s69, s61, 1
 s_lshl_b32 s69, s69, 12
 s_add_u32 s69, s69, s79
 s_lshr_b32 s67, s63, 1
 s_mul_i32 s67, s67, 10368
 s_and_b32 s68, s63, 1
 s_mul_i32 s68, s68, 5760
 s_add_u32 s67, s67, s68
 s_add_u32 m0, s69, 4096
 s_add_u32 s65, s67, 0
 buffer_load_dwordx4 v254, s[44:47], s65 offen lds
 s_add_u32 m0, s69, 5120
 s_add_u32 s65, s67, 576
 buffer_load_dwordx4 v254, s[44:47], s65 offen lds
 s_add_u32 m0, s69, 6144
 s_add_u32 s65, s67, 1152
 buffer_load_dwordx4 v254, s[44:47], s65 offen lds
 s_add_u32 m0, s69, 7168
 s_add_u32 s65, s67, 1728
 buffer_load_dwordx4 v254, s[44:47], s65 offen lds
 s_add_u32 m0, s69, 8192
 s_add_u32 s65, s67, 2304
 buffer_load_dwordx4 v254, s[44:47], s65 offen lds
 s_add_u32 m0, s69, 9216
 s_add_u32 s65, s67, 2880
 buffer_load_dwordx4 v254, s[44:47], s65 offen lds
 s_add_u32 m0, s69, 10240
 s_add_u32 s65, s67, 3456
 buffer_load_dwordx4 v254, s[44:47], s65 offen lds
 s_add_u32 m0, s69, 11264
 s_add_u32 s65, s67, 4032
 buffer_load_dwordx4 v254, s[44:47], s65 offen lds
 s_add_u32 m0, s69, 12288
 s_add_u32 s65, s67, 4608
 buffer_load_dwordx4 v254, s[44:47], s65 offen lds
 s_add_u32 m0, s69, 13312
 s_add_u32 s65, s67, 5184
 buffer_load_dwordx4 v254, s[44:47], s65 offen lds
L_ffn_nokv2:
 s_and_b32 s67, s61, 2
 s_cbranch_scc0 L_xw6
 s_waitcnt vmcnt(8)
L_xw6:
 s_waitcnt vmcnt(18)
 ds_read_b128 v[96:99], v146 offset:24576
 ds_read_b128 v[100:103], v146 offset:26624
 ds_read_b128 v[104:107], v147 offset:24576
 ds_read_b128 v[108:111], v147 offset:26624
 s_waitcnt lgkmcnt(4)
 v_dot2_f32_bf16 v208, v80, s78, v208
 v_dot2_f32_bf16 v210, v80, v80, v210
 v_dot2_f32_bf16 v209, v84, s78, v209
 v_dot2_f32_bf16 v211, v84, v84, v211
 v_dot2_f32_bf16 v208, v81, s78, v208
 v_dot2_f32_bf16 v210, v81, v81, v210
 v_dot2_f32_bf16 v209, v85, s78, v209
 v_dot2_f32_bf16 v211, v85, v85, v211
 v_dot2_f32_bf16 v208, v82, s78, v208
 v_dot2_f32_bf16 v210, v82, v82, v210
 v_dot2_f32_bf16 v209, v86, s78, v209
 v_dot2_f32_bf16 v211, v86, v86, v211
 v_dot2_f32_bf16 v208, v83, s78, v208
 v_dot2_f32_bf16 v210, v83, v83, v210
 v_dot2_f32_bf16 v209, v87, s78, v209
 v_dot2_f32_bf16 v211, v87, v87, v211
 v_dot2_f32_bf16 v208, v88, s78, v208
 v_dot2_f32_bf16 v210, v88, v88, v210
 v_dot2_f32_bf16 v209, v92, s78, v209
 v_dot2_f32_bf16 v211, v92, v92, v211
 v_dot2_f32_bf16 v208, v89, s78, v208
 v_dot2_f32_bf16 v210, v89, v89, v210
 v_dot2_f32_bf16 v209, v93, s78, v209
 v_dot2_f32_bf16 v211, v93, v93, v211
 v_dot2_f32_bf16 v208, v90, s78, v208
 v_dot2_f32_bf16 v210, v90, v90, v210
 v_dot2_f32_bf16 v209, v94, s78, v209
 v_dot2_f32_bf16 v211, v94, v94, v211
 v_dot2_f32_bf16 v208, v91, s78, v208
 v_dot2_f32_bf16 v210, v91, v91, v210
 v_dot2_f32_bf16 v209, v95, s78, v209
 v_dot2_f32_bf16 v211, v95, v95, v211
 s_and_b32 s67, s61, 2
 s_cbranch_scc0 L_xw7
 s_waitcnt vmcnt(4)
L_xw7:
 s_waitcnt vmcnt(14)
 ds_read_b128 v[112:115], v146 offset:28672
 ds_read_b128 v[116:119], v146 offset:30720
 ds_read_b128 v[120:123], v147 offset:28672
 ds_read_b128 v[124:127], v147 offset:30720
 s_waitcnt lgkmcnt(4)
 v_dot2_f32_bf16 v208, v96, s78, v208
 v_dot2_f32_bf16 v210, v96, v96, v210
 v_dot2_f32_bf16 v209, v100, s78, v209
 v_dot2_f32_bf16 v211, v100, v100, v211
 v_dot2_f32_bf16 v208, v97, s78, v208
 v_dot2_f32_bf16 v210, v97, v97, v210
 v_dot2_f32_bf16 v209, v101, s78, v209
 v_dot2_f32_bf16 v211, v101, v101, v211
 v_dot2_f32_bf16 v208, v98, s78, v208
 v_dot2_f32_bf16 v210, v98, v98, v210
 v_dot2_f32_bf16 v209, v102, s78, v209
 v_dot2_f32_bf16 v211, v102, v102, v211
 v_dot2_f32_bf16 v208, v99, s78, v208
 v_dot2_f32_bf16 v210, v99, v99, v210
 v_dot2_f32_bf16 v209, v103, s78, v209
 v_dot2_f32_bf16 v211, v103, v103, v211
 v_dot2_f32_bf16 v208, v104, s78, v208
 v_dot2_f32_bf16 v210, v104, v104, v210
 v_dot2_f32_bf16 v209, v108, s78, v209
 v_dot2_f32_bf16 v211, v108, v108, v211
 v_dot2_f32_bf16 v208, v105, s78, v208
 v_dot2_f32_bf16 v210, v105, v105, v210
 v_dot2_f32_bf16 v209, v109, s78, v209
 v_dot2_f32_bf16 v211, v109, v109, v211
 v_dot2_f32_bf16 v208, v106, s78, v208
 v_dot2_f32_bf16 v210, v106, v106, v210
 v_dot2_f32_bf16 v209, v110, s78, v209
 v_dot2_f32_bf16 v211, v110, v110, v211
 v_dot2_f32_bf16 v208, v107, s78, v208
 v_dot2_f32_bf16 v210, v107, v107, v210
 v_dot2_f32_bf16 v209, v111, s78, v209
 v_dot2_f32_bf16 v211, v111, v111, v211
 s_and_b32 s67, s61, 2
 s_cbranch_scc0 L_xw8
 s_waitcnt vmcnt(0)
L_xw8:
 s_waitcnt vmcnt(10)
 ds_read_b128 v[128:131], v146 offset:32768
 ds_read_b128 v[132:135], v146 offset:34816
 ds_read_b128 v[136:139], v147 offset:32768
 ds_read_b128 v[140:143], v147 offset:34816
 s_waitcnt lgkmcnt(4)
 v_dot2_f32_bf16 v208, v112, s78, v208
 v_dot2_f32_bf16 v210, v112, v112, v210
 v_dot2_f32_bf16 v209, v116, s78, v209
 v_dot2_f32_bf16 v211, v116, v116, v211
 v_dot2_f32_bf16 v208, v113, s78, v208
 v_dot2_f32_bf16 v210, v113, v113, v210
 v_dot2_f32_bf16 v209, v117, s78, v209
 v_dot2_f32_bf16 v211, v117, v117, v211
 v_dot2_f32_bf16 v208, v114, s78, v208
 v_dot2_f32_bf16 v210, v114, v114, v210
 v_dot2_f32_bf16 v209, v118, s78, v209
 v_dot2_f32_bf16 v211, v118, v118, v211
 v_dot2_f32_bf16 v208, v115, s78, v208
 v_dot2_f32_bf16 v210, v115, v115, v210
 v_dot2_f32_bf16 v209, v119, s78, v209
 v_dot2_f32_bf16 v211, v119, v119, v211
 v_dot2_f32_bf16 v208, v120, s78, v208
 v_dot2_f32_bf16 v210, v120, v120, v210
 v_dot2_f32_bf16 v209, v124, s78, v209
 v_dot2_f32_bf16 v211, v124, v124, v211
 v_dot2_f32_bf16 v208, v121, s78, v208
 v_dot2_f32_bf16 v210, v121, v121, v210
 v_dot2_f32_bf16 v209, v125, s78, v209
 v_dot2_f32_bf16 v211, v125, v125, v211
 v_dot2_f32_bf16 v208, v122, s78, v208
 v_dot2_f32_bf16 v210, v122, v122, v210
 v_dot2_f32_bf16 v209, v126, s78, v209
 v_dot2_f32_bf16 v211, v126, v126, v211
 v_dot2_f32_bf16 v208, v123, s78, v208
 v_dot2_f32_bf16 v210, v123, v123, v210
 v_dot2_f32_bf16 v209, v127, s78, v209
 v_dot2_f32_bf16 v211, v127, v127, v211
 ds_read_b64 a[224:225], v228 offset:0
 ds_read_b64 a[226:227], v228 offset:2048
 ds_read_b64 a[228:229], v229 offset:0
 ds_read_b64 a[230:231], v229 offset:2048
 ds_read_b64 a[232:233], v230 offset:0
 ds_read_b64 a[234:235], v230 offset:2048
 ds_read_b64 a[236:237], v231 offset:0
 ds_read_b64 a[238:239], v231 offset:2048
 s_waitcnt lgkmcnt(0) vmcnt(0)
 s_barrier
 s_waitcnt lgkmcnt(0)
 v_dot2_f32_bf16 v208, v128, s78, v208
 v_dot2_f32_bf16 v210, v128, v128, v210
 v_dot2_f32_bf16 v209, v132, s78, v209
 v_dot2_f32_bf16 v211, v132, v132, v211
 v_dot2_f32_bf16 v208, v129, s78, v208
 v_dot2_f32_bf16 v210, v129, v129, v210
 v_dot2_f32_bf16 v209, v133, s78, v209
 v_dot2_f32_bf16 v211, v133, v133, v211
 v_dot2_f32_bf16 v208, v130, s78, v208
 v_dot2_f32_bf16 v210, v130, v130, v210
 v_dot2_f32_bf16 v209, v134, s78, v209
 v_dot2_f32_bf16 v211, v134, v134, v211
 v_dot2_f32_bf16 v208, v131, s78, v208
 v_dot2_f32_bf16 v210, v131, v131, v210
 v_dot2_f32_bf16 v209, v135, s78, v209
 v_dot2_f32_bf16 v211, v135, v135, v211
 v_dot2_f32_bf16 v208, v136, s78, v208
 v_dot2_f32_bf16 v210, v136, v136, v210
 v_dot2_f32_bf16 v209, v140, s78, v209
 v_dot2_f32_bf16 v211, v140, v140, v211
 v_dot2_f32_bf16 v208, v137, s78, v208
 v_dot2_f32_bf16 v210, v137, v137, v210
 v_dot2_f32_bf16 v209, v141, s78, v209
 v_dot2_f32_bf16 v211, v141, v141, v211
 v_dot2_f32_bf16 v208, v138, s78, v208
 v_dot2_f32_bf16 v210, v138, v138, v210
 v_dot2_f32_bf16 v209, v142, s78, v209
 v_dot2_f32_bf16 v211, v142, v142, v211
 v_dot2_f32_bf16 v208, v139, s78, v208
 v_dot2_f32_bf16 v210, v139, v139, v210
 v_dot2_f32_bf16 v209, v143, s78, v209
 v_dot2_f32_bf16 v211, v143, v143, v211
 s_and_b32 s67, s61, 2
 s_cbranch_scc0 L_ffn_kv
 s_add_u32 m0, s64, 0
 s_mov_b32 s65, 0
 buffer_load_dwordx4 v248, s[32:35], s65 offen lds
 s_add_u32 m0, s64, 4096
 s_mov_b32 s65, 294912
 buffer_load_dwordx4 v248, s[32:35], s65 offen lds
 s_add_u32 m0, s64, 8192
 s_mov_b32 s65, 589824
 buffer_load_dwordx4 v248, s[32:35], s65 offen lds
 s_add_u32 m0, s64, 12288
 s_mov_b32 s65, 884736
 buffer_load_dwordx4 v248, s[32:35], s65 offen lds
 s_add_u32 m0, s64, 16384
 s_mov_b32 s65, 1179648
 buffer_load_dwordx4 v248, s[32:35], s65 offen lds
 s_add_u32 m0, s64, 20480
 s_mov_b32 s65, 1474560
 buffer_load_dwordx4 v248, s[32:35], s65 offen lds
 buffer_load_dword a248, v232, s[32:35], 0 offen
 v_mov_b32 v220, v208
 v_mov_b32 v221, v209
 v_mov_b32 v222, v210
 v_mov_b32 v223, v211
 v_permlane16_swap_b32 v208, v220
 v_permlane16_swap_b32 v209, v221
 v_permlane16_swap_b32 v210, v222
 v_permlane16_swap_b32 v211, v223
 v_add_f32 v208, v208, v220
 v_add_f32 v209, v209, v221
 v_add_f32 v210, v210, v222
 v_add_f32 v211, v211, v223
 v_mov_b32 v220, v208
 v_mov_b32 v221, v209
 v_mov_b32 v222, v210
 v_mov_b32 v223, v211
 v_permlane32_swap_b32 v208, v220
 v_permlane32_swap_b32 v209, v221
 v_permlane32_swap_b32 v210, v222
 v_permlane32_swap_b32 v211, v223
 v_add_f32 v208, v208, v220
 v_add_f32 v209, v209, v221
 v_add_f32 v210, v210, v222
 v_add_f32 v211, v211, v223
 v_mul_f32 v208, 987991609, v208
 v_mul_f32 v209, 987991609, v209
 v_mul_f32 v210, 987991609, v210
 v_mul_f32 v211, 987991609, v211
 v_fma_f32 v210, -v208, v208, v210
 v_fma_f32 v211, -v209, v209, v211
 v_max_f32 v210, 0, v210
 v_max_f32 v211, 0, v211
 v_add_f32 v210, 925353388, v210
 v_add_f32 v211, 925353388, v211
 v_rsq_f32 v210, v210
 v_rsq_f32 v211, v211
 s_branch L_ffn_norm
L_ffn_kv:
 buffer_load_dword a248, v234, s[32:35], 0 offen offset:0
 buffer_load_dword a248, v234, s[32:35], 0 offen offset:128
 s_cmp_ge_u32 s61, 4
 s_cbranch_scc1 L_ffn_v
 ds_read_b64_tr_b16 a[144:145], v233 offset:4096
 ds_read_b64_tr_b16 a[146:147], v233 offset:4352
 ds_read_b64_tr_b16 a[148:149], v233 offset:6144
 ds_read_b64_tr_b16 a[150:151], v233 offset:6400
 ds_read_b64_tr_b16 a[152:153], v233 offset:8192
 ds_read_b64_tr_b16 a[154:155], v233 offset:8448
 ds_read_b64_tr_b16 a[156:157], v233 offset:10240
 ds_read_b64_tr_b16 a[158:159], v233 offset:10496
 s_waitcnt lgkmcnt(6)
 v_mfma_f32_16x16x32_bf16 v[144:147], a[144:147], v[0:3], 0
 ds_read_b64_tr_b16 a[160:161], v233 offset:12288
 v_mov_b32 v220, v208
 v_mfma_f32_16x16x32_bf16 v[148:151], a[144:147], v[4:7], 0
 s_waitcnt lgkmcnt(5)
 ds_read_b64_tr_b16 a[162:163], v233 offset:12544
 v_mfma_f32_16x16x32_bf16 v[152:155], a[144:147], v[184:187], 0
 v_mov_b32 v221, v209
 v_mov_b32 v222, v210
 v_mov_b32 v223, v211
 v_mfma_f32_16x16x32_bf16 v[148:151], a[148:151], v[12:15], v[148:151]
 ds_read_b64_tr_b16 a[164:165], v233 offset:40960
 v_permlane16_swap_b32 v208, v220
 v_mfma_f32_16x16x32_bf16 v[144:147], a[148:151], v[8:11], v[144:147]
 s_waitcnt lgkmcnt(5)
 ds_read_b64_tr_b16 a[166:167], v233 offset:41216
 v_mfma_f32_16x16x32_bf16 v[152:155], a[148:151], v[184:187], v[152:155]
 v_permlane16_swap_b32 v209, v221
 v_permlane16_swap_b32 v210, v222
 v_permlane16_swap_b32 v211, v223
 v_mfma_f32_16x16x32_bf16 v[144:147], a[152:155], v[16:19], v[144:147]
 ds_read_b64_tr_b16 a[168:169], v233 offset:43008
 v_add_f32 v208, v208, v220
 v_mfma_f32_16x16x32_bf16 v[148:151], a[152:155], v[20:23], v[148:151]
 s_waitcnt lgkmcnt(5)
 ds_read_b64_tr_b16 a[170:171], v233 offset:43264
 v_mfma_f32_16x16x32_bf16 v[152:155], a[152:155], v[184:187], v[152:155]
 v_add_f32 v209, v209, v221
 v_add_f32 v210, v210, v222
 v_add_f32 v211, v211, v223
 v_mfma_f32_16x16x32_bf16 v[148:151], a[156:159], v[28:31], v[148:151]
 ds_read_b64_tr_b16 a[172:173], v233 offset:45056
 v_mov_b32 v220, v208
 v_mfma_f32_16x16x32_bf16 v[144:147], a[156:159], v[24:27], v[144:147]
 s_waitcnt lgkmcnt(5)
 ds_read_b64_tr_b16 a[174:175], v233 offset:45312
 v_mfma_f32_16x16x32_bf16 v[152:155], a[156:159], v[184:187], v[152:155]
 v_mov_b32 v221, v209
 v_mov_b32 v222, v210
 v_mov_b32 v223, v211
 v_mfma_f32_16x16x32_bf16 v[144:147], a[160:163], v[32:35], v[144:147]
 ds_read_b64_tr_b16 a[144:145], v233 offset:47104
 v_permlane32_swap_b32 v208, v220
 v_mfma_f32_16x16x32_bf16 v[148:151], a[160:163], v[36:39], v[148:151]
 s_waitcnt lgkmcnt(5)
 ds_read_b64_tr_b16 a[146:147], v233 offset:47360
 v_add_u32 v233, 73728, v233
 v_mfma_f32_16x16x32_bf16 v[152:155], a[160:163], v[184:187], v[152:155]
 v_permlane32_swap_b32 v209, v221
 v_permlane32_swap_b32 v210, v222
 v_permlane32_swap_b32 v211, v223
 v_mfma_f32_16x16x32_bf16 v[148:151], a[164:167], v[44:47], v[148:151]
 ds_read_b64_tr_b16 a[148:149], v233 offset:4096
 v_add_f32 v208, v208, v220
 v_mfma_f32_16x16x32_bf16 v[144:147], a[164:167], v[40:43], v[144:147]
 s_waitcnt lgkmcnt(5)
 ds_read_b64_tr_b16 a[150:151], v233 offset:4352
 v_mfma_f32_16x16x32_bf16 v[152:155], a[164:167], v[184:187], v[152:155]
 v_add_f32 v209, v209, v221
 v_add_f32 v210, v210, v222
 v_add_f32 v211, v211, v223
 v_mfma_f32_16x16x32_bf16 v[144:147], a[168:171], v[48:51], v[144:147]
 ds_read_b64_tr_b16 a[152:153], v233 offset:6144
 v_mul_f32 v208, 987991609, v208
 v_mfma_f32_16x16x32_bf16 v[148:151], a[168:171], v[52:55], v[148:151]
 s_waitcnt lgkmcnt(5)
 ds_read_b64_tr_b16 a[154:155], v233 offset:6400
 v_mfma_f32_16x16x32_bf16 v[152:155], a[168:171], v[184:187], v[152:155]
 v_mul_f32 v209, 987991609, v209
 v_mul_f32 v210, 987991609, v210
 v_mul_f32 v211, 987991609, v211
 v_mfma_f32_16x16x32_bf16 v[148:151], a[172:175], v[60:63], v[148:151]
 ds_read_b64_tr_b16 a[156:157], v233 offset:8192
 v_fma_f32 v210, -v208, v208, v210
 v_mfma_f32_16x16x32_bf16 v[144:147], a[172:175], v[56:59], v[144:147]
 s_waitcnt lgkmcnt(5)
 ds_read_b64_tr_b16 a[158:159], v233 offset:8448
 v_mfma_f32_16x16x32_bf16 v[152:155], a[172:175], v[184:187], v[152:155]
 v_fma_f32 v211, -v209, v209, v211
 v_max_f32 v210, 0, v210
 v_max_f32 v211, 0, v211
 v_mfma_f32_16x16x32_bf16 v[144:147], a[144:147], v[64:67], v[144:147]
 ds_read_b64_tr_b16 a[160:161], v233 offset:10240
 v_add_f32 v210, 925353388, v210
 v_mfma_f32_16x16x32_bf16 v[148:151], a[144:147], v[68:71], v[148:151]
 s_waitcnt lgkmcnt(5)
 ds_read_b64_tr_b16 a[162:163], v233 offset:10496
 v_mfma_f32_16x16x32_bf16 v[152:155], a[144:147], v[184:187], v[152:155]
 v_add_f32 v211, 925353388, v211
 v_rsq_f32 v210, v210
 v_rsq_f32 v211, v211
 v_mfma_f32_16x16x32_bf16 v[148:151], a[148:151], v[76:79], v[148:151]
 ds_read_b64_tr_b16 a[164:165], v233 offset:12288
 v_mul_f32 v212, v208, v210
 v_mfma_f32_16x16x32_bf16 v[144:147], a[148:151], v[72:75], v[144:147]
 s_waitcnt lgkmcnt(5)
 ds_read_b64_tr_b16 a[166:167], v233 offset:12544
 v_mfma_f32_16x16x32_bf16 v[152:155], a[148:151], v[184:187], v[152:155]
 v_mul_f32 v213, v209, v211
 s_mul_i32 s67, s60, 9984
 v_and_b32 v224, 15, v255
 v_mfma_f32_16x16x32_bf16 v[144:147], a[152:155], v[80:83], v[144:147]
 ds_read_b64_tr_b16 a[168:169], v233 offset:40960
 v_lshrrev_b32 v225, 5, v255
 v_mfma_f32_16x16x32_bf16 v[148:151], a[152:155], v[84:87], v[148:151]
 s_waitcnt lgkmcnt(5)
 ds_read_b64_tr_b16 a[170:171], v233 offset:41216
 v_mfma_f32_16x16x32_bf16 v[152:155], a[152:155], v[184:187], v[152:155]
 v_lshlrev_b32 v225, 9, v225
 v_lshl_add_u32 v225, v224, 4, v225
 v_bfe_u32 v226, v255, 4, 1
 v_mfma_f32_16x16x32_bf16 v[148:151], a[156:159], v[92:95], v[148:151]
 ds_read_b64_tr_b16 a[172:173], v233 offset:43008
 v_lshl_add_u32 v225, v226, 3, v225
 v_mfma_f32_16x16x32_bf16 v[144:147], a[156:159], v[88:91], v[144:147]
 s_waitcnt lgkmcnt(5)
 ds_read_b64_tr_b16 a[174:175], v233 offset:43264
 v_mfma_f32_16x16x32_bf16 v[152:155], a[156:159], v[184:187], v[152:155]
 v_add_u32 v225, s64, v225
 s_lshl_b32 s68, s63, 2
 v_lshl_add_u32 v224, v224, 4, s68
 v_mfma_f32_16x16x32_bf16 v[144:147], a[160:163], v[96:99], v[144:147]
 ds_read_b64_tr_b16 a[144:145], v233 offset:45056
 s_lshl_b32 s69, s60, 4
 v_mfma_f32_16x16x32_bf16 v[148:151], a[160:163], v[100:103], v[148:151]
 s_waitcnt lgkmcnt(5)
 ds_read_b64_tr_b16 a[146:147], v233 offset:45312
 v_mfma_f32_16x16x32_bf16 v[152:155], a[160:163], v[184:187], v[152:155]
 s_add_u32 s69, s69, s68
 s_lshl_b32 s68, s61, 8
 s_add_u32 s69, s69, s68
 v_mfma_f32_16x16x32_bf16 v[148:151], a[164:167], v[108:111], v[148:151]
 ds_read_b64_tr_b16 a[148:149], v233 offset:47104
 s_add_u32 s69, s69, 163840
 v_mfma_f32_16x16x32_bf16 v[144:147], a[164:167], v[104:107], v[144:147]
 s_waitcnt lgkmcnt(5)
 ds_read_b64_tr_b16 a[150:151], v233 offset:47360
 v_mfma_f32_16x16x32_bf16 v[152:155], a[164:167], v[184:187], v[152:155]
 v_cmp_gt_u32 vcc, 16, v255
 v_mfma_f32_16x16x32_bf16 v[144:147], a[168:171], v[112:115], v[144:147]
 v_mfma_f32_16x16x32_bf16 v[148:151], a[168:171], v[116:119], v[148:151]
 s_waitcnt lgkmcnt(4)
 v_mfma_f32_16x16x32_bf16 v[152:155], a[168:171], v[184:187], v[152:155]
 v_mfma_f32_16x16x32_bf16 v[148:151], a[172:175], v[124:127], v[148:151]
 v_mfma_f32_16x16x32_bf16 v[144:147], a[172:175], v[120:123], v[144:147]
 s_waitcnt lgkmcnt(2)
 v_mfma_f32_16x16x32_bf16 v[152:155], a[172:175], v[184:187], v[152:155]
 v_mfma_f32_16x16x32_bf16 v[144:147], a[144:147], v[128:131], v[144:147]
 v_mfma_f32_16x16x32_bf16 v[148:151], a[144:147], v[132:135], v[148:151]
 s_waitcnt lgkmcnt(0)
 v_mfma_f32_16x16x32_bf16 v[152:155], a[144:147], v[184:187], v[152:155]
 v_mfma_f32_16x16x32_bf16 v[148:151], a[148:151], v[140:143], v[148:151]
 v_mfma_f32_16x16x32_bf16 v[144:147], a[148:151], v[136:139], v[144:147]
 v_mfma_f32_16x16x32_bf16 v[152:155], a[148:151], v[184:187], v[152:155]
 s_nop 6
 v_mul_f32 v144, v210, v144
 v_mul_f32 v145, v210, v145
 v_mul_f32 v146, v210, v146
 v_mul_f32 v147, v210, v147
 v_mul_f32 v148, v211, v148
 v_mul_f32 v149, v211, v149
 v_mul_f32 v150, v211, v150
 v_mul_f32 v151, v211, v151
 v_fma_f32 v144, -v212, v152, v144
 v_fma_f32 v145, -v212, v153, v145
 v_fma_f32 v146, -v212, v154, v146
 v_fma_f32 v147, -v212, v155, v147
 v_fma_f32 v148, -v213, v152, v148
 v_fma_f32 v149, -v213, v153, v149
 v_fma_f32 v150, -v213, v154, v150
 v_fma_f32 v151, -v213, v155, v151
 v_cvt_pk_bf16_f32 v156, v144, v145
 v_cvt_pk_bf16_f32 v157, v146, v147
 v_cvt_pk_bf16_f32 v158, v148, v149
 v_cvt_pk_bf16_f32 v159, v150, v151
 s_cmp_eq_u32 s61, 1
 s_cbranch_scc1 L_ffn_k1
 buffer_store_dwordx2 v[156:157], v225, s[56:59], s67 offen offset:512 sc1
 buffer_store_dwordx2 v[158:159], v225, s[56:59], s67 offen offset:768 sc1
 v_mul_f32 v228, v144, v144
 v_mul_f32 v229, v148, v148
 v_fmac_f32 v228, v145, v145
 v_fmac_f32 v229, v149, v149
 v_fmac_f32 v228, v146, v146
 v_fmac_f32 v229, v150, v150
 v_fmac_f32 v228, v147, v147
 v_fmac_f32 v229, v151, v151
 v_mov_b32 v230, v228
 v_mov_b32 v231, v229
 s_nop 0
 v_permlane16_swap_b32 v228, v230
 v_permlane16_swap_b32 v229, v231
 v_add_f32 v228, v228, v230
 v_add_f32 v229, v229, v231
 v_mov_b32 v230, v228
 v_mov_b32 v231, v229
 s_nop 0
 v_permlane32_swap_b32 v228, v230
 v_permlane32_swap_b32 v229, v231
 v_add_f32 v228, v228, v230
 v_add_f32 v229, v229, v231
 s_branch L_ffn_kn
L_ffn_k1:
 s_mov_b64 exec, 0xffff
 buffer_store_dword v156, v224, s[56:59], s67 offen offset:0 sc1
 buffer_store_dword v158, v224, s[56:59], s67 offen offset:256 sc1
 s_mov_b64 exec, -1
 v_mul_f32 v228, v144, v144
 v_mul_f32 v229, v148, v148
 v_fmac_f32 v228, v145, v145
 v_fmac_f32 v229, v149, v149
 v_cndmask_b32 v228, 0, v228, vcc
 v_cndmask_b32 v229, 0, v229, vcc
L_ffn_kn:
 v_max_f32 v228, v228, v229
 s_nop 1
 v_max_f32_dpp v228, v228, v228 row_shr:1 row_mask:0xf bank_mask:0xf
 s_nop 1
 v_max_f32_dpp v228, v228, v228 row_shr:2 row_mask:0xf bank_mask:0xf
 s_nop 1
 v_max_f32_dpp v228, v228, v228 row_shr:4 row_mask:0xf bank_mask:0xf
 s_nop 1
 v_max_f32_dpp v228, v228, v228 row_shr:8 row_mask:0xf bank_mask:0xf
 s_nop 1
 v_max_f32_dpp v228, v228, v228 row_bcast:15 row_mask:0xa bank_mask:0xf
 s_nop 1
 v_max_f32_dpp v228, v228, v228 row_bcast:31 row_mask:0xc bank_mask:0xf
 s_mov_b32 exec_hi, 0x80000000
 s_mov_b32 exec_lo, 0
 buffer_store_dword v228, off, s[56:59], s69 sc1
 s_mov_b64 exec, -1
 s_branch L_ffn_kvdone
L_ffn_v:
 ds_read_b64_tr_b16 a[144:145], v233 offset:4096
 ds_read_b64_tr_b16 a[146:147], v233 offset:4352
 ds_read_b64_tr_b16 a[148:149], v233 offset:6144
 ds_read_b64_tr_b16 a[150:151], v233 offset:6400
 ds_read_b64_tr_b16 a[152:153], v233 offset:8192
 ds_read_b64_tr_b16 a[154:155], v233 offset:8448
 ds_read_b64_tr_b16 a[156:157], v233 offset:10240
 ds_read_b64_tr_b16 a[158:159], v233 offset:10496
 s_waitcnt lgkmcnt(6)
 v_mfma_f32_16x16x32_bf16 v[144:147], v[0:3], a[144:147], 0
 ds_read_b64_tr_b16 a[160:161], v233 offset:12288
 v_mov_b32 v220, v208
 v_mfma_f32_16x16x32_bf16 v[148:151], v[4:7], a[144:147], 0
 s_waitcnt lgkmcnt(5)
 ds_read_b64_tr_b16 a[162:163], v233 offset:12544
 v_mfma_f32_16x16x32_bf16 v[152:155], v[184:187], a[144:147], 0
 v_mov_b32 v221, v209
 v_mov_b32 v222, v210
 v_mov_b32 v223, v211
 v_mfma_f32_16x16x32_bf16 v[148:151], v[12:15], a[148:151], v[148:151]
 ds_read_b64_tr_b16 a[164:165], v233 offset:40960
 v_permlane16_swap_b32 v208, v220
 v_mfma_f32_16x16x32_bf16 v[144:147], v[8:11], a[148:151], v[144:147]
 s_waitcnt lgkmcnt(5)
 ds_read_b64_tr_b16 a[166:167], v233 offset:41216
 v_mfma_f32_16x16x32_bf16 v[152:155], v[184:187], a[148:151], v[152:155]
 v_permlane16_swap_b32 v209, v221
 v_permlane16_swap_b32 v210, v222
 v_permlane16_swap_b32 v211, v223
 v_mfma_f32_16x16x32_bf16 v[144:147], v[16:19], a[152:155], v[144:147]
 ds_read_b64_tr_b16 a[168:169], v233 offset:43008
 v_add_f32 v208, v208, v220
 v_mfma_f32_16x16x32_bf16 v[148:151], v[20:23], a[152:155], v[148:151]
 s_waitcnt lgkmcnt(5)
 ds_read_b64_tr_b16 a[170:171], v233 offset:43264
 v_mfma_f32_16x16x32_bf16 v[152:155], v[184:187], a[152:155], v[152:155]
 v_add_f32 v209, v209, v221
 v_add_f32 v210, v210, v222
 v_add_f32 v211, v211, v223
 v_mfma_f32_16x16x32_bf16 v[148:151], v[28:31], a[156:159], v[148:151]
 ds_read_b64_tr_b16 a[172:173], v233 offset:45056
 v_mov_b32 v220, v208
 v_mfma_f32_16x16x32_bf16 v[144:147], v[24:27], a[156:159], v[144:147]
 s_waitcnt lgkmcnt(5)
 ds_read_b64_tr_b16 a[174:175], v233 offset:45312
 v_mfma_f32_16x16x32_bf16 v[152:155], v[184:187], a[156:159], v[152:155]
 v_mov_b32 v221, v209
 v_mov_b32 v222, v210
 v_mov_b32 v223, v211
 v_mfma_f32_16x16x32_bf16 v[144:147], v[32:35], a[160:163], v[144:147]
 ds_read_b64_tr_b16 a[144:145], v233 offset:47104
 v_permlane32_swap_b32 v208, v220
 v_mfma_f32_16x16x32_bf16 v[148:151], v[36:39], a[160:163], v[148:151]
 s_waitcnt lgkmcnt(5)
 ds_read_b64_tr_b16 a[146:147], v233 offset:47360
 v_add_u32 v233, 73728, v233
 v_mfma_f32_16x16x32_bf16 v[152:155], v[184:187], a[160:163], v[152:155]
 v_permlane32_swap_b32 v209, v221
 v_permlane32_swap_b32 v210, v222
 v_permlane32_swap_b32 v211, v223
 v_mfma_f32_16x16x32_bf16 v[148:151], v[44:47], a[164:167], v[148:151]
 ds_read_b64_tr_b16 a[148:149], v233 offset:4096
 v_add_f32 v208, v208, v220
 v_mfma_f32_16x16x32_bf16 v[144:147], v[40:43], a[164:167], v[144:147]
 s_waitcnt lgkmcnt(5)
 ds_read_b64_tr_b16 a[150:151], v233 offset:4352
 v_mfma_f32_16x16x32_bf16 v[152:155], v[184:187], a[164:167], v[152:155]
 v_add_f32 v209, v209, v221
 v_add_f32 v210, v210, v222
 v_add_f32 v211, v211, v223
 v_mfma_f32_16x16x32_bf16 v[144:147], v[48:51], a[168:171], v[144:147]
 ds_read_b64_tr_b16 a[152:153], v233 offset:6144
 v_mul_f32 v208, 987991609, v208
 v_mfma_f32_16x16x32_bf16 v[148:151], v[52:55], a[168:171], v[148:151]
 s_waitcnt lgkmcnt(5)
 ds_read_b64_tr_b16 a[154:155], v233 offset:6400
 v_mfma_f32_16x16x32_bf16 v[152:155], v[184:187], a[168:171], v[152:155]
 v_mul_f32 v209, 987991609, v209
 v_mul_f32 v210, 987991609, v210
 v_mul_f32 v211, 987991609, v211
 v_mfma_f32_16x16x32_bf16 v[148:151], v[60:63], a[172:175], v[148:151]
 ds_read_b64_tr_b16 a[156:157], v233 offset:8192
 v_fma_f32 v210, -v208, v208, v210
 v_mfma_f32_16x16x32_bf16 v[144:147], v[56:59], a[172:175], v[144:147]
 s_waitcnt lgkmcnt(5)
 ds_read_b64_tr_b16 a[158:159], v233 offset:8448
 v_mfma_f32_16x16x32_bf16 v[152:155], v[184:187], a[172:175], v[152:155]
 v_fma_f32 v211, -v209, v209, v211
 v_max_f32 v210, 0, v210
 v_max_f32 v211, 0, v211
 v_mfma_f32_16x16x32_bf16 v[144:147], v[64:67], a[144:147], v[144:147]
 ds_read_b64_tr_b16 a[160:161], v233 offset:10240
 v_add_f32 v210, 925353388, v210
 v_mfma_f32_16x16x32_bf16 v[148:151], v[68:71], a[144:147], v[148:151]
 s_waitcnt lgkmcnt(5)
 ds_read_b64_tr_b16 a[162:163], v233 offset:10496
 v_mfma_f32_16x16x32_bf16 v[152:155], v[184:187], a[144:147], v[152:155]
 v_add_f32 v211, 925353388, v211
 v_rsq_f32 v210, v210
 v_rsq_f32 v211, v211
 v_mfma_f32_16x16x32_bf16 v[148:151], v[76:79], a[148:151], v[148:151]
 ds_read_b64_tr_b16 a[164:165], v233 offset:12288
 v_mul_f32 v212, v208, v210
 v_mfma_f32_16x16x32_bf16 v[144:147], v[72:75], a[148:151], v[144:147]
 s_waitcnt lgkmcnt(5)
 ds_read_b64_tr_b16 a[166:167], v233 offset:12544
 v_mfma_f32_16x16x32_bf16 v[152:155], v[184:187], a[148:151], v[152:155]
 v_mul_f32 v213, v209, v211
 s_lshl_b32 s67, s63, 8
 s_add_u32 s67, s67, 147456
 v_mfma_f32_16x16x32_bf16 v[144:147], v[80:83], a[152:155], v[144:147]
 ds_read_b64_tr_b16 a[168:169], v233 offset:40960
 v_and_b32 v224, 15, v255
 v_mfma_f32_16x16x32_bf16 v[148:151], v[84:87], a[152:155], v[148:151]
 s_waitcnt lgkmcnt(5)
 ds_read_b64_tr_b16 a[170:171], v233 offset:41216
 v_mfma_f32_16x16x32_bf16 v[152:155], v[184:187], a[152:155], v[152:155]
 v_lshl_add_u32 v229, v224, 2, s67
 v_lshrrev_b32 v225, 4, v255
 v_lshl_add_u32 v228, v225, 4, s67
 v_mfma_f32_16x16x32_bf16 v[148:151], v[92:95], a[156:159], v[148:151]
 ds_read_b64_tr_b16 a[172:173], v233 offset:43008
 s_mul_i32 s67, s60, 9984
 v_mfma_f32_16x16x32_bf16 v[144:147], v[88:91], a[156:159], v[144:147]
 s_waitcnt lgkmcnt(5)
 ds_read_b64_tr_b16 a[174:175], v233 offset:43264
 v_mfma_f32_16x16x32_bf16 v[152:155], v[184:187], a[156:159], v[152:155]
 s_mul_i32 s68, s63, 1344
 s_add_u32 s67, s67, s68
 s_add_u32 s67, s67, 4608
 v_mfma_f32_16x16x32_bf16 v[144:147], v[96:99], a[160:163], v[144:147]
 ds_read_b64_tr_b16 a[144:145], v233 offset:45056
 v_lshrrev_b32 v225, 5, v255
 v_mfma_f32_16x16x32_bf16 v[148:151], v[100:103], a[160:163], v[148:151]
 s_waitcnt lgkmcnt(5)
 ds_read_b64_tr_b16 a[146:147], v233 offset:45312
 v_mfma_f32_16x16x32_bf16 v[152:155], v[184:187], a[160:163], v[152:155]
 v_mul_u32_u24 v225, 336, v225
 v_lshl_add_u32 v225, v224, 4, v225
 v_bfe_u32 v226, v255, 4, 1
 v_mfma_f32_16x16x32_bf16 v[148:151], v[108:111], a[164:167], v[148:151]
 ds_read_b64_tr_b16 a[148:149], v233 offset:47104
 v_lshl_add_u32 v225, v226, 3, v225
 v_mfma_f32_16x16x32_bf16 v[144:147], v[104:107], a[164:167], v[144:147]
 s_waitcnt lgkmcnt(5)
 ds_read_b64_tr_b16 a[150:151], v233 offset:47360
 v_mfma_f32_16x16x32_bf16 v[152:155], v[184:187], a[164:167], v[152:155]
 v_cmp_eq_u32 vcc, 2, v224
 v_mov_b32 v226, s78
 s_nop 0
 v_cndmask_b32 v226, 0, v226, vcc
 v_mfma_f32_16x16x32_bf16 v[144:147], v[112:115], a[168:171], v[144:147]
 v_cmp_gt_u32 vcc, 2, v224
 v_mfma_f32_16x16x32_bf16 v[148:151], v[116:119], a[168:171], v[148:151]
 s_waitcnt lgkmcnt(4)
 v_mfma_f32_16x16x32_bf16 v[152:155], v[184:187], a[168:171], v[152:155]
 v_mfma_f32_16x16x32_bf16 v[148:151], v[124:127], a[172:175], v[148:151]
 v_mfma_f32_16x16x32_bf16 v[144:147], v[120:123], a[172:175], v[144:147]
 s_waitcnt lgkmcnt(2)
 v_mfma_f32_16x16x32_bf16 v[152:155], v[184:187], a[172:175], v[152:155]
 v_mfma_f32_16x16x32_bf16 v[144:147], v[128:131], a[144:147], v[144:147]
 v_mfma_f32_16x16x32_bf16 v[148:151], v[132:135], a[144:147], v[148:151]
 s_waitcnt lgkmcnt(0)
 v_mfma_f32_16x16x32_bf16 v[152:155], v[184:187], a[144:147], v[152:155]
 v_mfma_f32_16x16x32_bf16 v[148:151], v[140:143], a[148:151], v[148:151]
 v_mfma_f32_16x16x32_bf16 v[144:147], v[136:139], a[148:151], v[144:147]
 v_mfma_f32_16x16x32_bf16 v[152:155], v[184:187], a[148:151], v[152:155]
 ds_write2_b32 v229, v210, v211 offset0:0 offset1:16
 ds_write2_b32 v229, v212, v213 offset0:32 offset1:48
 s_waitcnt lgkmcnt(0)
 ds_read_b128 v[188:191], v228 offset:0
 ds_read_b128 v[192:195], v228 offset:64
 ds_read_b128 v[196:199], v228 offset:128
 ds_read_b128 v[200:203], v228 offset:192
 s_waitcnt lgkmcnt(0)
 v_mul_f32 v144, v188, v144
 v_mul_f32 v145, v189, v145
 v_mul_f32 v146, v190, v146
 v_mul_f32 v147, v191, v147
 v_mul_f32 v148, v192, v148
 v_mul_f32 v149, v193, v149
 v_mul_f32 v150, v194, v150
 v_mul_f32 v151, v195, v151
 v_fma_f32 v144, -v196, v152, v144
 v_fma_f32 v145, -v197, v152, v145
 v_fma_f32 v146, -v198, v152, v146
 v_fma_f32 v147, -v199, v152, v147
 v_fma_f32 v148, -v200, v152, v148
 v_fma_f32 v149, -v201, v152, v149
 v_fma_f32 v150, -v202, v152, v150
 v_fma_f32 v151, -v203, v152, v151
 v_cvt_pk_bf16_f32 v156, v144, v145
 v_cvt_pk_bf16_f32 v157, v146, v147
 v_cvt_pk_bf16_f32 v158, v148, v149
 v_cvt_pk_bf16_f32 v159, v150, v151
 s_cmp_eq_u32 s61, 4
 s_cbranch_scc1 L_ffn_v0
 v_cndmask_b32 v156, v226, v156, vcc
 v_cndmask_b32 v157, v226, v157, vcc
 v_cndmask_b32 v158, v226, v158, vcc
 v_cndmask_b32 v159, v226, v159, vcc
 s_add_u32 s67, s67, 256
 s_mov_b32 exec_lo, 0x1f001f
 s_mov_b32 exec_hi, 0x1f001f
L_ffn_v0:
 buffer_store_dwordx2 v[156:157], v225, s[56:59], s67 offen offset:0 sc1
 buffer_store_dwordx2 v[158:159], v225, s[56:59], s67 offen offset:672 sc1
 s_mov_b64 exec, -1
L_ffn_kvdone:
 s_barrier
 s_add_u32 m0, s64, 0
 s_mov_b32 s65, 0
 buffer_load_dwordx4 v248, s[32:35], s65 offen lds
 s_add_u32 m0, s64, 4096
 s_mov_b32 s65, 294912
 buffer_load_dwordx4 v248, s[32:35], s65 offen lds
 s_add_u32 m0, s64, 8192
 s_mov_b32 s65, 589824
 buffer_load_dwordx4 v248, s[32:35], s65 offen lds
 s_add_u32 m0, s64, 12288
 s_mov_b32 s65, 884736
 buffer_load_dwordx4 v248, s[32:35], s65 offen lds
 s_add_u32 m0, s64, 16384
 s_mov_b32 s65, 1179648
 buffer_load_dwordx4 v248, s[32:35], s65 offen lds
 s_add_u32 m0, s64, 20480
 s_mov_b32 s65, 1474560
 buffer_load_dwordx4 v248, s[32:35], s65 offen lds
L_ffn_norm:
 v_mul_f32 v212, 3216550459, v210
 v_mul_f32 v216, 3216550459, v211
 v_mul_f32_e64 v214, -v208, v212
 v_mul_f32_e64 v218, -v209, v216
 v_mov_b32 v213, v212
 v_mov_b32 v215, v214
 v_mov_b32 v217, v216
 v_mov_b32 v219, v218
 s_add_u32 m0, s64, 24576
 s_mov_b32 s65, 1769472
 buffer_load_dwordx4 v248, s[32:35], s65 offen lds
 v_lshlrev_b32 v220, 16, v0
 v_and_b32 v221, s97, v0
 v_lshlrev_b32 v222, 16, v1
 v_and_b32 v223, s97, v1
 v_pk_fma_f32 v[220:221], v[220:221], v[212:213], v[214:215]
 v_pk_fma_f32 v[222:223], v[222:223], v[212:213], v[214:215]
 v_cvt_pk_bf16_f32 v0, v220, v221
 v_cvt_pk_bf16_f32 v1, v222, v223
 v_lshlrev_b32 v220, 16, v2
 v_and_b32 v221, s97, v2
 v_lshlrev_b32 v222, 16, v3
 v_and_b32 v223, s97, v3
 v_pk_fma_f32 v[220:221], v[220:221], v[212:213], v[214:215]
 v_pk_fma_f32 v[222:223], v[222:223], v[212:213], v[214:215]
 v_cvt_pk_bf16_f32 v2, v220, v221
 v_cvt_pk_bf16_f32 v3, v222, v223
 v_lshlrev_b32 v220, 16, v4
 v_and_b32 v221, s97, v4
 v_lshlrev_b32 v222, 16, v5
 v_and_b32 v223, s97, v5
 v_pk_fma_f32 v[220:221], v[220:221], v[216:217], v[218:219]
 v_pk_fma_f32 v[222:223], v[222:223], v[216:217], v[218:219]
 v_cvt_pk_bf16_f32 v4, v220, v221
 v_cvt_pk_bf16_f32 v5, v222, v223
 v_lshlrev_b32 v220, 16, v6
 v_and_b32 v221, s97, v6
 v_lshlrev_b32 v222, 16, v7
 v_and_b32 v223, s97, v7
 v_pk_fma_f32 v[220:221], v[220:221], v[216:217], v[218:219]
 v_pk_fma_f32 v[222:223], v[222:223], v[216:217], v[218:219]
 v_cvt_pk_bf16_f32 v6, v220, v221
 v_cvt_pk_bf16_f32 v7, v222, v223
 v_lshlrev_b32 v220, 16, v8
 v_and_b32 v221, s97, v8
 v_lshlrev_b32 v222, 16, v9
 v_and_b32 v223, s97, v9
 v_pk_fma_f32 v[220:221], v[220:221], v[212:213], v[214:215]
 v_pk_fma_f32 v[222:223], v[222:223], v[212:213], v[214:215]
 v_cvt_pk_bf16_f32 v8, v220, v221
 v_cvt_pk_bf16_f32 v9, v222, v223
 v_lshlrev_b32 v220, 16, v10
 v_and_b32 v221, s97, v10
 v_lshlrev_b32 v222, 16, v11
 v_and_b32 v223, s97, v11
 v_pk_fma_f32 v[220:221], v[220:221], v[212:213], v[214:215]
 v_pk_fma_f32 v[222:223], v[222:223], v[212:213], v[214:215]
 v_cvt_pk_bf16_f32 v10, v220, v221
 v_cvt_pk_bf16_f32 v11, v222, v223
 v_lshlrev_b32 v220, 16, v12
 v_and_b32 v221, s97, v12
 v_lshlrev_b32 v222, 16, v13
 v_and_b32 v223, s97, v13
 v_pk_fma_f32 v[220:221], v[220:221], v[216:217], v[218:219]
 v_pk_fma_f32 v[222:223], v[222:223], v[216:217], v[218:219]
 v_cvt_pk_bf16_f32 v12, v220, v221
 v_cvt_pk_bf16_f32 v13, v222, v223
 v_lshlrev_b32 v220, 16, v14
 v_and_b32 v221, s97, v14
 v_lshlrev_b32 v222, 16, v15
 v_and_b32 v223, s97, v15
 v_pk_fma_f32 v[220:221], v[220:221], v[216:217], v[218:219]
 v_pk_fma_f32 v[222:223], v[222:223], v[216:217], v[218:219]
 v_cvt_pk_bf16_f32 v14, v220, v221
 v_cvt_pk_bf16_f32 v15, v222, v223
 v_lshlrev_b32 v220, 16, v16
 v_and_b32 v221, s97, v16
 v_lshlrev_b32 v222, 16, v17
 v_and_b32 v223, s97, v17
 v_pk_fma_f32 v[220:221], v[220:221], v[212:213], v[214:215]
 v_pk_fma_f32 v[222:223], v[222:223], v[212:213], v[214:215]
 v_cvt_pk_bf16_f32 v16, v220, v221
 v_cvt_pk_bf16_f32 v17, v222, v223
 s_add_u32 m0, s64, 28672
 s_mov_b32 s65, 2064384
 buffer_load_dwordx4 v248, s[32:35], s65 offen lds
 v_lshlrev_b32 v220, 16, v18
 v_and_b32 v221, s97, v18
 v_lshlrev_b32 v222, 16, v19
 v_and_b32 v223, s97, v19
 v_pk_fma_f32 v[220:221], v[220:221], v[212:213], v[214:215]
 v_pk_fma_f32 v[222:223], v[222:223], v[212:213], v[214:215]
 v_cvt_pk_bf16_f32 v18, v220, v221
 v_cvt_pk_bf16_f32 v19, v222, v223
 v_lshlrev_b32 v220, 16, v20
 v_and_b32 v221, s97, v20
 v_lshlrev_b32 v222, 16, v21
 v_and_b32 v223, s97, v21
 v_pk_fma_f32 v[220:221], v[220:221], v[216:217], v[218:219]
 v_pk_fma_f32 v[222:223], v[222:223], v[216:217], v[218:219]
 v_cvt_pk_bf16_f32 v20, v220, v221
 v_cvt_pk_bf16_f32 v21, v222, v223
 v_lshlrev_b32 v220, 16, v22
 v_and_b32 v221, s97, v22
 v_lshlrev_b32 v222, 16, v23
 v_and_b32 v223, s97, v23
 v_pk_fma_f32 v[220:221], v[220:221], v[216:217], v[218:219]
 v_pk_fma_f32 v[222:223], v[222:223], v[216:217], v[218:219]
 v_cvt_pk_bf16_f32 v22, v220, v221
 v_cvt_pk_bf16_f32 v23, v222, v223
 v_lshlrev_b32 v220, 16, v24
 v_and_b32 v221, s97, v24
 v_lshlrev_b32 v222, 16, v25
 v_and_b32 v223, s97, v25
 v_pk_fma_f32 v[220:221], v[220:221], v[212:213], v[214:215]
 v_pk_fma_f32 v[222:223], v[222:223], v[212:213], v[214:215]
 v_cvt_pk_bf16_f32 v24, v220, v221
 v_cvt_pk_bf16_f32 v25, v222, v223
 v_lshlrev_b32 v220, 16, v26
 v_and_b32 v221, s97, v26
 v_lshlrev_b32 v222, 16, v27
 v_and_b32 v223, s97, v27
 v_pk_fma_f32 v[220:221], v[220:221], v[212:213], v[214:215]
 v_pk_fma_f32 v[222:223], v[222:223], v[212:213], v[214:215]
 v_cvt_pk_bf16_f32 v26, v220, v221
 v_cvt_pk_bf16_f32 v27, v222, v223
 v_lshlrev_b32 v220, 16, v28
 v_and_b32 v221, s97, v28
 v_lshlrev_b32 v222, 16, v29
 v_and_b32 v223, s97, v29
 v_pk_fma_f32 v[220:221], v[220:221], v[216:217], v[218:219]
 v_pk_fma_f32 v[222:223], v[222:223], v[216:217], v[218:219]
 v_cvt_pk_bf16_f32 v28, v220, v221
 v_cvt_pk_bf16_f32 v29, v222, v223
 v_lshlrev_b32 v220, 16, v30
 v_and_b32 v221, s97, v30
 v_lshlrev_b32 v222, 16, v31
 v_and_b32 v223, s97, v31
 v_pk_fma_f32 v[220:221], v[220:221], v[216:217], v[218:219]
 v_pk_fma_f32 v[222:223], v[222:223], v[216:217], v[218:219]
 v_cvt_pk_bf16_f32 v30, v220, v221
 v_cvt_pk_bf16_f32 v31, v222, v223
 v_lshlrev_b32 v220, 16, v32
 v_and_b32 v221, s97, v32
 v_lshlrev_b32 v222, 16, v33
 v_and_b32 v223, s97, v33
 v_pk_fma_f32 v[220:221], v[220:221], v[212:213], v[214:215]
 v_pk_fma_f32 v[222:223], v[222:223], v[212:213], v[214:215]
 v_cvt_pk_bf16_f32 v32, v220, v221
 v_cvt_pk_bf16_f32 v33, v222, v223
 v_lshlrev_b32 v220, 16, v34
 v_and_b32 v221, s97, v34
 v_lshlrev_b32 v222, 16, v35
 v_and_b32 v223, s97, v35
 v_pk_fma_f32 v[220:221], v[220:221], v[212:213], v[214:215]
 v_pk_fma_f32 v[222:223], v[222:223], v[212:213], v[214:215]
 v_cvt_pk_bf16_f32 v34, v220, v221
 v_cvt_pk_bf16_f32 v35, v222, v223
 s_and_b32 s67, s61, 2
 s_cbranch_scc1 L_ffn_nosig
 s_waitcnt vmcnt(8)
 s_barrier
 buffer_atomic_add v252, v204, s[56:59], 0 offen sc1
 buffer_store_byte v252, v251, s[52:55], 0 offen sc1
L_ffn_nosig:
 v_lshlrev_b32 v220, 16, v36
 v_and_b32 v221, s97, v36
 v_lshlrev_b32 v222, 16, v37
 v_and_b32 v223, s97, v37
 v_pk_fma_f32 v[220:221], v[220:221], v[216:217], v[218:219]
 v_pk_fma_f32 v[222:223], v[222:223], v[216:217], v[218:219]
 v_cvt_pk_bf16_f32 v36, v220, v221
 v_cvt_pk_bf16_f32 v37, v222, v223
 v_lshlrev_b32 v220, 16, v38
 v_and_b32 v221, s97, v38
 v_lshlrev_b32 v222, 16, v39
 v_and_b32 v223, s97, v39
 v_pk_fma_f32 v[220:221], v[220:221], v[216:217], v[218:219]
 v_pk_fma_f32 v[222:223], v[222:223], v[216:217], v[218:219]
 v_cvt_pk_bf16_f32 v38, v220, v221
 v_cvt_pk_bf16_f32 v39, v222, v223
 v_lshlrev_b32 v220, 16, v40
 v_and_b32 v221, s97, v40
 v_lshlrev_b32 v222, 16, v41
 v_and_b32 v223, s97, v41
 v_pk_fma_f32 v[220:221], v[220:221], v[212:213], v[214:215]
 v_pk_fma_f32 v[222:223], v[222:223], v[212:213], v[214:215]
 v_cvt_pk_bf16_f32 v40, v220, v221
 v_cvt_pk_bf16_f32 v41, v222, v223
 v_lshlrev_b32 v220, 16, v42
 v_and_b32 v221, s97, v42
 v_lshlrev_b32 v222, 16, v43
 v_and_b32 v223, s97, v43
 v_pk_fma_f32 v[220:221], v[220:221], v[212:213], v[214:215]
 v_pk_fma_f32 v[222:223], v[222:223], v[212:213], v[214:215]
 v_cvt_pk_bf16_f32 v42, v220, v221
 v_cvt_pk_bf16_f32 v43, v222, v223
 v_lshlrev_b32 v220, 16, v44
 v_and_b32 v221, s97, v44
 v_lshlrev_b32 v222, 16, v45
 v_and_b32 v223, s97, v45
 v_pk_fma_f32 v[220:221], v[220:221], v[216:217], v[218:219]
 v_pk_fma_f32 v[222:223], v[222:223], v[216:217], v[218:219]
 v_cvt_pk_bf16_f32 v44, v220, v221
 v_cvt_pk_bf16_f32 v45, v222, v223
 v_lshlrev_b32 v220, 16, v46
 v_and_b32 v221, s97, v46
 v_lshlrev_b32 v222, 16, v47
 v_and_b32 v223, s97, v47
 v_pk_fma_f32 v[220:221], v[220:221], v[216:217], v[218:219]
 v_pk_fma_f32 v[222:223], v[222:223], v[216:217], v[218:219]
 v_cvt_pk_bf16_f32 v46, v220, v221
 v_cvt_pk_bf16_f32 v47, v222, v223
 v_lshlrev_b32 v220, 16, v48
 v_and_b32 v221, s97, v48
 v_lshlrev_b32 v222, 16, v49
 v_and_b32 v223, s97, v49
 v_pk_fma_f32 v[220:221], v[220:221], v[212:213], v[214:215]
 v_pk_fma_f32 v[222:223], v[222:223], v[212:213], v[214:215]
 v_cvt_pk_bf16_f32 v48, v220, v221
 v_cvt_pk_bf16_f32 v49, v222, v223
 v_lshlrev_b32 v220, 16, v50
 v_and_b32 v221, s97, v50
 v_lshlrev_b32 v222, 16, v51
 v_and_b32 v223, s97, v51
 v_pk_fma_f32 v[220:221], v[220:221], v[212:213], v[214:215]
 v_pk_fma_f32 v[222:223], v[222:223], v[212:213], v[214:215]
 v_cvt_pk_bf16_f32 v50, v220, v221
 v_cvt_pk_bf16_f32 v51, v222, v223
 v_lshlrev_b32 v220, 16, v52
 v_and_b32 v221, s97, v52
 v_lshlrev_b32 v222, 16, v53
 v_and_b32 v223, s97, v53
 v_pk_fma_f32 v[220:221], v[220:221], v[216:217], v[218:219]
 v_pk_fma_f32 v[222:223], v[222:223], v[216:217], v[218:219]
 v_cvt_pk_bf16_f32 v52, v220, v221
 v_cvt_pk_bf16_f32 v53, v222, v223
 s_add_u32 m0, s64, 32768
 s_mov_b32 s65, 2359296
 buffer_load_dwordx4 v248, s[32:35], s65 offen lds
 v_lshlrev_b32 v220, 16, v54
 v_and_b32 v221, s97, v54
 v_lshlrev_b32 v222, 16, v55
 v_and_b32 v223, s97, v55
 v_pk_fma_f32 v[220:221], v[220:221], v[216:217], v[218:219]
 v_pk_fma_f32 v[222:223], v[222:223], v[216:217], v[218:219]
 v_cvt_pk_bf16_f32 v54, v220, v221
 v_cvt_pk_bf16_f32 v55, v222, v223
 v_lshlrev_b32 v220, 16, v56
 v_and_b32 v221, s97, v56
 v_lshlrev_b32 v222, 16, v57
 v_and_b32 v223, s97, v57
 v_pk_fma_f32 v[220:221], v[220:221], v[212:213], v[214:215]
 v_pk_fma_f32 v[222:223], v[222:223], v[212:213], v[214:215]
 v_cvt_pk_bf16_f32 v56, v220, v221
 v_cvt_pk_bf16_f32 v57, v222, v223
 v_lshlrev_b32 v220, 16, v58
 v_and_b32 v221, s97, v58
 v_lshlrev_b32 v222, 16, v59
 v_and_b32 v223, s97, v59
 v_pk_fma_f32 v[220:221], v[220:221], v[212:213], v[214:215]
 v_pk_fma_f32 v[222:223], v[222:223], v[212:213], v[214:215]
 v_cvt_pk_bf16_f32 v58, v220, v221
 v_cvt_pk_bf16_f32 v59, v222, v223
 v_lshlrev_b32 v220, 16, v60
 v_and_b32 v221, s97, v60
 v_lshlrev_b32 v222, 16, v61
 v_and_b32 v223, s97, v61
 v_pk_fma_f32 v[220:221], v[220:221], v[216:217], v[218:219]
 v_pk_fma_f32 v[222:223], v[222:223], v[216:217], v[218:219]
 v_cvt_pk_bf16_f32 v60, v220, v221
 v_cvt_pk_bf16_f32 v61, v222, v223
 v_lshlrev_b32 v220, 16, v62
 v_and_b32 v221, s97, v62
 v_lshlrev_b32 v222, 16, v63
 v_and_b32 v223, s97, v63
 v_pk_fma_f32 v[220:221], v[220:221], v[216:217], v[218:219]
 v_pk_fma_f32 v[222:223], v[222:223], v[216:217], v[218:219]
 v_cvt_pk_bf16_f32 v62, v220, v221
 v_cvt_pk_bf16_f32 v63, v222, v223
 v_lshlrev_b32 v220, 16, v64
 v_and_b32 v221, s97, v64
 v_lshlrev_b32 v222, 16, v65
 v_and_b32 v223, s97, v65
 v_pk_fma_f32 v[220:221], v[220:221], v[212:213], v[214:215]
 v_pk_fma_f32 v[222:223], v[222:223], v[212:213], v[214:215]
 v_cvt_pk_bf16_f32 v64, v220, v221
 v_cvt_pk_bf16_f32 v65, v222, v223
 v_lshlrev_b32 v220, 16, v66
 v_and_b32 v221, s97, v66
 v_lshlrev_b32 v222, 16, v67
 v_and_b32 v223, s97, v67
 v_pk_fma_f32 v[220:221], v[220:221], v[212:213], v[214:215]
 v_pk_fma_f32 v[222:223], v[222:223], v[212:213], v[214:215]
 v_cvt_pk_bf16_f32 v66, v220, v221
 v_cvt_pk_bf16_f32 v67, v222, v223
 v_lshlrev_b32 v220, 16, v68
 v_and_b32 v221, s97, v68
 v_lshlrev_b32 v222, 16, v69
 v_and_b32 v223, s97, v69
 v_pk_fma_f32 v[220:221], v[220:221], v[216:217], v[218:219]
 v_pk_fma_f32 v[222:223], v[222:223], v[216:217], v[218:219]
 v_cvt_pk_bf16_f32 v68, v220, v221
 v_cvt_pk_bf16_f32 v69, v222, v223
 v_lshlrev_b32 v220, 16, v70
 v_and_b32 v221, s97, v70
 v_lshlrev_b32 v222, 16, v71
 v_and_b32 v223, s97, v71
 v_pk_fma_f32 v[220:221], v[220:221], v[216:217], v[218:219]
 v_pk_fma_f32 v[222:223], v[222:223], v[216:217], v[218:219]
 v_cvt_pk_bf16_f32 v70, v220, v221
 v_cvt_pk_bf16_f32 v71, v222, v223
 s_add_u32 m0, s64, 36864
 s_mov_b32 s65, 2654208
 buffer_load_dwordx4 v248, s[32:35], s65 offen lds
 v_lshlrev_b32 v220, 16, v72
 v_and_b32 v221, s97, v72
 v_lshlrev_b32 v222, 16, v73
 v_and_b32 v223, s97, v73
 v_pk_fma_f32 v[220:221], v[220:221], v[212:213], v[214:215]
 v_pk_fma_f32 v[222:223], v[222:223], v[212:213], v[214:215]
 v_cvt_pk_bf16_f32 v72, v220, v221
 v_cvt_pk_bf16_f32 v73, v222, v223
 v_lshlrev_b32 v220, 16, v74
 v_and_b32 v221, s97, v74
 v_lshlrev_b32 v222, 16, v75
 v_and_b32 v223, s97, v75
 v_pk_fma_f32 v[220:221], v[220:221], v[212:213], v[214:215]
 v_pk_fma_f32 v[222:223], v[222:223], v[212:213], v[214:215]
 v_cvt_pk_bf16_f32 v74, v220, v221
 v_cvt_pk_bf16_f32 v75, v222, v223
 v_lshlrev_b32 v220, 16, v76
 v_and_b32 v221, s97, v76
 v_lshlrev_b32 v222, 16, v77
 v_and_b32 v223, s97, v77
 v_pk_fma_f32 v[220:221], v[220:221], v[216:217], v[218:219]
 v_pk_fma_f32 v[222:223], v[222:223], v[216:217], v[218:219]
 v_cvt_pk_bf16_f32 v76, v220, v221
 v_cvt_pk_bf16_f32 v77, v222, v223
 v_lshlrev_b32 v220, 16, v78
 v_and_b32 v221, s97, v78
 v_lshlrev_b32 v222, 16, v79
 v_and_b32 v223, s97, v79
 v_pk_fma_f32 v[220:221], v[220:221], v[216:217], v[218:219]
 v_pk_fma_f32 v[222:223], v[222:223], v[216:217], v[218:219]
 v_cvt_pk_bf16_f32 v78, v220, v221
 v_cvt_pk_bf16_f32 v79, v222, v223
 v_lshlrev_b32 v220, 16, v80
 v_and_b32 v221, s97, v80
 v_lshlrev_b32 v222, 16, v81
 v_and_b32 v223, s97, v81
 v_pk_fma_f32 v[220:221], v[220:221], v[212:213], v[214:215]
 v_pk_fma_f32 v[222:223], v[222:223], v[212:213], v[214:215]
 v_cvt_pk_bf16_f32 v80, v220, v221
 v_cvt_pk_bf16_f32 v81, v222, v223
 v_lshlrev_b32 v220, 16, v82
 v_and_b32 v221, s97, v82
 v_lshlrev_b32 v222, 16, v83
 v_and_b32 v223, s97, v83
 v_pk_fma_f32 v[220:221], v[220:221], v[212:213], v[214:215]
 v_pk_fma_f32 v[222:223], v[222:223], v[212:213], v[214:215]
 v_cvt_pk_bf16_f32 v82, v220, v221
 v_cvt_pk_bf16_f32 v83, v222, v223
 v_lshlrev_b32 v220, 16, v84
 v_and_b32 v221, s97, v84
 v_lshlrev_b32 v222, 16, v85
 v_and_b32 v223, s97, v85
 v_pk_fma_f32 v[220:221], v[220:221], v[216:217], v[218:219]
 v_pk_fma_f32 v[222:223], v[222:223], v[216:217], v[218:219]
 v_cvt_pk_bf16_f32 v84, v220, v221
 v_cvt_pk_bf16_f32 v85, v222, v223
 v_lshlrev_b32 v220, 16, v86
 v_and_b32 v221, s97, v86
 v_lshlrev_b32 v222, 16, v87
 v_and_b32 v223, s97, v87
 v_pk_fma_f32 v[220:221], v[220:221], v[216:217], v[218:219]
 v_pk_fma_f32 v[222:223], v[222:223], v[216:217], v[218:219]
 v_cvt_pk_bf16_f32 v86, v220, v221
 v_cvt_pk_bf16_f32 v87, v222, v223
 v_lshlrev_b32 v220, 16, v88
 v_and_b32 v221, s97, v88
 v_lshlrev_b32 v222, 16, v89
 v_and_b32 v223, s97, v89
 v_pk_fma_f32 v[220:221], v[220:221], v[212:213], v[214:215]
 v_pk_fma_f32 v[222:223], v[222:223], v[212:213], v[214:215]
 v_cvt_pk_bf16_f32 v88, v220, v221
 v_cvt_pk_bf16_f32 v89, v222, v223
 s_add_u32 m0, s64, 40960
 s_mov_b32 s65, 2949120
 buffer_load_dwordx4 v248, s[32:35], s65 offen lds
 v_lshlrev_b32 v220, 16, v90
 v_and_b32 v221, s97, v90
 v_lshlrev_b32 v222, 16, v91
 v_and_b32 v223, s97, v91
 v_pk_fma_f32 v[220:221], v[220:221], v[212:213], v[214:215]
 v_pk_fma_f32 v[222:223], v[222:223], v[212:213], v[214:215]
 v_cvt_pk_bf16_f32 v90, v220, v221
 v_cvt_pk_bf16_f32 v91, v222, v223
 v_lshlrev_b32 v220, 16, v92
 v_and_b32 v221, s97, v92
 v_lshlrev_b32 v222, 16, v93
 v_and_b32 v223, s97, v93
 v_pk_fma_f32 v[220:221], v[220:221], v[216:217], v[218:219]
 v_pk_fma_f32 v[222:223], v[222:223], v[216:217], v[218:219]
 v_cvt_pk_bf16_f32 v92, v220, v221
 v_cvt_pk_bf16_f32 v93, v222, v223
 v_lshlrev_b32 v220, 16, v94
 v_and_b32 v221, s97, v94
 v_lshlrev_b32 v222, 16, v95
 v_and_b32 v223, s97, v95
 v_pk_fma_f32 v[220:221], v[220:221], v[216:217], v[218:219]
 v_pk_fma_f32 v[222:223], v[222:223], v[216:217], v[218:219]
 v_cvt_pk_bf16_f32 v94, v220, v221
 v_cvt_pk_bf16_f32 v95, v222, v223
 v_lshlrev_b32 v220, 16, v96
 v_and_b32 v221, s97, v96
 v_lshlrev_b32 v222, 16, v97
 v_and_b32 v223, s97, v97
 v_pk_fma_f32 v[220:221], v[220:221], v[212:213], v[214:215]
 v_pk_fma_f32 v[222:223], v[222:223], v[212:213], v[214:215]
 v_cvt_pk_bf16_f32 v96, v220, v221
 v_cvt_pk_bf16_f32 v97, v222, v223
 v_lshlrev_b32 v220, 16, v98
 v_and_b32 v221, s97, v98
 v_lshlrev_b32 v222, 16, v99
 v_and_b32 v223, s97, v99
 v_pk_fma_f32 v[220:221], v[220:221], v[212:213], v[214:215]
 v_pk_fma_f32 v[222:223], v[222:223], v[212:213], v[214:215]
 v_cvt_pk_bf16_f32 v98, v220, v221
 v_cvt_pk_bf16_f32 v99, v222, v223
 v_lshlrev_b32 v220, 16, v100
 v_and_b32 v221, s97, v100
 v_lshlrev_b32 v222, 16, v101
 v_and_b32 v223, s97, v101
 v_pk_fma_f32 v[220:221], v[220:221], v[216:217], v[218:219]
 v_pk_fma_f32 v[222:223], v[222:223], v[216:217], v[218:219]
 v_cvt_pk_bf16_f32 v100, v220, v221
 v_cvt_pk_bf16_f32 v101, v222, v223
 v_lshlrev_b32 v220, 16, v102
 v_and_b32 v221, s97, v102
 v_lshlrev_b32 v222, 16, v103
 v_and_b32 v223, s97, v103
 v_pk_fma_f32 v[220:221], v[220:221], v[216:217], v[218:219]
 v_pk_fma_f32 v[222:223], v[222:223], v[216:217], v[218:219]
 v_cvt_pk_bf16_f32 v102, v220, v221
 v_cvt_pk_bf16_f32 v103, v222, v223
 v_lshlrev_b32 v220, 16, v104
 v_and_b32 v221, s97, v104
 v_lshlrev_b32 v222, 16, v105
 v_and_b32 v223, s97, v105
 v_pk_fma_f32 v[220:221], v[220:221], v[212:213], v[214:215]
 v_pk_fma_f32 v[222:223], v[222:223], v[212:213], v[214:215]
 v_cvt_pk_bf16_f32 v104, v220, v221
 v_cvt_pk_bf16_f32 v105, v222, v223
 v_lshlrev_b32 v220, 16, v106
 v_and_b32 v221, s97, v106
 v_lshlrev_b32 v222, 16, v107
 v_and_b32 v223, s97, v107
 v_pk_fma_f32 v[220:221], v[220:221], v[212:213], v[214:215]
 v_pk_fma_f32 v[222:223], v[222:223], v[212:213], v[214:215]
 v_cvt_pk_bf16_f32 v106, v220, v221
 v_cvt_pk_bf16_f32 v107, v222, v223
 s_add_u32 m0, s64, 45056
 s_mov_b32 s65, 3244032
 buffer_load_dwordx4 v248, s[32:35], s65 offen lds
 v_lshlrev_b32 v220, 16, v108
 v_and_b32 v221, s97, v108
 v_lshlrev_b32 v222, 16, v109
 v_and_b32 v223, s97, v109
 v_pk_fma_f32 v[220:221], v[220:221], v[216:217], v[218:219]
 v_pk_fma_f32 v[222:223], v[222:223], v[216:217], v[218:219]
 v_cvt_pk_bf16_f32 v108, v220, v221
 v_cvt_pk_bf16_f32 v109, v222, v223
 v_lshlrev_b32 v220, 16, v110
 v_and_b32 v221, s97, v110
 v_lshlrev_b32 v222, 16, v111
 v_and_b32 v223, s97, v111
 v_pk_fma_f32 v[220:221], v[220:221], v[216:217], v[218:219]
 v_pk_fma_f32 v[222:223], v[222:223], v[216:217], v[218:219]
 v_cvt_pk_bf16_f32 v110, v220, v221
 v_cvt_pk_bf16_f32 v111, v222, v223
 v_lshlrev_b32 v220, 16, v112
 v_and_b32 v221, s97, v112
 v_lshlrev_b32 v222, 16, v113
 v_and_b32 v223, s97, v113
 v_pk_fma_f32 v[220:221], v[220:221], v[212:213], v[214:215]
 v_pk_fma_f32 v[222:223], v[222:223], v[212:213], v[214:215]
 v_cvt_pk_bf16_f32 v112, v220, v221
 v_cvt_pk_bf16_f32 v113, v222, v223
 v_lshlrev_b32 v220, 16, v114
 v_and_b32 v221, s97, v114
 v_lshlrev_b32 v222, 16, v115
 v_and_b32 v223, s97, v115
 v_pk_fma_f32 v[220:221], v[220:221], v[212:213], v[214:215]
 v_pk_fma_f32 v[222:223], v[222:223], v[212:213], v[214:215]
 v_cvt_pk_bf16_f32 v114, v220, v221
 v_cvt_pk_bf16_f32 v115, v222, v223
 v_lshlrev_b32 v220, 16, v116
 v_and_b32 v221, s97, v116
 v_lshlrev_b32 v222, 16, v117
 v_and_b32 v223, s97, v117
 v_pk_fma_f32 v[220:221], v[220:221], v[216:217], v[218:219]
 v_pk_fma_f32 v[222:223], v[222:223], v[216:217], v[218:219]
 v_cvt_pk_bf16_f32 v116, v220, v221
 v_cvt_pk_bf16_f32 v117, v222, v223
 v_lshlrev_b32 v220, 16, v118
 v_and_b32 v221, s97, v118
 v_lshlrev_b32 v222, 16, v119
 v_and_b32 v223, s97, v119
 v_pk_fma_f32 v[220:221], v[220:221], v[216:217], v[218:219]
 v_pk_fma_f32 v[222:223], v[222:223], v[216:217], v[218:219]
 v_cvt_pk_bf16_f32 v118, v220, v221
 v_cvt_pk_bf16_f32 v119, v222, v223
 v_lshlrev_b32 v220, 16, v120
 v_and_b32 v221, s97, v120
 v_lshlrev_b32 v222, 16, v121
 v_and_b32 v223, s97, v121
 v_pk_fma_f32 v[220:221], v[220:221], v[212:213], v[214:215]
 v_pk_fma_f32 v[222:223], v[222:223], v[212:213], v[214:215]
 v_cvt_pk_bf16_f32 v120, v220, v221
 v_cvt_pk_bf16_f32 v121, v222, v223
 v_lshlrev_b32 v220, 16, v122
 v_and_b32 v221, s97, v122
 v_lshlrev_b32 v222, 16, v123
 v_and_b32 v223, s97, v123
 v_pk_fma_f32 v[220:221], v[220:221], v[212:213], v[214:215]
 v_pk_fma_f32 v[222:223], v[222:223], v[212:213], v[214:215]
 v_cvt_pk_bf16_f32 v122, v220, v221
 v_cvt_pk_bf16_f32 v123, v222, v223
 v_lshlrev_b32 v220, 16, v124
 v_and_b32 v221, s97, v124
 v_lshlrev_b32 v222, 16, v125
 v_and_b32 v223, s97, v125
 v_pk_fma_f32 v[220:221], v[220:221], v[216:217], v[218:219]
 v_pk_fma_f32 v[222:223], v[222:223], v[216:217], v[218:219]
 v_cvt_pk_bf16_f32 v124, v220, v221
 v_cvt_pk_bf16_f32 v125, v222, v223
 v_lshlrev_b32 v220, 16, v126
 v_and_b32 v221, s97, v126
 v_lshlrev_b32 v222, 16, v127
 v_and_b32 v223, s97, v127
 v_pk_fma_f32 v[220:221], v[220:221], v[216:217], v[218:219]
 v_pk_fma_f32 v[222:223], v[222:223], v[216:217], v[218:219]
 v_cvt_pk_bf16_f32 v126, v220, v221
 v_cvt_pk_bf16_f32 v127, v222, v223
 v_lshlrev_b32 v220, 16, v128
 v_and_b32 v221, s97, v128
 v_lshlrev_b32 v222, 16, v129
 v_and_b32 v223, s97, v129
 v_pk_fma_f32 v[220:221], v[220:221], v[212:213], v[214:215]
 v_pk_fma_f32 v[222:223], v[222:223], v[212:213], v[214:215]
 v_cvt_pk_bf16_f32 v128, v220, v221
 v_cvt_pk_bf16_f32 v129, v222, v223
 v_lshlrev_b32 v220, 16, v130
 v_and_b32 v221, s97, v130
 v_lshlrev_b32 v222, 16, v131
 v_and_b32 v223, s97, v131
 v_pk_fma_f32 v[220:221], v[220:221], v[212:213], v[214:215]
 v_pk_fma_f32 v[222:223], v[222:223], v[212:213], v[214:215]
 v_cvt_pk_bf16_f32 v130, v220, v221
 v_cvt_pk_bf16_f32 v131, v222, v223
 v_lshlrev_b32 v220, 16, v132
 v_and_b32 v221, s97, v132
 v_lshlrev_b32 v222, 16, v133
 v_and_b32 v223, s97, v133
 v_pk_fma_f32 v[220:221], v[220:221], v[216:217], v[218:219]
 v_pk_fma_f32 v[222:223], v[222:223], v[216:217], v[218:219]
 v_cvt_pk_bf16_f32 v132, v220, v221
 v_cvt_pk_bf16_f32 v133, v222, v223
 v_lshlrev_b32 v220, 16, v134
 v_and_b32 v221, s97, v134
 v_lshlrev_b32 v222, 16, v135
 v_and_b32 v223, s97, v135
 v_pk_fma_f32 v[220:221], v[220:221], v[216:217], v[218:219]
 v_pk_fma_f32 v[222:223], v[222:223], v[216:217], v[218:219]
 v_cvt_pk_bf16_f32 v134, v220, v221
 v_cvt_pk_bf16_f32 v135, v222, v223
 v_lshlrev_b32 v220, 16, v136
 v_and_b32 v221, s97, v136
 v_lshlrev_b32 v222, 16, v137
 v_and_b32 v223, s97, v137
 v_pk_fma_f32 v[220:221], v[220:221], v[212:213], v[214:215]
 v_pk_fma_f32 v[222:223], v[222:223], v[212:213], v[214:215]
 v_cvt_pk_bf16_f32 v136, v220, v221
 v_cvt_pk_bf16_f32 v137, v222, v223
 v_lshlrev_b32 v220, 16, v138
 v_and_b32 v221, s97, v138
 v_lshlrev_b32 v222, 16, v139
 v_and_b32 v223, s97, v139
 v_pk_fma_f32 v[220:221], v[220:221], v[212:213], v[214:215]
 v_pk_fma_f32 v[222:223], v[222:223], v[212:213], v[214:215]
 v_cvt_pk_bf16_f32 v138, v220, v221
 v_cvt_pk_bf16_f32 v139, v222, v223
 v_lshlrev_b32 v220, 16, v140
 v_and_b32 v221, s97, v140
 v_lshlrev_b32 v222, 16, v141
 v_and_b32 v223, s97, v141
 v_pk_fma_f32 v[220:221], v[220:221], v[216:217], v[218:219]
 v_pk_fma_f32 v[222:223], v[222:223], v[216:217], v[218:219]
 v_cvt_pk_bf16_f32 v140, v220, v221
 v_cvt_pk_bf16_f32 v141, v222, v223
 v_lshlrev_b32 v220, 16, v142
 v_and_b32 v221, s97, v142
 v_lshlrev_b32 v222, 16, v143
 v_and_b32 v223, s97, v143
 v_pk_fma_f32 v[220:221], v[220:221], v[216:217], v[218:219]
 v_pk_fma_f32 v[222:223], v[222:223], v[216:217], v[218:219]
 v_cvt_pk_bf16_f32 v142, v220, v221
 v_cvt_pk_bf16_f32 v143, v222, v223
L_ffn_main:
 s_waitcnt vmcnt(6)
 s_barrier
 ds_read_b64_tr_b16 a[144:145], v236 offset:0
 ds_read_b64_tr_b16 a[146:147], v236 offset:256
 ds_read_b64_tr_b16 a[148:149], v237 offset:0
 ds_read_b64_tr_b16 a[150:151], v237 offset:256
 ds_read_b64_tr_b16 a[152:153], v236 offset:512
 ds_read_b64_tr_b16 a[154:155], v236 offset:768
 ds_read_b64_tr_b16 a[156:157], v237 offset:512
 ds_read_b64_tr_b16 a[158:159], v237 offset:768
 s_waitcnt lgkmcnt(6)
 v_mfma_f32_16x16x32_bf16 v[144:147], a[144:147], v[0:3], 0
 s_mov_b32 s48, s20
 ds_read_b64_tr_b16 a[160:161], v236 offset:4096
 ds_read_b64_tr_b16 a[162:163], v236 offset:4352
 v_mfma_f32_16x16x32_bf16 v[148:151], a[144:147], v[4:7], 0
 s_waitcnt lgkmcnt(6)
 v_mfma_f32_16x16x32_bf16 v[156:159], a[148:151], v[4:7], 0
 s_add_u32 m0, s64, 49152
 ds_read_b64_tr_b16 a[164:165], v237 offset:4096
 ds_read_b64_tr_b16 a[166:167], v237 offset:4352
 v_mfma_f32_16x16x32_bf16 v[152:155], a[148:151], v[0:3], 0
 s_waitcnt lgkmcnt(6)
 s_mov_b32 s49, s21
 s_mov_b32 s50, 2359296
 v_mfma_f32_16x16x32_bf16 v[160:163], a[152:155], v[0:3], 0
 s_mov_b32 s65, 3538944
 ds_read_b64_tr_b16 a[168:169], v236 offset:4608
 ds_read_b64_tr_b16 a[170:171], v236 offset:4864
 v_mfma_f32_16x16x32_bf16 v[164:167], a[152:155], v[4:7], 0
 s_waitcnt lgkmcnt(6)
 buffer_load_dwordx4 v248, s[32:35], s65 offen lds
 v_mfma_f32_16x16x32_bf16 v[172:175], a[156:159], v[4:7], 0
 s_add_u32 m0, s64, 53248
 ds_read_b64_tr_b16 a[172:173], v237 offset:4608
 ds_read_b64_tr_b16 a[174:175], v237 offset:4864
 v_mfma_f32_16x16x32_bf16 v[168:171], a[156:159], v[0:3], 0
 s_waitcnt lgkmcnt(6)
 s_mov_b32 s51, 0x20000
 s_mov_b32 s40, s12
 v_mfma_f32_16x16x32_bf16 v[144:147], a[160:163], v[8:11], v[144:147]
 s_mov_b32 s65, 3833856
 ds_read_b64_tr_b16 a[144:145], v236 offset:8192
 ds_read_b64_tr_b16 a[146:147], v236 offset:8448
 v_mfma_f32_16x16x32_bf16 v[148:151], a[160:163], v[12:15], v[148:151]
 s_waitcnt lgkmcnt(6)
 buffer_load_dwordx4 v248, s[32:35], s65 offen lds
 v_mfma_f32_16x16x32_bf16 v[156:159], a[164:167], v[12:15], v[156:159]
 s_add_u32 m0, s64, 57344
 ds_read_b64_tr_b16 a[148:149], v237 offset:8192
 ds_read_b64_tr_b16 a[150:151], v237 offset:8448
 v_mfma_f32_16x16x32_bf16 v[152:155], a[164:167], v[8:11], v[152:155]
 s_waitcnt lgkmcnt(6)
 s_mov_b32 s41, s13
 s_mov_b32 s42, 663552
 v_mfma_f32_16x16x32_bf16 v[160:163], a[168:171], v[8:11], v[160:163]
 s_mov_b32 s65, 4128768
 ds_read_b64_tr_b16 a[152:153], v236 offset:8704
 ds_read_b64_tr_b16 a[154:155], v236 offset:8960
 v_mfma_f32_16x16x32_bf16 v[164:167], a[168:171], v[12:15], v[164:167]
 s_waitcnt lgkmcnt(6)
 buffer_load_dwordx4 v248, s[32:35], s65 offen lds
 v_mfma_f32_16x16x32_bf16 v[172:175], a[172:175], v[12:15], v[172:175]
 s_add_u32 m0, s64, 61440
 ds_read_b64_tr_b16 a[156:157], v237 offset:8704
 ds_read_b64_tr_b16 a[158:159], v237 offset:8960
 v_mfma_f32_16x16x32_bf16 v[168:171], a[172:175], v[8:11], v[168:171]
 s_waitcnt lgkmcnt(6)
 s_mov_b32 s43, 0x20000
 s_mul_i32 s67, s61, 663552
 v_mfma_f32_16x16x32_bf16 v[144:147], a[144:147], v[16:19], v[144:147]
 s_mov_b32 s65, 4423680
 ds_read_b64_tr_b16 a[160:161], v236 offset:12288
 ds_read_b64_tr_b16 a[162:163], v236 offset:12544
 v_mfma_f32_16x16x32_bf16 v[148:151], a[144:147], v[20:23], v[148:151]
 s_waitcnt lgkmcnt(6)
 buffer_load_dwordx4 v248, s[32:35], s65 offen lds
 v_mfma_f32_16x16x32_bf16 v[156:159], a[148:151], v[20:23], v[156:159]
 s_add_u32 m0, s64, 65536
 ds_read_b64_tr_b16 a[164:165], v237 offset:12288
 ds_read_b64_tr_b16 a[166:167], v237 offset:12544
 v_mfma_f32_16x16x32_bf16 v[152:155], a[148:151], v[16:19], v[152:155]
 s_waitcnt lgkmcnt(6)
 s_add_u32 s36, s18, s67
 s_addc_u32 s37, s19, 0
 s_mov_b32 s38, 663552
 v_mfma_f32_16x16x32_bf16 v[160:163], a[152:155], v[16:19], v[160:163]
 s_mov_b32 s65, 4718592
 ds_read_b64_tr_b16 a[168:169], v236 offset:12800
 ds_read_b64_tr_b16 a[170:171], v236 offset:13056
 v_mfma_f32_16x16x32_bf16 v[164:167], a[152:155], v[20:23], v[164:167]
 s_waitcnt lgkmcnt(6)
 buffer_load_dwordx4 v248, s[32:35], s65 offen lds
 v_mfma_f32_16x16x32_bf16 v[172:175], a[156:159], v[20:23], v[172:175]
 s_add_u32 m0, s64, 69632
 ds_read_b64_tr_b16 a[172:173], v237 offset:12800
 ds_read_b64_tr_b16 a[174:175], v237 offset:13056
 v_mfma_f32_16x16x32_bf16 v[168:171], a[156:159], v[16:19], v[168:171]
 s_waitcnt lgkmcnt(6)
 s_mov_b32 s39, 0x20000
 s_add_u32 s67, s61, 1
 v_mfma_f32_16x16x32_bf16 v[144:147], a[160:163], v[24:27], v[144:147]
 s_mov_b32 s65, 5013504
 ds_read_b64_tr_b16 a[144:145], v236 offset:16384
 ds_read_b64_tr_b16 a[146:147], v236 offset:16640
 v_mfma_f32_16x16x32_bf16 v[148:151], a[160:163], v[28:31], v[148:151]
 s_waitcnt lgkmcnt(6)
 buffer_load_dwordx4 v248, s[32:35], s65 offen lds
 v_mfma_f32_16x16x32_bf16 v[156:159], a[164:167], v[28:31], v[156:159]
 s_add_u32 m0, s64, 73728
 ds_read_b64_tr_b16 a[148:149], v237 offset:16384
 ds_read_b64_tr_b16 a[150:151], v237 offset:16640
 v_mfma_f32_16x16x32_bf16 v[152:155], a[164:167], v[24:27], v[152:155]
 s_waitcnt lgkmcnt(6)
 s_and_b32 s67, s67, 7
 s_lshl_b32 s80, s67, 7
 v_mfma_f32_16x16x32_bf16 v[160:163], a[168:171], v[24:27], v[160:163]
 s_mov_b32 s65, 128
 ds_read_b64_tr_b16 a[152:153], v236 offset:16896
 ds_read_b64_tr_b16 a[154:155], v236 offset:17152
 v_mfma_f32_16x16x32_bf16 v[164:167], a[168:171], v[28:31], v[164:167]
 s_waitcnt lgkmcnt(6)
 buffer_load_dwordx4 v248, s[32:35], s65 offen lds
 v_mfma_f32_16x16x32_bf16 v[172:175], a[172:175], v[28:31], v[172:175]
 s_add_u32 m0, s64, 77824
 ds_read_b64_tr_b16 a[156:157], v237 offset:16896
 ds_read_b64_tr_b16 a[158:159], v237 offset:17152
 v_mfma_f32_16x16x32_bf16 v[168:171], a[172:175], v[24:27], v[168:171]
 s_waitcnt lgkmcnt(6)
 s_add_u32 s67, s61, 2
 s_and_b32 s67, s67, 7
 v_mfma_f32_16x16x32_bf16 v[144:147], a[144:147], v[32:35], v[144:147]
 s_mov_b32 s65, 295040
 ds_read_b64_tr_b16 a[160:161], v236 offset:20480
 ds_read_b64_tr_b16 a[162:163], v236 offset:20736
 v_mfma_f32_16x16x32_bf16 v[148:151], a[144:147], v[36:39], v[148:151]
 s_waitcnt lgkmcnt(6)
 buffer_load_dwordx4 v248, s[32:35], s65 offen lds
 v_mfma_f32_16x16x32_bf16 v[156:159], a[148:151], v[36:39], v[156:159]
 s_add_u32 m0, s64, 81920
 ds_read_b64_tr_b16 a[164:165], v237 offset:20480
 ds_read_b64_tr_b16 a[166:167], v237 offset:20736
 v_mfma_f32_16x16x32_bf16 v[152:155], a[148:151], v[32:35], v[152:155]
 s_waitcnt lgkmcnt(6)
 s_lshl_b32 s81, s67, 7
 s_add_u32 s67, s61, 3
 v_mfma_f32_16x16x32_bf16 v[160:163], a[152:155], v[32:35], v[160:163]
 s_mov_b32 s65, 589952
 ds_read_b64_tr_b16 a[168:169], v236 offset:20992
 ds_read_b64_tr_b16 a[170:171], v236 offset:21248
 v_mfma_f32_16x16x32_bf16 v[164:167], a[152:155], v[36:39], v[164:167]
 s_waitcnt lgkmcnt(6)
 buffer_load_dwordx4 v248, s[32:35], s65 offen lds
 v_mfma_f32_16x16x32_bf16 v[172:175], a[156:159], v[36:39], v[172:175]
 s_add_u32 m0, s64, 86016
 ds_read_b64_tr_b16 a[172:173], v237 offset:20992
 ds_read_b64_tr_b16 a[174:175], v237 offset:21248
 v_mfma_f32_16x16x32_bf16 v[168:171], a[156:159], v[32:35], v[168:171]
 s_waitcnt lgkmcnt(6)
 s_and_b32 s67, s67, 7
 s_lshl_b32 s82, s67, 7
 v_mfma_f32_16x16x32_bf16 v[144:147], a[160:163], v[40:43], v[144:147]
 s_mov_b32 s65, 884864
 s_waitcnt vmcnt(9)
 s_barrier
 ds_read_b64_tr_b16 a[144:145], v236 offset:24576
 ds_read_b64_tr_b16 a[146:147], v236 offset:24832
 v_mfma_f32_16x16x32_bf16 v[148:151], a[160:163], v[44:47], v[148:151]
 s_waitcnt lgkmcnt(6)
 buffer_load_dwordx4 v248, s[32:35], s65 offen lds
 v_mfma_f32_16x16x32_bf16 v[156:159], a[164:167], v[44:47], v[156:159]
 s_add_u32 m0, s64, 90112
 ds_read_b64_tr_b16 a[148:149], v237 offset:24576
 ds_read_b64_tr_b16 a[150:151], v237 offset:24832
 v_mfma_f32_16x16x32_bf16 v[152:155], a[164:167], v[40:43], v[152:155]
 s_waitcnt lgkmcnt(6)
 s_add_u32 s67, s61, 4
 s_and_b32 s67, s67, 7
 v_mfma_f32_16x16x32_bf16 v[160:163], a[168:171], v[40:43], v[160:163]
 s_mov_b32 s65, 1179776
 ds_read_b64_tr_b16 a[152:153], v236 offset:25088
 ds_read_b64_tr_b16 a[154:155], v236 offset:25344
 v_mfma_f32_16x16x32_bf16 v[164:167], a[168:171], v[44:47], v[164:167]
 s_waitcnt lgkmcnt(6)
 buffer_load_dwordx4 v248, s[32:35], s65 offen lds
 v_mfma_f32_16x16x32_bf16 v[172:175], a[172:175], v[44:47], v[172:175]
 s_add_u32 m0, s64, 94208
 ds_read_b64_tr_b16 a[156:157], v237 offset:25088
 ds_read_b64_tr_b16 a[158:159], v237 offset:25344
 v_mfma_f32_16x16x32_bf16 v[168:171], a[172:175], v[40:43], v[168:171]
 s_waitcnt lgkmcnt(6)
 s_lshl_b32 s83, s67, 7
 s_add_u32 s67, s61, 5
 v_mfma_f32_16x16x32_bf16 v[144:147], a[144:147], v[48:51], v[144:147]
 s_mov_b32 s65, 1474688
 ds_read_b64_tr_b16 a[160:161], v236 offset:28672
 ds_read_b64_tr_b16 a[162:163], v236 offset:28928
 v_mfma_f32_16x16x32_bf16 v[148:151], a[144:147], v[52:55], v[148:151]
 s_waitcnt lgkmcnt(6)
 buffer_load_dwordx4 v248, s[32:35], s65 offen lds
 v_mfma_f32_16x16x32_bf16 v[156:159], a[148:151], v[52:55], v[156:159]
 s_add_u32 m0, s64, 98304
 ds_read_b64_tr_b16 a[164:165], v237 offset:28672
 ds_read_b64_tr_b16 a[166:167], v237 offset:28928
 v_mfma_f32_16x16x32_bf16 v[152:155], a[148:151], v[48:51], v[152:155]
 s_waitcnt lgkmcnt(6)
 s_and_b32 s67, s67, 7
 s_lshl_b32 s84, s67, 7
 v_mfma_f32_16x16x32_bf16 v[160:163], a[152:155], v[48:51], v[160:163]
 s_mov_b32 s65, 1769600
 ds_read_b64_tr_b16 a[168:169], v236 offset:29184
 ds_read_b64_tr_b16 a[170:171], v236 offset:29440
 v_mfma_f32_16x16x32_bf16 v[164:167], a[152:155], v[52:55], v[164:167]
 s_waitcnt lgkmcnt(6)
 buffer_load_dwordx4 v248, s[32:35], s65 offen lds
 v_mfma_f32_16x16x32_bf16 v[172:175], a[156:159], v[52:55], v[172:175]
 s_add_u32 m0, s64, 102400
 ds_read_b64_tr_b16 a[172:173], v237 offset:29184
 ds_read_b64_tr_b16 a[174:175], v237 offset:29440
 v_mfma_f32_16x16x32_bf16 v[168:171], a[156:159], v[48:51], v[168:171]
 s_waitcnt lgkmcnt(6)
 s_add_u32 s67, s61, 6
 s_and_b32 s67, s67, 7
 v_mfma_f32_16x16x32_bf16 v[144:147], a[160:163], v[56:59], v[144:147]
 s_mov_b32 s65, 2064512
 ds_read_b64_tr_b16 a[144:145], v236 offset:32768
 ds_read_b64_tr_b16 a[146:147], v236 offset:33024
 v_mfma_f32_16x16x32_bf16 v[148:151], a[160:163], v[60:63], v[148:151]
 s_waitcnt lgkmcnt(6)
 buffer_load_dwordx4 v248, s[32:35], s65 offen lds
 v_mfma_f32_16x16x32_bf16 v[156:159], a[164:167], v[60:63], v[156:159]
 s_add_u32 m0, s64, 106496
 ds_read_b64_tr_b16 a[148:149], v237 offset:32768
 ds_read_b64_tr_b16 a[150:151], v237 offset:33024
 v_mfma_f32_16x16x32_bf16 v[152:155], a[164:167], v[56:59], v[152:155]
 s_waitcnt lgkmcnt(6)
 s_lshl_b32 s85, s67, 7
 s_add_u32 s67, s61, 7
 v_mfma_f32_16x16x32_bf16 v[160:163], a[168:171], v[56:59], v[160:163]
 s_mov_b32 s65, 2359424
 ds_read_b64_tr_b16 a[152:153], v236 offset:33280
 ds_read_b64_tr_b16 a[154:155], v236 offset:33536
 v_mfma_f32_16x16x32_bf16 v[164:167], a[168:171], v[60:63], v[164:167]
 s_waitcnt lgkmcnt(6)
 buffer_load_dwordx4 v248, s[32:35], s65 offen lds
 v_mfma_f32_16x16x32_bf16 v[172:175], a[172:175], v[60:63], v[172:175]
 s_add_u32 m0, s64, 110592
 ds_read_b64_tr_b16 a[156:157], v237 offset:33280
 ds_read_b64_tr_b16 a[158:159], v237 offset:33536
 v_mfma_f32_16x16x32_bf16 v[168:171], a[172:175], v[56:59], v[168:171]
 s_waitcnt lgkmcnt(6)
 s_and_b32 s67, s67, 7
 s_lshl_b32 s86, s67, 7
 v_mfma_f32_16x16x32_bf16 v[144:147], a[144:147], v[64:67], v[144:147]
 s_mov_b32 s65, 2654336
 ds_read_b64_tr_b16 a[160:161], v236 offset:36864
 ds_read_b64_tr_b16 a[162:163], v236 offset:37120
 v_mfma_f32_16x16x32_bf16 v[148:151], a[144:147], v[68:71], v[148:151]
 s_waitcnt lgkmcnt(6)
 buffer_load_dwordx4 v248, s[32:35], s65 offen lds
 v_mfma_f32_16x16x32_bf16 v[156:159], a[148:151], v[68:71], v[156:159]
 s_add_u32 m0, s64, 114688
 ds_read_b64_tr_b16 a[164:165], v237 offset:36864
 ds_read_b64_tr_b16 a[166:167], v237 offset:37120
 v_mfma_f32_16x16x32_bf16 v[152:155], a[148:151], v[64:67], v[152:155]
 s_waitcnt lgkmcnt(6)
 s_mov_b32 s87, 1024
 s_mov_b32 s88, s72
 v_mfma_f32_16x16x32_bf16 v[160:163], a[152:155], v[64:67], v[160:163]
 s_mov_b32 s65, 2949248
 ds_read_b64_tr_b16 a[168:169], v236 offset:37376
 ds_read_b64_tr_b16 a[170:171], v236 offset:37632
 v_mfma_f32_16x16x32_bf16 v[164:167], a[152:155], v[68:71], v[164:167]
 s_waitcnt lgkmcnt(6)
 buffer_load_dwordx4 v248, s[32:35], s65 offen lds
 v_mfma_f32_16x16x32_bf16 v[172:175], a[156:159], v[68:71], v[172:175]
 s_add_u32 m0, s64, 118784
 ds_read_b64_tr_b16 a[172:173], v237 offset:37376
 ds_read_b64_tr_b16 a[174:175], v237 offset:37632
 v_mfma_f32_16x16x32_bf16 v[168:171], a[156:159], v[64:67], v[168:171]
 s_waitcnt lgkmcnt(6)
 s_mov_b32 s75, 3216550459
 v_bfe_u32 v224, v255, 2, 3
 v_mfma_f32_16x16x32_bf16 v[144:147], a[160:163], v[72:75], v[144:147]
 s_mov_b32 s65, 3244160
 ds_read_b64_tr_b16 a[144:145], v236 offset:40960
 ds_read_b64_tr_b16 a[146:147], v236 offset:41216
 v_mfma_f32_16x16x32_bf16 v[148:151], a[160:163], v[76:79], v[148:151]
 s_waitcnt lgkmcnt(6)
 buffer_load_dwordx4 v248, s[32:35], s65 offen lds
 v_mfma_f32_16x16x32_bf16 v[156:159], a[164:167], v[76:79], v[156:159]
 s_add_u32 m0, s64, 122880
 ds_read_b64_tr_b16 a[148:149], v237 offset:40960
 ds_read_b64_tr_b16 a[150:151], v237 offset:41216
 v_mfma_f32_16x16x32_bf16 v[152:155], a[164:167], v[72:75], v[152:155]
 s_waitcnt lgkmcnt(6)
 v_lshl_add_u32 v225, s63, 3, v224
 v_mul_u32_u24 v249, 1152, v225
 v_mfma_f32_16x16x32_bf16 v[160:163], a[168:171], v[72:75], v[160:163]
 s_mov_b32 s65, 3539072
 ds_read_b64_tr_b16 a[152:153], v236 offset:41472
 ds_read_b64_tr_b16 a[154:155], v236 offset:41728
 v_mfma_f32_16x16x32_bf16 v[164:167], a[168:171], v[76:79], v[164:167]
 s_waitcnt lgkmcnt(6)
 buffer_load_dwordx4 v248, s[32:35], s65 offen lds
 v_mfma_f32_16x16x32_bf16 v[172:175], a[172:175], v[76:79], v[172:175]
 s_add_u32 m0, s64, 126976
 ds_read_b64_tr_b16 a[156:157], v237 offset:41472
 ds_read_b64_tr_b16 a[158:159], v237 offset:41728
 v_mfma_f32_16x16x32_bf16 v[168:171], a[172:175], v[72:75], v[168:171]
 s_waitcnt lgkmcnt(6)
 v_lshrrev_b32 v226, 5, v255
 v_lshl_add_u32 v249, v226, 6, v249
 v_mfma_f32_16x16x32_bf16 v[144:147], a[144:147], v[80:83], v[144:147]
 s_mov_b32 s65, 3833984
 ds_read_b64_tr_b16 a[160:161], v236 offset:45056
 ds_read_b64_tr_b16 a[162:163], v236 offset:45312
 v_mfma_f32_16x16x32_bf16 v[148:151], a[144:147], v[84:87], v[148:151]
 s_waitcnt lgkmcnt(6)
 buffer_load_dwordx4 v248, s[32:35], s65 offen lds
 v_mfma_f32_16x16x32_bf16 v[156:159], a[148:151], v[84:87], v[156:159]
 s_add_u32 m0, s64, 131072
 ds_read_b64_tr_b16 a[164:165], v237 offset:45056
 ds_read_b64_tr_b16 a[166:167], v237 offset:45312
 v_mfma_f32_16x16x32_bf16 v[152:155], a[148:151], v[80:83], v[152:155]
 s_waitcnt lgkmcnt(6)
 v_and_b32 v226, 3, v255
 v_lshl_add_u32 v249, v226, 4, v249
 v_mfma_f32_16x16x32_bf16 v[160:163], a[152:155], v[80:83], v[160:163]
 s_mov_b32 s65, 4128896
 ds_read_b64_tr_b16 a[168:169], v236 offset:45568
 ds_read_b64_tr_b16 a[170:171], v236 offset:45824
 v_mfma_f32_16x16x32_bf16 v[164:167], a[152:155], v[84:87], v[164:167]
 s_waitcnt lgkmcnt(6)
 buffer_load_dwordx4 v248, s[32:35], s65 offen lds
 v_mfma_f32_16x16x32_bf16 v[172:175], a[156:159], v[84:87], v[172:175]
 s_add_u32 m0, s64, 135168
 ds_read_b64_tr_b16 a[172:173], v237 offset:45568
 ds_read_b64_tr_b16 a[174:175], v237 offset:45824
 v_mfma_f32_16x16x32_bf16 v[168:171], a[156:159], v[80:83], v[168:171]
 s_waitcnt lgkmcnt(6)
 v_and_b32 v226, 16, v255
 v_lshlrev_b32 v226, 1, v226
 v_mfma_f32_16x16x32_bf16 v[144:147], a[160:163], v[88:91], v[144:147]
 s_mov_b32 s65, 4423808
 s_waitcnt vmcnt(15)
 s_barrier
 ds_read_b64_tr_b16 a[144:145], v238 offset:0
 ds_read_b64_tr_b16 a[146:147], v238 offset:256
 v_mfma_f32_16x16x32_bf16 v[148:151], a[160:163], v[92:95], v[148:151]
 s_waitcnt lgkmcnt(6)
 buffer_load_dwordx4 v248, s[32:35], s65 offen lds
 v_mfma_f32_16x16x32_bf16 v[156:159], a[164:167], v[92:95], v[156:159]
 s_add_u32 m0, s64, 139264
 ds_read_b64_tr_b16 a[148:149], v239 offset:0
 ds_read_b64_tr_b16 a[150:151], v239 offset:256
 v_mfma_f32_16x16x32_bf16 v[152:155], a[164:167], v[88:91], v[152:155]
 s_waitcnt lgkmcnt(6)
 v_xor_b32 v249, v249, v226
 v_bfe_u32 v226, v255, 2, 2
 v_mfma_f32_16x16x32_bf16 v[160:163], a[168:171], v[88:91], v[160:163]
 s_mov_b32 s65, 4718720
 ds_read_b64_tr_b16 a[152:153], v238 offset:512
 ds_read_b64_tr_b16 a[154:155], v238 offset:768
 v_mfma_f32_16x16x32_bf16 v[164:167], a[168:171], v[92:95], v[164:167]
 s_waitcnt lgkmcnt(6)
 buffer_load_dwordx4 v248, s[32:35], s65 offen lds
 v_mfma_f32_16x16x32_bf16 v[172:175], a[172:175], v[92:95], v[172:175]
 s_add_u32 m0, s64, 143360
 ds_read_b64_tr_b16 a[156:157], v239 offset:512
 ds_read_b64_tr_b16 a[158:159], v239 offset:768
 v_mfma_f32_16x16x32_bf16 v[168:171], a[172:175], v[88:91], v[168:171]
 s_waitcnt lgkmcnt(6)
 v_lshlrev_b32 v242, 6, v226
 v_and_b32 v226, 3, v255
 v_mfma_f32_16x16x32_bf16 v[144:147], a[144:147], v[96:99], v[144:147]
 s_mov_b32 s65, 5013632
 ds_read_b64_tr_b16 a[160:161], v238 offset:4096
 ds_read_b64_tr_b16 a[162:163], v238 offset:4352
 v_mfma_f32_16x16x32_bf16 v[148:151], a[144:147], v[100:103], v[148:151]
 s_waitcnt lgkmcnt(6)
 buffer_load_dwordx4 v248, s[32:35], s65 offen lds
 v_mfma_f32_16x16x32_bf16 v[156:159], a[148:151], v[100:103], v[156:159]
 s_add_u32 m0, s64, 0
 ds_read_b64_tr_b16 a[164:165], v239 offset:4096
 ds_read_b64_tr_b16 a[166:167], v239 offset:4352
 v_mfma_f32_16x16x32_bf16 v[152:155], a[148:151], v[96:99], v[152:155]
 s_waitcnt lgkmcnt(6)
 v_lshl_add_u32 v242, v226, 3, v242
 v_bfe_u32 v226, v255, 4, 1
 v_mfma_f32_16x16x32_bf16 v[160:163], a[152:155], v[96:99], v[160:163]
 s_mov_b32 s65, 256
 ds_read_b64_tr_b16 a[168:169], v238 offset:4608
 ds_read_b64_tr_b16 a[170:171], v238 offset:4864
 v_mfma_f32_16x16x32_bf16 v[164:167], a[152:155], v[100:103], v[164:167]
 s_waitcnt lgkmcnt(6)
 buffer_load_dwordx4 v248, s[32:35], s65 offen lds
 v_mfma_f32_16x16x32_bf16 v[172:175], a[156:159], v[100:103], v[172:175]
 s_add_u32 m0, s64, 4096
 ds_read_b64_tr_b16 a[172:173], v239 offset:4608
 ds_read_b64_tr_b16 a[174:175], v239 offset:4864
 v_mfma_f32_16x16x32_bf16 v[168:171], a[156:159], v[96:99], v[168:171]
 s_waitcnt lgkmcnt(6)
 v_mul_u32_u24 v226, 288, v226
 v_add_u32 v242, v242, v226
 v_mfma_f32_16x16x32_bf16 v[144:147], a[160:163], v[104:107], v[144:147]
 s_mov_b32 s65, 295168
 ds_read_b64_tr_b16 a[144:145], v238 offset:8192
 ds_read_b64_tr_b16 a[146:147], v238 offset:8448
 v_mfma_f32_16x16x32_bf16 v[148:151], a[160:163], v[108:111], v[148:151]
 s_waitcnt lgkmcnt(6)
 buffer_load_dwordx4 v248, s[32:35], s65 offen lds
 v_mfma_f32_16x16x32_bf16 v[156:159], a[164:167], v[108:111], v[156:159]
 s_add_u32 m0, s64, 8192
 ds_read_b64_tr_b16 a[148:149], v239 offset:8192
 ds_read_b64_tr_b16 a[150:151], v239 offset:8448
 v_mfma_f32_16x16x32_bf16 v[152:155], a[164:167], v[104:107], v[152:155]
 s_waitcnt lgkmcnt(6)
 v_lshrrev_b32 v226, 5, v255
 v_lshl_add_u32 v242, v226, 10, v242
 v_mfma_f32_16x16x32_bf16 v[160:163], a[168:171], v[104:107], v[160:163]
 s_mov_b32 s65, 590080
 ds_read_b64_tr_b16 a[152:153], v238 offset:8704
 ds_read_b64_tr_b16 a[154:155], v238 offset:8960
 v_mfma_f32_16x16x32_bf16 v[164:167], a[168:171], v[108:111], v[164:167]
 s_waitcnt lgkmcnt(6)
 buffer_load_dwordx4 v248, s[32:35], s65 offen lds
 v_mfma_f32_16x16x32_bf16 v[172:175], a[172:175], v[108:111], v[172:175]
 s_add_u32 m0, s64, 12288
 ds_read_b64_tr_b16 a[156:157], v239 offset:8704
 ds_read_b64_tr_b16 a[158:159], v239 offset:8960
 v_mfma_f32_16x16x32_bf16 v[168:171], a[172:175], v[104:107], v[168:171]
 s_waitcnt lgkmcnt(6)
 v_xor_b32 v243, 32, v242
 v_add_u32 v244, 49152, v242
 v_mfma_f32_16x16x32_bf16 v[144:147], a[144:147], v[112:115], v[144:147]
 s_mov_b32 s65, 884992
 ds_read_b64_tr_b16 a[160:161], v238 offset:12288
 ds_read_b64_tr_b16 a[162:163], v238 offset:12544
 v_mfma_f32_16x16x32_bf16 v[148:151], a[144:147], v[116:119], v[148:151]
 s_waitcnt lgkmcnt(6)
 buffer_load_dwordx4 v248, s[32:35], s65 offen lds
 v_mfma_f32_16x16x32_bf16 v[156:159], a[148:151], v[116:119], v[156:159]
 s_add_u32 m0, s64, 16384
 ds_read_b64_tr_b16 a[164:165], v239 offset:12288
 ds_read_b64_tr_b16 a[166:167], v239 offset:12544
 v_mfma_f32_16x16x32_bf16 v[152:155], a[148:151], v[112:115], v[152:155]
 s_waitcnt lgkmcnt(6)
 v_add_u32 v245, 49152, v243
 v_add_u32 v246, 98304, v242
 v_mfma_f32_16x16x32_bf16 v[160:163], a[152:155], v[112:115], v[160:163]
 s_mov_b32 s65, 1179904
 ds_read_b64_tr_b16 a[168:169], v238 offset:12800
 ds_read_b64_tr_b16 a[170:171], v238 offset:13056
 v_mfma_f32_16x16x32_bf16 v[164:167], a[152:155], v[116:119], v[164:167]
 s_waitcnt lgkmcnt(6)
 buffer_load_dwordx4 v248, s[32:35], s65 offen lds
 v_mfma_f32_16x16x32_bf16 v[172:175], a[156:159], v[116:119], v[172:175]
 s_add_u32 m0, s64, 20480
 ds_read_b64_tr_b16 a[172:173], v239 offset:12800
 ds_read_b64_tr_b16 a[174:175], v239 offset:13056
 v_mfma_f32_16x16x32_bf16 v[168:171], a[156:159], v[112:115], v[168:171]
 s_waitcnt lgkmcnt(6)
 v_add_u32 v247, 98304, v243
 s_lshl_b32 s74, s61, 2
 v_mfma_f32_16x16x32_bf16 v[144:147], a[160:163], v[120:123], v[144:147]
 s_mov_b32 s65, 1474816
 ds_read_b64_tr_b16 a[144:145], v238 offset:16384
 ds_read_b64_tr_b16 a[146:147], v238 offset:16640
 v_mfma_f32_16x16x32_bf16 v[148:151], a[160:163], v[124:127], v[148:151]
 s_waitcnt lgkmcnt(6)
 buffer_load_dwordx4 v248, s[32:35], s65 offen lds
 v_mfma_f32_16x16x32_bf16 v[156:159], a[164:167], v[124:127], v[156:159]
 s_add_u32 s74, s74, s63
 ds_read_b64_tr_b16 a[148:149], v239 offset:16384
 ds_read_b64_tr_b16 a[150:151], v239 offset:16640
 v_mfma_f32_16x16x32_bf16 v[152:155], a[164:167], v[120:123], v[152:155]
 s_waitcnt lgkmcnt(6)
 s_lshl_b32 s74, s74, 7
 s_add_u32 s74, s74, s3
 v_mfma_f32_16x16x32_bf16 v[160:163], a[168:171], v[120:123], v[160:163]
 ds_read_b64_tr_b16 a[152:153], v238 offset:16896
 ds_read_b64_tr_b16 a[154:155], v238 offset:17152
 v_mfma_f32_16x16x32_bf16 v[164:167], a[168:171], v[124:127], v[164:167]
 s_waitcnt lgkmcnt(6)
 v_mov_b32 v225, s74
 v_accvgpr_write_b32 a242, v225
 v_mfma_f32_16x16x32_bf16 v[172:175], a[172:175], v[124:127], v[172:175]
 s_lshl_b32 s67, s60, 3
 ds_read_b64_tr_b16 a[156:157], v239 offset:16896
 ds_read_b64_tr_b16 a[158:159], v239 offset:17152
 v_mfma_f32_16x16x32_bf16 v[168:171], a[172:175], v[120:123], v[168:171]
 s_waitcnt lgkmcnt(6)
 v_and_b32 v225, 15, v255
 v_mul_u32_u24 v225, 1152, v225
 v_mfma_f32_16x16x32_bf16 v[144:147], a[144:147], v[128:131], v[144:147]
 ds_read_b64_tr_b16 a[160:161], v238 offset:20480
 ds_read_b64_tr_b16 a[162:163], v238 offset:20736
 v_mfma_f32_16x16x32_bf16 v[148:151], a[144:147], v[132:135], v[148:151]
 s_waitcnt lgkmcnt(6)
 v_add_u32 v225, s66, v225
 v_bfe_u32 v226, v255, 4, 1
 v_mfma_f32_16x16x32_bf16 v[156:159], a[148:151], v[132:135], v[156:159]
 ds_read_b64_tr_b16 a[164:165], v239 offset:20480
 ds_read_b64_tr_b16 a[166:167], v239 offset:20736
 v_mfma_f32_16x16x32_bf16 v[152:155], a[148:151], v[128:131], v[152:155]
 s_waitcnt lgkmcnt(6)
 v_lshl_add_u32 v225, v226, 5, v225
 v_lshrrev_b32 v226, 5, v255
 v_mfma_f32_16x16x32_bf16 v[160:163], a[152:155], v[128:131], v[160:163]
 ds_read_b64_tr_b16 a[168:169], v238 offset:20992
 ds_read_b64_tr_b16 a[170:171], v238 offset:21248
 v_mfma_f32_16x16x32_bf16 v[164:167], a[152:155], v[132:135], v[164:167]
 s_waitcnt lgkmcnt(6)
 v_lshl_add_u32 v225, v226, 4, v225
 v_accvgpr_write_b32 a244, v225
 v_mfma_f32_16x16x32_bf16 v[172:175], a[156:159], v[132:135], v[172:175]
 s_lshl_b32 s68, s63, 12
 ds_read_b64_tr_b16 a[172:173], v239 offset:20992
 ds_read_b64_tr_b16 a[174:175], v239 offset:21248
 v_mfma_f32_16x16x32_bf16 v[168:171], a[156:159], v[128:131], v[168:171]
 s_waitcnt lgkmcnt(6)
 v_lshl_add_u32 v250, v255, 4, s68
 s_add_u32 s67, s67, s61
 v_mfma_f32_16x16x32_bf16 v[144:147], a[160:163], v[136:139], v[144:147]
 s_mul_i32 s67, s67, 147456
 s_waitcnt vmcnt(18)
 s_barrier
 ds_read_b64_tr_b16 a[144:145], v238 offset:24576
 ds_read_b64_tr_b16 a[146:147], v238 offset:24832
 v_mfma_f32_16x16x32_bf16 v[148:151], a[160:163], v[140:143], v[148:151]
 s_waitcnt lgkmcnt(6)
 s_add_u32 s67, s67, 2621440
 s_mul_i32 s73, s60, 1179648
 v_mfma_f32_16x16x32_bf16 v[156:159], a[164:167], v[140:143], v[156:159]
 s_add_u32 m0, s64, 24576
 ds_read_b64_tr_b16 a[148:149], v239 offset:24576
 ds_read_b64_tr_b16 a[150:151], v239 offset:24832
 v_mfma_f32_16x16x32_bf16 v[152:155], a[164:167], v[136:139], v[152:155]
 s_waitcnt lgkmcnt(6)
 s_lshl_b32 s68, s61, 14
 s_add_u32 s73, s73, s68
 v_mfma_f32_16x16x32_bf16 v[160:163], a[168:171], v[136:139], v[160:163]
 s_mov_b32 s65, 1769728
 ds_read_b64_tr_b16 a[152:153], v238 offset:25088
 ds_read_b64_tr_b16 a[154:155], v238 offset:25344
 v_mfma_f32_16x16x32_bf16 v[164:167], a[168:171], v[140:143], v[164:167]
 s_waitcnt lgkmcnt(6)
 buffer_load_dwordx4 v248, s[32:35], s65 offen lds
 v_mfma_f32_16x16x32_bf16 v[172:175], a[172:175], v[140:143], v[172:175]
 s_add_u32 m0, s64, 28672
 ds_read_b64_tr_b16 a[156:157], v239 offset:25088
 ds_read_b64_tr_b16 a[158:159], v239 offset:25344
 v_mfma_f32_16x16x32_bf16 v[168:171], a[172:175], v[136:139], v[168:171]
 s_waitcnt lgkmcnt(6)
 s_add_u32 s73, s73, 2621440
 s_lshl_b32 s68, s80, 7
 s_add_u32 s89, s68, s67
 s_lshl_b32 s68, s81, 7
 s_add_u32 s90, s68, s67
 s_lshl_b32 s68, s82, 7
 s_add_u32 s91, s68, s67
 s_lshl_b32 s68, s83, 7
 s_add_u32 s92, s68, s67
 s_lshl_b32 s68, s84, 7
 s_add_u32 s93, s68, s67
 s_lshl_b32 s68, s85, 7
 s_add_u32 s94, s68, s67
 s_lshl_b32 s68, s86, 7
 s_add_u32 s95, s68, s67
 s_lshl_b32 s68, s87, 7
 s_add_u32 s96, s68, s67
 s_lshl_b32 s67, s63, 7
 s_add_u32 s67, s67, s61
 s_add_u32 s67, s67, 0
 v_lshl_add_u32 v227, v255, 9, s67
 v_mov_b32 v225, 67108864
 v_cmp_gt_u32 vcc, 1, v255
 s_nop 1
 v_cndmask_b32 v227, v225, v227, vcc
 v_accvgpr_write_b32 a245, v227
 s_lshr_b32 s68, s63, 1
 s_lshl_b32 s68, s68, 11
 s_add_u32 s68, s68, s61
 s_lshl_b32 s67, s63, 7
 s_add_u32 s67, s67, s68
 s_add_u32 s67, s67, 4128
 v_lshl_add_u32 v227, v255, 9, s67
 v_mov_b32 v225, 67108864
 v_cmp_gt_u32 vcc, 4, v255
 s_nop 1
 v_cndmask_b32 v227, v225, v227, vcc
 v_accvgpr_write_b32 a246, v227
 s_lshl_b32 s15, s63, 4
 s_add_u32 s15, s15, s61
 v_mfma_f32_16x16x32_bf16 v[176:179], a[144:147], v[0:3], 0
 s_cmp_eq_u32 s15, 0
 s_cbranch_scc1 L_hsl1
L_hsl1_ok:
 ds_read_b64_tr_b16 a[160:161], v238 offset:28672
 ds_read_b64_tr_b16 a[162:163], v238 offset:28928
 v_mfma_f32_16x16x32_bf16 v[180:183], a[144:147], v[4:7], 0
 s_waitcnt lgkmcnt(6)
 v_mfma_f32_16x16x32_bf16 v[188:191], a[148:151], v[4:7], 0
 s_add_u32 m0, s64, 28672
 ds_read_b64_tr_b16 a[164:165], v239 offset:28672
 ds_read_b64_tr_b16 a[166:167], v239 offset:28928
 v_mfma_f32_16x16x32_bf16 v[184:187], a[148:151], v[0:3], 0
 s_waitcnt lgkmcnt(6)
 v_exp_f32 v224, v144
 v_exp_f32 v225, v145
 v_mfma_f32_16x16x32_bf16 v[192:195], a[152:155], v[0:3], 0
 s_mov_b32 s65, 2064640
 ds_read_b64_tr_b16 a[168:169], v238 offset:29184
 ds_read_b64_tr_b16 a[170:171], v238 offset:29440
 buffer_load_dwordx4 v248, s[32:35], s65 offen lds
 v_mfma_f32_16x16x32_bf16 v[196:199], a[152:155], v[4:7], 0
 s_waitcnt lgkmcnt(6)
 v_fma_f32 v224, v224, s75, s75
 v_fma_f32 v225, v225, s75, s75
 v_rcp_f32 v224, v224
 v_mfma_f32_16x16x32_bf16 v[204:207], a[156:159], v[4:7], 0
 ds_read_b64_tr_b16 a[172:173], v239 offset:29184
 ds_read_b64_tr_b16 a[174:175], v239 offset:29440
 v_mfma_f32_16x16x32_bf16 v[200:203], a[156:159], v[0:3], 0
 s_waitcnt lgkmcnt(6)
 v_rcp_f32 v225, v225
 v_mfma_f32_16x16x32_bf16 v[176:179], a[160:163], v[8:11], v[176:179]
 ds_read_b64_tr_b16 a[144:145], v238 offset:32768
 ds_read_b64_tr_b16 a[146:147], v238 offset:33024
 v_mfma_f32_16x16x32_bf16 v[180:183], a[160:163], v[12:15], v[180:183]
 s_waitcnt lgkmcnt(6)
 v_mul_f32 v224, v144, v224
 v_mul_f32 v225, v145, v225
 v_cvt_pk_bf16_f32 v230, v224, v225
 v_mfma_f32_16x16x32_bf16 v[188:191], a[164:167], v[12:15], v[188:191]
 s_add_u32 m0, s64, 32768
 ds_read_b64_tr_b16 a[148:149], v239 offset:32768
 ds_read_b64_tr_b16 a[150:151], v239 offset:33024
 v_mfma_f32_16x16x32_bf16 v[184:187], a[164:167], v[8:11], v[184:187]
 s_waitcnt lgkmcnt(6)
 v_accvgpr_write_b32 a0, v230
 v_exp_f32 v226, v146
 v_mfma_f32_16x16x32_bf16 v[192:195], a[168:171], v[8:11], v[192:195]
 s_mov_b32 s65, 2359552
 ds_read_b64_tr_b16 a[152:153], v238 offset:33280
 ds_read_b64_tr_b16 a[154:155], v238 offset:33536
 buffer_load_dwordx4 v248, s[32:35], s65 offen lds
 v_mfma_f32_16x16x32_bf16 v[196:199], a[168:171], v[12:15], v[196:199]
 s_waitcnt lgkmcnt(6)
 v_exp_f32 v227, v147
 v_fma_f32 v226, v226, s75, s75
 v_mfma_f32_16x16x32_bf16 v[204:207], a[172:175], v[12:15], v[204:207]
 ds_read_b64_tr_b16 a[156:157], v239 offset:33280
 ds_read_b64_tr_b16 a[158:159], v239 offset:33536
 v_mfma_f32_16x16x32_bf16 v[200:203], a[172:175], v[8:11], v[200:203]
 s_waitcnt lgkmcnt(6)
 v_fma_f32 v227, v227, s75, s75
 v_rcp_f32 v226, v226
 v_mfma_f32_16x16x32_bf16 v[176:179], a[144:147], v[16:19], v[176:179]
 ds_read_b64_tr_b16 a[160:161], v238 offset:36864
 ds_read_b64_tr_b16 a[162:163], v238 offset:37120
 v_mfma_f32_16x16x32_bf16 v[180:183], a[144:147], v[20:23], v[180:183]
 s_waitcnt lgkmcnt(6)
 v_rcp_f32 v227, v227
 v_mul_f32 v226, v146, v226
 v_mul_f32 v227, v147, v227
 v_mfma_f32_16x16x32_bf16 v[188:191], a[148:151], v[20:23], v[188:191]
 s_add_u32 m0, s64, 36864
 ds_read_b64_tr_b16 a[164:165], v239 offset:36864
 ds_read_b64_tr_b16 a[166:167], v239 offset:37120
 v_mfma_f32_16x16x32_bf16 v[184:187], a[148:151], v[16:19], v[184:187]
 s_waitcnt lgkmcnt(6)
 v_cvt_pk_bf16_f32 v231, v226, v227
 v_accvgpr_write_b32 a1, v231
 v_exp_f32 v228, v148
 v_mfma_f32_16x16x32_bf16 v[192:195], a[152:155], v[16:19], v[192:195]
 s_mov_b32 s65, 2654464
 ds_read_b64_tr_b16 a[168:169], v238 offset:37376
 ds_read_b64_tr_b16 a[170:171], v238 offset:37632
 buffer_load_dwordx4 v248, s[32:35], s65 offen lds
 v_mfma_f32_16x16x32_bf16 v[196:199], a[152:155], v[20:23], v[196:199]
 s_waitcnt lgkmcnt(6)
 v_exp_f32 v229, v149
 v_mfma_f32_16x16x32_bf16 v[204:207], a[156:159], v[20:23], v[204:207]
 ds_read_b64_tr_b16 a[172:173], v239 offset:37376
 ds_read_b64_tr_b16 a[174:175], v239 offset:37632
 v_mfma_f32_16x16x32_bf16 v[200:203], a[156:159], v[16:19], v[200:203]
 s_waitcnt lgkmcnt(6)
 v_fma_f32 v228, v228, s75, s75
 v_fma_f32 v229, v229, s75, s75
 v_rcp_f32 v228, v228
 v_mfma_f32_16x16x32_bf16 v[176:179], a[160:163], v[24:27], v[176:179]
 ds_read_b64_tr_b16 a[144:145], v238 offset:40960
 ds_read_b64_tr_b16 a[146:147], v238 offset:41216
 v_mfma_f32_16x16x32_bf16 v[180:183], a[160:163], v[28:31], v[180:183]
 s_waitcnt lgkmcnt(6)
 v_rcp_f32 v229, v229
 v_mfma_f32_16x16x32_bf16 v[188:191], a[164:167], v[28:31], v[188:191]
 s_add_u32 m0, s64, 40960
 ds_read_b64_tr_b16 a[148:149], v239 offset:40960
 ds_read_b64_tr_b16 a[150:151], v239 offset:41216
 v_mfma_f32_16x16x32_bf16 v[184:187], a[164:167], v[24:27], v[184:187]
 s_waitcnt lgkmcnt(6)
 v_mul_f32 v228, v148, v228
 v_mul_f32 v229, v149, v229
 v_cvt_pk_bf16_f32 v232, v228, v229
 v_accvgpr_write_b32 a4, v232
 v_mfma_f32_16x16x32_bf16 v[192:195], a[168:171], v[24:27], v[192:195]
 s_mov_b32 s65, 2949376
 ds_read_b64_tr_b16 a[152:153], v238 offset:41472
 ds_read_b64_tr_b16 a[154:155], v238 offset:41728
 buffer_load_dwordx4 v248, s[32:35], s65 offen lds
 v_mfma_f32_16x16x32_bf16 v[196:199], a[168:171], v[28:31], v[196:199]
 s_waitcnt lgkmcnt(6)
 v_exp_f32 v224, v150
 v_exp_f32 v225, v151
 v_mfma_f32_16x16x32_bf16 v[204:207], a[172:175], v[28:31], v[204:207]
 ds_read_b64_tr_b16 a[156:157], v239 offset:41472
 ds_read_b64_tr_b16 a[158:159], v239 offset:41728
 v_mfma_f32_16x16x32_bf16 v[200:203], a[172:175], v[24:27], v[200:203]
 s_waitcnt lgkmcnt(6)
 v_fma_f32 v224, v224, s75, s75
 v_fma_f32 v225, v225, s75, s75
 v_mfma_f32_16x16x32_bf16 v[176:179], a[144:147], v[32:35], v[176:179]
 ds_read_b64_tr_b16 a[160:161], v238 offset:45056
 ds_read_b64_tr_b16 a[162:163], v238 offset:45312
 v_mfma_f32_16x16x32_bf16 v[180:183], a[144:147], v[36:39], v[180:183]
 s_waitcnt lgkmcnt(6)
 v_rcp_f32 v224, v224
 v_rcp_f32 v225, v225
 v_mfma_f32_16x16x32_bf16 v[188:191], a[148:151], v[36:39], v[188:191]
 s_add_u32 m0, s64, 45056
 ds_read_b64_tr_b16 a[164:165], v239 offset:45056
 ds_read_b64_tr_b16 a[166:167], v239 offset:45312
 v_mfma_f32_16x16x32_bf16 v[184:187], a[148:151], v[32:35], v[184:187]
 s_waitcnt lgkmcnt(6)
 v_mul_f32 v224, v150, v224
 v_mul_f32 v225, v151, v225
 v_mfma_f32_16x16x32_bf16 v[192:195], a[152:155], v[32:35], v[192:195]
 s_mov_b32 s65, 3244288
 ds_read_b64_tr_b16 a[168:169], v238 offset:45568
 ds_read_b64_tr_b16 a[170:171], v238 offset:45824
 buffer_load_dwordx4 v248, s[32:35], s65 offen lds
 v_mfma_f32_16x16x32_bf16 v[196:199], a[152:155], v[36:39], v[196:199]
 s_waitcnt lgkmcnt(6)
 v_cvt_pk_bf16_f32 v230, v224, v225
 v_accvgpr_write_b32 a5, v230
 v_exp_f32 v226, v152
 v_mfma_f32_16x16x32_bf16 v[204:207], a[156:159], v[36:39], v[204:207]
 ds_read_b64_tr_b16 a[172:173], v239 offset:45568
 ds_read_b64_tr_b16 a[174:175], v239 offset:45824
 v_mfma_f32_16x16x32_bf16 v[200:203], a[156:159], v[32:35], v[200:203]
 s_waitcnt lgkmcnt(6)
 v_exp_f32 v227, v153
 v_mfma_f32_16x16x32_bf16 v[176:179], a[160:163], v[40:43], v[176:179]
 s_waitcnt vmcnt(18)
 s_barrier
 ds_read_b64_tr_b16 a[144:145], v240 offset:0
 ds_read_b64_tr_b16 a[146:147], v240 offset:256
 v_mfma_f32_16x16x32_bf16 v[180:183], a[160:163], v[44:47], v[180:183]
 s_waitcnt lgkmcnt(6)
 v_fma_f32 v226, v226, s75, s75
 v_fma_f32 v227, v227, s75, s75
 v_rcp_f32 v226, v226
 v_mfma_f32_16x16x32_bf16 v[188:191], a[164:167], v[44:47], v[188:191]
 s_add_u32 m0, s64, 49152
 ds_read_b64_tr_b16 a[148:149], v241 offset:0
 ds_read_b64_tr_b16 a[150:151], v241 offset:256
 v_mfma_f32_16x16x32_bf16 v[184:187], a[164:167], v[40:43], v[184:187]
 s_waitcnt lgkmcnt(6)
 v_rcp_f32 v227, v227
 v_mul_f32 v226, v152, v226
 v_mfma_f32_16x16x32_bf16 v[192:195], a[168:171], v[40:43], v[192:195]
 s_mov_b32 s65, 3539200
 ds_read_b64_tr_b16 a[152:153], v240 offset:512
 ds_read_b64_tr_b16 a[154:155], v240 offset:768
 buffer_load_dwordx4 v248, s[32:35], s65 offen lds
 v_mfma_f32_16x16x32_bf16 v[196:199], a[168:171], v[44:47], v[196:199]
 s_waitcnt lgkmcnt(6)
 v_mul_f32 v227, v153, v227
 v_cvt_pk_bf16_f32 v231, v226, v227
 v_accvgpr_write_b32 a2, v231
 v_mfma_f32_16x16x32_bf16 v[204:207], a[172:175], v[44:47], v[204:207]
 ds_read_b64_tr_b16 a[156:157], v241 offset:512
 ds_read_b64_tr_b16 a[158:159], v241 offset:768
 v_mfma_f32_16x16x32_bf16 v[200:203], a[172:175], v[40:43], v[200:203]
 s_waitcnt lgkmcnt(6)
 v_exp_f32 v228, v154
 v_exp_f32 v229, v155
 v_mfma_f32_16x16x32_bf16 v[176:179], a[144:147], v[48:51], v[176:179]
 ds_read_b64_tr_b16 a[160:161], v240 offset:4096
 ds_read_b64_tr_b16 a[162:163], v240 offset:4352
 v_mfma_f32_16x16x32_bf16 v[180:183], a[144:147], v[52:55], v[180:183]
 s_waitcnt lgkmcnt(6)
 v_fma_f32 v228, v228, s75, s75
 v_fma_f32 v229, v229, s75, s75
 v_mfma_f32_16x16x32_bf16 v[188:191], a[148:151], v[52:55], v[188:191]
 s_add_u32 m0, s64, 53248
 ds_read_b64_tr_b16 a[164:165], v241 offset:4096
 ds_read_b64_tr_b16 a[166:167], v241 offset:4352
 v_mfma_f32_16x16x32_bf16 v[184:187], a[148:151], v[48:51], v[184:187]
 s_waitcnt lgkmcnt(6)
 v_rcp_f32 v228, v228
 v_rcp_f32 v229, v229
 v_mfma_f32_16x16x32_bf16 v[192:195], a[152:155], v[48:51], v[192:195]
 s_mov_b32 s65, 3834112
 ds_read_b64_tr_b16 a[168:169], v240 offset:4608
 ds_read_b64_tr_b16 a[170:171], v240 offset:4864
 buffer_load_dwordx4 v248, s[32:35], s65 offen lds
 v_mfma_f32_16x16x32_bf16 v[196:199], a[152:155], v[52:55], v[196:199]
 s_waitcnt lgkmcnt(6)
 v_mul_f32 v228, v154, v228
 v_mul_f32 v229, v155, v229
 v_cvt_pk_bf16_f32 v232, v228, v229
 v_mfma_f32_16x16x32_bf16 v[204:207], a[156:159], v[52:55], v[204:207]
 ds_read_b64_tr_b16 a[172:173], v241 offset:4608
 ds_read_b64_tr_b16 a[174:175], v241 offset:4864
 v_mfma_f32_16x16x32_bf16 v[200:203], a[156:159], v[48:51], v[200:203]
 s_waitcnt lgkmcnt(6)
 v_accvgpr_write_b32 a3, v232
 v_exp_f32 v224, v156
 v_mfma_f32_16x16x32_bf16 v[176:179], a[160:163], v[56:59], v[176:179]
 ds_read_b64_tr_b16 a[144:145], v240 offset:8192
 ds_read_b64_tr_b16 a[146:147], v240 offset:8448
 v_mfma_f32_16x16x32_bf16 v[180:183], a[160:163], v[60:63], v[180:183]
 s_waitcnt lgkmcnt(6)
 v_exp_f32 v225, v157
 v_fma_f32 v224, v224, s75, s75
 v_mfma_f32_16x16x32_bf16 v[188:191], a[164:167], v[60:63], v[188:191]
 s_add_u32 m0, s64, 57344
 ds_read_b64_tr_b16 a[148:149], v241 offset:8192
 ds_read_b64_tr_b16 a[150:151], v241 offset:8448
 v_mfma_f32_16x16x32_bf16 v[184:187], a[164:167], v[56:59], v[184:187]
 s_waitcnt lgkmcnt(6)
 v_fma_f32 v225, v225, s75, s75
 v_rcp_f32 v224, v224
 v_mfma_f32_16x16x32_bf16 v[192:195], a[168:171], v[56:59], v[192:195]
 s_mov_b32 s65, 4129024
 ds_read_b64_tr_b16 a[152:153], v240 offset:8704
 ds_read_b64_tr_b16 a[154:155], v240 offset:8960
 buffer_load_dwordx4 v248, s[32:35], s65 offen lds
 v_mfma_f32_16x16x32_bf16 v[196:199], a[168:171], v[60:63], v[196:199]
 s_waitcnt lgkmcnt(6)
 v_rcp_f32 v225, v225
 v_mul_f32 v224, v156, v224
 v_mfma_f32_16x16x32_bf16 v[204:207], a[172:175], v[60:63], v[204:207]
 ds_read_b64_tr_b16 a[156:157], v241 offset:8704
 ds_read_b64_tr_b16 a[158:159], v241 offset:8960
 v_mfma_f32_16x16x32_bf16 v[200:203], a[172:175], v[56:59], v[200:203]
 s_waitcnt lgkmcnt(6)
 v_mul_f32 v225, v157, v225
 v_cvt_pk_bf16_f32 v230, v224, v225
 v_accvgpr_write_b32 a6, v230
 v_mfma_f32_16x16x32_bf16 v[176:179], a[144:147], v[64:67], v[176:179]
 ds_read_b64_tr_b16 a[160:161], v240 offset:12288
 ds_read_b64_tr_b16 a[162:163], v240 offset:12544
 v_mfma_f32_16x16x32_bf16 v[180:183], a[144:147], v[68:71], v[180:183]
 s_waitcnt lgkmcnt(6)
 v_exp_f32 v226, v158
 v_exp_f32 v227, v159
 v_mfma_f32_16x16x32_bf16 v[188:191], a[148:151], v[68:71], v[188:191]
 s_add_u32 m0, s64, 61440
 ds_read_b64_tr_b16 a[164:165], v241 offset:12288
 ds_read_b64_tr_b16 a[166:167], v241 offset:12544
 v_mfma_f32_16x16x32_bf16 v[184:187], a[148:151], v[64:67], v[184:187]
 s_waitcnt lgkmcnt(6)
 v_fma_f32 v226, v226, s75, s75
 v_fma_f32 v227, v227, s75, s75
 v_rcp_f32 v226, v226
 v_mfma_f32_16x16x32_bf16 v[192:195], a[152:155], v[64:67], v[192:195]
 s_mov_b32 s65, 4423936
 ds_read_b64_tr_b16 a[168:169], v240 offset:12800
 ds_read_b64_tr_b16 a[170:171], v240 offset:13056
 buffer_load_dwordx4 v248, s[32:35], s65 offen lds
 v_mfma_f32_16x16x32_bf16 v[196:199], a[152:155], v[68:71], v[196:199]
 s_waitcnt lgkmcnt(6)
 v_rcp_f32 v227, v227
 v_mfma_f32_16x16x32_bf16 v[204:207], a[156:159], v[68:71], v[204:207]
 ds_read_b64_tr_b16 a[172:173], v241 offset:12800
 ds_read_b64_tr_b16 a[174:175], v241 offset:13056
 v_mfma_f32_16x16x32_bf16 v[200:203], a[156:159], v[64:67], v[200:203]
 s_waitcnt lgkmcnt(6)
 v_mul_f32 v226, v158, v226
 v_mul_f32 v227, v159, v227
 v_cvt_pk_bf16_f32 v231, v226, v227
 v_mfma_f32_16x16x32_bf16 v[176:179], a[160:163], v[72:75], v[176:179]
 ds_read_b64_tr_b16 a[144:145], v240 offset:16384
 ds_read_b64_tr_b16 a[146:147], v240 offset:16640
 v_mfma_f32_16x16x32_bf16 v[180:183], a[160:163], v[76:79], v[180:183]
 s_waitcnt lgkmcnt(6)
 v_accvgpr_write_b32 a7, v231
 v_exp_f32 v228, v160
 v_mfma_f32_16x16x32_bf16 v[188:191], a[164:167], v[76:79], v[188:191]
 s_add_u32 m0, s64, 65536
 ds_read_b64_tr_b16 a[148:149], v241 offset:16384
 ds_read_b64_tr_b16 a[150:151], v241 offset:16640
 v_mfma_f32_16x16x32_bf16 v[184:187], a[164:167], v[72:75], v[184:187]
 s_waitcnt lgkmcnt(6)
 v_exp_f32 v229, v161
 v_fma_f32 v228, v228, s75, s75
 v_mfma_f32_16x16x32_bf16 v[192:195], a[168:171], v[72:75], v[192:195]
 s_mov_b32 s65, 4718848
 ds_read_b64_tr_b16 a[152:153], v240 offset:16896
 ds_read_b64_tr_b16 a[154:155], v240 offset:17152
 buffer_load_dwordx4 v248, s[32:35], s65 offen lds
 v_mfma_f32_16x16x32_bf16 v[196:199], a[168:171], v[76:79], v[196:199]
 s_waitcnt lgkmcnt(6)
 v_fma_f32 v229, v229, s75, s75
 v_rcp_f32 v228, v228
 v_mfma_f32_16x16x32_bf16 v[204:207], a[172:175], v[76:79], v[204:207]
 ds_read_b64_tr_b16 a[156:157], v241 offset:16896
 ds_read_b64_tr_b16 a[158:159], v241 offset:17152
 v_mfma_f32_16x16x32_bf16 v[200:203], a[172:175], v[72:75], v[200:203]
 s_waitcnt lgkmcnt(6)
 v_rcp_f32 v229, v229
 v_mul_f32 v228, v160, v228
 v_mul_f32 v229, v161, v229
 v_mfma_f32_16x16x32_bf16 v[176:179], a[144:147], v[80:83], v[176:179]
 ds_read_b64_tr_b16 a[160:161], v240 offset:20480
 ds_read_b64_tr_b16 a[162:163], v240 offset:20736
 v_mfma_f32_16x16x32_bf16 v[180:183], a[144:147], v[84:87], v[180:183]
 s_waitcnt lgkmcnt(6)
 v_cvt_pk_bf16_f32 v232, v228, v229
 v_accvgpr_write_b32 a8, v232
 v_exp_f32 v224, v162
 v_mfma_f32_16x16x32_bf16 v[188:191], a[148:151], v[84:87], v[188:191]
 s_add_u32 m0, s64, 69632
 ds_read_b64_tr_b16 a[164:165], v241 offset:20480
 ds_read_b64_tr_b16 a[166:167], v241 offset:20736
 v_mfma_f32_16x16x32_bf16 v[184:187], a[148:151], v[80:83], v[184:187]
 s_waitcnt lgkmcnt(6)
 v_exp_f32 v225, v163
 v_mfma_f32_16x16x32_bf16 v[192:195], a[152:155], v[80:83], v[192:195]
 s_mov_b32 s65, 5013760
 ds_read_b64_tr_b16 a[168:169], v240 offset:20992
 ds_read_b64_tr_b16 a[170:171], v240 offset:21248
 buffer_load_dwordx4 v248, s[32:35], s65 offen lds
 v_mfma_f32_16x16x32_bf16 v[196:199], a[152:155], v[84:87], v[196:199]
 s_waitcnt lgkmcnt(6)
 v_fma_f32 v224, v224, s75, s75
 v_fma_f32 v225, v225, s75, s75
 v_rcp_f32 v224, v224
 v_mfma_f32_16x16x32_bf16 v[204:207], a[156:159], v[84:87], v[204:207]
 ds_read_b64_tr_b16 a[172:173], v241 offset:20992
 ds_read_b64_tr_b16 a[174:175], v241 offset:21248
 v_mfma_f32_16x16x32_bf16 v[200:203], a[156:159], v[80:83], v[200:203]
 s_waitcnt lgkmcnt(6)
 v_rcp_f32 v225, v225
 v_mfma_f32_16x16x32_bf16 v[176:179], a[160:163], v[88:91], v[176:179]
 s_waitcnt vmcnt(18)
 s_barrier
 ds_read_b64_tr_b16 a[144:145], v240 offset:24576
 ds_read_b64_tr_b16 a[146:147], v240 offset:24832
 v_mfma_f32_16x16x32_bf16 v[180:183], a[160:163], v[92:95], v[180:183]
 s_waitcnt lgkmcnt(6)
 v_mul_f32 v224, v162, v224
 v_mul_f32 v225, v163, v225
 v_cvt_pk_bf16_f32 v230, v224, v225
 v_mfma_f32_16x16x32_bf16 v[188:191], a[164:167], v[92:95], v[188:191]
 s_add_u32 m0, s64, 73728
 ds_read_b64_tr_b16 a[148:149], v241 offset:24576
 ds_read_b64_tr_b16 a[150:151], v241 offset:24832
 v_mfma_f32_16x16x32_bf16 v[184:187], a[164:167], v[88:91], v[184:187]
 s_waitcnt lgkmcnt(6)
 v_accvgpr_write_b32 a9, v230
 v_exp_f32 v226, v164
 v_mfma_f32_16x16x32_bf16 v[192:195], a[168:171], v[88:91], v[192:195]
 s_mov_b32 s65, 384
 ds_read_b64_tr_b16 a[152:153], v240 offset:25088
 ds_read_b64_tr_b16 a[154:155], v240 offset:25344
 buffer_load_dwordx4 v248, s[32:35], s65 offen lds
 v_mfma_f32_16x16x32_bf16 v[196:199], a[168:171], v[92:95], v[196:199]
 s_waitcnt lgkmcnt(6)
 v_exp_f32 v227, v165
 v_fma_f32 v226, v226, s75, s75
 v_fma_f32 v227, v227, s75, s75
 v_mfma_f32_16x16x32_bf16 v[204:207], a[172:175], v[92:95], v[204:207]
 ds_read_b64_tr_b16 a[156:157], v241 offset:25088
 ds_read_b64_tr_b16 a[158:159], v241 offset:25344
 v_mfma_f32_16x16x32_bf16 v[200:203], a[172:175], v[88:91], v[200:203]
 s_waitcnt lgkmcnt(6)
 v_rcp_f32 v226, v226
 v_rcp_f32 v227, v227
 v_mfma_f32_16x16x32_bf16 v[176:179], a[144:147], v[96:99], v[176:179]
 ds_read_b64_tr_b16 a[160:161], v240 offset:28672
 ds_read_b64_tr_b16 a[162:163], v240 offset:28928
 v_mfma_f32_16x16x32_bf16 v[180:183], a[144:147], v[100:103], v[180:183]
 s_waitcnt lgkmcnt(6)
 v_mul_f32 v226, v164, v226
 v_mul_f32 v227, v165, v227
 v_mfma_f32_16x16x32_bf16 v[188:191], a[148:151], v[100:103], v[188:191]
 s_add_u32 m0, s64, 77824
 ds_read_b64_tr_b16 a[164:165], v241 offset:28672
 ds_read_b64_tr_b16 a[166:167], v241 offset:28928
 v_mfma_f32_16x16x32_bf16 v[184:187], a[148:151], v[96:99], v[184:187]
 s_waitcnt lgkmcnt(6)
 v_cvt_pk_bf16_f32 v231, v226, v227
 v_accvgpr_write_b32 a12, v231
 v_exp_f32 v228, v166
 v_mfma_f32_16x16x32_bf16 v[192:195], a[152:155], v[96:99], v[192:195]
 s_mov_b32 s65, 295296
 ds_read_b64_tr_b16 a[168:169], v240 offset:29184
 ds_read_b64_tr_b16 a[170:171], v240 offset:29440
 buffer_load_dwordx4 v248, s[32:35], s65 offen lds
 v_mfma_f32_16x16x32_bf16 v[196:199], a[152:155], v[100:103], v[196:199]
 s_waitcnt lgkmcnt(6)
 v_exp_f32 v229, v167
 v_mfma_f32_16x16x32_bf16 v[204:207], a[156:159], v[100:103], v[204:207]
 ds_read_b64_tr_b16 a[172:173], v241 offset:29184
 ds_read_b64_tr_b16 a[174:175], v241 offset:29440
 v_mfma_f32_16x16x32_bf16 v[200:203], a[156:159], v[96:99], v[200:203]
 s_waitcnt lgkmcnt(6)
 v_fma_f32 v228, v228, s75, s75
 v_fma_f32 v229, v229, s75, s75
 v_rcp_f32 v228, v228
 v_mfma_f32_16x16x32_bf16 v[176:179], a[160:163], v[104:107], v[176:179]
 ds_read_b64_tr_b16 a[144:145], v240 offset:32768
 ds_read_b64_tr_b16 a[146:147], v240 offset:33024
 v_mfma_f32_16x16x32_bf16 v[180:183], a[160:163], v[108:111], v[180:183]
 s_waitcnt lgkmcnt(6)
 v_rcp_f32 v229, v229
 v_mul_f32 v228, v166, v228
 v_mfma_f32_16x16x32_bf16 v[188:191], a[164:167], v[108:111], v[188:191]
 s_add_u32 m0, s64, 81920
 ds_read_b64_tr_b16 a[148:149], v241 offset:32768
 ds_read_b64_tr_b16 a[150:151], v241 offset:33024
 v_mfma_f32_16x16x32_bf16 v[184:187], a[164:167], v[104:107], v[184:187]
 s_waitcnt lgkmcnt(6)
 v_mul_f32 v229, v167, v229
 v_cvt_pk_bf16_f32 v232, v228, v229
 v_accvgpr_write_b32 a13, v232
 v_mfma_f32_16x16x32_bf16 v[192:195], a[168:171], v[104:107], v[192:195]
 s_mov_b32 s65, 590208
 ds_read_b64_tr_b16 a[152:153], v240 offset:33280
 ds_read_b64_tr_b16 a[154:155], v240 offset:33536
 buffer_load_dwordx4 v248, s[32:35], s65 offen lds
 v_mfma_f32_16x16x32_bf16 v[196:199], a[168:171], v[108:111], v[196:199]
 s_waitcnt lgkmcnt(6)
 v_exp_f32 v224, v168
 v_exp_f32 v225, v169
 v_mfma_f32_16x16x32_bf16 v[204:207], a[172:175], v[108:111], v[204:207]
 ds_read_b64_tr_b16 a[156:157], v241 offset:33280
 ds_read_b64_tr_b16 a[158:159], v241 offset:33536
 v_mfma_f32_16x16x32_bf16 v[200:203], a[172:175], v[104:107], v[200:203]
 s_waitcnt lgkmcnt(6)
 v_fma_f32 v224, v224, s75, s75
 v_fma_f32 v225, v225, s75, s75
 v_mfma_f32_16x16x32_bf16 v[176:179], a[144:147], v[112:115], v[176:179]
 ds_read_b64_tr_b16 a[160:161], v240 offset:36864
 ds_read_b64_tr_b16 a[162:163], v240 offset:37120
 v_mfma_f32_16x16x32_bf16 v[180:183], a[144:147], v[116:119], v[180:183]
 s_waitcnt lgkmcnt(6)
 v_rcp_f32 v224, v224
 v_rcp_f32 v225, v225
 v_mfma_f32_16x16x32_bf16 v[188:191], a[148:151], v[116:119], v[188:191]
 s_add_u32 m0, s64, 86016
 ds_read_b64_tr_b16 a[164:165], v241 offset:36864
 ds_read_b64_tr_b16 a[166:167], v241 offset:37120
 v_mfma_f32_16x16x32_bf16 v[184:187], a[148:151], v[112:115], v[184:187]
 s_waitcnt lgkmcnt(6)
 v_mul_f32 v224, v168, v224
 v_mul_f32 v225, v169, v225
 v_mfma_f32_16x16x32_bf16 v[192:195], a[152:155], v[112:115], v[192:195]
 s_mov_b32 s65, 885120
 ds_read_b64_tr_b16 a[168:169], v240 offset:37376
 ds_read_b64_tr_b16 a[170:171], v240 offset:37632
 buffer_load_dwordx4 v248, s[32:35], s65 offen lds
 v_mfma_f32_16x16x32_bf16 v[196:199], a[152:155], v[116:119], v[196:199]
 s_waitcnt lgkmcnt(6)
 v_cvt_pk_bf16_f32 v230, v224, v225
 v_accvgpr_write_b32 a10, v230
 v_exp_f32 v226, v170
 v_mfma_f32_16x16x32_bf16 v[204:207], a[156:159], v[116:119], v[204:207]
 ds_read_b64_tr_b16 a[172:173], v241 offset:37376
 ds_read_b64_tr_b16 a[174:175], v241 offset:37632
 v_mfma_f32_16x16x32_bf16 v[200:203], a[156:159], v[112:115], v[200:203]
 s_waitcnt lgkmcnt(6)
 v_exp_f32 v227, v171
 v_fma_f32 v226, v226, s75, s75
 v_mfma_f32_16x16x32_bf16 v[176:179], a[160:163], v[120:123], v[176:179]
 ds_read_b64_tr_b16 a[144:145], v240 offset:40960
 ds_read_b64_tr_b16 a[146:147], v240 offset:41216
 v_mfma_f32_16x16x32_bf16 v[180:183], a[160:163], v[124:127], v[180:183]
 s_waitcnt lgkmcnt(6)
 v_fma_f32 v227, v227, s75, s75
 v_rcp_f32 v226, v226
 v_mfma_f32_16x16x32_bf16 v[188:191], a[164:167], v[124:127], v[188:191]
 s_add_u32 m0, s64, 90112
 ds_read_b64_tr_b16 a[148:149], v241 offset:40960
 ds_read_b64_tr_b16 a[150:151], v241 offset:41216
 v_mfma_f32_16x16x32_bf16 v[184:187], a[164:167], v[120:123], v[184:187]
 s_waitcnt lgkmcnt(6)
 v_rcp_f32 v227, v227
 v_mul_f32 v226, v170, v226
 v_mfma_f32_16x16x32_bf16 v[192:195], a[168:171], v[120:123], v[192:195]
 s_mov_b32 s65, 1180032
 ds_read_b64_tr_b16 a[152:153], v240 offset:41472
 ds_read_b64_tr_b16 a[154:155], v240 offset:41728
 buffer_load_dwordx4 v248, s[32:35], s65 offen lds
 v_mfma_f32_16x16x32_bf16 v[196:199], a[168:171], v[124:127], v[196:199]
 s_waitcnt lgkmcnt(6)
 v_mul_f32 v227, v171, v227
 v_cvt_pk_bf16_f32 v231, v226, v227
 v_accvgpr_write_b32 a11, v231
 v_mfma_f32_16x16x32_bf16 v[204:207], a[172:175], v[124:127], v[204:207]
 ds_read_b64_tr_b16 a[156:157], v241 offset:41472
 ds_read_b64_tr_b16 a[158:159], v241 offset:41728
 v_mfma_f32_16x16x32_bf16 v[200:203], a[172:175], v[120:123], v[200:203]
 s_waitcnt lgkmcnt(6)
 v_exp_f32 v228, v172
 v_exp_f32 v229, v173
 v_mfma_f32_16x16x32_bf16 v[176:179], a[144:147], v[128:131], v[176:179]
 ds_read_b64_tr_b16 a[160:161], v240 offset:45056
 ds_read_b64_tr_b16 a[162:163], v240 offset:45312
 v_mfma_f32_16x16x32_bf16 v[180:183], a[144:147], v[132:135], v[180:183]
 s_waitcnt lgkmcnt(6)
 v_fma_f32 v228, v228, s75, s75
 v_fma_f32 v229, v229, s75, s75
 v_mfma_f32_16x16x32_bf16 v[188:191], a[148:151], v[132:135], v[188:191]
 s_add_u32 m0, s64, 94208
 ds_read_b64_tr_b16 a[164:165], v241 offset:45056
 ds_read_b64_tr_b16 a[166:167], v241 offset:45312
 v_mfma_f32_16x16x32_bf16 v[184:187], a[148:151], v[128:131], v[184:187]
 s_waitcnt lgkmcnt(6)
 v_rcp_f32 v228, v228
 v_rcp_f32 v229, v229
 v_mfma_f32_16x16x32_bf16 v[192:195], a[152:155], v[128:131], v[192:195]
 s_mov_b32 s65, 1474944
 ds_read_b64_tr_b16 a[168:169], v240 offset:45568
 ds_read_b64_tr_b16 a[170:171], v240 offset:45824
 buffer_load_dwordx4 v248, s[32:35], s65 offen lds
 v_mfma_f32_16x16x32_bf16 v[196:199], a[152:155], v[132:135], v[196:199]
 s_waitcnt lgkmcnt(6)
 v_mul_f32 v228, v172, v228
 v_mul_f32 v229, v173, v229
 v_cvt_pk_bf16_f32 v232, v228, v229
 v_mfma_f32_16x16x32_bf16 v[204:207], a[156:159], v[132:135], v[204:207]
 ds_read_b64_tr_b16 a[172:173], v241 offset:45568
 ds_read_b64_tr_b16 a[174:175], v241 offset:45824
 v_mfma_f32_16x16x32_bf16 v[200:203], a[156:159], v[128:131], v[200:203]
 s_waitcnt lgkmcnt(6)
 v_accvgpr_write_b32 a14, v232
 v_exp_f32 v224, v174
 v_mfma_f32_16x16x32_bf16 v[176:179], a[160:163], v[136:139], v[176:179]
 s_waitcnt vmcnt(18)
 s_barrier
 ds_read_b64_tr_b16 a[144:145], v236 offset:0
 ds_read_b64_tr_b16 a[146:147], v236 offset:256
 v_mfma_f32_16x16x32_bf16 v[180:183], a[160:163], v[140:143], v[180:183]
 s_waitcnt lgkmcnt(6)
 v_exp_f32 v225, v175
 v_fma_f32 v224, v224, s75, s75
 v_mfma_f32_16x16x32_bf16 v[188:191], a[164:167], v[140:143], v[188:191]
 s_add_u32 m0, s64, 98304
 ds_read_b64_tr_b16 a[148:149], v237 offset:0
 ds_read_b64_tr_b16 a[150:151], v237 offset:256
 v_mfma_f32_16x16x32_bf16 v[184:187], a[164:167], v[136:139], v[184:187]
 s_waitcnt lgkmcnt(6)
 v_fma_f32 v225, v225, s75, s75
 v_rcp_f32 v224, v224
 v_mfma_f32_16x16x32_bf16 v[192:195], a[168:171], v[136:139], v[192:195]
 s_mov_b32 s65, 1769856
 ds_read_b64_tr_b16 a[152:153], v236 offset:512
 ds_read_b64_tr_b16 a[154:155], v236 offset:768
 buffer_load_dwordx4 v248, s[32:35], s65 offen lds
 v_mfma_f32_16x16x32_bf16 v[196:199], a[168:171], v[140:143], v[196:199]
 s_waitcnt lgkmcnt(6)
 v_rcp_f32 v225, v225
 v_mul_f32 v224, v174, v224
 v_mfma_f32_16x16x32_bf16 v[204:207], a[172:175], v[140:143], v[204:207]
 ds_read_b64_tr_b16 a[156:157], v237 offset:512
 ds_read_b64_tr_b16 a[158:159], v237 offset:768
 v_mfma_f32_16x16x32_bf16 v[200:203], a[172:175], v[136:139], v[200:203]
 s_waitcnt lgkmcnt(6)
 v_mul_f32 v225, v175, v225
 v_cvt_pk_bf16_f32 v230, v224, v225
 v_accvgpr_write_b32 a15, v230
 v_mfma_f32_16x16x32_bf16 v[144:147], a[144:147], v[0:3], 0
 s_cmp_eq_u32 s15, 1
 s_cbranch_scc1 L_hsl2
L_hsl2_ok:
 ds_read_b64_tr_b16 a[160:161], v236 offset:4096
 ds_read_b64_tr_b16 a[162:163], v236 offset:4352
 v_mfma_f32_16x16x32_bf16 v[148:151], a[144:147], v[4:7], 0
 s_waitcnt lgkmcnt(6)
 v_mfma_f32_16x16x32_bf16 v[156:159], a[148:151], v[4:7], 0
 s_add_u32 m0, s64, 102400
 ds_read_b64_tr_b16 a[164:165], v237 offset:4096
 ds_read_b64_tr_b16 a[166:167], v237 offset:4352
 v_mfma_f32_16x16x32_bf16 v[152:155], a[148:151], v[0:3], 0
 s_waitcnt lgkmcnt(6)
 v_exp_f32 v224, v176
 v_exp_f32 v225, v177
 v_mfma_f32_16x16x32_bf16 v[160:163], a[152:155], v[0:3], 0
 s_mov_b32 s65, 2064768
 ds_read_b64_tr_b16 a[168:169], v236 offset:4608
 ds_read_b64_tr_b16 a[170:171], v236 offset:4864
 buffer_load_dwordx4 v248, s[32:35], s65 offen lds
 v_mfma_f32_16x16x32_bf16 v[164:167], a[152:155], v[4:7], 0
 s_waitcnt lgkmcnt(6)
 v_fma_f32 v224, v224, s75, s75
 v_fma_f32 v225, v225, s75, s75
 v_rcp_f32 v224, v224
 v_mfma_f32_16x16x32_bf16 v[172:175], a[156:159], v[4:7], 0
 ds_read_b64_tr_b16 a[172:173], v237 offset:4608
 ds_read_b64_tr_b16 a[174:175], v237 offset:4864
 v_mfma_f32_16x16x32_bf16 v[168:171], a[156:159], v[0:3], 0
 s_waitcnt lgkmcnt(6)
 v_rcp_f32 v225, v225
 v_mfma_f32_16x16x32_bf16 v[144:147], a[160:163], v[8:11], v[144:147]
 ds_read_b64_tr_b16 a[144:145], v236 offset:8192
 ds_read_b64_tr_b16 a[146:147], v236 offset:8448
 v_mfma_f32_16x16x32_bf16 v[148:151], a[160:163], v[12:15], v[148:151]
 s_waitcnt lgkmcnt(6)
 v_mul_f32 v224, v176, v224
 v_mul_f32 v225, v177, v225
 v_cvt_pk_bf16_f32 v230, v224, v225
 v_mfma_f32_16x16x32_bf16 v[156:159], a[164:167], v[12:15], v[156:159]
 s_add_u32 m0, s64, 106496
 ds_read_b64_tr_b16 a[148:149], v237 offset:8192
 ds_read_b64_tr_b16 a[150:151], v237 offset:8448
 v_mfma_f32_16x16x32_bf16 v[152:155], a[164:167], v[8:11], v[152:155]
 s_waitcnt lgkmcnt(6)
 v_accvgpr_write_b32 a16, v230
 v_exp_f32 v226, v178
 v_mfma_f32_16x16x32_bf16 v[160:163], a[168:171], v[8:11], v[160:163]
 s_mov_b32 s65, 2359680
 ds_read_b64_tr_b16 a[152:153], v236 offset:8704
 ds_read_b64_tr_b16 a[154:155], v236 offset:8960
 buffer_load_dwordx4 v248, s[32:35], s65 offen lds
 v_mfma_f32_16x16x32_bf16 v[164:167], a[168:171], v[12:15], v[164:167]
 s_waitcnt lgkmcnt(6)
 v_exp_f32 v227, v179
 v_fma_f32 v226, v226, s75, s75
 v_mfma_f32_16x16x32_bf16 v[172:175], a[172:175], v[12:15], v[172:175]
 ds_read_b64_tr_b16 a[156:157], v237 offset:8704
 ds_read_b64_tr_b16 a[158:159], v237 offset:8960
 v_mfma_f32_16x16x32_bf16 v[168:171], a[172:175], v[8:11], v[168:171]
 s_waitcnt lgkmcnt(6)
 v_fma_f32 v227, v227, s75, s75
 v_rcp_f32 v226, v226
 v_mfma_f32_16x16x32_bf16 v[144:147], a[144:147], v[16:19], v[144:147]
 ds_read_b64_tr_b16 a[160:161], v236 offset:12288
 ds_read_b64_tr_b16 a[162:163], v236 offset:12544
 v_mfma_f32_16x16x32_bf16 v[148:151], a[144:147], v[20:23], v[148:151]
 s_waitcnt lgkmcnt(6)
 v_rcp_f32 v227, v227
 v_mul_f32 v226, v178, v226
 v_mul_f32 v227, v179, v227
 v_mfma_f32_16x16x32_bf16 v[156:159], a[148:151], v[20:23], v[156:159]
 s_add_u32 m0, s64, 110592
 ds_read_b64_tr_b16 a[164:165], v237 offset:12288
 ds_read_b64_tr_b16 a[166:167], v237 offset:12544
 v_mfma_f32_16x16x32_bf16 v[152:155], a[148:151], v[16:19], v[152:155]
 s_waitcnt lgkmcnt(6)
 v_cvt_pk_bf16_f32 v231, v226, v227
 v_accvgpr_write_b32 a17, v231
 v_exp_f32 v228, v180
 v_mfma_f32_16x16x32_bf16 v[160:163], a[152:155], v[16:19], v[160:163]
 s_mov_b32 s65, 2654592
 ds_read_b64_tr_b16 a[168:169], v236 offset:12800
 ds_read_b64_tr_b16 a[170:171], v236 offset:13056
 buffer_load_dwordx4 v248, s[32:35], s65 offen lds
 v_mfma_f32_16x16x32_bf16 v[164:167], a[152:155], v[20:23], v[164:167]
 s_waitcnt lgkmcnt(6)
 v_exp_f32 v229, v181
 v_mfma_f32_16x16x32_bf16 v[172:175], a[156:159], v[20:23], v[172:175]
 ds_read_b64_tr_b16 a[172:173], v237 offset:12800
 ds_read_b64_tr_b16 a[174:175], v237 offset:13056
 v_mfma_f32_16x16x32_bf16 v[168:171], a[156:159], v[16:19], v[168:171]
 s_waitcnt lgkmcnt(6)
 v_fma_f32 v228, v228, s75, s75
 v_fma_f32 v229, v229, s75, s75
 v_rcp_f32 v228, v228
 v_mfma_f32_16x16x32_bf16 v[144:147], a[160:163], v[24:27], v[144:147]
 ds_read_b64_tr_b16 a[144:145], v236 offset:16384
 ds_read_b64_tr_b16 a[146:147], v236 offset:16640
 v_mfma_f32_16x16x32_bf16 v[148:151], a[160:163], v[28:31], v[148:151]
 s_waitcnt lgkmcnt(6)
 v_rcp_f32 v229, v229
 v_mfma_f32_16x16x32_bf16 v[156:159], a[164:167], v[28:31], v[156:159]
 s_add_u32 m0, s64, 114688
 ds_read_b64_tr_b16 a[148:149], v237 offset:16384
 ds_read_b64_tr_b16 a[150:151], v237 offset:16640
 v_mfma_f32_16x16x32_bf16 v[152:155], a[164:167], v[24:27], v[152:155]
 s_waitcnt lgkmcnt(6)
 v_mul_f32 v228, v180, v228
 v_mul_f32 v229, v181, v229
 v_cvt_pk_bf16_f32 v232, v228, v229
 v_accvgpr_write_b32 a20, v232
 v_mfma_f32_16x16x32_bf16 v[160:163], a[168:171], v[24:27], v[160:163]
 s_mov_b32 s65, 2949504
 ds_read_b64_tr_b16 a[152:153], v236 offset:16896
 ds_read_b64_tr_b16 a[154:155], v236 offset:17152
 buffer_load_dwordx4 v248, s[32:35], s65 offen lds
 v_mfma_f32_16x16x32_bf16 v[164:167], a[168:171], v[28:31], v[164:167]
 s_waitcnt lgkmcnt(6)
 v_exp_f32 v224, v182
 v_exp_f32 v225, v183
 v_mfma_f32_16x16x32_bf16 v[172:175], a[172:175], v[28:31], v[172:175]
 ds_read_b64_tr_b16 a[156:157], v237 offset:16896
 ds_read_b64_tr_b16 a[158:159], v237 offset:17152
 v_mfma_f32_16x16x32_bf16 v[168:171], a[172:175], v[24:27], v[168:171]
 s_waitcnt lgkmcnt(6)
 v_fma_f32 v224, v224, s75, s75
 v_fma_f32 v225, v225, s75, s75
 v_mfma_f32_16x16x32_bf16 v[144:147], a[144:147], v[32:35], v[144:147]
 ds_read_b64_tr_b16 a[160:161], v236 offset:20480
 ds_read_b64_tr_b16 a[162:163], v236 offset:20736
 v_mfma_f32_16x16x32_bf16 v[148:151], a[144:147], v[36:39], v[148:151]
 s_waitcnt lgkmcnt(6)
 v_rcp_f32 v224, v224
 v_rcp_f32 v225, v225
 v_mfma_f32_16x16x32_bf16 v[156:159], a[148:151], v[36:39], v[156:159]
 s_add_u32 m0, s64, 118784
 ds_read_b64_tr_b16 a[164:165], v237 offset:20480
 ds_read_b64_tr_b16 a[166:167], v237 offset:20736
 v_mfma_f32_16x16x32_bf16 v[152:155], a[148:151], v[32:35], v[152:155]
 s_waitcnt lgkmcnt(6)
 v_mul_f32 v224, v182, v224
 v_mul_f32 v225, v183, v225
 v_mfma_f32_16x16x32_bf16 v[160:163], a[152:155], v[32:35], v[160:163]
 s_mov_b32 s65, 3244416
 ds_read_b64_tr_b16 a[168:169], v236 offset:20992
 ds_read_b64_tr_b16 a[170:171], v236 offset:21248
 buffer_load_dwordx4 v248, s[32:35], s65 offen lds
 v_mfma_f32_16x16x32_bf16 v[164:167], a[152:155], v[36:39], v[164:167]
 s_waitcnt lgkmcnt(6)
 v_cvt_pk_bf16_f32 v230, v224, v225
 v_accvgpr_write_b32 a21, v230
 v_exp_f32 v226, v184
 v_mfma_f32_16x16x32_bf16 v[172:175], a[156:159], v[36:39], v[172:175]
 ds_read_b64_tr_b16 a[172:173], v237 offset:20992
 ds_read_b64_tr_b16 a[174:175], v237 offset:21248
 v_mfma_f32_16x16x32_bf16 v[168:171], a[156:159], v[32:35], v[168:171]
 s_waitcnt lgkmcnt(6)
 v_exp_f32 v227, v185
 v_mfma_f32_16x16x32_bf16 v[144:147], a[160:163], v[40:43], v[144:147]
 s_waitcnt vmcnt(18)
 s_barrier
 ds_read_b64_tr_b16 a[144:145], v236 offset:24576
 ds_read_b64_tr_b16 a[146:147], v236 offset:24832
 v_mfma_f32_16x16x32_bf16 v[148:151], a[160:163], v[44:47], v[148:151]
 s_waitcnt lgkmcnt(6)
 v_fma_f32 v226, v226, s75, s75
 v_fma_f32 v227, v227, s75, s75
 v_rcp_f32 v226, v226
 v_mfma_f32_16x16x32_bf16 v[156:159], a[164:167], v[44:47], v[156:159]
 s_add_u32 m0, s64, 122880
 ds_read_b64_tr_b16 a[148:149], v237 offset:24576
 ds_read_b64_tr_b16 a[150:151], v237 offset:24832
 v_mfma_f32_16x16x32_bf16 v[152:155], a[164:167], v[40:43], v[152:155]
 s_waitcnt lgkmcnt(6)
 v_rcp_f32 v227, v227
 v_mul_f32 v226, v184, v226
 v_mfma_f32_16x16x32_bf16 v[160:163], a[168:171], v[40:43], v[160:163]
 s_mov_b32 s65, 3539328
 ds_read_b64_tr_b16 a[152:153], v236 offset:25088
 ds_read_b64_tr_b16 a[154:155], v236 offset:25344
 buffer_load_dwordx4 v248, s[32:35], s65 offen lds
 v_mfma_f32_16x16x32_bf16 v[164:167], a[168:171], v[44:47], v[164:167]
 s_waitcnt lgkmcnt(6)
 v_mul_f32 v227, v185, v227
 v_cvt_pk_bf16_f32 v231, v226, v227
 v_accvgpr_write_b32 a18, v231
 v_mfma_f32_16x16x32_bf16 v[172:175], a[172:175], v[44:47], v[172:175]
 ds_read_b64_tr_b16 a[156:157], v237 offset:25088
 ds_read_b64_tr_b16 a[158:159], v237 offset:25344
 v_mfma_f32_16x16x32_bf16 v[168:171], a[172:175], v[40:43], v[168:171]
 s_waitcnt lgkmcnt(6)
 v_exp_f32 v228, v186
 v_exp_f32 v229, v187
 v_mfma_f32_16x16x32_bf16 v[144:147], a[144:147], v[48:51], v[144:147]
 ds_read_b64_tr_b16 a[160:161], v236 offset:28672
 ds_read_b64_tr_b16 a[162:163], v236 offset:28928
 v_mfma_f32_16x16x32_bf16 v[148:151], a[144:147], v[52:55], v[148:151]
 s_waitcnt lgkmcnt(6)
 v_fma_f32 v228, v228, s75, s75
 v_fma_f32 v229, v229, s75, s75
 v_mfma_f32_16x16x32_bf16 v[156:159], a[148:151], v[52:55], v[156:159]
 s_add_u32 m0, s64, 126976
 ds_read_b64_tr_b16 a[164:165], v237 offset:28672
 ds_read_b64_tr_b16 a[166:167], v237 offset:28928
 v_mfma_f32_16x16x32_bf16 v[152:155], a[148:151], v[48:51], v[152:155]
 s_waitcnt lgkmcnt(6)
 v_rcp_f32 v228, v228
 v_rcp_f32 v229, v229
 v_mfma_f32_16x16x32_bf16 v[160:163], a[152:155], v[48:51], v[160:163]
 s_mov_b32 s65, 3834240
 ds_read_b64_tr_b16 a[168:169], v236 offset:29184
 ds_read_b64_tr_b16 a[170:171], v236 offset:29440
 buffer_load_dwordx4 v248, s[32:35], s65 offen lds
 v_mfma_f32_16x16x32_bf16 v[164:167], a[152:155], v[52:55], v[164:167]
 s_waitcnt lgkmcnt(6)
 v_mul_f32 v228, v186, v228
 v_mul_f32 v229, v187, v229
 v_cvt_pk_bf16_f32 v232, v228, v229
 v_mfma_f32_16x16x32_bf16 v[172:175], a[156:159], v[52:55], v[172:175]
 ds_read_b64_tr_b16 a[172:173], v237 offset:29184
 ds_read_b64_tr_b16 a[174:175], v237 offset:29440
 v_mfma_f32_16x16x32_bf16 v[168:171], a[156:159], v[48:51], v[168:171]
 s_waitcnt lgkmcnt(6)
 v_accvgpr_write_b32 a19, v232
 v_exp_f32 v224, v188
 v_mfma_f32_16x16x32_bf16 v[144:147], a[160:163], v[56:59], v[144:147]
 ds_read_b64_tr_b16 a[144:145], v236 offset:32768
 ds_read_b64_tr_b16 a[146:147], v236 offset:33024
 v_mfma_f32_16x16x32_bf16 v[148:151], a[160:163], v[60:63], v[148:151]
 s_waitcnt lgkmcnt(6)
 v_exp_f32 v225, v189
 v_fma_f32 v224, v224, s75, s75
 v_mfma_f32_16x16x32_bf16 v[156:159], a[164:167], v[60:63], v[156:159]
 s_add_u32 m0, s64, 131072
 ds_read_b64_tr_b16 a[148:149], v237 offset:32768
 ds_read_b64_tr_b16 a[150:151], v237 offset:33024
 v_mfma_f32_16x16x32_bf16 v[152:155], a[164:167], v[56:59], v[152:155]
 s_waitcnt lgkmcnt(6)
 v_fma_f32 v225, v225, s75, s75
 v_rcp_f32 v224, v224
 v_mfma_f32_16x16x32_bf16 v[160:163], a[168:171], v[56:59], v[160:163]
 s_mov_b32 s65, 4129152
 ds_read_b64_tr_b16 a[152:153], v236 offset:33280
 ds_read_b64_tr_b16 a[154:155], v236 offset:33536
 buffer_load_dwordx4 v248, s[32:35], s65 offen lds
 v_mfma_f32_16x16x32_bf16 v[164:167], a[168:171], v[60:63], v[164:167]
 s_waitcnt lgkmcnt(6)
 v_rcp_f32 v225, v225
 v_mul_f32 v224, v188, v224
 v_mfma_f32_16x16x32_bf16 v[172:175], a[172:175], v[60:63], v[172:175]
 ds_read_b64_tr_b16 a[156:157], v237 offset:33280
 ds_read_b64_tr_b16 a[158:159], v237 offset:33536
 v_mfma_f32_16x16x32_bf16 v[168:171], a[172:175], v[56:59], v[168:171]
 s_waitcnt lgkmcnt(6)
 v_mul_f32 v225, v189, v225
 v_cvt_pk_bf16_f32 v230, v224, v225
 v_accvgpr_write_b32 a22, v230
 v_mfma_f32_16x16x32_bf16 v[144:147], a[144:147], v[64:67], v[144:147]
 ds_read_b64_tr_b16 a[160:161], v236 offset:36864
 ds_read_b64_tr_b16 a[162:163], v236 offset:37120
 v_mfma_f32_16x16x32_bf16 v[148:151], a[144:147], v[68:71], v[148:151]
 s_waitcnt lgkmcnt(6)
 v_exp_f32 v226, v190
 v_exp_f32 v227, v191
 v_mfma_f32_16x16x32_bf16 v[156:159], a[148:151], v[68:71], v[156:159]
 s_add_u32 m0, s64, 135168
 ds_read_b64_tr_b16 a[164:165], v237 offset:36864
 ds_read_b64_tr_b16 a[166:167], v237 offset:37120
 v_mfma_f32_16x16x32_bf16 v[152:155], a[148:151], v[64:67], v[152:155]
 s_waitcnt lgkmcnt(6)
 v_fma_f32 v226, v226, s75, s75
 v_fma_f32 v227, v227, s75, s75
 v_rcp_f32 v226, v226
 v_mfma_f32_16x16x32_bf16 v[160:163], a[152:155], v[64:67], v[160:163]
 s_mov_b32 s65, 4424064
 ds_read_b64_tr_b16 a[168:169], v236 offset:37376
 ds_read_b64_tr_b16 a[170:171], v236 offset:37632
 buffer_load_dwordx4 v248, s[32:35], s65 offen lds
 v_mfma_f32_16x16x32_bf16 v[164:167], a[152:155], v[68:71], v[164:167]
 s_waitcnt lgkmcnt(6)
 v_rcp_f32 v227, v227
 v_mfma_f32_16x16x32_bf16 v[172:175], a[156:159], v[68:71], v[172:175]
 ds_read_b64_tr_b16 a[172:173], v237 offset:37376
 ds_read_b64_tr_b16 a[174:175], v237 offset:37632
 v_mfma_f32_16x16x32_bf16 v[168:171], a[156:159], v[64:67], v[168:171]
 s_waitcnt lgkmcnt(6)
 v_mul_f32 v226, v190, v226
 v_mul_f32 v227, v191, v227
 v_cvt_pk_bf16_f32 v231, v226, v227
 v_mfma_f32_16x16x32_bf16 v[144:147], a[160:163], v[72:75], v[144:147]
 ds_read_b64_tr_b16 a[144:145], v236 offset:40960
 ds_read_b64_tr_b16 a[146:147], v236 offset:41216
 v_mfma_f32_16x16x32_bf16 v[148:151], a[160:163], v[76:79], v[148:151]
 s_waitcnt lgkmcnt(6)
 v_accvgpr_write_b32 a23, v231
 v_exp_f32 v228, v192
 v_mfma_f32_16x16x32_bf16 v[156:159], a[164:167], v[76:79], v[156:159]
 s_add_u32 m0, s64, 139264
 ds_read_b64_tr_b16 a[148:149], v237 offset:40960
 ds_read_b64_tr_b16 a[150:151], v237 offset:41216
 v_mfma_f32_16x16x32_bf16 v[152:155], a[164:167], v[72:75], v[152:155]
 s_waitcnt lgkmcnt(6)
 v_exp_f32 v229, v193
 v_fma_f32 v228, v228, s75, s75
 v_mfma_f32_16x16x32_bf16 v[160:163], a[168:171], v[72:75], v[160:163]
 s_mov_b32 s65, 4718976
 ds_read_b64_tr_b16 a[152:153], v236 offset:41472
 ds_read_b64_tr_b16 a[154:155], v236 offset:41728
 buffer_load_dwordx4 v248, s[32:35], s65 offen lds
 v_mfma_f32_16x16x32_bf16 v[164:167], a[168:171], v[76:79], v[164:167]
 s_waitcnt lgkmcnt(6)
 v_fma_f32 v229, v229, s75, s75
 v_rcp_f32 v228, v228
 v_mfma_f32_16x16x32_bf16 v[172:175], a[172:175], v[76:79], v[172:175]
 ds_read_b64_tr_b16 a[156:157], v237 offset:41472
 ds_read_b64_tr_b16 a[158:159], v237 offset:41728
 v_mfma_f32_16x16x32_bf16 v[168:171], a[172:175], v[72:75], v[168:171]
 s_waitcnt lgkmcnt(6)
 v_rcp_f32 v229, v229
 v_mul_f32 v228, v192, v228
 v_mul_f32 v229, v193, v229
 v_mfma_f32_16x16x32_bf16 v[144:147], a[144:147], v[80:83], v[144:147]
 ds_read_b64_tr_b16 a[160:161], v236 offset:45056
 ds_read_b64_tr_b16 a[162:163], v236 offset:45312
 v_mfma_f32_16x16x32_bf16 v[148:151], a[144:147], v[84:87], v[148:151]
 s_waitcnt lgkmcnt(6)
 v_cvt_pk_bf16_f32 v232, v228, v229
 v_accvgpr_write_b32 a24, v232
 v_exp_f32 v224, v194
 v_mfma_f32_16x16x32_bf16 v[156:159], a[148:151], v[84:87], v[156:159]
 s_add_u32 m0, s64, 143360
 ds_read_b64_tr_b16 a[164:165], v237 offset:45056
 ds_read_b64_tr_b16 a[166:167], v237 offset:45312
 v_mfma_f32_16x16x32_bf16 v[152:155], a[148:151], v[80:83], v[152:155]
 s_waitcnt lgkmcnt(6)
 v_exp_f32 v225, v195
 v_mfma_f32_16x16x32_bf16 v[160:163], a[152:155], v[80:83], v[160:163]
 s_mov_b32 s65, 5013888
 ds_read_b64_tr_b16 a[168:169], v236 offset:45568
 ds_read_b64_tr_b16 a[170:171], v236 offset:45824
 buffer_load_dwordx4 v248, s[32:35], s65 offen lds
 v_mfma_f32_16x16x32_bf16 v[164:167], a[152:155], v[84:87], v[164:167]
 s_waitcnt lgkmcnt(6)
 v_fma_f32 v224, v224, s75, s75
 v_fma_f32 v225, v225, s75, s75
 v_rcp_f32 v224, v224
 v_mfma_f32_16x16x32_bf16 v[172:175], a[156:159], v[84:87], v[172:175]
 ds_read_b64_tr_b16 a[172:173], v237 offset:45568
 ds_read_b64_tr_b16 a[174:175], v237 offset:45824
 v_mfma_f32_16x16x32_bf16 v[168:171], a[156:159], v[80:83], v[168:171]
 s_waitcnt lgkmcnt(6)
 v_rcp_f32 v225, v225
 v_mfma_f32_16x16x32_bf16 v[144:147], a[160:163], v[88:91], v[144:147]
 s_waitcnt vmcnt(18)
 s_barrier
 ds_read_b64_tr_b16 a[144:145], v238 offset:0
 ds_read_b64_tr_b16 a[146:147], v238 offset:256
 v_mfma_f32_16x16x32_bf16 v[148:151], a[160:163], v[92:95], v[148:151]
 s_waitcnt lgkmcnt(6)
 v_mul_f32 v224, v194, v224
 v_mul_f32 v225, v195, v225
 v_cvt_pk_bf16_f32 v230, v224, v225
 v_mfma_f32_16x16x32_bf16 v[156:159], a[164:167], v[92:95], v[156:159]
 s_add_u32 m0, s64, 0
 ds_read_b64_tr_b16 a[148:149], v239 offset:0
 ds_read_b64_tr_b16 a[150:151], v239 offset:256
 v_mfma_f32_16x16x32_bf16 v[152:155], a[164:167], v[88:91], v[152:155]
 s_waitcnt lgkmcnt(6)
 v_accvgpr_write_b32 a25, v230
 v_exp_f32 v226, v196
 v_mfma_f32_16x16x32_bf16 v[160:163], a[168:171], v[88:91], v[160:163]
 s_mov_b32 s65, 512
 ds_read_b64_tr_b16 a[152:153], v238 offset:512
 ds_read_b64_tr_b16 a[154:155], v238 offset:768
 buffer_load_dwordx4 v248, s[32:35], s65 offen lds
 v_mfma_f32_16x16x32_bf16 v[164:167], a[168:171], v[92:95], v[164:167]
 s_waitcnt lgkmcnt(6)
 v_exp_f32 v227, v197
 v_fma_f32 v226, v226, s75, s75
 v_fma_f32 v227, v227, s75, s75
 v_mfma_f32_16x16x32_bf16 v[172:175], a[172:175], v[92:95], v[172:175]
 ds_read_b64_tr_b16 a[156:157], v239 offset:512
 ds_read_b64_tr_b16 a[158:159], v239 offset:768
 v_mfma_f32_16x16x32_bf16 v[168:171], a[172:175], v[88:91], v[168:171]
 s_waitcnt lgkmcnt(6)
 v_rcp_f32 v226, v226
 v_rcp_f32 v227, v227
 v_mfma_f32_16x16x32_bf16 v[144:147], a[144:147], v[96:99], v[144:147]
 ds_read_b64_tr_b16 a[160:161], v238 offset:4096
 ds_read_b64_tr_b16 a[162:163], v238 offset:4352
 v_mfma_f32_16x16x32_bf16 v[148:151], a[144:147], v[100:103], v[148:151]
 s_waitcnt lgkmcnt(6)
 v_mul_f32 v226, v196, v226
 v_mul_f32 v227, v197, v227
 v_mfma_f32_16x16x32_bf16 v[156:159], a[148:151], v[100:103], v[156:159]
 s_add_u32 m0, s64, 4096
 ds_read_b64_tr_b16 a[164:165], v239 offset:4096
 ds_read_b64_tr_b16 a[166:167], v239 offset:4352
 v_mfma_f32_16x16x32_bf16 v[152:155], a[148:151], v[96:99], v[152:155]
 s_waitcnt lgkmcnt(6)
 v_cvt_pk_bf16_f32 v231, v226, v227
 v_accvgpr_write_b32 a28, v231
 v_exp_f32 v228, v198
 v_mfma_f32_16x16x32_bf16 v[160:163], a[152:155], v[96:99], v[160:163]
 s_mov_b32 s65, 295424
 ds_read_b64_tr_b16 a[168:169], v238 offset:4608
 ds_read_b64_tr_b16 a[170:171], v238 offset:4864
 buffer_load_dwordx4 v248, s[32:35], s65 offen lds
 v_mfma_f32_16x16x32_bf16 v[164:167], a[152:155], v[100:103], v[164:167]
 s_waitcnt lgkmcnt(6)
 v_exp_f32 v229, v199
 v_mfma_f32_16x16x32_bf16 v[172:175], a[156:159], v[100:103], v[172:175]
 ds_read_b64_tr_b16 a[172:173], v239 offset:4608
 ds_read_b64_tr_b16 a[174:175], v239 offset:4864
 v_mfma_f32_16x16x32_bf16 v[168:171], a[156:159], v[96:99], v[168:171]
 s_waitcnt lgkmcnt(6)
 v_fma_f32 v228, v228, s75, s75
 v_fma_f32 v229, v229, s75, s75
 v_rcp_f32 v228, v228
 v_mfma_f32_16x16x32_bf16 v[144:147], a[160:163], v[104:107], v[144:147]
 ds_read_b64_tr_b16 a[144:145], v238 offset:8192
 ds_read_b64_tr_b16 a[146:147], v238 offset:8448
 v_mfma_f32_16x16x32_bf16 v[148:151], a[160:163], v[108:111], v[148:151]
 s_waitcnt lgkmcnt(6)
 v_rcp_f32 v229, v229
 v_mul_f32 v228, v198, v228
 v_mfma_f32_16x16x32_bf16 v[156:159], a[164:167], v[108:111], v[156:159]
 s_add_u32 m0, s64, 8192
 ds_read_b64_tr_b16 a[148:149], v239 offset:8192
 ds_read_b64_tr_b16 a[150:151], v239 offset:8448
 v_mfma_f32_16x16x32_bf16 v[152:155], a[164:167], v[104:107], v[152:155]
 s_waitcnt lgkmcnt(6)
 v_mul_f32 v229, v199, v229
 v_cvt_pk_bf16_f32 v232, v228, v229
 v_accvgpr_write_b32 a29, v232
 v_mfma_f32_16x16x32_bf16 v[160:163], a[168:171], v[104:107], v[160:163]
 s_mov_b32 s65, 590336
 ds_read_b64_tr_b16 a[152:153], v238 offset:8704
 ds_read_b64_tr_b16 a[154:155], v238 offset:8960
 buffer_load_dwordx4 v248, s[32:35], s65 offen lds
 v_mfma_f32_16x16x32_bf16 v[164:167], a[168:171], v[108:111], v[164:167]
 s_waitcnt lgkmcnt(6)
 v_exp_f32 v224, v200
 v_exp_f32 v225, v201
 v_mfma_f32_16x16x32_bf16 v[172:175], a[172:175], v[108:111], v[172:175]
 ds_read_b64_tr_b16 a[156:157], v239 offset:8704
 ds_read_b64_tr_b16 a[158:159], v239 offset:8960
 v_mfma_f32_16x16x32_bf16 v[168:171], a[172:175], v[104:107], v[168:171]
 s_waitcnt lgkmcnt(6)
 v_fma_f32 v224, v224, s75, s75
 v_fma_f32 v225, v225, s75, s75
 v_mfma_f32_16x16x32_bf16 v[144:147], a[144:147], v[112:115], v[144:147]
 ds_read_b64_tr_b16 a[160:161], v238 offset:12288
 ds_read_b64_tr_b16 a[162:163], v238 offset:12544
 v_mfma_f32_16x16x32_bf16 v[148:151], a[144:147], v[116:119], v[148:151]
 s_waitcnt lgkmcnt(6)
 v_rcp_f32 v224, v224
 v_rcp_f32 v225, v225
 v_mfma_f32_16x16x32_bf16 v[156:159], a[148:151], v[116:119], v[156:159]
 s_add_u32 m0, s64, 12288
 ds_read_b64_tr_b16 a[164:165], v239 offset:12288
 ds_read_b64_tr_b16 a[166:167], v239 offset:12544
 v_mfma_f32_16x16x32_bf16 v[152:155], a[148:151], v[112:115], v[152:155]
 s_waitcnt lgkmcnt(6)
 v_mul_f32 v224, v200, v224
 v_mul_f32 v225, v201, v225
 v_mfma_f32_16x16x32_bf16 v[160:163], a[152:155], v[112:115], v[160:163]
 s_mov_b32 s65, 885248
 ds_read_b64_tr_b16 a[168:169], v238 offset:12800
 ds_read_b64_tr_b16 a[170:171], v238 offset:13056
 buffer_load_dwordx4 v248, s[32:35], s65 offen lds
 v_mfma_f32_16x16x32_bf16 v[164:167], a[152:155], v[116:119], v[164:167]
 s_waitcnt lgkmcnt(6)
 v_cvt_pk_bf16_f32 v230, v224, v225
 v_accvgpr_write_b32 a26, v230
 v_exp_f32 v226, v202
 v_mfma_f32_16x16x32_bf16 v[172:175], a[156:159], v[116:119], v[172:175]
 ds_read_b64_tr_b16 a[172:173], v239 offset:12800
 ds_read_b64_tr_b16 a[174:175], v239 offset:13056
 v_mfma_f32_16x16x32_bf16 v[168:171], a[156:159], v[112:115], v[168:171]
 s_waitcnt lgkmcnt(6)
 v_exp_f32 v227, v203
 v_fma_f32 v226, v226, s75, s75
 v_mfma_f32_16x16x32_bf16 v[144:147], a[160:163], v[120:123], v[144:147]
 ds_read_b64_tr_b16 a[144:145], v238 offset:16384
 ds_read_b64_tr_b16 a[146:147], v238 offset:16640
 v_mfma_f32_16x16x32_bf16 v[148:151], a[160:163], v[124:127], v[148:151]
 s_waitcnt lgkmcnt(6)
 v_fma_f32 v227, v227, s75, s75
 v_rcp_f32 v226, v226
 v_mfma_f32_16x16x32_bf16 v[156:159], a[164:167], v[124:127], v[156:159]
 s_add_u32 m0, s64, 16384
 ds_read_b64_tr_b16 a[148:149], v239 offset:16384
 ds_read_b64_tr_b16 a[150:151], v239 offset:16640
 v_mfma_f32_16x16x32_bf16 v[152:155], a[164:167], v[120:123], v[152:155]
 s_waitcnt lgkmcnt(6)
 v_rcp_f32 v227, v227
 v_mul_f32 v226, v202, v226
 v_mfma_f32_16x16x32_bf16 v[160:163], a[168:171], v[120:123], v[160:163]
 s_mov_b32 s65, 1180160
 ds_read_b64_tr_b16 a[152:153], v238 offset:16896
 ds_read_b64_tr_b16 a[154:155], v238 offset:17152
 buffer_load_dwordx4 v248, s[32:35], s65 offen lds
 v_mfma_f32_16x16x32_bf16 v[164:167], a[168:171], v[124:127], v[164:167]
 s_waitcnt lgkmcnt(6)
 v_mul_f32 v227, v203, v227
 v_cvt_pk_bf16_f32 v231, v226, v227
 v_accvgpr_write_b32 a27, v231
 v_mfma_f32_16x16x32_bf16 v[172:175], a[172:175], v[124:127], v[172:175]
 ds_read_b64_tr_b16 a[156:157], v239 offset:16896
 ds_read_b64_tr_b16 a[158:159], v239 offset:17152
 v_mfma_f32_16x16x32_bf16 v[168:171], a[172:175], v[120:123], v[168:171]
 s_waitcnt lgkmcnt(6)
 v_exp_f32 v228, v204
 v_exp_f32 v229, v205
 v_mfma_f32_16x16x32_bf16 v[144:147], a[144:147], v[128:131], v[144:147]
 ds_read_b64_tr_b16 a[160:161], v238 offset:20480
 ds_read_b64_tr_b16 a[162:163], v238 offset:20736
 v_mfma_f32_16x16x32_bf16 v[148:151], a[144:147], v[132:135], v[148:151]
 s_waitcnt lgkmcnt(6)
 v_fma_f32 v228, v228, s75, s75
 v_fma_f32 v229, v229, s75, s75
 v_mfma_f32_16x16x32_bf16 v[156:159], a[148:151], v[132:135], v[156:159]
 s_add_u32 m0, s64, 20480
 ds_read_b64_tr_b16 a[164:165], v239 offset:20480
 ds_read_b64_tr_b16 a[166:167], v239 offset:20736
 v_mfma_f32_16x16x32_bf16 v[152:155], a[148:151], v[128:131], v[152:155]
 s_waitcnt lgkmcnt(6)
 v_rcp_f32 v228, v228
 v_rcp_f32 v229, v229
 v_mfma_f32_16x16x32_bf16 v[160:163], a[152:155], v[128:131], v[160:163]
 s_mov_b32 s65, 1475072
 ds_read_b64_tr_b16 a[168:169], v238 offset:20992
 ds_read_b64_tr_b16 a[170:171], v238 offset:21248
 buffer_load_dwordx4 v248, s[32:35], s65 offen lds
 v_mfma_f32_16x16x32_bf16 v[164:167], a[152:155], v[132:135], v[164:167]
 s_waitcnt lgkmcnt(6)
 v_mul_f32 v228, v204, v228
 v_mul_f32 v229, v205, v229
 v_cvt_pk_bf16_f32 v232, v228, v229
 v_mfma_f32_16x16x32_bf16 v[172:175], a[156:159], v[132:135], v[172:175]
 ds_read_b64_tr_b16 a[172:173], v239 offset:20992
 ds_read_b64_tr_b16 a[174:175], v239 offset:21248
 v_mfma_f32_16x16x32_bf16 v[168:171], a[156:159], v[128:131], v[168:171]
 s_waitcnt lgkmcnt(6)
 v_accvgpr_write_b32 a30, v232
 v_exp_f32 v224, v206
 v_mfma_f32_16x16x32_bf16 v[144:147], a[160:163], v[136:139], v[144:147]
 s_waitcnt vmcnt(18)
 s_barrier
 ds_read_b64_tr_b16 a[144:145], v238 offset:24576
 ds_read_b64_tr_b16 a[146:147], v238 offset:24832
 v_mfma_f32_16x16x32_bf16 v[148:151], a[160:163], v[140:143], v[148:151]
 s_waitcnt lgkmcnt(6)
 v_exp_f32 v225, v207
 v_fma_f32 v224, v224, s75, s75
 v_mfma_f32_16x16x32_bf16 v[156:159], a[164:167], v[140:143], v[156:159]
 s_add_u32 m0, s64, 24576
 ds_read_b64_tr_b16 a[148:149], v239 offset:24576
 ds_read_b64_tr_b16 a[150:151], v239 offset:24832
 v_mfma_f32_16x16x32_bf16 v[152:155], a[164:167], v[136:139], v[152:155]
 s_waitcnt lgkmcnt(6)
 v_fma_f32 v225, v225, s75, s75
 v_rcp_f32 v224, v224
 v_mfma_f32_16x16x32_bf16 v[160:163], a[168:171], v[136:139], v[160:163]
 s_mov_b32 s65, 1769984
 ds_read_b64_tr_b16 a[152:153], v238 offset:25088
 ds_read_b64_tr_b16 a[154:155], v238 offset:25344
 buffer_load_dwordx4 v248, s[32:35], s65 offen lds
 v_mfma_f32_16x16x32_bf16 v[164:167], a[168:171], v[140:143], v[164:167]
 s_waitcnt lgkmcnt(6)
 v_rcp_f32 v225, v225
 v_mul_f32 v224, v206, v224
 v_mfma_f32_16x16x32_bf16 v[172:175], a[172:175], v[140:143], v[172:175]
 ds_read_b64_tr_b16 a[156:157], v239 offset:25088
 ds_read_b64_tr_b16 a[158:159], v239 offset:25344
 v_mfma_f32_16x16x32_bf16 v[168:171], a[172:175], v[136:139], v[168:171]
 s_waitcnt lgkmcnt(6)
 v_mul_f32 v225, v207, v225
 v_cvt_pk_bf16_f32 v230, v224, v225
 v_accvgpr_write_b32 a31, v230
 v_mfma_f32_16x16x32_bf16 v[176:179], a[144:147], v[0:3], 0
 s_cmp_eq_u32 s15, 2
 s_cbranch_scc1 L_hsl3
L_hsl3_ok:
 s_cmp_eq_u32 s15, 0
 s_cbranch_scc1 L_hsc3
L_hsc3_ok:
 ds_read_b64_tr_b16 a[160:161], v238 offset:28672
 ds_read_b64_tr_b16 a[162:163], v238 offset:28928
 v_mfma_f32_16x16x32_bf16 v[180:183], a[144:147], v[4:7], 0
 s_waitcnt lgkmcnt(6)
 v_mfma_f32_16x16x32_bf16 v[188:191], a[148:151], v[4:7], 0
 s_add_u32 m0, s64, 28672
 ds_read_b64_tr_b16 a[164:165], v239 offset:28672
 ds_read_b64_tr_b16 a[166:167], v239 offset:28928
 v_mfma_f32_16x16x32_bf16 v[184:187], a[148:151], v[0:3], 0
 s_waitcnt lgkmcnt(6)
 v_exp_f32 v224, v144
 v_exp_f32 v225, v145
 v_mfma_f32_16x16x32_bf16 v[192:195], a[152:155], v[0:3], 0
 s_mov_b32 s65, 2064896
 ds_read_b64_tr_b16 a[168:169], v238 offset:29184
 ds_read_b64_tr_b16 a[170:171], v238 offset:29440
 buffer_load_dwordx4 v248, s[32:35], s65 offen lds
 v_mfma_f32_16x16x32_bf16 v[196:199], a[152:155], v[4:7], 0
 s_waitcnt lgkmcnt(6)
 v_fma_f32 v224, v224, s75, s75
 v_fma_f32 v225, v225, s75, s75
 v_rcp_f32 v224, v224
 v_mfma_f32_16x16x32_bf16 v[204:207], a[156:159], v[4:7], 0
 ds_read_b64_tr_b16 a[172:173], v239 offset:29184
 ds_read_b64_tr_b16 a[174:175], v239 offset:29440
 v_mfma_f32_16x16x32_bf16 v[200:203], a[156:159], v[0:3], 0
 s_waitcnt lgkmcnt(6)
 v_rcp_f32 v225, v225
 v_mfma_f32_16x16x32_bf16 v[176:179], a[160:163], v[8:11], v[176:179]
 ds_read_b64_tr_b16 a[144:145], v238 offset:32768
 ds_read_b64_tr_b16 a[146:147], v238 offset:33024
 v_mfma_f32_16x16x32_bf16 v[180:183], a[160:163], v[12:15], v[180:183]
 s_waitcnt lgkmcnt(6)
 v_mul_f32 v224, v144, v224
 v_mul_f32 v225, v145, v225
 v_cvt_pk_bf16_f32 v230, v224, v225
 v_mfma_f32_16x16x32_bf16 v[188:191], a[164:167], v[12:15], v[188:191]
 s_add_u32 m0, s64, 32768
 ds_read_b64_tr_b16 a[148:149], v239 offset:32768
 ds_read_b64_tr_b16 a[150:151], v239 offset:33024
 v_mfma_f32_16x16x32_bf16 v[184:187], a[164:167], v[8:11], v[184:187]
 s_waitcnt lgkmcnt(6)
 v_accvgpr_write_b32 a32, v230
 v_exp_f32 v226, v146
 v_mfma_f32_16x16x32_bf16 v[192:195], a[168:171], v[8:11], v[192:195]
 s_mov_b32 s65, 2359808
 ds_read_b64_tr_b16 a[152:153], v238 offset:33280
 ds_read_b64_tr_b16 a[154:155], v238 offset:33536
 buffer_load_dwordx4 v248, s[32:35], s65 offen lds
 v_mfma_f32_16x16x32_bf16 v[196:199], a[168:171], v[12:15], v[196:199]
 s_waitcnt lgkmcnt(6)
 v_exp_f32 v227, v147
 v_fma_f32 v226, v226, s75, s75
 v_mfma_f32_16x16x32_bf16 v[204:207], a[172:175], v[12:15], v[204:207]
 ds_read_b64_tr_b16 a[156:157], v239 offset:33280
 ds_read_b64_tr_b16 a[158:159], v239 offset:33536
 v_mfma_f32_16x16x32_bf16 v[200:203], a[172:175], v[8:11], v[200:203]
 s_waitcnt lgkmcnt(6)
 v_fma_f32 v227, v227, s75, s75
 v_rcp_f32 v226, v226
 v_mfma_f32_16x16x32_bf16 v[176:179], a[144:147], v[16:19], v[176:179]
 ds_read_b64_tr_b16 a[160:161], v238 offset:36864
 ds_read_b64_tr_b16 a[162:163], v238 offset:37120
 v_mfma_f32_16x16x32_bf16 v[180:183], a[144:147], v[20:23], v[180:183]
 s_waitcnt lgkmcnt(6)
 v_rcp_f32 v227, v227
 v_mul_f32 v226, v146, v226
 v_mul_f32 v227, v147, v227
 v_mfma_f32_16x16x32_bf16 v[188:191], a[148:151], v[20:23], v[188:191]
 s_add_u32 m0, s64, 36864
 ds_read_b64_tr_b16 a[164:165], v239 offset:36864
 ds_read_b64_tr_b16 a[166:167], v239 offset:37120
 v_mfma_f32_16x16x32_bf16 v[184:187], a[148:151], v[16:19], v[184:187]
 s_waitcnt lgkmcnt(6)
 v_cvt_pk_bf16_f32 v231, v226, v227
 v_accvgpr_write_b32 a33, v231
 v_exp_f32 v228, v148
 v_mfma_f32_16x16x32_bf16 v[192:195], a[152:155], v[16:19], v[192:195]
 s_mov_b32 s65, 2654720
 ds_read_b64_tr_b16 a[168:169], v238 offset:37376
 ds_read_b64_tr_b16 a[170:171], v238 offset:37632
 buffer_load_dwordx4 v248, s[32:35], s65 offen lds
 v_mfma_f32_16x16x32_bf16 v[196:199], a[152:155], v[20:23], v[196:199]
 s_waitcnt lgkmcnt(6)
 v_exp_f32 v229, v149
 v_mfma_f32_16x16x32_bf16 v[204:207], a[156:159], v[20:23], v[204:207]
 ds_read_b64_tr_b16 a[172:173], v239 offset:37376
 ds_read_b64_tr_b16 a[174:175], v239 offset:37632
 v_mfma_f32_16x16x32_bf16 v[200:203], a[156:159], v[16:19], v[200:203]
 s_waitcnt lgkmcnt(6)
 v_fma_f32 v228, v228, s75, s75
 v_fma_f32 v229, v229, s75, s75
 v_rcp_f32 v228, v228
 v_mfma_f32_16x16x32_bf16 v[176:179], a[160:163], v[24:27], v[176:179]
 ds_read_b64_tr_b16 a[144:145], v238 offset:40960
 ds_read_b64_tr_b16 a[146:147], v238 offset:41216
 v_mfma_f32_16x16x32_bf16 v[180:183], a[160:163], v[28:31], v[180:183]
 s_waitcnt lgkmcnt(6)
 v_rcp_f32 v229, v229
 v_mfma_f32_16x16x32_bf16 v[188:191], a[164:167], v[28:31], v[188:191]
 s_add_u32 m0, s64, 40960
 ds_read_b64_tr_b16 a[148:149], v239 offset:40960
 ds_read_b64_tr_b16 a[150:151], v239 offset:41216
 v_mfma_f32_16x16x32_bf16 v[184:187], a[164:167], v[24:27], v[184:187]
 s_waitcnt lgkmcnt(6)
 v_mul_f32 v228, v148, v228
 v_mul_f32 v229, v149, v229
 v_cvt_pk_bf16_f32 v232, v228, v229
 v_accvgpr_write_b32 a36, v232
 v_mfma_f32_16x16x32_bf16 v[192:195], a[168:171], v[24:27], v[192:195]
 s_mov_b32 s65, 2949632
 ds_read_b64_tr_b16 a[152:153], v238 offset:41472
 ds_read_b64_tr_b16 a[154:155], v238 offset:41728
 buffer_load_dwordx4 v248, s[32:35], s65 offen lds
 v_mfma_f32_16x16x32_bf16 v[196:199], a[168:171], v[28:31], v[196:199]
 s_waitcnt lgkmcnt(6)
 v_exp_f32 v224, v150
 v_exp_f32 v225, v151
 v_mfma_f32_16x16x32_bf16 v[204:207], a[172:175], v[28:31], v[204:207]
 ds_read_b64_tr_b16 a[156:157], v239 offset:41472
 ds_read_b64_tr_b16 a[158:159], v239 offset:41728
 v_mfma_f32_16x16x32_bf16 v[200:203], a[172:175], v[24:27], v[200:203]
 s_waitcnt lgkmcnt(6)
 v_fma_f32 v224, v224, s75, s75
 v_fma_f32 v225, v225, s75, s75
 v_mfma_f32_16x16x32_bf16 v[176:179], a[144:147], v[32:35], v[176:179]
 ds_read_b64_tr_b16 a[160:161], v238 offset:45056
 ds_read_b64_tr_b16 a[162:163], v238 offset:45312
 v_mfma_f32_16x16x32_bf16 v[180:183], a[144:147], v[36:39], v[180:183]
 s_waitcnt lgkmcnt(6)
 v_rcp_f32 v224, v224
 v_rcp_f32 v225, v225
 v_mfma_f32_16x16x32_bf16 v[188:191], a[148:151], v[36:39], v[188:191]
 s_add_u32 m0, s64, 45056
 ds_read_b64_tr_b16 a[164:165], v239 offset:45056
 ds_read_b64_tr_b16 a[166:167], v239 offset:45312
 v_mfma_f32_16x16x32_bf16 v[184:187], a[148:151], v[32:35], v[184:187]
 s_waitcnt lgkmcnt(6)
 v_mul_f32 v224, v150, v224
 v_mul_f32 v225, v151, v225
 v_mfma_f32_16x16x32_bf16 v[192:195], a[152:155], v[32:35], v[192:195]
 s_mov_b32 s65, 3244544
 ds_read_b64_tr_b16 a[168:169], v238 offset:45568
 ds_read_b64_tr_b16 a[170:171], v238 offset:45824
 buffer_load_dwordx4 v248, s[32:35], s65 offen lds
 v_mfma_f32_16x16x32_bf16 v[196:199], a[152:155], v[36:39], v[196:199]
 s_waitcnt lgkmcnt(6)
 v_cvt_pk_bf16_f32 v230, v224, v225
 v_accvgpr_write_b32 a37, v230
 v_exp_f32 v226, v152
 v_mfma_f32_16x16x32_bf16 v[204:207], a[156:159], v[36:39], v[204:207]
 ds_read_b64_tr_b16 a[172:173], v239 offset:45568
 ds_read_b64_tr_b16 a[174:175], v239 offset:45824
 v_mfma_f32_16x16x32_bf16 v[200:203], a[156:159], v[32:35], v[200:203]
 s_waitcnt lgkmcnt(6)
 v_exp_f32 v227, v153
 v_mfma_f32_16x16x32_bf16 v[176:179], a[160:163], v[40:43], v[176:179]
 s_waitcnt vmcnt(18)
 s_barrier
 ds_read_b64_tr_b16 a[144:145], v240 offset:0
 ds_read_b64_tr_b16 a[146:147], v240 offset:256
 v_mfma_f32_16x16x32_bf16 v[180:183], a[160:163], v[44:47], v[180:183]
 s_waitcnt lgkmcnt(6)
 v_fma_f32 v226, v226, s75, s75
 v_fma_f32 v227, v227, s75, s75
 v_rcp_f32 v226, v226
 v_mfma_f32_16x16x32_bf16 v[188:191], a[164:167], v[44:47], v[188:191]
 s_add_u32 m0, s64, 49152
 ds_read_b64_tr_b16 a[148:149], v241 offset:0
 ds_read_b64_tr_b16 a[150:151], v241 offset:256
 v_mfma_f32_16x16x32_bf16 v[184:187], a[164:167], v[40:43], v[184:187]
 s_waitcnt lgkmcnt(6)
 v_rcp_f32 v227, v227
 v_mul_f32 v226, v152, v226
 v_mfma_f32_16x16x32_bf16 v[192:195], a[168:171], v[40:43], v[192:195]
 s_mov_b32 s65, 3539456
 ds_read_b64_tr_b16 a[152:153], v240 offset:512
 ds_read_b64_tr_b16 a[154:155], v240 offset:768
 buffer_load_dwordx4 v248, s[32:35], s65 offen lds
 v_mfma_f32_16x16x32_bf16 v[196:199], a[168:171], v[44:47], v[196:199]
 s_waitcnt lgkmcnt(6)
 v_mul_f32 v227, v153, v227
 v_cvt_pk_bf16_f32 v231, v226, v227
 v_accvgpr_write_b32 a34, v231
 v_mfma_f32_16x16x32_bf16 v[204:207], a[172:175], v[44:47], v[204:207]
 ds_read_b64_tr_b16 a[156:157], v241 offset:512
 ds_read_b64_tr_b16 a[158:159], v241 offset:768
 v_mfma_f32_16x16x32_bf16 v[200:203], a[172:175], v[40:43], v[200:203]
 s_waitcnt lgkmcnt(6)
 v_exp_f32 v228, v154
 v_exp_f32 v229, v155
 v_mfma_f32_16x16x32_bf16 v[176:179], a[144:147], v[48:51], v[176:179]
 ds_read_b64_tr_b16 a[160:161], v240 offset:4096
 ds_read_b64_tr_b16 a[162:163], v240 offset:4352
 v_mfma_f32_16x16x32_bf16 v[180:183], a[144:147], v[52:55], v[180:183]
 s_waitcnt lgkmcnt(6)
 v_fma_f32 v228, v228, s75, s75
 v_fma_f32 v229, v229, s75, s75
 v_mfma_f32_16x16x32_bf16 v[188:191], a[148:151], v[52:55], v[188:191]
 s_add_u32 m0, s64, 53248
 ds_read_b64_tr_b16 a[164:165], v241 offset:4096
 ds_read_b64_tr_b16 a[166:167], v241 offset:4352
 v_mfma_f32_16x16x32_bf16 v[184:187], a[148:151], v[48:51], v[184:187]
 s_waitcnt lgkmcnt(6)
 v_rcp_f32 v228, v228
 v_rcp_f32 v229, v229
 v_mfma_f32_16x16x32_bf16 v[192:195], a[152:155], v[48:51], v[192:195]
 s_mov_b32 s65, 3834368
 ds_read_b64_tr_b16 a[168:169], v240 offset:4608
 ds_read_b64_tr_b16 a[170:171], v240 offset:4864
 buffer_load_dwordx4 v248, s[32:35], s65 offen lds
 v_mfma_f32_16x16x32_bf16 v[196:199], a[152:155], v[52:55], v[196:199]
 s_waitcnt lgkmcnt(6)
 v_mul_f32 v228, v154, v228
 v_mul_f32 v229, v155, v229
 v_cvt_pk_bf16_f32 v232, v228, v229
 v_mfma_f32_16x16x32_bf16 v[204:207], a[156:159], v[52:55], v[204:207]
 ds_read_b64_tr_b16 a[172:173], v241 offset:4608
 ds_read_b64_tr_b16 a[174:175], v241 offset:4864
 v_mfma_f32_16x16x32_bf16 v[200:203], a[156:159], v[48:51], v[200:203]
 s_waitcnt lgkmcnt(6)
 v_accvgpr_write_b32 a35, v232
 v_exp_f32 v224, v156
 v_mfma_f32_16x16x32_bf16 v[176:179], a[160:163], v[56:59], v[176:179]
 ds_read_b64_tr_b16 a[144:145], v240 offset:8192
 ds_read_b64_tr_b16 a[146:147], v240 offset:8448
 v_mfma_f32_16x16x32_bf16 v[180:183], a[160:163], v[60:63], v[180:183]
 s_waitcnt lgkmcnt(6)
 v_exp_f32 v225, v157
 v_fma_f32 v224, v224, s75, s75
 v_mfma_f32_16x16x32_bf16 v[188:191], a[164:167], v[60:63], v[188:191]
 s_add_u32 m0, s64, 57344
 ds_read_b64_tr_b16 a[148:149], v241 offset:8192
 ds_read_b64_tr_b16 a[150:151], v241 offset:8448
 v_mfma_f32_16x16x32_bf16 v[184:187], a[164:167], v[56:59], v[184:187]
 s_waitcnt lgkmcnt(6)
 v_fma_f32 v225, v225, s75, s75
 v_rcp_f32 v224, v224
 v_mfma_f32_16x16x32_bf16 v[192:195], a[168:171], v[56:59], v[192:195]
 s_mov_b32 s65, 4129280
 ds_read_b64_tr_b16 a[152:153], v240 offset:8704
 ds_read_b64_tr_b16 a[154:155], v240 offset:8960
 buffer_load_dwordx4 v248, s[32:35], s65 offen lds
 v_mfma_f32_16x16x32_bf16 v[196:199], a[168:171], v[60:63], v[196:199]
 s_waitcnt lgkmcnt(6)
 v_rcp_f32 v225, v225
 v_mul_f32 v224, v156, v224
 v_mfma_f32_16x16x32_bf16 v[204:207], a[172:175], v[60:63], v[204:207]
 ds_read_b64_tr_b16 a[156:157], v241 offset:8704
 ds_read_b64_tr_b16 a[158:159], v241 offset:8960
 v_mfma_f32_16x16x32_bf16 v[200:203], a[172:175], v[56:59], v[200:203]
 s_waitcnt lgkmcnt(6)
 v_mul_f32 v225, v157, v225
 v_cvt_pk_bf16_f32 v230, v224, v225
 v_accvgpr_write_b32 a38, v230
 v_mfma_f32_16x16x32_bf16 v[176:179], a[144:147], v[64:67], v[176:179]
 ds_read_b64_tr_b16 a[160:161], v240 offset:12288
 ds_read_b64_tr_b16 a[162:163], v240 offset:12544
 v_mfma_f32_16x16x32_bf16 v[180:183], a[144:147], v[68:71], v[180:183]
 s_waitcnt lgkmcnt(6)
 v_exp_f32 v226, v158
 v_exp_f32 v227, v159
 v_mfma_f32_16x16x32_bf16 v[188:191], a[148:151], v[68:71], v[188:191]
 s_add_u32 m0, s64, 61440
 ds_read_b64_tr_b16 a[164:165], v241 offset:12288
 ds_read_b64_tr_b16 a[166:167], v241 offset:12544
 v_mfma_f32_16x16x32_bf16 v[184:187], a[148:151], v[64:67], v[184:187]
 s_waitcnt lgkmcnt(6)
 v_fma_f32 v226, v226, s75, s75
 v_fma_f32 v227, v227, s75, s75
 v_rcp_f32 v226, v226
 v_mfma_f32_16x16x32_bf16 v[192:195], a[152:155], v[64:67], v[192:195]
 s_mov_b32 s65, 4424192
 ds_read_b64_tr_b16 a[168:169], v240 offset:12800
 ds_read_b64_tr_b16 a[170:171], v240 offset:13056
 buffer_load_dwordx4 v248, s[32:35], s65 offen lds
 v_mfma_f32_16x16x32_bf16 v[196:199], a[152:155], v[68:71], v[196:199]
 s_waitcnt lgkmcnt(6)
 v_rcp_f32 v227, v227
 v_mfma_f32_16x16x32_bf16 v[204:207], a[156:159], v[68:71], v[204:207]
 ds_read_b64_tr_b16 a[172:173], v241 offset:12800
 ds_read_b64_tr_b16 a[174:175], v241 offset:13056
 v_mfma_f32_16x16x32_bf16 v[200:203], a[156:159], v[64:67], v[200:203]
 s_waitcnt lgkmcnt(6)
 v_mul_f32 v226, v158, v226
 v_mul_f32 v227, v159, v227
 v_cvt_pk_bf16_f32 v231, v226, v227
 v_mfma_f32_16x16x32_bf16 v[176:179], a[160:163], v[72:75], v[176:179]
 ds_read_b64_tr_b16 a[144:145], v240 offset:16384
 ds_read_b64_tr_b16 a[146:147], v240 offset:16640
 v_mfma_f32_16x16x32_bf16 v[180:183], a[160:163], v[76:79], v[180:183]
 s_waitcnt lgkmcnt(6)
 v_accvgpr_write_b32 a39, v231
 v_exp_f32 v228, v160
 v_mfma_f32_16x16x32_bf16 v[188:191], a[164:167], v[76:79], v[188:191]
 s_add_u32 m0, s64, 65536
 ds_read_b64_tr_b16 a[148:149], v241 offset:16384
 ds_read_b64_tr_b16 a[150:151], v241 offset:16640
 v_mfma_f32_16x16x32_bf16 v[184:187], a[164:167], v[72:75], v[184:187]
 s_waitcnt lgkmcnt(6)
 v_exp_f32 v229, v161
 v_fma_f32 v228, v228, s75, s75
 v_mfma_f32_16x16x32_bf16 v[192:195], a[168:171], v[72:75], v[192:195]
 s_mov_b32 s65, 4719104
 ds_read_b64_tr_b16 a[152:153], v240 offset:16896
 ds_read_b64_tr_b16 a[154:155], v240 offset:17152
 buffer_load_dwordx4 v248, s[32:35], s65 offen lds
 v_mfma_f32_16x16x32_bf16 v[196:199], a[168:171], v[76:79], v[196:199]
 s_waitcnt lgkmcnt(6)
 v_fma_f32 v229, v229, s75, s75
 v_rcp_f32 v228, v228
 v_mfma_f32_16x16x32_bf16 v[204:207], a[172:175], v[76:79], v[204:207]
 ds_read_b64_tr_b16 a[156:157], v241 offset:16896
 ds_read_b64_tr_b16 a[158:159], v241 offset:17152
 v_mfma_f32_16x16x32_bf16 v[200:203], a[172:175], v[72:75], v[200:203]
 s_waitcnt lgkmcnt(6)
 v_rcp_f32 v229, v229
 v_mul_f32 v228, v160, v228
 v_mul_f32 v229, v161, v229
 v_mfma_f32_16x16x32_bf16 v[176:179], a[144:147], v[80:83], v[176:179]
 ds_read_b64_tr_b16 a[160:161], v240 offset:20480
 ds_read_b64_tr_b16 a[162:163], v240 offset:20736
 v_mfma_f32_16x16x32_bf16 v[180:183], a[144:147], v[84:87], v[180:183]
 s_waitcnt lgkmcnt(6)
 v_cvt_pk_bf16_f32 v232, v228, v229
 v_accvgpr_write_b32 a40, v232
 v_exp_f32 v224, v162
 v_mfma_f32_16x16x32_bf16 v[188:191], a[148:151], v[84:87], v[188:191]
 s_add_u32 m0, s64, 69632
 ds_read_b64_tr_b16 a[164:165], v241 offset:20480
 ds_read_b64_tr_b16 a[166:167], v241 offset:20736
 v_mfma_f32_16x16x32_bf16 v[184:187], a[148:151], v[80:83], v[184:187]
 s_waitcnt lgkmcnt(6)
 v_exp_f32 v225, v163
 v_mfma_f32_16x16x32_bf16 v[192:195], a[152:155], v[80:83], v[192:195]
 s_mov_b32 s65, 5014016
 ds_read_b64_tr_b16 a[168:169], v240 offset:20992
 ds_read_b64_tr_b16 a[170:171], v240 offset:21248
 buffer_load_dwordx4 v248, s[32:35], s65 offen lds
 v_mfma_f32_16x16x32_bf16 v[196:199], a[152:155], v[84:87], v[196:199]
 s_waitcnt lgkmcnt(6)
 v_fma_f32 v224, v224, s75, s75
 v_fma_f32 v225, v225, s75, s75
 v_rcp_f32 v224, v224
 v_mfma_f32_16x16x32_bf16 v[204:207], a[156:159], v[84:87], v[204:207]
 ds_read_b64_tr_b16 a[172:173], v241 offset:20992
 ds_read_b64_tr_b16 a[174:175], v241 offset:21248
 v_mfma_f32_16x16x32_bf16 v[200:203], a[156:159], v[80:83], v[200:203]
 s_waitcnt lgkmcnt(6)
 v_rcp_f32 v225, v225
 v_mfma_f32_16x16x32_bf16 v[176:179], a[160:163], v[88:91], v[176:179]
 s_waitcnt vmcnt(18)
 s_barrier
 ds_read_b64_tr_b16 a[144:145], v240 offset:24576
 ds_read_b64_tr_b16 a[146:147], v240 offset:24832
 v_mfma_f32_16x16x32_bf16 v[180:183], a[160:163], v[92:95], v[180:183]
 s_waitcnt lgkmcnt(6)
 v_mul_f32 v224, v162, v224
 v_mul_f32 v225, v163, v225
 v_cvt_pk_bf16_f32 v230, v224, v225
 v_mfma_f32_16x16x32_bf16 v[188:191], a[164:167], v[92:95], v[188:191]
 s_add_u32 m0, s64, 73728
 ds_read_b64_tr_b16 a[148:149], v241 offset:24576
 ds_read_b64_tr_b16 a[150:151], v241 offset:24832
 v_mfma_f32_16x16x32_bf16 v[184:187], a[164:167], v[88:91], v[184:187]
 s_waitcnt lgkmcnt(6)
 v_accvgpr_write_b32 a41, v230
 v_exp_f32 v226, v164
 v_mfma_f32_16x16x32_bf16 v[192:195], a[168:171], v[88:91], v[192:195]
 s_mov_b32 s65, 640
 ds_read_b64_tr_b16 a[152:153], v240 offset:25088
 ds_read_b64_tr_b16 a[154:155], v240 offset:25344
 buffer_load_dwordx4 v248, s[32:35], s65 offen lds
 v_mfma_f32_16x16x32_bf16 v[196:199], a[168:171], v[92:95], v[196:199]
 s_waitcnt lgkmcnt(6)
 v_exp_f32 v227, v165
 v_fma_f32 v226, v226, s75, s75
 v_fma_f32 v227, v227, s75, s75
 v_mfma_f32_16x16x32_bf16 v[204:207], a[172:175], v[92:95], v[204:207]
 ds_read_b64_tr_b16 a[156:157], v241 offset:25088
 ds_read_b64_tr_b16 a[158:159], v241 offset:25344
 v_mfma_f32_16x16x32_bf16 v[200:203], a[172:175], v[88:91], v[200:203]
 s_waitcnt lgkmcnt(6)
 v_rcp_f32 v226, v226
 v_rcp_f32 v227, v227
 v_mfma_f32_16x16x32_bf16 v[176:179], a[144:147], v[96:99], v[176:179]
 ds_read_b64_tr_b16 a[160:161], v240 offset:28672
 ds_read_b64_tr_b16 a[162:163], v240 offset:28928
 v_mfma_f32_16x16x32_bf16 v[180:183], a[144:147], v[100:103], v[180:183]
 s_waitcnt lgkmcnt(6)
 v_mul_f32 v226, v164, v226
 v_mul_f32 v227, v165, v227
 v_mfma_f32_16x16x32_bf16 v[188:191], a[148:151], v[100:103], v[188:191]
 s_add_u32 m0, s64, 77824
 ds_read_b64_tr_b16 a[164:165], v241 offset:28672
 ds_read_b64_tr_b16 a[166:167], v241 offset:28928
 v_mfma_f32_16x16x32_bf16 v[184:187], a[148:151], v[96:99], v[184:187]
 s_waitcnt lgkmcnt(6)
 v_cvt_pk_bf16_f32 v231, v226, v227
 v_accvgpr_write_b32 a44, v231
 v_exp_f32 v228, v166
 v_mfma_f32_16x16x32_bf16 v[192:195], a[152:155], v[96:99], v[192:195]
 s_mov_b32 s65, 295552
 ds_read_b64_tr_b16 a[168:169], v240 offset:29184
 ds_read_b64_tr_b16 a[170:171], v240 offset:29440
 buffer_load_dwordx4 v248, s[32:35], s65 offen lds
 v_mfma_f32_16x16x32_bf16 v[196:199], a[152:155], v[100:103], v[196:199]
 s_waitcnt lgkmcnt(6)
 v_exp_f32 v229, v167
 v_mfma_f32_16x16x32_bf16 v[204:207], a[156:159], v[100:103], v[204:207]
 ds_read_b64_tr_b16 a[172:173], v241 offset:29184
 ds_read_b64_tr_b16 a[174:175], v241 offset:29440
 v_mfma_f32_16x16x32_bf16 v[200:203], a[156:159], v[96:99], v[200:203]
 s_waitcnt lgkmcnt(6)
 v_fma_f32 v228, v228, s75, s75
 v_fma_f32 v229, v229, s75, s75
 v_rcp_f32 v228, v228
 v_mfma_f32_16x16x32_bf16 v[176:179], a[160:163], v[104:107], v[176:179]
 ds_read_b64_tr_b16 a[144:145], v240 offset:32768
 ds_read_b64_tr_b16 a[146:147], v240 offset:33024
 v_mfma_f32_16x16x32_bf16 v[180:183], a[160:163], v[108:111], v[180:183]
 s_waitcnt lgkmcnt(6)
 v_rcp_f32 v229, v229
 v_mul_f32 v228, v166, v228
 v_mfma_f32_16x16x32_bf16 v[188:191], a[164:167], v[108:111], v[188:191]
 s_add_u32 m0, s64, 81920
 ds_read_b64_tr_b16 a[148:149], v241 offset:32768
 ds_read_b64_tr_b16 a[150:151], v241 offset:33024
 v_mfma_f32_16x16x32_bf16 v[184:187], a[164:167], v[104:107], v[184:187]
 s_waitcnt lgkmcnt(6)
 v_mul_f32 v229, v167, v229
 v_cvt_pk_bf16_f32 v232, v228, v229
 v_accvgpr_write_b32 a45, v232
 v_mfma_f32_16x16x32_bf16 v[192:195], a[168:171], v[104:107], v[192:195]
 s_mov_b32 s65, 590464
 ds_read_b64_tr_b16 a[152:153], v240 offset:33280
 ds_read_b64_tr_b16 a[154:155], v240 offset:33536
 buffer_load_dwordx4 v248, s[32:35], s65 offen lds
 v_mfma_f32_16x16x32_bf16 v[196:199], a[168:171], v[108:111], v[196:199]
 s_waitcnt lgkmcnt(6)
 v_exp_f32 v224, v168
 v_exp_f32 v225, v169
 v_mfma_f32_16x16x32_bf16 v[204:207], a[172:175], v[108:111], v[204:207]
 ds_read_b64_tr_b16 a[156:157], v241 offset:33280
 ds_read_b64_tr_b16 a[158:159], v241 offset:33536
 v_mfma_f32_16x16x32_bf16 v[200:203], a[172:175], v[104:107], v[200:203]
 s_waitcnt lgkmcnt(6)
 v_fma_f32 v224, v224, s75, s75
 v_fma_f32 v225, v225, s75, s75
 v_mfma_f32_16x16x32_bf16 v[176:179], a[144:147], v[112:115], v[176:179]
 ds_read_b64_tr_b16 a[160:161], v240 offset:36864
 ds_read_b64_tr_b16 a[162:163], v240 offset:37120
 v_mfma_f32_16x16x32_bf16 v[180:183], a[144:147], v[116:119], v[180:183]
 s_waitcnt lgkmcnt(6)
 v_rcp_f32 v224, v224
 v_rcp_f32 v225, v225
 v_mfma_f32_16x16x32_bf16 v[188:191], a[148:151], v[116:119], v[188:191]
 s_add_u32 m0, s64, 86016
 ds_read_b64_tr_b16 a[164:165], v241 offset:36864
 ds_read_b64_tr_b16 a[166:167], v241 offset:37120
 v_mfma_f32_16x16x32_bf16 v[184:187], a[148:151], v[112:115], v[184:187]
 s_waitcnt lgkmcnt(6)
 v_mul_f32 v224, v168, v224
 v_mul_f32 v225, v169, v225
 v_mfma_f32_16x16x32_bf16 v[192:195], a[152:155], v[112:115], v[192:195]
 s_mov_b32 s65, 885376
 ds_read_b64_tr_b16 a[168:169], v240 offset:37376
 ds_read_b64_tr_b16 a[170:171], v240 offset:37632
 buffer_load_dwordx4 v248, s[32:35], s65 offen lds
 v_mfma_f32_16x16x32_bf16 v[196:199], a[152:155], v[116:119], v[196:199]
 s_waitcnt lgkmcnt(6)
 v_cvt_pk_bf16_f32 v230, v224, v225
 v_accvgpr_write_b32 a42, v230
 v_exp_f32 v226, v170
 v_mfma_f32_16x16x32_bf16 v[204:207], a[156:159], v[116:119], v[204:207]
 ds_read_b64_tr_b16 a[172:173], v241 offset:37376
 ds_read_b64_tr_b16 a[174:175], v241 offset:37632
 v_mfma_f32_16x16x32_bf16 v[200:203], a[156:159], v[112:115], v[200:203]
 s_waitcnt lgkmcnt(6)
 v_exp_f32 v227, v171
 v_fma_f32 v226, v226, s75, s75
 v_mfma_f32_16x16x32_bf16 v[176:179], a[160:163], v[120:123], v[176:179]
 ds_read_b64_tr_b16 a[144:145], v240 offset:40960
 ds_read_b64_tr_b16 a[146:147], v240 offset:41216
 v_mfma_f32_16x16x32_bf16 v[180:183], a[160:163], v[124:127], v[180:183]
 s_waitcnt lgkmcnt(6)
 v_fma_f32 v227, v227, s75, s75
 v_rcp_f32 v226, v226
 v_mfma_f32_16x16x32_bf16 v[188:191], a[164:167], v[124:127], v[188:191]
 s_add_u32 m0, s64, 90112
 ds_read_b64_tr_b16 a[148:149], v241 offset:40960
 ds_read_b64_tr_b16 a[150:151], v241 offset:41216
 v_mfma_f32_16x16x32_bf16 v[184:187], a[164:167], v[120:123], v[184:187]
 s_waitcnt lgkmcnt(6)
 v_rcp_f32 v227, v227
 v_mul_f32 v226, v170, v226
 v_mfma_f32_16x16x32_bf16 v[192:195], a[168:171], v[120:123], v[192:195]
 s_mov_b32 s65, 1180288
 ds_read_b64_tr_b16 a[152:153], v240 offset:41472
 ds_read_b64_tr_b16 a[154:155], v240 offset:41728
 buffer_load_dwordx4 v248, s[32:35], s65 offen lds
 v_mfma_f32_16x16x32_bf16 v[196:199], a[168:171], v[124:127], v[196:199]
 s_waitcnt lgkmcnt(6)
 v_mul_f32 v227, v171, v227
 v_cvt_pk_bf16_f32 v231, v226, v227
 v_accvgpr_write_b32 a43, v231
 v_mfma_f32_16x16x32_bf16 v[204:207], a[172:175], v[124:127], v[204:207]
 ds_read_b64_tr_b16 a[156:157], v241 offset:41472
 ds_read_b64_tr_b16 a[158:159], v241 offset:41728
 v_mfma_f32_16x16x32_bf16 v[200:203], a[172:175], v[120:123], v[200:203]
 s_waitcnt lgkmcnt(6)
 v_exp_f32 v228, v172
 v_exp_f32 v229, v173
 v_mfma_f32_16x16x32_bf16 v[176:179], a[144:147], v[128:131], v[176:179]
 ds_read_b64_tr_b16 a[160:161], v240 offset:45056
 ds_read_b64_tr_b16 a[162:163], v240 offset:45312
 v_mfma_f32_16x16x32_bf16 v[180:183], a[144:147], v[132:135], v[180:183]
 s_waitcnt lgkmcnt(6)
 v_fma_f32 v228, v228, s75, s75
 v_fma_f32 v229, v229, s75, s75
 v_mfma_f32_16x16x32_bf16 v[188:191], a[148:151], v[132:135], v[188:191]
 s_add_u32 m0, s64, 94208
 ds_read_b64_tr_b16 a[164:165], v241 offset:45056
 ds_read_b64_tr_b16 a[166:167], v241 offset:45312
 v_mfma_f32_16x16x32_bf16 v[184:187], a[148:151], v[128:131], v[184:187]
 s_waitcnt lgkmcnt(6)
 v_rcp_f32 v228, v228
 v_rcp_f32 v229, v229
 v_mfma_f32_16x16x32_bf16 v[192:195], a[152:155], v[128:131], v[192:195]
 s_mov_b32 s65, 1475200
 ds_read_b64_tr_b16 a[168:169], v240 offset:45568
 ds_read_b64_tr_b16 a[170:171], v240 offset:45824
 buffer_load_dwordx4 v248, s[32:35], s65 offen lds
 v_mfma_f32_16x16x32_bf16 v[196:199], a[152:155], v[132:135], v[196:199]
 s_waitcnt lgkmcnt(6)
 v_mul_f32 v228, v172, v228
 v_mul_f32 v229, v173, v229
 v_cvt_pk_bf16_f32 v232, v228, v229
 v_mfma_f32_16x16x32_bf16 v[204:207], a[156:159], v[132:135], v[204:207]
 ds_read_b64_tr_b16 a[172:173], v241 offset:45568
 ds_read_b64_tr_b16 a[174:175], v241 offset:45824
 v_mfma_f32_16x16x32_bf16 v[200:203], a[156:159], v[128:131], v[200:203]
 s_waitcnt lgkmcnt(6)
 v_accvgpr_write_b32 a46, v232
 v_exp_f32 v224, v174
 v_mfma_f32_16x16x32_bf16 v[176:179], a[160:163], v[136:139], v[176:179]
 s_waitcnt vmcnt(18)
 s_barrier
 ds_read_b64_tr_b16 a[144:145], v236 offset:0
 ds_read_b64_tr_b16 a[146:147], v236 offset:256
 v_mfma_f32_16x16x32_bf16 v[180:183], a[160:163], v[140:143], v[180:183]
 s_waitcnt lgkmcnt(6)
 v_exp_f32 v225, v175
 v_fma_f32 v224, v224, s75, s75
 v_mfma_f32_16x16x32_bf16 v[188:191], a[164:167], v[140:143], v[188:191]
 s_add_u32 m0, s64, 98304
 ds_read_b64_tr_b16 a[148:149], v237 offset:0
 ds_read_b64_tr_b16 a[150:151], v237 offset:256
 v_mfma_f32_16x16x32_bf16 v[184:187], a[164:167], v[136:139], v[184:187]
 s_waitcnt lgkmcnt(6)
 v_fma_f32 v225, v225, s75, s75
 v_rcp_f32 v224, v224
 v_mfma_f32_16x16x32_bf16 v[192:195], a[168:171], v[136:139], v[192:195]
 s_mov_b32 s65, 1770112
 ds_read_b64_tr_b16 a[152:153], v236 offset:512
 ds_read_b64_tr_b16 a[154:155], v236 offset:768
 buffer_load_dwordx4 v248, s[32:35], s65 offen lds
 v_mfma_f32_16x16x32_bf16 v[196:199], a[168:171], v[140:143], v[196:199]
 s_waitcnt lgkmcnt(6)
 v_rcp_f32 v225, v225
 v_mul_f32 v224, v174, v224
 v_mfma_f32_16x16x32_bf16 v[204:207], a[172:175], v[140:143], v[204:207]
 ds_read_b64_tr_b16 a[156:157], v237 offset:512
 ds_read_b64_tr_b16 a[158:159], v237 offset:768
 v_mfma_f32_16x16x32_bf16 v[200:203], a[172:175], v[136:139], v[200:203]
 s_waitcnt lgkmcnt(6)
 v_mul_f32 v225, v175, v225
 v_cvt_pk_bf16_f32 v230, v224, v225
 v_accvgpr_write_b32 a47, v230
 v_mfma_f32_16x16x32_bf16 v[144:147], a[144:147], v[0:3], 0
 s_cmp_eq_u32 s15, 3
 s_cbranch_scc1 L_hsl4
L_hsl4_ok:
 s_cmp_eq_u32 s15, 1
 s_cbranch_scc1 L_hsc4
L_hsc4_ok:
 ds_read_b64_tr_b16 a[160:161], v236 offset:4096
 ds_read_b64_tr_b16 a[162:163], v236 offset:4352
 v_mfma_f32_16x16x32_bf16 v[148:151], a[144:147], v[4:7], 0
 s_waitcnt lgkmcnt(6)
 v_mfma_f32_16x16x32_bf16 v[156:159], a[148:151], v[4:7], 0
 s_add_u32 m0, s64, 102400
 ds_read_b64_tr_b16 a[164:165], v237 offset:4096
 ds_read_b64_tr_b16 a[166:167], v237 offset:4352
 v_mfma_f32_16x16x32_bf16 v[152:155], a[148:151], v[0:3], 0
 s_waitcnt lgkmcnt(6)
 v_exp_f32 v224, v176
 v_exp_f32 v225, v177
 v_mfma_f32_16x16x32_bf16 v[160:163], a[152:155], v[0:3], 0
 s_mov_b32 s65, 2065024
 ds_read_b64_tr_b16 a[168:169], v236 offset:4608
 ds_read_b64_tr_b16 a[170:171], v236 offset:4864
 buffer_load_dwordx4 v248, s[32:35], s65 offen lds
 v_mfma_f32_16x16x32_bf16 v[164:167], a[152:155], v[4:7], 0
 s_waitcnt lgkmcnt(6)
 v_fma_f32 v224, v224, s75, s75
 v_fma_f32 v225, v225, s75, s75
 v_rcp_f32 v224, v224
 v_mfma_f32_16x16x32_bf16 v[172:175], a[156:159], v[4:7], 0
 ds_read_b64_tr_b16 a[172:173], v237 offset:4608
 ds_read_b64_tr_b16 a[174:175], v237 offset:4864
 v_mfma_f32_16x16x32_bf16 v[168:171], a[156:159], v[0:3], 0
 s_waitcnt lgkmcnt(6)
 v_rcp_f32 v225, v225
 v_mfma_f32_16x16x32_bf16 v[144:147], a[160:163], v[8:11], v[144:147]
 ds_read_b64_tr_b16 a[144:145], v236 offset:8192
 ds_read_b64_tr_b16 a[146:147], v236 offset:8448
 v_mfma_f32_16x16x32_bf16 v[148:151], a[160:163], v[12:15], v[148:151]
 s_waitcnt lgkmcnt(6)
 v_mul_f32 v224, v176, v224
 v_mul_f32 v225, v177, v225
 v_cvt_pk_bf16_f32 v230, v224, v225
 v_mfma_f32_16x16x32_bf16 v[156:159], a[164:167], v[12:15], v[156:159]
 s_add_u32 m0, s64, 106496
 ds_read_b64_tr_b16 a[148:149], v237 offset:8192
 ds_read_b64_tr_b16 a[150:151], v237 offset:8448
 v_mfma_f32_16x16x32_bf16 v[152:155], a[164:167], v[8:11], v[152:155]
 s_waitcnt lgkmcnt(6)
 v_accvgpr_write_b32 a48, v230
 v_exp_f32 v226, v178
 v_mfma_f32_16x16x32_bf16 v[160:163], a[168:171], v[8:11], v[160:163]
 s_mov_b32 s65, 2359936
 ds_read_b64_tr_b16 a[152:153], v236 offset:8704
 ds_read_b64_tr_b16 a[154:155], v236 offset:8960
 buffer_load_dwordx4 v248, s[32:35], s65 offen lds
 v_mfma_f32_16x16x32_bf16 v[164:167], a[168:171], v[12:15], v[164:167]
 s_waitcnt lgkmcnt(6)
 v_exp_f32 v227, v179
 v_fma_f32 v226, v226, s75, s75
 v_mfma_f32_16x16x32_bf16 v[172:175], a[172:175], v[12:15], v[172:175]
 ds_read_b64_tr_b16 a[156:157], v237 offset:8704
 ds_read_b64_tr_b16 a[158:159], v237 offset:8960
 v_mfma_f32_16x16x32_bf16 v[168:171], a[172:175], v[8:11], v[168:171]
 s_waitcnt lgkmcnt(6)
 v_fma_f32 v227, v227, s75, s75
 v_rcp_f32 v226, v226
 v_mfma_f32_16x16x32_bf16 v[144:147], a[144:147], v[16:19], v[144:147]
 ds_read_b64_tr_b16 a[160:161], v236 offset:12288
 ds_read_b64_tr_b16 a[162:163], v236 offset:12544
 v_mfma_f32_16x16x32_bf16 v[148:151], a[144:147], v[20:23], v[148:151]
 s_waitcnt lgkmcnt(6)
 v_rcp_f32 v227, v227
 v_mul_f32 v226, v178, v226
 v_mul_f32 v227, v179, v227
 v_mfma_f32_16x16x32_bf16 v[156:159], a[148:151], v[20:23], v[156:159]
 s_add_u32 m0, s64, 110592
 ds_read_b64_tr_b16 a[164:165], v237 offset:12288
 ds_read_b64_tr_b16 a[166:167], v237 offset:12544
 v_mfma_f32_16x16x32_bf16 v[152:155], a[148:151], v[16:19], v[152:155]
 s_waitcnt lgkmcnt(6)
 v_cvt_pk_bf16_f32 v231, v226, v227
 v_accvgpr_write_b32 a49, v231
 v_exp_f32 v228, v180
 v_mfma_f32_16x16x32_bf16 v[160:163], a[152:155], v[16:19], v[160:163]
 s_mov_b32 s65, 2654848
 ds_read_b64_tr_b16 a[168:169], v236 offset:12800
 ds_read_b64_tr_b16 a[170:171], v236 offset:13056
 buffer_load_dwordx4 v248, s[32:35], s65 offen lds
 v_mfma_f32_16x16x32_bf16 v[164:167], a[152:155], v[20:23], v[164:167]
 s_waitcnt lgkmcnt(6)
 v_exp_f32 v229, v181
 v_mfma_f32_16x16x32_bf16 v[172:175], a[156:159], v[20:23], v[172:175]
 ds_read_b64_tr_b16 a[172:173], v237 offset:12800
 ds_read_b64_tr_b16 a[174:175], v237 offset:13056
 v_mfma_f32_16x16x32_bf16 v[168:171], a[156:159], v[16:19], v[168:171]
 s_waitcnt lgkmcnt(6)
 v_fma_f32 v228, v228, s75, s75
 v_fma_f32 v229, v229, s75, s75
 v_rcp_f32 v228, v228
 v_mfma_f32_16x16x32_bf16 v[144:147], a[160:163], v[24:27], v[144:147]
 ds_read_b64_tr_b16 a[144:145], v236 offset:16384
 ds_read_b64_tr_b16 a[146:147], v236 offset:16640
 v_mfma_f32_16x16x32_bf16 v[148:151], a[160:163], v[28:31], v[148:151]
 s_waitcnt lgkmcnt(6)
 v_rcp_f32 v229, v229
 v_mfma_f32_16x16x32_bf16 v[156:159], a[164:167], v[28:31], v[156:159]
 s_add_u32 m0, s64, 114688
 ds_read_b64_tr_b16 a[148:149], v237 offset:16384
 ds_read_b64_tr_b16 a[150:151], v237 offset:16640
 v_mfma_f32_16x16x32_bf16 v[152:155], a[164:167], v[24:27], v[152:155]
 s_waitcnt lgkmcnt(6)
 v_mul_f32 v228, v180, v228
 v_mul_f32 v229, v181, v229
 v_cvt_pk_bf16_f32 v232, v228, v229
 v_accvgpr_write_b32 a52, v232
 v_mfma_f32_16x16x32_bf16 v[160:163], a[168:171], v[24:27], v[160:163]
 s_mov_b32 s65, 2949760
 ds_read_b64_tr_b16 a[152:153], v236 offset:16896
 ds_read_b64_tr_b16 a[154:155], v236 offset:17152
 buffer_load_dwordx4 v248, s[32:35], s65 offen lds
 v_mfma_f32_16x16x32_bf16 v[164:167], a[168:171], v[28:31], v[164:167]
 s_waitcnt lgkmcnt(6)
 v_exp_f32 v224, v182
 v_exp_f32 v225, v183
 v_mfma_f32_16x16x32_bf16 v[172:175], a[172:175], v[28:31], v[172:175]
 ds_read_b64_tr_b16 a[156:157], v237 offset:16896
 ds_read_b64_tr_b16 a[158:159], v237 offset:17152
 v_mfma_f32_16x16x32_bf16 v[168:171], a[172:175], v[24:27], v[168:171]
 s_waitcnt lgkmcnt(6)
 v_fma_f32 v224, v224, s75, s75
 v_fma_f32 v225, v225, s75, s75
 v_mfma_f32_16x16x32_bf16 v[144:147], a[144:147], v[32:35], v[144:147]
 ds_read_b64_tr_b16 a[160:161], v236 offset:20480
 ds_read_b64_tr_b16 a[162:163], v236 offset:20736
 v_mfma_f32_16x16x32_bf16 v[148:151], a[144:147], v[36:39], v[148:151]
 s_waitcnt lgkmcnt(6)
 v_rcp_f32 v224, v224
 v_rcp_f32 v225, v225
 v_mfma_f32_16x16x32_bf16 v[156:159], a[148:151], v[36:39], v[156:159]
 s_add_u32 m0, s64, 118784
 ds_read_b64_tr_b16 a[164:165], v237 offset:20480
 ds_read_b64_tr_b16 a[166:167], v237 offset:20736
 v_mfma_f32_16x16x32_bf16 v[152:155], a[148:151], v[32:35], v[152:155]
 s_waitcnt lgkmcnt(6)
 v_mul_f32 v224, v182, v224
 v_mul_f32 v225, v183, v225
 v_mfma_f32_16x16x32_bf16 v[160:163], a[152:155], v[32:35], v[160:163]
 s_mov_b32 s65, 3244672
 ds_read_b64_tr_b16 a[168:169], v236 offset:20992
 ds_read_b64_tr_b16 a[170:171], v236 offset:21248
 buffer_load_dwordx4 v248, s[32:35], s65 offen lds
 v_mfma_f32_16x16x32_bf16 v[164:167], a[152:155], v[36:39], v[164:167]
 s_waitcnt lgkmcnt(6)
 v_cvt_pk_bf16_f32 v230, v224, v225
 v_accvgpr_write_b32 a53, v230
 v_exp_f32 v226, v184
 v_mfma_f32_16x16x32_bf16 v[172:175], a[156:159], v[36:39], v[172:175]
 ds_read_b64_tr_b16 a[172:173], v237 offset:20992
 ds_read_b64_tr_b16 a[174:175], v237 offset:21248
 v_mfma_f32_16x16x32_bf16 v[168:171], a[156:159], v[32:35], v[168:171]
 s_waitcnt lgkmcnt(6)
 v_exp_f32 v227, v185
 v_mfma_f32_16x16x32_bf16 v[144:147], a[160:163], v[40:43], v[144:147]
 s_waitcnt vmcnt(18)
 s_barrier
 ds_read_b64_tr_b16 a[144:145], v236 offset:24576
 ds_read_b64_tr_b16 a[146:147], v236 offset:24832
 v_mfma_f32_16x16x32_bf16 v[148:151], a[160:163], v[44:47], v[148:151]
 s_waitcnt lgkmcnt(6)
 v_fma_f32 v226, v226, s75, s75
 v_fma_f32 v227, v227, s75, s75
 v_rcp_f32 v226, v226
 v_mfma_f32_16x16x32_bf16 v[156:159], a[164:167], v[44:47], v[156:159]
 s_add_u32 m0, s64, 122880
 ds_read_b64_tr_b16 a[148:149], v237 offset:24576
 ds_read_b64_tr_b16 a[150:151], v237 offset:24832
 v_mfma_f32_16x16x32_bf16 v[152:155], a[164:167], v[40:43], v[152:155]
 s_waitcnt lgkmcnt(6)
 v_rcp_f32 v227, v227
 v_mul_f32 v226, v184, v226
 v_mfma_f32_16x16x32_bf16 v[160:163], a[168:171], v[40:43], v[160:163]
 s_mov_b32 s65, 3539584
 ds_read_b64_tr_b16 a[152:153], v236 offset:25088
 ds_read_b64_tr_b16 a[154:155], v236 offset:25344
 buffer_load_dwordx4 v248, s[32:35], s65 offen lds
 v_mfma_f32_16x16x32_bf16 v[164:167], a[168:171], v[44:47], v[164:167]
 s_waitcnt lgkmcnt(6)
 v_mul_f32 v227, v185, v227
 v_cvt_pk_bf16_f32 v231, v226, v227
 v_accvgpr_write_b32 a50, v231
 v_mfma_f32_16x16x32_bf16 v[172:175], a[172:175], v[44:47], v[172:175]
 ds_read_b64_tr_b16 a[156:157], v237 offset:25088
 ds_read_b64_tr_b16 a[158:159], v237 offset:25344
 v_mfma_f32_16x16x32_bf16 v[168:171], a[172:175], v[40:43], v[168:171]
 s_waitcnt lgkmcnt(6)
 v_exp_f32 v228, v186
 v_exp_f32 v229, v187
 v_mfma_f32_16x16x32_bf16 v[144:147], a[144:147], v[48:51], v[144:147]
 ds_read_b64_tr_b16 a[160:161], v236 offset:28672
 ds_read_b64_tr_b16 a[162:163], v236 offset:28928
 v_mfma_f32_16x16x32_bf16 v[148:151], a[144:147], v[52:55], v[148:151]
 s_waitcnt lgkmcnt(6)
 v_fma_f32 v228, v228, s75, s75
 v_fma_f32 v229, v229, s75, s75
 v_mfma_f32_16x16x32_bf16 v[156:159], a[148:151], v[52:55], v[156:159]
 s_add_u32 m0, s64, 126976
 ds_read_b64_tr_b16 a[164:165], v237 offset:28672
 ds_read_b64_tr_b16 a[166:167], v237 offset:28928
 v_mfma_f32_16x16x32_bf16 v[152:155], a[148:151], v[48:51], v[152:155]
 s_waitcnt lgkmcnt(6)
 v_rcp_f32 v228, v228
 v_rcp_f32 v229, v229
 v_mfma_f32_16x16x32_bf16 v[160:163], a[152:155], v[48:51], v[160:163]
 s_mov_b32 s65, 3834496
 ds_read_b64_tr_b16 a[168:169], v236 offset:29184
 ds_read_b64_tr_b16 a[170:171], v236 offset:29440
 buffer_load_dwordx4 v248, s[32:35], s65 offen lds
 v_mfma_f32_16x16x32_bf16 v[164:167], a[152:155], v[52:55], v[164:167]
 s_waitcnt lgkmcnt(6)
 v_mul_f32 v228, v186, v228
 v_mul_f32 v229, v187, v229
 v_cvt_pk_bf16_f32 v232, v228, v229
 v_mfma_f32_16x16x32_bf16 v[172:175], a[156:159], v[52:55], v[172:175]
 ds_read_b64_tr_b16 a[172:173], v237 offset:29184
 ds_read_b64_tr_b16 a[174:175], v237 offset:29440
 v_mfma_f32_16x16x32_bf16 v[168:171], a[156:159], v[48:51], v[168:171]
 s_waitcnt lgkmcnt(6)
 v_accvgpr_write_b32 a51, v232
 v_exp_f32 v224, v188
 v_mfma_f32_16x16x32_bf16 v[144:147], a[160:163], v[56:59], v[144:147]
 ds_read_b64_tr_b16 a[144:145], v236 offset:32768
 ds_read_b64_tr_b16 a[146:147], v236 offset:33024
 v_mfma_f32_16x16x32_bf16 v[148:151], a[160:163], v[60:63], v[148:151]
 s_waitcnt lgkmcnt(6)
 v_exp_f32 v225, v189
 v_fma_f32 v224, v224, s75, s75
 v_mfma_f32_16x16x32_bf16 v[156:159], a[164:167], v[60:63], v[156:159]
 s_add_u32 m0, s64, 131072
 ds_read_b64_tr_b16 a[148:149], v237 offset:32768
 ds_read_b64_tr_b16 a[150:151], v237 offset:33024
 v_mfma_f32_16x16x32_bf16 v[152:155], a[164:167], v[56:59], v[152:155]
 s_waitcnt lgkmcnt(6)
 v_fma_f32 v225, v225, s75, s75
 v_rcp_f32 v224, v224
 v_mfma_f32_16x16x32_bf16 v[160:163], a[168:171], v[56:59], v[160:163]
 s_mov_b32 s65, 4129408
 ds_read_b64_tr_b16 a[152:153], v236 offset:33280
 ds_read_b64_tr_b16 a[154:155], v236 offset:33536
 buffer_load_dwordx4 v248, s[32:35], s65 offen lds
 v_mfma_f32_16x16x32_bf16 v[164:167], a[168:171], v[60:63], v[164:167]
 s_waitcnt lgkmcnt(6)
 v_rcp_f32 v225, v225
 v_mul_f32 v224, v188, v224
 v_mfma_f32_16x16x32_bf16 v[172:175], a[172:175], v[60:63], v[172:175]
 ds_read_b64_tr_b16 a[156:157], v237 offset:33280
 ds_read_b64_tr_b16 a[158:159], v237 offset:33536
 v_mfma_f32_16x16x32_bf16 v[168:171], a[172:175], v[56:59], v[168:171]
 s_waitcnt lgkmcnt(6)
 v_mul_f32 v225, v189, v225
 v_cvt_pk_bf16_f32 v230, v224, v225
 v_accvgpr_write_b32 a54, v230
 v_mfma_f32_16x16x32_bf16 v[144:147], a[144:147], v[64:67], v[144:147]
 ds_read_b64_tr_b16 a[160:161], v236 offset:36864
 ds_read_b64_tr_b16 a[162:163], v236 offset:37120
 v_mfma_f32_16x16x32_bf16 v[148:151], a[144:147], v[68:71], v[148:151]
 s_waitcnt lgkmcnt(6)
 v_exp_f32 v226, v190
 v_exp_f32 v227, v191
 v_mfma_f32_16x16x32_bf16 v[156:159], a[148:151], v[68:71], v[156:159]
 s_add_u32 m0, s64, 135168
 ds_read_b64_tr_b16 a[164:165], v237 offset:36864
 ds_read_b64_tr_b16 a[166:167], v237 offset:37120
 v_mfma_f32_16x16x32_bf16 v[152:155], a[148:151], v[64:67], v[152:155]
 s_waitcnt lgkmcnt(6)
 v_fma_f32 v226, v226, s75, s75
 v_fma_f32 v227, v227, s75, s75
 v_rcp_f32 v226, v226
 v_mfma_f32_16x16x32_bf16 v[160:163], a[152:155], v[64:67], v[160:163]
 s_mov_b32 s65, 4424320
 ds_read_b64_tr_b16 a[168:169], v236 offset:37376
 ds_read_b64_tr_b16 a[170:171], v236 offset:37632
 buffer_load_dwordx4 v248, s[32:35], s65 offen lds
 v_mfma_f32_16x16x32_bf16 v[164:167], a[152:155], v[68:71], v[164:167]
 s_waitcnt lgkmcnt(6)
 v_rcp_f32 v227, v227
 v_mfma_f32_16x16x32_bf16 v[172:175], a[156:159], v[68:71], v[172:175]
 ds_read_b64_tr_b16 a[172:173], v237 offset:37376
 ds_read_b64_tr_b16 a[174:175], v237 offset:37632
 v_mfma_f32_16x16x32_bf16 v[168:171], a[156:159], v[64:67], v[168:171]
 s_waitcnt lgkmcnt(6)
 v_mul_f32 v226, v190, v226
 v_mul_f32 v227, v191, v227
 v_cvt_pk_bf16_f32 v231, v226, v227
 v_mfma_f32_16x16x32_bf16 v[144:147], a[160:163], v[72:75], v[144:147]
 ds_read_b64_tr_b16 a[144:145], v236 offset:40960
 ds_read_b64_tr_b16 a[146:147], v236 offset:41216
 v_mfma_f32_16x16x32_bf16 v[148:151], a[160:163], v[76:79], v[148:151]
 s_waitcnt lgkmcnt(6)
 v_accvgpr_write_b32 a55, v231
 v_exp_f32 v228, v192
 v_mfma_f32_16x16x32_bf16 v[156:159], a[164:167], v[76:79], v[156:159]
 s_add_u32 m0, s64, 139264
 ds_read_b64_tr_b16 a[148:149], v237 offset:40960
 ds_read_b64_tr_b16 a[150:151], v237 offset:41216
 v_mfma_f32_16x16x32_bf16 v[152:155], a[164:167], v[72:75], v[152:155]
 s_waitcnt lgkmcnt(6)
 v_exp_f32 v229, v193
 v_fma_f32 v228, v228, s75, s75
 v_mfma_f32_16x16x32_bf16 v[160:163], a[168:171], v[72:75], v[160:163]
 s_mov_b32 s65, 4719232
 ds_read_b64_tr_b16 a[152:153], v236 offset:41472
 ds_read_b64_tr_b16 a[154:155], v236 offset:41728
 buffer_load_dwordx4 v248, s[32:35], s65 offen lds
 v_mfma_f32_16x16x32_bf16 v[164:167], a[168:171], v[76:79], v[164:167]
 s_waitcnt lgkmcnt(6)
 v_fma_f32 v229, v229, s75, s75
 v_rcp_f32 v228, v228
 v_mfma_f32_16x16x32_bf16 v[172:175], a[172:175], v[76:79], v[172:175]
 ds_read_b64_tr_b16 a[156:157], v237 offset:41472
 ds_read_b64_tr_b16 a[158:159], v237 offset:41728
 v_mfma_f32_16x16x32_bf16 v[168:171], a[172:175], v[72:75], v[168:171]
 s_waitcnt lgkmcnt(6)
 v_rcp_f32 v229, v229
 v_mul_f32 v228, v192, v228
 v_mul_f32 v229, v193, v229
 v_mfma_f32_16x16x32_bf16 v[144:147], a[144:147], v[80:83], v[144:147]
 ds_read_b64_tr_b16 a[160:161], v236 offset:45056
 ds_read_b64_tr_b16 a[162:163], v236 offset:45312
 v_mfma_f32_16x16x32_bf16 v[148:151], a[144:147], v[84:87], v[148:151]
 s_waitcnt lgkmcnt(6)
 v_cvt_pk_bf16_f32 v232, v228, v229
 v_accvgpr_write_b32 a56, v232
 v_exp_f32 v224, v194
 v_mfma_f32_16x16x32_bf16 v[156:159], a[148:151], v[84:87], v[156:159]
 s_add_u32 m0, s64, 143360
 ds_read_b64_tr_b16 a[164:165], v237 offset:45056
 ds_read_b64_tr_b16 a[166:167], v237 offset:45312
 v_mfma_f32_16x16x32_bf16 v[152:155], a[148:151], v[80:83], v[152:155]
 s_waitcnt lgkmcnt(6)
 v_exp_f32 v225, v195
 v_mfma_f32_16x16x32_bf16 v[160:163], a[152:155], v[80:83], v[160:163]
 s_mov_b32 s65, 5014144
 ds_read_b64_tr_b16 a[168:169], v236 offset:45568
 ds_read_b64_tr_b16 a[170:171], v236 offset:45824
 buffer_load_dwordx4 v248, s[32:35], s65 offen lds
 v_mfma_f32_16x16x32_bf16 v[164:167], a[152:155], v[84:87], v[164:167]
 s_waitcnt lgkmcnt(6)
 v_fma_f32 v224, v224, s75, s75
 v_fma_f32 v225, v225, s75, s75
 v_rcp_f32 v224, v224
 v_mfma_f32_16x16x32_bf16 v[172:175], a[156:159], v[84:87], v[172:175]
 ds_read_b64_tr_b16 a[172:173], v237 offset:45568
 ds_read_b64_tr_b16 a[174:175], v237 offset:45824
 v_mfma_f32_16x16x32_bf16 v[168:171], a[156:159], v[80:83], v[168:171]
 s_waitcnt lgkmcnt(6)
 v_rcp_f32 v225, v225
 v_mfma_f32_16x16x32_bf16 v[144:147], a[160:163], v[88:91], v[144:147]
 s_waitcnt vmcnt(18)
 s_barrier
 ds_read_b64_tr_b16 a[144:145], v238 offset:0
 ds_read_b64_tr_b16 a[146:147], v238 offset:256
 v_mfma_f32_16x16x32_bf16 v[148:151], a[160:163], v[92:95], v[148:151]
 s_waitcnt lgkmcnt(6)
 v_mul_f32 v224, v194, v224
 v_mul_f32 v225, v195, v225
 v_cvt_pk_bf16_f32 v230, v224, v225
 v_mfma_f32_16x16x32_bf16 v[156:159], a[164:167], v[92:95], v[156:159]
 s_add_u32 m0, s64, 0
 ds_read_b64_tr_b16 a[148:149], v239 offset:0
 ds_read_b64_tr_b16 a[150:151], v239 offset:256
 v_mfma_f32_16x16x32_bf16 v[152:155], a[164:167], v[88:91], v[152:155]
 s_waitcnt lgkmcnt(6)
 v_accvgpr_write_b32 a57, v230
 v_exp_f32 v226, v196
 v_mfma_f32_16x16x32_bf16 v[160:163], a[168:171], v[88:91], v[160:163]
 s_mov_b32 s65, 768
 ds_read_b64_tr_b16 a[152:153], v238 offset:512
 ds_read_b64_tr_b16 a[154:155], v238 offset:768
 buffer_load_dwordx4 v248, s[32:35], s65 offen lds
 v_mfma_f32_16x16x32_bf16 v[164:167], a[168:171], v[92:95], v[164:167]
 s_waitcnt lgkmcnt(6)
 v_exp_f32 v227, v197
 v_fma_f32 v226, v226, s75, s75
 v_fma_f32 v227, v227, s75, s75
 v_mfma_f32_16x16x32_bf16 v[172:175], a[172:175], v[92:95], v[172:175]
 ds_read_b64_tr_b16 a[156:157], v239 offset:512
 ds_read_b64_tr_b16 a[158:159], v239 offset:768
 v_mfma_f32_16x16x32_bf16 v[168:171], a[172:175], v[88:91], v[168:171]
 s_waitcnt lgkmcnt(6)
 v_rcp_f32 v226, v226
 v_rcp_f32 v227, v227
 v_mfma_f32_16x16x32_bf16 v[144:147], a[144:147], v[96:99], v[144:147]
 ds_read_b64_tr_b16 a[160:161], v238 offset:4096
 ds_read_b64_tr_b16 a[162:163], v238 offset:4352
 v_mfma_f32_16x16x32_bf16 v[148:151], a[144:147], v[100:103], v[148:151]
 s_waitcnt lgkmcnt(6)
 v_mul_f32 v226, v196, v226
 v_mul_f32 v227, v197, v227
 v_mfma_f32_16x16x32_bf16 v[156:159], a[148:151], v[100:103], v[156:159]
 s_add_u32 m0, s64, 4096
 ds_read_b64_tr_b16 a[164:165], v239 offset:4096
 ds_read_b64_tr_b16 a[166:167], v239 offset:4352
 v_mfma_f32_16x16x32_bf16 v[152:155], a[148:151], v[96:99], v[152:155]
 s_waitcnt lgkmcnt(6)
 v_cvt_pk_bf16_f32 v231, v226, v227
 v_accvgpr_write_b32 a60, v231
 v_exp_f32 v228, v198
 v_mfma_f32_16x16x32_bf16 v[160:163], a[152:155], v[96:99], v[160:163]
 s_mov_b32 s65, 295680
 ds_read_b64_tr_b16 a[168:169], v238 offset:4608
 ds_read_b64_tr_b16 a[170:171], v238 offset:4864
 buffer_load_dwordx4 v248, s[32:35], s65 offen lds
 v_mfma_f32_16x16x32_bf16 v[164:167], a[152:155], v[100:103], v[164:167]
 s_waitcnt lgkmcnt(6)
 v_exp_f32 v229, v199
 v_mfma_f32_16x16x32_bf16 v[172:175], a[156:159], v[100:103], v[172:175]
 ds_read_b64_tr_b16 a[172:173], v239 offset:4608
 ds_read_b64_tr_b16 a[174:175], v239 offset:4864
 v_mfma_f32_16x16x32_bf16 v[168:171], a[156:159], v[96:99], v[168:171]
 s_waitcnt lgkmcnt(6)
 v_fma_f32 v228, v228, s75, s75
 v_fma_f32 v229, v229, s75, s75
 v_rcp_f32 v228, v228
 v_mfma_f32_16x16x32_bf16 v[144:147], a[160:163], v[104:107], v[144:147]
 ds_read_b64_tr_b16 a[144:145], v238 offset:8192
 ds_read_b64_tr_b16 a[146:147], v238 offset:8448
 v_mfma_f32_16x16x32_bf16 v[148:151], a[160:163], v[108:111], v[148:151]
 s_waitcnt lgkmcnt(6)
 v_rcp_f32 v229, v229
 v_mul_f32 v228, v198, v228
 v_mfma_f32_16x16x32_bf16 v[156:159], a[164:167], v[108:111], v[156:159]
 s_add_u32 m0, s64, 8192
 ds_read_b64_tr_b16 a[148:149], v239 offset:8192
 ds_read_b64_tr_b16 a[150:151], v239 offset:8448
 v_mfma_f32_16x16x32_bf16 v[152:155], a[164:167], v[104:107], v[152:155]
 s_waitcnt lgkmcnt(6)
 v_mul_f32 v229, v199, v229
 v_cvt_pk_bf16_f32 v232, v228, v229
 v_accvgpr_write_b32 a61, v232
 v_mfma_f32_16x16x32_bf16 v[160:163], a[168:171], v[104:107], v[160:163]
 s_mov_b32 s65, 590592
 ds_read_b64_tr_b16 a[152:153], v238 offset:8704
 ds_read_b64_tr_b16 a[154:155], v238 offset:8960
 buffer_load_dwordx4 v248, s[32:35], s65 offen lds
 v_mfma_f32_16x16x32_bf16 v[164:167], a[168:171], v[108:111], v[164:167]
 s_waitcnt lgkmcnt(6)
 v_exp_f32 v224, v200
 v_exp_f32 v225, v201
 v_mfma_f32_16x16x32_bf16 v[172:175], a[172:175], v[108:111], v[172:175]
 ds_read_b64_tr_b16 a[156:157], v239 offset:8704
 ds_read_b64_tr_b16 a[158:159], v239 offset:8960
 v_mfma_f32_16x16x32_bf16 v[168:171], a[172:175], v[104:107], v[168:171]
 s_waitcnt lgkmcnt(6)
 v_fma_f32 v224, v224, s75, s75
 v_fma_f32 v225, v225, s75, s75
 v_mfma_f32_16x16x32_bf16 v[144:147], a[144:147], v[112:115], v[144:147]
 ds_read_b64_tr_b16 a[160:161], v238 offset:12288
 ds_read_b64_tr_b16 a[162:163], v238 offset:12544
 v_mfma_f32_16x16x32_bf16 v[148:151], a[144:147], v[116:119], v[148:151]
 s_waitcnt lgkmcnt(6)
 v_rcp_f32 v224, v224
 v_rcp_f32 v225, v225
 v_mfma_f32_16x16x32_bf16 v[156:159], a[148:151], v[116:119], v[156:159]
 s_add_u32 m0, s64, 12288
 ds_read_b64_tr_b16 a[164:165], v239 offset:12288
 ds_read_b64_tr_b16 a[166:167], v239 offset:12544
 v_mfma_f32_16x16x32_bf16 v[152:155], a[148:151], v[112:115], v[152:155]
 s_waitcnt lgkmcnt(6)
 v_mul_f32 v224, v200, v224
 v_mul_f32 v225, v201, v225
 v_mfma_f32_16x16x32_bf16 v[160:163], a[152:155], v[112:115], v[160:163]
 s_mov_b32 s65, 885504
 ds_read_b64_tr_b16 a[168:169], v238 offset:12800
 ds_read_b64_tr_b16 a[170:171], v238 offset:13056
 buffer_load_dwordx4 v248, s[32:35], s65 offen lds
 v_mfma_f32_16x16x32_bf16 v[164:167], a[152:155], v[116:119], v[164:167]
 s_waitcnt lgkmcnt(6)
 v_cvt_pk_bf16_f32 v230, v224, v225
 v_accvgpr_write_b32 a58, v230
 v_exp_f32 v226, v202
 v_mfma_f32_16x16x32_bf16 v[172:175], a[156:159], v[116:119], v[172:175]
 ds_read_b64_tr_b16 a[172:173], v239 offset:12800
 ds_read_b64_tr_b16 a[174:175], v239 offset:13056
 v_mfma_f32_16x16x32_bf16 v[168:171], a[156:159], v[112:115], v[168:171]
 s_waitcnt lgkmcnt(6)
 v_exp_f32 v227, v203
 v_fma_f32 v226, v226, s75, s75
 v_mfma_f32_16x16x32_bf16 v[144:147], a[160:163], v[120:123], v[144:147]
 ds_read_b64_tr_b16 a[144:145], v238 offset:16384
 ds_read_b64_tr_b16 a[146:147], v238 offset:16640
 v_mfma_f32_16x16x32_bf16 v[148:151], a[160:163], v[124:127], v[148:151]
 s_waitcnt lgkmcnt(6)
 v_fma_f32 v227, v227, s75, s75
 v_rcp_f32 v226, v226
 v_mfma_f32_16x16x32_bf16 v[156:159], a[164:167], v[124:127], v[156:159]
 s_add_u32 m0, s64, 16384
 ds_read_b64_tr_b16 a[148:149], v239 offset:16384
 ds_read_b64_tr_b16 a[150:151], v239 offset:16640
 v_mfma_f32_16x16x32_bf16 v[152:155], a[164:167], v[120:123], v[152:155]
 s_waitcnt lgkmcnt(6)
 v_rcp_f32 v227, v227
 v_mul_f32 v226, v202, v226
 v_mfma_f32_16x16x32_bf16 v[160:163], a[168:171], v[120:123], v[160:163]
 s_mov_b32 s65, 1180416
 ds_read_b64_tr_b16 a[152:153], v238 offset:16896
 ds_read_b64_tr_b16 a[154:155], v238 offset:17152
 buffer_load_dwordx4 v248, s[32:35], s65 offen lds
 v_mfma_f32_16x16x32_bf16 v[164:167], a[168:171], v[124:127], v[164:167]
 s_waitcnt lgkmcnt(6)
 v_mul_f32 v227, v203, v227
 v_cvt_pk_bf16_f32 v231, v226, v227
 v_accvgpr_write_b32 a59, v231
 v_mfma_f32_16x16x32_bf16 v[172:175], a[172:175], v[124:127], v[172:175]
 ds_read_b64_tr_b16 a[156:157], v239 offset:16896
 ds_read_b64_tr_b16 a[158:159], v239 offset:17152
 v_mfma_f32_16x16x32_bf16 v[168:171], a[172:175], v[120:123], v[168:171]
 s_waitcnt lgkmcnt(6)
 v_exp_f32 v228, v204
 v_exp_f32 v229, v205
 v_mfma_f32_16x16x32_bf16 v[144:147], a[144:147], v[128:131], v[144:147]
 ds_read_b64_tr_b16 a[160:161], v238 offset:20480
 ds_read_b64_tr_b16 a[162:163], v238 offset:20736
 v_mfma_f32_16x16x32_bf16 v[148:151], a[144:147], v[132:135], v[148:151]
 s_waitcnt lgkmcnt(6)
 v_fma_f32 v228, v228, s75, s75
 v_fma_f32 v229, v229, s75, s75
 v_mfma_f32_16x16x32_bf16 v[156:159], a[148:151], v[132:135], v[156:159]
 s_add_u32 m0, s64, 20480
 ds_read_b64_tr_b16 a[164:165], v239 offset:20480
 ds_read_b64_tr_b16 a[166:167], v239 offset:20736
 v_mfma_f32_16x16x32_bf16 v[152:155], a[148:151], v[128:131], v[152:155]
 s_waitcnt lgkmcnt(6)
 v_rcp_f32 v228, v228
 v_rcp_f32 v229, v229
 v_mfma_f32_16x16x32_bf16 v[160:163], a[152:155], v[128:131], v[160:163]
 s_mov_b32 s65, 1475328
 ds_read_b64_tr_b16 a[168:169], v238 offset:20992
 ds_read_b64_tr_b16 a[170:171], v238 offset:21248
 buffer_load_dwordx4 v248, s[32:35], s65 offen lds
 v_mfma_f32_16x16x32_bf16 v[164:167], a[152:155], v[132:135], v[164:167]
 s_waitcnt lgkmcnt(6)
 v_mul_f32 v228, v204, v228
 v_mul_f32 v229, v205, v229
 v_cvt_pk_bf16_f32 v232, v228, v229
 v_mfma_f32_16x16x32_bf16 v[172:175], a[156:159], v[132:135], v[172:175]
 ds_read_b64_tr_b16 a[172:173], v239 offset:20992
 ds_read_b64_tr_b16 a[174:175], v239 offset:21248
 v_mfma_f32_16x16x32_bf16 v[168:171], a[156:159], v[128:131], v[168:171]
 s_waitcnt lgkmcnt(6)
 v_accvgpr_write_b32 a62, v232
 v_exp_f32 v224, v206
 v_mfma_f32_16x16x32_bf16 v[144:147], a[160:163], v[136:139], v[144:147]
 s_waitcnt vmcnt(18)
 s_barrier
 ds_read_b64_tr_b16 a[144:145], v238 offset:24576
 ds_read_b64_tr_b16 a[146:147], v238 offset:24832
 v_mfma_f32_16x16x32_bf16 v[148:151], a[160:163], v[140:143], v[148:151]
 s_waitcnt lgkmcnt(6)
 v_exp_f32 v225, v207
 v_fma_f32 v224, v224, s75, s75
 v_mfma_f32_16x16x32_bf16 v[156:159], a[164:167], v[140:143], v[156:159]
 s_add_u32 m0, s64, 24576
 ds_read_b64_tr_b16 a[148:149], v239 offset:24576
 ds_read_b64_tr_b16 a[150:151], v239 offset:24832
 v_mfma_f32_16x16x32_bf16 v[152:155], a[164:167], v[136:139], v[152:155]
 s_waitcnt lgkmcnt(6)
 v_fma_f32 v225, v225, s75, s75
 v_rcp_f32 v224, v224
 v_mfma_f32_16x16x32_bf16 v[160:163], a[168:171], v[136:139], v[160:163]
 s_mov_b32 s65, 1770240
 ds_read_b64_tr_b16 a[152:153], v238 offset:25088
 ds_read_b64_tr_b16 a[154:155], v238 offset:25344
 buffer_load_dwordx4 v248, s[32:35], s65 offen lds
 v_mfma_f32_16x16x32_bf16 v[164:167], a[168:171], v[140:143], v[164:167]
 s_waitcnt lgkmcnt(6)
 v_rcp_f32 v225, v225
 v_mul_f32 v224, v206, v224
 v_mfma_f32_16x16x32_bf16 v[172:175], a[172:175], v[140:143], v[172:175]
 ds_read_b64_tr_b16 a[156:157], v239 offset:25088
 ds_read_b64_tr_b16 a[158:159], v239 offset:25344
 v_mfma_f32_16x16x32_bf16 v[168:171], a[172:175], v[136:139], v[168:171]
 s_waitcnt lgkmcnt(6)
 v_mul_f32 v225, v207, v225
 v_cvt_pk_bf16_f32 v230, v224, v225
 v_accvgpr_write_b32 a63, v230
 v_mfma_f32_16x16x32_bf16 v[176:179], a[144:147], v[0:3], 0
 s_cmp_eq_u32 s15, 4
 s_cbranch_scc1 L_hsl5
L_hsl5_ok:
 s_cmp_eq_u32 s15, 2
 s_cbranch_scc1 L_hsc5
L_hsc5_ok:
 ds_read_b64_tr_b16 a[160:161], v238 offset:28672
 ds_read_b64_tr_b16 a[162:163], v238 offset:28928
 v_mfma_f32_16x16x32_bf16 v[180:183], a[144:147], v[4:7], 0
 s_waitcnt lgkmcnt(6)
 v_mfma_f32_16x16x32_bf16 v[188:191], a[148:151], v[4:7], 0
 s_add_u32 m0, s64, 28672
 ds_read_b64_tr_b16 a[164:165], v239 offset:28672
 ds_read_b64_tr_b16 a[166:167], v239 offset:28928
 v_mfma_f32_16x16x32_bf16 v[184:187], a[148:151], v[0:3], 0
 s_waitcnt lgkmcnt(6)
 v_exp_f32 v224, v144
 v_exp_f32 v225, v145
 v_mfma_f32_16x16x32_bf16 v[192:195], a[152:155], v[0:3], 0
 s_mov_b32 s65, 2065152
 ds_read_b64_tr_b16 a[168:169], v238 offset:29184
 ds_read_b64_tr_b16 a[170:171], v238 offset:29440
 buffer_load_dwordx4 v248, s[32:35], s65 offen lds
 v_mfma_f32_16x16x32_bf16 v[196:199], a[152:155], v[4:7], 0
 s_waitcnt lgkmcnt(6)
 v_fma_f32 v224, v224, s75, s75
 v_fma_f32 v225, v225, s75, s75
 v_rcp_f32 v224, v224
 v_mfma_f32_16x16x32_bf16 v[204:207], a[156:159], v[4:7], 0
 ds_read_b64_tr_b16 a[172:173], v239 offset:29184
 ds_read_b64_tr_b16 a[174:175], v239 offset:29440
 v_mfma_f32_16x16x32_bf16 v[200:203], a[156:159], v[0:3], 0
 s_waitcnt lgkmcnt(6)
 v_rcp_f32 v225, v225
 v_mfma_f32_16x16x32_bf16 v[176:179], a[160:163], v[8:11], v[176:179]
 ds_read_b64_tr_b16 a[144:145], v238 offset:32768
 ds_read_b64_tr_b16 a[146:147], v238 offset:33024
 v_mfma_f32_16x16x32_bf16 v[180:183], a[160:163], v[12:15], v[180:183]
 s_waitcnt lgkmcnt(6)
 v_mul_f32 v224, v144, v224
 v_mul_f32 v225, v145, v225
 v_cvt_pk_bf16_f32 v230, v224, v225
 v_mfma_f32_16x16x32_bf16 v[188:191], a[164:167], v[12:15], v[188:191]
 s_add_u32 m0, s64, 32768
 ds_read_b64_tr_b16 a[148:149], v239 offset:32768
 ds_read_b64_tr_b16 a[150:151], v239 offset:33024
 v_mfma_f32_16x16x32_bf16 v[184:187], a[164:167], v[8:11], v[184:187]
 s_waitcnt lgkmcnt(6)
 v_accvgpr_write_b32 a64, v230
 v_exp_f32 v226, v146
 v_mfma_f32_16x16x32_bf16 v[192:195], a[168:171], v[8:11], v[192:195]
 s_mov_b32 s65, 2360064
 ds_read_b64_tr_b16 a[152:153], v238 offset:33280
 ds_read_b64_tr_b16 a[154:155], v238 offset:33536
 buffer_load_dwordx4 v248, s[32:35], s65 offen lds
 v_mfma_f32_16x16x32_bf16 v[196:199], a[168:171], v[12:15], v[196:199]
 s_waitcnt lgkmcnt(6)
 v_exp_f32 v227, v147
 v_fma_f32 v226, v226, s75, s75
 v_mfma_f32_16x16x32_bf16 v[204:207], a[172:175], v[12:15], v[204:207]
 ds_read_b64_tr_b16 a[156:157], v239 offset:33280
 ds_read_b64_tr_b16 a[158:159], v239 offset:33536
 v_mfma_f32_16x16x32_bf16 v[200:203], a[172:175], v[8:11], v[200:203]
 s_waitcnt lgkmcnt(6)
 v_fma_f32 v227, v227, s75, s75
 v_rcp_f32 v226, v226
 v_mfma_f32_16x16x32_bf16 v[176:179], a[144:147], v[16:19], v[176:179]
 ds_read_b64_tr_b16 a[160:161], v238 offset:36864
 ds_read_b64_tr_b16 a[162:163], v238 offset:37120
 v_mfma_f32_16x16x32_bf16 v[180:183], a[144:147], v[20:23], v[180:183]
 s_waitcnt lgkmcnt(6)
 v_rcp_f32 v227, v227
 v_mul_f32 v226, v146, v226
 v_mul_f32 v227, v147, v227
 v_mfma_f32_16x16x32_bf16 v[188:191], a[148:151], v[20:23], v[188:191]
 s_add_u32 m0, s64, 36864
 ds_read_b64_tr_b16 a[164:165], v239 offset:36864
 ds_read_b64_tr_b16 a[166:167], v239 offset:37120
 v_mfma_f32_16x16x32_bf16 v[184:187], a[148:151], v[16:19], v[184:187]
 s_waitcnt lgkmcnt(6)
 v_cvt_pk_bf16_f32 v231, v226, v227
 v_accvgpr_write_b32 a65, v231
 v_exp_f32 v228, v148
 v_mfma_f32_16x16x32_bf16 v[192:195], a[152:155], v[16:19], v[192:195]
 s_mov_b32 s65, 2654976
 ds_read_b64_tr_b16 a[168:169], v238 offset:37376
 ds_read_b64_tr_b16 a[170:171], v238 offset:37632
 buffer_load_dwordx4 v248, s[32:35], s65 offen lds
 v_mfma_f32_16x16x32_bf16 v[196:199], a[152:155], v[20:23], v[196:199]
 s_waitcnt lgkmcnt(6)
 v_exp_f32 v229, v149
 v_mfma_f32_16x16x32_bf16 v[204:207], a[156:159], v[20:23], v[204:207]
 ds_read_b64_tr_b16 a[172:173], v239 offset:37376
 ds_read_b64_tr_b16 a[174:175], v239 offset:37632
 v_mfma_f32_16x16x32_bf16 v[200:203], a[156:159], v[16:19], v[200:203]
 s_waitcnt lgkmcnt(6)
 v_fma_f32 v228, v228, s75, s75
 v_fma_f32 v229, v229, s75, s75
 v_rcp_f32 v228, v228
 v_mfma_f32_16x16x32_bf16 v[176:179], a[160:163], v[24:27], v[176:179]
 ds_read_b64_tr_b16 a[144:145], v238 offset:40960
 ds_read_b64_tr_b16 a[146:147], v238 offset:41216
 v_mfma_f32_16x16x32_bf16 v[180:183], a[160:163], v[28:31], v[180:183]
 s_waitcnt lgkmcnt(6)
 v_rcp_f32 v229, v229
 v_mfma_f32_16x16x32_bf16 v[188:191], a[164:167], v[28:31], v[188:191]
 s_add_u32 m0, s64, 40960
 ds_read_b64_tr_b16 a[148:149], v239 offset:40960
 ds_read_b64_tr_b16 a[150:151], v239 offset:41216
 v_mfma_f32_16x16x32_bf16 v[184:187], a[164:167], v[24:27], v[184:187]
 s_waitcnt lgkmcnt(6)
 v_mul_f32 v228, v148, v228
 v_mul_f32 v229, v149, v229
 v_cvt_pk_bf16_f32 v232, v228, v229
 v_accvgpr_write_b32 a68, v232
 v_mfma_f32_16x16x32_bf16 v[192:195], a[168:171], v[24:27], v[192:195]
 s_mov_b32 s65, 2949888
 ds_read_b64_tr_b16 a[152:153], v238 offset:41472
 ds_read_b64_tr_b16 a[154:155], v238 offset:41728
 buffer_load_dwordx4 v248, s[32:35], s65 offen lds
 v_mfma_f32_16x16x32_bf16 v[196:199], a[168:171], v[28:31], v[196:199]
 s_waitcnt lgkmcnt(6)
 v_exp_f32 v224, v150
 v_exp_f32 v225, v151
 v_mfma_f32_16x16x32_bf16 v[204:207], a[172:175], v[28:31], v[204:207]
 ds_read_b64_tr_b16 a[156:157], v239 offset:41472
 ds_read_b64_tr_b16 a[158:159], v239 offset:41728
 v_mfma_f32_16x16x32_bf16 v[200:203], a[172:175], v[24:27], v[200:203]
 s_waitcnt lgkmcnt(6)
 v_fma_f32 v224, v224, s75, s75
 v_fma_f32 v225, v225, s75, s75
 v_mfma_f32_16x16x32_bf16 v[176:179], a[144:147], v[32:35], v[176:179]
 ds_read_b64_tr_b16 a[160:161], v238 offset:45056
 ds_read_b64_tr_b16 a[162:163], v238 offset:45312
 v_mfma_f32_16x16x32_bf16 v[180:183], a[144:147], v[36:39], v[180:183]
 s_waitcnt lgkmcnt(6)
 v_rcp_f32 v224, v224
 v_rcp_f32 v225, v225
 v_mfma_f32_16x16x32_bf16 v[188:191], a[148:151], v[36:39], v[188:191]
 s_add_u32 m0, s64, 45056
 ds_read_b64_tr_b16 a[164:165], v239 offset:45056
 ds_read_b64_tr_b16 a[166:167], v239 offset:45312
 v_mfma_f32_16x16x32_bf16 v[184:187], a[148:151], v[32:35], v[184:187]
 s_waitcnt lgkmcnt(6)
 v_mul_f32 v224, v150, v224
 v_mul_f32 v225, v151, v225
 v_mfma_f32_16x16x32_bf16 v[192:195], a[152:155], v[32:35], v[192:195]
 s_mov_b32 s65, 3244800
 ds_read_b64_tr_b16 a[168:169], v238 offset:45568
 ds_read_b64_tr_b16 a[170:171], v238 offset:45824
 buffer_load_dwordx4 v248, s[32:35], s65 offen lds
 v_mfma_f32_16x16x32_bf16 v[196:199], a[152:155], v[36:39], v[196:199]
 s_waitcnt lgkmcnt(6)
 v_cvt_pk_bf16_f32 v230, v224, v225
 v_accvgpr_write_b32 a69, v230
 v_exp_f32 v226, v152
 v_mfma_f32_16x16x32_bf16 v[204:207], a[156:159], v[36:39], v[204:207]
 ds_read_b64_tr_b16 a[172:173], v239 offset:45568
 ds_read_b64_tr_b16 a[174:175], v239 offset:45824
 v_mfma_f32_16x16x32_bf16 v[200:203], a[156:159], v[32:35], v[200:203]
 s_waitcnt lgkmcnt(6)
 v_exp_f32 v227, v153
 v_mfma_f32_16x16x32_bf16 v[176:179], a[160:163], v[40:43], v[176:179]
 s_waitcnt vmcnt(18)
 s_barrier
 ds_read_b64_tr_b16 a[144:145], v240 offset:0
 ds_read_b64_tr_b16 a[146:147], v240 offset:256
 v_mfma_f32_16x16x32_bf16 v[180:183], a[160:163], v[44:47], v[180:183]
 s_waitcnt lgkmcnt(6)
 v_fma_f32 v226, v226, s75, s75
 v_fma_f32 v227, v227, s75, s75
 v_rcp_f32 v226, v226
 v_mfma_f32_16x16x32_bf16 v[188:191], a[164:167], v[44:47], v[188:191]
 s_add_u32 m0, s64, 49152
 ds_read_b64_tr_b16 a[148:149], v241 offset:0
 ds_read_b64_tr_b16 a[150:151], v241 offset:256
 v_mfma_f32_16x16x32_bf16 v[184:187], a[164:167], v[40:43], v[184:187]
 s_waitcnt lgkmcnt(6)
 v_rcp_f32 v227, v227
 v_mul_f32 v226, v152, v226
 v_mfma_f32_16x16x32_bf16 v[192:195], a[168:171], v[40:43], v[192:195]
 s_mov_b32 s65, 3539712
 ds_read_b64_tr_b16 a[152:153], v240 offset:512
 ds_read_b64_tr_b16 a[154:155], v240 offset:768
 buffer_load_dwordx4 v248, s[32:35], s65 offen lds
 v_mfma_f32_16x16x32_bf16 v[196:199], a[168:171], v[44:47], v[196:199]
 s_waitcnt lgkmcnt(6)
 v_mul_f32 v227, v153, v227
 v_cvt_pk_bf16_f32 v231, v226, v227
 v_accvgpr_write_b32 a66, v231
 v_mfma_f32_16x16x32_bf16 v[204:207], a[172:175], v[44:47], v[204:207]
 ds_read_b64_tr_b16 a[156:157], v241 offset:512
 ds_read_b64_tr_b16 a[158:159], v241 offset:768
 v_mfma_f32_16x16x32_bf16 v[200:203], a[172:175], v[40:43], v[200:203]
 s_waitcnt lgkmcnt(6)
 v_exp_f32 v228, v154
 v_exp_f32 v229, v155
 v_mfma_f32_16x16x32_bf16 v[176:179], a[144:147], v[48:51], v[176:179]
 ds_read_b64_tr_b16 a[160:161], v240 offset:4096
 ds_read_b64_tr_b16 a[162:163], v240 offset:4352
 v_mfma_f32_16x16x32_bf16 v[180:183], a[144:147], v[52:55], v[180:183]
 s_waitcnt lgkmcnt(6)
 v_fma_f32 v228, v228, s75, s75
 v_fma_f32 v229, v229, s75, s75
 v_mfma_f32_16x16x32_bf16 v[188:191], a[148:151], v[52:55], v[188:191]
 s_add_u32 m0, s64, 53248
 ds_read_b64_tr_b16 a[164:165], v241 offset:4096
 ds_read_b64_tr_b16 a[166:167], v241 offset:4352
 v_mfma_f32_16x16x32_bf16 v[184:187], a[148:151], v[48:51], v[184:187]
 s_waitcnt lgkmcnt(6)
 v_rcp_f32 v228, v228
 v_rcp_f32 v229, v229
 v_mfma_f32_16x16x32_bf16 v[192:195], a[152:155], v[48:51], v[192:195]
 s_mov_b32 s65, 3834624
 ds_read_b64_tr_b16 a[168:169], v240 offset:4608
 ds_read_b64_tr_b16 a[170:171], v240 offset:4864
 buffer_load_dwordx4 v248, s[32:35], s65 offen lds
 v_mfma_f32_16x16x32_bf16 v[196:199], a[152:155], v[52:55], v[196:199]
 s_waitcnt lgkmcnt(6)
 v_mul_f32 v228, v154, v228
 v_mul_f32 v229, v155, v229
 v_cvt_pk_bf16_f32 v232, v228, v229
 v_mfma_f32_16x16x32_bf16 v[204:207], a[156:159], v[52:55], v[204:207]
 ds_read_b64_tr_b16 a[172:173], v241 offset:4608
 ds_read_b64_tr_b16 a[174:175], v241 offset:4864
 v_mfma_f32_16x16x32_bf16 v[200:203], a[156:159], v[48:51], v[200:203]
 s_waitcnt lgkmcnt(6)
 v_accvgpr_write_b32 a67, v232
 v_exp_f32 v224, v156
 v_mfma_f32_16x16x32_bf16 v[176:179], a[160:163], v[56:59], v[176:179]
 ds_read_b64_tr_b16 a[144:145], v240 offset:8192
 ds_read_b64_tr_b16 a[146:147], v240 offset:8448
 v_mfma_f32_16x16x32_bf16 v[180:183], a[160:163], v[60:63], v[180:183]
 s_waitcnt lgkmcnt(6)
 v_exp_f32 v225, v157
 v_fma_f32 v224, v224, s75, s75
 v_mfma_f32_16x16x32_bf16 v[188:191], a[164:167], v[60:63], v[188:191]
 s_add_u32 m0, s64, 57344
 ds_read_b64_tr_b16 a[148:149], v241 offset:8192
 ds_read_b64_tr_b16 a[150:151], v241 offset:8448
 v_mfma_f32_16x16x32_bf16 v[184:187], a[164:167], v[56:59], v[184:187]
 s_waitcnt lgkmcnt(6)
 v_fma_f32 v225, v225, s75, s75
 v_rcp_f32 v224, v224
 v_mfma_f32_16x16x32_bf16 v[192:195], a[168:171], v[56:59], v[192:195]
 s_mov_b32 s65, 4129536
 ds_read_b64_tr_b16 a[152:153], v240 offset:8704
 ds_read_b64_tr_b16 a[154:155], v240 offset:8960
 buffer_load_dwordx4 v248, s[32:35], s65 offen lds
 v_mfma_f32_16x16x32_bf16 v[196:199], a[168:171], v[60:63], v[196:199]
 s_waitcnt lgkmcnt(6)
 v_rcp_f32 v225, v225
 v_mul_f32 v224, v156, v224
 v_mfma_f32_16x16x32_bf16 v[204:207], a[172:175], v[60:63], v[204:207]
 ds_read_b64_tr_b16 a[156:157], v241 offset:8704
 ds_read_b64_tr_b16 a[158:159], v241 offset:8960
 v_mfma_f32_16x16x32_bf16 v[200:203], a[172:175], v[56:59], v[200:203]
 s_waitcnt lgkmcnt(6)
 v_mul_f32 v225, v157, v225
 v_cvt_pk_bf16_f32 v230, v224, v225
 v_accvgpr_write_b32 a70, v230
 v_mfma_f32_16x16x32_bf16 v[176:179], a[144:147], v[64:67], v[176:179]
 ds_read_b64_tr_b16 a[160:161], v240 offset:12288
 ds_read_b64_tr_b16 a[162:163], v240 offset:12544
 v_mfma_f32_16x16x32_bf16 v[180:183], a[144:147], v[68:71], v[180:183]
 s_waitcnt lgkmcnt(6)
 v_exp_f32 v226, v158
 v_exp_f32 v227, v159
 v_mfma_f32_16x16x32_bf16 v[188:191], a[148:151], v[68:71], v[188:191]
 s_add_u32 m0, s64, 61440
 ds_read_b64_tr_b16 a[164:165], v241 offset:12288
 ds_read_b64_tr_b16 a[166:167], v241 offset:12544
 v_mfma_f32_16x16x32_bf16 v[184:187], a[148:151], v[64:67], v[184:187]
 s_waitcnt lgkmcnt(6)
 v_fma_f32 v226, v226, s75, s75
 v_fma_f32 v227, v227, s75, s75
 v_rcp_f32 v226, v226
 v_mfma_f32_16x16x32_bf16 v[192:195], a[152:155], v[64:67], v[192:195]
 s_mov_b32 s65, 4424448
 ds_read_b64_tr_b16 a[168:169], v240 offset:12800
 ds_read_b64_tr_b16 a[170:171], v240 offset:13056
 buffer_load_dwordx4 v248, s[32:35], s65 offen lds
 v_mfma_f32_16x16x32_bf16 v[196:199], a[152:155], v[68:71], v[196:199]
 s_waitcnt lgkmcnt(6)
 v_rcp_f32 v227, v227
 v_mfma_f32_16x16x32_bf16 v[204:207], a[156:159], v[68:71], v[204:207]
 ds_read_b64_tr_b16 a[172:173], v241 offset:12800
 ds_read_b64_tr_b16 a[174:175], v241 offset:13056
 v_mfma_f32_16x16x32_bf16 v[200:203], a[156:159], v[64:67], v[200:203]
 s_waitcnt lgkmcnt(6)
 v_mul_f32 v226, v158, v226
 v_mul_f32 v227, v159, v227
 v_cvt_pk_bf16_f32 v231, v226, v227
 v_mfma_f32_16x16x32_bf16 v[176:179], a[160:163], v[72:75], v[176:179]
 ds_read_b64_tr_b16 a[144:145], v240 offset:16384
 ds_read_b64_tr_b16 a[146:147], v240 offset:16640
 v_mfma_f32_16x16x32_bf16 v[180:183], a[160:163], v[76:79], v[180:183]
 s_waitcnt lgkmcnt(6)
 v_accvgpr_write_b32 a71, v231
 v_exp_f32 v228, v160
 v_mfma_f32_16x16x32_bf16 v[188:191], a[164:167], v[76:79], v[188:191]
 s_add_u32 m0, s64, 65536
 ds_read_b64_tr_b16 a[148:149], v241 offset:16384
 ds_read_b64_tr_b16 a[150:151], v241 offset:16640
 v_mfma_f32_16x16x32_bf16 v[184:187], a[164:167], v[72:75], v[184:187]
 s_waitcnt lgkmcnt(6)
 v_exp_f32 v229, v161
 v_fma_f32 v228, v228, s75, s75
 v_mfma_f32_16x16x32_bf16 v[192:195], a[168:171], v[72:75], v[192:195]
 s_mov_b32 s65, 4719360
 ds_read_b64_tr_b16 a[152:153], v240 offset:16896
 ds_read_b64_tr_b16 a[154:155], v240 offset:17152
 buffer_load_dwordx4 v248, s[32:35], s65 offen lds
 v_mfma_f32_16x16x32_bf16 v[196:199], a[168:171], v[76:79], v[196:199]
 s_waitcnt lgkmcnt(6)
 v_fma_f32 v229, v229, s75, s75
 v_rcp_f32 v228, v228
 v_mfma_f32_16x16x32_bf16 v[204:207], a[172:175], v[76:79], v[204:207]
 ds_read_b64_tr_b16 a[156:157], v241 offset:16896
 ds_read_b64_tr_b16 a[158:159], v241 offset:17152
 v_mfma_f32_16x16x32_bf16 v[200:203], a[172:175], v[72:75], v[200:203]
 s_waitcnt lgkmcnt(6)
 v_rcp_f32 v229, v229
 v_mul_f32 v228, v160, v228
 v_mul_f32 v229, v161, v229
 v_mfma_f32_16x16x32_bf16 v[176:179], a[144:147], v[80:83], v[176:179]
 ds_read_b64_tr_b16 a[160:161], v240 offset:20480
 ds_read_b64_tr_b16 a[162:163], v240 offset:20736
 v_mfma_f32_16x16x32_bf16 v[180:183], a[144:147], v[84:87], v[180:183]
 s_waitcnt lgkmcnt(6)
 v_cvt_pk_bf16_f32 v232, v228, v229
 v_accvgpr_write_b32 a72, v232
 v_exp_f32 v224, v162
 v_mfma_f32_16x16x32_bf16 v[188:191], a[148:151], v[84:87], v[188:191]
 s_add_u32 m0, s64, 69632
 ds_read_b64_tr_b16 a[164:165], v241 offset:20480
 ds_read_b64_tr_b16 a[166:167], v241 offset:20736
 v_mfma_f32_16x16x32_bf16 v[184:187], a[148:151], v[80:83], v[184:187]
 s_waitcnt lgkmcnt(6)
 v_exp_f32 v225, v163
 v_mfma_f32_16x16x32_bf16 v[192:195], a[152:155], v[80:83], v[192:195]
 s_mov_b32 s65, 5014272
 ds_read_b64_tr_b16 a[168:169], v240 offset:20992
 ds_read_b64_tr_b16 a[170:171], v240 offset:21248
 buffer_load_dwordx4 v248, s[32:35], s65 offen lds
 v_mfma_f32_16x16x32_bf16 v[196:199], a[152:155], v[84:87], v[196:199]
 s_waitcnt lgkmcnt(6)
 v_fma_f32 v224, v224, s75, s75
 v_fma_f32 v225, v225, s75, s75
 v_rcp_f32 v224, v224
 v_mfma_f32_16x16x32_bf16 v[204:207], a[156:159], v[84:87], v[204:207]
 ds_read_b64_tr_b16 a[172:173], v241 offset:20992
 ds_read_b64_tr_b16 a[174:175], v241 offset:21248
 v_mfma_f32_16x16x32_bf16 v[200:203], a[156:159], v[80:83], v[200:203]
 s_waitcnt lgkmcnt(6)
 v_rcp_f32 v225, v225
 v_mfma_f32_16x16x32_bf16 v[176:179], a[160:163], v[88:91], v[176:179]
 s_waitcnt vmcnt(18)
 s_barrier
 ds_read_b64_tr_b16 a[144:145], v240 offset:24576
 ds_read_b64_tr_b16 a[146:147], v240 offset:24832
 v_mfma_f32_16x16x32_bf16 v[180:183], a[160:163], v[92:95], v[180:183]
 s_waitcnt lgkmcnt(6)
 v_mul_f32 v224, v162, v224
 v_mul_f32 v225, v163, v225
 v_cvt_pk_bf16_f32 v230, v224, v225
 v_mfma_f32_16x16x32_bf16 v[188:191], a[164:167], v[92:95], v[188:191]
 s_add_u32 m0, s64, 73728
 ds_read_b64_tr_b16 a[148:149], v241 offset:24576
 ds_read_b64_tr_b16 a[150:151], v241 offset:24832
 v_mfma_f32_16x16x32_bf16 v[184:187], a[164:167], v[88:91], v[184:187]
 s_waitcnt lgkmcnt(6)
 v_accvgpr_write_b32 a73, v230
 v_exp_f32 v226, v164
 v_mfma_f32_16x16x32_bf16 v[192:195], a[168:171], v[88:91], v[192:195]
 s_mov_b32 s65, 896
 ds_read_b64_tr_b16 a[152:153], v240 offset:25088
 ds_read_b64_tr_b16 a[154:155], v240 offset:25344
 buffer_load_dwordx4 v248, s[32:35], s65 offen lds
 v_mfma_f32_16x16x32_bf16 v[196:199], a[168:171], v[92:95], v[196:199]
 s_waitcnt lgkmcnt(6)
 v_exp_f32 v227, v165
 v_fma_f32 v226, v226, s75, s75
 v_fma_f32 v227, v227, s75, s75
 v_mfma_f32_16x16x32_bf16 v[204:207], a[172:175], v[92:95], v[204:207]
 ds_read_b64_tr_b16 a[156:157], v241 offset:25088
 ds_read_b64_tr_b16 a[158:159], v241 offset:25344
 v_mfma_f32_16x16x32_bf16 v[200:203], a[172:175], v[88:91], v[200:203]
 s_waitcnt lgkmcnt(6)
 v_rcp_f32 v226, v226
 v_rcp_f32 v227, v227
 v_mfma_f32_16x16x32_bf16 v[176:179], a[144:147], v[96:99], v[176:179]
 ds_read_b64_tr_b16 a[160:161], v240 offset:28672
 ds_read_b64_tr_b16 a[162:163], v240 offset:28928
 v_mfma_f32_16x16x32_bf16 v[180:183], a[144:147], v[100:103], v[180:183]
 s_waitcnt lgkmcnt(6)
 v_mul_f32 v226, v164, v226
 v_mul_f32 v227, v165, v227
 v_mfma_f32_16x16x32_bf16 v[188:191], a[148:151], v[100:103], v[188:191]
 s_add_u32 m0, s64, 77824
 ds_read_b64_tr_b16 a[164:165], v241 offset:28672
 ds_read_b64_tr_b16 a[166:167], v241 offset:28928
 v_mfma_f32_16x16x32_bf16 v[184:187], a[148:151], v[96:99], v[184:187]
 s_waitcnt lgkmcnt(6)
 v_cvt_pk_bf16_f32 v231, v226, v227
 v_accvgpr_write_b32 a76, v231
 v_exp_f32 v228, v166
 v_mfma_f32_16x16x32_bf16 v[192:195], a[152:155], v[96:99], v[192:195]
 s_mov_b32 s65, 295808
 ds_read_b64_tr_b16 a[168:169], v240 offset:29184
 ds_read_b64_tr_b16 a[170:171], v240 offset:29440
 buffer_load_dwordx4 v248, s[32:35], s65 offen lds
 v_mfma_f32_16x16x32_bf16 v[196:199], a[152:155], v[100:103], v[196:199]
 s_waitcnt lgkmcnt(6)
 v_exp_f32 v229, v167
 v_mfma_f32_16x16x32_bf16 v[204:207], a[156:159], v[100:103], v[204:207]
 ds_read_b64_tr_b16 a[172:173], v241 offset:29184
 ds_read_b64_tr_b16 a[174:175], v241 offset:29440
 v_mfma_f32_16x16x32_bf16 v[200:203], a[156:159], v[96:99], v[200:203]
 s_waitcnt lgkmcnt(6)
 v_fma_f32 v228, v228, s75, s75
 v_fma_f32 v229, v229, s75, s75
 v_rcp_f32 v228, v228
 v_mfma_f32_16x16x32_bf16 v[176:179], a[160:163], v[104:107], v[176:179]
 ds_read_b64_tr_b16 a[144:145], v240 offset:32768
 ds_read_b64_tr_b16 a[146:147], v240 offset:33024
 v_mfma_f32_16x16x32_bf16 v[180:183], a[160:163], v[108:111], v[180:183]
 s_waitcnt lgkmcnt(6)
 v_rcp_f32 v229, v229
 v_mul_f32 v228, v166, v228
 v_mfma_f32_16x16x32_bf16 v[188:191], a[164:167], v[108:111], v[188:191]
 s_add_u32 m0, s64, 81920
 ds_read_b64_tr_b16 a[148:149], v241 offset:32768
 ds_read_b64_tr_b16 a[150:151], v241 offset:33024
 v_mfma_f32_16x16x32_bf16 v[184:187], a[164:167], v[104:107], v[184:187]
 s_waitcnt lgkmcnt(6)
 v_mul_f32 v229, v167, v229
 v_cvt_pk_bf16_f32 v232, v228, v229
 v_accvgpr_write_b32 a77, v232
 v_mfma_f32_16x16x32_bf16 v[192:195], a[168:171], v[104:107], v[192:195]
 s_mov_b32 s65, 590720
 ds_read_b64_tr_b16 a[152:153], v240 offset:33280
 ds_read_b64_tr_b16 a[154:155], v240 offset:33536
 buffer_load_dwordx4 v248, s[32:35], s65 offen lds
 v_mfma_f32_16x16x32_bf16 v[196:199], a[168:171], v[108:111], v[196:199]
 s_waitcnt lgkmcnt(6)
 v_exp_f32 v224, v168
 v_exp_f32 v225, v169
 v_mfma_f32_16x16x32_bf16 v[204:207], a[172:175], v[108:111], v[204:207]
 ds_read_b64_tr_b16 a[156:157], v241 offset:33280
 ds_read_b64_tr_b16 a[158:159], v241 offset:33536
 v_mfma_f32_16x16x32_bf16 v[200:203], a[172:175], v[104:107], v[200:203]
 s_waitcnt lgkmcnt(6)
 v_fma_f32 v224, v224, s75, s75
 v_fma_f32 v225, v225, s75, s75
 v_mfma_f32_16x16x32_bf16 v[176:179], a[144:147], v[112:115], v[176:179]
 ds_read_b64_tr_b16 a[160:161], v240 offset:36864
 ds_read_b64_tr_b16 a[162:163], v240 offset:37120
 v_mfma_f32_16x16x32_bf16 v[180:183], a[144:147], v[116:119], v[180:183]
 s_waitcnt lgkmcnt(6)
 v_rcp_f32 v224, v224
 v_rcp_f32 v225, v225
 v_mfma_f32_16x16x32_bf16 v[188:191], a[148:151], v[116:119], v[188:191]
 s_add_u32 m0, s64, 86016
 ds_read_b64_tr_b16 a[164:165], v241 offset:36864
 ds_read_b64_tr_b16 a[166:167], v241 offset:37120
 v_mfma_f32_16x16x32_bf16 v[184:187], a[148:151], v[112:115], v[184:187]
 s_waitcnt lgkmcnt(6)
 v_mul_f32 v224, v168, v224
 v_mul_f32 v225, v169, v225
 v_mfma_f32_16x16x32_bf16 v[192:195], a[152:155], v[112:115], v[192:195]
 s_mov_b32 s65, 885632
 ds_read_b64_tr_b16 a[168:169], v240 offset:37376
 ds_read_b64_tr_b16 a[170:171], v240 offset:37632
 buffer_load_dwordx4 v248, s[32:35], s65 offen lds
 v_mfma_f32_16x16x32_bf16 v[196:199], a[152:155], v[116:119], v[196:199]
 s_waitcnt lgkmcnt(6)
 v_cvt_pk_bf16_f32 v230, v224, v225
 v_accvgpr_write_b32 a74, v230
 v_exp_f32 v226, v170
 v_mfma_f32_16x16x32_bf16 v[204:207], a[156:159], v[116:119], v[204:207]
 ds_read_b64_tr_b16 a[172:173], v241 offset:37376
 ds_read_b64_tr_b16 a[174:175], v241 offset:37632
 v_mfma_f32_16x16x32_bf16 v[200:203], a[156:159], v[112:115], v[200:203]
 s_waitcnt lgkmcnt(6)
 v_exp_f32 v227, v171
 v_fma_f32 v226, v226, s75, s75
 v_mfma_f32_16x16x32_bf16 v[176:179], a[160:163], v[120:123], v[176:179]
 ds_read_b64_tr_b16 a[144:145], v240 offset:40960
 ds_read_b64_tr_b16 a[146:147], v240 offset:41216
 v_mfma_f32_16x16x32_bf16 v[180:183], a[160:163], v[124:127], v[180:183]
 s_waitcnt lgkmcnt(6)
 v_fma_f32 v227, v227, s75, s75
 v_rcp_f32 v226, v226
 v_mfma_f32_16x16x32_bf16 v[188:191], a[164:167], v[124:127], v[188:191]
 s_add_u32 m0, s64, 90112
 ds_read_b64_tr_b16 a[148:149], v241 offset:40960
 ds_read_b64_tr_b16 a[150:151], v241 offset:41216
 v_mfma_f32_16x16x32_bf16 v[184:187], a[164:167], v[120:123], v[184:187]
 s_waitcnt lgkmcnt(6)
 v_rcp_f32 v227, v227
 v_mul_f32 v226, v170, v226
 v_mfma_f32_16x16x32_bf16 v[192:195], a[168:171], v[120:123], v[192:195]
 s_mov_b32 s65, 1180544
 ds_read_b64_tr_b16 a[152:153], v240 offset:41472
 ds_read_b64_tr_b16 a[154:155], v240 offset:41728
 buffer_load_dwordx4 v248, s[32:35], s65 offen lds
 v_mfma_f32_16x16x32_bf16 v[196:199], a[168:171], v[124:127], v[196:199]
 s_waitcnt lgkmcnt(6)
 v_mul_f32 v227, v171, v227
 v_cvt_pk_bf16_f32 v231, v226, v227
 v_accvgpr_write_b32 a75, v231
 v_mfma_f32_16x16x32_bf16 v[204:207], a[172:175], v[124:127], v[204:207]
 ds_read_b64_tr_b16 a[156:157], v241 offset:41472
 ds_read_b64_tr_b16 a[158:159], v241 offset:41728
 v_mfma_f32_16x16x32_bf16 v[200:203], a[172:175], v[120:123], v[200:203]
 s_waitcnt lgkmcnt(6)
 v_exp_f32 v228, v172
 v_exp_f32 v229, v173
 v_mfma_f32_16x16x32_bf16 v[176:179], a[144:147], v[128:131], v[176:179]
 ds_read_b64_tr_b16 a[160:161], v240 offset:45056
 ds_read_b64_tr_b16 a[162:163], v240 offset:45312
 v_mfma_f32_16x16x32_bf16 v[180:183], a[144:147], v[132:135], v[180:183]
 s_waitcnt lgkmcnt(6)
 v_fma_f32 v228, v228, s75, s75
 v_fma_f32 v229, v229, s75, s75
 v_mfma_f32_16x16x32_bf16 v[188:191], a[148:151], v[132:135], v[188:191]
 s_add_u32 m0, s64, 94208
 ds_read_b64_tr_b16 a[164:165], v241 offset:45056
 ds_read_b64_tr_b16 a[166:167], v241 offset:45312
 v_mfma_f32_16x16x32_bf16 v[184:187], a[148:151], v[128:131], v[184:187]
 s_waitcnt lgkmcnt(6)
 v_rcp_f32 v228, v228
 v_rcp_f32 v229, v229
 v_mfma_f32_16x16x32_bf16 v[192:195], a[152:155], v[128:131], v[192:195]
 s_mov_b32 s65, 1475456
 ds_read_b64_tr_b16 a[168:169], v240 offset:45568
 ds_read_b64_tr_b16 a[170:171], v240 offset:45824
 buffer_load_dwordx4 v248, s[32:35], s65 offen lds
 v_mfma_f32_16x16x32_bf16 v[196:199], a[152:155], v[132:135], v[196:199]
 s_waitcnt lgkmcnt(6)
 v_mul_f32 v228, v172, v228
 v_mul_f32 v229, v173, v229
 v_cvt_pk_bf16_f32 v232, v228, v229
 v_mfma_f32_16x16x32_bf16 v[204:207], a[156:159], v[132:135], v[204:207]
 ds_read_b64_tr_b16 a[172:173], v241 offset:45568
 ds_read_b64_tr_b16 a[174:175], v241 offset:45824
 v_mfma_f32_16x16x32_bf16 v[200:203], a[156:159], v[128:131], v[200:203]
 s_waitcnt lgkmcnt(6)
 v_accvgpr_write_b32 a78, v232
 v_exp_f32 v224, v174
 v_mfma_f32_16x16x32_bf16 v[176:179], a[160:163], v[136:139], v[176:179]
 s_waitcnt vmcnt(18)
 s_barrier
 ds_read_b64_tr_b16 a[144:145], v236 offset:0
 ds_read_b64_tr_b16 a[146:147], v236 offset:256
 v_mfma_f32_16x16x32_bf16 v[180:183], a[160:163], v[140:143], v[180:183]
 s_waitcnt lgkmcnt(6)
 v_exp_f32 v225, v175
 v_fma_f32 v224, v224, s75, s75
 v_mfma_f32_16x16x32_bf16 v[188:191], a[164:167], v[140:143], v[188:191]
 s_add_u32 m0, s64, 98304
 ds_read_b64_tr_b16 a[148:149], v237 offset:0
 ds_read_b64_tr_b16 a[150:151], v237 offset:256
 v_mfma_f32_16x16x32_bf16 v[184:187], a[164:167], v[136:139], v[184:187]
 s_waitcnt lgkmcnt(6)
 v_fma_f32 v225, v225, s75, s75
 v_rcp_f32 v224, v224
 v_mfma_f32_16x16x32_bf16 v[192:195], a[168:171], v[136:139], v[192:195]
 s_mov_b32 s65, 1770368
 ds_read_b64_tr_b16 a[152:153], v236 offset:512
 ds_read_b64_tr_b16 a[154:155], v236 offset:768
 buffer_load_dwordx4 v248, s[32:35], s65 offen lds
 v_mfma_f32_16x16x32_bf16 v[196:199], a[168:171], v[140:143], v[196:199]
 s_waitcnt lgkmcnt(6)
 v_rcp_f32 v225, v225
 v_mul_f32 v224, v174, v224
 v_mfma_f32_16x16x32_bf16 v[204:207], a[172:175], v[140:143], v[204:207]
 ds_read_b64_tr_b16 a[156:157], v237 offset:512
 ds_read_b64_tr_b16 a[158:159], v237 offset:768
 v_mfma_f32_16x16x32_bf16 v[200:203], a[172:175], v[136:139], v[200:203]
 s_waitcnt lgkmcnt(6)
 v_mul_f32 v225, v175, v225
 v_cvt_pk_bf16_f32 v230, v224, v225
 v_accvgpr_write_b32 a79, v230
 v_mfma_f32_16x16x32_bf16 v[144:147], a[144:147], v[0:3], 0
 s_cmp_eq_u32 s15, 5
 s_cbranch_scc1 L_hsl6
L_hsl6_ok:
 s_cmp_eq_u32 s15, 3
 s_cbranch_scc1 L_hsc6
L_hsc6_ok:
 ds_read_b64_tr_b16 a[160:161], v236 offset:4096
 ds_read_b64_tr_b16 a[162:163], v236 offset:4352
 v_mfma_f32_16x16x32_bf16 v[148:151], a[144:147], v[4:7], 0
 s_waitcnt lgkmcnt(6)
 v_mfma_f32_16x16x32_bf16 v[156:159], a[148:151], v[4:7], 0
 s_add_u32 m0, s64, 102400
 ds_read_b64_tr_b16 a[164:165], v237 offset:4096
 ds_read_b64_tr_b16 a[166:167], v237 offset:4352
 v_mfma_f32_16x16x32_bf16 v[152:155], a[148:151], v[0:3], 0
 s_waitcnt lgkmcnt(6)
 v_exp_f32 v224, v176
 v_exp_f32 v225, v177
 v_mfma_f32_16x16x32_bf16 v[160:163], a[152:155], v[0:3], 0
 s_mov_b32 s65, 2065280
 ds_read_b64_tr_b16 a[168:169], v236 offset:4608
 ds_read_b64_tr_b16 a[170:171], v236 offset:4864
 buffer_load_dwordx4 v248, s[32:35], s65 offen lds
 v_mfma_f32_16x16x32_bf16 v[164:167], a[152:155], v[4:7], 0
 s_waitcnt lgkmcnt(6)
 v_fma_f32 v224, v224, s75, s75
 v_fma_f32 v225, v225, s75, s75
 v_rcp_f32 v224, v224
 v_mfma_f32_16x16x32_bf16 v[172:175], a[156:159], v[4:7], 0
 ds_read_b64_tr_b16 a[172:173], v237 offset:4608
 ds_read_b64_tr_b16 a[174:175], v237 offset:4864
 v_mfma_f32_16x16x32_bf16 v[168:171], a[156:159], v[0:3], 0
 s_waitcnt lgkmcnt(6)
 v_rcp_f32 v225, v225
 v_mfma_f32_16x16x32_bf16 v[144:147], a[160:163], v[8:11], v[144:147]
 ds_read_b64_tr_b16 a[144:145], v236 offset:8192
 ds_read_b64_tr_b16 a[146:147], v236 offset:8448
 v_mfma_f32_16x16x32_bf16 v[148:151], a[160:163], v[12:15], v[148:151]
 s_waitcnt lgkmcnt(6)
 v_mul_f32 v224, v176, v224
 v_mul_f32 v225, v177, v225
 v_cvt_pk_bf16_f32 v230, v224, v225
 v_mfma_f32_16x16x32_bf16 v[156:159], a[164:167], v[12:15], v[156:159]
 s_add_u32 m0, s64, 106496
 ds_read_b64_tr_b16 a[148:149], v237 offset:8192
 ds_read_b64_tr_b16 a[150:151], v237 offset:8448
 v_mfma_f32_16x16x32_bf16 v[152:155], a[164:167], v[8:11], v[152:155]
 s_waitcnt lgkmcnt(6)
 v_accvgpr_write_b32 a80, v230
 v_exp_f32 v226, v178
 v_mfma_f32_16x16x32_bf16 v[160:163], a[168:171], v[8:11], v[160:163]
 s_mov_b32 s65, 2360192
 ds_read_b64_tr_b16 a[152:153], v236 offset:8704
 ds_read_b64_tr_b16 a[154:155], v236 offset:8960
 buffer_load_dwordx4 v248, s[32:35], s65 offen lds
 v_mfma_f32_16x16x32_bf16 v[164:167], a[168:171], v[12:15], v[164:167]
 s_waitcnt lgkmcnt(6)
 v_exp_f32 v227, v179
 v_fma_f32 v226, v226, s75, s75
 v_mfma_f32_16x16x32_bf16 v[172:175], a[172:175], v[12:15], v[172:175]
 ds_read_b64_tr_b16 a[156:157], v237 offset:8704
 ds_read_b64_tr_b16 a[158:159], v237 offset:8960
 v_mfma_f32_16x16x32_bf16 v[168:171], a[172:175], v[8:11], v[168:171]
 s_waitcnt lgkmcnt(6)
 v_fma_f32 v227, v227, s75, s75
 v_rcp_f32 v226, v226
 v_mfma_f32_16x16x32_bf16 v[144:147], a[144:147], v[16:19], v[144:147]
 ds_read_b64_tr_b16 a[160:161], v236 offset:12288
 ds_read_b64_tr_b16 a[162:163], v236 offset:12544
 v_mfma_f32_16x16x32_bf16 v[148:151], a[144:147], v[20:23], v[148:151]
 s_waitcnt lgkmcnt(6)
 v_rcp_f32 v227, v227
 v_mul_f32 v226, v178, v226
 v_mul_f32 v227, v179, v227
 v_mfma_f32_16x16x32_bf16 v[156:159], a[148:151], v[20:23], v[156:159]
 s_add_u32 m0, s64, 110592
 ds_read_b64_tr_b16 a[164:165], v237 offset:12288
 ds_read_b64_tr_b16 a[166:167], v237 offset:12544
 v_mfma_f32_16x16x32_bf16 v[152:155], a[148:151], v[16:19], v[152:155]
 s_waitcnt lgkmcnt(6)
 v_cvt_pk_bf16_f32 v231, v226, v227
 v_accvgpr_write_b32 a81, v231
 v_exp_f32 v228, v180
 v_mfma_f32_16x16x32_bf16 v[160:163], a[152:155], v[16:19], v[160:163]
 s_mov_b32 s65, 2655104
 ds_read_b64_tr_b16 a[168:169], v236 offset:12800
 ds_read_b64_tr_b16 a[170:171], v236 offset:13056
 buffer_load_dwordx4 v248, s[32:35], s65 offen lds
 v_mfma_f32_16x16x32_bf16 v[164:167], a[152:155], v[20:23], v[164:167]
 s_waitcnt lgkmcnt(6)
 v_exp_f32 v229, v181
 v_mfma_f32_16x16x32_bf16 v[172:175], a[156:159], v[20:23], v[172:175]
 ds_read_b64_tr_b16 a[172:173], v237 offset:12800
 ds_read_b64_tr_b16 a[174:175], v237 offset:13056
 v_mfma_f32_16x16x32_bf16 v[168:171], a[156:159], v[16:19], v[168:171]
 s_waitcnt lgkmcnt(6)
 v_fma_f32 v228, v228, s75, s75
 v_fma_f32 v229, v229, s75, s75
 v_rcp_f32 v228, v228
 v_mfma_f32_16x16x32_bf16 v[144:147], a[160:163], v[24:27], v[144:147]
 ds_read_b64_tr_b16 a[144:145], v236 offset:16384
 ds_read_b64_tr_b16 a[146:147], v236 offset:16640
 v_mfma_f32_16x16x32_bf16 v[148:151], a[160:163], v[28:31], v[148:151]
 s_waitcnt lgkmcnt(6)
 v_rcp_f32 v229, v229
 v_mfma_f32_16x16x32_bf16 v[156:159], a[164:167], v[28:31], v[156:159]
 s_add_u32 m0, s64, 114688
 ds_read_b64_tr_b16 a[148:149], v237 offset:16384
 ds_read_b64_tr_b16 a[150:151], v237 offset:16640
 v_mfma_f32_16x16x32_bf16 v[152:155], a[164:167], v[24:27], v[152:155]
 s_waitcnt lgkmcnt(6)
 v_mul_f32 v228, v180, v228
 v_mul_f32 v229, v181, v229
 v_cvt_pk_bf16_f32 v232, v228, v229
 v_accvgpr_write_b32 a84, v232
 v_mfma_f32_16x16x32_bf16 v[160:163], a[168:171], v[24:27], v[160:163]
 s_mov_b32 s65, 2950016
 ds_read_b64_tr_b16 a[152:153], v236 offset:16896
 ds_read_b64_tr_b16 a[154:155], v236 offset:17152
 buffer_load_dwordx4 v248, s[32:35], s65 offen lds
 v_mfma_f32_16x16x32_bf16 v[164:167], a[168:171], v[28:31], v[164:167]
 s_waitcnt lgkmcnt(6)
 v_exp_f32 v224, v182
 v_exp_f32 v225, v183
 v_mfma_f32_16x16x32_bf16 v[172:175], a[172:175], v[28:31], v[172:175]
 ds_read_b64_tr_b16 a[156:157], v237 offset:16896
 ds_read_b64_tr_b16 a[158:159], v237 offset:17152
 v_mfma_f32_16x16x32_bf16 v[168:171], a[172:175], v[24:27], v[168:171]
 s_waitcnt lgkmcnt(6)
 v_fma_f32 v224, v224, s75, s75
 v_fma_f32 v225, v225, s75, s75
 v_mfma_f32_16x16x32_bf16 v[144:147], a[144:147], v[32:35], v[144:147]
 ds_read_b64_tr_b16 a[160:161], v236 offset:20480
 ds_read_b64_tr_b16 a[162:163], v236 offset:20736
 v_mfma_f32_16x16x32_bf16 v[148:151], a[144:147], v[36:39], v[148:151]
 s_waitcnt lgkmcnt(6)
 v_rcp_f32 v224, v224
 v_rcp_f32 v225, v225
 v_mfma_f32_16x16x32_bf16 v[156:159], a[148:151], v[36:39], v[156:159]
 s_add_u32 m0, s64, 118784
 ds_read_b64_tr_b16 a[164:165], v237 offset:20480
 ds_read_b64_tr_b16 a[166:167], v237 offset:20736
 v_mfma_f32_16x16x32_bf16 v[152:155], a[148:151], v[32:35], v[152:155]
 s_waitcnt lgkmcnt(6)
 v_mul_f32 v224, v182, v224
 v_mul_f32 v225, v183, v225
 v_mfma_f32_16x16x32_bf16 v[160:163], a[152:155], v[32:35], v[160:163]
 s_mov_b32 s65, 3244928
 ds_read_b64_tr_b16 a[168:169], v236 offset:20992
 ds_read_b64_tr_b16 a[170:171], v236 offset:21248
 buffer_load_dwordx4 v248, s[32:35], s65 offen lds
 v_mfma_f32_16x16x32_bf16 v[164:167], a[152:155], v[36:39], v[164:167]
 s_waitcnt lgkmcnt(6)
 v_cvt_pk_bf16_f32 v230, v224, v225
 v_accvgpr_write_b32 a85, v230
 v_exp_f32 v226, v184
 v_mfma_f32_16x16x32_bf16 v[172:175], a[156:159], v[36:39], v[172:175]
 ds_read_b64_tr_b16 a[172:173], v237 offset:20992
 ds_read_b64_tr_b16 a[174:175], v237 offset:21248
 v_mfma_f32_16x16x32_bf16 v[168:171], a[156:159], v[32:35], v[168:171]
 s_waitcnt lgkmcnt(6)
 v_exp_f32 v227, v185
 v_mfma_f32_16x16x32_bf16 v[144:147], a[160:163], v[40:43], v[144:147]
 s_waitcnt vmcnt(18)
 s_barrier
 ds_read_b64_tr_b16 a[144:145], v236 offset:24576
 ds_read_b64_tr_b16 a[146:147], v236 offset:24832
 v_mfma_f32_16x16x32_bf16 v[148:151], a[160:163], v[44:47], v[148:151]
 s_waitcnt lgkmcnt(6)
 v_fma_f32 v226, v226, s75, s75
 v_fma_f32 v227, v227, s75, s75
 v_rcp_f32 v226, v226
 v_mfma_f32_16x16x32_bf16 v[156:159], a[164:167], v[44:47], v[156:159]
 s_add_u32 m0, s64, 122880
 ds_read_b64_tr_b16 a[148:149], v237 offset:24576
 ds_read_b64_tr_b16 a[150:151], v237 offset:24832
 v_mfma_f32_16x16x32_bf16 v[152:155], a[164:167], v[40:43], v[152:155]
 s_waitcnt lgkmcnt(6)
 v_rcp_f32 v227, v227
 v_mul_f32 v226, v184, v226
 v_mfma_f32_16x16x32_bf16 v[160:163], a[168:171], v[40:43], v[160:163]
 s_mov_b32 s65, 3539840
 ds_read_b64_tr_b16 a[152:153], v236 offset:25088
 ds_read_b64_tr_b16 a[154:155], v236 offset:25344
 buffer_load_dwordx4 v248, s[32:35], s65 offen lds
 v_mfma_f32_16x16x32_bf16 v[164:167], a[168:171], v[44:47], v[164:167]
 s_waitcnt lgkmcnt(6)
 v_mul_f32 v227, v185, v227
 v_cvt_pk_bf16_f32 v231, v226, v227
 v_accvgpr_write_b32 a82, v231
 v_mfma_f32_16x16x32_bf16 v[172:175], a[172:175], v[44:47], v[172:175]
 ds_read_b64_tr_b16 a[156:157], v237 offset:25088
 ds_read_b64_tr_b16 a[158:159], v237 offset:25344
 v_mfma_f32_16x16x32_bf16 v[168:171], a[172:175], v[40:43], v[168:171]
 s_waitcnt lgkmcnt(6)
 v_exp_f32 v228, v186
 v_exp_f32 v229, v187
 v_mfma_f32_16x16x32_bf16 v[144:147], a[144:147], v[48:51], v[144:147]
 ds_read_b64_tr_b16 a[160:161], v236 offset:28672
 ds_read_b64_tr_b16 a[162:163], v236 offset:28928
 v_mfma_f32_16x16x32_bf16 v[148:151], a[144:147], v[52:55], v[148:151]
 s_waitcnt lgkmcnt(6)
 v_fma_f32 v228, v228, s75, s75
 v_fma_f32 v229, v229, s75, s75
 v_mfma_f32_16x16x32_bf16 v[156:159], a[148:151], v[52:55], v[156:159]
 s_add_u32 m0, s64, 126976
 ds_read_b64_tr_b16 a[164:165], v237 offset:28672
 ds_read_b64_tr_b16 a[166:167], v237 offset:28928
 v_mfma_f32_16x16x32_bf16 v[152:155], a[148:151], v[48:51], v[152:155]
 s_waitcnt lgkmcnt(6)
 v_rcp_f32 v228, v228
 v_rcp_f32 v229, v229
 v_mfma_f32_16x16x32_bf16 v[160:163], a[152:155], v[48:51], v[160:163]
 s_mov_b32 s65, 3834752
 ds_read_b64_tr_b16 a[168:169], v236 offset:29184
 ds_read_b64_tr_b16 a[170:171], v236 offset:29440
 buffer_load_dwordx4 v248, s[32:35], s65 offen lds
 v_mfma_f32_16x16x32_bf16 v[164:167], a[152:155], v[52:55], v[164:167]
 s_waitcnt lgkmcnt(6)
 v_mul_f32 v228, v186, v228
 v_mul_f32 v229, v187, v229
 v_cvt_pk_bf16_f32 v232, v228, v229
 v_mfma_f32_16x16x32_bf16 v[172:175], a[156:159], v[52:55], v[172:175]
 ds_read_b64_tr_b16 a[172:173], v237 offset:29184
 ds_read_b64_tr_b16 a[174:175], v237 offset:29440
 v_mfma_f32_16x16x32_bf16 v[168:171], a[156:159], v[48:51], v[168:171]
 s_waitcnt lgkmcnt(6)
 v_accvgpr_write_b32 a83, v232
 v_exp_f32 v224, v188
 v_mfma_f32_16x16x32_bf16 v[144:147], a[160:163], v[56:59], v[144:147]
 ds_read_b64_tr_b16 a[144:145], v236 offset:32768
 ds_read_b64_tr_b16 a[146:147], v236 offset:33024
 v_mfma_f32_16x16x32_bf16 v[148:151], a[160:163], v[60:63], v[148:151]
 s_waitcnt lgkmcnt(6)
 v_exp_f32 v225, v189
 v_fma_f32 v224, v224, s75, s75
 v_mfma_f32_16x16x32_bf16 v[156:159], a[164:167], v[60:63], v[156:159]
 s_add_u32 m0, s64, 131072
 ds_read_b64_tr_b16 a[148:149], v237 offset:32768
 ds_read_b64_tr_b16 a[150:151], v237 offset:33024
 v_mfma_f32_16x16x32_bf16 v[152:155], a[164:167], v[56:59], v[152:155]
 s_waitcnt lgkmcnt(6)
 v_fma_f32 v225, v225, s75, s75
 v_rcp_f32 v224, v224
 v_mfma_f32_16x16x32_bf16 v[160:163], a[168:171], v[56:59], v[160:163]
 s_mov_b32 s65, 4129664
 ds_read_b64_tr_b16 a[152:153], v236 offset:33280
 ds_read_b64_tr_b16 a[154:155], v236 offset:33536
 buffer_load_dwordx4 v248, s[32:35], s65 offen lds
 v_mfma_f32_16x16x32_bf16 v[164:167], a[168:171], v[60:63], v[164:167]
 s_waitcnt lgkmcnt(6)
 v_rcp_f32 v225, v225
 v_mul_f32 v224, v188, v224
 v_mfma_f32_16x16x32_bf16 v[172:175], a[172:175], v[60:63], v[172:175]
 ds_read_b64_tr_b16 a[156:157], v237 offset:33280
 ds_read_b64_tr_b16 a[158:159], v237 offset:33536
 v_mfma_f32_16x16x32_bf16 v[168:171], a[172:175], v[56:59], v[168:171]
 s_waitcnt lgkmcnt(6)
 v_mul_f32 v225, v189, v225
 v_cvt_pk_bf16_f32 v230, v224, v225
 v_accvgpr_write_b32 a86, v230
 v_mfma_f32_16x16x32_bf16 v[144:147], a[144:147], v[64:67], v[144:147]
 ds_read_b64_tr_b16 a[160:161], v236 offset:36864
 ds_read_b64_tr_b16 a[162:163], v236 offset:37120
 v_mfma_f32_16x16x32_bf16 v[148:151], a[144:147], v[68:71], v[148:151]
 s_waitcnt lgkmcnt(6)
 v_exp_f32 v226, v190
 v_exp_f32 v227, v191
 v_mfma_f32_16x16x32_bf16 v[156:159], a[148:151], v[68:71], v[156:159]
 s_add_u32 m0, s64, 135168
 ds_read_b64_tr_b16 a[164:165], v237 offset:36864
 ds_read_b64_tr_b16 a[166:167], v237 offset:37120
 v_mfma_f32_16x16x32_bf16 v[152:155], a[148:151], v[64:67], v[152:155]
 s_waitcnt lgkmcnt(6)
 v_fma_f32 v226, v226, s75, s75
 v_fma_f32 v227, v227, s75, s75
 v_rcp_f32 v226, v226
 v_mfma_f32_16x16x32_bf16 v[160:163], a[152:155], v[64:67], v[160:163]
 s_mov_b32 s65, 4424576
 ds_read_b64_tr_b16 a[168:169], v236 offset:37376
 ds_read_b64_tr_b16 a[170:171], v236 offset:37632
 buffer_load_dwordx4 v248, s[32:35], s65 offen lds
 v_mfma_f32_16x16x32_bf16 v[164:167], a[152:155], v[68:71], v[164:167]
 s_waitcnt lgkmcnt(6)
 v_rcp_f32 v227, v227
 v_mfma_f32_16x16x32_bf16 v[172:175], a[156:159], v[68:71], v[172:175]
 ds_read_b64_tr_b16 a[172:173], v237 offset:37376
 ds_read_b64_tr_b16 a[174:175], v237 offset:37632
 v_mfma_f32_16x16x32_bf16 v[168:171], a[156:159], v[64:67], v[168:171]
 s_waitcnt lgkmcnt(6)
 v_mul_f32 v226, v190, v226
 v_mul_f32 v227, v191, v227
 v_cvt_pk_bf16_f32 v231, v226, v227
 v_mfma_f32_16x16x32_bf16 v[144:147], a[160:163], v[72:75], v[144:147]
 ds_read_b64_tr_b16 a[144:145], v236 offset:40960
 ds_read_b64_tr_b16 a[146:147], v236 offset:41216
 v_mfma_f32_16x16x32_bf16 v[148:151], a[160:163], v[76:79], v[148:151]
 s_waitcnt lgkmcnt(6)
 v_accvgpr_write_b32 a87, v231
 v_exp_f32 v228, v192
 v_mfma_f32_16x16x32_bf16 v[156:159], a[164:167], v[76:79], v[156:159]
 s_add_u32 m0, s64, 139264
 ds_read_b64_tr_b16 a[148:149], v237 offset:40960
 ds_read_b64_tr_b16 a[150:151], v237 offset:41216
 v_mfma_f32_16x16x32_bf16 v[152:155], a[164:167], v[72:75], v[152:155]
 s_waitcnt lgkmcnt(6)
 v_exp_f32 v229, v193
 v_fma_f32 v228, v228, s75, s75
 v_mfma_f32_16x16x32_bf16 v[160:163], a[168:171], v[72:75], v[160:163]
 s_mov_b32 s65, 4719488
 ds_read_b64_tr_b16 a[152:153], v236 offset:41472
 ds_read_b64_tr_b16 a[154:155], v236 offset:41728
 buffer_load_dwordx4 v248, s[32:35], s65 offen lds
 v_mfma_f32_16x16x32_bf16 v[164:167], a[168:171], v[76:79], v[164:167]
 s_waitcnt lgkmcnt(6)
 v_fma_f32 v229, v229, s75, s75
 v_rcp_f32 v228, v228
 v_mfma_f32_16x16x32_bf16 v[172:175], a[172:175], v[76:79], v[172:175]
 ds_read_b64_tr_b16 a[156:157], v237 offset:41472
 ds_read_b64_tr_b16 a[158:159], v237 offset:41728
 v_mfma_f32_16x16x32_bf16 v[168:171], a[172:175], v[72:75], v[168:171]
 s_waitcnt lgkmcnt(6)
 v_rcp_f32 v229, v229
 v_mul_f32 v228, v192, v228
 v_mul_f32 v229, v193, v229
 v_mfma_f32_16x16x32_bf16 v[144:147], a[144:147], v[80:83], v[144:147]
 ds_read_b64_tr_b16 a[160:161], v236 offset:45056
 ds_read_b64_tr_b16 a[162:163], v236 offset:45312
 v_mfma_f32_16x16x32_bf16 v[148:151], a[144:147], v[84:87], v[148:151]
 s_waitcnt lgkmcnt(6)
 v_cvt_pk_bf16_f32 v232, v228, v229
 v_accvgpr_write_b32 a88, v232
 v_exp_f32 v224, v194
 v_mfma_f32_16x16x32_bf16 v[156:159], a[148:151], v[84:87], v[156:159]
 s_add_u32 m0, s64, 143360
 ds_read_b64_tr_b16 a[164:165], v237 offset:45056
 ds_read_b64_tr_b16 a[166:167], v237 offset:45312
 v_mfma_f32_16x16x32_bf16 v[152:155], a[148:151], v[80:83], v[152:155]
 s_waitcnt lgkmcnt(6)
 v_exp_f32 v225, v195
 v_mfma_f32_16x16x32_bf16 v[160:163], a[152:155], v[80:83], v[160:163]
 s_mov_b32 s65, 5014400
 ds_read_b64_tr_b16 a[168:169], v236 offset:45568
 ds_read_b64_tr_b16 a[170:171], v236 offset:45824
 buffer_load_dwordx4 v248, s[32:35], s65 offen lds
 v_mfma_f32_16x16x32_bf16 v[164:167], a[152:155], v[84:87], v[164:167]
 s_waitcnt lgkmcnt(6)
 v_fma_f32 v224, v224, s75, s75
 v_fma_f32 v225, v225, s75, s75
 v_rcp_f32 v224, v224
 v_mfma_f32_16x16x32_bf16 v[172:175], a[156:159], v[84:87], v[172:175]
 ds_read_b64_tr_b16 a[172:173], v237 offset:45568
 ds_read_b64_tr_b16 a[174:175], v237 offset:45824
 v_mfma_f32_16x16x32_bf16 v[168:171], a[156:159], v[80:83], v[168:171]
 s_waitcnt lgkmcnt(6)
 v_rcp_f32 v225, v225
 v_mfma_f32_16x16x32_bf16 v[144:147], a[160:163], v[88:91], v[144:147]
 s_waitcnt vmcnt(18)
 s_barrier
 ds_read_b64_tr_b16 a[144:145], v238 offset:0
 ds_read_b64_tr_b16 a[146:147], v238 offset:256
 v_mfma_f32_16x16x32_bf16 v[148:151], a[160:163], v[92:95], v[148:151]
 s_waitcnt lgkmcnt(6)
 v_mul_f32 v224, v194, v224
 v_mul_f32 v225, v195, v225
 v_cvt_pk_bf16_f32 v230, v224, v225
 v_mfma_f32_16x16x32_bf16 v[156:159], a[164:167], v[92:95], v[156:159]
 s_add_u32 m0, s64, 0
 ds_read_b64_tr_b16 a[148:149], v239 offset:0
 ds_read_b64_tr_b16 a[150:151], v239 offset:256
 v_mfma_f32_16x16x32_bf16 v[152:155], a[164:167], v[88:91], v[152:155]
 s_waitcnt lgkmcnt(6)
 v_accvgpr_write_b32 a89, v230
 v_exp_f32 v226, v196
 v_mfma_f32_16x16x32_bf16 v[160:163], a[168:171], v[88:91], v[160:163]
 s_mov_b32 s65, 1024
 ds_read_b64_tr_b16 a[152:153], v238 offset:512
 ds_read_b64_tr_b16 a[154:155], v238 offset:768
 buffer_load_dwordx4 v248, s[32:35], s65 offen lds
 v_mfma_f32_16x16x32_bf16 v[164:167], a[168:171], v[92:95], v[164:167]
 s_waitcnt lgkmcnt(6)
 v_exp_f32 v227, v197
 v_fma_f32 v226, v226, s75, s75
 v_fma_f32 v227, v227, s75, s75
 v_mfma_f32_16x16x32_bf16 v[172:175], a[172:175], v[92:95], v[172:175]
 ds_read_b64_tr_b16 a[156:157], v239 offset:512
 ds_read_b64_tr_b16 a[158:159], v239 offset:768
 v_mfma_f32_16x16x32_bf16 v[168:171], a[172:175], v[88:91], v[168:171]
 s_waitcnt lgkmcnt(6)
 v_rcp_f32 v226, v226
 v_rcp_f32 v227, v227
 v_mfma_f32_16x16x32_bf16 v[144:147], a[144:147], v[96:99], v[144:147]
 ds_read_b64_tr_b16 a[160:161], v238 offset:4096
 ds_read_b64_tr_b16 a[162:163], v238 offset:4352
 v_mfma_f32_16x16x32_bf16 v[148:151], a[144:147], v[100:103], v[148:151]
 s_waitcnt lgkmcnt(6)
 v_mul_f32 v226, v196, v226
 v_mul_f32 v227, v197, v227
 v_mfma_f32_16x16x32_bf16 v[156:159], a[148:151], v[100:103], v[156:159]
 s_add_u32 m0, s64, 4096
 ds_read_b64_tr_b16 a[164:165], v239 offset:4096
 ds_read_b64_tr_b16 a[166:167], v239 offset:4352
 v_mfma_f32_16x16x32_bf16 v[152:155], a[148:151], v[96:99], v[152:155]
 s_waitcnt lgkmcnt(6)
 v_cvt_pk_bf16_f32 v231, v226, v227
 v_accvgpr_write_b32 a92, v231
 v_exp_f32 v228, v198
 v_mfma_f32_16x16x32_bf16 v[160:163], a[152:155], v[96:99], v[160:163]
 s_mov_b32 s65, 295936
 ds_read_b64_tr_b16 a[168:169], v238 offset:4608
 ds_read_b64_tr_b16 a[170:171], v238 offset:4864
 buffer_load_dwordx4 v248, s[32:35], s65 offen lds
 v_mfma_f32_16x16x32_bf16 v[164:167], a[152:155], v[100:103], v[164:167]
 s_waitcnt lgkmcnt(6)
 v_exp_f32 v229, v199
 v_mfma_f32_16x16x32_bf16 v[172:175], a[156:159], v[100:103], v[172:175]
 ds_read_b64_tr_b16 a[172:173], v239 offset:4608
 ds_read_b64_tr_b16 a[174:175], v239 offset:4864
 v_mfma_f32_16x16x32_bf16 v[168:171], a[156:159], v[96:99], v[168:171]
 s_waitcnt lgkmcnt(6)
 v_fma_f32 v228, v228, s75, s75
 v_fma_f32 v229, v229, s75, s75
 v_rcp_f32 v228, v228
 v_mfma_f32_16x16x32_bf16 v[144:147], a[160:163], v[104:107], v[144:147]
 ds_read_b64_tr_b16 a[144:145], v238 offset:8192
 ds_read_b64_tr_b16 a[146:147], v238 offset:8448
 v_mfma_f32_16x16x32_bf16 v[148:151], a[160:163], v[108:111], v[148:151]
 s_waitcnt lgkmcnt(6)
 v_rcp_f32 v229, v229
 v_mul_f32 v228, v198, v228
 v_mfma_f32_16x16x32_bf16 v[156:159], a[164:167], v[108:111], v[156:159]
 s_add_u32 m0, s64, 8192
 ds_read_b64_tr_b16 a[148:149], v239 offset:8192
 ds_read_b64_tr_b16 a[150:151], v239 offset:8448
 v_mfma_f32_16x16x32_bf16 v[152:155], a[164:167], v[104:107], v[152:155]
 s_waitcnt lgkmcnt(6)
 v_mul_f32 v229, v199, v229
 v_cvt_pk_bf16_f32 v232, v228, v229
 v_accvgpr_write_b32 a93, v232
 v_mfma_f32_16x16x32_bf16 v[160:163], a[168:171], v[104:107], v[160:163]
 s_mov_b32 s65, 590848
 ds_read_b64_tr_b16 a[152:153], v238 offset:8704
 ds_read_b64_tr_b16 a[154:155], v238 offset:8960
 buffer_load_dwordx4 v248, s[32:35], s65 offen lds
 v_mfma_f32_16x16x32_bf16 v[164:167], a[168:171], v[108:111], v[164:167]
 s_waitcnt lgkmcnt(6)
 v_exp_f32 v224, v200
 v_exp_f32 v225, v201
 v_mfma_f32_16x16x32_bf16 v[172:175], a[172:175], v[108:111], v[172:175]
 ds_read_b64_tr_b16 a[156:157], v239 offset:8704
 ds_read_b64_tr_b16 a[158:159], v239 offset:8960
 v_mfma_f32_16x16x32_bf16 v[168:171], a[172:175], v[104:107], v[168:171]
 s_waitcnt lgkmcnt(6)
 v_fma_f32 v224, v224, s75, s75
 v_fma_f32 v225, v225, s75, s75
 v_mfma_f32_16x16x32_bf16 v[144:147], a[144:147], v[112:115], v[144:147]
 ds_read_b64_tr_b16 a[160:161], v238 offset:12288
 ds_read_b64_tr_b16 a[162:163], v238 offset:12544
 v_mfma_f32_16x16x32_bf16 v[148:151], a[144:147], v[116:119], v[148:151]
 s_waitcnt lgkmcnt(6)
 v_rcp_f32 v224, v224
 v_rcp_f32 v225, v225
 v_mfma_f32_16x16x32_bf16 v[156:159], a[148:151], v[116:119], v[156:159]
 s_add_u32 m0, s64, 12288
 ds_read_b64_tr_b16 a[164:165], v239 offset:12288
 ds_read_b64_tr_b16 a[166:167], v239 offset:12544
 v_mfma_f32_16x16x32_bf16 v[152:155], a[148:151], v[112:115], v[152:155]
 s_waitcnt lgkmcnt(6)
 v_mul_f32 v224, v200, v224
 v_mul_f32 v225, v201, v225
 v_mfma_f32_16x16x32_bf16 v[160:163], a[152:155], v[112:115], v[160:163]
 s_mov_b32 s65, 885760
 ds_read_b64_tr_b16 a[168:169], v238 offset:12800
 ds_read_b64_tr_b16 a[170:171], v238 offset:13056
 buffer_load_dwordx4 v248, s[32:35], s65 offen lds
 v_mfma_f32_16x16x32_bf16 v[164:167], a[152:155], v[116:119], v[164:167]
 s_waitcnt lgkmcnt(6)
 v_cvt_pk_bf16_f32 v230, v224, v225
 v_accvgpr_write_b32 a90, v230
 v_exp_f32 v226, v202
 v_mfma_f32_16x16x32_bf16 v[172:175], a[156:159], v[116:119], v[172:175]
 ds_read_b64_tr_b16 a[172:173], v239 offset:12800
 ds_read_b64_tr_b16 a[174:175], v239 offset:13056
 v_mfma_f32_16x16x32_bf16 v[168:171], a[156:159], v[112:115], v[168:171]
 s_waitcnt lgkmcnt(6)
 v_exp_f32 v227, v203
 v_fma_f32 v226, v226, s75, s75
 v_mfma_f32_16x16x32_bf16 v[144:147], a[160:163], v[120:123], v[144:147]
 ds_read_b64_tr_b16 a[144:145], v238 offset:16384
 ds_read_b64_tr_b16 a[146:147], v238 offset:16640
 v_mfma_f32_16x16x32_bf16 v[148:151], a[160:163], v[124:127], v[148:151]
 s_waitcnt lgkmcnt(6)
 v_fma_f32 v227, v227, s75, s75
 v_rcp_f32 v226, v226
 v_mfma_f32_16x16x32_bf16 v[156:159], a[164:167], v[124:127], v[156:159]
 s_add_u32 m0, s64, 16384
 ds_read_b64_tr_b16 a[148:149], v239 offset:16384
 ds_read_b64_tr_b16 a[150:151], v239 offset:16640
 v_mfma_f32_16x16x32_bf16 v[152:155], a[164:167], v[120:123], v[152:155]
 s_waitcnt lgkmcnt(6)
 v_rcp_f32 v227, v227
 v_mul_f32 v226, v202, v226
 v_mfma_f32_16x16x32_bf16 v[160:163], a[168:171], v[120:123], v[160:163]
 s_mov_b32 s65, 1180672
 ds_read_b64_tr_b16 a[152:153], v238 offset:16896
 ds_read_b64_tr_b16 a[154:155], v238 offset:17152
 buffer_load_dwordx4 v248, s[32:35], s65 offen lds
 v_mfma_f32_16x16x32_bf16 v[164:167], a[168:171], v[124:127], v[164:167]
 s_waitcnt lgkmcnt(6)
 v_mul_f32 v227, v203, v227
 v_cvt_pk_bf16_f32 v231, v226, v227
 v_accvgpr_write_b32 a91, v231
 v_mfma_f32_16x16x32_bf16 v[172:175], a[172:175], v[124:127], v[172:175]
 ds_read_b64_tr_b16 a[156:157], v239 offset:16896
 ds_read_b64_tr_b16 a[158:159], v239 offset:17152
 v_mfma_f32_16x16x32_bf16 v[168:171], a[172:175], v[120:123], v[168:171]
 s_waitcnt lgkmcnt(6)
 v_exp_f32 v228, v204
 v_exp_f32 v229, v205
 v_mfma_f32_16x16x32_bf16 v[144:147], a[144:147], v[128:131], v[144:147]
 ds_read_b64_tr_b16 a[160:161], v238 offset:20480
 ds_read_b64_tr_b16 a[162:163], v238 offset:20736
 v_mfma_f32_16x16x32_bf16 v[148:151], a[144:147], v[132:135], v[148:151]
 s_waitcnt lgkmcnt(6)
 v_fma_f32 v228, v228, s75, s75
 v_fma_f32 v229, v229, s75, s75
 v_mfma_f32_16x16x32_bf16 v[156:159], a[148:151], v[132:135], v[156:159]
 s_add_u32 m0, s64, 20480
 ds_read_b64_tr_b16 a[164:165], v239 offset:20480
 ds_read_b64_tr_b16 a[166:167], v239 offset:20736
 v_mfma_f32_16x16x32_bf16 v[152:155], a[148:151], v[128:131], v[152:155]
 s_waitcnt lgkmcnt(6)
 v_rcp_f32 v228, v228
 v_rcp_f32 v229, v229
 v_mfma_f32_16x16x32_bf16 v[160:163], a[152:155], v[128:131], v[160:163]
 s_mov_b32 s65, 1475584
 ds_read_b64_tr_b16 a[168:169], v238 offset:20992
 ds_read_b64_tr_b16 a[170:171], v238 offset:21248
 buffer_load_dwordx4 v248, s[32:35], s65 offen lds
 v_mfma_f32_16x16x32_bf16 v[164:167], a[152:155], v[132:135], v[164:167]
 s_waitcnt lgkmcnt(6)
 v_mul_f32 v228, v204, v228
 v_mul_f32 v229, v205, v229
 v_cvt_pk_bf16_f32 v232, v228, v229
 v_mfma_f32_16x16x32_bf16 v[172:175], a[156:159], v[132:135], v[172:175]
 ds_read_b64_tr_b16 a[172:173], v239 offset:20992
 ds_read_b64_tr_b16 a[174:175], v239 offset:21248
 v_mfma_f32_16x16x32_bf16 v[168:171], a[156:159], v[128:131], v[168:171]
 s_waitcnt lgkmcnt(6)
 v_accvgpr_write_b32 a94, v232
 v_exp_f32 v224, v206
 v_mfma_f32_16x16x32_bf16 v[144:147], a[160:163], v[136:139], v[144:147]
 s_waitcnt vmcnt(18)
 s_barrier
 ds_read_b64_tr_b16 a[144:145], v238 offset:24576
 ds_read_b64_tr_b16 a[146:147], v238 offset:24832
 v_mfma_f32_16x16x32_bf16 v[148:151], a[160:163], v[140:143], v[148:151]
 s_waitcnt lgkmcnt(6)
 v_exp_f32 v225, v207
 v_fma_f32 v224, v224, s75, s75
 v_mfma_f32_16x16x32_bf16 v[156:159], a[164:167], v[140:143], v[156:159]
 s_add_u32 m0, s64, 24576
 ds_read_b64_tr_b16 a[148:149], v239 offset:24576
 ds_read_b64_tr_b16 a[150:151], v239 offset:24832
 v_mfma_f32_16x16x32_bf16 v[152:155], a[164:167], v[136:139], v[152:155]
 s_waitcnt lgkmcnt(6)
 v_fma_f32 v225, v225, s75, s75
 v_rcp_f32 v224, v224
 v_mfma_f32_16x16x32_bf16 v[160:163], a[168:171], v[136:139], v[160:163]
 s_mov_b32 s65, 1770496
 ds_read_b64_tr_b16 a[152:153], v238 offset:25088
 ds_read_b64_tr_b16 a[154:155], v238 offset:25344
 buffer_load_dwordx4 v248, s[32:35], s65 offen lds
 v_mfma_f32_16x16x32_bf16 v[164:167], a[168:171], v[140:143], v[164:167]
 s_waitcnt lgkmcnt(6)
 v_rcp_f32 v225, v225
 v_mul_f32 v224, v206, v224
 v_mfma_f32_16x16x32_bf16 v[172:175], a[172:175], v[140:143], v[172:175]
 ds_read_b64_tr_b16 a[156:157], v239 offset:25088
 ds_read_b64_tr_b16 a[158:159], v239 offset:25344
 v_mfma_f32_16x16x32_bf16 v[168:171], a[172:175], v[136:139], v[168:171]
 s_waitcnt lgkmcnt(6)
 v_mul_f32 v225, v207, v225
 v_cvt_pk_bf16_f32 v230, v224, v225
 v_accvgpr_write_b32 a95, v230
 v_mfma_f32_16x16x32_bf16 v[176:179], a[144:147], v[0:3], 0
 s_cmp_eq_u32 s15, 6
 s_cbranch_scc1 L_hsl7
L_hsl7_ok:
 s_cmp_eq_u32 s15, 4
 s_cbranch_scc1 L_hsc7
L_hsc7_ok:
 ds_read_b64_tr_b16 a[160:161], v238 offset:28672
 ds_read_b64_tr_b16 a[162:163], v238 offset:28928
 v_mfma_f32_16x16x32_bf16 v[180:183], a[144:147], v[4:7], 0
 s_waitcnt lgkmcnt(6)
 v_mfma_f32_16x16x32_bf16 v[188:191], a[148:151], v[4:7], 0
 s_add_u32 m0, s64, 28672
 ds_read_b64_tr_b16 a[164:165], v239 offset:28672
 ds_read_b64_tr_b16 a[166:167], v239 offset:28928
 v_mfma_f32_16x16x32_bf16 v[184:187], a[148:151], v[0:3], 0
 s_waitcnt lgkmcnt(6)
 v_exp_f32 v224, v144
 v_exp_f32 v225, v145
 v_mfma_f32_16x16x32_bf16 v[192:195], a[152:155], v[0:3], 0
 s_mov_b32 s65, 2065408
 ds_read_b64_tr_b16 a[168:169], v238 offset:29184
 ds_read_b64_tr_b16 a[170:171], v238 offset:29440
 buffer_load_dwordx4 v248, s[32:35], s65 offen lds
 v_mfma_f32_16x16x32_bf16 v[196:199], a[152:155], v[4:7], 0
 s_waitcnt lgkmcnt(6)
 v_fma_f32 v224, v224, s75, s75
 v_fma_f32 v225, v225, s75, s75
 v_rcp_f32 v224, v224
 v_mfma_f32_16x16x32_bf16 v[204:207], a[156:159], v[4:7], 0
 ds_read_b64_tr_b16 a[172:173], v239 offset:29184
 ds_read_b64_tr_b16 a[174:175], v239 offset:29440
 v_mfma_f32_16x16x32_bf16 v[200:203], a[156:159], v[0:3], 0
 s_waitcnt lgkmcnt(6)
 v_rcp_f32 v225, v225
 v_mfma_f32_16x16x32_bf16 v[176:179], a[160:163], v[8:11], v[176:179]
 ds_read_b64_tr_b16 a[144:145], v238 offset:32768
 ds_read_b64_tr_b16 a[146:147], v238 offset:33024
 v_mfma_f32_16x16x32_bf16 v[180:183], a[160:163], v[12:15], v[180:183]
 s_waitcnt lgkmcnt(6)
 v_mul_f32 v224, v144, v224
 v_mul_f32 v225, v145, v225
 v_cvt_pk_bf16_f32 v230, v224, v225
 v_mfma_f32_16x16x32_bf16 v[188:191], a[164:167], v[12:15], v[188:191]
 s_add_u32 m0, s64, 32768
 ds_read_b64_tr_b16 a[148:149], v239 offset:32768
 ds_read_b64_tr_b16 a[150:151], v239 offset:33024
 v_mfma_f32_16x16x32_bf16 v[184:187], a[164:167], v[8:11], v[184:187]
 s_waitcnt lgkmcnt(6)
 v_accvgpr_write_b32 a96, v230
 v_exp_f32 v226, v146
 v_mfma_f32_16x16x32_bf16 v[192:195], a[168:171], v[8:11], v[192:195]
 s_mov_b32 s65, 2360320
 ds_read_b64_tr_b16 a[152:153], v238 offset:33280
 ds_read_b64_tr_b16 a[154:155], v238 offset:33536
 buffer_load_dwordx4 v248, s[32:35], s65 offen lds
 v_mfma_f32_16x16x32_bf16 v[196:199], a[168:171], v[12:15], v[196:199]
 s_waitcnt lgkmcnt(6)
 v_exp_f32 v227, v147
 v_fma_f32 v226, v226, s75, s75
 v_mfma_f32_16x16x32_bf16 v[204:207], a[172:175], v[12:15], v[204:207]
 ds_read_b64_tr_b16 a[156:157], v239 offset:33280
 ds_read_b64_tr_b16 a[158:159], v239 offset:33536
 v_mfma_f32_16x16x32_bf16 v[200:203], a[172:175], v[8:11], v[200:203]
 s_waitcnt lgkmcnt(6)
 v_fma_f32 v227, v227, s75, s75
 v_rcp_f32 v226, v226
 v_mfma_f32_16x16x32_bf16 v[176:179], a[144:147], v[16:19], v[176:179]
 ds_read_b64_tr_b16 a[160:161], v238 offset:36864
 ds_read_b64_tr_b16 a[162:163], v238 offset:37120
 v_mfma_f32_16x16x32_bf16 v[180:183], a[144:147], v[20:23], v[180:183]
 s_waitcnt lgkmcnt(6)
 v_rcp_f32 v227, v227
 v_mul_f32 v226, v146, v226
 v_mul_f32 v227, v147, v227
 v_mfma_f32_16x16x32_bf16 v[188:191], a[148:151], v[20:23], v[188:191]
 s_add_u32 m0, s64, 36864
 ds_read_b64_tr_b16 a[164:165], v239 offset:36864
 ds_read_b64_tr_b16 a[166:167], v239 offset:37120
 v_mfma_f32_16x16x32_bf16 v[184:187], a[148:151], v[16:19], v[184:187]
 s_waitcnt lgkmcnt(6)
 v_cvt_pk_bf16_f32 v231, v226, v227
 v_accvgpr_write_b32 a97, v231
 v_exp_f32 v228, v148
 v_mfma_f32_16x16x32_bf16 v[192:195], a[152:155], v[16:19], v[192:195]
 s_mov_b32 s65, 2655232
 ds_read_b64_tr_b16 a[168:169], v238 offset:37376
 ds_read_b64_tr_b16 a[170:171], v238 offset:37632
 buffer_load_dwordx4 v248, s[32:35], s65 offen lds
 v_mfma_f32_16x16x32_bf16 v[196:199], a[152:155], v[20:23], v[196:199]
 s_waitcnt lgkmcnt(6)
 v_exp_f32 v229, v149
 v_mfma_f32_16x16x32_bf16 v[204:207], a[156:159], v[20:23], v[204:207]
 ds_read_b64_tr_b16 a[172:173], v239 offset:37376
 ds_read_b64_tr_b16 a[174:175], v239 offset:37632
 v_mfma_f32_16x16x32_bf16 v[200:203], a[156:159], v[16:19], v[200:203]
 s_waitcnt lgkmcnt(6)
 v_fma_f32 v228, v228, s75, s75
 v_fma_f32 v229, v229, s75, s75
 v_rcp_f32 v228, v228
 v_mfma_f32_16x16x32_bf16 v[176:179], a[160:163], v[24:27], v[176:179]
 ds_read_b64_tr_b16 a[144:145], v238 offset:40960
 ds_read_b64_tr_b16 a[146:147], v238 offset:41216
 v_mfma_f32_16x16x32_bf16 v[180:183], a[160:163], v[28:31], v[180:183]
 s_waitcnt lgkmcnt(6)
 v_rcp_f32 v229, v229
 v_mfma_f32_16x16x32_bf16 v[188:191], a[164:167], v[28:31], v[188:191]
 s_add_u32 m0, s64, 40960
 ds_read_b64_tr_b16 a[148:149], v239 offset:40960
 ds_read_b64_tr_b16 a[150:151], v239 offset:41216
 v_mfma_f32_16x16x32_bf16 v[184:187], a[164:167], v[24:27], v[184:187]
 s_waitcnt lgkmcnt(6)
 v_mul_f32 v228, v148, v228
 v_mul_f32 v229, v149, v229
 v_cvt_pk_bf16_f32 v232, v228, v229
 v_accvgpr_write_b32 a100, v232
 v_mfma_f32_16x16x32_bf16 v[192:195], a[168:171], v[24:27], v[192:195]
 s_mov_b32 s65, 2950144
 ds_read_b64_tr_b16 a[152:153], v238 offset:41472
 ds_read_b64_tr_b16 a[154:155], v238 offset:41728
 buffer_load_dwordx4 v248, s[32:35], s65 offen lds
 v_mfma_f32_16x16x32_bf16 v[196:199], a[168:171], v[28:31], v[196:199]
 s_waitcnt lgkmcnt(6)
 v_exp_f32 v224, v150
 v_exp_f32 v225, v151
 v_mfma_f32_16x16x32_bf16 v[204:207], a[172:175], v[28:31], v[204:207]
 ds_read_b64_tr_b16 a[156:157], v239 offset:41472
 ds_read_b64_tr_b16 a[158:159], v239 offset:41728
 v_mfma_f32_16x16x32_bf16 v[200:203], a[172:175], v[24:27], v[200:203]
 s_waitcnt lgkmcnt(6)
 v_fma_f32 v224, v224, s75, s75
 v_fma_f32 v225, v225, s75, s75
 v_mfma_f32_16x16x32_bf16 v[176:179], a[144:147], v[32:35], v[176:179]
 ds_read_b64_tr_b16 a[160:161], v238 offset:45056
 ds_read_b64_tr_b16 a[162:163], v238 offset:45312
 v_mfma_f32_16x16x32_bf16 v[180:183], a[144:147], v[36:39], v[180:183]
 s_waitcnt lgkmcnt(6)
 v_rcp_f32 v224, v224
 v_rcp_f32 v225, v225
 v_mfma_f32_16x16x32_bf16 v[188:191], a[148:151], v[36:39], v[188:191]
 s_add_u32 m0, s64, 45056
 ds_read_b64_tr_b16 a[164:165], v239 offset:45056
 ds_read_b64_tr_b16 a[166:167], v239 offset:45312
 v_mfma_f32_16x16x32_bf16 v[184:187], a[148:151], v[32:35], v[184:187]
 s_waitcnt lgkmcnt(6)
 v_mul_f32 v224, v150, v224
 v_mul_f32 v225, v151, v225
 v_mfma_f32_16x16x32_bf16 v[192:195], a[152:155], v[32:35], v[192:195]
 s_mov_b32 s65, 3245056
 ds_read_b64_tr_b16 a[168:169], v238 offset:45568
 ds_read_b64_tr_b16 a[170:171], v238 offset:45824
 buffer_load_dwordx4 v248, s[32:35], s65 offen lds
 v_mfma_f32_16x16x32_bf16 v[196:199], a[152:155], v[36:39], v[196:199]
 s_waitcnt lgkmcnt(6)
 v_cvt_pk_bf16_f32 v230, v224, v225
 v_accvgpr_write_b32 a101, v230
 v_exp_f32 v226, v152
 v_mfma_f32_16x16x32_bf16 v[204:207], a[156:159], v[36:39], v[204:207]
 ds_read_b64_tr_b16 a[172:173], v239 offset:45568
 ds_read_b64_tr_b16 a[174:175], v239 offset:45824
 v_mfma_f32_16x16x32_bf16 v[200:203], a[156:159], v[32:35], v[200:203]
 s_waitcnt lgkmcnt(6)
 v_exp_f32 v227, v153
 v_mfma_f32_16x16x32_bf16 v[176:179], a[160:163], v[40:43], v[176:179]
 s_waitcnt vmcnt(18)
 s_barrier
 ds_read_b64_tr_b16 a[144:145], v240 offset:0
 ds_read_b64_tr_b16 a[146:147], v240 offset:256
 v_mfma_f32_16x16x32_bf16 v[180:183], a[160:163], v[44:47], v[180:183]
 s_waitcnt lgkmcnt(6)
 v_fma_f32 v226, v226, s75, s75
 v_fma_f32 v227, v227, s75, s75
 v_rcp_f32 v226, v226
 v_mfma_f32_16x16x32_bf16 v[188:191], a[164:167], v[44:47], v[188:191]
 s_add_u32 m0, s64, 49152
 ds_read_b64_tr_b16 a[148:149], v241 offset:0
 ds_read_b64_tr_b16 a[150:151], v241 offset:256
 v_mfma_f32_16x16x32_bf16 v[184:187], a[164:167], v[40:43], v[184:187]
 s_waitcnt lgkmcnt(6)
 v_rcp_f32 v227, v227
 v_mul_f32 v226, v152, v226
 v_mfma_f32_16x16x32_bf16 v[192:195], a[168:171], v[40:43], v[192:195]
 s_mov_b32 s65, 3539968
 ds_read_b64_tr_b16 a[152:153], v240 offset:512
 ds_read_b64_tr_b16 a[154:155], v240 offset:768
 buffer_load_dwordx4 v248, s[32:35], s65 offen lds
 v_mfma_f32_16x16x32_bf16 v[196:199], a[168:171], v[44:47], v[196:199]
 s_waitcnt lgkmcnt(6)
 v_mul_f32 v227, v153, v227
 v_cvt_pk_bf16_f32 v231, v226, v227
 v_accvgpr_write_b32 a98, v231
 v_mfma_f32_16x16x32_bf16 v[204:207], a[172:175], v[44:47], v[204:207]
 ds_read_b64_tr_b16 a[156:157], v241 offset:512
 ds_read_b64_tr_b16 a[158:159], v241 offset:768
 v_mfma_f32_16x16x32_bf16 v[200:203], a[172:175], v[40:43], v[200:203]
 s_waitcnt lgkmcnt(6)
 v_exp_f32 v228, v154
 v_exp_f32 v229, v155
 v_mfma_f32_16x16x32_bf16 v[176:179], a[144:147], v[48:51], v[176:179]
 ds_read_b64_tr_b16 a[160:161], v240 offset:4096
 ds_read_b64_tr_b16 a[162:163], v240 offset:4352
 v_mfma_f32_16x16x32_bf16 v[180:183], a[144:147], v[52:55], v[180:183]
 s_waitcnt lgkmcnt(6)
 v_fma_f32 v228, v228, s75, s75
 v_fma_f32 v229, v229, s75, s75
 v_mfma_f32_16x16x32_bf16 v[188:191], a[148:151], v[52:55], v[188:191]
 s_add_u32 m0, s64, 53248
 ds_read_b64_tr_b16 a[164:165], v241 offset:4096
 ds_read_b64_tr_b16 a[166:167], v241 offset:4352
 v_mfma_f32_16x16x32_bf16 v[184:187], a[148:151], v[48:51], v[184:187]
 s_waitcnt lgkmcnt(6)
 v_rcp_f32 v228, v228
 v_rcp_f32 v229, v229
 v_mfma_f32_16x16x32_bf16 v[192:195], a[152:155], v[48:51], v[192:195]
 s_mov_b32 s65, 3834880
 ds_read_b64_tr_b16 a[168:169], v240 offset:4608
 ds_read_b64_tr_b16 a[170:171], v240 offset:4864
 buffer_load_dwordx4 v248, s[32:35], s65 offen lds
 v_mfma_f32_16x16x32_bf16 v[196:199], a[152:155], v[52:55], v[196:199]
 s_waitcnt lgkmcnt(6)
 v_mul_f32 v228, v154, v228
 v_mul_f32 v229, v155, v229
 v_cvt_pk_bf16_f32 v232, v228, v229
 v_mfma_f32_16x16x32_bf16 v[204:207], a[156:159], v[52:55], v[204:207]
 ds_read_b64_tr_b16 a[172:173], v241 offset:4608
 ds_read_b64_tr_b16 a[174:175], v241 offset:4864
 v_mfma_f32_16x16x32_bf16 v[200:203], a[156:159], v[48:51], v[200:203]
 s_waitcnt lgkmcnt(6)
 v_accvgpr_write_b32 a99, v232
 v_exp_f32 v224, v156
 v_mfma_f32_16x16x32_bf16 v[176:179], a[160:163], v[56:59], v[176:179]
 ds_read_b64_tr_b16 a[144:145], v240 offset:8192
 ds_read_b64_tr_b16 a[146:147], v240 offset:8448
 v_mfma_f32_16x16x32_bf16 v[180:183], a[160:163], v[60:63], v[180:183]
 s_waitcnt lgkmcnt(6)
 v_exp_f32 v225, v157
 v_fma_f32 v224, v224, s75, s75
 v_mfma_f32_16x16x32_bf16 v[188:191], a[164:167], v[60:63], v[188:191]
 s_add_u32 m0, s64, 57344
 ds_read_b64_tr_b16 a[148:149], v241 offset:8192
 ds_read_b64_tr_b16 a[150:151], v241 offset:8448
 v_mfma_f32_16x16x32_bf16 v[184:187], a[164:167], v[56:59], v[184:187]
 s_waitcnt lgkmcnt(6)
 v_fma_f32 v225, v225, s75, s75
 v_rcp_f32 v224, v224
 v_mfma_f32_16x16x32_bf16 v[192:195], a[168:171], v[56:59], v[192:195]
 s_mov_b32 s65, 4129792
 ds_read_b64_tr_b16 a[152:153], v240 offset:8704
 ds_read_b64_tr_b16 a[154:155], v240 offset:8960
 buffer_load_dwordx4 v248, s[32:35], s65 offen lds
 v_mfma_f32_16x16x32_bf16 v[196:199], a[168:171], v[60:63], v[196:199]
 s_waitcnt lgkmcnt(6)
 v_rcp_f32 v225, v225
 v_mul_f32 v224, v156, v224
 v_mfma_f32_16x16x32_bf16 v[204:207], a[172:175], v[60:63], v[204:207]
 ds_read_b64_tr_b16 a[156:157], v241 offset:8704
 ds_read_b64_tr_b16 a[158:159], v241 offset:8960
 v_mfma_f32_16x16x32_bf16 v[200:203], a[172:175], v[56:59], v[200:203]
 s_waitcnt lgkmcnt(6)
 v_mul_f32 v225, v157, v225
 v_cvt_pk_bf16_f32 v230, v224, v225
 v_accvgpr_write_b32 a102, v230
 v_mfma_f32_16x16x32_bf16 v[176:179], a[144:147], v[64:67], v[176:179]
 ds_read_b64_tr_b16 a[160:161], v240 offset:12288
 ds_read_b64_tr_b16 a[162:163], v240 offset:12544
 v_mfma_f32_16x16x32_bf16 v[180:183], a[144:147], v[68:71], v[180:183]
 s_waitcnt lgkmcnt(6)
 v_exp_f32 v226, v158
 v_exp_f32 v227, v159
 v_mfma_f32_16x16x32_bf16 v[188:191], a[148:151], v[68:71], v[188:191]
 s_add_u32 m0, s64, 61440
 ds_read_b64_tr_b16 a[164:165], v241 offset:12288
 ds_read_b64_tr_b16 a[166:167], v241 offset:12544
 v_mfma_f32_16x16x32_bf16 v[184:187], a[148:151], v[64:67], v[184:187]
 s_waitcnt lgkmcnt(6)
 v_fma_f32 v226, v226, s75, s75
 v_fma_f32 v227, v227, s75, s75
 v_rcp_f32 v226, v226
 v_mfma_f32_16x16x32_bf16 v[192:195], a[152:155], v[64:67], v[192:195]
 s_mov_b32 s65, 4424704
 ds_read_b64_tr_b16 a[168:169], v240 offset:12800
 ds_read_b64_tr_b16 a[170:171], v240 offset:13056
 buffer_load_dwordx4 v248, s[32:35], s65 offen lds
 v_mfma_f32_16x16x32_bf16 v[196:199], a[152:155], v[68:71], v[196:199]
 s_waitcnt lgkmcnt(6)
 v_rcp_f32 v227, v227
 v_mfma_f32_16x16x32_bf16 v[204:207], a[156:159], v[68:71], v[204:207]
 ds_read_b64_tr_b16 a[172:173], v241 offset:12800
 ds_read_b64_tr_b16 a[174:175], v241 offset:13056
 v_mfma_f32_16x16x32_bf16 v[200:203], a[156:159], v[64:67], v[200:203]
 s_waitcnt lgkmcnt(6)
 v_mul_f32 v226, v158, v226
 v_mul_f32 v227, v159, v227
 v_cvt_pk_bf16_f32 v231, v226, v227
 v_mfma_f32_16x16x32_bf16 v[176:179], a[160:163], v[72:75], v[176:179]
 ds_read_b64_tr_b16 a[144:145], v240 offset:16384
 ds_read_b64_tr_b16 a[146:147], v240 offset:16640
 v_mfma_f32_16x16x32_bf16 v[180:183], a[160:163], v[76:79], v[180:183]
 s_waitcnt lgkmcnt(6)
 v_accvgpr_write_b32 a103, v231
 v_exp_f32 v228, v160
 v_mfma_f32_16x16x32_bf16 v[188:191], a[164:167], v[76:79], v[188:191]
 s_add_u32 m0, s64, 65536
 ds_read_b64_tr_b16 a[148:149], v241 offset:16384
 ds_read_b64_tr_b16 a[150:151], v241 offset:16640
 v_mfma_f32_16x16x32_bf16 v[184:187], a[164:167], v[72:75], v[184:187]
 s_waitcnt lgkmcnt(6)
 v_exp_f32 v229, v161
 v_fma_f32 v228, v228, s75, s75
 v_mfma_f32_16x16x32_bf16 v[192:195], a[168:171], v[72:75], v[192:195]
 s_mov_b32 s65, 4719616
 ds_read_b64_tr_b16 a[152:153], v240 offset:16896
 ds_read_b64_tr_b16 a[154:155], v240 offset:17152
 buffer_load_dwordx4 v248, s[32:35], s65 offen lds
 v_mfma_f32_16x16x32_bf16 v[196:199], a[168:171], v[76:79], v[196:199]
 s_waitcnt lgkmcnt(6)
 v_fma_f32 v229, v229, s75, s75
 v_rcp_f32 v228, v228
 v_mfma_f32_16x16x32_bf16 v[204:207], a[172:175], v[76:79], v[204:207]
 ds_read_b64_tr_b16 a[156:157], v241 offset:16896
 ds_read_b64_tr_b16 a[158:159], v241 offset:17152
 v_mfma_f32_16x16x32_bf16 v[200:203], a[172:175], v[72:75], v[200:203]
 s_waitcnt lgkmcnt(6)
 v_rcp_f32 v229, v229
 v_mul_f32 v228, v160, v228
 v_mul_f32 v229, v161, v229
 v_mfma_f32_16x16x32_bf16 v[176:179], a[144:147], v[80:83], v[176:179]
 ds_read_b64_tr_b16 a[160:161], v240 offset:20480
 ds_read_b64_tr_b16 a[162:163], v240 offset:20736
 v_mfma_f32_16x16x32_bf16 v[180:183], a[144:147], v[84:87], v[180:183]
 s_waitcnt lgkmcnt(6)
 v_cvt_pk_bf16_f32 v232, v228, v229
 v_accvgpr_write_b32 a104, v232
 v_exp_f32 v224, v162
 v_mfma_f32_16x16x32_bf16 v[188:191], a[148:151], v[84:87], v[188:191]
 s_add_u32 m0, s64, 69632
 ds_read_b64_tr_b16 a[164:165], v241 offset:20480
 ds_read_b64_tr_b16 a[166:167], v241 offset:20736
 v_mfma_f32_16x16x32_bf16 v[184:187], a[148:151], v[80:83], v[184:187]
 s_waitcnt lgkmcnt(6)
 v_exp_f32 v225, v163
 v_mfma_f32_16x16x32_bf16 v[192:195], a[152:155], v[80:83], v[192:195]
 s_mov_b32 s65, 5014528
 ds_read_b64_tr_b16 a[168:169], v240 offset:20992
 ds_read_b64_tr_b16 a[170:171], v240 offset:21248
 buffer_load_dwordx4 v248, s[32:35], s65 offen lds
 v_mfma_f32_16x16x32_bf16 v[196:199], a[152:155], v[84:87], v[196:199]
 s_waitcnt lgkmcnt(6)
 v_fma_f32 v224, v224, s75, s75
 v_fma_f32 v225, v225, s75, s75
 v_rcp_f32 v224, v224
 v_mfma_f32_16x16x32_bf16 v[204:207], a[156:159], v[84:87], v[204:207]
 ds_read_b64_tr_b16 a[172:173], v241 offset:20992
 ds_read_b64_tr_b16 a[174:175], v241 offset:21248
 v_mfma_f32_16x16x32_bf16 v[200:203], a[156:159], v[80:83], v[200:203]
 s_waitcnt lgkmcnt(6)
 v_rcp_f32 v225, v225
 v_mfma_f32_16x16x32_bf16 v[176:179], a[160:163], v[88:91], v[176:179]
 s_waitcnt vmcnt(18)
 s_barrier
 ds_read_b64_tr_b16 a[144:145], v240 offset:24576
 ds_read_b64_tr_b16 a[146:147], v240 offset:24832
 v_mfma_f32_16x16x32_bf16 v[180:183], a[160:163], v[92:95], v[180:183]
 s_waitcnt lgkmcnt(6)
 v_mul_f32 v224, v162, v224
 v_mul_f32 v225, v163, v225
 v_cvt_pk_bf16_f32 v230, v224, v225
 v_mfma_f32_16x16x32_bf16 v[188:191], a[164:167], v[92:95], v[188:191]
 s_add_u32 m0, s64, 73728
 ds_read_b64_tr_b16 a[148:149], v241 offset:24576
 ds_read_b64_tr_b16 a[150:151], v241 offset:24832
 v_mfma_f32_16x16x32_bf16 v[184:187], a[164:167], v[88:91], v[184:187]
 s_waitcnt lgkmcnt(6)
 v_accvgpr_write_b32 a105, v230
 v_exp_f32 v226, v164
 v_mfma_f32_16x16x32_bf16 v[192:195], a[168:171], v[88:91], v[192:195]
 s_add_u32 s65, s80, 0
 ds_read_b64_tr_b16 a[152:153], v240 offset:25088
 ds_read_b64_tr_b16 a[154:155], v240 offset:25344
 buffer_load_dwordx4 v249, s[36:39], s65 offen lds
 v_mfma_f32_16x16x32_bf16 v[196:199], a[168:171], v[92:95], v[196:199]
 s_waitcnt lgkmcnt(6)
 v_exp_f32 v227, v165
 v_fma_f32 v226, v226, s75, s75
 v_fma_f32 v227, v227, s75, s75
 v_mfma_f32_16x16x32_bf16 v[204:207], a[172:175], v[92:95], v[204:207]
 ds_read_b64_tr_b16 a[156:157], v241 offset:25088
 ds_read_b64_tr_b16 a[158:159], v241 offset:25344
 v_mfma_f32_16x16x32_bf16 v[200:203], a[172:175], v[88:91], v[200:203]
 s_waitcnt lgkmcnt(6)
 v_rcp_f32 v226, v226
 v_rcp_f32 v227, v227
 v_mfma_f32_16x16x32_bf16 v[176:179], a[144:147], v[96:99], v[176:179]
 ds_read_b64_tr_b16 a[160:161], v240 offset:28672
 ds_read_b64_tr_b16 a[162:163], v240 offset:28928
 v_mfma_f32_16x16x32_bf16 v[180:183], a[144:147], v[100:103], v[180:183]
 s_waitcnt lgkmcnt(6)
 v_mul_f32 v226, v164, v226
 v_mul_f32 v227, v165, v227
 v_mfma_f32_16x16x32_bf16 v[188:191], a[148:151], v[100:103], v[188:191]
 s_add_u32 m0, s64, 77824
 ds_read_b64_tr_b16 a[164:165], v241 offset:28672
 ds_read_b64_tr_b16 a[166:167], v241 offset:28928
 v_mfma_f32_16x16x32_bf16 v[184:187], a[148:151], v[96:99], v[184:187]
 s_waitcnt lgkmcnt(6)
 v_cvt_pk_bf16_f32 v231, v226, v227
 v_accvgpr_write_b32 a108, v231
 v_exp_f32 v228, v166
 v_mfma_f32_16x16x32_bf16 v[192:195], a[152:155], v[96:99], v[192:195]
 s_add_u32 s65, s80, 36864
 ds_read_b64_tr_b16 a[168:169], v240 offset:29184
 ds_read_b64_tr_b16 a[170:171], v240 offset:29440
 buffer_load_dwordx4 v249, s[36:39], s65 offen lds
 v_mfma_f32_16x16x32_bf16 v[196:199], a[152:155], v[100:103], v[196:199]
 s_waitcnt lgkmcnt(6)
 v_exp_f32 v229, v167
 v_mfma_f32_16x16x32_bf16 v[204:207], a[156:159], v[100:103], v[204:207]
 ds_read_b64_tr_b16 a[172:173], v241 offset:29184
 ds_read_b64_tr_b16 a[174:175], v241 offset:29440
 v_mfma_f32_16x16x32_bf16 v[200:203], a[156:159], v[96:99], v[200:203]
 s_waitcnt lgkmcnt(6)
 v_fma_f32 v228, v228, s75, s75
 v_fma_f32 v229, v229, s75, s75
 v_rcp_f32 v228, v228
 v_mfma_f32_16x16x32_bf16 v[176:179], a[160:163], v[104:107], v[176:179]
 ds_read_b64_tr_b16 a[144:145], v240 offset:32768
 ds_read_b64_tr_b16 a[146:147], v240 offset:33024
 v_mfma_f32_16x16x32_bf16 v[180:183], a[160:163], v[108:111], v[180:183]
 s_waitcnt lgkmcnt(6)
 v_rcp_f32 v229, v229
 v_mul_f32 v228, v166, v228
 v_mfma_f32_16x16x32_bf16 v[188:191], a[164:167], v[108:111], v[188:191]
 s_add_u32 m0, s64, 81920
 ds_read_b64_tr_b16 a[148:149], v241 offset:32768
 ds_read_b64_tr_b16 a[150:151], v241 offset:33024
 v_mfma_f32_16x16x32_bf16 v[184:187], a[164:167], v[104:107], v[184:187]
 s_waitcnt lgkmcnt(6)
 v_mul_f32 v229, v167, v229
 v_cvt_pk_bf16_f32 v232, v228, v229
 v_accvgpr_write_b32 a109, v232
 v_mfma_f32_16x16x32_bf16 v[192:195], a[168:171], v[104:107], v[192:195]
 s_add_u32 s65, s80, 73728
 ds_read_b64_tr_b16 a[152:153], v240 offset:33280
 ds_read_b64_tr_b16 a[154:155], v240 offset:33536
 buffer_load_dwordx4 v249, s[36:39], s65 offen lds
 v_mfma_f32_16x16x32_bf16 v[196:199], a[168:171], v[108:111], v[196:199]
 s_waitcnt lgkmcnt(6)
 v_exp_f32 v224, v168
 v_exp_f32 v225, v169
 v_mfma_f32_16x16x32_bf16 v[204:207], a[172:175], v[108:111], v[204:207]
 ds_read_b64_tr_b16 a[156:157], v241 offset:33280
 ds_read_b64_tr_b16 a[158:159], v241 offset:33536
 v_mfma_f32_16x16x32_bf16 v[200:203], a[172:175], v[104:107], v[200:203]
 s_waitcnt lgkmcnt(6)
 v_fma_f32 v224, v224, s75, s75
 v_fma_f32 v225, v225, s75, s75
 v_mfma_f32_16x16x32_bf16 v[176:179], a[144:147], v[112:115], v[176:179]
 ds_read_b64_tr_b16 a[160:161], v240 offset:36864
 ds_read_b64_tr_b16 a[162:163], v240 offset:37120
 v_mfma_f32_16x16x32_bf16 v[180:183], a[144:147], v[116:119], v[180:183]
 s_waitcnt lgkmcnt(6)
 v_rcp_f32 v224, v224
 v_rcp_f32 v225, v225
 v_mfma_f32_16x16x32_bf16 v[188:191], a[148:151], v[116:119], v[188:191]
 s_add_u32 m0, s64, 86016
 ds_read_b64_tr_b16 a[164:165], v241 offset:36864
 ds_read_b64_tr_b16 a[166:167], v241 offset:37120
 v_mfma_f32_16x16x32_bf16 v[184:187], a[148:151], v[112:115], v[184:187]
 s_waitcnt lgkmcnt(6)
 v_mul_f32 v224, v168, v224
 v_mul_f32 v225, v169, v225
 v_mfma_f32_16x16x32_bf16 v[192:195], a[152:155], v[112:115], v[192:195]
 s_add_u32 s65, s80, 110592
 ds_read_b64_tr_b16 a[168:169], v240 offset:37376
 ds_read_b64_tr_b16 a[170:171], v240 offset:37632
 buffer_load_dwordx4 v249, s[36:39], s65 offen lds
 v_mfma_f32_16x16x32_bf16 v[196:199], a[152:155], v[116:119], v[196:199]
 s_waitcnt lgkmcnt(6)
 v_cvt_pk_bf16_f32 v230, v224, v225
 v_accvgpr_write_b32 a106, v230
 v_exp_f32 v226, v170
 v_mfma_f32_16x16x32_bf16 v[204:207], a[156:159], v[116:119], v[204:207]
 ds_read_b64_tr_b16 a[172:173], v241 offset:37376
 ds_read_b64_tr_b16 a[174:175], v241 offset:37632
 v_mfma_f32_16x16x32_bf16 v[200:203], a[156:159], v[112:115], v[200:203]
 s_waitcnt lgkmcnt(6)
 v_exp_f32 v227, v171
 v_fma_f32 v226, v226, s75, s75
 v_mfma_f32_16x16x32_bf16 v[176:179], a[160:163], v[120:123], v[176:179]
 ds_read_b64_tr_b16 a[144:145], v240 offset:40960
 ds_read_b64_tr_b16 a[146:147], v240 offset:41216
 v_mfma_f32_16x16x32_bf16 v[180:183], a[160:163], v[124:127], v[180:183]
 s_waitcnt lgkmcnt(6)
 v_fma_f32 v227, v227, s75, s75
 v_rcp_f32 v226, v226
 v_mfma_f32_16x16x32_bf16 v[188:191], a[164:167], v[124:127], v[188:191]
 s_add_u32 m0, s64, 90112
 ds_read_b64_tr_b16 a[148:149], v241 offset:40960
 ds_read_b64_tr_b16 a[150:151], v241 offset:41216
 v_mfma_f32_16x16x32_bf16 v[184:187], a[164:167], v[120:123], v[184:187]
 s_waitcnt lgkmcnt(6)
 v_rcp_f32 v227, v227
 v_mul_f32 v226, v170, v226
 v_mfma_f32_16x16x32_bf16 v[192:195], a[168:171], v[120:123], v[192:195]
 s_add_u32 s65, s80, 147456
 ds_read_b64_tr_b16 a[152:153], v240 offset:41472
 ds_read_b64_tr_b16 a[154:155], v240 offset:41728
 buffer_load_dwordx4 v249, s[36:39], s65 offen lds
 v_mfma_f32_16x16x32_bf16 v[196:199], a[168:171], v[124:127], v[196:199]
 s_waitcnt lgkmcnt(6)
 v_mul_f32 v227, v171, v227
 v_cvt_pk_bf16_f32 v231, v226, v227
 v_accvgpr_write_b32 a107, v231
 v_mfma_f32_16x16x32_bf16 v[204:207], a[172:175], v[124:127], v[204:207]
 ds_read_b64_tr_b16 a[156:157], v241 offset:41472
 ds_read_b64_tr_b16 a[158:159], v241 offset:41728
 v_mfma_f32_16x16x32_bf16 v[200:203], a[172:175], v[120:123], v[200:203]
 s_waitcnt lgkmcnt(6)
 v_exp_f32 v228, v172
 v_exp_f32 v229, v173
 v_mfma_f32_16x16x32_bf16 v[176:179], a[144:147], v[128:131], v[176:179]
 ds_read_b64_tr_b16 a[160:161], v240 offset:45056
 ds_read_b64_tr_b16 a[162:163], v240 offset:45312
 v_mfma_f32_16x16x32_bf16 v[180:183], a[144:147], v[132:135], v[180:183]
 s_waitcnt lgkmcnt(6)
 v_fma_f32 v228, v228, s75, s75
 v_fma_f32 v229, v229, s75, s75
 v_mfma_f32_16x16x32_bf16 v[188:191], a[148:151], v[132:135], v[188:191]
 s_add_u32 m0, s64, 94208
 ds_read_b64_tr_b16 a[164:165], v241 offset:45056
 ds_read_b64_tr_b16 a[166:167], v241 offset:45312
 v_mfma_f32_16x16x32_bf16 v[184:187], a[148:151], v[128:131], v[184:187]
 s_waitcnt lgkmcnt(6)
 v_rcp_f32 v228, v228
 v_rcp_f32 v229, v229
 v_mfma_f32_16x16x32_bf16 v[192:195], a[152:155], v[128:131], v[192:195]
 s_add_u32 s65, s80, 184320
 ds_read_b64_tr_b16 a[168:169], v240 offset:45568
 ds_read_b64_tr_b16 a[170:171], v240 offset:45824
 buffer_load_dwordx4 v249, s[36:39], s65 offen lds
 v_mfma_f32_16x16x32_bf16 v[196:199], a[152:155], v[132:135], v[196:199]
 s_waitcnt lgkmcnt(6)
 v_mul_f32 v228, v172, v228
 v_mul_f32 v229, v173, v229
 v_cvt_pk_bf16_f32 v232, v228, v229
 v_mfma_f32_16x16x32_bf16 v[204:207], a[156:159], v[132:135], v[204:207]
 ds_read_b64_tr_b16 a[172:173], v241 offset:45568
 ds_read_b64_tr_b16 a[174:175], v241 offset:45824
 v_mfma_f32_16x16x32_bf16 v[200:203], a[156:159], v[128:131], v[200:203]
 s_waitcnt lgkmcnt(6)
 v_accvgpr_write_b32 a110, v232
 v_exp_f32 v224, v174
 v_mfma_f32_16x16x32_bf16 v[176:179], a[160:163], v[136:139], v[176:179]
 s_waitcnt vmcnt(18)
 s_barrier
 ds_read_b64_tr_b16 a[144:145], v236 offset:0
 ds_read_b64_tr_b16 a[146:147], v236 offset:256
 v_mfma_f32_16x16x32_bf16 v[180:183], a[160:163], v[140:143], v[180:183]
 s_waitcnt lgkmcnt(6)
 v_exp_f32 v225, v175
 v_fma_f32 v224, v224, s75, s75
 v_mfma_f32_16x16x32_bf16 v[188:191], a[164:167], v[140:143], v[188:191]
 s_add_u32 m0, s64, 98304
 ds_read_b64_tr_b16 a[148:149], v237 offset:0
 ds_read_b64_tr_b16 a[150:151], v237 offset:256
 v_mfma_f32_16x16x32_bf16 v[184:187], a[164:167], v[136:139], v[184:187]
 s_waitcnt lgkmcnt(6)
 v_fma_f32 v225, v225, s75, s75
 v_rcp_f32 v224, v224
 v_mfma_f32_16x16x32_bf16 v[192:195], a[168:171], v[136:139], v[192:195]
 s_add_u32 s65, s80, 221184
 ds_read_b64_tr_b16 a[152:153], v236 offset:512
 ds_read_b64_tr_b16 a[154:155], v236 offset:768
 buffer_load_dwordx4 v249, s[36:39], s65 offen lds
 v_mfma_f32_16x16x32_bf16 v[196:199], a[168:171], v[140:143], v[196:199]
 s_waitcnt lgkmcnt(6)
 v_rcp_f32 v225, v225
 v_mul_f32 v224, v174, v224
 v_mfma_f32_16x16x32_bf16 v[204:207], a[172:175], v[140:143], v[204:207]
 ds_read_b64_tr_b16 a[156:157], v237 offset:512
 ds_read_b64_tr_b16 a[158:159], v237 offset:768
 v_mfma_f32_16x16x32_bf16 v[200:203], a[172:175], v[136:139], v[200:203]
 s_waitcnt lgkmcnt(6)
 v_mul_f32 v225, v175, v225
 v_cvt_pk_bf16_f32 v230, v224, v225
 v_accvgpr_write_b32 a111, v230
 v_mfma_f32_16x16x32_bf16 v[144:147], a[144:147], v[0:3], 0
 s_cmp_eq_u32 s15, 7
 s_cbranch_scc1 L_hsl8
L_hsl8_ok:
 s_cmp_eq_u32 s15, 5
 s_cbranch_scc1 L_hsc8
L_hsc8_ok:
 ds_read_b64_tr_b16 a[160:161], v236 offset:4096
 ds_read_b64_tr_b16 a[162:163], v236 offset:4352
 v_mfma_f32_16x16x32_bf16 v[148:151], a[144:147], v[4:7], 0
 s_waitcnt lgkmcnt(6)
 v_mfma_f32_16x16x32_bf16 v[156:159], a[148:151], v[4:7], 0
 s_add_u32 m0, s64, 102400
 ds_read_b64_tr_b16 a[164:165], v237 offset:4096
 ds_read_b64_tr_b16 a[166:167], v237 offset:4352
 v_mfma_f32_16x16x32_bf16 v[152:155], a[148:151], v[0:3], 0
 s_waitcnt lgkmcnt(6)
 v_exp_f32 v224, v176
 v_exp_f32 v225, v177
 v_mfma_f32_16x16x32_bf16 v[160:163], a[152:155], v[0:3], 0
 s_add_u32 s65, s80, 258048
 ds_read_b64_tr_b16 a[168:169], v236 offset:4608
 ds_read_b64_tr_b16 a[170:171], v236 offset:4864
 buffer_load_dwordx4 v249, s[36:39], s65 offen lds
 v_mfma_f32_16x16x32_bf16 v[164:167], a[152:155], v[4:7], 0
 s_waitcnt lgkmcnt(6)
 v_fma_f32 v224, v224, s75, s75
 v_fma_f32 v225, v225, s75, s75
 v_mfma_f32_16x16x32_bf16 v[172:175], a[156:159], v[4:7], 0
 ds_read_b64_tr_b16 a[172:173], v237 offset:4608
 ds_read_b64_tr_b16 a[174:175], v237 offset:4864
 v_mfma_f32_16x16x32_bf16 v[168:171], a[156:159], v[0:3], 0
 s_waitcnt lgkmcnt(6)
 v_rcp_f32 v224, v224
 v_rcp_f32 v225, v225
 v_mfma_f32_16x16x32_bf16 v[144:147], a[160:163], v[8:11], v[144:147]
 ds_read_b64_tr_b16 a[144:145], v236 offset:8192
 ds_read_b64_tr_b16 a[146:147], v236 offset:8448
 v_mfma_f32_16x16x32_bf16 v[148:151], a[160:163], v[12:15], v[148:151]
 s_waitcnt lgkmcnt(6)
 v_mul_f32 v224, v176, v224
 v_mul_f32 v225, v177, v225
 v_mfma_f32_16x16x32_bf16 v[156:159], a[164:167], v[12:15], v[156:159]
 s_add_u32 m0, s64, 106496
 ds_read_b64_tr_b16 a[148:149], v237 offset:8192
 ds_read_b64_tr_b16 a[150:151], v237 offset:8448
 v_mfma_f32_16x16x32_bf16 v[152:155], a[164:167], v[8:11], v[152:155]
 s_waitcnt lgkmcnt(6)
 v_cvt_pk_bf16_f32 v208, v224, v225
 v_exp_f32 v226, v178
 v_mfma_f32_16x16x32_bf16 v[160:163], a[168:171], v[8:11], v[160:163]
 s_add_u32 s65, s80, 294912
 ds_read_b64_tr_b16 a[152:153], v236 offset:8704
 ds_read_b64_tr_b16 a[154:155], v236 offset:8960
 buffer_load_dwordx4 v249, s[36:39], s65 offen lds
 v_mfma_f32_16x16x32_bf16 v[164:167], a[168:171], v[12:15], v[164:167]
 s_waitcnt lgkmcnt(6)
 v_exp_f32 v227, v179
 v_fma_f32 v226, v226, s75, s75
 v_mfma_f32_16x16x32_bf16 v[172:175], a[172:175], v[12:15], v[172:175]
 ds_read_b64_tr_b16 a[156:157], v237 offset:8704
 ds_read_b64_tr_b16 a[158:159], v237 offset:8960
 v_mfma_f32_16x16x32_bf16 v[168:171], a[172:175], v[8:11], v[168:171]
 s_waitcnt lgkmcnt(6)
 v_fma_f32 v227, v227, s75, s75
 v_rcp_f32 v226, v226
 v_mfma_f32_16x16x32_bf16 v[144:147], a[144:147], v[16:19], v[144:147]
 ds_read_b64_tr_b16 a[160:161], v236 offset:12288
 ds_read_b64_tr_b16 a[162:163], v236 offset:12544
 v_mfma_f32_16x16x32_bf16 v[148:151], a[144:147], v[20:23], v[148:151]
 s_waitcnt lgkmcnt(6)
 v_rcp_f32 v227, v227
 v_mul_f32 v226, v178, v226
 v_mfma_f32_16x16x32_bf16 v[156:159], a[148:151], v[20:23], v[156:159]
 s_add_u32 m0, s64, 110592
 ds_read_b64_tr_b16 a[164:165], v237 offset:12288
 ds_read_b64_tr_b16 a[166:167], v237 offset:12544
 v_mfma_f32_16x16x32_bf16 v[152:155], a[148:151], v[16:19], v[152:155]
 s_waitcnt lgkmcnt(6)
 v_mul_f32 v227, v179, v227
 v_cvt_pk_bf16_f32 v209, v226, v227
 v_exp_f32 v228, v180
 v_mfma_f32_16x16x32_bf16 v[160:163], a[152:155], v[16:19], v[160:163]
 s_add_u32 s65, s80, 331776
 ds_read_b64_tr_b16 a[168:169], v236 offset:12800
 ds_read_b64_tr_b16 a[170:171], v236 offset:13056
 buffer_load_dwordx4 v249, s[36:39], s65 offen lds
 v_mfma_f32_16x16x32_bf16 v[164:167], a[152:155], v[20:23], v[164:167]
 s_waitcnt lgkmcnt(6)
 v_exp_f32 v229, v181
 v_mfma_f32_16x16x32_bf16 v[172:175], a[156:159], v[20:23], v[172:175]
 ds_read_b64_tr_b16 a[172:173], v237 offset:12800
 ds_read_b64_tr_b16 a[174:175], v237 offset:13056
 v_mfma_f32_16x16x32_bf16 v[168:171], a[156:159], v[16:19], v[168:171]
 s_waitcnt lgkmcnt(6)
 v_fma_f32 v228, v228, s75, s75
 v_fma_f32 v229, v229, s75, s75
 v_rcp_f32 v228, v228
 v_mfma_f32_16x16x32_bf16 v[144:147], a[160:163], v[24:27], v[144:147]
 ds_read_b64_tr_b16 a[144:145], v236 offset:16384
 ds_read_b64_tr_b16 a[146:147], v236 offset:16640
 v_mfma_f32_16x16x32_bf16 v[148:151], a[160:163], v[28:31], v[148:151]
 s_waitcnt lgkmcnt(6)
 v_rcp_f32 v229, v229
 v_mfma_f32_16x16x32_bf16 v[156:159], a[164:167], v[28:31], v[156:159]
 s_add_u32 m0, s64, 114688
 ds_read_b64_tr_b16 a[148:149], v237 offset:16384
 ds_read_b64_tr_b16 a[150:151], v237 offset:16640
 v_mfma_f32_16x16x32_bf16 v[152:155], a[164:167], v[24:27], v[152:155]
 s_waitcnt lgkmcnt(6)
 v_mul_f32 v228, v180, v228
 v_mul_f32 v229, v181, v229
 v_cvt_pk_bf16_f32 v212, v228, v229
 v_mfma_f32_16x16x32_bf16 v[160:163], a[168:171], v[24:27], v[160:163]
 s_add_u32 s65, s80, 368640
 ds_read_b64_tr_b16 a[152:153], v236 offset:16896
 ds_read_b64_tr_b16 a[154:155], v236 offset:17152
 buffer_load_dwordx4 v249, s[36:39], s65 offen lds
 v_mfma_f32_16x16x32_bf16 v[164:167], a[168:171], v[28:31], v[164:167]
 s_waitcnt lgkmcnt(6)
 v_exp_f32 v224, v182
 v_exp_f32 v225, v183
 v_mfma_f32_16x16x32_bf16 v[172:175], a[172:175], v[28:31], v[172:175]
 ds_read_b64_tr_b16 a[156:157], v237 offset:16896
 ds_read_b64_tr_b16 a[158:159], v237 offset:17152
 v_mfma_f32_16x16x32_bf16 v[168:171], a[172:175], v[24:27], v[168:171]
 s_waitcnt lgkmcnt(6)
 v_fma_f32 v224, v224, s75, s75
 v_mfma_f32_16x16x32_bf16 v[144:147], a[144:147], v[32:35], v[144:147]
 ds_read_b64_tr_b16 a[160:161], v236 offset:20480
 ds_read_b64_tr_b16 a[162:163], v236 offset:20736
 v_mfma_f32_16x16x32_bf16 v[148:151], a[144:147], v[36:39], v[148:151]
 s_waitcnt lgkmcnt(6)
 v_fma_f32 v225, v225, s75, s75
 v_rcp_f32 v224, v224
 v_mfma_f32_16x16x32_bf16 v[156:159], a[148:151], v[36:39], v[156:159]
 s_add_u32 m0, s64, 118784
 ds_read_b64_tr_b16 a[164:165], v237 offset:20480
 ds_read_b64_tr_b16 a[166:167], v237 offset:20736
 v_mfma_f32_16x16x32_bf16 v[152:155], a[148:151], v[32:35], v[152:155]
 s_waitcnt lgkmcnt(6)
 v_rcp_f32 v225, v225
 v_mul_f32 v224, v182, v224
 v_mfma_f32_16x16x32_bf16 v[160:163], a[152:155], v[32:35], v[160:163]
 s_add_u32 s65, s80, 405504
 ds_read_b64_tr_b16 a[168:169], v236 offset:20992
 ds_read_b64_tr_b16 a[170:171], v236 offset:21248
 buffer_load_dwordx4 v249, s[36:39], s65 offen lds
 v_mfma_f32_16x16x32_bf16 v[164:167], a[152:155], v[36:39], v[164:167]
 s_waitcnt lgkmcnt(6)
 v_mul_f32 v225, v183, v225
 v_cvt_pk_bf16_f32 v213, v224, v225
 v_exp_f32 v226, v184
 v_mfma_f32_16x16x32_bf16 v[172:175], a[156:159], v[36:39], v[172:175]
 ds_read_b64_tr_b16 a[172:173], v237 offset:20992
 ds_read_b64_tr_b16 a[174:175], v237 offset:21248
 v_mfma_f32_16x16x32_bf16 v[168:171], a[156:159], v[32:35], v[168:171]
 s_waitcnt lgkmcnt(6)
 v_exp_f32 v227, v185
 v_mfma_f32_16x16x32_bf16 v[144:147], a[160:163], v[40:43], v[144:147]
 s_waitcnt vmcnt(18)
 s_barrier
 ds_read_b64_tr_b16 a[144:145], v236 offset:24576
 ds_read_b64_tr_b16 a[146:147], v236 offset:24832
 v_mfma_f32_16x16x32_bf16 v[148:151], a[160:163], v[44:47], v[148:151]
 s_waitcnt lgkmcnt(6)
 v_fma_f32 v226, v226, s75, s75
 v_fma_f32 v227, v227, s75, s75
 v_rcp_f32 v226, v226
 v_mfma_f32_16x16x32_bf16 v[156:159], a[164:167], v[44:47], v[156:159]
 s_add_u32 m0, s64, 122880
 ds_read_b64_tr_b16 a[148:149], v237 offset:24576
 ds_read_b64_tr_b16 a[150:151], v237 offset:24832
 v_mfma_f32_16x16x32_bf16 v[152:155], a[164:167], v[40:43], v[152:155]
 s_waitcnt lgkmcnt(6)
 v_rcp_f32 v227, v227
 v_mfma_f32_16x16x32_bf16 v[160:163], a[168:171], v[40:43], v[160:163]
 s_add_u32 s65, s80, 442368
 ds_read_b64_tr_b16 a[152:153], v236 offset:25088
 ds_read_b64_tr_b16 a[154:155], v236 offset:25344
 buffer_load_dwordx4 v249, s[36:39], s65 offen lds
 v_mfma_f32_16x16x32_bf16 v[164:167], a[168:171], v[44:47], v[164:167]
 s_waitcnt lgkmcnt(6)
 v_mul_f32 v226, v184, v226
 v_mul_f32 v227, v185, v227
 v_cvt_pk_bf16_f32 v210, v226, v227
 v_mfma_f32_16x16x32_bf16 v[172:175], a[172:175], v[44:47], v[172:175]
 ds_read_b64_tr_b16 a[156:157], v237 offset:25088
 ds_read_b64_tr_b16 a[158:159], v237 offset:25344
 v_mfma_f32_16x16x32_bf16 v[168:171], a[172:175], v[40:43], v[168:171]
 s_waitcnt lgkmcnt(6)
 v_exp_f32 v228, v186
 v_exp_f32 v229, v187
 v_mfma_f32_16x16x32_bf16 v[144:147], a[144:147], v[48:51], v[144:147]
 ds_read_b64_tr_b16 a[160:161], v236 offset:28672
 ds_read_b64_tr_b16 a[162:163], v236 offset:28928
 v_mfma_f32_16x16x32_bf16 v[148:151], a[144:147], v[52:55], v[148:151]
 s_waitcnt lgkmcnt(6)
 v_fma_f32 v228, v228, s75, s75
 v_fma_f32 v229, v229, s75, s75
 v_mfma_f32_16x16x32_bf16 v[156:159], a[148:151], v[52:55], v[156:159]
 s_add_u32 m0, s64, 126976
 ds_read_b64_tr_b16 a[164:165], v237 offset:28672
 ds_read_b64_tr_b16 a[166:167], v237 offset:28928
 v_mfma_f32_16x16x32_bf16 v[152:155], a[148:151], v[48:51], v[152:155]
 s_waitcnt lgkmcnt(6)
 v_rcp_f32 v228, v228
 v_rcp_f32 v229, v229
 v_mfma_f32_16x16x32_bf16 v[160:163], a[152:155], v[48:51], v[160:163]
 s_add_u32 s65, s80, 479232
 ds_read_b64_tr_b16 a[168:169], v236 offset:29184
 ds_read_b64_tr_b16 a[170:171], v236 offset:29440
 buffer_load_dwordx4 v249, s[36:39], s65 offen lds
 v_mfma_f32_16x16x32_bf16 v[164:167], a[152:155], v[52:55], v[164:167]
 s_waitcnt lgkmcnt(6)
 v_mul_f32 v228, v186, v228
 v_mul_f32 v229, v187, v229
 v_mfma_f32_16x16x32_bf16 v[172:175], a[156:159], v[52:55], v[172:175]
 ds_read_b64_tr_b16 a[172:173], v237 offset:29184
 ds_read_b64_tr_b16 a[174:175], v237 offset:29440
 v_mfma_f32_16x16x32_bf16 v[168:171], a[156:159], v[48:51], v[168:171]
 s_waitcnt lgkmcnt(6)
 v_cvt_pk_bf16_f32 v211, v228, v229
 v_exp_f32 v224, v188
 v_mfma_f32_16x16x32_bf16 v[144:147], a[160:163], v[56:59], v[144:147]
 ds_read_b64_tr_b16 a[144:145], v236 offset:32768
 ds_read_b64_tr_b16 a[146:147], v236 offset:33024
 v_mfma_f32_16x16x32_bf16 v[148:151], a[160:163], v[60:63], v[148:151]
 s_waitcnt lgkmcnt(6)
 v_exp_f32 v225, v189
 v_fma_f32 v224, v224, s75, s75
 v_mfma_f32_16x16x32_bf16 v[156:159], a[164:167], v[60:63], v[156:159]
 s_add_u32 m0, s64, 131072
 ds_read_b64_tr_b16 a[148:149], v237 offset:32768
 ds_read_b64_tr_b16 a[150:151], v237 offset:33024
 v_mfma_f32_16x16x32_bf16 v[152:155], a[164:167], v[56:59], v[152:155]
 s_waitcnt lgkmcnt(6)
 v_fma_f32 v225, v225, s75, s75
 v_rcp_f32 v224, v224
 v_mfma_f32_16x16x32_bf16 v[160:163], a[168:171], v[56:59], v[160:163]
 s_add_u32 s65, s80, 516096
 ds_read_b64_tr_b16 a[152:153], v236 offset:33280
 ds_read_b64_tr_b16 a[154:155], v236 offset:33536
 buffer_load_dwordx4 v249, s[36:39], s65 offen lds
 v_mfma_f32_16x16x32_bf16 v[164:167], a[168:171], v[60:63], v[164:167]
 s_waitcnt lgkmcnt(6)
 v_rcp_f32 v225, v225
 v_mfma_f32_16x16x32_bf16 v[172:175], a[172:175], v[60:63], v[172:175]
 ds_read_b64_tr_b16 a[156:157], v237 offset:33280
 ds_read_b64_tr_b16 a[158:159], v237 offset:33536
 v_mfma_f32_16x16x32_bf16 v[168:171], a[172:175], v[56:59], v[168:171]
 s_waitcnt lgkmcnt(6)
 v_mul_f32 v224, v188, v224
 v_mul_f32 v225, v189, v225
 v_cvt_pk_bf16_f32 v214, v224, v225
 v_mfma_f32_16x16x32_bf16 v[144:147], a[144:147], v[64:67], v[144:147]
 ds_read_b64_tr_b16 a[160:161], v236 offset:36864
 ds_read_b64_tr_b16 a[162:163], v236 offset:37120
 v_mfma_f32_16x16x32_bf16 v[148:151], a[144:147], v[68:71], v[148:151]
 s_waitcnt lgkmcnt(6)
 v_exp_f32 v226, v190
 v_exp_f32 v227, v191
 v_mfma_f32_16x16x32_bf16 v[156:159], a[148:151], v[68:71], v[156:159]
 s_add_u32 m0, s64, 135168
 ds_read_b64_tr_b16 a[164:165], v237 offset:36864
 ds_read_b64_tr_b16 a[166:167], v237 offset:37120
 v_mfma_f32_16x16x32_bf16 v[152:155], a[148:151], v[64:67], v[152:155]
 s_waitcnt lgkmcnt(6)
 v_fma_f32 v226, v226, s75, s75
 v_fma_f32 v227, v227, s75, s75
 v_mfma_f32_16x16x32_bf16 v[160:163], a[152:155], v[64:67], v[160:163]
 s_add_u32 s65, s80, 552960
 ds_read_b64_tr_b16 a[168:169], v236 offset:37376
 ds_read_b64_tr_b16 a[170:171], v236 offset:37632
 buffer_load_dwordx4 v249, s[36:39], s65 offen lds
 v_mfma_f32_16x16x32_bf16 v[164:167], a[152:155], v[68:71], v[164:167]
 s_waitcnt lgkmcnt(6)
 v_rcp_f32 v226, v226
 v_rcp_f32 v227, v227
 v_mfma_f32_16x16x32_bf16 v[172:175], a[156:159], v[68:71], v[172:175]
 ds_read_b64_tr_b16 a[172:173], v237 offset:37376
 ds_read_b64_tr_b16 a[174:175], v237 offset:37632
 v_mfma_f32_16x16x32_bf16 v[168:171], a[156:159], v[64:67], v[168:171]
 s_waitcnt lgkmcnt(6)
 v_mul_f32 v226, v190, v226
 v_mul_f32 v227, v191, v227
 v_mfma_f32_16x16x32_bf16 v[144:147], a[160:163], v[72:75], v[144:147]
 ds_read_b64_tr_b16 a[144:145], v236 offset:40960
 ds_read_b64_tr_b16 a[146:147], v236 offset:41216
 v_mfma_f32_16x16x32_bf16 v[148:151], a[160:163], v[76:79], v[148:151]
 s_waitcnt lgkmcnt(6)
 v_cvt_pk_bf16_f32 v215, v226, v227
 v_exp_f32 v228, v192
 v_mfma_f32_16x16x32_bf16 v[156:159], a[164:167], v[76:79], v[156:159]
 s_add_u32 m0, s64, 139264
 ds_read_b64_tr_b16 a[148:149], v237 offset:40960
 ds_read_b64_tr_b16 a[150:151], v237 offset:41216
 v_mfma_f32_16x16x32_bf16 v[152:155], a[164:167], v[72:75], v[152:155]
 s_waitcnt lgkmcnt(6)
 v_exp_f32 v229, v193
 v_fma_f32 v228, v228, s75, s75
 v_mfma_f32_16x16x32_bf16 v[160:163], a[168:171], v[72:75], v[160:163]
 s_add_u32 s65, s80, 589824
 ds_read_b64_tr_b16 a[152:153], v236 offset:41472
 ds_read_b64_tr_b16 a[154:155], v236 offset:41728
 buffer_load_dwordx4 v249, s[36:39], s65 offen lds
 v_mfma_f32_16x16x32_bf16 v[164:167], a[168:171], v[76:79], v[164:167]
 s_waitcnt lgkmcnt(6)
 v_fma_f32 v229, v229, s75, s75
 v_rcp_f32 v228, v228
 v_mfma_f32_16x16x32_bf16 v[172:175], a[172:175], v[76:79], v[172:175]
 ds_read_b64_tr_b16 a[156:157], v237 offset:41472
 ds_read_b64_tr_b16 a[158:159], v237 offset:41728
 v_mfma_f32_16x16x32_bf16 v[168:171], a[172:175], v[72:75], v[168:171]
 s_waitcnt lgkmcnt(6)
 v_rcp_f32 v229, v229
 v_mul_f32 v228, v192, v228
 v_mfma_f32_16x16x32_bf16 v[144:147], a[144:147], v[80:83], v[144:147]
 ds_read_b64_tr_b16 a[160:161], v236 offset:45056
 ds_read_b64_tr_b16 a[162:163], v236 offset:45312
 v_mfma_f32_16x16x32_bf16 v[148:151], a[144:147], v[84:87], v[148:151]
 s_waitcnt lgkmcnt(6)
 v_mul_f32 v229, v193, v229
 v_cvt_pk_bf16_f32 v216, v228, v229
 v_exp_f32 v224, v194
 v_mfma_f32_16x16x32_bf16 v[156:159], a[148:151], v[84:87], v[156:159]
 s_add_u32 m0, s64, 143360
 ds_read_b64_tr_b16 a[164:165], v237 offset:45056
 ds_read_b64_tr_b16 a[166:167], v237 offset:45312
 v_mfma_f32_16x16x32_bf16 v[152:155], a[148:151], v[80:83], v[152:155]
 s_waitcnt lgkmcnt(6)
 v_exp_f32 v225, v195
 v_mfma_f32_16x16x32_bf16 v[160:163], a[152:155], v[80:83], v[160:163]
 s_add_u32 s65, s80, 626688
 ds_read_b64_tr_b16 a[168:169], v236 offset:45568
 ds_read_b64_tr_b16 a[170:171], v236 offset:45824
 buffer_load_dwordx4 v249, s[36:39], s65 offen lds
 v_mfma_f32_16x16x32_bf16 v[164:167], a[152:155], v[84:87], v[164:167]
 s_waitcnt lgkmcnt(6)
 v_fma_f32 v224, v224, s75, s75
 v_fma_f32 v225, v225, s75, s75
 v_rcp_f32 v224, v224
 v_mfma_f32_16x16x32_bf16 v[172:175], a[156:159], v[84:87], v[172:175]
 ds_read_b64_tr_b16 a[172:173], v237 offset:45568
 ds_read_b64_tr_b16 a[174:175], v237 offset:45824
 v_mfma_f32_16x16x32_bf16 v[168:171], a[156:159], v[80:83], v[168:171]
 s_waitcnt lgkmcnt(6)
 v_rcp_f32 v225, v225
 v_mfma_f32_16x16x32_bf16 v[144:147], a[160:163], v[88:91], v[144:147]
 s_waitcnt vmcnt(18)
 s_barrier
 ds_read_b64_tr_b16 a[144:145], v238 offset:0
 ds_read_b64_tr_b16 a[146:147], v238 offset:256
 v_mfma_f32_16x16x32_bf16 v[148:151], a[160:163], v[92:95], v[148:151]
 s_waitcnt lgkmcnt(6)
 v_mul_f32 v224, v194, v224
 v_mul_f32 v225, v195, v225
 v_mfma_f32_16x16x32_bf16 v[156:159], a[164:167], v[92:95], v[156:159]
 s_add_u32 m0, s64, 0
 ds_read_b64_tr_b16 a[148:149], v239 offset:0
 ds_read_b64_tr_b16 a[150:151], v239 offset:256
 v_mfma_f32_16x16x32_bf16 v[152:155], a[164:167], v[88:91], v[152:155]
 s_waitcnt lgkmcnt(6)
 v_cvt_pk_bf16_f32 v217, v224, v225
 v_exp_f32 v226, v196
 v_mfma_f32_16x16x32_bf16 v[160:163], a[168:171], v[88:91], v[160:163]
 s_add_u32 s65, s81, 0
 ds_read_b64_tr_b16 a[152:153], v238 offset:512
 ds_read_b64_tr_b16 a[154:155], v238 offset:768
 buffer_load_dwordx4 v249, s[36:39], s65 offen lds
 v_mfma_f32_16x16x32_bf16 v[164:167], a[168:171], v[92:95], v[164:167]
 s_waitcnt lgkmcnt(6)
 v_exp_f32 v227, v197
 v_fma_f32 v226, v226, s75, s75
 v_mfma_f32_16x16x32_bf16 v[172:175], a[172:175], v[92:95], v[172:175]
 ds_read_b64_tr_b16 a[156:157], v239 offset:512
 ds_read_b64_tr_b16 a[158:159], v239 offset:768
 v_mfma_f32_16x16x32_bf16 v[168:171], a[172:175], v[88:91], v[168:171]
 s_waitcnt lgkmcnt(6)
 v_fma_f32 v227, v227, s75, s75
 v_rcp_f32 v226, v226
 v_mfma_f32_16x16x32_bf16 v[144:147], a[144:147], v[96:99], v[144:147]
 ds_read_b64_tr_b16 a[160:161], v238 offset:4096
 ds_read_b64_tr_b16 a[162:163], v238 offset:4352
 v_mfma_f32_16x16x32_bf16 v[148:151], a[144:147], v[100:103], v[148:151]
 s_waitcnt lgkmcnt(6)
 v_rcp_f32 v227, v227
 v_mul_f32 v226, v196, v226
 v_mfma_f32_16x16x32_bf16 v[156:159], a[148:151], v[100:103], v[156:159]
 s_add_u32 m0, s64, 4096
 ds_read_b64_tr_b16 a[164:165], v239 offset:4096
 ds_read_b64_tr_b16 a[166:167], v239 offset:4352
 v_mfma_f32_16x16x32_bf16 v[152:155], a[148:151], v[96:99], v[152:155]
 s_waitcnt lgkmcnt(6)
 v_mul_f32 v227, v197, v227
 v_cvt_pk_bf16_f32 v220, v226, v227
 v_exp_f32 v228, v198
 v_mfma_f32_16x16x32_bf16 v[160:163], a[152:155], v[96:99], v[160:163]
 s_add_u32 s65, s81, 36864
 ds_read_b64_tr_b16 a[168:169], v238 offset:4608
 ds_read_b64_tr_b16 a[170:171], v238 offset:4864
 buffer_load_dwordx4 v249, s[36:39], s65 offen lds
 v_mfma_f32_16x16x32_bf16 v[164:167], a[152:155], v[100:103], v[164:167]
 s_waitcnt lgkmcnt(6)
 v_exp_f32 v229, v199
 v_mfma_f32_16x16x32_bf16 v[172:175], a[156:159], v[100:103], v[172:175]
 ds_read_b64_tr_b16 a[172:173], v239 offset:4608
 ds_read_b64_tr_b16 a[174:175], v239 offset:4864
 v_mfma_f32_16x16x32_bf16 v[168:171], a[156:159], v[96:99], v[168:171]
 s_waitcnt lgkmcnt(6)
 v_fma_f32 v228, v228, s75, s75
 v_fma_f32 v229, v229, s75, s75
 v_rcp_f32 v228, v228
 v_mfma_f32_16x16x32_bf16 v[144:147], a[160:163], v[104:107], v[144:147]
 ds_read_b64_tr_b16 a[144:145], v238 offset:8192
 ds_read_b64_tr_b16 a[146:147], v238 offset:8448
 v_mfma_f32_16x16x32_bf16 v[148:151], a[160:163], v[108:111], v[148:151]
 s_waitcnt lgkmcnt(6)
 v_rcp_f32 v229, v229
 v_mfma_f32_16x16x32_bf16 v[156:159], a[164:167], v[108:111], v[156:159]
 s_add_u32 m0, s64, 8192
 ds_read_b64_tr_b16 a[148:149], v239 offset:8192
 ds_read_b64_tr_b16 a[150:151], v239 offset:8448
 v_mfma_f32_16x16x32_bf16 v[152:155], a[164:167], v[104:107], v[152:155]
 s_waitcnt lgkmcnt(6)
 v_mul_f32 v228, v198, v228
 v_mul_f32 v229, v199, v229
 v_cvt_pk_bf16_f32 v221, v228, v229
 v_mfma_f32_16x16x32_bf16 v[160:163], a[168:171], v[104:107], v[160:163]
 s_add_u32 s65, s81, 73728
 ds_read_b64_tr_b16 a[152:153], v238 offset:8704
 ds_read_b64_tr_b16 a[154:155], v238 offset:8960
 buffer_load_dwordx4 v249, s[36:39], s65 offen lds
 v_mfma_f32_16x16x32_bf16 v[164:167], a[168:171], v[108:111], v[164:167]
 s_waitcnt lgkmcnt(6)
 v_exp_f32 v224, v200
 v_exp_f32 v225, v201
 v_mfma_f32_16x16x32_bf16 v[172:175], a[172:175], v[108:111], v[172:175]
 ds_read_b64_tr_b16 a[156:157], v239 offset:8704
 ds_read_b64_tr_b16 a[158:159], v239 offset:8960
 v_mfma_f32_16x16x32_bf16 v[168:171], a[172:175], v[104:107], v[168:171]
 s_waitcnt lgkmcnt(6)
 v_fma_f32 v224, v224, s75, s75
 v_fma_f32 v225, v225, s75, s75
 v_mfma_f32_16x16x32_bf16 v[144:147], a[144:147], v[112:115], v[144:147]
 ds_read_b64_tr_b16 a[160:161], v238 offset:12288
 ds_read_b64_tr_b16 a[162:163], v238 offset:12544
 v_mfma_f32_16x16x32_bf16 v[148:151], a[144:147], v[116:119], v[148:151]
 s_waitcnt lgkmcnt(6)
 v_rcp_f32 v224, v224
 v_rcp_f32 v225, v225
 v_mfma_f32_16x16x32_bf16 v[156:159], a[148:151], v[116:119], v[156:159]
 s_add_u32 m0, s64, 12288
 ds_read_b64_tr_b16 a[164:165], v239 offset:12288
 ds_read_b64_tr_b16 a[166:167], v239 offset:12544
 v_mfma_f32_16x16x32_bf16 v[152:155], a[148:151], v[112:115], v[152:155]
 s_waitcnt lgkmcnt(6)
 v_mul_f32 v224, v200, v224
 v_mfma_f32_16x16x32_bf16 v[160:163], a[152:155], v[112:115], v[160:163]
 s_add_u32 s65, s81, 110592
 ds_read_b64_tr_b16 a[168:169], v238 offset:12800
 ds_read_b64_tr_b16 a[170:171], v238 offset:13056
 buffer_load_dwordx4 v249, s[36:39], s65 offen lds
 v_mfma_f32_16x16x32_bf16 v[164:167], a[152:155], v[116:119], v[164:167]
 s_waitcnt lgkmcnt(6)
 v_mul_f32 v225, v201, v225
 v_cvt_pk_bf16_f32 v218, v224, v225
 v_exp_f32 v226, v202
 v_mfma_f32_16x16x32_bf16 v[172:175], a[156:159], v[116:119], v[172:175]
 ds_read_b64_tr_b16 a[172:173], v239 offset:12800
 ds_read_b64_tr_b16 a[174:175], v239 offset:13056
 v_mfma_f32_16x16x32_bf16 v[168:171], a[156:159], v[112:115], v[168:171]
 s_waitcnt lgkmcnt(6)
 v_exp_f32 v227, v203
 v_mfma_f32_16x16x32_bf16 v[144:147], a[160:163], v[120:123], v[144:147]
 ds_read_b64_tr_b16 a[144:145], v238 offset:16384
 ds_read_b64_tr_b16 a[146:147], v238 offset:16640
 v_mfma_f32_16x16x32_bf16 v[148:151], a[160:163], v[124:127], v[148:151]
 s_waitcnt lgkmcnt(6)
 v_fma_f32 v226, v226, s75, s75
 v_fma_f32 v227, v227, s75, s75
 v_rcp_f32 v226, v226
 v_mfma_f32_16x16x32_bf16 v[156:159], a[164:167], v[124:127], v[156:159]
 s_add_u32 m0, s64, 16384
 ds_read_b64_tr_b16 a[148:149], v239 offset:16384
 ds_read_b64_tr_b16 a[150:151], v239 offset:16640
 v_mfma_f32_16x16x32_bf16 v[152:155], a[164:167], v[120:123], v[152:155]
 s_waitcnt lgkmcnt(6)
 v_rcp_f32 v227, v227
 v_mfma_f32_16x16x32_bf16 v[160:163], a[168:171], v[120:123], v[160:163]
 s_add_u32 s65, s81, 147456
 ds_read_b64_tr_b16 a[152:153], v238 offset:16896
 ds_read_b64_tr_b16 a[154:155], v238 offset:17152
 buffer_load_dwordx4 v249, s[36:39], s65 offen lds
 v_mfma_f32_16x16x32_bf16 v[164:167], a[168:171], v[124:127], v[164:167]
 s_waitcnt lgkmcnt(6)
 v_mul_f32 v226, v202, v226
 v_mul_f32 v227, v203, v227
 v_cvt_pk_bf16_f32 v219, v226, v227
 v_mfma_f32_16x16x32_bf16 v[172:175], a[172:175], v[124:127], v[172:175]
 ds_read_b64_tr_b16 a[156:157], v239 offset:16896
 ds_read_b64_tr_b16 a[158:159], v239 offset:17152
 v_mfma_f32_16x16x32_bf16 v[168:171], a[172:175], v[120:123], v[168:171]
 s_waitcnt lgkmcnt(6)
 v_exp_f32 v228, v204
 v_exp_f32 v229, v205
 v_mfma_f32_16x16x32_bf16 v[144:147], a[144:147], v[128:131], v[144:147]
 ds_read_b64_tr_b16 a[160:161], v238 offset:20480
 ds_read_b64_tr_b16 a[162:163], v238 offset:20736
 v_mfma_f32_16x16x32_bf16 v[148:151], a[144:147], v[132:135], v[148:151]
 s_waitcnt lgkmcnt(6)
 v_fma_f32 v228, v228, s75, s75
 v_fma_f32 v229, v229, s75, s75
 v_mfma_f32_16x16x32_bf16 v[156:159], a[148:151], v[132:135], v[156:159]
 s_add_u32 m0, s64, 20480
 ds_read_b64_tr_b16 a[164:165], v239 offset:20480
 ds_read_b64_tr_b16 a[166:167], v239 offset:20736
 v_mfma_f32_16x16x32_bf16 v[152:155], a[148:151], v[128:131], v[152:155]
 s_waitcnt lgkmcnt(6)
 v_rcp_f32 v228, v228
 v_rcp_f32 v229, v229
 v_mfma_f32_16x16x32_bf16 v[160:163], a[152:155], v[128:131], v[160:163]
 s_add_u32 s65, s81, 184320
 ds_read_b64_tr_b16 a[168:169], v238 offset:20992
 ds_read_b64_tr_b16 a[170:171], v238 offset:21248
 buffer_load_dwordx4 v249, s[36:39], s65 offen lds
 v_mfma_f32_16x16x32_bf16 v[164:167], a[152:155], v[132:135], v[164:167]
 s_waitcnt lgkmcnt(6)
 v_mul_f32 v228, v204, v228
 v_mul_f32 v229, v205, v229
 v_mfma_f32_16x16x32_bf16 v[172:175], a[156:159], v[132:135], v[172:175]
 ds_read_b64_tr_b16 a[172:173], v239 offset:20992
 ds_read_b64_tr_b16 a[174:175], v239 offset:21248
 v_mfma_f32_16x16x32_bf16 v[168:171], a[156:159], v[128:131], v[168:171]
 s_waitcnt lgkmcnt(6)
 v_cvt_pk_bf16_f32 v222, v228, v229
 v_exp_f32 v224, v206
 v_mfma_f32_16x16x32_bf16 v[144:147], a[160:163], v[136:139], v[144:147]
 s_waitcnt vmcnt(18)
 s_barrier
 ds_read_b64_tr_b16 a[144:145], v244 offset:24576
 ds_read_b64_tr_b16 a[146:147], v244 offset:26624
 v_mfma_f32_16x16x32_bf16 v[148:151], a[160:163], v[140:143], v[148:151]
 s_waitcnt lgkmcnt(6)
 v_exp_f32 v225, v207
 v_fma_f32 v224, v224, s75, s75
 v_mfma_f32_16x16x32_bf16 v[156:159], a[164:167], v[140:143], v[156:159]
 s_add_u32 m0, s64, 24576
 ds_read_b64_tr_b16 a[148:149], v245 offset:24576
 ds_read_b64_tr_b16 a[150:151], v245 offset:26624
 v_mfma_f32_16x16x32_bf16 v[152:155], a[164:167], v[136:139], v[152:155]
 s_waitcnt lgkmcnt(6)
 v_fma_f32 v225, v225, s75, s75
 v_rcp_f32 v224, v224
 v_mfma_f32_16x16x32_bf16 v[160:163], a[168:171], v[136:139], v[160:163]
 s_add_u32 s65, s81, 221184
 ds_read_b64_tr_b16 a[152:153], v244 offset:25088
 ds_read_b64_tr_b16 a[154:155], v244 offset:27136
 buffer_load_dwordx4 v249, s[36:39], s65 offen lds
 v_mfma_f32_16x16x32_bf16 v[164:167], a[168:171], v[140:143], v[164:167]
 s_waitcnt lgkmcnt(6)
 v_rcp_f32 v225, v225
 v_mul_f32 v224, v206, v224
 v_mfma_f32_16x16x32_bf16 v[172:175], a[172:175], v[140:143], v[172:175]
 ds_read_b64_tr_b16 a[156:157], v245 offset:25088
 ds_read_b64_tr_b16 a[158:159], v245 offset:27136
 v_mfma_f32_16x16x32_bf16 v[168:171], a[172:175], v[136:139], v[168:171]
 s_waitcnt lgkmcnt(6)
 v_mul_f32 v225, v207, v225
 v_cvt_pk_bf16_f32 v223, v224, v225
 v_mfma_f32_16x16x32_bf16 v[176:179], a[144:147], a[0:3], 0
 s_cmp_eq_u32 s15, 6
 s_cbranch_scc1 L_hsc9
L_hsc9_ok:
 ds_read_b64_tr_b16 a[160:161], v244 offset:28672
 ds_read_b64_tr_b16 a[162:163], v244 offset:30720
 v_mfma_f32_16x16x32_bf16 v[180:183], a[144:147], a[4:7], 0
 s_waitcnt lgkmcnt(6)
 v_mfma_f32_16x16x32_bf16 v[188:191], a[148:151], a[4:7], 0
 s_add_u32 m0, s64, 28672
 ds_read_b64_tr_b16 a[164:165], v245 offset:28672
 ds_read_b64_tr_b16 a[166:167], v245 offset:30720
 v_mfma_f32_16x16x32_bf16 v[184:187], a[148:151], a[0:3], 0
 s_waitcnt lgkmcnt(6)
 v_exp_f32 v224, v144
 v_exp_f32 v225, v145
 v_mfma_f32_16x16x32_bf16 v[192:195], a[152:155], a[0:3], 0
 s_add_u32 s65, s81, 258048
 ds_read_b64_tr_b16 a[168:169], v244 offset:29184
 ds_read_b64_tr_b16 a[170:171], v244 offset:31232
 buffer_load_dwordx4 v249, s[36:39], s65 offen lds
 v_mfma_f32_16x16x32_bf16 v[196:199], a[152:155], a[4:7], 0
 s_waitcnt lgkmcnt(6)
 v_fma_f32 v224, v224, s75, s75
 v_fma_f32 v225, v225, s75, s75
 v_rcp_f32 v224, v224
 v_mfma_f32_16x16x32_bf16 v[204:207], a[156:159], a[4:7], 0
 ds_read_b64_tr_b16 a[172:173], v245 offset:29184
 ds_read_b64_tr_b16 a[174:175], v245 offset:31232
 v_mfma_f32_16x16x32_bf16 v[200:203], a[156:159], a[0:3], 0
 s_waitcnt lgkmcnt(6)
 v_rcp_f32 v225, v225
 v_mfma_f32_16x16x32_bf16 v[176:179], a[160:163], a[8:11], v[176:179]
 ds_read_b64_tr_b16 a[144:145], v244 offset:32768
 ds_read_b64_tr_b16 a[146:147], v244 offset:34816
 v_mfma_f32_16x16x32_bf16 v[180:183], a[160:163], a[12:15], v[180:183]
 s_waitcnt lgkmcnt(6)
 v_mul_f32 v224, v144, v224
 v_mul_f32 v225, v145, v225
 v_cvt_pk_bf16_f32 v0, v224, v225
 v_mfma_f32_16x16x32_bf16 v[188:191], a[164:167], a[12:15], v[188:191]
 s_add_u32 m0, s64, 32768
 ds_read_b64_tr_b16 a[148:149], v245 offset:32768
 ds_read_b64_tr_b16 a[150:151], v245 offset:34816
 v_mfma_f32_16x16x32_bf16 v[184:187], a[164:167], a[8:11], v[184:187]
 s_waitcnt lgkmcnt(6)
 v_exp_f32 v226, v146
 v_exp_f32 v227, v147
 v_mfma_f32_16x16x32_bf16 v[192:195], a[168:171], a[8:11], v[192:195]
 s_add_u32 s65, s81, 294912
 ds_read_b64_tr_b16 a[152:153], v244 offset:33280
 ds_read_b64_tr_b16 a[154:155], v244 offset:35328
 buffer_load_dwordx4 v249, s[36:39], s65 offen lds
 v_mfma_f32_16x16x32_bf16 v[196:199], a[168:171], a[12:15], v[196:199]
 s_waitcnt lgkmcnt(6)
 v_fma_f32 v226, v226, s75, s75
 v_fma_f32 v227, v227, s75, s75
 v_rcp_f32 v226, v226
 v_mfma_f32_16x16x32_bf16 v[204:207], a[172:175], a[12:15], v[204:207]
 ds_read_b64_tr_b16 a[156:157], v245 offset:33280
 ds_read_b64_tr_b16 a[158:159], v245 offset:35328
 v_mfma_f32_16x16x32_bf16 v[200:203], a[172:175], a[8:11], v[200:203]
 s_waitcnt lgkmcnt(6)
 v_rcp_f32 v227, v227
 v_mfma_f32_16x16x32_bf16 v[176:179], a[144:147], a[16:19], v[176:179]
 ds_read_b64_tr_b16 a[160:161], v244 offset:36864
 ds_read_b64_tr_b16 a[162:163], v244 offset:38912
 v_mfma_f32_16x16x32_bf16 v[180:183], a[144:147], a[20:23], v[180:183]
 s_waitcnt lgkmcnt(6)
 v_mul_f32 v226, v146, v226
 v_mul_f32 v227, v147, v227
 v_cvt_pk_bf16_f32 v1, v226, v227
 v_mfma_f32_16x16x32_bf16 v[188:191], a[148:151], a[20:23], v[188:191]
 s_add_u32 m0, s64, 36864
 ds_read_b64_tr_b16 a[164:165], v245 offset:36864
 ds_read_b64_tr_b16 a[166:167], v245 offset:38912
 v_mfma_f32_16x16x32_bf16 v[184:187], a[148:151], a[16:19], v[184:187]
 s_waitcnt lgkmcnt(6)
 v_exp_f32 v228, v148
 v_exp_f32 v229, v149
 v_mfma_f32_16x16x32_bf16 v[192:195], a[152:155], a[16:19], v[192:195]
 s_add_u32 s65, s81, 331776
 ds_read_b64_tr_b16 a[168:169], v244 offset:37376
 ds_read_b64_tr_b16 a[170:171], v244 offset:39424
 buffer_load_dwordx4 v249, s[36:39], s65 offen lds
 v_mfma_f32_16x16x32_bf16 v[196:199], a[152:155], a[20:23], v[196:199]
 s_waitcnt lgkmcnt(6)
 v_fma_f32 v228, v228, s75, s75
 v_fma_f32 v229, v229, s75, s75
 v_mfma_f32_16x16x32_bf16 v[204:207], a[156:159], a[20:23], v[204:207]
 ds_read_b64_tr_b16 a[172:173], v245 offset:37376
 ds_read_b64_tr_b16 a[174:175], v245 offset:39424
 v_mfma_f32_16x16x32_bf16 v[200:203], a[156:159], a[16:19], v[200:203]
 s_waitcnt lgkmcnt(6)
 v_rcp_f32 v228, v228
 v_rcp_f32 v229, v229
 v_mfma_f32_16x16x32_bf16 v[176:179], a[160:163], a[24:27], v[176:179]
 ds_read_b64_tr_b16 a[144:145], v244 offset:40960
 ds_read_b64_tr_b16 a[146:147], v244 offset:43008
 v_mfma_f32_16x16x32_bf16 v[180:183], a[160:163], a[28:31], v[180:183]
 s_waitcnt lgkmcnt(6)
 v_mul_f32 v228, v148, v228
 v_mul_f32 v229, v149, v229
 v_cvt_pk_bf16_f32 v4, v228, v229
 v_mfma_f32_16x16x32_bf16 v[188:191], a[164:167], a[28:31], v[188:191]
 s_add_u32 m0, s64, 40960
 ds_read_b64_tr_b16 a[148:149], v245 offset:40960
 ds_read_b64_tr_b16 a[150:151], v245 offset:43008
 v_mfma_f32_16x16x32_bf16 v[184:187], a[164:167], a[24:27], v[184:187]
 s_waitcnt lgkmcnt(6)
 v_exp_f32 v224, v150
 v_exp_f32 v225, v151
 v_mfma_f32_16x16x32_bf16 v[192:195], a[168:171], a[24:27], v[192:195]
 s_add_u32 s65, s81, 368640
 ds_read_b64_tr_b16 a[152:153], v244 offset:41472
 ds_read_b64_tr_b16 a[154:155], v244 offset:43520
 buffer_load_dwordx4 v249, s[36:39], s65 offen lds
 v_mfma_f32_16x16x32_bf16 v[196:199], a[168:171], a[28:31], v[196:199]
 s_waitcnt lgkmcnt(6)
 v_fma_f32 v224, v224, s75, s75
 v_fma_f32 v225, v225, s75, s75
 v_mfma_f32_16x16x32_bf16 v[204:207], a[172:175], a[28:31], v[204:207]
 ds_read_b64_tr_b16 a[156:157], v245 offset:41472
 ds_read_b64_tr_b16 a[158:159], v245 offset:43520
 v_mfma_f32_16x16x32_bf16 v[200:203], a[172:175], a[24:27], v[200:203]
 s_waitcnt lgkmcnt(6)
 v_rcp_f32 v224, v224
 v_rcp_f32 v225, v225
 v_mfma_f32_16x16x32_bf16 v[176:179], a[144:147], a[32:35], v[176:179]
 ds_read_b64_tr_b16 a[160:161], v244 offset:45056
 ds_read_b64_tr_b16 a[162:163], v244 offset:47104
 v_mfma_f32_16x16x32_bf16 v[180:183], a[144:147], a[36:39], v[180:183]
 s_waitcnt lgkmcnt(6)
 v_mul_f32 v224, v150, v224
 v_mul_f32 v225, v151, v225
 v_cvt_pk_bf16_f32 v5, v224, v225
 v_mfma_f32_16x16x32_bf16 v[188:191], a[148:151], a[36:39], v[188:191]
 s_add_u32 m0, s64, 45056
 ds_read_b64_tr_b16 a[164:165], v245 offset:45056
 ds_read_b64_tr_b16 a[166:167], v245 offset:47104
 v_mfma_f32_16x16x32_bf16 v[184:187], a[148:151], a[32:35], v[184:187]
 s_waitcnt lgkmcnt(6)
 v_exp_f32 v226, v152
 v_exp_f32 v227, v153
 v_mfma_f32_16x16x32_bf16 v[192:195], a[152:155], a[32:35], v[192:195]
 s_add_u32 s65, s81, 405504
 ds_read_b64_tr_b16 a[168:169], v244 offset:45568
 ds_read_b64_tr_b16 a[170:171], v244 offset:47616
 buffer_load_dwordx4 v249, s[36:39], s65 offen lds
 v_mfma_f32_16x16x32_bf16 v[196:199], a[152:155], a[36:39], v[196:199]
 s_waitcnt lgkmcnt(6)
 v_fma_f32 v226, v226, s75, s75
 v_fma_f32 v227, v227, s75, s75
 v_mfma_f32_16x16x32_bf16 v[204:207], a[156:159], a[36:39], v[204:207]
 ds_read_b64_tr_b16 a[172:173], v245 offset:45568
 ds_read_b64_tr_b16 a[174:175], v245 offset:47616
 v_mfma_f32_16x16x32_bf16 v[200:203], a[156:159], a[32:35], v[200:203]
 s_waitcnt lgkmcnt(6)
 v_rcp_f32 v226, v226
 v_rcp_f32 v227, v227
 v_mfma_f32_16x16x32_bf16 v[176:179], a[160:163], a[40:43], v[176:179]
 s_waitcnt vmcnt(18)
 s_barrier
 ds_read_b64_tr_b16 a[144:145], v246 offset:0
 ds_read_b64_tr_b16 a[146:147], v246 offset:2048
 v_mfma_f32_16x16x32_bf16 v[180:183], a[160:163], a[44:47], v[180:183]
 s_waitcnt lgkmcnt(6)
 v_mul_f32 v226, v152, v226
 v_mul_f32 v227, v153, v227
 v_mfma_f32_16x16x32_bf16 v[188:191], a[164:167], a[44:47], v[188:191]
 s_add_u32 m0, s64, 49152
 ds_read_b64_tr_b16 a[148:149], v247 offset:0
 ds_read_b64_tr_b16 a[150:151], v247 offset:2048
 v_mfma_f32_16x16x32_bf16 v[184:187], a[164:167], a[40:43], v[184:187]
 s_waitcnt lgkmcnt(6)
 v_cvt_pk_bf16_f32 v2, v226, v227
 v_exp_f32 v228, v154
 v_mfma_f32_16x16x32_bf16 v[192:195], a[168:171], a[40:43], v[192:195]
 s_add_u32 s65, s81, 442368
 ds_read_b64_tr_b16 a[152:153], v246 offset:512
 ds_read_b64_tr_b16 a[154:155], v246 offset:2560
 buffer_load_dwordx4 v249, s[36:39], s65 offen lds
 v_mfma_f32_16x16x32_bf16 v[196:199], a[168:171], a[44:47], v[196:199]
 s_waitcnt lgkmcnt(6)
 v_exp_f32 v229, v155
 v_fma_f32 v228, v228, s75, s75
 v_fma_f32 v229, v229, s75, s75
 v_mfma_f32_16x16x32_bf16 v[204:207], a[172:175], a[44:47], v[204:207]
 ds_read_b64_tr_b16 a[156:157], v247 offset:512
 ds_read_b64_tr_b16 a[158:159], v247 offset:2560
 v_mfma_f32_16x16x32_bf16 v[200:203], a[172:175], a[40:43], v[200:203]
 s_waitcnt lgkmcnt(6)
 v_rcp_f32 v228, v228
 v_rcp_f32 v229, v229
 v_mfma_f32_16x16x32_bf16 v[176:179], a[144:147], a[48:51], v[176:179]
 ds_read_b64_tr_b16 a[160:161], v246 offset:4096
 ds_read_b64_tr_b16 a[162:163], v246 offset:6144
 v_mfma_f32_16x16x32_bf16 v[180:183], a[144:147], a[52:55], v[180:183]
 s_waitcnt lgkmcnt(6)
 v_mul_f32 v228, v154, v228
 v_mul_f32 v229, v155, v229
 v_mfma_f32_16x16x32_bf16 v[188:191], a[148:151], a[52:55], v[188:191]
 s_add_u32 m0, s64, 53248
 ds_read_b64_tr_b16 a[164:165], v247 offset:4096
 ds_read_b64_tr_b16 a[166:167], v247 offset:6144
 v_mfma_f32_16x16x32_bf16 v[184:187], a[148:151], a[48:51], v[184:187]
 s_waitcnt lgkmcnt(6)
 v_cvt_pk_bf16_f32 v3, v228, v229
 v_exp_f32 v224, v156
 v_mfma_f32_16x16x32_bf16 v[192:195], a[152:155], a[48:51], v[192:195]
 s_add_u32 s65, s81, 479232
 ds_read_b64_tr_b16 a[168:169], v246 offset:4608
 ds_read_b64_tr_b16 a[170:171], v246 offset:6656
 buffer_load_dwordx4 v249, s[36:39], s65 offen lds
 v_mfma_f32_16x16x32_bf16 v[196:199], a[152:155], a[52:55], v[196:199]
 s_waitcnt lgkmcnt(6)
 v_exp_f32 v225, v157
 v_fma_f32 v224, v224, s75, s75
 v_fma_f32 v225, v225, s75, s75
 v_mfma_f32_16x16x32_bf16 v[204:207], a[156:159], a[52:55], v[204:207]
 ds_read_b64_tr_b16 a[172:173], v247 offset:4608
 ds_read_b64_tr_b16 a[174:175], v247 offset:6656
 v_mfma_f32_16x16x32_bf16 v[200:203], a[156:159], a[48:51], v[200:203]
 s_waitcnt lgkmcnt(6)
 v_rcp_f32 v224, v224
 v_rcp_f32 v225, v225
 v_mfma_f32_16x16x32_bf16 v[176:179], a[160:163], a[56:59], v[176:179]
 ds_read_b64_tr_b16 a[144:145], v246 offset:8192
 ds_read_b64_tr_b16 a[146:147], v246 offset:10240
 v_mfma_f32_16x16x32_bf16 v[180:183], a[160:163], a[60:63], v[180:183]
 s_waitcnt lgkmcnt(6)
 v_mul_f32 v224, v156, v224
 v_mul_f32 v225, v157, v225
 v_mfma_f32_16x16x32_bf16 v[188:191], a[164:167], a[60:63], v[188:191]
 s_add_u32 m0, s64, 57344
 ds_read_b64_tr_b16 a[148:149], v247 offset:8192
 ds_read_b64_tr_b16 a[150:151], v247 offset:10240
 v_mfma_f32_16x16x32_bf16 v[184:187], a[164:167], a[56:59], v[184:187]
 s_waitcnt lgkmcnt(6)
 v_cvt_pk_bf16_f32 v6, v224, v225
 v_exp_f32 v226, v158
 v_mfma_f32_16x16x32_bf16 v[192:195], a[168:171], a[56:59], v[192:195]
 s_add_u32 s65, s81, 516096
 ds_read_b64_tr_b16 a[152:153], v246 offset:8704
 ds_read_b64_tr_b16 a[154:155], v246 offset:10752
 buffer_load_dwordx4 v249, s[36:39], s65 offen lds
 v_mfma_f32_16x16x32_bf16 v[196:199], a[168:171], a[60:63], v[196:199]
 s_waitcnt lgkmcnt(6)
 v_exp_f32 v227, v159
 v_fma_f32 v226, v226, s75, s75
 v_mfma_f32_16x16x32_bf16 v[204:207], a[172:175], a[60:63], v[204:207]
 ds_read_b64_tr_b16 a[156:157], v247 offset:8704
 ds_read_b64_tr_b16 a[158:159], v247 offset:10752
 v_mfma_f32_16x16x32_bf16 v[200:203], a[172:175], a[56:59], v[200:203]
 s_waitcnt lgkmcnt(6)
 v_fma_f32 v227, v227, s75, s75
 v_rcp_f32 v226, v226
 v_mfma_f32_16x16x32_bf16 v[176:179], a[144:147], a[64:67], v[176:179]
 ds_read_b64_tr_b16 a[160:161], v246 offset:12288
 ds_read_b64_tr_b16 a[162:163], v246 offset:14336
 v_mfma_f32_16x16x32_bf16 v[180:183], a[144:147], a[68:71], v[180:183]
 s_waitcnt lgkmcnt(6)
 v_rcp_f32 v227, v227
 v_mul_f32 v226, v158, v226
 v_mul_f32 v227, v159, v227
 v_mfma_f32_16x16x32_bf16 v[188:191], a[148:151], a[68:71], v[188:191]
 s_add_u32 m0, s64, 61440
 ds_read_b64_tr_b16 a[164:165], v247 offset:12288
 ds_read_b64_tr_b16 a[166:167], v247 offset:14336
 v_mfma_f32_16x16x32_bf16 v[184:187], a[148:151], a[64:67], v[184:187]
 s_waitcnt lgkmcnt(6)
 v_cvt_pk_bf16_f32 v7, v226, v227
 v_exp_f32 v228, v160
 v_mfma_f32_16x16x32_bf16 v[192:195], a[152:155], a[64:67], v[192:195]
 s_add_u32 s65, s81, 552960
 ds_read_b64_tr_b16 a[168:169], v246 offset:12800
 ds_read_b64_tr_b16 a[170:171], v246 offset:14848
 buffer_load_dwordx4 v249, s[36:39], s65 offen lds
 v_mfma_f32_16x16x32_bf16 v[196:199], a[152:155], a[68:71], v[196:199]
 s_waitcnt lgkmcnt(6)
 v_exp_f32 v229, v161
 v_fma_f32 v228, v228, s75, s75
 v_mfma_f32_16x16x32_bf16 v[204:207], a[156:159], a[68:71], v[204:207]
 ds_read_b64_tr_b16 a[172:173], v247 offset:12800
 ds_read_b64_tr_b16 a[174:175], v247 offset:14848
 v_mfma_f32_16x16x32_bf16 v[200:203], a[156:159], a[64:67], v[200:203]
 s_waitcnt lgkmcnt(6)
 v_fma_f32 v229, v229, s75, s75
 v_rcp_f32 v228, v228
 v_mfma_f32_16x16x32_bf16 v[176:179], a[160:163], a[72:75], v[176:179]
 ds_read_b64_tr_b16 a[144:145], v246 offset:16384
 ds_read_b64_tr_b16 a[146:147], v246 offset:18432
 v_mfma_f32_16x16x32_bf16 v[180:183], a[160:163], a[76:79], v[180:183]
 s_waitcnt lgkmcnt(6)
 v_rcp_f32 v229, v229
 v_mul_f32 v228, v160, v228
 v_mul_f32 v229, v161, v229
 v_mfma_f32_16x16x32_bf16 v[188:191], a[164:167], a[76:79], v[188:191]
 s_add_u32 m0, s64, 65536
 ds_read_b64_tr_b16 a[148:149], v247 offset:16384
 ds_read_b64_tr_b16 a[150:151], v247 offset:18432
 v_mfma_f32_16x16x32_bf16 v[184:187], a[164:167], a[72:75], v[184:187]
 s_waitcnt lgkmcnt(6)
 v_cvt_pk_bf16_f32 v8, v228, v229
 v_exp_f32 v224, v162
 v_mfma_f32_16x16x32_bf16 v[192:195], a[168:171], a[72:75], v[192:195]
 s_add_u32 s65, s81, 589824
 ds_read_b64_tr_b16 a[152:153], v246 offset:16896
 ds_read_b64_tr_b16 a[154:155], v246 offset:18944
 buffer_load_dwordx4 v249, s[36:39], s65 offen lds
 v_mfma_f32_16x16x32_bf16 v[196:199], a[168:171], a[76:79], v[196:199]
 s_waitcnt lgkmcnt(6)
 v_exp_f32 v225, v163
 v_fma_f32 v224, v224, s75, s75
 v_mfma_f32_16x16x32_bf16 v[204:207], a[172:175], a[76:79], v[204:207]
 ds_read_b64_tr_b16 a[156:157], v247 offset:16896
 ds_read_b64_tr_b16 a[158:159], v247 offset:18944
 v_mfma_f32_16x16x32_bf16 v[200:203], a[172:175], a[72:75], v[200:203]
 s_waitcnt lgkmcnt(6)
 v_fma_f32 v225, v225, s75, s75
 v_rcp_f32 v224, v224
 v_mfma_f32_16x16x32_bf16 v[176:179], a[144:147], a[80:83], v[176:179]
 ds_read_b64_tr_b16 a[160:161], v246 offset:20480
 ds_read_b64_tr_b16 a[162:163], v246 offset:22528
 v_mfma_f32_16x16x32_bf16 v[180:183], a[144:147], a[84:87], v[180:183]
 s_waitcnt lgkmcnt(6)
 v_rcp_f32 v225, v225
 v_mul_f32 v224, v162, v224
 v_mfma_f32_16x16x32_bf16 v[188:191], a[148:151], a[84:87], v[188:191]
 s_add_u32 m0, s64, 69632
 ds_read_b64_tr_b16 a[164:165], v247 offset:20480
 ds_read_b64_tr_b16 a[166:167], v247 offset:22528
 v_mfma_f32_16x16x32_bf16 v[184:187], a[148:151], a[80:83], v[184:187]
 s_waitcnt lgkmcnt(6)
 v_mul_f32 v225, v163, v225
 v_cvt_pk_bf16_f32 v9, v224, v225
 v_exp_f32 v226, v164
 v_mfma_f32_16x16x32_bf16 v[192:195], a[152:155], a[80:83], v[192:195]
 s_add_u32 s65, s81, 626688
 ds_read_b64_tr_b16 a[168:169], v246 offset:20992
 ds_read_b64_tr_b16 a[170:171], v246 offset:23040
 buffer_load_dwordx4 v249, s[36:39], s65 offen lds
 v_mfma_f32_16x16x32_bf16 v[196:199], a[152:155], a[84:87], v[196:199]
 s_waitcnt lgkmcnt(6)
 v_exp_f32 v227, v165
 v_fma_f32 v226, v226, s75, s75
 v_mfma_f32_16x16x32_bf16 v[204:207], a[156:159], a[84:87], v[204:207]
 ds_read_b64_tr_b16 a[172:173], v247 offset:20992
 ds_read_b64_tr_b16 a[174:175], v247 offset:23040
 v_mfma_f32_16x16x32_bf16 v[200:203], a[156:159], a[80:83], v[200:203]
 s_waitcnt lgkmcnt(6)
 v_fma_f32 v227, v227, s75, s75
 v_rcp_f32 v226, v226
 v_mfma_f32_16x16x32_bf16 v[176:179], a[160:163], a[88:91], v[176:179]
 s_waitcnt vmcnt(18)
 s_barrier
 ds_read_b64_tr_b16 a[144:145], v246 offset:24576
 ds_read_b64_tr_b16 a[146:147], v246 offset:26624
 v_mfma_f32_16x16x32_bf16 v[180:183], a[160:163], a[92:95], v[180:183]
 s_waitcnt lgkmcnt(6)
 v_rcp_f32 v227, v227
 v_mul_f32 v226, v164, v226
 v_mfma_f32_16x16x32_bf16 v[188:191], a[164:167], a[92:95], v[188:191]
 s_add_u32 m0, s64, 73728
 ds_read_b64_tr_b16 a[148:149], v247 offset:24576
 ds_read_b64_tr_b16 a[150:151], v247 offset:26624
 v_mfma_f32_16x16x32_bf16 v[184:187], a[164:167], a[88:91], v[184:187]
 s_waitcnt lgkmcnt(6)
 v_mul_f32 v227, v165, v227
 v_cvt_pk_bf16_f32 v12, v226, v227
 v_exp_f32 v228, v166
 v_mfma_f32_16x16x32_bf16 v[192:195], a[168:171], a[88:91], v[192:195]
 s_add_u32 s65, s82, 0
 ds_read_b64_tr_b16 a[152:153], v246 offset:25088
 ds_read_b64_tr_b16 a[154:155], v246 offset:27136
 buffer_load_dwordx4 v249, s[36:39], s65 offen lds
 v_mfma_f32_16x16x32_bf16 v[196:199], a[168:171], a[92:95], v[196:199]
 s_waitcnt lgkmcnt(6)
 v_exp_f32 v229, v167
 v_fma_f32 v228, v228, s75, s75
 v_mfma_f32_16x16x32_bf16 v[204:207], a[172:175], a[92:95], v[204:207]
 ds_read_b64_tr_b16 a[156:157], v247 offset:25088
 ds_read_b64_tr_b16 a[158:159], v247 offset:27136
 v_mfma_f32_16x16x32_bf16 v[200:203], a[172:175], a[88:91], v[200:203]
 s_waitcnt lgkmcnt(6)
 v_fma_f32 v229, v229, s75, s75
 v_rcp_f32 v228, v228
 v_mfma_f32_16x16x32_bf16 v[176:179], a[144:147], a[96:99], v[176:179]
 ds_read_b64_tr_b16 a[160:161], v246 offset:28672
 ds_read_b64_tr_b16 a[162:163], v246 offset:30720
 v_mfma_f32_16x16x32_bf16 v[180:183], a[144:147], a[100:103], v[180:183]
 s_waitcnt lgkmcnt(6)
 v_rcp_f32 v229, v229
 v_mul_f32 v228, v166, v228
 v_mfma_f32_16x16x32_bf16 v[188:191], a[148:151], a[100:103], v[188:191]
 s_add_u32 m0, s64, 77824
 ds_read_b64_tr_b16 a[164:165], v247 offset:28672
 ds_read_b64_tr_b16 a[166:167], v247 offset:30720
 v_mfma_f32_16x16x32_bf16 v[184:187], a[148:151], a[96:99], v[184:187]
 s_waitcnt lgkmcnt(6)
 v_mul_f32 v229, v167, v229
 v_cvt_pk_bf16_f32 v13, v228, v229
 v_exp_f32 v224, v168
 v_mfma_f32_16x16x32_bf16 v[192:195], a[152:155], a[96:99], v[192:195]
 s_add_u32 s65, s82, 36864
 ds_read_b64_tr_b16 a[168:169], v246 offset:29184
 ds_read_b64_tr_b16 a[170:171], v246 offset:31232
 buffer_load_dwordx4 v249, s[36:39], s65 offen lds
 v_mfma_f32_16x16x32_bf16 v[196:199], a[152:155], a[100:103], v[196:199]
 s_waitcnt lgkmcnt(6)
 v_exp_f32 v225, v169
 v_mfma_f32_16x16x32_bf16 v[204:207], a[156:159], a[100:103], v[204:207]
 ds_read_b64_tr_b16 a[172:173], v247 offset:29184
 ds_read_b64_tr_b16 a[174:175], v247 offset:31232
 v_mfma_f32_16x16x32_bf16 v[200:203], a[156:159], a[96:99], v[200:203]
 s_waitcnt lgkmcnt(6)
 v_fma_f32 v224, v224, s75, s75
 v_fma_f32 v225, v225, s75, s75
 v_rcp_f32 v224, v224
 v_mfma_f32_16x16x32_bf16 v[176:179], a[160:163], a[104:107], v[176:179]
 ds_read_b64_tr_b16 a[144:145], v246 offset:32768
 ds_read_b64_tr_b16 a[146:147], v246 offset:34816
 v_mfma_f32_16x16x32_bf16 v[180:183], a[160:163], a[108:111], v[180:183]
 s_waitcnt lgkmcnt(6)
 v_rcp_f32 v225, v225
 v_mul_f32 v224, v168, v224
 v_mfma_f32_16x16x32_bf16 v[188:191], a[164:167], a[108:111], v[188:191]
 s_add_u32 m0, s64, 81920
 ds_read_b64_tr_b16 a[148:149], v247 offset:32768
 ds_read_b64_tr_b16 a[150:151], v247 offset:34816
 v_mfma_f32_16x16x32_bf16 v[184:187], a[164:167], a[104:107], v[184:187]
 s_waitcnt lgkmcnt(6)
 v_mul_f32 v225, v169, v225
 v_cvt_pk_bf16_f32 v10, v224, v225
 v_exp_f32 v226, v170
 v_mfma_f32_16x16x32_bf16 v[192:195], a[168:171], a[104:107], v[192:195]
 s_add_u32 s65, s82, 73728
 ds_read_b64_tr_b16 a[152:153], v246 offset:33280
 ds_read_b64_tr_b16 a[154:155], v246 offset:35328
 buffer_load_dwordx4 v249, s[36:39], s65 offen lds
 v_mfma_f32_16x16x32_bf16 v[196:199], a[168:171], a[108:111], v[196:199]
 s_waitcnt lgkmcnt(6)
 v_exp_f32 v227, v171
 v_mfma_f32_16x16x32_bf16 v[204:207], a[172:175], a[108:111], v[204:207]
 ds_read_b64_tr_b16 a[156:157], v247 offset:33280
 ds_read_b64_tr_b16 a[158:159], v247 offset:35328
 v_mfma_f32_16x16x32_bf16 v[200:203], a[172:175], a[104:107], v[200:203]
 s_waitcnt lgkmcnt(6)
 v_fma_f32 v226, v226, s75, s75
 v_fma_f32 v227, v227, s75, s75
 v_rcp_f32 v226, v226
 v_mfma_f32_16x16x32_bf16 v[176:179], a[144:147], v[208:211], v[176:179]
 ds_read_b64_tr_b16 a[160:161], v246 offset:36864
 ds_read_b64_tr_b16 a[162:163], v246 offset:38912
 v_mfma_f32_16x16x32_bf16 v[180:183], a[144:147], v[212:215], v[180:183]
 s_waitcnt lgkmcnt(6)
 v_rcp_f32 v227, v227
 v_mul_f32 v226, v170, v226
 v_mfma_f32_16x16x32_bf16 v[188:191], a[148:151], v[212:215], v[188:191]
 s_add_u32 m0, s64, 86016
 ds_read_b64_tr_b16 a[164:165], v247 offset:36864
 ds_read_b64_tr_b16 a[166:167], v247 offset:38912
 v_mfma_f32_16x16x32_bf16 v[184:187], a[148:151], v[208:211], v[184:187]
 s_waitcnt lgkmcnt(6)
 v_mul_f32 v227, v171, v227
 v_cvt_pk_bf16_f32 v11, v226, v227
 v_exp_f32 v228, v172
 v_mfma_f32_16x16x32_bf16 v[192:195], a[152:155], v[208:211], v[192:195]
 s_add_u32 s65, s82, 110592
 ds_read_b64_tr_b16 a[168:169], v246 offset:37376
 ds_read_b64_tr_b16 a[170:171], v246 offset:39424
 buffer_load_dwordx4 v249, s[36:39], s65 offen lds
 v_mfma_f32_16x16x32_bf16 v[196:199], a[152:155], v[212:215], v[196:199]
 s_waitcnt lgkmcnt(6)
 v_exp_f32 v229, v173
 v_mfma_f32_16x16x32_bf16 v[204:207], a[156:159], v[212:215], v[204:207]
 ds_read_b64_tr_b16 a[172:173], v247 offset:37376
 ds_read_b64_tr_b16 a[174:175], v247 offset:39424
 v_mfma_f32_16x16x32_bf16 v[200:203], a[156:159], v[208:211], v[200:203]
 s_waitcnt lgkmcnt(6)
 v_fma_f32 v228, v228, s75, s75
 v_fma_f32 v229, v229, s75, s75
 v_rcp_f32 v228, v228
 v_mfma_f32_16x16x32_bf16 v[176:179], a[160:163], v[216:219], v[176:179]
 ds_read_b64_tr_b16 a[144:145], v246 offset:40960
 ds_read_b64_tr_b16 a[146:147], v246 offset:43008
 v_mfma_f32_16x16x32_bf16 v[180:183], a[160:163], v[220:223], v[180:183]
 s_waitcnt lgkmcnt(6)
 v_rcp_f32 v229, v229
 v_mfma_f32_16x16x32_bf16 v[188:191], a[164:167], v[220:223], v[188:191]
 s_add_u32 m0, s64, 90112
 ds_read_b64_tr_b16 a[148:149], v247 offset:40960
 ds_read_b64_tr_b16 a[150:151], v247 offset:43008
 v_mfma_f32_16x16x32_bf16 v[184:187], a[164:167], v[216:219], v[184:187]
 s_waitcnt lgkmcnt(6)
 v_mul_f32 v228, v172, v228
 v_mul_f32 v229, v173, v229
 v_cvt_pk_bf16_f32 v14, v228, v229
 v_mfma_f32_16x16x32_bf16 v[192:195], a[168:171], v[216:219], v[192:195]
 s_add_u32 s65, s82, 147456
 ds_read_b64_tr_b16 a[152:153], v246 offset:41472
 ds_read_b64_tr_b16 a[154:155], v246 offset:43520
 buffer_load_dwordx4 v249, s[36:39], s65 offen lds
 v_mfma_f32_16x16x32_bf16 v[196:199], a[168:171], v[220:223], v[196:199]
 s_waitcnt lgkmcnt(6)
 v_exp_f32 v224, v174
 v_exp_f32 v225, v175
 v_mfma_f32_16x16x32_bf16 v[204:207], a[172:175], v[220:223], v[204:207]
 ds_read_b64_tr_b16 a[156:157], v247 offset:41472
 ds_read_b64_tr_b16 a[158:159], v247 offset:43520
 v_mfma_f32_16x16x32_bf16 v[200:203], a[172:175], v[216:219], v[200:203]
 s_waitcnt lgkmcnt(6)
 v_fma_f32 v224, v224, s75, s75
 v_fma_f32 v225, v225, s75, s75
 v_rcp_f32 v224, v224
 v_mfma_f32_16x16x32_bf16 v[176:179], a[144:147], v[0:3], v[176:179]
 ds_read_b64_tr_b16 a[160:161], v246 offset:45056
 ds_read_b64_tr_b16 a[162:163], v246 offset:47104
 v_mfma_f32_16x16x32_bf16 v[180:183], a[144:147], v[4:7], v[180:183]
 s_waitcnt lgkmcnt(6)
 v_rcp_f32 v225, v225
 v_mfma_f32_16x16x32_bf16 v[188:191], a[148:151], v[4:7], v[188:191]
 s_add_u32 m0, s64, 94208
 ds_read_b64_tr_b16 a[164:165], v247 offset:45056
 ds_read_b64_tr_b16 a[166:167], v247 offset:47104
 v_mfma_f32_16x16x32_bf16 v[184:187], a[148:151], v[0:3], v[184:187]
 s_waitcnt lgkmcnt(6)
 v_mul_f32 v224, v174, v224
 v_mul_f32 v225, v175, v225
 v_cvt_pk_bf16_f32 v15, v224, v225
 v_mfma_f32_16x16x32_bf16 v[192:195], a[152:155], v[0:3], v[192:195]
 s_add_u32 s65, s82, 184320
 ds_read_b64_tr_b16 a[168:169], v246 offset:45568
 ds_read_b64_tr_b16 a[170:171], v246 offset:47616
 buffer_load_dwordx4 v249, s[36:39], s65 offen lds
 v_mfma_f32_16x16x32_bf16 v[196:199], a[152:155], v[4:7], v[196:199]
 s_waitcnt lgkmcnt(6)
 v_mfma_f32_16x16x32_bf16 v[204:207], a[156:159], v[4:7], v[204:207]
 ds_read_b64_tr_b16 a[172:173], v247 offset:45568
 ds_read_b64_tr_b16 a[174:175], v247 offset:47616
 v_mfma_f32_16x16x32_bf16 v[200:203], a[156:159], v[0:3], v[200:203]
 s_waitcnt lgkmcnt(6)
 v_mfma_f32_16x16x32_bf16 v[176:179], a[160:163], v[8:11], v[176:179]
 s_waitcnt vmcnt(18)
 s_barrier
 ds_read_b64_tr_b16 a[144:145], v242 offset:0
 ds_read_b64_tr_b16 a[146:147], v242 offset:2048
 v_mfma_f32_16x16x32_bf16 v[180:183], a[160:163], v[12:15], v[180:183]
 s_waitcnt lgkmcnt(6)
 v_mfma_f32_16x16x32_bf16 v[188:191], a[164:167], v[12:15], v[188:191]
 s_add_u32 m0, s64, 98304
 ds_read_b64_tr_b16 a[148:149], v243 offset:0
 ds_read_b64_tr_b16 a[150:151], v243 offset:2048
 v_mfma_f32_16x16x32_bf16 v[184:187], a[164:167], v[8:11], v[184:187]
 s_waitcnt lgkmcnt(6)
 v_mfma_f32_16x16x32_bf16 v[192:195], a[168:171], v[8:11], v[192:195]
 s_add_u32 s65, s82, 221184
 ds_read_b64_tr_b16 a[152:153], v242 offset:512
 ds_read_b64_tr_b16 a[154:155], v242 offset:2560
 buffer_load_dwordx4 v249, s[36:39], s65 offen lds
 v_mfma_f32_16x16x32_bf16 v[196:199], a[168:171], v[12:15], v[196:199]
 s_waitcnt lgkmcnt(6)
 v_mfma_f32_16x16x32_bf16 v[204:207], a[172:175], v[12:15], v[204:207]
 ds_read_b64_tr_b16 a[156:157], v243 offset:512
 ds_read_b64_tr_b16 a[158:159], v243 offset:2560
 v_mfma_f32_16x16x32_bf16 v[200:203], a[172:175], v[8:11], v[200:203]
 s_waitcnt lgkmcnt(6)
 v_mfma_f32_16x16x32_bf16 v[144:147], a[144:147], a[0:3], 0
 s_cmp_eq_u32 s15, 7
 s_cbranch_scc1 L_hsc10
L_hsc10_ok:
 ds_read_b64_tr_b16 a[160:161], v242 offset:4096
 ds_read_b64_tr_b16 a[162:163], v242 offset:6144
 v_mfma_f32_16x16x32_bf16 v[148:151], a[144:147], a[4:7], 0
 s_waitcnt lgkmcnt(6)
 v_mfma_f32_16x16x32_bf16 v[156:159], a[148:151], a[4:7], 0
 s_add_u32 m0, s64, 102400
 ds_read_b64_tr_b16 a[164:165], v243 offset:4096
 ds_read_b64_tr_b16 a[166:167], v243 offset:6144
 v_mfma_f32_16x16x32_bf16 v[152:155], a[148:151], a[0:3], 0
 s_waitcnt lgkmcnt(6)
 v_accvgpr_read_b32 v98, a242
 v_accvgpr_read_b32 v100, a244
 v_mfma_f32_16x16x32_bf16 v[160:163], a[152:155], a[0:3], 0
 s_add_u32 s65, s82, 258048
 ds_read_b64_tr_b16 a[168:169], v242 offset:4608
 ds_read_b64_tr_b16 a[170:171], v242 offset:6656
 v_mfma_f32_16x16x32_bf16 v[164:167], a[152:155], a[4:7], 0
 s_waitcnt lgkmcnt(6)
 buffer_load_dwordx4 v249, s[36:39], s65 offen lds
 v_mfma_f32_16x16x32_bf16 v[172:175], a[156:159], a[4:7], 0
 ds_read_b64_tr_b16 a[172:173], v243 offset:4608
 ds_read_b64_tr_b16 a[174:175], v243 offset:6656
 v_mfma_f32_16x16x32_bf16 v[168:171], a[156:159], a[0:3], 0
 s_waitcnt lgkmcnt(6)
 v_accvgpr_read_b32 v101, a245
 v_accvgpr_read_b32 v104, a246
 v_mfma_f32_16x16x32_bf16 v[144:147], a[160:163], a[8:11], v[144:147]
 ds_read_b64_tr_b16 a[144:145], v242 offset:8192
 ds_read_b64_tr_b16 a[146:147], v242 offset:10240
 v_mfma_f32_16x16x32_bf16 v[148:151], a[160:163], a[12:15], v[148:151]
 s_waitcnt lgkmcnt(6)
 v_cvt_pk_bf16_f32 v224, v176, v177
 v_cvt_pk_bf16_f32 v225, v178, v179
 v_mfma_f32_16x16x32_bf16 v[156:159], a[164:167], a[12:15], v[156:159]
 s_add_u32 m0, s64, 106496
 ds_read_b64_tr_b16 a[148:149], v243 offset:8192
 ds_read_b64_tr_b16 a[150:151], v243 offset:10240
 v_mfma_f32_16x16x32_bf16 v[152:155], a[164:167], a[8:11], v[152:155]
 s_waitcnt lgkmcnt(6)
 v_cvt_pk_bf16_f32 v226, v180, v181
 v_cvt_pk_bf16_f32 v227, v182, v183
 v_mfma_f32_16x16x32_bf16 v[160:163], a[168:171], a[8:11], v[160:163]
 s_add_u32 s65, s82, 294912
 ds_read_b64_tr_b16 a[152:153], v242 offset:8704
 ds_read_b64_tr_b16 a[154:155], v242 offset:10752
 v_mfma_f32_16x16x32_bf16 v[164:167], a[168:171], a[12:15], v[164:167]
 s_waitcnt lgkmcnt(6)
 buffer_load_dwordx4 v249, s[36:39], s65 offen lds
 v_mfma_f32_16x16x32_bf16 v[172:175], a[172:175], a[12:15], v[172:175]
 ds_read_b64_tr_b16 a[156:157], v243 offset:8704
 ds_read_b64_tr_b16 a[158:159], v243 offset:10752
 v_mfma_f32_16x16x32_bf16 v[168:171], a[172:175], a[8:11], v[168:171]
 s_waitcnt lgkmcnt(6)
 buffer_store_dwordx4 v[224:227], v250, s[56:59], s89 offen offset:0 sc1
 v_mfma_f32_16x16x32_bf16 v[144:147], a[144:147], a[16:19], v[144:147]
 ds_read_b64_tr_b16 a[160:161], v242 offset:12288
 ds_read_b64_tr_b16 a[162:163], v242 offset:14336
 v_mfma_f32_16x16x32_bf16 v[148:151], a[144:147], a[20:23], v[148:151]
 s_waitcnt lgkmcnt(6)
 v_cvt_pk_bf16_f32 v228, v184, v185
 v_cvt_pk_bf16_f32 v229, v186, v187
 v_mfma_f32_16x16x32_bf16 v[156:159], a[148:151], a[20:23], v[156:159]
 s_add_u32 m0, s64, 110592
 ds_read_b64_tr_b16 a[164:165], v243 offset:12288
 ds_read_b64_tr_b16 a[166:167], v243 offset:14336
 v_mfma_f32_16x16x32_bf16 v[152:155], a[148:151], a[16:19], v[152:155]
 s_waitcnt lgkmcnt(6)
 v_cvt_pk_bf16_f32 v230, v188, v189
 v_cvt_pk_bf16_f32 v231, v190, v191
 v_mfma_f32_16x16x32_bf16 v[160:163], a[152:155], a[16:19], v[160:163]
 s_add_u32 s65, s82, 331776
 ds_read_b64_tr_b16 a[168:169], v242 offset:12800
 ds_read_b64_tr_b16 a[170:171], v242 offset:14848
 v_mfma_f32_16x16x32_bf16 v[164:167], a[152:155], a[20:23], v[164:167]
 s_waitcnt lgkmcnt(6)
 buffer_load_dwordx4 v249, s[36:39], s65 offen lds
 v_mfma_f32_16x16x32_bf16 v[172:175], a[156:159], a[20:23], v[172:175]
 ds_read_b64_tr_b16 a[172:173], v243 offset:12800
 ds_read_b64_tr_b16 a[174:175], v243 offset:14848
 v_mfma_f32_16x16x32_bf16 v[168:171], a[156:159], a[16:19], v[168:171]
 s_waitcnt lgkmcnt(6)
 buffer_store_dwordx4 v[228:231], v250, s[56:59], s89 offen offset:1024 sc1
 v_mfma_f32_16x16x32_bf16 v[144:147], a[160:163], a[24:27], v[144:147]
 ds_read_b64_tr_b16 a[144:145], v242 offset:16384
 ds_read_b64_tr_b16 a[146:147], v242 offset:18432
 v_mfma_f32_16x16x32_bf16 v[148:151], a[160:163], a[28:31], v[148:151]
 s_waitcnt lgkmcnt(6)
 v_cvt_pk_bf16_f32 v232, v192, v193
 v_cvt_pk_bf16_f32 v233, v194, v195
 v_mfma_f32_16x16x32_bf16 v[156:159], a[164:167], a[28:31], v[156:159]
 s_add_u32 m0, s64, 114688
 ds_read_b64_tr_b16 a[148:149], v243 offset:16384
 ds_read_b64_tr_b16 a[150:151], v243 offset:18432
 v_mfma_f32_16x16x32_bf16 v[152:155], a[164:167], a[24:27], v[152:155]
 s_waitcnt lgkmcnt(6)
 v_cvt_pk_bf16_f32 v234, v196, v197
 v_cvt_pk_bf16_f32 v235, v198, v199
 v_mfma_f32_16x16x32_bf16 v[160:163], a[168:171], a[24:27], v[160:163]
 s_add_u32 s65, s82, 368640
 ds_read_b64_tr_b16 a[152:153], v242 offset:16896
 ds_read_b64_tr_b16 a[154:155], v242 offset:18944
 v_mfma_f32_16x16x32_bf16 v[164:167], a[168:171], a[28:31], v[164:167]
 s_waitcnt lgkmcnt(6)
 buffer_load_dwordx4 v249, s[36:39], s65 offen lds
 v_mfma_f32_16x16x32_bf16 v[172:175], a[172:175], a[28:31], v[172:175]
 ds_read_b64_tr_b16 a[156:157], v243 offset:16896
 ds_read_b64_tr_b16 a[158:159], v243 offset:18944
 v_mfma_f32_16x16x32_bf16 v[168:171], a[172:175], a[24:27], v[168:171]
 s_waitcnt lgkmcnt(6)
 buffer_store_dwordx4 v[232:235], v250, s[56:59], s89 offen offset:2048 sc1
 v_mfma_f32_16x16x32_bf16 v[144:147], a[144:147], a[32:35], v[144:147]
 ds_read_b64_tr_b16 a[160:161], v242 offset:20480
 ds_read_b64_tr_b16 a[162:163], v242 offset:22528
 v_mfma_f32_16x16x32_bf16 v[148:151], a[144:147], a[36:39], v[148:151]
 s_waitcnt lgkmcnt(6)
 v_cvt_pk_bf16_f32 v224, v200, v201
 v_cvt_pk_bf16_f32 v225, v202, v203
 v_mfma_f32_16x16x32_bf16 v[156:159], a[148:151], a[36:39], v[156:159]
 s_add_u32 m0, s64, 118784
 ds_read_b64_tr_b16 a[164:165], v243 offset:20480
 ds_read_b64_tr_b16 a[166:167], v243 offset:22528
 v_mfma_f32_16x16x32_bf16 v[152:155], a[148:151], a[32:35], v[152:155]
 s_waitcnt lgkmcnt(6)
 v_cvt_pk_bf16_f32 v226, v204, v205
 v_cvt_pk_bf16_f32 v227, v206, v207
 v_mfma_f32_16x16x32_bf16 v[160:163], a[152:155], a[32:35], v[160:163]
 s_add_u32 s65, s82, 405504
 ds_read_b64_tr_b16 a[168:169], v242 offset:20992
 ds_read_b64_tr_b16 a[170:171], v242 offset:23040
 v_mfma_f32_16x16x32_bf16 v[164:167], a[152:155], a[36:39], v[164:167]
 s_waitcnt lgkmcnt(6)
 buffer_load_dwordx4 v249, s[36:39], s65 offen lds
 v_mfma_f32_16x16x32_bf16 v[172:175], a[156:159], a[36:39], v[172:175]
 ds_read_b64_tr_b16 a[172:173], v243 offset:20992
 ds_read_b64_tr_b16 a[174:175], v243 offset:23040
 v_mfma_f32_16x16x32_bf16 v[168:171], a[156:159], a[32:35], v[168:171]
 s_waitcnt lgkmcnt(6)
 buffer_store_dwordx4 v[224:227], v250, s[56:59], s89 offen offset:3072 sc1
 v_mfma_f32_16x16x32_bf16 v[144:147], a[160:163], a[40:43], v[144:147]
 s_waitcnt vmcnt(22)
 s_barrier
 ds_read_b64_tr_b16 a[144:145], v242 offset:24576
 ds_read_b64_tr_b16 a[146:147], v242 offset:26624
 v_mfma_f32_16x16x32_bf16 v[148:151], a[160:163], a[44:47], v[148:151]
 s_waitcnt lgkmcnt(6)
 v_mfma_f32_16x16x32_bf16 v[156:159], a[164:167], a[44:47], v[156:159]
 s_add_u32 m0, s64, 122880
 ds_read_b64_tr_b16 a[148:149], v243 offset:24576
 ds_read_b64_tr_b16 a[150:151], v243 offset:26624
 v_mfma_f32_16x16x32_bf16 v[152:155], a[164:167], a[40:43], v[152:155]
 s_waitcnt lgkmcnt(6)
 v_mfma_f32_16x16x32_bf16 v[160:163], a[168:171], a[40:43], v[160:163]
 s_add_u32 s65, s82, 442368
 ds_read_b64_tr_b16 a[152:153], v242 offset:25088
 ds_read_b64_tr_b16 a[154:155], v242 offset:27136
 v_mfma_f32_16x16x32_bf16 v[164:167], a[168:171], a[44:47], v[164:167]
 s_waitcnt lgkmcnt(6)
 buffer_load_dwordx4 v249, s[36:39], s65 offen lds
 v_mfma_f32_16x16x32_bf16 v[172:175], a[172:175], a[44:47], v[172:175]
 ds_read_b64_tr_b16 a[156:157], v243 offset:25088
 ds_read_b64_tr_b16 a[158:159], v243 offset:27136
 v_mfma_f32_16x16x32_bf16 v[168:171], a[172:175], a[40:43], v[168:171]
 s_waitcnt lgkmcnt(6)
 v_mfma_f32_16x16x32_bf16 v[144:147], a[144:147], a[48:51], v[144:147]
 ds_read_b64_tr_b16 a[160:161], v242 offset:28672
 ds_read_b64_tr_b16 a[162:163], v242 offset:30720
 v_mfma_f32_16x16x32_bf16 v[148:151], a[144:147], a[52:55], v[148:151]
 s_waitcnt lgkmcnt(6)
 v_mfma_f32_16x16x32_bf16 v[156:159], a[148:151], a[52:55], v[156:159]
 s_add_u32 m0, s64, 126976
 ds_read_b64_tr_b16 a[164:165], v243 offset:28672
 ds_read_b64_tr_b16 a[166:167], v243 offset:30720
 v_mfma_f32_16x16x32_bf16 v[152:155], a[148:151], a[48:51], v[152:155]
 s_waitcnt lgkmcnt(6)
 v_mfma_f32_16x16x32_bf16 v[160:163], a[152:155], a[48:51], v[160:163]
 s_add_u32 s65, s82, 479232
 ds_read_b64_tr_b16 a[168:169], v242 offset:29184
 ds_read_b64_tr_b16 a[170:171], v242 offset:31232
 v_mfma_f32_16x16x32_bf16 v[164:167], a[152:155], a[52:55], v[164:167]
 s_waitcnt lgkmcnt(6)
 buffer_load_dwordx4 v249, s[36:39], s65 offen lds
 v_mfma_f32_16x16x32_bf16 v[172:175], a[156:159], a[52:55], v[172:175]
 ds_read_b64_tr_b16 a[172:173], v243 offset:29184
 ds_read_b64_tr_b16 a[174:175], v243 offset:31232
 v_mfma_f32_16x16x32_bf16 v[168:171], a[156:159], a[48:51], v[168:171]
 s_waitcnt lgkmcnt(6)
 v_mfma_f32_16x16x32_bf16 v[144:147], a[160:163], a[56:59], v[144:147]
 ds_read_b64_tr_b16 a[144:145], v242 offset:32768
 ds_read_b64_tr_b16 a[146:147], v242 offset:34816
 v_mfma_f32_16x16x32_bf16 v[148:151], a[160:163], a[60:63], v[148:151]
 s_waitcnt lgkmcnt(6)
 v_mfma_f32_16x16x32_bf16 v[156:159], a[164:167], a[60:63], v[156:159]
 s_add_u32 m0, s64, 131072
 ds_read_b64_tr_b16 a[148:149], v243 offset:32768
 ds_read_b64_tr_b16 a[150:151], v243 offset:34816
 v_mfma_f32_16x16x32_bf16 v[152:155], a[164:167], a[56:59], v[152:155]
 s_waitcnt lgkmcnt(6)
 v_mfma_f32_16x16x32_bf16 v[160:163], a[168:171], a[56:59], v[160:163]
 s_add_u32 s65, s82, 516096
 ds_read_b64_tr_b16 a[152:153], v242 offset:33280
 ds_read_b64_tr_b16 a[154:155], v242 offset:35328
 v_mfma_f32_16x16x32_bf16 v[164:167], a[168:171], a[60:63], v[164:167]
 s_waitcnt lgkmcnt(6)
 buffer_load_dwordx4 v249, s[36:39], s65 offen lds
 v_mfma_f32_16x16x32_bf16 v[172:175], a[172:175], a[60:63], v[172:175]
 ds_read_b64_tr_b16 a[156:157], v243 offset:33280
 ds_read_b64_tr_b16 a[158:159], v243 offset:35328
 v_mfma_f32_16x16x32_bf16 v[168:171], a[172:175], a[56:59], v[168:171]
 s_waitcnt lgkmcnt(6)
 v_mfma_f32_16x16x32_bf16 v[144:147], a[144:147], a[64:67], v[144:147]
 ds_read_b64_tr_b16 a[160:161], v242 offset:36864
 ds_read_b64_tr_b16 a[162:163], v242 offset:38912
 v_mfma_f32_16x16x32_bf16 v[148:151], a[144:147], a[68:71], v[148:151]
 s_waitcnt lgkmcnt(6)
 v_mfma_f32_16x16x32_bf16 v[156:159], a[148:151], a[68:71], v[156:159]
 s_add_u32 m0, s64, 135168
 ds_read_b64_tr_b16 a[164:165], v243 offset:36864
 ds_read_b64_tr_b16 a[166:167], v243 offset:38912
 v_mfma_f32_16x16x32_bf16 v[152:155], a[148:151], a[64:67], v[152:155]
 s_waitcnt lgkmcnt(6)
 v_mfma_f32_16x16x32_bf16 v[160:163], a[152:155], a[64:67], v[160:163]
 s_add_u32 s65, s82, 552960
 ds_read_b64_tr_b16 a[168:169], v242 offset:37376
 ds_read_b64_tr_b16 a[170:171], v242 offset:39424
 v_mfma_f32_16x16x32_bf16 v[164:167], a[152:155], a[68:71], v[164:167]
 s_waitcnt lgkmcnt(6)
 buffer_load_dwordx4 v249, s[36:39], s65 offen lds
 v_mfma_f32_16x16x32_bf16 v[172:175], a[156:159], a[68:71], v[172:175]
 ds_read_b64_tr_b16 a[172:173], v243 offset:37376
 ds_read_b64_tr_b16 a[174:175], v243 offset:39424
 v_mfma_f32_16x16x32_bf16 v[168:171], a[156:159], a[64:67], v[168:171]
 s_waitcnt lgkmcnt(6)
 v_mfma_f32_16x16x32_bf16 v[144:147], a[160:163], a[72:75], v[144:147]
 ds_read_b64_tr_b16 a[144:145], v242 offset:40960
 ds_read_b64_tr_b16 a[146:147], v242 offset:43008
 v_mfma_f32_16x16x32_bf16 v[148:151], a[160:163], a[76:79], v[148:151]
 s_waitcnt lgkmcnt(6)
 v_mfma_f32_16x16x32_bf16 v[156:159], a[164:167], a[76:79], v[156:159]
 s_add_u32 m0, s64, 139264
 ds_read_b64_tr_b16 a[148:149], v243 offset:40960
 ds_read_b64_tr_b16 a[150:151], v243 offset:43008
 v_mfma_f32_16x16x32_bf16 v[152:155], a[164:167], a[72:75], v[152:155]
 s_waitcnt lgkmcnt(6)
 v_mfma_f32_16x16x32_bf16 v[160:163], a[168:171], a[72:75], v[160:163]
 s_add_u32 s65, s82, 589824
 ds_read_b64_tr_b16 a[152:153], v242 offset:41472
 ds_read_b64_tr_b16 a[154:155], v242 offset:43520
 v_mfma_f32_16x16x32_bf16 v[164:167], a[168:171], a[76:79], v[164:167]
 s_waitcnt lgkmcnt(6)
 buffer_load_dwordx4 v249, s[36:39], s65 offen lds
 v_mfma_f32_16x16x32_bf16 v[172:175], a[172:175], a[76:79], v[172:175]
 ds_read_b64_tr_b16 a[156:157], v243 offset:41472
 ds_read_b64_tr_b16 a[158:159], v243 offset:43520
 v_mfma_f32_16x16x32_bf16 v[168:171], a[172:175], a[72:75], v[168:171]
 s_waitcnt lgkmcnt(6)
 v_mfma_f32_16x16x32_bf16 v[144:147], a[144:147], a[80:83], v[144:147]
 ds_read_b64_tr_b16 a[160:161], v242 offset:45056
 ds_read_b64_tr_b16 a[162:163], v242 offset:47104
 v_mfma_f32_16x16x32_bf16 v[148:151], a[144:147], a[84:87], v[148:151]
 s_waitcnt lgkmcnt(6)
 v_mfma_f32_16x16x32_bf16 v[156:159], a[148:151], a[84:87], v[156:159]
 s_add_u32 m0, s64, 143360
 ds_read_b64_tr_b16 a[164:165], v243 offset:45056
 ds_read_b64_tr_b16 a[166:167], v243 offset:47104
 v_mfma_f32_16x16x32_bf16 v[152:155], a[148:151], a[80:83], v[152:155]
 s_waitcnt lgkmcnt(6)
 v_mfma_f32_16x16x32_bf16 v[160:163], a[152:155], a[80:83], v[160:163]
 s_add_u32 s65, s82, 626688
 ds_read_b64_tr_b16 a[168:169], v242 offset:45568
 ds_read_b64_tr_b16 a[170:171], v242 offset:47616
 v_mfma_f32_16x16x32_bf16 v[164:167], a[152:155], a[84:87], v[164:167]
 s_waitcnt lgkmcnt(6)
 buffer_load_dwordx4 v249, s[36:39], s65 offen lds
 v_mfma_f32_16x16x32_bf16 v[172:175], a[156:159], a[84:87], v[172:175]
 ds_read_b64_tr_b16 a[172:173], v243 offset:45568
 ds_read_b64_tr_b16 a[174:175], v243 offset:47616
 v_mfma_f32_16x16x32_bf16 v[168:171], a[156:159], a[80:83], v[168:171]
 s_waitcnt lgkmcnt(6)
 v_mfma_f32_16x16x32_bf16 v[144:147], a[160:163], a[88:91], v[144:147]
 s_waitcnt vmcnt(22)
 s_barrier
 ds_read_b64_tr_b16 a[144:145], v244 offset:0
 ds_read_b64_tr_b16 a[146:147], v244 offset:2048
 v_mfma_f32_16x16x32_bf16 v[148:151], a[160:163], a[92:95], v[148:151]
 s_waitcnt lgkmcnt(6)
 v_mfma_f32_16x16x32_bf16 v[156:159], a[164:167], a[92:95], v[156:159]
 s_add_u32 m0, s64, 0
 ds_read_b64_tr_b16 a[148:149], v245 offset:0
 ds_read_b64_tr_b16 a[150:151], v245 offset:2048
 v_mfma_f32_16x16x32_bf16 v[152:155], a[164:167], a[88:91], v[152:155]
 s_waitcnt lgkmcnt(6)
 v_mfma_f32_16x16x32_bf16 v[160:163], a[168:171], a[88:91], v[160:163]
 s_add_u32 s65, s83, 0
 ds_read_b64_tr_b16 a[152:153], v244 offset:512
 ds_read_b64_tr_b16 a[154:155], v244 offset:2560
 v_mfma_f32_16x16x32_bf16 v[164:167], a[168:171], a[92:95], v[164:167]
 s_waitcnt lgkmcnt(6)
 buffer_load_dwordx4 v249, s[36:39], s65 offen lds
 v_mfma_f32_16x16x32_bf16 v[172:175], a[172:175], a[92:95], v[172:175]
 ds_read_b64_tr_b16 a[156:157], v245 offset:512
 ds_read_b64_tr_b16 a[158:159], v245 offset:2560
 v_mfma_f32_16x16x32_bf16 v[168:171], a[172:175], a[88:91], v[168:171]
 s_waitcnt lgkmcnt(6)
 v_mfma_f32_16x16x32_bf16 v[144:147], a[144:147], a[96:99], v[144:147]
 ds_read_b64_tr_b16 a[160:161], v244 offset:4096
 ds_read_b64_tr_b16 a[162:163], v244 offset:6144
 v_mfma_f32_16x16x32_bf16 v[148:151], a[144:147], a[100:103], v[148:151]
 s_waitcnt lgkmcnt(6)
 v_mfma_f32_16x16x32_bf16 v[156:159], a[148:151], a[100:103], v[156:159]
 s_add_u32 m0, s64, 4096
 ds_read_b64_tr_b16 a[164:165], v245 offset:4096
 ds_read_b64_tr_b16 a[166:167], v245 offset:6144
 v_mfma_f32_16x16x32_bf16 v[152:155], a[148:151], a[96:99], v[152:155]
 s_waitcnt lgkmcnt(6)
 v_mfma_f32_16x16x32_bf16 v[160:163], a[152:155], a[96:99], v[160:163]
 s_add_u32 s65, s83, 36864
 ds_read_b64_tr_b16 a[168:169], v244 offset:4608
 ds_read_b64_tr_b16 a[170:171], v244 offset:6656
 v_mfma_f32_16x16x32_bf16 v[164:167], a[152:155], a[100:103], v[164:167]
 s_waitcnt lgkmcnt(6)
 buffer_load_dwordx4 v249, s[36:39], s65 offen lds
 v_mfma_f32_16x16x32_bf16 v[172:175], a[156:159], a[100:103], v[172:175]
 s_waitcnt vmcnt(8)
 ds_read_b64_tr_b16 a[172:173], v245 offset:4608
 ds_read_b64_tr_b16 a[174:175], v245 offset:6656
 v_mfma_f32_16x16x32_bf16 v[168:171], a[156:159], a[96:99], v[168:171]
 s_waitcnt lgkmcnt(6)
 s_lshl2_add_u32 s69, s80, s3
 v_mfma_f32_16x16x32_bf16 v[144:147], a[160:163], a[104:107], v[144:147]
 ds_read_b64_tr_b16 a[144:145], v244 offset:8192
 ds_read_b64_tr_b16 a[146:147], v244 offset:10240
 v_mfma_f32_16x16x32_bf16 v[148:151], a[160:163], a[108:111], v[148:151]
 s_waitcnt lgkmcnt(6)
 buffer_store_byte v252, v101, s[56:59], s69 offen sc1
 v_mfma_f32_16x16x32_bf16 v[156:159], a[164:167], a[108:111], v[156:159]
 s_add_u32 m0, s64, 8192
 ds_read_b64_tr_b16 a[148:149], v245 offset:8192
 ds_read_b64_tr_b16 a[150:151], v245 offset:10240
 v_mfma_f32_16x16x32_bf16 v[152:155], a[164:167], a[104:107], v[152:155]
 s_waitcnt lgkmcnt(6)
 v_mfma_f32_16x16x32_bf16 v[160:163], a[168:171], a[104:107], v[160:163]
 s_add_u32 s65, s83, 73728
 ds_read_b64_tr_b16 a[152:153], v244 offset:8704
 ds_read_b64_tr_b16 a[154:155], v244 offset:10752
 v_mfma_f32_16x16x32_bf16 v[164:167], a[168:171], a[108:111], v[164:167]
 s_waitcnt lgkmcnt(6)
 buffer_load_dwordx4 v249, s[36:39], s65 offen lds
 v_mfma_f32_16x16x32_bf16 v[172:175], a[172:175], a[108:111], v[172:175]
 ds_read_b64_tr_b16 a[156:157], v245 offset:8704
 ds_read_b64_tr_b16 a[158:159], v245 offset:10752
 v_mfma_f32_16x16x32_bf16 v[168:171], a[172:175], a[104:107], v[168:171]
 s_waitcnt lgkmcnt(6)
 v_mfma_f32_16x16x32_bf16 v[144:147], a[144:147], v[208:211], v[144:147]
 ds_read_b64_tr_b16 a[160:161], v244 offset:12288
 ds_read_b64_tr_b16 a[162:163], v244 offset:14336
 v_mfma_f32_16x16x32_bf16 v[148:151], a[144:147], v[212:215], v[148:151]
 s_waitcnt lgkmcnt(6)
 v_mfma_f32_16x16x32_bf16 v[156:159], a[148:151], v[212:215], v[156:159]
 s_add_u32 m0, s64, 12288
 ds_read_b64_tr_b16 a[164:165], v245 offset:12288
 ds_read_b64_tr_b16 a[166:167], v245 offset:14336
 v_mfma_f32_16x16x32_bf16 v[152:155], a[148:151], v[208:211], v[152:155]
 s_waitcnt lgkmcnt(6)
 v_mfma_f32_16x16x32_bf16 v[160:163], a[152:155], v[208:211], v[160:163]
 s_add_u32 s65, s83, 110592
 ds_read_b64_tr_b16 a[168:169], v244 offset:12800
 ds_read_b64_tr_b16 a[170:171], v244 offset:14848
 v_mfma_f32_16x16x32_bf16 v[164:167], a[152:155], v[212:215], v[164:167]
 s_waitcnt lgkmcnt(6)
 buffer_load_dwordx4 v249, s[36:39], s65 offen lds
 v_mfma_f32_16x16x32_bf16 v[172:175], a[156:159], v[212:215], v[172:175]
 ds_read_b64_tr_b16 a[172:173], v245 offset:12800
 ds_read_b64_tr_b16 a[174:175], v245 offset:14848
 v_mfma_f32_16x16x32_bf16 v[168:171], a[156:159], v[208:211], v[168:171]
 s_waitcnt lgkmcnt(6)
 v_mfma_f32_16x16x32_bf16 v[144:147], a[160:163], v[216:219], v[144:147]
 ds_read_b64_tr_b16 a[144:145], v244 offset:16384
 ds_read_b64_tr_b16 a[146:147], v244 offset:18432
 v_mfma_f32_16x16x32_bf16 v[148:151], a[160:163], v[220:223], v[148:151]
 s_waitcnt lgkmcnt(6)
 v_mfma_f32_16x16x32_bf16 v[156:159], a[164:167], v[220:223], v[156:159]
 s_add_u32 m0, s64, 16384
 ds_read_b64_tr_b16 a[148:149], v245 offset:16384
 ds_read_b64_tr_b16 a[150:151], v245 offset:18432
 v_mfma_f32_16x16x32_bf16 v[152:155], a[164:167], v[216:219], v[152:155]
 s_waitcnt lgkmcnt(6)
 v_mfma_f32_16x16x32_bf16 v[160:163], a[168:171], v[216:219], v[160:163]
 s_add_u32 s65, s83, 147456
 ds_read_b64_tr_b16 a[152:153], v244 offset:16896
 ds_read_b64_tr_b16 a[154:155], v244 offset:18944
 v_mfma_f32_16x16x32_bf16 v[164:167], a[168:171], v[220:223], v[164:167]
 s_waitcnt lgkmcnt(6)
 buffer_load_dwordx4 v249, s[36:39], s65 offen lds
 v_mfma_f32_16x16x32_bf16 v[172:175], a[172:175], v[220:223], v[172:175]
 ds_read_b64_tr_b16 a[156:157], v245 offset:16896
 ds_read_b64_tr_b16 a[158:159], v245 offset:18944
 v_mfma_f32_16x16x32_bf16 v[168:171], a[172:175], v[216:219], v[168:171]
 s_waitcnt lgkmcnt(6)
 v_mfma_f32_16x16x32_bf16 v[144:147], a[144:147], v[0:3], v[144:147]
 ds_read_b64_tr_b16 a[160:161], v244 offset:20480
 ds_read_b64_tr_b16 a[162:163], v244 offset:22528
 v_mfma_f32_16x16x32_bf16 v[148:151], a[144:147], v[4:7], v[148:151]
 s_waitcnt lgkmcnt(6)
 v_mfma_f32_16x16x32_bf16 v[156:159], a[148:151], v[4:7], v[156:159]
 s_add_u32 m0, s64, 20480
 ds_read_b64_tr_b16 a[164:165], v245 offset:20480
 ds_read_b64_tr_b16 a[166:167], v245 offset:22528
 v_mfma_f32_16x16x32_bf16 v[152:155], a[148:151], v[0:3], v[152:155]
 s_waitcnt lgkmcnt(6)
 v_mfma_f32_16x16x32_bf16 v[160:163], a[152:155], v[0:3], v[160:163]
 s_add_u32 s65, s83, 184320
 ds_read_b64_tr_b16 a[168:169], v244 offset:20992
 ds_read_b64_tr_b16 a[170:171], v244 offset:23040
 v_mfma_f32_16x16x32_bf16 v[164:167], a[152:155], v[4:7], v[164:167]
 s_waitcnt lgkmcnt(6)
 buffer_load_dwordx4 v249, s[36:39], s65 offen lds
 v_mfma_f32_16x16x32_bf16 v[172:175], a[156:159], v[4:7], v[172:175]
 ds_read_b64_tr_b16 a[172:173], v245 offset:20992
 ds_read_b64_tr_b16 a[174:175], v245 offset:23040
 v_mfma_f32_16x16x32_bf16 v[168:171], a[156:159], v[0:3], v[168:171]
 s_waitcnt lgkmcnt(6)
 v_mfma_f32_16x16x32_bf16 v[144:147], a[160:163], v[8:11], v[144:147]
 s_barrier
 ds_read_b64_tr_b16 a[144:145], v244 offset:24576
 ds_read_b64_tr_b16 a[146:147], v244 offset:26624
 v_mfma_f32_16x16x32_bf16 v[148:151], a[160:163], v[12:15], v[148:151]
 s_waitcnt lgkmcnt(6)
 v_mfma_f32_16x16x32_bf16 v[156:159], a[164:167], v[12:15], v[156:159]
 s_add_u32 m0, s64, 24576
 ds_read_b64_tr_b16 a[148:149], v245 offset:24576
 ds_read_b64_tr_b16 a[150:151], v245 offset:26624
 v_mfma_f32_16x16x32_bf16 v[152:155], a[164:167], v[8:11], v[152:155]
 s_waitcnt lgkmcnt(6)
 v_mfma_f32_16x16x32_bf16 v[160:163], a[168:171], v[8:11], v[160:163]
 s_add_u32 s65, s83, 221184
 ds_read_b64_tr_b16 a[152:153], v244 offset:25088
 ds_read_b64_tr_b16 a[154:155], v244 offset:27136
 v_mfma_f32_16x16x32_bf16 v[164:167], a[168:171], v[12:15], v[164:167]
 s_waitcnt lgkmcnt(6)
 buffer_load_dwordx4 v249, s[36:39], s65 offen lds
 v_mfma_f32_16x16x32_bf16 v[172:175], a[172:175], v[12:15], v[172:175]
 ds_read_b64_tr_b16 a[156:157], v245 offset:25088
 ds_read_b64_tr_b16 a[158:159], v245 offset:27136
 v_mfma_f32_16x16x32_bf16 v[168:171], a[172:175], v[8:11], v[168:171]
 s_waitcnt lgkmcnt(6)
 v_mfma_f32_16x16x32_bf16 v[176:179], a[144:147], a[0:3], 0
 ds_read_b64_tr_b16 a[160:161], v244 offset:28672
 ds_read_b64_tr_b16 a[162:163], v244 offset:30720
 v_mfma_f32_16x16x32_bf16 v[180:183], a[144:147], a[4:7], 0
 s_waitcnt lgkmcnt(6)
 v_mfma_f32_16x16x32_bf16 v[188:191], a[148:151], a[4:7], 0
 s_add_u32 m0, s64, 28672
 ds_read_b64_tr_b16 a[164:165], v245 offset:28672
 ds_read_b64_tr_b16 a[166:167], v245 offset:30720
 v_mfma_f32_16x16x32_bf16 v[184:187], a[148:151], a[0:3], 0
 s_waitcnt lgkmcnt(6)
 v_cvt_pk_bf16_f32 v224, v144, v145
 v_cvt_pk_bf16_f32 v225, v146, v147
 v_mfma_f32_16x16x32_bf16 v[192:195], a[152:155], a[0:3], 0
 s_add_u32 s65, s83, 258048
 ds_read_b64_tr_b16 a[168:169], v244 offset:29184
 ds_read_b64_tr_b16 a[170:171], v244 offset:31232
 v_mfma_f32_16x16x32_bf16 v[196:199], a[152:155], a[4:7], 0
 s_waitcnt lgkmcnt(6)
 buffer_load_dwordx4 v249, s[36:39], s65 offen lds
 v_mfma_f32_16x16x32_bf16 v[204:207], a[156:159], a[4:7], 0
 ds_read_b64_tr_b16 a[172:173], v245 offset:29184
 ds_read_b64_tr_b16 a[174:175], v245 offset:31232
 v_mfma_f32_16x16x32_bf16 v[200:203], a[156:159], a[0:3], 0
 s_waitcnt lgkmcnt(6)
 v_cvt_pk_bf16_f32 v226, v148, v149
 v_cvt_pk_bf16_f32 v227, v150, v151
 v_mfma_f32_16x16x32_bf16 v[176:179], a[160:163], a[8:11], v[176:179]
 ds_read_b64_tr_b16 a[144:145], v244 offset:32768
 ds_read_b64_tr_b16 a[146:147], v244 offset:34816
 v_mfma_f32_16x16x32_bf16 v[180:183], a[160:163], a[12:15], v[180:183]
 s_waitcnt lgkmcnt(6)
 buffer_store_dwordx4 v[224:227], v250, s[56:59], s90 offen offset:0 sc1
 v_mfma_f32_16x16x32_bf16 v[188:191], a[164:167], a[12:15], v[188:191]
 s_add_u32 m0, s64, 32768
 ds_read_b64_tr_b16 a[148:149], v245 offset:32768
 ds_read_b64_tr_b16 a[150:151], v245 offset:34816
 v_mfma_f32_16x16x32_bf16 v[184:187], a[164:167], a[8:11], v[184:187]
 s_waitcnt lgkmcnt(6)
 v_cvt_pk_bf16_f32 v228, v152, v153
 v_cvt_pk_bf16_f32 v229, v154, v155
 v_mfma_f32_16x16x32_bf16 v[192:195], a[168:171], a[8:11], v[192:195]
 s_add_u32 s65, s83, 294912
 ds_read_b64_tr_b16 a[152:153], v244 offset:33280
 ds_read_b64_tr_b16 a[154:155], v244 offset:35328
 v_mfma_f32_16x16x32_bf16 v[196:199], a[168:171], a[12:15], v[196:199]
 s_waitcnt lgkmcnt(6)
 buffer_load_dwordx4 v249, s[36:39], s65 offen lds
 v_mfma_f32_16x16x32_bf16 v[204:207], a[172:175], a[12:15], v[204:207]
 ds_read_b64_tr_b16 a[156:157], v245 offset:33280
 ds_read_b64_tr_b16 a[158:159], v245 offset:35328
 v_mfma_f32_16x16x32_bf16 v[200:203], a[172:175], a[8:11], v[200:203]
 s_waitcnt lgkmcnt(6)
 v_cvt_pk_bf16_f32 v230, v156, v157
 v_cvt_pk_bf16_f32 v231, v158, v159
 v_mfma_f32_16x16x32_bf16 v[176:179], a[144:147], a[16:19], v[176:179]
 ds_read_b64_tr_b16 a[160:161], v244 offset:36864
 ds_read_b64_tr_b16 a[162:163], v244 offset:38912
 v_mfma_f32_16x16x32_bf16 v[180:183], a[144:147], a[20:23], v[180:183]
 s_waitcnt lgkmcnt(6)
 buffer_store_dwordx4 v[228:231], v250, s[56:59], s90 offen offset:1024 sc1
 v_mfma_f32_16x16x32_bf16 v[188:191], a[148:151], a[20:23], v[188:191]
 s_add_u32 m0, s64, 36864
 ds_read_b64_tr_b16 a[164:165], v245 offset:36864
 ds_read_b64_tr_b16 a[166:167], v245 offset:38912
 v_mfma_f32_16x16x32_bf16 v[184:187], a[148:151], a[16:19], v[184:187]
 s_waitcnt lgkmcnt(6)
 v_cvt_pk_bf16_f32 v232, v160, v161
 v_cvt_pk_bf16_f32 v233, v162, v163
 v_mfma_f32_16x16x32_bf16 v[192:195], a[152:155], a[16:19], v[192:195]
 s_add_u32 s65, s83, 331776
 ds_read_b64_tr_b16 a[168:169], v244 offset:37376
 ds_read_b64_tr_b16 a[170:171], v244 offset:39424
 v_mfma_f32_16x16x32_bf16 v[196:199], a[152:155], a[20:23], v[196:199]
 s_waitcnt lgkmcnt(6)
 buffer_load_dwordx4 v249, s[36:39], s65 offen lds
 v_mfma_f32_16x16x32_bf16 v[204:207], a[156:159], a[20:23], v[204:207]
 ds_read_b64_tr_b16 a[172:173], v245 offset:37376
 ds_read_b64_tr_b16 a[174:175], v245 offset:39424
 v_mfma_f32_16x16x32_bf16 v[200:203], a[156:159], a[16:19], v[200:203]
 s_waitcnt lgkmcnt(6)
 v_cvt_pk_bf16_f32 v234, v164, v165
 v_cvt_pk_bf16_f32 v235, v166, v167
 v_mfma_f32_16x16x32_bf16 v[176:179], a[160:163], a[24:27], v[176:179]
 ds_read_b64_tr_b16 a[144:145], v244 offset:40960
 ds_read_b64_tr_b16 a[146:147], v244 offset:43008
 v_mfma_f32_16x16x32_bf16 v[180:183], a[160:163], a[28:31], v[180:183]
 s_waitcnt lgkmcnt(6)
 buffer_store_dwordx4 v[232:235], v250, s[56:59], s90 offen offset:2048 sc1
 v_mfma_f32_16x16x32_bf16 v[188:191], a[164:167], a[28:31], v[188:191]
 s_add_u32 m0, s64, 40960
 ds_read_b64_tr_b16 a[148:149], v245 offset:40960
 ds_read_b64_tr_b16 a[150:151], v245 offset:43008
 v_mfma_f32_16x16x32_bf16 v[184:187], a[164:167], a[24:27], v[184:187]
 s_waitcnt lgkmcnt(6)
 v_cvt_pk_bf16_f32 v224, v168, v169
 v_cvt_pk_bf16_f32 v225, v170, v171
 v_mfma_f32_16x16x32_bf16 v[192:195], a[168:171], a[24:27], v[192:195]
 s_add_u32 s65, s83, 368640
 ds_read_b64_tr_b16 a[152:153], v244 offset:41472
 ds_read_b64_tr_b16 a[154:155], v244 offset:43520
 v_mfma_f32_16x16x32_bf16 v[196:199], a[168:171], a[28:31], v[196:199]
 s_waitcnt lgkmcnt(6)
 buffer_load_dwordx4 v249, s[36:39], s65 offen lds
 v_mfma_f32_16x16x32_bf16 v[204:207], a[172:175], a[28:31], v[204:207]
 ds_read_b64_tr_b16 a[156:157], v245 offset:41472
 ds_read_b64_tr_b16 a[158:159], v245 offset:43520
 v_mfma_f32_16x16x32_bf16 v[200:203], a[172:175], a[24:27], v[200:203]
 s_waitcnt lgkmcnt(6)
 v_cvt_pk_bf16_f32 v226, v172, v173
 v_cvt_pk_bf16_f32 v227, v174, v175
 v_mfma_f32_16x16x32_bf16 v[176:179], a[144:147], a[32:35], v[176:179]
 ds_read_b64_tr_b16 a[160:161], v244 offset:45056
 ds_read_b64_tr_b16 a[162:163], v244 offset:47104
 v_mfma_f32_16x16x32_bf16 v[180:183], a[144:147], a[36:39], v[180:183]
 s_waitcnt lgkmcnt(6)
 buffer_store_dwordx4 v[224:227], v250, s[56:59], s90 offen offset:3072 sc1
 v_mfma_f32_16x16x32_bf16 v[188:191], a[148:151], a[36:39], v[188:191]
 s_add_u32 m0, s64, 45056
 ds_read_b64_tr_b16 a[164:165], v245 offset:45056
 ds_read_b64_tr_b16 a[166:167], v245 offset:47104
 v_mfma_f32_16x16x32_bf16 v[184:187], a[148:151], a[32:35], v[184:187]
 s_waitcnt lgkmcnt(6)
 v_accvgpr_read_b32 v224, a224
 v_lshlrev_b32 v16, 16, v224
 v_mfma_f32_16x16x32_bf16 v[192:195], a[152:155], a[32:35], v[192:195]
 s_add_u32 s65, s83, 405504
 ds_read_b64_tr_b16 a[168:169], v244 offset:45568
 ds_read_b64_tr_b16 a[170:171], v244 offset:47616
 v_mfma_f32_16x16x32_bf16 v[196:199], a[152:155], a[36:39], v[196:199]
 s_waitcnt lgkmcnt(6)
 buffer_load_dwordx4 v249, s[36:39], s65 offen lds
 v_mfma_f32_16x16x32_bf16 v[204:207], a[156:159], a[36:39], v[204:207]
 ds_read_b64_tr_b16 a[172:173], v245 offset:45568
 ds_read_b64_tr_b16 a[174:175], v245 offset:47616
 v_mfma_f32_16x16x32_bf16 v[200:203], a[156:159], a[32:35], v[200:203]
 s_waitcnt lgkmcnt(6)
 v_and_b32 v17, s97, v224
 v_accvgpr_read_b32 v225, a225
 v_mfma_f32_16x16x32_bf16 v[176:179], a[160:163], a[40:43], v[176:179]
 s_barrier
 ds_read_b64_tr_b16 a[144:145], v246 offset:0
 ds_read_b64_tr_b16 a[146:147], v246 offset:2048
 v_mfma_f32_16x16x32_bf16 v[180:183], a[160:163], a[44:47], v[180:183]
 s_waitcnt lgkmcnt(6)
 v_lshlrev_b32 v18, 16, v225
 v_and_b32 v19, s97, v225
 v_mfma_f32_16x16x32_bf16 v[188:191], a[164:167], a[44:47], v[188:191]
 s_add_u32 m0, s64, 49152
 ds_read_b64_tr_b16 a[148:149], v247 offset:0
 ds_read_b64_tr_b16 a[150:151], v247 offset:2048
 v_mfma_f32_16x16x32_bf16 v[184:187], a[164:167], a[40:43], v[184:187]
 s_waitcnt lgkmcnt(6)
 v_accvgpr_read_b32 v224, a226
 v_lshlrev_b32 v20, 16, v224
 v_mfma_f32_16x16x32_bf16 v[192:195], a[168:171], a[40:43], v[192:195]
 s_add_u32 s65, s83, 442368
 ds_read_b64_tr_b16 a[152:153], v246 offset:512
 ds_read_b64_tr_b16 a[154:155], v246 offset:2560
 v_mfma_f32_16x16x32_bf16 v[196:199], a[168:171], a[44:47], v[196:199]
 s_waitcnt lgkmcnt(6)
 buffer_load_dwordx4 v249, s[36:39], s65 offen lds
 v_mfma_f32_16x16x32_bf16 v[204:207], a[172:175], a[44:47], v[204:207]
 ds_read_b64_tr_b16 a[156:157], v247 offset:512
 ds_read_b64_tr_b16 a[158:159], v247 offset:2560
 v_mfma_f32_16x16x32_bf16 v[200:203], a[172:175], a[40:43], v[200:203]
 s_waitcnt lgkmcnt(6)
 v_and_b32 v21, s97, v224
 v_accvgpr_read_b32 v225, a227
 v_mfma_f32_16x16x32_bf16 v[176:179], a[144:147], a[48:51], v[176:179]
 ds_read_b64_tr_b16 a[160:161], v246 offset:4096
 ds_read_b64_tr_b16 a[162:163], v246 offset:6144
 v_mfma_f32_16x16x32_bf16 v[180:183], a[144:147], a[52:55], v[180:183]
 s_waitcnt lgkmcnt(6)
 v_lshlrev_b32 v22, 16, v225
 v_and_b32 v23, s97, v225
 v_mfma_f32_16x16x32_bf16 v[188:191], a[148:151], a[52:55], v[188:191]
 s_add_u32 m0, s64, 53248
 ds_read_b64_tr_b16 a[164:165], v247 offset:4096
 ds_read_b64_tr_b16 a[166:167], v247 offset:6144
 v_mfma_f32_16x16x32_bf16 v[184:187], a[148:151], a[48:51], v[184:187]
 s_waitcnt lgkmcnt(6)
 v_accvgpr_read_b32 v224, a228
 v_lshlrev_b32 v24, 16, v224
 v_mfma_f32_16x16x32_bf16 v[192:195], a[152:155], a[48:51], v[192:195]
 s_add_u32 s65, s83, 479232
 ds_read_b64_tr_b16 a[168:169], v246 offset:4608
 ds_read_b64_tr_b16 a[170:171], v246 offset:6656
 v_mfma_f32_16x16x32_bf16 v[196:199], a[152:155], a[52:55], v[196:199]
 s_waitcnt lgkmcnt(6)
 buffer_load_dwordx4 v249, s[36:39], s65 offen lds
 v_mfma_f32_16x16x32_bf16 v[204:207], a[156:159], a[52:55], v[204:207]
 ds_read_b64_tr_b16 a[172:173], v247 offset:4608
 ds_read_b64_tr_b16 a[174:175], v247 offset:6656
 v_mfma_f32_16x16x32_bf16 v[200:203], a[156:159], a[48:51], v[200:203]
 s_waitcnt lgkmcnt(6)
 v_and_b32 v25, s97, v224
 v_accvgpr_read_b32 v225, a229
 v_mfma_f32_16x16x32_bf16 v[176:179], a[160:163], a[56:59], v[176:179]
 ds_read_b64_tr_b16 a[144:145], v246 offset:8192
 ds_read_b64_tr_b16 a[146:147], v246 offset:10240
 v_mfma_f32_16x16x32_bf16 v[180:183], a[160:163], a[60:63], v[180:183]
 s_waitcnt lgkmcnt(6)
 v_lshlrev_b32 v26, 16, v225
 v_and_b32 v27, s97, v225
 v_mfma_f32_16x16x32_bf16 v[188:191], a[164:167], a[60:63], v[188:191]
 s_add_u32 m0, s64, 57344
 ds_read_b64_tr_b16 a[148:149], v247 offset:8192
 ds_read_b64_tr_b16 a[150:151], v247 offset:10240
 v_mfma_f32_16x16x32_bf16 v[184:187], a[164:167], a[56:59], v[184:187]
 s_waitcnt lgkmcnt(6)
 v_accvgpr_read_b32 v224, a230
 v_lshlrev_b32 v28, 16, v224
 v_mfma_f32_16x16x32_bf16 v[192:195], a[168:171], a[56:59], v[192:195]
 s_add_u32 s65, s83, 516096
 ds_read_b64_tr_b16 a[152:153], v246 offset:8704
 ds_read_b64_tr_b16 a[154:155], v246 offset:10752
 v_mfma_f32_16x16x32_bf16 v[196:199], a[168:171], a[60:63], v[196:199]
 s_waitcnt lgkmcnt(6)
 buffer_load_dwordx4 v249, s[36:39], s65 offen lds
 v_mfma_f32_16x16x32_bf16 v[204:207], a[172:175], a[60:63], v[204:207]
 ds_read_b64_tr_b16 a[156:157], v247 offset:8704
 ds_read_b64_tr_b16 a[158:159], v247 offset:10752
 v_mfma_f32_16x16x32_bf16 v[200:203], a[172:175], a[56:59], v[200:203]
 s_waitcnt lgkmcnt(6)
 v_and_b32 v29, s97, v224
 v_accvgpr_read_b32 v225, a231
 v_mfma_f32_16x16x32_bf16 v[176:179], a[144:147], a[64:67], v[176:179]
 ds_read_b64_tr_b16 a[160:161], v246 offset:12288
 ds_read_b64_tr_b16 a[162:163], v246 offset:14336
 v_mfma_f32_16x16x32_bf16 v[180:183], a[144:147], a[68:71], v[180:183]
 s_waitcnt lgkmcnt(6)
 v_lshlrev_b32 v30, 16, v225
 v_and_b32 v31, s97, v225
 v_mfma_f32_16x16x32_bf16 v[188:191], a[148:151], a[68:71], v[188:191]
 s_add_u32 m0, s64, 61440
 ds_read_b64_tr_b16 a[164:165], v247 offset:12288
 ds_read_b64_tr_b16 a[166:167], v247 offset:14336
 v_mfma_f32_16x16x32_bf16 v[184:187], a[148:151], a[64:67], v[184:187]
 s_waitcnt lgkmcnt(6)
 v_accvgpr_read_b32 v224, a232
 v_lshlrev_b32 v32, 16, v224
 v_mfma_f32_16x16x32_bf16 v[192:195], a[152:155], a[64:67], v[192:195]
 s_add_u32 s65, s83, 552960
 ds_read_b64_tr_b16 a[168:169], v246 offset:12800
 ds_read_b64_tr_b16 a[170:171], v246 offset:14848
 v_mfma_f32_16x16x32_bf16 v[196:199], a[152:155], a[68:71], v[196:199]
 s_waitcnt lgkmcnt(6)
 buffer_load_dwordx4 v249, s[36:39], s65 offen lds
 v_mfma_f32_16x16x32_bf16 v[204:207], a[156:159], a[68:71], v[204:207]
 ds_read_b64_tr_b16 a[172:173], v247 offset:12800
 ds_read_b64_tr_b16 a[174:175], v247 offset:14848
 v_mfma_f32_16x16x32_bf16 v[200:203], a[156:159], a[64:67], v[200:203]
 s_waitcnt lgkmcnt(6)
 v_and_b32 v33, s97, v224
 v_accvgpr_read_b32 v225, a233
 v_mfma_f32_16x16x32_bf16 v[176:179], a[160:163], a[72:75], v[176:179]
 ds_read_b64_tr_b16 a[144:145], v246 offset:16384
 ds_read_b64_tr_b16 a[146:147], v246 offset:18432
 v_mfma_f32_16x16x32_bf16 v[180:183], a[160:163], a[76:79], v[180:183]
 s_waitcnt lgkmcnt(6)
 v_lshlrev_b32 v34, 16, v225
 v_and_b32 v35, s97, v225
 v_mfma_f32_16x16x32_bf16 v[188:191], a[164:167], a[76:79], v[188:191]
 s_add_u32 m0, s64, 65536
 ds_read_b64_tr_b16 a[148:149], v247 offset:16384
 ds_read_b64_tr_b16 a[150:151], v247 offset:18432
 v_mfma_f32_16x16x32_bf16 v[184:187], a[164:167], a[72:75], v[184:187]
 s_waitcnt lgkmcnt(6)
 v_accvgpr_read_b32 v224, a234
 v_lshlrev_b32 v36, 16, v224
 v_mfma_f32_16x16x32_bf16 v[192:195], a[168:171], a[72:75], v[192:195]
 s_add_u32 s65, s83, 589824
 ds_read_b64_tr_b16 a[152:153], v246 offset:16896
 ds_read_b64_tr_b16 a[154:155], v246 offset:18944
 v_mfma_f32_16x16x32_bf16 v[196:199], a[168:171], a[76:79], v[196:199]
 s_waitcnt lgkmcnt(6)
 buffer_load_dwordx4 v249, s[36:39], s65 offen lds
 v_mfma_f32_16x16x32_bf16 v[204:207], a[172:175], a[76:79], v[204:207]
 ds_read_b64_tr_b16 a[156:157], v247 offset:16896
 ds_read_b64_tr_b16 a[158:159], v247 offset:18944
 v_mfma_f32_16x16x32_bf16 v[200:203], a[172:175], a[72:75], v[200:203]
 s_waitcnt lgkmcnt(6)
 v_and_b32 v37, s97, v224
 v_accvgpr_read_b32 v225, a235
 v_mfma_f32_16x16x32_bf16 v[176:179], a[144:147], a[80:83], v[176:179]
 ds_read_b64_tr_b16 a[160:161], v246 offset:20480
 ds_read_b64_tr_b16 a[162:163], v246 offset:22528
 v_mfma_f32_16x16x32_bf16 v[180:183], a[144:147], a[84:87], v[180:183]
 s_waitcnt lgkmcnt(6)
 v_lshlrev_b32 v38, 16, v225
 v_and_b32 v39, s97, v225
 v_mfma_f32_16x16x32_bf16 v[188:191], a[148:151], a[84:87], v[188:191]
 s_add_u32 m0, s64, 69632
 ds_read_b64_tr_b16 a[164:165], v247 offset:20480
 ds_read_b64_tr_b16 a[166:167], v247 offset:22528
 v_mfma_f32_16x16x32_bf16 v[184:187], a[148:151], a[80:83], v[184:187]
 s_waitcnt lgkmcnt(6)
 v_accvgpr_read_b32 v224, a236
 v_mfma_f32_16x16x32_bf16 v[192:195], a[152:155], a[80:83], v[192:195]
 s_add_u32 s65, s83, 626688
 ds_read_b64_tr_b16 a[168:169], v246 offset:20992
 ds_read_b64_tr_b16 a[170:171], v246 offset:23040
 v_mfma_f32_16x16x32_bf16 v[196:199], a[152:155], a[84:87], v[196:199]
 s_waitcnt lgkmcnt(6)
 buffer_load_dwordx4 v249, s[36:39], s65 offen lds
 v_mfma_f32_16x16x32_bf16 v[204:207], a[156:159], a[84:87], v[204:207]
 ds_read_b64_tr_b16 a[172:173], v247 offset:20992
 ds_read_b64_tr_b16 a[174:175], v247 offset:23040
 v_mfma_f32_16x16x32_bf16 v[200:203], a[156:159], a[80:83], v[200:203]
 s_waitcnt lgkmcnt(6)
 v_mfma_f32_16x16x32_bf16 v[176:179], a[160:163], a[88:91], v[176:179]
 s_waitcnt vmcnt(23)
 s_barrier
 ds_read_b64_tr_b16 a[144:145], v246 offset:24576
 ds_read_b64_tr_b16 a[146:147], v246 offset:26624
 v_mfma_f32_16x16x32_bf16 v[180:183], a[160:163], a[92:95], v[180:183]
 s_waitcnt lgkmcnt(6)
 v_mfma_f32_16x16x32_bf16 v[188:191], a[164:167], a[92:95], v[188:191]
 s_add_u32 m0, s64, 73728
 ds_read_b64_tr_b16 a[148:149], v247 offset:24576
 ds_read_b64_tr_b16 a[150:151], v247 offset:26624
 v_mfma_f32_16x16x32_bf16 v[184:187], a[164:167], a[88:91], v[184:187]
 s_waitcnt lgkmcnt(6)
 v_mfma_f32_16x16x32_bf16 v[192:195], a[168:171], a[88:91], v[192:195]
 s_add_u32 s65, s84, 0
 ds_read_b64_tr_b16 a[152:153], v246 offset:25088
 ds_read_b64_tr_b16 a[154:155], v246 offset:27136
 v_mfma_f32_16x16x32_bf16 v[196:199], a[168:171], a[92:95], v[196:199]
 s_waitcnt lgkmcnt(6)
 buffer_load_dwordx4 v249, s[36:39], s65 offen lds
 v_mfma_f32_16x16x32_bf16 v[204:207], a[172:175], a[92:95], v[204:207]
 ds_read_b64_tr_b16 a[156:157], v247 offset:25088
 ds_read_b64_tr_b16 a[158:159], v247 offset:27136
 v_mfma_f32_16x16x32_bf16 v[200:203], a[172:175], a[88:91], v[200:203]
 s_waitcnt lgkmcnt(6)
 v_mfma_f32_16x16x32_bf16 v[176:179], a[144:147], a[96:99], v[176:179]
 ds_read_b64_tr_b16 a[160:161], v246 offset:28672
 ds_read_b64_tr_b16 a[162:163], v246 offset:30720
 v_mfma_f32_16x16x32_bf16 v[180:183], a[144:147], a[100:103], v[180:183]
 s_waitcnt lgkmcnt(6)
 v_mfma_f32_16x16x32_bf16 v[188:191], a[148:151], a[100:103], v[188:191]
 s_add_u32 m0, s64, 77824
 ds_read_b64_tr_b16 a[164:165], v247 offset:28672
 ds_read_b64_tr_b16 a[166:167], v247 offset:30720
 v_mfma_f32_16x16x32_bf16 v[184:187], a[148:151], a[96:99], v[184:187]
 s_waitcnt lgkmcnt(6)
 v_mfma_f32_16x16x32_bf16 v[192:195], a[152:155], a[96:99], v[192:195]
 s_add_u32 s65, s84, 36864
 ds_read_b64_tr_b16 a[168:169], v246 offset:29184
 ds_read_b64_tr_b16 a[170:171], v246 offset:31232
 v_mfma_f32_16x16x32_bf16 v[196:199], a[152:155], a[100:103], v[196:199]
 s_waitcnt lgkmcnt(6)
 buffer_load_dwordx4 v249, s[36:39], s65 offen lds
 v_mfma_f32_16x16x32_bf16 v[204:207], a[156:159], a[100:103], v[204:207]
 s_waitcnt vmcnt(9)
 ds_read_b64_tr_b16 a[172:173], v247 offset:29184
 ds_read_b64_tr_b16 a[174:175], v247 offset:31232
 v_mfma_f32_16x16x32_bf16 v[200:203], a[156:159], a[96:99], v[200:203]
 s_waitcnt lgkmcnt(6)
 s_lshl2_add_u32 s69, s81, s3
 v_mfma_f32_16x16x32_bf16 v[176:179], a[160:163], a[104:107], v[176:179]
 ds_read_b64_tr_b16 a[144:145], v246 offset:32768
 ds_read_b64_tr_b16 a[146:147], v246 offset:34816
 v_mfma_f32_16x16x32_bf16 v[180:183], a[160:163], a[108:111], v[180:183]
 s_waitcnt lgkmcnt(6)
 buffer_store_byte v252, v101, s[56:59], s69 offen sc1
 v_mfma_f32_16x16x32_bf16 v[188:191], a[164:167], a[108:111], v[188:191]
 s_add_u32 m0, s64, 81920
 ds_read_b64_tr_b16 a[148:149], v247 offset:32768
 ds_read_b64_tr_b16 a[150:151], v247 offset:34816
 v_mfma_f32_16x16x32_bf16 v[184:187], a[164:167], a[104:107], v[184:187]
 s_waitcnt lgkmcnt(6)
 v_lshlrev_b32 v40, 16, v224
 v_and_b32 v41, s97, v224
 v_mfma_f32_16x16x32_bf16 v[192:195], a[168:171], a[104:107], v[192:195]
 s_add_u32 s65, s84, 73728
 ds_read_b64_tr_b16 a[152:153], v246 offset:33280
 ds_read_b64_tr_b16 a[154:155], v246 offset:35328
 v_mfma_f32_16x16x32_bf16 v[196:199], a[168:171], a[108:111], v[196:199]
 s_waitcnt lgkmcnt(6)
 buffer_load_dwordx4 v249, s[36:39], s65 offen lds
 v_mfma_f32_16x16x32_bf16 v[204:207], a[172:175], a[108:111], v[204:207]
 ds_read_b64_tr_b16 a[156:157], v247 offset:33280
 ds_read_b64_tr_b16 a[158:159], v247 offset:35328
 v_mfma_f32_16x16x32_bf16 v[200:203], a[172:175], a[104:107], v[200:203]
 s_waitcnt lgkmcnt(6)
 v_accvgpr_read_b32 v225, a237
 v_lshlrev_b32 v42, 16, v225
 v_mfma_f32_16x16x32_bf16 v[176:179], a[144:147], v[208:211], v[176:179]
 ds_read_b64_tr_b16 a[160:161], v246 offset:36864
 ds_read_b64_tr_b16 a[162:163], v246 offset:38912
 v_mfma_f32_16x16x32_bf16 v[180:183], a[144:147], v[212:215], v[180:183]
 s_waitcnt lgkmcnt(6)
 v_and_b32 v43, s97, v225
 v_accvgpr_read_b32 v224, a238
 v_mfma_f32_16x16x32_bf16 v[188:191], a[148:151], v[212:215], v[188:191]
 s_add_u32 m0, s64, 86016
 ds_read_b64_tr_b16 a[164:165], v247 offset:36864
 ds_read_b64_tr_b16 a[166:167], v247 offset:38912
 v_mfma_f32_16x16x32_bf16 v[184:187], a[148:151], v[208:211], v[184:187]
 s_waitcnt lgkmcnt(6)
 v_lshlrev_b32 v44, 16, v224
 v_and_b32 v45, s97, v224
 v_mfma_f32_16x16x32_bf16 v[192:195], a[152:155], v[208:211], v[192:195]
 s_add_u32 s65, s84, 110592
 ds_read_b64_tr_b16 a[168:169], v246 offset:37376
 ds_read_b64_tr_b16 a[170:171], v246 offset:39424
 v_mfma_f32_16x16x32_bf16 v[196:199], a[152:155], v[212:215], v[196:199]
 s_waitcnt lgkmcnt(6)
 buffer_load_dwordx4 v249, s[36:39], s65 offen lds
 v_mfma_f32_16x16x32_bf16 v[204:207], a[156:159], v[212:215], v[204:207]
 ds_read_b64_tr_b16 a[172:173], v247 offset:37376
 ds_read_b64_tr_b16 a[174:175], v247 offset:39424
 v_mfma_f32_16x16x32_bf16 v[200:203], a[156:159], v[208:211], v[200:203]
 s_waitcnt lgkmcnt(6)
 v_accvgpr_read_b32 v225, a239
 v_lshlrev_b32 v46, 16, v225
 v_mfma_f32_16x16x32_bf16 v[176:179], a[160:163], v[216:219], v[176:179]
 ds_read_b64_tr_b16 a[144:145], v246 offset:40960
 ds_read_b64_tr_b16 a[146:147], v246 offset:43008
 v_mfma_f32_16x16x32_bf16 v[180:183], a[160:163], v[220:223], v[180:183]
 s_waitcnt lgkmcnt(6)
 v_and_b32 v47, s97, v225
 v_mfma_f32_16x16x32_bf16 v[188:191], a[164:167], v[220:223], v[188:191]
 s_add_u32 m0, s64, 90112
 ds_read_b64_tr_b16 a[148:149], v247 offset:40960
 ds_read_b64_tr_b16 a[150:151], v247 offset:43008
 v_mfma_f32_16x16x32_bf16 v[184:187], a[164:167], v[216:219], v[184:187]
 s_waitcnt lgkmcnt(6)
 v_mfma_f32_16x16x32_bf16 v[192:195], a[168:171], v[216:219], v[192:195]
 s_add_u32 s65, s84, 147456
 ds_read_b64_tr_b16 a[152:153], v246 offset:41472
 ds_read_b64_tr_b16 a[154:155], v246 offset:43520
 v_mfma_f32_16x16x32_bf16 v[196:199], a[168:171], v[220:223], v[196:199]
 s_waitcnt lgkmcnt(6)
 buffer_load_dwordx4 v249, s[36:39], s65 offen lds
 v_mfma_f32_16x16x32_bf16 v[204:207], a[172:175], v[220:223], v[204:207]
 ds_read_b64_tr_b16 a[156:157], v247 offset:41472
 ds_read_b64_tr_b16 a[158:159], v247 offset:43520
 v_mfma_f32_16x16x32_bf16 v[200:203], a[172:175], v[216:219], v[200:203]
 s_waitcnt lgkmcnt(6)
 v_mfma_f32_16x16x32_bf16 v[176:179], a[144:147], v[0:3], v[176:179]
 ds_read_b64_tr_b16 a[160:161], v246 offset:45056
 ds_read_b64_tr_b16 a[162:163], v246 offset:47104
 v_mfma_f32_16x16x32_bf16 v[180:183], a[144:147], v[4:7], v[180:183]
 s_waitcnt lgkmcnt(6)
 v_mfma_f32_16x16x32_bf16 v[188:191], a[148:151], v[4:7], v[188:191]
 s_add_u32 m0, s64, 94208
 ds_read_b64_tr_b16 a[164:165], v247 offset:45056
 ds_read_b64_tr_b16 a[166:167], v247 offset:47104
 v_mfma_f32_16x16x32_bf16 v[184:187], a[148:151], v[0:3], v[184:187]
 s_waitcnt lgkmcnt(6)
 v_mfma_f32_16x16x32_bf16 v[192:195], a[152:155], v[0:3], v[192:195]
 s_add_u32 s65, s84, 184320
 ds_read_b64_tr_b16 a[168:169], v246 offset:45568
 ds_read_b64_tr_b16 a[170:171], v246 offset:47616
 v_mfma_f32_16x16x32_bf16 v[196:199], a[152:155], v[4:7], v[196:199]
 s_waitcnt lgkmcnt(6)
 buffer_load_dwordx4 v249, s[36:39], s65 offen lds
 v_mfma_f32_16x16x32_bf16 v[204:207], a[156:159], v[4:7], v[204:207]
 ds_read_b64_tr_b16 a[172:173], v247 offset:45568
 ds_read_b64_tr_b16 a[174:175], v247 offset:47616
 v_mfma_f32_16x16x32_bf16 v[200:203], a[156:159], v[0:3], v[200:203]
 s_waitcnt lgkmcnt(6)
 v_mfma_f32_16x16x32_bf16 v[176:179], a[160:163], v[8:11], v[176:179]
 s_barrier
 ds_read_b64_tr_b16 a[144:145], v242 offset:0
 ds_read_b64_tr_b16 a[146:147], v242 offset:2048
 v_mfma_f32_16x16x32_bf16 v[180:183], a[160:163], v[12:15], v[180:183]
 s_waitcnt lgkmcnt(6)
 v_mfma_f32_16x16x32_bf16 v[188:191], a[164:167], v[12:15], v[188:191]
 s_add_u32 m0, s64, 98304
 ds_read_b64_tr_b16 a[148:149], v243 offset:0
 ds_read_b64_tr_b16 a[150:151], v243 offset:2048
 v_mfma_f32_16x16x32_bf16 v[184:187], a[164:167], v[8:11], v[184:187]
 s_waitcnt lgkmcnt(6)
 v_mfma_f32_16x16x32_bf16 v[192:195], a[168:171], v[8:11], v[192:195]
 s_add_u32 s65, s84, 221184
 ds_read_b64_tr_b16 a[152:153], v242 offset:512
 ds_read_b64_tr_b16 a[154:155], v242 offset:2560
 v_mfma_f32_16x16x32_bf16 v[196:199], a[168:171], v[12:15], v[196:199]
 s_waitcnt lgkmcnt(6)
 buffer_load_dwordx4 v249, s[36:39], s65 offen lds
 v_mfma_f32_16x16x32_bf16 v[204:207], a[172:175], v[12:15], v[204:207]
 ds_read_b64_tr_b16 a[156:157], v243 offset:512
 ds_read_b64_tr_b16 a[158:159], v243 offset:2560
 v_mfma_f32_16x16x32_bf16 v[200:203], a[172:175], v[8:11], v[200:203]
 s_waitcnt lgkmcnt(6)
 v_mfma_f32_16x16x32_bf16 v[144:147], a[144:147], a[0:3], 0
 ds_read_b64_tr_b16 a[160:161], v242 offset:4096
 ds_read_b64_tr_b16 a[162:163], v242 offset:6144
 v_mfma_f32_16x16x32_bf16 v[148:151], a[144:147], a[4:7], 0
 s_waitcnt lgkmcnt(6)
 v_mfma_f32_16x16x32_bf16 v[156:159], a[148:151], a[4:7], 0
 s_add_u32 m0, s64, 102400
 ds_read_b64_tr_b16 a[164:165], v243 offset:4096
 ds_read_b64_tr_b16 a[166:167], v243 offset:6144
 v_mfma_f32_16x16x32_bf16 v[152:155], a[148:151], a[0:3], 0
 s_waitcnt lgkmcnt(6)
 v_cvt_pk_bf16_f32 v224, v176, v177
 v_cvt_pk_bf16_f32 v225, v178, v179
 v_mfma_f32_16x16x32_bf16 v[160:163], a[152:155], a[0:3], 0
 s_add_u32 s65, s84, 258048
 ds_read_b64_tr_b16 a[168:169], v242 offset:4608
 ds_read_b64_tr_b16 a[170:171], v242 offset:6656
 v_mfma_f32_16x16x32_bf16 v[164:167], a[152:155], a[4:7], 0
 s_waitcnt lgkmcnt(6)
 buffer_load_dwordx4 v249, s[36:39], s65 offen lds
 v_mfma_f32_16x16x32_bf16 v[172:175], a[156:159], a[4:7], 0
 ds_read_b64_tr_b16 a[172:173], v243 offset:4608
 ds_read_b64_tr_b16 a[174:175], v243 offset:6656
 v_mfma_f32_16x16x32_bf16 v[168:171], a[156:159], a[0:3], 0
 s_waitcnt lgkmcnt(6)
 v_cvt_pk_bf16_f32 v226, v180, v181
 v_cvt_pk_bf16_f32 v227, v182, v183
 v_mfma_f32_16x16x32_bf16 v[144:147], a[160:163], a[8:11], v[144:147]
 ds_read_b64_tr_b16 a[144:145], v242 offset:8192
 ds_read_b64_tr_b16 a[146:147], v242 offset:10240
 v_mfma_f32_16x16x32_bf16 v[148:151], a[160:163], a[12:15], v[148:151]
 s_waitcnt lgkmcnt(6)
 buffer_store_dwordx4 v[224:227], v250, s[56:59], s91 offen offset:0 sc1
 v_mfma_f32_16x16x32_bf16 v[156:159], a[164:167], a[12:15], v[156:159]
 s_add_u32 m0, s64, 106496
 ds_read_b64_tr_b16 a[148:149], v243 offset:8192
 ds_read_b64_tr_b16 a[150:151], v243 offset:10240
 v_mfma_f32_16x16x32_bf16 v[152:155], a[164:167], a[8:11], v[152:155]
 s_waitcnt lgkmcnt(6)
 v_cvt_pk_bf16_f32 v228, v184, v185
 v_cvt_pk_bf16_f32 v229, v186, v187
 v_mfma_f32_16x16x32_bf16 v[160:163], a[168:171], a[8:11], v[160:163]
 s_add_u32 s65, s84, 294912
 ds_read_b64_tr_b16 a[152:153], v242 offset:8704
 ds_read_b64_tr_b16 a[154:155], v242 offset:10752
 v_mfma_f32_16x16x32_bf16 v[164:167], a[168:171], a[12:15], v[164:167]
 s_waitcnt lgkmcnt(6)
 buffer_load_dwordx4 v249, s[36:39], s65 offen lds
 v_mfma_f32_16x16x32_bf16 v[172:175], a[172:175], a[12:15], v[172:175]
 ds_read_b64_tr_b16 a[156:157], v243 offset:8704
 ds_read_b64_tr_b16 a[158:159], v243 offset:10752
 v_mfma_f32_16x16x32_bf16 v[168:171], a[172:175], a[8:11], v[168:171]
 s_waitcnt lgkmcnt(6)
 v_cvt_pk_bf16_f32 v230, v188, v189
 v_cvt_pk_bf16_f32 v231, v190, v191
 v_mfma_f32_16x16x32_bf16 v[144:147], a[144:147], a[16:19], v[144:147]
 ds_read_b64_tr_b16 a[160:161], v242 offset:12288
 ds_read_b64_tr_b16 a[162:163], v242 offset:14336
 v_mfma_f32_16x16x32_bf16 v[148:151], a[144:147], a[20:23], v[148:151]
 s_waitcnt lgkmcnt(6)
 buffer_store_dwordx4 v[228:231], v250, s[56:59], s91 offen offset:1024 sc1
 v_mfma_f32_16x16x32_bf16 v[156:159], a[148:151], a[20:23], v[156:159]
 s_add_u32 m0, s64, 110592
 ds_read_b64_tr_b16 a[164:165], v243 offset:12288
 ds_read_b64_tr_b16 a[166:167], v243 offset:14336
 v_mfma_f32_16x16x32_bf16 v[152:155], a[148:151], a[16:19], v[152:155]
 s_waitcnt lgkmcnt(6)
 v_cvt_pk_bf16_f32 v232, v192, v193
 v_cvt_pk_bf16_f32 v233, v194, v195
 v_mfma_f32_16x16x32_bf16 v[160:163], a[152:155], a[16:19], v[160:163]
 s_add_u32 s65, s84, 331776
 ds_read_b64_tr_b16 a[168:169], v242 offset:12800
 ds_read_b64_tr_b16 a[170:171], v242 offset:14848
 v_mfma_f32_16x16x32_bf16 v[164:167], a[152:155], a[20:23], v[164:167]
 s_waitcnt lgkmcnt(6)
 buffer_load_dwordx4 v249, s[36:39], s65 offen lds
 v_mfma_f32_16x16x32_bf16 v[172:175], a[156:159], a[20:23], v[172:175]
 ds_read_b64_tr_b16 a[172:173], v243 offset:12800
 ds_read_b64_tr_b16 a[174:175], v243 offset:14848
 v_mfma_f32_16x16x32_bf16 v[168:171], a[156:159], a[16:19], v[168:171]
 s_waitcnt lgkmcnt(6)
 v_cvt_pk_bf16_f32 v234, v196, v197
 v_cvt_pk_bf16_f32 v235, v198, v199
 v_mfma_f32_16x16x32_bf16 v[144:147], a[160:163], a[24:27], v[144:147]
 ds_read_b64_tr_b16 a[144:145], v242 offset:16384
 ds_read_b64_tr_b16 a[146:147], v242 offset:18432
 v_mfma_f32_16x16x32_bf16 v[148:151], a[160:163], a[28:31], v[148:151]
 s_waitcnt lgkmcnt(6)
 buffer_store_dwordx4 v[232:235], v250, s[56:59], s91 offen offset:2048 sc1
 v_mfma_f32_16x16x32_bf16 v[156:159], a[164:167], a[28:31], v[156:159]
 s_add_u32 m0, s64, 114688
 ds_read_b64_tr_b16 a[148:149], v243 offset:16384
 ds_read_b64_tr_b16 a[150:151], v243 offset:18432
 v_mfma_f32_16x16x32_bf16 v[152:155], a[164:167], a[24:27], v[152:155]
 s_waitcnt lgkmcnt(6)
 v_cvt_pk_bf16_f32 v224, v200, v201
 v_cvt_pk_bf16_f32 v225, v202, v203
 v_mfma_f32_16x16x32_bf16 v[160:163], a[168:171], a[24:27], v[160:163]
 s_add_u32 s65, s84, 368640
 ds_read_b64_tr_b16 a[152:153], v242 offset:16896
 ds_read_b64_tr_b16 a[154:155], v242 offset:18944
 v_mfma_f32_16x16x32_bf16 v[164:167], a[168:171], a[28:31], v[164:167]
 s_waitcnt lgkmcnt(6)
 buffer_load_dwordx4 v249, s[36:39], s65 offen lds
 v_mfma_f32_16x16x32_bf16 v[172:175], a[172:175], a[28:31], v[172:175]
 ds_read_b64_tr_b16 a[156:157], v243 offset:16896
 ds_read_b64_tr_b16 a[158:159], v243 offset:18944
 v_mfma_f32_16x16x32_bf16 v[168:171], a[172:175], a[24:27], v[168:171]
 s_waitcnt lgkmcnt(6)
 v_cvt_pk_bf16_f32 v226, v204, v205
 v_cvt_pk_bf16_f32 v227, v206, v207
 v_mfma_f32_16x16x32_bf16 v[144:147], a[144:147], a[32:35], v[144:147]
 ds_read_b64_tr_b16 a[160:161], v242 offset:20480
 ds_read_b64_tr_b16 a[162:163], v242 offset:22528
 v_mfma_f32_16x16x32_bf16 v[148:151], a[144:147], a[36:39], v[148:151]
 s_waitcnt lgkmcnt(6)
 buffer_store_dwordx4 v[224:227], v250, s[56:59], s91 offen offset:3072 sc1
 v_mfma_f32_16x16x32_bf16 v[156:159], a[148:151], a[36:39], v[156:159]
 s_add_u32 m0, s64, 118784
 ds_read_b64_tr_b16 a[164:165], v243 offset:20480
 ds_read_b64_tr_b16 a[166:167], v243 offset:22528
 v_mfma_f32_16x16x32_bf16 v[152:155], a[148:151], a[32:35], v[152:155]
 s_waitcnt lgkmcnt(6)
 buffer_load_dwordx2 v[102:103], v98, s[56:59], 0 offen sc1
 v_mfma_f32_16x16x32_bf16 v[160:163], a[152:155], a[32:35], v[160:163]
 s_add_u32 s65, s84, 405504
 ds_read_b64_tr_b16 a[168:169], v242 offset:20992
 ds_read_b64_tr_b16 a[170:171], v242 offset:23040
 v_mfma_f32_16x16x32_bf16 v[164:167], a[152:155], a[36:39], v[164:167]
 s_waitcnt lgkmcnt(6)
 buffer_load_dwordx4 v249, s[36:39], s65 offen lds
 v_mfma_f32_16x16x32_bf16 v[172:175], a[156:159], a[36:39], v[172:175]
 ds_read_b64_tr_b16 a[172:173], v243 offset:20992
 ds_read_b64_tr_b16 a[174:175], v243 offset:23040
 v_mfma_f32_16x16x32_bf16 v[168:171], a[156:159], a[32:35], v[168:171]
 s_waitcnt lgkmcnt(6)
 v_mfma_f32_16x16x32_bf16 v[144:147], a[160:163], a[40:43], v[144:147]
 s_waitcnt vmcnt(24)
 s_barrier
 ds_read_b64_tr_b16 a[144:145], v242 offset:24576
 ds_read_b64_tr_b16 a[146:147], v242 offset:26624
 v_mfma_f32_16x16x32_bf16 v[148:151], a[160:163], a[44:47], v[148:151]
 s_waitcnt lgkmcnt(6)
 v_mfma_f32_16x16x32_bf16 v[156:159], a[164:167], a[44:47], v[156:159]
 s_add_u32 m0, s64, 122880
 ds_read_b64_tr_b16 a[148:149], v243 offset:24576
 ds_read_b64_tr_b16 a[150:151], v243 offset:26624
 v_mfma_f32_16x16x32_bf16 v[152:155], a[164:167], a[40:43], v[152:155]
 s_waitcnt lgkmcnt(6)
 v_mfma_f32_16x16x32_bf16 v[160:163], a[168:171], a[40:43], v[160:163]
 s_add_u32 s65, s84, 442368
 ds_read_b64_tr_b16 a[152:153], v242 offset:25088
 ds_read_b64_tr_b16 a[154:155], v242 offset:27136
 v_mfma_f32_16x16x32_bf16 v[164:167], a[168:171], a[44:47], v[164:167]
 s_waitcnt lgkmcnt(6)
 buffer_load_dwordx4 v249, s[36:39], s65 offen lds
 v_mfma_f32_16x16x32_bf16 v[172:175], a[172:175], a[44:47], v[172:175]
 ds_read_b64_tr_b16 a[156:157], v243 offset:25088
 ds_read_b64_tr_b16 a[158:159], v243 offset:27136
 v_mfma_f32_16x16x32_bf16 v[168:171], a[172:175], a[40:43], v[168:171]
 s_waitcnt lgkmcnt(6)
 v_mfma_f32_16x16x32_bf16 v[144:147], a[144:147], a[48:51], v[144:147]
 ds_read_b64_tr_b16 a[160:161], v242 offset:28672
 ds_read_b64_tr_b16 a[162:163], v242 offset:30720
 v_mfma_f32_16x16x32_bf16 v[148:151], a[144:147], a[52:55], v[148:151]
 s_waitcnt lgkmcnt(6)
 v_mfma_f32_16x16x32_bf16 v[156:159], a[148:151], a[52:55], v[156:159]
 s_add_u32 m0, s64, 126976
 ds_read_b64_tr_b16 a[164:165], v243 offset:28672
 ds_read_b64_tr_b16 a[166:167], v243 offset:30720
 v_mfma_f32_16x16x32_bf16 v[152:155], a[148:151], a[48:51], v[152:155]
 s_waitcnt lgkmcnt(6)
 v_mfma_f32_16x16x32_bf16 v[160:163], a[152:155], a[48:51], v[160:163]
 s_add_u32 s65, s84, 479232
 ds_read_b64_tr_b16 a[168:169], v242 offset:29184
 ds_read_b64_tr_b16 a[170:171], v242 offset:31232
 v_mfma_f32_16x16x32_bf16 v[164:167], a[152:155], a[52:55], v[164:167]
 s_waitcnt lgkmcnt(6)
 buffer_load_dwordx4 v249, s[36:39], s65 offen lds
 v_mfma_f32_16x16x32_bf16 v[172:175], a[156:159], a[52:55], v[172:175]
 ds_read_b64_tr_b16 a[172:173], v243 offset:29184
 ds_read_b64_tr_b16 a[174:175], v243 offset:31232
 v_mfma_f32_16x16x32_bf16 v[168:171], a[156:159], a[48:51], v[168:171]
 s_waitcnt lgkmcnt(6)
 v_mfma_f32_16x16x32_bf16 v[144:147], a[160:163], a[56:59], v[144:147]
 ds_read_b64_tr_b16 a[144:145], v242 offset:32768
 ds_read_b64_tr_b16 a[146:147], v242 offset:34816
 v_mfma_f32_16x16x32_bf16 v[148:151], a[160:163], a[60:63], v[148:151]
 s_waitcnt lgkmcnt(6)
 v_mfma_f32_16x16x32_bf16 v[156:159], a[164:167], a[60:63], v[156:159]
 s_add_u32 m0, s64, 131072
 ds_read_b64_tr_b16 a[148:149], v243 offset:32768
 ds_read_b64_tr_b16 a[150:151], v243 offset:34816
 v_mfma_f32_16x16x32_bf16 v[152:155], a[164:167], a[56:59], v[152:155]
 s_waitcnt lgkmcnt(6)
 v_mfma_f32_16x16x32_bf16 v[160:163], a[168:171], a[56:59], v[160:163]
 s_add_u32 s65, s84, 516096
 ds_read_b64_tr_b16 a[152:153], v242 offset:33280
 ds_read_b64_tr_b16 a[154:155], v242 offset:35328
 v_mfma_f32_16x16x32_bf16 v[164:167], a[168:171], a[60:63], v[164:167]
 s_waitcnt lgkmcnt(6)
 buffer_load_dwordx4 v249, s[36:39], s65 offen lds
 v_mfma_f32_16x16x32_bf16 v[172:175], a[172:175], a[60:63], v[172:175]
 ds_read_b64_tr_b16 a[156:157], v243 offset:33280
 ds_read_b64_tr_b16 a[158:159], v243 offset:35328
 v_mfma_f32_16x16x32_bf16 v[168:171], a[172:175], a[56:59], v[168:171]
 s_waitcnt lgkmcnt(6)
 v_mfma_f32_16x16x32_bf16 v[144:147], a[144:147], a[64:67], v[144:147]
 ds_read_b64_tr_b16 a[160:161], v242 offset:36864
 ds_read_b64_tr_b16 a[162:163], v242 offset:38912
 v_mfma_f32_16x16x32_bf16 v[148:151], a[144:147], a[68:71], v[148:151]
 s_waitcnt lgkmcnt(6)
 v_mfma_f32_16x16x32_bf16 v[156:159], a[148:151], a[68:71], v[156:159]
 s_add_u32 m0, s64, 135168
 ds_read_b64_tr_b16 a[164:165], v243 offset:36864
 ds_read_b64_tr_b16 a[166:167], v243 offset:38912
 v_mfma_f32_16x16x32_bf16 v[152:155], a[148:151], a[64:67], v[152:155]
 s_waitcnt lgkmcnt(6)
 v_mfma_f32_16x16x32_bf16 v[160:163], a[152:155], a[64:67], v[160:163]
 s_add_u32 s65, s84, 552960
 ds_read_b64_tr_b16 a[168:169], v242 offset:37376
 ds_read_b64_tr_b16 a[170:171], v242 offset:39424
 v_mfma_f32_16x16x32_bf16 v[164:167], a[152:155], a[68:71], v[164:167]
 s_waitcnt lgkmcnt(6)
 buffer_load_dwordx4 v249, s[36:39], s65 offen lds
 v_mfma_f32_16x16x32_bf16 v[172:175], a[156:159], a[68:71], v[172:175]
 ds_read_b64_tr_b16 a[172:173], v243 offset:37376
 ds_read_b64_tr_b16 a[174:175], v243 offset:39424
 v_mfma_f32_16x16x32_bf16 v[168:171], a[156:159], a[64:67], v[168:171]
 s_waitcnt lgkmcnt(6)
 v_mfma_f32_16x16x32_bf16 v[144:147], a[160:163], a[72:75], v[144:147]
 ds_read_b64_tr_b16 a[144:145], v242 offset:40960
 ds_read_b64_tr_b16 a[146:147], v242 offset:43008
 v_mfma_f32_16x16x32_bf16 v[148:151], a[160:163], a[76:79], v[148:151]
 s_waitcnt lgkmcnt(6)
 v_mfma_f32_16x16x32_bf16 v[156:159], a[164:167], a[76:79], v[156:159]
 s_add_u32 m0, s64, 139264
 ds_read_b64_tr_b16 a[148:149], v243 offset:40960
 ds_read_b64_tr_b16 a[150:151], v243 offset:43008
 v_mfma_f32_16x16x32_bf16 v[152:155], a[164:167], a[72:75], v[152:155]
 s_waitcnt lgkmcnt(6)
 v_mfma_f32_16x16x32_bf16 v[160:163], a[168:171], a[72:75], v[160:163]
 s_add_u32 s65, s84, 589824
 ds_read_b64_tr_b16 a[152:153], v242 offset:41472
 ds_read_b64_tr_b16 a[154:155], v242 offset:43520
 v_mfma_f32_16x16x32_bf16 v[164:167], a[168:171], a[76:79], v[164:167]
 s_waitcnt lgkmcnt(6)
 buffer_load_dwordx4 v249, s[36:39], s65 offen lds
 v_mfma_f32_16x16x32_bf16 v[172:175], a[172:175], a[76:79], v[172:175]
 ds_read_b64_tr_b16 a[156:157], v243 offset:41472
 ds_read_b64_tr_b16 a[158:159], v243 offset:43520
 v_mfma_f32_16x16x32_bf16 v[168:171], a[172:175], a[72:75], v[168:171]
 s_waitcnt lgkmcnt(6)
 v_mfma_f32_16x16x32_bf16 v[144:147], a[144:147], a[80:83], v[144:147]
 ds_read_b64_tr_b16 a[160:161], v242 offset:45056
 ds_read_b64_tr_b16 a[162:163], v242 offset:47104
 v_mfma_f32_16x16x32_bf16 v[148:151], a[144:147], a[84:87], v[148:151]
 s_waitcnt lgkmcnt(6)
 v_mfma_f32_16x16x32_bf16 v[156:159], a[148:151], a[84:87], v[156:159]
 s_add_u32 m0, s64, 143360
 ds_read_b64_tr_b16 a[164:165], v243 offset:45056
 ds_read_b64_tr_b16 a[166:167], v243 offset:47104
 v_mfma_f32_16x16x32_bf16 v[152:155], a[148:151], a[80:83], v[152:155]
 s_waitcnt lgkmcnt(6)
 v_mfma_f32_16x16x32_bf16 v[160:163], a[152:155], a[80:83], v[160:163]
 s_add_u32 s65, s84, 626688
 ds_read_b64_tr_b16 a[168:169], v242 offset:45568
 ds_read_b64_tr_b16 a[170:171], v242 offset:47616
 v_mfma_f32_16x16x32_bf16 v[164:167], a[152:155], a[84:87], v[164:167]
 s_waitcnt lgkmcnt(6)
 buffer_load_dwordx4 v249, s[36:39], s65 offen lds
 v_mfma_f32_16x16x32_bf16 v[172:175], a[156:159], a[84:87], v[172:175]
 s_sub_u32 s67, s61, 1
 ds_read_b64_tr_b16 a[172:173], v243 offset:45568
 ds_read_b64_tr_b16 a[174:175], v243 offset:47616
 v_mfma_f32_16x16x32_bf16 v[168:171], a[156:159], a[80:83], v[168:171]
 s_waitcnt lgkmcnt(6)
 s_and_b32 s67, s67, 7
 s_lshl_b32 s68, s67, 3
 v_mfma_f32_16x16x32_bf16 v[144:147], a[160:163], a[88:91], v[144:147]
 s_mul_i32 s67, s67, 147456
 s_waitcnt vmcnt(24)
 s_barrier
 ds_read_b64_tr_b16 a[144:145], v244 offset:0
 ds_read_b64_tr_b16 a[146:147], v244 offset:2048
 v_mfma_f32_16x16x32_bf16 v[148:151], a[160:163], a[92:95], v[148:151]
 s_waitcnt lgkmcnt(6)
 s_add_u32 s67, s67, s73
 v_mfma_f32_16x16x32_bf16 v[156:159], a[164:167], a[92:95], v[156:159]
 s_add_u32 m0, s64, 0
 ds_read_b64_tr_b16 a[148:149], v245 offset:0
 ds_read_b64_tr_b16 a[150:151], v245 offset:2048
 v_mfma_f32_16x16x32_bf16 v[152:155], a[164:167], a[88:91], v[152:155]
 s_waitcnt lgkmcnt(6)
 v_mfma_f32_16x16x32_bf16 v[160:163], a[168:171], a[88:91], v[160:163]
 s_add_u32 s65, s85, 0
 ds_read_b64_tr_b16 a[152:153], v244 offset:512
 ds_read_b64_tr_b16 a[154:155], v244 offset:2560
 v_mfma_f32_16x16x32_bf16 v[164:167], a[168:171], a[92:95], v[164:167]
 s_waitcnt lgkmcnt(6)
 buffer_load_dwordx4 v249, s[36:39], s65 offen lds
 v_mfma_f32_16x16x32_bf16 v[172:175], a[172:175], a[92:95], v[172:175]
 s_waitcnt vmcnt(8)
 ds_read_b64_tr_b16 a[156:157], v245 offset:512
 ds_read_b64_tr_b16 a[158:159], v245 offset:2560
 v_mfma_f32_16x16x32_bf16 v[168:171], a[172:175], a[88:91], v[168:171]
 s_waitcnt lgkmcnt(6)
 s_lshl2_add_u32 s69, s82, s3
 v_mfma_f32_16x16x32_bf16 v[144:147], a[144:147], a[96:99], v[144:147]
 ds_read_b64_tr_b16 a[160:161], v244 offset:4096
 ds_read_b64_tr_b16 a[162:163], v244 offset:6144
 v_mfma_f32_16x16x32_bf16 v[148:151], a[144:147], a[100:103], v[148:151]
 s_waitcnt lgkmcnt(6)
 buffer_store_byte v252, v101, s[56:59], s69 offen sc1
 v_mfma_f32_16x16x32_bf16 v[156:159], a[148:151], a[100:103], v[156:159]
 s_add_u32 m0, s64, 4096
 ds_read_b64_tr_b16 a[164:165], v245 offset:4096
 ds_read_b64_tr_b16 a[166:167], v245 offset:6144
 v_mfma_f32_16x16x32_bf16 v[152:155], a[148:151], a[96:99], v[152:155]
 s_waitcnt lgkmcnt(6)
 v_readfirstlane_b32 s26, v102
 v_readfirstlane_b32 s27, v103
 v_mfma_f32_16x16x32_bf16 v[160:163], a[152:155], a[96:99], v[160:163]
 s_add_u32 s65, s85, 36864
 ds_read_b64_tr_b16 a[168:169], v244 offset:4608
 ds_read_b64_tr_b16 a[170:171], v244 offset:6656
 v_mfma_f32_16x16x32_bf16 v[164:167], a[152:155], a[100:103], v[164:167]
 s_waitcnt lgkmcnt(6)
 buffer_load_dwordx4 v249, s[36:39], s65 offen lds
 v_mfma_f32_16x16x32_bf16 v[172:175], a[156:159], a[100:103], v[172:175]
 ds_read_b64_tr_b16 a[172:173], v245 offset:4608
 ds_read_b64_tr_b16 a[174:175], v245 offset:6656
 v_mfma_f32_16x16x32_bf16 v[168:171], a[156:159], a[96:99], v[168:171]
 s_waitcnt lgkmcnt(6)
 s_lshr_b64 s[26:27], s[26:27], s68
 s_and_b32 s26, s26, 0xff
 s_cbranch_scc0 L_chk0
L_chk0_ok:
 v_mfma_f32_16x16x32_bf16 v[144:147], a[160:163], a[104:107], v[144:147]
 ds_read_b64_tr_b16 a[144:145], v244 offset:8192
 ds_read_b64_tr_b16 a[146:147], v244 offset:10240
 v_mfma_f32_16x16x32_bf16 v[148:151], a[160:163], a[108:111], v[148:151]
 s_waitcnt lgkmcnt(6)
 buffer_load_dwordx4 v[48:51], v250, s[56:59], s67 offen offset:0 sc1
 v_mfma_f32_16x16x32_bf16 v[156:159], a[164:167], a[108:111], v[156:159]
 s_add_u32 m0, s64, 8192
 ds_read_b64_tr_b16 a[148:149], v245 offset:8192
 ds_read_b64_tr_b16 a[150:151], v245 offset:10240
 v_mfma_f32_16x16x32_bf16 v[152:155], a[164:167], a[104:107], v[152:155]
 s_waitcnt lgkmcnt(6)
 buffer_load_dwordx4 v[52:55], v250, s[56:59], s67 offen offset:1024 sc1
 v_mfma_f32_16x16x32_bf16 v[160:163], a[168:171], a[104:107], v[160:163]
 s_add_u32 s65, s85, 73728
 ds_read_b64_tr_b16 a[152:153], v244 offset:8704
 ds_read_b64_tr_b16 a[154:155], v244 offset:10752
 v_mfma_f32_16x16x32_bf16 v[164:167], a[168:171], a[108:111], v[164:167]
 s_waitcnt lgkmcnt(6)
 buffer_load_dwordx4 v249, s[36:39], s65 offen lds
 v_mfma_f32_16x16x32_bf16 v[172:175], a[172:175], a[108:111], v[172:175]
 ds_read_b64_tr_b16 a[156:157], v245 offset:8704
 ds_read_b64_tr_b16 a[158:159], v245 offset:10752
 v_mfma_f32_16x16x32_bf16 v[168:171], a[172:175], a[104:107], v[168:171]
 s_waitcnt lgkmcnt(6)
 buffer_load_dwordx4 v[56:59], v250, s[56:59], s67 offen offset:2048 sc1
 v_mfma_f32_16x16x32_bf16 v[144:147], a[144:147], v[208:211], v[144:147]
 ds_read_b64_tr_b16 a[160:161], v244 offset:12288
 ds_read_b64_tr_b16 a[162:163], v244 offset:14336
 v_mfma_f32_16x16x32_bf16 v[148:151], a[144:147], v[212:215], v[148:151]
 s_waitcnt lgkmcnt(6)
 buffer_load_dwordx4 v[60:63], v250, s[56:59], s67 offen offset:3072 sc1
 v_mfma_f32_16x16x32_bf16 v[156:159], a[148:151], v[212:215], v[156:159]
 s_add_u32 m0, s64, 12288
 ds_read_b64_tr_b16 a[164:165], v245 offset:12288
 ds_read_b64_tr_b16 a[166:167], v245 offset:14336
 v_mfma_f32_16x16x32_bf16 v[152:155], a[148:151], v[208:211], v[152:155]
 s_waitcnt lgkmcnt(6)
 v_mfma_f32_16x16x32_bf16 v[160:163], a[152:155], v[208:211], v[160:163]
 s_add_u32 s65, s85, 110592
 ds_read_b64_tr_b16 a[168:169], v244 offset:12800
 ds_read_b64_tr_b16 a[170:171], v244 offset:14848
 v_mfma_f32_16x16x32_bf16 v[164:167], a[152:155], v[212:215], v[164:167]
 s_waitcnt lgkmcnt(6)
 buffer_load_dwordx4 v249, s[36:39], s65 offen lds
 v_mfma_f32_16x16x32_bf16 v[172:175], a[156:159], v[212:215], v[172:175]
 ds_read_b64_tr_b16 a[172:173], v245 offset:12800
 ds_read_b64_tr_b16 a[174:175], v245 offset:14848
 v_mfma_f32_16x16x32_bf16 v[168:171], a[156:159], v[208:211], v[168:171]
 s_waitcnt lgkmcnt(6)
 v_mfma_f32_16x16x32_bf16 v[144:147], a[160:163], v[216:219], v[144:147]
 ds_read_b64_tr_b16 a[144:145], v244 offset:16384
 ds_read_b64_tr_b16 a[146:147], v244 offset:18432
 v_mfma_f32_16x16x32_bf16 v[148:151], a[160:163], v[220:223], v[148:151]
 s_waitcnt lgkmcnt(6)
 v_mfma_f32_16x16x32_bf16 v[156:159], a[164:167], v[220:223], v[156:159]
 s_add_u32 m0, s64, 16384
 ds_read_b64_tr_b16 a[148:149], v245 offset:16384
 ds_read_b64_tr_b16 a[150:151], v245 offset:18432
 v_mfma_f32_16x16x32_bf16 v[152:155], a[164:167], v[216:219], v[152:155]
 s_waitcnt lgkmcnt(6)
 v_mfma_f32_16x16x32_bf16 v[160:163], a[168:171], v[216:219], v[160:163]
 s_add_u32 s65, s85, 147456
 ds_read_b64_tr_b16 a[152:153], v244 offset:16896
 ds_read_b64_tr_b16 a[154:155], v244 offset:18944
 v_mfma_f32_16x16x32_bf16 v[164:167], a[168:171], v[220:223], v[164:167]
 s_waitcnt lgkmcnt(6)
 buffer_load_dwordx4 v249, s[36:39], s65 offen lds
 v_mfma_f32_16x16x32_bf16 v[172:175], a[172:175], v[220:223], v[172:175]
 ds_read_b64_tr_b16 a[156:157], v245 offset:16896
 ds_read_b64_tr_b16 a[158:159], v245 offset:18944
 v_mfma_f32_16x16x32_bf16 v[168:171], a[172:175], v[216:219], v[168:171]
 s_waitcnt lgkmcnt(6)
 v_mfma_f32_16x16x32_bf16 v[144:147], a[144:147], v[0:3], v[144:147]
 ds_read_b64_tr_b16 a[160:161], v244 offset:20480
 ds_read_b64_tr_b16 a[162:163], v244 offset:22528
 v_mfma_f32_16x16x32_bf16 v[148:151], a[144:147], v[4:7], v[148:151]
 s_waitcnt lgkmcnt(6)
 v_mfma_f32_16x16x32_bf16 v[156:159], a[148:151], v[4:7], v[156:159]
 s_add_u32 m0, s64, 20480
 ds_read_b64_tr_b16 a[164:165], v245 offset:20480
 ds_read_b64_tr_b16 a[166:167], v245 offset:22528
 v_mfma_f32_16x16x32_bf16 v[152:155], a[148:151], v[0:3], v[152:155]
 s_waitcnt lgkmcnt(6)
 v_mfma_f32_16x16x32_bf16 v[160:163], a[152:155], v[0:3], v[160:163]
 s_add_u32 s65, s85, 184320
 ds_read_b64_tr_b16 a[168:169], v244 offset:20992
 ds_read_b64_tr_b16 a[170:171], v244 offset:23040
 v_mfma_f32_16x16x32_bf16 v[164:167], a[152:155], v[4:7], v[164:167]
 s_waitcnt lgkmcnt(6)
 buffer_load_dwordx4 v249, s[36:39], s65 offen lds
 v_mfma_f32_16x16x32_bf16 v[172:175], a[156:159], v[4:7], v[172:175]
 ds_read_b64_tr_b16 a[172:173], v245 offset:20992
 ds_read_b64_tr_b16 a[174:175], v245 offset:23040
 v_mfma_f32_16x16x32_bf16 v[168:171], a[156:159], v[0:3], v[168:171]
 s_waitcnt lgkmcnt(6)
 v_mfma_f32_16x16x32_bf16 v[144:147], a[160:163], v[8:11], v[144:147]
 s_barrier
 ds_read_b64_tr_b16 a[144:145], v244 offset:24576
 ds_read_b64_tr_b16 a[146:147], v244 offset:26624
 v_mfma_f32_16x16x32_bf16 v[148:151], a[160:163], v[12:15], v[148:151]
 s_waitcnt lgkmcnt(6)
 v_mfma_f32_16x16x32_bf16 v[156:159], a[164:167], v[12:15], v[156:159]
 s_add_u32 m0, s64, 24576
 ds_read_b64_tr_b16 a[148:149], v245 offset:24576
 ds_read_b64_tr_b16 a[150:151], v245 offset:26624
 v_mfma_f32_16x16x32_bf16 v[152:155], a[164:167], v[8:11], v[152:155]
 s_waitcnt lgkmcnt(6)
 v_mfma_f32_16x16x32_bf16 v[160:163], a[168:171], v[8:11], v[160:163]
 s_add_u32 s65, s85, 221184
 ds_read_b64_tr_b16 a[152:153], v244 offset:25088
 ds_read_b64_tr_b16 a[154:155], v244 offset:27136
 v_mfma_f32_16x16x32_bf16 v[164:167], a[168:171], v[12:15], v[164:167]
 s_waitcnt lgkmcnt(6)
 buffer_load_dwordx4 v249, s[36:39], s65 offen lds
 v_mfma_f32_16x16x32_bf16 v[172:175], a[172:175], v[12:15], v[172:175]
 ds_read_b64_tr_b16 a[156:157], v245 offset:25088
 ds_read_b64_tr_b16 a[158:159], v245 offset:27136
 v_mfma_f32_16x16x32_bf16 v[168:171], a[172:175], v[8:11], v[168:171]
 s_waitcnt lgkmcnt(6)
 v_mfma_f32_16x16x32_bf16 v[176:179], a[144:147], a[0:3], 0
 ds_read_b64_tr_b16 a[160:161], v244 offset:28672
 ds_read_b64_tr_b16 a[162:163], v244 offset:30720
 v_mfma_f32_16x16x32_bf16 v[180:183], a[144:147], a[4:7], 0
 s_waitcnt lgkmcnt(6)
 v_mfma_f32_16x16x32_bf16 v[188:191], a[148:151], a[4:7], 0
 s_add_u32 m0, s64, 28672
 ds_read_b64_tr_b16 a[164:165], v245 offset:28672
 ds_read_b64_tr_b16 a[166:167], v245 offset:30720
 v_mfma_f32_16x16x32_bf16 v[184:187], a[148:151], a[0:3], 0
 s_waitcnt lgkmcnt(6)
 v_cvt_pk_bf16_f32 v224, v144, v145
 v_cvt_pk_bf16_f32 v225, v146, v147
 v_mfma_f32_16x16x32_bf16 v[192:195], a[152:155], a[0:3], 0
 s_add_u32 s65, s85, 258048
 ds_read_b64_tr_b16 a[168:169], v244 offset:29184
 ds_read_b64_tr_b16 a[170:171], v244 offset:31232
 v_mfma_f32_16x16x32_bf16 v[196:199], a[152:155], a[4:7], 0
 s_waitcnt lgkmcnt(6)
 buffer_load_dwordx4 v249, s[36:39], s65 offen lds
 v_mfma_f32_16x16x32_bf16 v[204:207], a[156:159], a[4:7], 0
 ds_read_b64_tr_b16 a[172:173], v245 offset:29184
 ds_read_b64_tr_b16 a[174:175], v245 offset:31232
 v_mfma_f32_16x16x32_bf16 v[200:203], a[156:159], a[0:3], 0
 s_waitcnt lgkmcnt(6)
 v_cvt_pk_bf16_f32 v226, v148, v149
 v_cvt_pk_bf16_f32 v227, v150, v151
 v_mfma_f32_16x16x32_bf16 v[176:179], a[160:163], a[8:11], v[176:179]
 ds_read_b64_tr_b16 a[144:145], v244 offset:32768
 ds_read_b64_tr_b16 a[146:147], v244 offset:34816
 v_mfma_f32_16x16x32_bf16 v[180:183], a[160:163], a[12:15], v[180:183]
 s_waitcnt lgkmcnt(6)
 buffer_store_dwordx4 v[224:227], v250, s[56:59], s92 offen offset:0 sc1
 v_mfma_f32_16x16x32_bf16 v[188:191], a[164:167], a[12:15], v[188:191]
 s_add_u32 m0, s64, 32768
 ds_read_b64_tr_b16 a[148:149], v245 offset:32768
 ds_read_b64_tr_b16 a[150:151], v245 offset:34816
 v_mfma_f32_16x16x32_bf16 v[184:187], a[164:167], a[8:11], v[184:187]
 s_waitcnt lgkmcnt(6)
 v_cvt_pk_bf16_f32 v228, v152, v153
 v_cvt_pk_bf16_f32 v229, v154, v155
 v_mfma_f32_16x16x32_bf16 v[192:195], a[168:171], a[8:11], v[192:195]
 s_add_u32 s65, s85, 294912
 ds_read_b64_tr_b16 a[152:153], v244 offset:33280
 ds_read_b64_tr_b16 a[154:155], v244 offset:35328
 v_mfma_f32_16x16x32_bf16 v[196:199], a[168:171], a[12:15], v[196:199]
 s_waitcnt lgkmcnt(6)
 buffer_load_dwordx4 v249, s[36:39], s65 offen lds
 v_mfma_f32_16x16x32_bf16 v[204:207], a[172:175], a[12:15], v[204:207]
 ds_read_b64_tr_b16 a[156:157], v245 offset:33280
 ds_read_b64_tr_b16 a[158:159], v245 offset:35328
 v_mfma_f32_16x16x32_bf16 v[200:203], a[172:175], a[8:11], v[200:203]
 s_waitcnt lgkmcnt(6)
 v_cvt_pk_bf16_f32 v230, v156, v157
 v_cvt_pk_bf16_f32 v231, v158, v159
 v_mfma_f32_16x16x32_bf16 v[176:179], a[144:147], a[16:19], v[176:179]
 ds_read_b64_tr_b16 a[160:161], v244 offset:36864
 ds_read_b64_tr_b16 a[162:163], v244 offset:38912
 v_mfma_f32_16x16x32_bf16 v[180:183], a[144:147], a[20:23], v[180:183]
 s_waitcnt lgkmcnt(6)
 buffer_store_dwordx4 v[228:231], v250, s[56:59], s92 offen offset:1024 sc1
 v_mfma_f32_16x16x32_bf16 v[188:191], a[148:151], a[20:23], v[188:191]
 s_add_u32 m0, s64, 36864
 ds_read_b64_tr_b16 a[164:165], v245 offset:36864
 ds_read_b64_tr_b16 a[166:167], v245 offset:38912
 v_mfma_f32_16x16x32_bf16 v[184:187], a[148:151], a[16:19], v[184:187]
 s_waitcnt lgkmcnt(6)
 v_cvt_pk_bf16_f32 v232, v160, v161
 v_cvt_pk_bf16_f32 v233, v162, v163
 v_mfma_f32_16x16x32_bf16 v[192:195], a[152:155], a[16:19], v[192:195]
 s_add_u32 s65, s85, 331776
 ds_read_b64_tr_b16 a[168:169], v244 offset:37376
 ds_read_b64_tr_b16 a[170:171], v244 offset:39424
 v_mfma_f32_16x16x32_bf16 v[196:199], a[152:155], a[20:23], v[196:199]
 s_waitcnt lgkmcnt(6)
 buffer_load_dwordx4 v249, s[36:39], s65 offen lds
 v_mfma_f32_16x16x32_bf16 v[204:207], a[156:159], a[20:23], v[204:207]
 ds_read_b64_tr_b16 a[172:173], v245 offset:37376
 ds_read_b64_tr_b16 a[174:175], v245 offset:39424
 v_mfma_f32_16x16x32_bf16 v[200:203], a[156:159], a[16:19], v[200:203]
 s_waitcnt lgkmcnt(6)
 v_cvt_pk_bf16_f32 v234, v164, v165
 v_cvt_pk_bf16_f32 v235, v166, v167
 v_mfma_f32_16x16x32_bf16 v[176:179], a[160:163], a[24:27], v[176:179]
 ds_read_b64_tr_b16 a[144:145], v244 offset:40960
 ds_read_b64_tr_b16 a[146:147], v244 offset:43008
 v_mfma_f32_16x16x32_bf16 v[180:183], a[160:163], a[28:31], v[180:183]
 s_waitcnt lgkmcnt(6)
 buffer_store_dwordx4 v[232:235], v250, s[56:59], s92 offen offset:2048 sc1
 v_mfma_f32_16x16x32_bf16 v[188:191], a[164:167], a[28:31], v[188:191]
 s_add_u32 m0, s64, 40960
 ds_read_b64_tr_b16 a[148:149], v245 offset:40960
 ds_read_b64_tr_b16 a[150:151], v245 offset:43008
 v_mfma_f32_16x16x32_bf16 v[184:187], a[164:167], a[24:27], v[184:187]
 s_waitcnt lgkmcnt(6)
 v_cvt_pk_bf16_f32 v224, v168, v169
 v_cvt_pk_bf16_f32 v225, v170, v171
 v_mfma_f32_16x16x32_bf16 v[192:195], a[168:171], a[24:27], v[192:195]
 s_add_u32 s65, s85, 368640
 ds_read_b64_tr_b16 a[152:153], v244 offset:41472
 ds_read_b64_tr_b16 a[154:155], v244 offset:43520
 v_mfma_f32_16x16x32_bf16 v[196:199], a[168:171], a[28:31], v[196:199]
 s_waitcnt lgkmcnt(6)
 buffer_load_dwordx4 v249, s[36:39], s65 offen lds
 v_mfma_f32_16x16x32_bf16 v[204:207], a[172:175], a[28:31], v[204:207]
 ds_read_b64_tr_b16 a[156:157], v245 offset:41472
 ds_read_b64_tr_b16 a[158:159], v245 offset:43520
 v_mfma_f32_16x16x32_bf16 v[200:203], a[172:175], a[24:27], v[200:203]
 s_waitcnt lgkmcnt(6)
 v_cvt_pk_bf16_f32 v226, v172, v173
 v_cvt_pk_bf16_f32 v227, v174, v175
 v_mfma_f32_16x16x32_bf16 v[176:179], a[144:147], a[32:35], v[176:179]
 ds_read_b64_tr_b16 a[160:161], v244 offset:45056
 ds_read_b64_tr_b16 a[162:163], v244 offset:47104
 v_mfma_f32_16x16x32_bf16 v[180:183], a[144:147], a[36:39], v[180:183]
 s_waitcnt lgkmcnt(6)
 buffer_store_dwordx4 v[224:227], v250, s[56:59], s92 offen offset:3072 sc1
 v_mfma_f32_16x16x32_bf16 v[188:191], a[148:151], a[36:39], v[188:191]
 s_add_u32 m0, s64, 45056
 ds_read_b64_tr_b16 a[164:165], v245 offset:45056
 ds_read_b64_tr_b16 a[166:167], v245 offset:47104
 v_mfma_f32_16x16x32_bf16 v[184:187], a[148:151], a[32:35], v[184:187]
 s_waitcnt lgkmcnt(6)
 buffer_load_dwordx2 v[102:103], v98, s[56:59], 0 offen sc1
 v_mfma_f32_16x16x32_bf16 v[192:195], a[152:155], a[32:35], v[192:195]
 s_add_u32 s65, s85, 405504
 ds_read_b64_tr_b16 a[168:169], v244 offset:45568
 ds_read_b64_tr_b16 a[170:171], v244 offset:47616
 v_mfma_f32_16x16x32_bf16 v[196:199], a[152:155], a[36:39], v[196:199]
 s_waitcnt lgkmcnt(6)
 buffer_load_dwordx4 v249, s[36:39], s65 offen lds
 v_mfma_f32_16x16x32_bf16 v[204:207], a[156:159], a[36:39], v[204:207]
 s_waitcnt vmcnt(14)
 ds_read_b64_tr_b16 a[172:173], v245 offset:45568
 ds_read_b64_tr_b16 a[174:175], v245 offset:47616
 v_mfma_f32_16x16x32_bf16 v[200:203], a[156:159], a[32:35], v[200:203]
 s_waitcnt lgkmcnt(6)
 v_lshlrev_b32 v224, 16, v48
 v_and_b32 v225, s97, v48
 v_mfma_f32_16x16x32_bf16 v[176:179], a[160:163], a[40:43], v[176:179]
 s_barrier
 ds_read_b64_tr_b16 a[144:145], v246 offset:0
 ds_read_b64_tr_b16 a[146:147], v246 offset:2048
 v_mfma_f32_16x16x32_bf16 v[180:183], a[160:163], a[44:47], v[180:183]
 s_waitcnt lgkmcnt(6)
 v_add_f32 v16, v16, v224
 v_add_f32 v17, v17, v225
 v_mfma_f32_16x16x32_bf16 v[188:191], a[164:167], a[44:47], v[188:191]
 s_add_u32 m0, s64, 49152
 ds_read_b64_tr_b16 a[148:149], v247 offset:0
 ds_read_b64_tr_b16 a[150:151], v247 offset:2048
 v_mfma_f32_16x16x32_bf16 v[184:187], a[164:167], a[40:43], v[184:187]
 s_waitcnt lgkmcnt(6)
 v_lshlrev_b32 v226, 16, v49
 v_and_b32 v227, s97, v49
 v_mfma_f32_16x16x32_bf16 v[192:195], a[168:171], a[40:43], v[192:195]
 s_add_u32 s65, s85, 442368
 ds_read_b64_tr_b16 a[152:153], v246 offset:512
 ds_read_b64_tr_b16 a[154:155], v246 offset:2560
 v_mfma_f32_16x16x32_bf16 v[196:199], a[168:171], a[44:47], v[196:199]
 s_waitcnt lgkmcnt(6)
 buffer_load_dwordx4 v249, s[36:39], s65 offen lds
 v_mfma_f32_16x16x32_bf16 v[204:207], a[172:175], a[44:47], v[204:207]
 ds_read_b64_tr_b16 a[156:157], v247 offset:512
 ds_read_b64_tr_b16 a[158:159], v247 offset:2560
 v_mfma_f32_16x16x32_bf16 v[200:203], a[172:175], a[40:43], v[200:203]
 s_waitcnt lgkmcnt(6)
 v_add_f32 v18, v18, v226
 v_add_f32 v19, v19, v227
 v_mfma_f32_16x16x32_bf16 v[176:179], a[144:147], a[48:51], v[176:179]
 ds_read_b64_tr_b16 a[160:161], v246 offset:4096
 ds_read_b64_tr_b16 a[162:163], v246 offset:6144
 v_mfma_f32_16x16x32_bf16 v[180:183], a[144:147], a[52:55], v[180:183]
 s_waitcnt lgkmcnt(6)
 v_lshlrev_b32 v224, 16, v50
 v_and_b32 v225, s97, v50
 v_mfma_f32_16x16x32_bf16 v[188:191], a[148:151], a[52:55], v[188:191]
 s_add_u32 m0, s64, 53248
 ds_read_b64_tr_b16 a[164:165], v247 offset:4096
 ds_read_b64_tr_b16 a[166:167], v247 offset:6144
 v_mfma_f32_16x16x32_bf16 v[184:187], a[148:151], a[48:51], v[184:187]
 s_waitcnt lgkmcnt(6)
 v_add_f32 v20, v20, v224
 v_add_f32 v21, v21, v225
 v_mfma_f32_16x16x32_bf16 v[192:195], a[152:155], a[48:51], v[192:195]
 s_add_u32 s65, s85, 479232
 ds_read_b64_tr_b16 a[168:169], v246 offset:4608
 ds_read_b64_tr_b16 a[170:171], v246 offset:6656
 v_mfma_f32_16x16x32_bf16 v[196:199], a[152:155], a[52:55], v[196:199]
 s_waitcnt lgkmcnt(6)
 buffer_load_dwordx4 v249, s[36:39], s65 offen lds
 v_mfma_f32_16x16x32_bf16 v[204:207], a[156:159], a[52:55], v[204:207]
 ds_read_b64_tr_b16 a[172:173], v247 offset:4608
 ds_read_b64_tr_b16 a[174:175], v247 offset:6656
 v_mfma_f32_16x16x32_bf16 v[200:203], a[156:159], a[48:51], v[200:203]
 s_waitcnt lgkmcnt(6)
 v_lshlrev_b32 v226, 16, v51
 v_and_b32 v227, s97, v51
 v_mfma_f32_16x16x32_bf16 v[176:179], a[160:163], a[56:59], v[176:179]
 ds_read_b64_tr_b16 a[144:145], v246 offset:8192
 ds_read_b64_tr_b16 a[146:147], v246 offset:10240
 v_mfma_f32_16x16x32_bf16 v[180:183], a[160:163], a[60:63], v[180:183]
 s_waitcnt lgkmcnt(6)
 v_add_f32 v22, v22, v226
 v_add_f32 v23, v23, v227
 v_mfma_f32_16x16x32_bf16 v[188:191], a[164:167], a[60:63], v[188:191]
 s_add_u32 m0, s64, 57344
 ds_read_b64_tr_b16 a[148:149], v247 offset:8192
 ds_read_b64_tr_b16 a[150:151], v247 offset:10240
 v_mfma_f32_16x16x32_bf16 v[184:187], a[164:167], a[56:59], v[184:187]
 s_waitcnt lgkmcnt(6)
 v_lshlrev_b32 v224, 16, v52
 v_and_b32 v225, s97, v52
 v_mfma_f32_16x16x32_bf16 v[192:195], a[168:171], a[56:59], v[192:195]
 s_add_u32 s65, s85, 516096
 ds_read_b64_tr_b16 a[152:153], v246 offset:8704
 ds_read_b64_tr_b16 a[154:155], v246 offset:10752
 v_mfma_f32_16x16x32_bf16 v[196:199], a[168:171], a[60:63], v[196:199]
 s_waitcnt lgkmcnt(6)
 buffer_load_dwordx4 v249, s[36:39], s65 offen lds
 v_mfma_f32_16x16x32_bf16 v[204:207], a[172:175], a[60:63], v[204:207]
 ds_read_b64_tr_b16 a[156:157], v247 offset:8704
 ds_read_b64_tr_b16 a[158:159], v247 offset:10752
 v_mfma_f32_16x16x32_bf16 v[200:203], a[172:175], a[56:59], v[200:203]
 s_waitcnt lgkmcnt(6)
 v_add_f32 v24, v24, v224
 v_add_f32 v25, v25, v225
 v_mfma_f32_16x16x32_bf16 v[176:179], a[144:147], a[64:67], v[176:179]
 ds_read_b64_tr_b16 a[160:161], v246 offset:12288
 ds_read_b64_tr_b16 a[162:163], v246 offset:14336
 v_mfma_f32_16x16x32_bf16 v[180:183], a[144:147], a[68:71], v[180:183]
 s_waitcnt lgkmcnt(6)
 v_lshlrev_b32 v226, 16, v53
 v_and_b32 v227, s97, v53
 v_mfma_f32_16x16x32_bf16 v[188:191], a[148:151], a[68:71], v[188:191]
 s_add_u32 m0, s64, 61440
 ds_read_b64_tr_b16 a[164:165], v247 offset:12288
 ds_read_b64_tr_b16 a[166:167], v247 offset:14336
 v_mfma_f32_16x16x32_bf16 v[184:187], a[148:151], a[64:67], v[184:187]
 s_waitcnt lgkmcnt(6)
 v_add_f32 v26, v26, v226
 v_add_f32 v27, v27, v227
 v_mfma_f32_16x16x32_bf16 v[192:195], a[152:155], a[64:67], v[192:195]
 s_add_u32 s65, s85, 552960
 ds_read_b64_tr_b16 a[168:169], v246 offset:12800
 ds_read_b64_tr_b16 a[170:171], v246 offset:14848
 v_mfma_f32_16x16x32_bf16 v[196:199], a[152:155], a[68:71], v[196:199]
 s_waitcnt lgkmcnt(6)
 buffer_load_dwordx4 v249, s[36:39], s65 offen lds
 v_mfma_f32_16x16x32_bf16 v[204:207], a[156:159], a[68:71], v[204:207]
 ds_read_b64_tr_b16 a[172:173], v247 offset:12800
 ds_read_b64_tr_b16 a[174:175], v247 offset:14848
 v_mfma_f32_16x16x32_bf16 v[200:203], a[156:159], a[64:67], v[200:203]
 s_waitcnt lgkmcnt(6)
 v_lshlrev_b32 v224, 16, v54
 v_and_b32 v225, s97, v54
 v_mfma_f32_16x16x32_bf16 v[176:179], a[160:163], a[72:75], v[176:179]
 ds_read_b64_tr_b16 a[144:145], v246 offset:16384
 ds_read_b64_tr_b16 a[146:147], v246 offset:18432
 v_mfma_f32_16x16x32_bf16 v[180:183], a[160:163], a[76:79], v[180:183]
 s_waitcnt lgkmcnt(6)
 v_add_f32 v28, v28, v224
 v_add_f32 v29, v29, v225
 v_mfma_f32_16x16x32_bf16 v[188:191], a[164:167], a[76:79], v[188:191]
 s_add_u32 m0, s64, 65536
 ds_read_b64_tr_b16 a[148:149], v247 offset:16384
 ds_read_b64_tr_b16 a[150:151], v247 offset:18432
 v_mfma_f32_16x16x32_bf16 v[184:187], a[164:167], a[72:75], v[184:187]
 s_waitcnt lgkmcnt(6)
 v_lshlrev_b32 v226, 16, v55
 v_and_b32 v227, s97, v55
 v_mfma_f32_16x16x32_bf16 v[192:195], a[168:171], a[72:75], v[192:195]
 s_add_u32 s65, s85, 589824
 ds_read_b64_tr_b16 a[152:153], v246 offset:16896
 ds_read_b64_tr_b16 a[154:155], v246 offset:18944
 v_mfma_f32_16x16x32_bf16 v[196:199], a[168:171], a[76:79], v[196:199]
 s_waitcnt lgkmcnt(6)
 buffer_load_dwordx4 v249, s[36:39], s65 offen lds
 v_mfma_f32_16x16x32_bf16 v[204:207], a[172:175], a[76:79], v[204:207]
 ds_read_b64_tr_b16 a[156:157], v247 offset:16896
 ds_read_b64_tr_b16 a[158:159], v247 offset:18944
 v_mfma_f32_16x16x32_bf16 v[200:203], a[172:175], a[72:75], v[200:203]
 s_waitcnt lgkmcnt(6)
 v_add_f32 v30, v30, v226
 v_add_f32 v31, v31, v227
 v_mfma_f32_16x16x32_bf16 v[176:179], a[144:147], a[80:83], v[176:179]
 ds_read_b64_tr_b16 a[160:161], v246 offset:20480
 ds_read_b64_tr_b16 a[162:163], v246 offset:22528
 v_mfma_f32_16x16x32_bf16 v[180:183], a[144:147], a[84:87], v[180:183]
 s_waitcnt lgkmcnt(6)
 v_lshlrev_b32 v224, 16, v56
 v_and_b32 v225, s97, v56
 v_mfma_f32_16x16x32_bf16 v[188:191], a[148:151], a[84:87], v[188:191]
 s_add_u32 m0, s64, 69632
 ds_read_b64_tr_b16 a[164:165], v247 offset:20480
 ds_read_b64_tr_b16 a[166:167], v247 offset:22528
 v_mfma_f32_16x16x32_bf16 v[184:187], a[148:151], a[80:83], v[184:187]
 s_waitcnt lgkmcnt(6)
 v_add_f32 v32, v32, v224
 v_add_f32 v33, v33, v225
 v_mfma_f32_16x16x32_bf16 v[192:195], a[152:155], a[80:83], v[192:195]
 s_add_u32 s65, s85, 626688
 ds_read_b64_tr_b16 a[168:169], v246 offset:20992
 ds_read_b64_tr_b16 a[170:171], v246 offset:23040
 v_mfma_f32_16x16x32_bf16 v[196:199], a[152:155], a[84:87], v[196:199]
 s_waitcnt lgkmcnt(6)
 buffer_load_dwordx4 v249, s[36:39], s65 offen lds
 v_mfma_f32_16x16x32_bf16 v[204:207], a[156:159], a[84:87], v[204:207]
 s_sub_u32 s67, s61, 2
 ds_read_b64_tr_b16 a[172:173], v247 offset:20992
 ds_read_b64_tr_b16 a[174:175], v247 offset:23040
 v_mfma_f32_16x16x32_bf16 v[200:203], a[156:159], a[80:83], v[200:203]
 s_waitcnt lgkmcnt(6)
 s_and_b32 s67, s67, 7
 s_lshl_b32 s68, s67, 3
 v_mfma_f32_16x16x32_bf16 v[176:179], a[160:163], a[88:91], v[176:179]
 s_mul_i32 s67, s67, 147456
 s_barrier
 ds_read_b64_tr_b16 a[144:145], v246 offset:24576
 ds_read_b64_tr_b16 a[146:147], v246 offset:26624
 v_mfma_f32_16x16x32_bf16 v[180:183], a[160:163], a[92:95], v[180:183]
 s_waitcnt lgkmcnt(6)
 s_add_u32 s67, s67, s73
 v_mfma_f32_16x16x32_bf16 v[188:191], a[164:167], a[92:95], v[188:191]
 s_add_u32 m0, s64, 73728
 ds_read_b64_tr_b16 a[148:149], v247 offset:24576
 ds_read_b64_tr_b16 a[150:151], v247 offset:26624
 v_mfma_f32_16x16x32_bf16 v[184:187], a[164:167], a[88:91], v[184:187]
 s_waitcnt lgkmcnt(6)
 v_mfma_f32_16x16x32_bf16 v[192:195], a[168:171], a[88:91], v[192:195]
 s_add_u32 s65, s86, 0
 ds_read_b64_tr_b16 a[152:153], v246 offset:25088
 ds_read_b64_tr_b16 a[154:155], v246 offset:27136
 v_mfma_f32_16x16x32_bf16 v[196:199], a[168:171], a[92:95], v[196:199]
 s_waitcnt lgkmcnt(6)
 buffer_load_dwordx4 v249, s[36:39], s65 offen lds
 v_mfma_f32_16x16x32_bf16 v[204:207], a[172:175], a[92:95], v[204:207]
 s_waitcnt vmcnt(8)
 ds_read_b64_tr_b16 a[156:157], v247 offset:25088
 ds_read_b64_tr_b16 a[158:159], v247 offset:27136
 v_mfma_f32_16x16x32_bf16 v[200:203], a[172:175], a[88:91], v[200:203]
 s_waitcnt lgkmcnt(6)
 s_lshl2_add_u32 s69, s83, s3
 v_mfma_f32_16x16x32_bf16 v[176:179], a[144:147], a[96:99], v[176:179]
 ds_read_b64_tr_b16 a[160:161], v246 offset:28672
 ds_read_b64_tr_b16 a[162:163], v246 offset:30720
 v_mfma_f32_16x16x32_bf16 v[180:183], a[144:147], a[100:103], v[180:183]
 s_waitcnt lgkmcnt(6)
 buffer_store_byte v252, v101, s[56:59], s69 offen sc1
 v_mfma_f32_16x16x32_bf16 v[188:191], a[148:151], a[100:103], v[188:191]
 s_add_u32 m0, s64, 77824
 ds_read_b64_tr_b16 a[164:165], v247 offset:28672
 ds_read_b64_tr_b16 a[166:167], v247 offset:30720
 v_mfma_f32_16x16x32_bf16 v[184:187], a[148:151], a[96:99], v[184:187]
 s_waitcnt lgkmcnt(6)
 v_readfirstlane_b32 s26, v102
 v_readfirstlane_b32 s27, v103
 v_mfma_f32_16x16x32_bf16 v[192:195], a[152:155], a[96:99], v[192:195]
 s_add_u32 s65, s86, 36864
 ds_read_b64_tr_b16 a[168:169], v246 offset:29184
 ds_read_b64_tr_b16 a[170:171], v246 offset:31232
 v_mfma_f32_16x16x32_bf16 v[196:199], a[152:155], a[100:103], v[196:199]
 s_waitcnt lgkmcnt(6)
 buffer_load_dwordx4 v249, s[36:39], s65 offen lds
 v_mfma_f32_16x16x32_bf16 v[204:207], a[156:159], a[100:103], v[204:207]
 ds_read_b64_tr_b16 a[172:173], v247 offset:29184
 ds_read_b64_tr_b16 a[174:175], v247 offset:31232
 v_mfma_f32_16x16x32_bf16 v[200:203], a[156:159], a[96:99], v[200:203]
 s_waitcnt lgkmcnt(6)
 s_lshr_b64 s[26:27], s[26:27], s68
 s_and_b32 s26, s26, 0xff
 s_cbranch_scc0 L_chk1
L_chk1_ok:
 v_mfma_f32_16x16x32_bf16 v[176:179], a[160:163], a[104:107], v[176:179]
 ds_read_b64_tr_b16 a[144:145], v246 offset:32768
 ds_read_b64_tr_b16 a[146:147], v246 offset:34816
 v_mfma_f32_16x16x32_bf16 v[180:183], a[160:163], a[108:111], v[180:183]
 s_waitcnt lgkmcnt(6)
 buffer_load_dwordx4 v[64:67], v250, s[56:59], s67 offen offset:0 sc1
 v_mfma_f32_16x16x32_bf16 v[188:191], a[164:167], a[108:111], v[188:191]
 s_add_u32 m0, s64, 81920
 ds_read_b64_tr_b16 a[148:149], v247 offset:32768
 ds_read_b64_tr_b16 a[150:151], v247 offset:34816
 v_mfma_f32_16x16x32_bf16 v[184:187], a[164:167], a[104:107], v[184:187]
 s_waitcnt lgkmcnt(6)
 buffer_load_dwordx4 v[68:71], v250, s[56:59], s67 offen offset:1024 sc1
 v_mfma_f32_16x16x32_bf16 v[192:195], a[168:171], a[104:107], v[192:195]
 s_add_u32 s65, s86, 73728
 ds_read_b64_tr_b16 a[152:153], v246 offset:33280
 ds_read_b64_tr_b16 a[154:155], v246 offset:35328
 v_mfma_f32_16x16x32_bf16 v[196:199], a[168:171], a[108:111], v[196:199]
 s_waitcnt lgkmcnt(6)
 buffer_load_dwordx4 v249, s[36:39], s65 offen lds
 v_mfma_f32_16x16x32_bf16 v[204:207], a[172:175], a[108:111], v[204:207]
 ds_read_b64_tr_b16 a[156:157], v247 offset:33280
 ds_read_b64_tr_b16 a[158:159], v247 offset:35328
 v_mfma_f32_16x16x32_bf16 v[200:203], a[172:175], a[104:107], v[200:203]
 s_waitcnt lgkmcnt(6)
 buffer_load_dwordx4 v[72:75], v250, s[56:59], s67 offen offset:2048 sc1
 v_mfma_f32_16x16x32_bf16 v[176:179], a[144:147], v[208:211], v[176:179]
 ds_read_b64_tr_b16 a[160:161], v246 offset:36864
 ds_read_b64_tr_b16 a[162:163], v246 offset:38912
 v_mfma_f32_16x16x32_bf16 v[180:183], a[144:147], v[212:215], v[180:183]
 s_waitcnt lgkmcnt(6)
 buffer_load_dwordx4 v[76:79], v250, s[56:59], s67 offen offset:3072 sc1
 v_mfma_f32_16x16x32_bf16 v[188:191], a[148:151], v[212:215], v[188:191]
 s_add_u32 m0, s64, 86016
 ds_read_b64_tr_b16 a[164:165], v247 offset:36864
 ds_read_b64_tr_b16 a[166:167], v247 offset:38912
 v_mfma_f32_16x16x32_bf16 v[184:187], a[148:151], v[208:211], v[184:187]
 s_waitcnt lgkmcnt(6)
 v_lshlrev_b32 v226, 16, v57
 v_and_b32 v227, s97, v57
 v_mfma_f32_16x16x32_bf16 v[192:195], a[152:155], v[208:211], v[192:195]
 s_add_u32 s65, s86, 110592
 ds_read_b64_tr_b16 a[168:169], v246 offset:37376
 ds_read_b64_tr_b16 a[170:171], v246 offset:39424
 v_mfma_f32_16x16x32_bf16 v[196:199], a[152:155], v[212:215], v[196:199]
 s_waitcnt lgkmcnt(6)
 buffer_load_dwordx4 v249, s[36:39], s65 offen lds
 v_mfma_f32_16x16x32_bf16 v[204:207], a[156:159], v[212:215], v[204:207]
 ds_read_b64_tr_b16 a[172:173], v247 offset:37376
 ds_read_b64_tr_b16 a[174:175], v247 offset:39424
 v_mfma_f32_16x16x32_bf16 v[200:203], a[156:159], v[208:211], v[200:203]
 s_waitcnt lgkmcnt(6)
 v_add_f32 v34, v34, v226
 v_add_f32 v35, v35, v227
 v_mfma_f32_16x16x32_bf16 v[176:179], a[160:163], v[216:219], v[176:179]
 ds_read_b64_tr_b16 a[144:145], v246 offset:40960
 ds_read_b64_tr_b16 a[146:147], v246 offset:43008
 v_mfma_f32_16x16x32_bf16 v[180:183], a[160:163], v[220:223], v[180:183]
 s_waitcnt lgkmcnt(6)
 v_lshlrev_b32 v224, 16, v58
 v_and_b32 v225, s97, v58
 v_mfma_f32_16x16x32_bf16 v[188:191], a[164:167], v[220:223], v[188:191]
 s_add_u32 m0, s64, 90112
 ds_read_b64_tr_b16 a[148:149], v247 offset:40960
 ds_read_b64_tr_b16 a[150:151], v247 offset:43008
 v_mfma_f32_16x16x32_bf16 v[184:187], a[164:167], v[216:219], v[184:187]
 s_waitcnt lgkmcnt(6)
 v_add_f32 v36, v36, v224
 v_add_f32 v37, v37, v225
 v_mfma_f32_16x16x32_bf16 v[192:195], a[168:171], v[216:219], v[192:195]
 s_add_u32 s65, s86, 147456
 ds_read_b64_tr_b16 a[152:153], v246 offset:41472
 ds_read_b64_tr_b16 a[154:155], v246 offset:43520
 v_mfma_f32_16x16x32_bf16 v[196:199], a[168:171], v[220:223], v[196:199]
 s_waitcnt lgkmcnt(6)
 buffer_load_dwordx4 v249, s[36:39], s65 offen lds
 v_mfma_f32_16x16x32_bf16 v[204:207], a[172:175], v[220:223], v[204:207]
 ds_read_b64_tr_b16 a[156:157], v247 offset:41472
 ds_read_b64_tr_b16 a[158:159], v247 offset:43520
 v_mfma_f32_16x16x32_bf16 v[200:203], a[172:175], v[216:219], v[200:203]
 s_waitcnt lgkmcnt(6)
 v_lshlrev_b32 v226, 16, v59
 v_and_b32 v227, s97, v59
 v_mfma_f32_16x16x32_bf16 v[176:179], a[144:147], v[0:3], v[176:179]
 ds_read_b64_tr_b16 a[160:161], v246 offset:45056
 ds_read_b64_tr_b16 a[162:163], v246 offset:47104
 v_mfma_f32_16x16x32_bf16 v[180:183], a[144:147], v[4:7], v[180:183]
 s_waitcnt lgkmcnt(6)
 v_add_f32 v38, v38, v226
 v_add_f32 v39, v39, v227
 v_mfma_f32_16x16x32_bf16 v[188:191], a[148:151], v[4:7], v[188:191]
 s_add_u32 m0, s64, 94208
 ds_read_b64_tr_b16 a[164:165], v247 offset:45056
 ds_read_b64_tr_b16 a[166:167], v247 offset:47104
 v_mfma_f32_16x16x32_bf16 v[184:187], a[148:151], v[0:3], v[184:187]
 s_waitcnt lgkmcnt(6)
 v_lshlrev_b32 v224, 16, v60
 v_and_b32 v225, s97, v60
 v_mfma_f32_16x16x32_bf16 v[192:195], a[152:155], v[0:3], v[192:195]
 s_add_u32 s65, s86, 184320
 ds_read_b64_tr_b16 a[168:169], v246 offset:45568
 ds_read_b64_tr_b16 a[170:171], v246 offset:47616
 v_mfma_f32_16x16x32_bf16 v[196:199], a[152:155], v[4:7], v[196:199]
 s_waitcnt lgkmcnt(6)
 buffer_load_dwordx4 v249, s[36:39], s65 offen lds
 v_mfma_f32_16x16x32_bf16 v[204:207], a[156:159], v[4:7], v[204:207]
 ds_read_b64_tr_b16 a[172:173], v247 offset:45568
 ds_read_b64_tr_b16 a[174:175], v247 offset:47616
 v_mfma_f32_16x16x32_bf16 v[200:203], a[156:159], v[0:3], v[200:203]
 s_waitcnt lgkmcnt(6)
 v_add_f32 v40, v40, v224
 v_add_f32 v41, v41, v225
 v_mfma_f32_16x16x32_bf16 v[176:179], a[160:163], v[8:11], v[176:179]
 s_barrier
 ds_read_b64_tr_b16 a[144:145], v242 offset:0
 ds_read_b64_tr_b16 a[146:147], v242 offset:2048
 v_mfma_f32_16x16x32_bf16 v[180:183], a[160:163], v[12:15], v[180:183]
 s_waitcnt lgkmcnt(6)
 v_lshlrev_b32 v226, 16, v61
 v_and_b32 v227, s97, v61
 v_mfma_f32_16x16x32_bf16 v[188:191], a[164:167], v[12:15], v[188:191]
 s_add_u32 m0, s64, 98304
 ds_read_b64_tr_b16 a[148:149], v243 offset:0
 ds_read_b64_tr_b16 a[150:151], v243 offset:2048
 v_mfma_f32_16x16x32_bf16 v[184:187], a[164:167], v[8:11], v[184:187]
 s_waitcnt lgkmcnt(6)
 v_add_f32 v42, v42, v226
 v_add_f32 v43, v43, v227
 v_mfma_f32_16x16x32_bf16 v[192:195], a[168:171], v[8:11], v[192:195]
 s_add_u32 s65, s86, 221184
 ds_read_b64_tr_b16 a[152:153], v242 offset:512
 ds_read_b64_tr_b16 a[154:155], v242 offset:2560
 v_mfma_f32_16x16x32_bf16 v[196:199], a[168:171], v[12:15], v[196:199]
 s_waitcnt lgkmcnt(6)
 buffer_load_dwordx4 v249, s[36:39], s65 offen lds
 v_mfma_f32_16x16x32_bf16 v[204:207], a[172:175], v[12:15], v[204:207]
 ds_read_b64_tr_b16 a[156:157], v243 offset:512
 ds_read_b64_tr_b16 a[158:159], v243 offset:2560
 v_mfma_f32_16x16x32_bf16 v[200:203], a[172:175], v[8:11], v[200:203]
 s_waitcnt lgkmcnt(6)
 v_lshlrev_b32 v224, 16, v62
 v_and_b32 v225, s97, v62
 v_add_f32 v44, v44, v224
 v_add_f32 v45, v45, v225
 v_lshlrev_b32 v226, 16, v63
 v_and_b32 v227, s97, v63
 v_add_f32 v46, v46, v226
 v_add_f32 v47, v47, v227
 v_mfma_f32_16x16x32_bf16 v[144:147], a[144:147], a[0:3], 0
 ds_read_b64_tr_b16 a[160:161], v242 offset:4096
 ds_read_b64_tr_b16 a[162:163], v242 offset:6144
 v_mfma_f32_16x16x32_bf16 v[148:151], a[144:147], a[4:7], 0
 s_waitcnt lgkmcnt(6)
 v_mfma_f32_16x16x32_bf16 v[156:159], a[148:151], a[4:7], 0
 s_add_u32 m0, s64, 102400
 ds_read_b64_tr_b16 a[164:165], v243 offset:4096
 ds_read_b64_tr_b16 a[166:167], v243 offset:6144
 v_mfma_f32_16x16x32_bf16 v[152:155], a[148:151], a[0:3], 0
 s_waitcnt lgkmcnt(6)
 v_cvt_pk_bf16_f32 v224, v176, v177
 v_cvt_pk_bf16_f32 v225, v178, v179
 v_mfma_f32_16x16x32_bf16 v[160:163], a[152:155], a[0:3], 0
 s_add_u32 s65, s86, 258048
 ds_read_b64_tr_b16 a[168:169], v242 offset:4608
 ds_read_b64_tr_b16 a[170:171], v242 offset:6656
 v_mfma_f32_16x16x32_bf16 v[164:167], a[152:155], a[4:7], 0
 s_waitcnt lgkmcnt(6)
 buffer_load_dwordx4 v249, s[36:39], s65 offen lds
 v_mfma_f32_16x16x32_bf16 v[172:175], a[156:159], a[4:7], 0
 ds_read_b64_tr_b16 a[172:173], v243 offset:4608
 ds_read_b64_tr_b16 a[174:175], v243 offset:6656
 v_mfma_f32_16x16x32_bf16 v[168:171], a[156:159], a[0:3], 0
 s_waitcnt lgkmcnt(6)
 v_cvt_pk_bf16_f32 v226, v180, v181
 v_cvt_pk_bf16_f32 v227, v182, v183
 v_mfma_f32_16x16x32_bf16 v[144:147], a[160:163], a[8:11], v[144:147]
 ds_read_b64_tr_b16 a[144:145], v242 offset:8192
 ds_read_b64_tr_b16 a[146:147], v242 offset:10240
 v_mfma_f32_16x16x32_bf16 v[148:151], a[160:163], a[12:15], v[148:151]
 s_waitcnt lgkmcnt(6)
 buffer_store_dwordx4 v[224:227], v250, s[56:59], s93 offen offset:0 sc1
 v_mfma_f32_16x16x32_bf16 v[156:159], a[164:167], a[12:15], v[156:159]
 s_add_u32 m0, s64, 106496
 ds_read_b64_tr_b16 a[148:149], v243 offset:8192
 ds_read_b64_tr_b16 a[150:151], v243 offset:10240
 v_mfma_f32_16x16x32_bf16 v[152:155], a[164:167], a[8:11], v[152:155]
 s_waitcnt lgkmcnt(6)
 v_cvt_pk_bf16_f32 v228, v184, v185
 v_cvt_pk_bf16_f32 v229, v186, v187
 v_mfma_f32_16x16x32_bf16 v[160:163], a[168:171], a[8:11], v[160:163]
 s_add_u32 s65, s86, 294912
 ds_read_b64_tr_b16 a[152:153], v242 offset:8704
 ds_read_b64_tr_b16 a[154:155], v242 offset:10752
 v_mfma_f32_16x16x32_bf16 v[164:167], a[168:171], a[12:15], v[164:167]
 s_waitcnt lgkmcnt(6)
 buffer_load_dwordx4 v249, s[36:39], s65 offen lds
 v_mfma_f32_16x16x32_bf16 v[172:175], a[172:175], a[12:15], v[172:175]
 ds_read_b64_tr_b16 a[156:157], v243 offset:8704
 ds_read_b64_tr_b16 a[158:159], v243 offset:10752
 v_mfma_f32_16x16x32_bf16 v[168:171], a[172:175], a[8:11], v[168:171]
 s_waitcnt lgkmcnt(6)
 v_cvt_pk_bf16_f32 v230, v188, v189
 v_cvt_pk_bf16_f32 v231, v190, v191
 v_mfma_f32_16x16x32_bf16 v[144:147], a[144:147], a[16:19], v[144:147]
 ds_read_b64_tr_b16 a[160:161], v242 offset:12288
 ds_read_b64_tr_b16 a[162:163], v242 offset:14336
 v_mfma_f32_16x16x32_bf16 v[148:151], a[144:147], a[20:23], v[148:151]
 s_waitcnt lgkmcnt(6)
 buffer_store_dwordx4 v[228:231], v250, s[56:59], s93 offen offset:1024 sc1
 v_mfma_f32_16x16x32_bf16 v[156:159], a[148:151], a[20:23], v[156:159]
 s_add_u32 m0, s64, 110592
 ds_read_b64_tr_b16 a[164:165], v243 offset:12288
 ds_read_b64_tr_b16 a[166:167], v243 offset:14336
 v_mfma_f32_16x16x32_bf16 v[152:155], a[148:151], a[16:19], v[152:155]
 s_waitcnt lgkmcnt(6)
 v_cvt_pk_bf16_f32 v232, v192, v193
 v_cvt_pk_bf16_f32 v233, v194, v195
 v_mfma_f32_16x16x32_bf16 v[160:163], a[152:155], a[16:19], v[160:163]
 s_add_u32 s65, s86, 331776
 ds_read_b64_tr_b16 a[168:169], v242 offset:12800
 ds_read_b64_tr_b16 a[170:171], v242 offset:14848
 v_mfma_f32_16x16x32_bf16 v[164:167], a[152:155], a[20:23], v[164:167]
 s_waitcnt lgkmcnt(6)
 buffer_load_dwordx4 v249, s[36:39], s65 offen lds
 v_mfma_f32_16x16x32_bf16 v[172:175], a[156:159], a[20:23], v[172:175]
 ds_read_b64_tr_b16 a[172:173], v243 offset:12800
 ds_read_b64_tr_b16 a[174:175], v243 offset:14848
 v_mfma_f32_16x16x32_bf16 v[168:171], a[156:159], a[16:19], v[168:171]
 s_waitcnt lgkmcnt(6)
 v_cvt_pk_bf16_f32 v234, v196, v197
 v_cvt_pk_bf16_f32 v235, v198, v199
 v_mfma_f32_16x16x32_bf16 v[144:147], a[160:163], a[24:27], v[144:147]
 ds_read_b64_tr_b16 a[144:145], v242 offset:16384
 ds_read_b64_tr_b16 a[146:147], v242 offset:18432
 v_mfma_f32_16x16x32_bf16 v[148:151], a[160:163], a[28:31], v[148:151]
 s_waitcnt lgkmcnt(6)
 buffer_store_dwordx4 v[232:235], v250, s[56:59], s93 offen offset:2048 sc1
 v_mfma_f32_16x16x32_bf16 v[156:159], a[164:167], a[28:31], v[156:159]
 s_add_u32 m0, s64, 114688
 ds_read_b64_tr_b16 a[148:149], v243 offset:16384
 ds_read_b64_tr_b16 a[150:151], v243 offset:18432
 v_mfma_f32_16x16x32_bf16 v[152:155], a[164:167], a[24:27], v[152:155]
 s_waitcnt lgkmcnt(6)
 v_cvt_pk_bf16_f32 v224, v200, v201
 v_cvt_pk_bf16_f32 v225, v202, v203
 v_mfma_f32_16x16x32_bf16 v[160:163], a[168:171], a[24:27], v[160:163]
 s_add_u32 s65, s86, 368640
 ds_read_b64_tr_b16 a[152:153], v242 offset:16896
 ds_read_b64_tr_b16 a[154:155], v242 offset:18944
 v_mfma_f32_16x16x32_bf16 v[164:167], a[168:171], a[28:31], v[164:167]
 s_waitcnt lgkmcnt(6)
 buffer_load_dwordx4 v249, s[36:39], s65 offen lds
 v_mfma_f32_16x16x32_bf16 v[172:175], a[172:175], a[28:31], v[172:175]
 ds_read_b64_tr_b16 a[156:157], v243 offset:16896
 ds_read_b64_tr_b16 a[158:159], v243 offset:18944
 v_mfma_f32_16x16x32_bf16 v[168:171], a[172:175], a[24:27], v[168:171]
 s_waitcnt lgkmcnt(6)
 v_cvt_pk_bf16_f32 v226, v204, v205
 v_cvt_pk_bf16_f32 v227, v206, v207
 v_mfma_f32_16x16x32_bf16 v[144:147], a[144:147], a[32:35], v[144:147]
 ds_read_b64_tr_b16 a[160:161], v242 offset:20480
 ds_read_b64_tr_b16 a[162:163], v242 offset:22528
 v_mfma_f32_16x16x32_bf16 v[148:151], a[144:147], a[36:39], v[148:151]
 s_waitcnt lgkmcnt(6)
 buffer_store_dwordx4 v[224:227], v250, s[56:59], s93 offen offset:3072 sc1
 v_mfma_f32_16x16x32_bf16 v[156:159], a[148:151], a[36:39], v[156:159]
 s_add_u32 m0, s64, 118784
 ds_read_b64_tr_b16 a[164:165], v243 offset:20480
 ds_read_b64_tr_b16 a[166:167], v243 offset:22528
 v_mfma_f32_16x16x32_bf16 v[152:155], a[148:151], a[32:35], v[152:155]
 s_waitcnt lgkmcnt(6)
 buffer_load_dwordx2 v[102:103], v98, s[56:59], 0 offen sc1
 v_mfma_f32_16x16x32_bf16 v[160:163], a[152:155], a[32:35], v[160:163]
 s_add_u32 s65, s86, 405504
 ds_read_b64_tr_b16 a[168:169], v242 offset:20992
 ds_read_b64_tr_b16 a[170:171], v242 offset:23040
 v_mfma_f32_16x16x32_bf16 v[164:167], a[152:155], a[36:39], v[164:167]
 s_waitcnt lgkmcnt(6)
 buffer_load_dwordx4 v249, s[36:39], s65 offen lds
 v_mfma_f32_16x16x32_bf16 v[172:175], a[156:159], a[36:39], v[172:175]
 s_waitcnt vmcnt(14)
 ds_read_b64_tr_b16 a[172:173], v243 offset:20992
 ds_read_b64_tr_b16 a[174:175], v243 offset:23040
 v_mfma_f32_16x16x32_bf16 v[168:171], a[156:159], a[32:35], v[168:171]
 s_waitcnt lgkmcnt(6)
 v_lshlrev_b32 v224, 16, v64
 v_and_b32 v225, s97, v64
 v_mfma_f32_16x16x32_bf16 v[144:147], a[160:163], a[40:43], v[144:147]
 s_barrier
 ds_read_b64_tr_b16 a[144:145], v242 offset:24576
 ds_read_b64_tr_b16 a[146:147], v242 offset:26624
 v_mfma_f32_16x16x32_bf16 v[148:151], a[160:163], a[44:47], v[148:151]
 s_waitcnt lgkmcnt(6)
 v_add_f32 v16, v16, v224
 v_add_f32 v17, v17, v225
 v_mfma_f32_16x16x32_bf16 v[156:159], a[164:167], a[44:47], v[156:159]
 s_add_u32 m0, s64, 122880
 ds_read_b64_tr_b16 a[148:149], v243 offset:24576
 ds_read_b64_tr_b16 a[150:151], v243 offset:26624
 v_mfma_f32_16x16x32_bf16 v[152:155], a[164:167], a[40:43], v[152:155]
 s_waitcnt lgkmcnt(6)
 v_lshlrev_b32 v226, 16, v65
 v_and_b32 v227, s97, v65
 v_mfma_f32_16x16x32_bf16 v[160:163], a[168:171], a[40:43], v[160:163]
 s_add_u32 s65, s86, 442368
 ds_read_b64_tr_b16 a[152:153], v242 offset:25088
 ds_read_b64_tr_b16 a[154:155], v242 offset:27136
 v_mfma_f32_16x16x32_bf16 v[164:167], a[168:171], a[44:47], v[164:167]
 s_waitcnt lgkmcnt(6)
 buffer_load_dwordx4 v249, s[36:39], s65 offen lds
 v_mfma_f32_16x16x32_bf16 v[172:175], a[172:175], a[44:47], v[172:175]
 ds_read_b64_tr_b16 a[156:157], v243 offset:25088
 ds_read_b64_tr_b16 a[158:159], v243 offset:27136
 v_mfma_f32_16x16x32_bf16 v[168:171], a[172:175], a[40:43], v[168:171]
 s_waitcnt lgkmcnt(6)
 v_add_f32 v18, v18, v226
 v_add_f32 v19, v19, v227
 v_mfma_f32_16x16x32_bf16 v[144:147], a[144:147], a[48:51], v[144:147]
 ds_read_b64_tr_b16 a[160:161], v242 offset:28672
 ds_read_b64_tr_b16 a[162:163], v242 offset:30720
 v_mfma_f32_16x16x32_bf16 v[148:151], a[144:147], a[52:55], v[148:151]
 s_waitcnt lgkmcnt(6)
 v_lshlrev_b32 v224, 16, v66
 v_and_b32 v225, s97, v66
 v_mfma_f32_16x16x32_bf16 v[156:159], a[148:151], a[52:55], v[156:159]
 s_add_u32 m0, s64, 126976
 ds_read_b64_tr_b16 a[164:165], v243 offset:28672
 ds_read_b64_tr_b16 a[166:167], v243 offset:30720
 v_mfma_f32_16x16x32_bf16 v[152:155], a[148:151], a[48:51], v[152:155]
 s_waitcnt lgkmcnt(6)
 v_add_f32 v20, v20, v224
 v_add_f32 v21, v21, v225
 v_mfma_f32_16x16x32_bf16 v[160:163], a[152:155], a[48:51], v[160:163]
 s_add_u32 s65, s86, 479232
 ds_read_b64_tr_b16 a[168:169], v242 offset:29184
 ds_read_b64_tr_b16 a[170:171], v242 offset:31232
 v_mfma_f32_16x16x32_bf16 v[164:167], a[152:155], a[52:55], v[164:167]
 s_waitcnt lgkmcnt(6)
 buffer_load_dwordx4 v249, s[36:39], s65 offen lds
 v_mfma_f32_16x16x32_bf16 v[172:175], a[156:159], a[52:55], v[172:175]
 ds_read_b64_tr_b16 a[172:173], v243 offset:29184
 ds_read_b64_tr_b16 a[174:175], v243 offset:31232
 v_mfma_f32_16x16x32_bf16 v[168:171], a[156:159], a[48:51], v[168:171]
 s_waitcnt lgkmcnt(6)
 v_lshlrev_b32 v226, 16, v67
 v_and_b32 v227, s97, v67
 v_mfma_f32_16x16x32_bf16 v[144:147], a[160:163], a[56:59], v[144:147]
 ds_read_b64_tr_b16 a[144:145], v242 offset:32768
 ds_read_b64_tr_b16 a[146:147], v242 offset:34816
 v_mfma_f32_16x16x32_bf16 v[148:151], a[160:163], a[60:63], v[148:151]
 s_waitcnt lgkmcnt(6)
 v_add_f32 v22, v22, v226
 v_add_f32 v23, v23, v227
 v_mfma_f32_16x16x32_bf16 v[156:159], a[164:167], a[60:63], v[156:159]
 s_add_u32 m0, s64, 131072
 ds_read_b64_tr_b16 a[148:149], v243 offset:32768
 ds_read_b64_tr_b16 a[150:151], v243 offset:34816
 v_mfma_f32_16x16x32_bf16 v[152:155], a[164:167], a[56:59], v[152:155]
 s_waitcnt lgkmcnt(6)
 v_lshlrev_b32 v224, 16, v68
 v_and_b32 v225, s97, v68
 v_mfma_f32_16x16x32_bf16 v[160:163], a[168:171], a[56:59], v[160:163]
 s_add_u32 s65, s86, 516096
 ds_read_b64_tr_b16 a[152:153], v242 offset:33280
 ds_read_b64_tr_b16 a[154:155], v242 offset:35328
 v_mfma_f32_16x16x32_bf16 v[164:167], a[168:171], a[60:63], v[164:167]
 s_waitcnt lgkmcnt(6)
 buffer_load_dwordx4 v249, s[36:39], s65 offen lds
 v_mfma_f32_16x16x32_bf16 v[172:175], a[172:175], a[60:63], v[172:175]
 ds_read_b64_tr_b16 a[156:157], v243 offset:33280
 ds_read_b64_tr_b16 a[158:159], v243 offset:35328
 v_mfma_f32_16x16x32_bf16 v[168:171], a[172:175], a[56:59], v[168:171]
 s_waitcnt lgkmcnt(6)
 v_add_f32 v24, v24, v224
 v_add_f32 v25, v25, v225
 v_mfma_f32_16x16x32_bf16 v[144:147], a[144:147], a[64:67], v[144:147]
 ds_read_b64_tr_b16 a[160:161], v242 offset:36864
 ds_read_b64_tr_b16 a[162:163], v242 offset:38912
 v_mfma_f32_16x16x32_bf16 v[148:151], a[144:147], a[68:71], v[148:151]
 s_waitcnt lgkmcnt(6)
 v_lshlrev_b32 v226, 16, v69
 v_and_b32 v227, s97, v69
 v_mfma_f32_16x16x32_bf16 v[156:159], a[148:151], a[68:71], v[156:159]
 s_add_u32 m0, s64, 135168
 ds_read_b64_tr_b16 a[164:165], v243 offset:36864
 ds_read_b64_tr_b16 a[166:167], v243 offset:38912
 v_mfma_f32_16x16x32_bf16 v[152:155], a[148:151], a[64:67], v[152:155]
 s_waitcnt lgkmcnt(6)
 v_add_f32 v26, v26, v226
 v_add_f32 v27, v27, v227
 v_mfma_f32_16x16x32_bf16 v[160:163], a[152:155], a[64:67], v[160:163]
 s_add_u32 s65, s86, 552960
 ds_read_b64_tr_b16 a[168:169], v242 offset:37376
 ds_read_b64_tr_b16 a[170:171], v242 offset:39424
 v_mfma_f32_16x16x32_bf16 v[164:167], a[152:155], a[68:71], v[164:167]
 s_waitcnt lgkmcnt(6)
 buffer_load_dwordx4 v249, s[36:39], s65 offen lds
 v_mfma_f32_16x16x32_bf16 v[172:175], a[156:159], a[68:71], v[172:175]
 ds_read_b64_tr_b16 a[172:173], v243 offset:37376
 ds_read_b64_tr_b16 a[174:175], v243 offset:39424
 v_mfma_f32_16x16x32_bf16 v[168:171], a[156:159], a[64:67], v[168:171]
 s_waitcnt lgkmcnt(6)
 v_lshlrev_b32 v224, 16, v70
 v_and_b32 v225, s97, v70
 v_mfma_f32_16x16x32_bf16 v[144:147], a[160:163], a[72:75], v[144:147]
 ds_read_b64_tr_b16 a[144:145], v242 offset:40960
 ds_read_b64_tr_b16 a[146:147], v242 offset:43008
 v_mfma_f32_16x16x32_bf16 v[148:151], a[160:163], a[76:79], v[148:151]
 s_waitcnt lgkmcnt(6)
 v_add_f32 v28, v28, v224
 v_add_f32 v29, v29, v225
 v_mfma_f32_16x16x32_bf16 v[156:159], a[164:167], a[76:79], v[156:159]
 s_add_u32 m0, s64, 139264
 ds_read_b64_tr_b16 a[148:149], v243 offset:40960
 ds_read_b64_tr_b16 a[150:151], v243 offset:43008
 v_mfma_f32_16x16x32_bf16 v[152:155], a[164:167], a[72:75], v[152:155]
 s_waitcnt lgkmcnt(6)
 v_lshlrev_b32 v226, 16, v71
 v_and_b32 v227, s97, v71
 v_mfma_f32_16x16x32_bf16 v[160:163], a[168:171], a[72:75], v[160:163]
 s_add_u32 s65, s86, 589824
 ds_read_b64_tr_b16 a[152:153], v242 offset:41472
 ds_read_b64_tr_b16 a[154:155], v242 offset:43520
 v_mfma_f32_16x16x32_bf16 v[164:167], a[168:171], a[76:79], v[164:167]
 s_waitcnt lgkmcnt(6)
 buffer_load_dwordx4 v249, s[36:39], s65 offen lds
 v_mfma_f32_16x16x32_bf16 v[172:175], a[172:175], a[76:79], v[172:175]
 ds_read_b64_tr_b16 a[156:157], v243 offset:41472
 ds_read_b64_tr_b16 a[158:159], v243 offset:43520
 v_mfma_f32_16x16x32_bf16 v[168:171], a[172:175], a[72:75], v[168:171]
 s_waitcnt lgkmcnt(6)
 v_add_f32 v30, v30, v226
 v_add_f32 v31, v31, v227
 v_mfma_f32_16x16x32_bf16 v[144:147], a[144:147], a[80:83], v[144:147]
 ds_read_b64_tr_b16 a[160:161], v242 offset:45056
 ds_read_b64_tr_b16 a[162:163], v242 offset:47104
 v_mfma_f32_16x16x32_bf16 v[148:151], a[144:147], a[84:87], v[148:151]
 s_waitcnt lgkmcnt(6)
 v_lshlrev_b32 v224, 16, v72
 v_and_b32 v225, s97, v72
 v_mfma_f32_16x16x32_bf16 v[156:159], a[148:151], a[84:87], v[156:159]
 s_add_u32 m0, s64, 143360
 ds_read_b64_tr_b16 a[164:165], v243 offset:45056
 ds_read_b64_tr_b16 a[166:167], v243 offset:47104
 v_mfma_f32_16x16x32_bf16 v[152:155], a[148:151], a[80:83], v[152:155]
 s_waitcnt lgkmcnt(6)
 v_add_f32 v32, v32, v224
 v_add_f32 v33, v33, v225
 v_mfma_f32_16x16x32_bf16 v[160:163], a[152:155], a[80:83], v[160:163]
 s_add_u32 s65, s86, 626688
 ds_read_b64_tr_b16 a[168:169], v242 offset:45568
 ds_read_b64_tr_b16 a[170:171], v242 offset:47616
 v_mfma_f32_16x16x32_bf16 v[164:167], a[152:155], a[84:87], v[164:167]
 s_waitcnt lgkmcnt(6)
 buffer_load_dwordx4 v249, s[36:39], s65 offen lds
 v_mfma_f32_16x16x32_bf16 v[172:175], a[156:159], a[84:87], v[172:175]
 s_sub_u32 s67, s61, 3
 ds_read_b64_tr_b16 a[172:173], v243 offset:45568
 ds_read_b64_tr_b16 a[174:175], v243 offset:47616
 v_mfma_f32_16x16x32_bf16 v[168:171], a[156:159], a[80:83], v[168:171]
 s_waitcnt lgkmcnt(6)
 s_and_b32 s67, s67, 7
 s_lshl_b32 s68, s67, 3
 v_mfma_f32_16x16x32_bf16 v[144:147], a[160:163], a[88:91], v[144:147]
 s_mul_i32 s67, s67, 147456
 s_barrier
 ds_read_b64_tr_b16 a[144:145], v244 offset:0
 ds_read_b64_tr_b16 a[146:147], v244 offset:2048
 v_mfma_f32_16x16x32_bf16 v[148:151], a[160:163], a[92:95], v[148:151]
 s_waitcnt lgkmcnt(6)
 s_add_u32 s67, s67, s73
 v_mfma_f32_16x16x32_bf16 v[156:159], a[164:167], a[92:95], v[156:159]
 s_add_u32 m0, s64, 0
 ds_read_b64_tr_b16 a[148:149], v245 offset:0
 ds_read_b64_tr_b16 a[150:151], v245 offset:2048
 v_mfma_f32_16x16x32_bf16 v[152:155], a[164:167], a[88:91], v[152:155]
 s_waitcnt lgkmcnt(6)
 v_mfma_f32_16x16x32_bf16 v[160:163], a[168:171], a[88:91], v[160:163]
 s_add_u32 s65, s87, 0
 ds_read_b64_tr_b16 a[152:153], v244 offset:512
 ds_read_b64_tr_b16 a[154:155], v244 offset:2560
 v_mfma_f32_16x16x32_bf16 v[164:167], a[168:171], a[92:95], v[164:167]
 s_waitcnt lgkmcnt(6)
 buffer_load_dwordx4 v249, s[36:39], s65 offen lds
 v_mfma_f32_16x16x32_bf16 v[172:175], a[172:175], a[92:95], v[172:175]
 s_waitcnt vmcnt(8)
 ds_read_b64_tr_b16 a[156:157], v245 offset:512
 ds_read_b64_tr_b16 a[158:159], v245 offset:2560
 v_mfma_f32_16x16x32_bf16 v[168:171], a[172:175], a[88:91], v[168:171]
 s_waitcnt lgkmcnt(6)
 s_lshl2_add_u32 s69, s84, s3
 v_mfma_f32_16x16x32_bf16 v[144:147], a[144:147], a[96:99], v[144:147]
 ds_read_b64_tr_b16 a[160:161], v244 offset:4096
 ds_read_b64_tr_b16 a[162:163], v244 offset:6144
 v_mfma_f32_16x16x32_bf16 v[148:151], a[144:147], a[100:103], v[148:151]
 s_waitcnt lgkmcnt(6)
 buffer_store_byte v252, v101, s[56:59], s69 offen sc1
 v_mfma_f32_16x16x32_bf16 v[156:159], a[148:151], a[100:103], v[156:159]
 s_add_u32 m0, s64, 4096
 ds_read_b64_tr_b16 a[164:165], v245 offset:4096
 ds_read_b64_tr_b16 a[166:167], v245 offset:6144
 v_mfma_f32_16x16x32_bf16 v[152:155], a[148:151], a[96:99], v[152:155]
 s_waitcnt lgkmcnt(6)
 v_readfirstlane_b32 s26, v102
 v_readfirstlane_b32 s27, v103
 v_mfma_f32_16x16x32_bf16 v[160:163], a[152:155], a[96:99], v[160:163]
 s_add_u32 s65, s87, 36864
 ds_read_b64_tr_b16 a[168:169], v244 offset:4608
 ds_read_b64_tr_b16 a[170:171], v244 offset:6656
 v_mfma_f32_16x16x32_bf16 v[164:167], a[152:155], a[100:103], v[164:167]
 s_waitcnt lgkmcnt(6)
 buffer_load_dwordx4 v249, s[36:39], s65 offen lds
 v_mfma_f32_16x16x32_bf16 v[172:175], a[156:159], a[100:103], v[172:175]
 ds_read_b64_tr_b16 a[172:173], v245 offset:4608
 ds_read_b64_tr_b16 a[174:175], v245 offset:6656
 v_mfma_f32_16x16x32_bf16 v[168:171], a[156:159], a[96:99], v[168:171]
 s_waitcnt lgkmcnt(6)
 s_lshr_b64 s[26:27], s[26:27], s68
 s_and_b32 s26, s26, 0xff
 s_cbranch_scc0 L_chk2
L_chk2_ok:
 v_mfma_f32_16x16x32_bf16 v[144:147], a[160:163], a[104:107], v[144:147]
 ds_read_b64_tr_b16 a[144:145], v244 offset:8192
 ds_read_b64_tr_b16 a[146:147], v244 offset:10240
 v_mfma_f32_16x16x32_bf16 v[148:151], a[160:163], a[108:111], v[148:151]
 s_waitcnt lgkmcnt(6)
 buffer_load_dwordx4 v[48:51], v250, s[56:59], s67 offen offset:0 sc1
 v_mfma_f32_16x16x32_bf16 v[156:159], a[164:167], a[108:111], v[156:159]
 s_add_u32 m0, s64, 8192
 ds_read_b64_tr_b16 a[148:149], v245 offset:8192
 ds_read_b64_tr_b16 a[150:151], v245 offset:10240
 v_mfma_f32_16x16x32_bf16 v[152:155], a[164:167], a[104:107], v[152:155]
 s_waitcnt lgkmcnt(6)
 buffer_load_dwordx4 v[52:55], v250, s[56:59], s67 offen offset:1024 sc1
 v_mfma_f32_16x16x32_bf16 v[160:163], a[168:171], a[104:107], v[160:163]
 s_add_u32 s65, s87, 73728
 ds_read_b64_tr_b16 a[152:153], v244 offset:8704
 ds_read_b64_tr_b16 a[154:155], v244 offset:10752
 v_mfma_f32_16x16x32_bf16 v[164:167], a[168:171], a[108:111], v[164:167]
 s_waitcnt lgkmcnt(6)
 buffer_load_dwordx4 v249, s[36:39], s65 offen lds
 v_mfma_f32_16x16x32_bf16 v[172:175], a[172:175], a[108:111], v[172:175]
 ds_read_b64_tr_b16 a[156:157], v245 offset:8704
 ds_read_b64_tr_b16 a[158:159], v245 offset:10752
 v_mfma_f32_16x16x32_bf16 v[168:171], a[172:175], a[104:107], v[168:171]
 s_waitcnt lgkmcnt(6)
 buffer_load_dwordx4 v[56:59], v250, s[56:59], s67 offen offset:2048 sc1
 v_mfma_f32_16x16x32_bf16 v[144:147], a[144:147], v[208:211], v[144:147]
 ds_read_b64_tr_b16 a[160:161], v244 offset:12288
 ds_read_b64_tr_b16 a[162:163], v244 offset:14336
 v_mfma_f32_16x16x32_bf16 v[148:151], a[144:147], v[212:215], v[148:151]
 s_waitcnt lgkmcnt(6)
 buffer_load_dwordx4 v[60:63], v250, s[56:59], s67 offen offset:3072 sc1
 v_mfma_f32_16x16x32_bf16 v[156:159], a[148:151], v[212:215], v[156:159]
 s_add_u32 m0, s64, 12288
 ds_read_b64_tr_b16 a[164:165], v245 offset:12288
 ds_read_b64_tr_b16 a[166:167], v245 offset:14336
 v_mfma_f32_16x16x32_bf16 v[152:155], a[148:151], v[208:211], v[152:155]
 s_waitcnt lgkmcnt(6)
 v_lshlrev_b32 v226, 16, v73
 v_and_b32 v227, s97, v73
 v_mfma_f32_16x16x32_bf16 v[160:163], a[152:155], v[208:211], v[160:163]
 s_add_u32 s65, s87, 110592
 ds_read_b64_tr_b16 a[168:169], v244 offset:12800
 ds_read_b64_tr_b16 a[170:171], v244 offset:14848
 v_mfma_f32_16x16x32_bf16 v[164:167], a[152:155], v[212:215], v[164:167]
 s_waitcnt lgkmcnt(6)
 buffer_load_dwordx4 v249, s[36:39], s65 offen lds
 v_mfma_f32_16x16x32_bf16 v[172:175], a[156:159], v[212:215], v[172:175]
 ds_read_b64_tr_b16 a[172:173], v245 offset:12800
 ds_read_b64_tr_b16 a[174:175], v245 offset:14848
 v_mfma_f32_16x16x32_bf16 v[168:171], a[156:159], v[208:211], v[168:171]
 s_waitcnt lgkmcnt(6)
 v_add_f32 v34, v34, v226
 v_add_f32 v35, v35, v227
 v_mfma_f32_16x16x32_bf16 v[144:147], a[160:163], v[216:219], v[144:147]
 ds_read_b64_tr_b16 a[144:145], v244 offset:16384
 ds_read_b64_tr_b16 a[146:147], v244 offset:18432
 v_mfma_f32_16x16x32_bf16 v[148:151], a[160:163], v[220:223], v[148:151]
 s_waitcnt lgkmcnt(6)
 v_lshlrev_b32 v224, 16, v74
 v_and_b32 v225, s97, v74
 v_mfma_f32_16x16x32_bf16 v[156:159], a[164:167], v[220:223], v[156:159]
 s_add_u32 m0, s64, 16384
 ds_read_b64_tr_b16 a[148:149], v245 offset:16384
 ds_read_b64_tr_b16 a[150:151], v245 offset:18432
 v_mfma_f32_16x16x32_bf16 v[152:155], a[164:167], v[216:219], v[152:155]
 s_waitcnt lgkmcnt(6)
 v_add_f32 v36, v36, v224
 v_add_f32 v37, v37, v225
 v_mfma_f32_16x16x32_bf16 v[160:163], a[168:171], v[216:219], v[160:163]
 s_add_u32 s65, s87, 147456
 ds_read_b64_tr_b16 a[152:153], v244 offset:16896
 ds_read_b64_tr_b16 a[154:155], v244 offset:18944
 v_mfma_f32_16x16x32_bf16 v[164:167], a[168:171], v[220:223], v[164:167]
 s_waitcnt lgkmcnt(6)
 buffer_load_dwordx4 v249, s[36:39], s65 offen lds
 v_mfma_f32_16x16x32_bf16 v[172:175], a[172:175], v[220:223], v[172:175]
 ds_read_b64_tr_b16 a[156:157], v245 offset:16896
 ds_read_b64_tr_b16 a[158:159], v245 offset:18944
 v_mfma_f32_16x16x32_bf16 v[168:171], a[172:175], v[216:219], v[168:171]
 s_waitcnt lgkmcnt(6)
 v_lshlrev_b32 v226, 16, v75
 v_and_b32 v227, s97, v75
 v_mfma_f32_16x16x32_bf16 v[144:147], a[144:147], v[0:3], v[144:147]
 ds_read_b64_tr_b16 a[160:161], v244 offset:20480
 ds_read_b64_tr_b16 a[162:163], v244 offset:22528
 v_mfma_f32_16x16x32_bf16 v[148:151], a[144:147], v[4:7], v[148:151]
 s_waitcnt lgkmcnt(6)
 v_add_f32 v38, v38, v226
 v_add_f32 v39, v39, v227
 v_mfma_f32_16x16x32_bf16 v[156:159], a[148:151], v[4:7], v[156:159]
 s_add_u32 m0, s64, 20480
 ds_read_b64_tr_b16 a[164:165], v245 offset:20480
 ds_read_b64_tr_b16 a[166:167], v245 offset:22528
 v_mfma_f32_16x16x32_bf16 v[152:155], a[148:151], v[0:3], v[152:155]
 s_waitcnt lgkmcnt(6)
 v_lshlrev_b32 v224, 16, v76
 v_and_b32 v225, s97, v76
 v_mfma_f32_16x16x32_bf16 v[160:163], a[152:155], v[0:3], v[160:163]
 s_add_u32 s65, s87, 184320
 ds_read_b64_tr_b16 a[168:169], v244 offset:20992
 ds_read_b64_tr_b16 a[170:171], v244 offset:23040
 v_mfma_f32_16x16x32_bf16 v[164:167], a[152:155], v[4:7], v[164:167]
 s_waitcnt lgkmcnt(6)
 buffer_load_dwordx4 v249, s[36:39], s65 offen lds
 v_mfma_f32_16x16x32_bf16 v[172:175], a[156:159], v[4:7], v[172:175]
 ds_read_b64_tr_b16 a[172:173], v245 offset:20992
 ds_read_b64_tr_b16 a[174:175], v245 offset:23040
 v_mfma_f32_16x16x32_bf16 v[168:171], a[156:159], v[0:3], v[168:171]
 s_waitcnt lgkmcnt(6)
 v_add_f32 v40, v40, v224
 v_add_f32 v41, v41, v225
 v_mfma_f32_16x16x32_bf16 v[144:147], a[160:163], v[8:11], v[144:147]
 s_barrier
 ds_read_b64_tr_b16 a[144:145], v244 offset:24576
 ds_read_b64_tr_b16 a[146:147], v244 offset:26624
 v_mfma_f32_16x16x32_bf16 v[148:151], a[160:163], v[12:15], v[148:151]
 s_waitcnt lgkmcnt(6)
 v_lshlrev_b32 v226, 16, v77
 v_and_b32 v227, s97, v77
 v_mfma_f32_16x16x32_bf16 v[156:159], a[164:167], v[12:15], v[156:159]
 s_add_u32 m0, s64, 24576
 ds_read_b64_tr_b16 a[148:149], v245 offset:24576
 ds_read_b64_tr_b16 a[150:151], v245 offset:26624
 v_mfma_f32_16x16x32_bf16 v[152:155], a[164:167], v[8:11], v[152:155]
 s_waitcnt lgkmcnt(6)
 v_add_f32 v42, v42, v226
 v_add_f32 v43, v43, v227
 v_mfma_f32_16x16x32_bf16 v[160:163], a[168:171], v[8:11], v[160:163]
 s_add_u32 s65, s87, 221184
 ds_read_b64_tr_b16 a[152:153], v244 offset:25088
 ds_read_b64_tr_b16 a[154:155], v244 offset:27136
 v_mfma_f32_16x16x32_bf16 v[164:167], a[168:171], v[12:15], v[164:167]
 s_waitcnt lgkmcnt(6)
 buffer_load_dwordx4 v249, s[36:39], s65 offen lds
 v_mfma_f32_16x16x32_bf16 v[172:175], a[172:175], v[12:15], v[172:175]
 ds_read_b64_tr_b16 a[156:157], v245 offset:25088
 ds_read_b64_tr_b16 a[158:159], v245 offset:27136
 v_mfma_f32_16x16x32_bf16 v[168:171], a[172:175], v[8:11], v[168:171]
 s_waitcnt lgkmcnt(6)
 v_lshlrev_b32 v224, 16, v78
 v_and_b32 v225, s97, v78
 v_add_f32 v44, v44, v224
 v_add_f32 v45, v45, v225
 v_lshlrev_b32 v226, 16, v79
 v_and_b32 v227, s97, v79
 v_add_f32 v46, v46, v226
 v_add_f32 v47, v47, v227
 v_mfma_f32_16x16x32_bf16 v[176:179], a[144:147], a[0:3], 0
 ds_read_b64_tr_b16 a[160:161], v244 offset:28672
 ds_read_b64_tr_b16 a[162:163], v244 offset:30720
 v_mfma_f32_16x16x32_bf16 v[180:183], a[144:147], a[4:7], 0
 s_waitcnt lgkmcnt(6)
 v_mfma_f32_16x16x32_bf16 v[188:191], a[148:151], a[4:7], 0
 s_add_u32 m0, s64, 28672
 ds_read_b64_tr_b16 a[164:165], v245 offset:28672
 ds_read_b64_tr_b16 a[166:167], v245 offset:30720
 v_mfma_f32_16x16x32_bf16 v[184:187], a[148:151], a[0:3], 0
 s_waitcnt lgkmcnt(6)
 v_cvt_pk_bf16_f32 v224, v144, v145
 v_cvt_pk_bf16_f32 v225, v146, v147
 v_mfma_f32_16x16x32_bf16 v[192:195], a[152:155], a[0:3], 0
 s_add_u32 s65, s87, 258048
 ds_read_b64_tr_b16 a[168:169], v244 offset:29184
 ds_read_b64_tr_b16 a[170:171], v244 offset:31232
 v_mfma_f32_16x16x32_bf16 v[196:199], a[152:155], a[4:7], 0
 s_waitcnt lgkmcnt(6)
 buffer_load_dwordx4 v249, s[36:39], s65 offen lds
 v_mfma_f32_16x16x32_bf16 v[204:207], a[156:159], a[4:7], 0
 ds_read_b64_tr_b16 a[172:173], v245 offset:29184
 ds_read_b64_tr_b16 a[174:175], v245 offset:31232
 v_mfma_f32_16x16x32_bf16 v[200:203], a[156:159], a[0:3], 0
 s_waitcnt lgkmcnt(6)
 v_cvt_pk_bf16_f32 v226, v148, v149
 v_cvt_pk_bf16_f32 v227, v150, v151
 v_mfma_f32_16x16x32_bf16 v[176:179], a[160:163], a[8:11], v[176:179]
 ds_read_b64_tr_b16 a[144:145], v244 offset:32768
 ds_read_b64_tr_b16 a[146:147], v244 offset:34816
 v_mfma_f32_16x16x32_bf16 v[180:183], a[160:163], a[12:15], v[180:183]
 s_waitcnt lgkmcnt(6)
 buffer_store_dwordx4 v[224:227], v250, s[56:59], s94 offen offset:0 sc1
 v_mfma_f32_16x16x32_bf16 v[188:191], a[164:167], a[12:15], v[188:191]
 s_add_u32 m0, s64, 32768
 ds_read_b64_tr_b16 a[148:149], v245 offset:32768
 ds_read_b64_tr_b16 a[150:151], v245 offset:34816
 v_mfma_f32_16x16x32_bf16 v[184:187], a[164:167], a[8:11], v[184:187]
 s_waitcnt lgkmcnt(6)
 v_cvt_pk_bf16_f32 v228, v152, v153
 v_cvt_pk_bf16_f32 v229, v154, v155
 v_mfma_f32_16x16x32_bf16 v[192:195], a[168:171], a[8:11], v[192:195]
 s_add_u32 s65, s87, 294912
 ds_read_b64_tr_b16 a[152:153], v244 offset:33280
 ds_read_b64_tr_b16 a[154:155], v244 offset:35328
 v_mfma_f32_16x16x32_bf16 v[196:199], a[168:171], a[12:15], v[196:199]
 s_waitcnt lgkmcnt(6)
 buffer_load_dwordx4 v249, s[36:39], s65 offen lds
 v_mfma_f32_16x16x32_bf16 v[204:207], a[172:175], a[12:15], v[204:207]
 ds_read_b64_tr_b16 a[156:157], v245 offset:33280
 ds_read_b64_tr_b16 a[158:159], v245 offset:35328
 v_mfma_f32_16x16x32_bf16 v[200:203], a[172:175], a[8:11], v[200:203]
 s_waitcnt lgkmcnt(6)
 v_cvt_pk_bf16_f32 v230, v156, v157
 v_cvt_pk_bf16_f32 v231, v158, v159
 v_mfma_f32_16x16x32_bf16 v[176:179], a[144:147], a[16:19], v[176:179]
 ds_read_b64_tr_b16 a[160:161], v244 offset:36864
 ds_read_b64_tr_b16 a[162:163], v244 offset:38912
 v_mfma_f32_16x16x32_bf16 v[180:183], a[144:147], a[20:23], v[180:183]
 s_waitcnt lgkmcnt(6)
 buffer_store_dwordx4 v[228:231], v250, s[56:59], s94 offen offset:1024 sc1
 v_mfma_f32_16x16x32_bf16 v[188:191], a[148:151], a[20:23], v[188:191]
 s_add_u32 m0, s64, 36864
 ds_read_b64_tr_b16 a[164:165], v245 offset:36864
 ds_read_b64_tr_b16 a[166:167], v245 offset:38912
 v_mfma_f32_16x16x32_bf16 v[184:187], a[148:151], a[16:19], v[184:187]
 s_waitcnt lgkmcnt(6)
 v_cvt_pk_bf16_f32 v232, v160, v161
 v_cvt_pk_bf16_f32 v233, v162, v163
 v_mfma_f32_16x16x32_bf16 v[192:195], a[152:155], a[16:19], v[192:195]
 s_add_u32 s65, s87, 331776
 ds_read_b64_tr_b16 a[168:169], v244 offset:37376
 ds_read_b64_tr_b16 a[170:171], v244 offset:39424
 v_mfma_f32_16x16x32_bf16 v[196:199], a[152:155], a[20:23], v[196:199]
 s_waitcnt lgkmcnt(6)
 buffer_load_dwordx4 v249, s[36:39], s65 offen lds
 v_mfma_f32_16x16x32_bf16 v[204:207], a[156:159], a[20:23], v[204:207]
 ds_read_b64_tr_b16 a[172:173], v245 offset:37376
 ds_read_b64_tr_b16 a[174:175], v245 offset:39424
 v_mfma_f32_16x16x32_bf16 v[200:203], a[156:159], a[16:19], v[200:203]
 s_waitcnt lgkmcnt(6)
 v_cvt_pk_bf16_f32 v234, v164, v165
 v_cvt_pk_bf16_f32 v235, v166, v167
 v_mfma_f32_16x16x32_bf16 v[176:179], a[160:163], a[24:27], v[176:179]
 ds_read_b64_tr_b16 a[144:145], v244 offset:40960
 ds_read_b64_tr_b16 a[146:147], v244 offset:43008
 v_mfma_f32_16x16x32_bf16 v[180:183], a[160:163], a[28:31], v[180:183]
 s_waitcnt lgkmcnt(6)
 buffer_store_dwordx4 v[232:235], v250, s[56:59], s94 offen offset:2048 sc1
 v_mfma_f32_16x16x32_bf16 v[188:191], a[164:167], a[28:31], v[188:191]
 s_add_u32 m0, s64, 40960
 ds_read_b64_tr_b16 a[148:149], v245 offset:40960
 ds_read_b64_tr_b16 a[150:151], v245 offset:43008
 v_mfma_f32_16x16x32_bf16 v[184:187], a[164:167], a[24:27], v[184:187]
 s_waitcnt lgkmcnt(6)
 v_cvt_pk_bf16_f32 v224, v168, v169
 v_cvt_pk_bf16_f32 v225, v170, v171
 v_mfma_f32_16x16x32_bf16 v[192:195], a[168:171], a[24:27], v[192:195]
 s_add_u32 s65, s87, 368640
 ds_read_b64_tr_b16 a[152:153], v244 offset:41472
 ds_read_b64_tr_b16 a[154:155], v244 offset:43520
 v_mfma_f32_16x16x32_bf16 v[196:199], a[168:171], a[28:31], v[196:199]
 s_waitcnt lgkmcnt(6)
 buffer_load_dwordx4 v249, s[36:39], s65 offen lds
 v_mfma_f32_16x16x32_bf16 v[204:207], a[172:175], a[28:31], v[204:207]
 ds_read_b64_tr_b16 a[156:157], v245 offset:41472
 ds_read_b64_tr_b16 a[158:159], v245 offset:43520
 v_mfma_f32_16x16x32_bf16 v[200:203], a[172:175], a[24:27], v[200:203]
 s_waitcnt lgkmcnt(6)
 v_cvt_pk_bf16_f32 v226, v172, v173
 v_cvt_pk_bf16_f32 v227, v174, v175
 v_mfma_f32_16x16x32_bf16 v[176:179], a[144:147], a[32:35], v[176:179]
 ds_read_b64_tr_b16 a[160:161], v244 offset:45056
 ds_read_b64_tr_b16 a[162:163], v244 offset:47104
 v_mfma_f32_16x16x32_bf16 v[180:183], a[144:147], a[36:39], v[180:183]
 s_waitcnt lgkmcnt(6)
 buffer_store_dwordx4 v[224:227], v250, s[56:59], s94 offen offset:3072 sc1
 v_mfma_f32_16x16x32_bf16 v[188:191], a[148:151], a[36:39], v[188:191]
 s_add_u32 m0, s64, 45056
 ds_read_b64_tr_b16 a[164:165], v245 offset:45056
 ds_read_b64_tr_b16 a[166:167], v245 offset:47104
 v_mfma_f32_16x16x32_bf16 v[184:187], a[148:151], a[32:35], v[184:187]
 s_waitcnt lgkmcnt(6)
 buffer_load_dwordx2 v[102:103], v98, s[56:59], 0 offen sc1
 v_mfma_f32_16x16x32_bf16 v[192:195], a[152:155], a[32:35], v[192:195]
 s_add_u32 s65, s87, 405504
 ds_read_b64_tr_b16 a[168:169], v244 offset:45568
 ds_read_b64_tr_b16 a[170:171], v244 offset:47616
 v_mfma_f32_16x16x32_bf16 v[196:199], a[152:155], a[36:39], v[196:199]
 s_waitcnt lgkmcnt(6)
 buffer_load_dwordx4 v249, s[36:39], s65 offen lds
 v_mfma_f32_16x16x32_bf16 v[204:207], a[156:159], a[36:39], v[204:207]
 s_waitcnt vmcnt(14)
 ds_read_b64_tr_b16 a[172:173], v245 offset:45568
 ds_read_b64_tr_b16 a[174:175], v245 offset:47616
 v_mfma_f32_16x16x32_bf16 v[200:203], a[156:159], a[32:35], v[200:203]
 s_waitcnt lgkmcnt(6)
 v_lshlrev_b32 v224, 16, v48
 v_and_b32 v225, s97, v48
 v_mfma_f32_16x16x32_bf16 v[176:179], a[160:163], a[40:43], v[176:179]
 s_barrier
 ds_read_b64_tr_b16 a[144:145], v246 offset:0
 ds_read_b64_tr_b16 a[146:147], v246 offset:2048
 v_mfma_f32_16x16x32_bf16 v[180:183], a[160:163], a[44:47], v[180:183]
 s_waitcnt lgkmcnt(6)
 v_add_f32 v16, v16, v224
 v_add_f32 v17, v17, v225
 v_mfma_f32_16x16x32_bf16 v[188:191], a[164:167], a[44:47], v[188:191]
 s_add_u32 m0, s64, 49152
 ds_read_b64_tr_b16 a[148:149], v247 offset:0
 ds_read_b64_tr_b16 a[150:151], v247 offset:2048
 v_mfma_f32_16x16x32_bf16 v[184:187], a[164:167], a[40:43], v[184:187]
 s_waitcnt lgkmcnt(6)
 v_lshlrev_b32 v226, 16, v49
 v_and_b32 v227, s97, v49
 v_mfma_f32_16x16x32_bf16 v[192:195], a[168:171], a[40:43], v[192:195]
 s_add_u32 s65, s87, 442368
 ds_read_b64_tr_b16 a[152:153], v246 offset:512
 ds_read_b64_tr_b16 a[154:155], v246 offset:2560
 v_mfma_f32_16x16x32_bf16 v[196:199], a[168:171], a[44:47], v[196:199]
 s_waitcnt lgkmcnt(6)
 buffer_load_dwordx4 v249, s[36:39], s65 offen lds
 v_mfma_f32_16x16x32_bf16 v[204:207], a[172:175], a[44:47], v[204:207]
 ds_read_b64_tr_b16 a[156:157], v247 offset:512
 ds_read_b64_tr_b16 a[158:159], v247 offset:2560
 v_mfma_f32_16x16x32_bf16 v[200:203], a[172:175], a[40:43], v[200:203]
 s_waitcnt lgkmcnt(6)
 v_add_f32 v18, v18, v226
 v_add_f32 v19, v19, v227
 v_mfma_f32_16x16x32_bf16 v[176:179], a[144:147], a[48:51], v[176:179]
 ds_read_b64_tr_b16 a[160:161], v246 offset:4096
 ds_read_b64_tr_b16 a[162:163], v246 offset:6144
 v_mfma_f32_16x16x32_bf16 v[180:183], a[144:147], a[52:55], v[180:183]
 s_waitcnt lgkmcnt(6)
 v_lshlrev_b32 v224, 16, v50
 v_and_b32 v225, s97, v50
 v_mfma_f32_16x16x32_bf16 v[188:191], a[148:151], a[52:55], v[188:191]
 s_add_u32 m0, s64, 53248
 ds_read_b64_tr_b16 a[164:165], v247 offset:4096
 ds_read_b64_tr_b16 a[166:167], v247 offset:6144
 v_mfma_f32_16x16x32_bf16 v[184:187], a[148:151], a[48:51], v[184:187]
 s_waitcnt lgkmcnt(6)
 v_add_f32 v20, v20, v224
 v_add_f32 v21, v21, v225
 v_mfma_f32_16x16x32_bf16 v[192:195], a[152:155], a[48:51], v[192:195]
 s_add_u32 s65, s87, 479232
 ds_read_b64_tr_b16 a[168:169], v246 offset:4608
 ds_read_b64_tr_b16 a[170:171], v246 offset:6656
 v_mfma_f32_16x16x32_bf16 v[196:199], a[152:155], a[52:55], v[196:199]
 s_waitcnt lgkmcnt(6)
 buffer_load_dwordx4 v249, s[36:39], s65 offen lds
 v_mfma_f32_16x16x32_bf16 v[204:207], a[156:159], a[52:55], v[204:207]
 ds_read_b64_tr_b16 a[172:173], v247 offset:4608
 ds_read_b64_tr_b16 a[174:175], v247 offset:6656
 v_mfma_f32_16x16x32_bf16 v[200:203], a[156:159], a[48:51], v[200:203]
 s_waitcnt lgkmcnt(6)
 v_lshlrev_b32 v226, 16, v51
 v_and_b32 v227, s97, v51
 v_mfma_f32_16x16x32_bf16 v[176:179], a[160:163], a[56:59], v[176:179]
 ds_read_b64_tr_b16 a[144:145], v246 offset:8192
 ds_read_b64_tr_b16 a[146:147], v246 offset:10240
 v_mfma_f32_16x16x32_bf16 v[180:183], a[160:163], a[60:63], v[180:183]
 s_waitcnt lgkmcnt(6)
 v_add_f32 v22, v22, v226
 v_add_f32 v23, v23, v227
 v_mfma_f32_16x16x32_bf16 v[188:191], a[164:167], a[60:63], v[188:191]
 s_add_u32 m0, s64, 57344
 ds_read_b64_tr_b16 a[148:149], v247 offset:8192
 ds_read_b64_tr_b16 a[150:151], v247 offset:10240
 v_mfma_f32_16x16x32_bf16 v[184:187], a[164:167], a[56:59], v[184:187]
 s_waitcnt lgkmcnt(6)
 v_lshlrev_b32 v224, 16, v52
 v_and_b32 v225, s97, v52
 v_mfma_f32_16x16x32_bf16 v[192:195], a[168:171], a[56:59], v[192:195]
 s_add_u32 s65, s87, 516096
 ds_read_b64_tr_b16 a[152:153], v246 offset:8704
 ds_read_b64_tr_b16 a[154:155], v246 offset:10752
 v_mfma_f32_16x16x32_bf16 v[196:199], a[168:171], a[60:63], v[196:199]
 s_waitcnt lgkmcnt(6)
 buffer_load_dwordx4 v249, s[36:39], s65 offen lds
 v_mfma_f32_16x16x32_bf16 v[204:207], a[172:175], a[60:63], v[204:207]
 ds_read_b64_tr_b16 a[156:157], v247 offset:8704
 ds_read_b64_tr_b16 a[158:159], v247 offset:10752
 v_mfma_f32_16x16x32_bf16 v[200:203], a[172:175], a[56:59], v[200:203]
 s_waitcnt lgkmcnt(6)
 v_add_f32 v24, v24, v224
 v_add_f32 v25, v25, v225
 v_mfma_f32_16x16x32_bf16 v[176:179], a[144:147], a[64:67], v[176:179]
 ds_read_b64_tr_b16 a[160:161], v246 offset:12288
 ds_read_b64_tr_b16 a[162:163], v246 offset:14336
 v_mfma_f32_16x16x32_bf16 v[180:183], a[144:147], a[68:71], v[180:183]
 s_waitcnt lgkmcnt(6)
 v_lshlrev_b32 v226, 16, v53
 v_and_b32 v227, s97, v53
 v_mfma_f32_16x16x32_bf16 v[188:191], a[148:151], a[68:71], v[188:191]
 s_add_u32 m0, s64, 61440
 ds_read_b64_tr_b16 a[164:165], v247 offset:12288
 ds_read_b64_tr_b16 a[166:167], v247 offset:14336
 v_mfma_f32_16x16x32_bf16 v[184:187], a[148:151], a[64:67], v[184:187]
 s_waitcnt lgkmcnt(6)
 v_add_f32 v26, v26, v226
 v_add_f32 v27, v27, v227
 v_mfma_f32_16x16x32_bf16 v[192:195], a[152:155], a[64:67], v[192:195]
 s_add_u32 s65, s87, 552960
 ds_read_b64_tr_b16 a[168:169], v246 offset:12800
 ds_read_b64_tr_b16 a[170:171], v246 offset:14848
 v_mfma_f32_16x16x32_bf16 v[196:199], a[152:155], a[68:71], v[196:199]
 s_waitcnt lgkmcnt(6)
 buffer_load_dwordx4 v249, s[36:39], s65 offen lds
 v_mfma_f32_16x16x32_bf16 v[204:207], a[156:159], a[68:71], v[204:207]
 ds_read_b64_tr_b16 a[172:173], v247 offset:12800
 ds_read_b64_tr_b16 a[174:175], v247 offset:14848
 v_mfma_f32_16x16x32_bf16 v[200:203], a[156:159], a[64:67], v[200:203]
 s_waitcnt lgkmcnt(6)
 v_lshlrev_b32 v224, 16, v54
 v_and_b32 v225, s97, v54
 v_mfma_f32_16x16x32_bf16 v[176:179], a[160:163], a[72:75], v[176:179]
 ds_read_b64_tr_b16 a[144:145], v246 offset:16384
 ds_read_b64_tr_b16 a[146:147], v246 offset:18432
 v_mfma_f32_16x16x32_bf16 v[180:183], a[160:163], a[76:79], v[180:183]
 s_waitcnt lgkmcnt(6)
 v_add_f32 v28, v28, v224
 v_add_f32 v29, v29, v225
 v_mfma_f32_16x16x32_bf16 v[188:191], a[164:167], a[76:79], v[188:191]
 s_add_u32 m0, s64, 65536
 ds_read_b64_tr_b16 a[148:149], v247 offset:16384
 ds_read_b64_tr_b16 a[150:151], v247 offset:18432
 v_mfma_f32_16x16x32_bf16 v[184:187], a[164:167], a[72:75], v[184:187]
 s_waitcnt lgkmcnt(6)
 v_lshlrev_b32 v226, 16, v55
 v_and_b32 v227, s97, v55
 v_mfma_f32_16x16x32_bf16 v[192:195], a[168:171], a[72:75], v[192:195]
 s_add_u32 s65, s87, 589824
 ds_read_b64_tr_b16 a[152:153], v246 offset:16896
 ds_read_b64_tr_b16 a[154:155], v246 offset:18944
 v_mfma_f32_16x16x32_bf16 v[196:199], a[168:171], a[76:79], v[196:199]
 s_waitcnt lgkmcnt(6)
 buffer_load_dwordx4 v249, s[36:39], s65 offen lds
 v_mfma_f32_16x16x32_bf16 v[204:207], a[172:175], a[76:79], v[204:207]
 ds_read_b64_tr_b16 a[156:157], v247 offset:16896
 ds_read_b64_tr_b16 a[158:159], v247 offset:18944
 v_mfma_f32_16x16x32_bf16 v[200:203], a[172:175], a[72:75], v[200:203]
 s_waitcnt lgkmcnt(6)
 v_add_f32 v30, v30, v226
 v_add_f32 v31, v31, v227
 v_mfma_f32_16x16x32_bf16 v[176:179], a[144:147], a[80:83], v[176:179]
 ds_read_b64_tr_b16 a[160:161], v246 offset:20480
 ds_read_b64_tr_b16 a[162:163], v246 offset:22528
 v_mfma_f32_16x16x32_bf16 v[180:183], a[144:147], a[84:87], v[180:183]
 s_waitcnt lgkmcnt(6)
 v_lshlrev_b32 v224, 16, v56
 v_and_b32 v225, s97, v56
 v_mfma_f32_16x16x32_bf16 v[188:191], a[148:151], a[84:87], v[188:191]
 s_add_u32 m0, s64, 69632
 ds_read_b64_tr_b16 a[164:165], v247 offset:20480
 ds_read_b64_tr_b16 a[166:167], v247 offset:22528
 v_mfma_f32_16x16x32_bf16 v[184:187], a[148:151], a[80:83], v[184:187]
 s_waitcnt lgkmcnt(6)
 v_add_f32 v32, v32, v224
 v_add_f32 v33, v33, v225
 v_mfma_f32_16x16x32_bf16 v[192:195], a[152:155], a[80:83], v[192:195]
 s_add_u32 s65, s87, 626688
 ds_read_b64_tr_b16 a[168:169], v246 offset:20992
 ds_read_b64_tr_b16 a[170:171], v246 offset:23040
 v_mfma_f32_16x16x32_bf16 v[196:199], a[152:155], a[84:87], v[196:199]
 s_waitcnt lgkmcnt(6)
 buffer_load_dwordx4 v249, s[36:39], s65 offen lds
 v_mfma_f32_16x16x32_bf16 v[204:207], a[156:159], a[84:87], v[204:207]
 s_sub_u32 s67, s61, 4
 ds_read_b64_tr_b16 a[172:173], v247 offset:20992
 ds_read_b64_tr_b16 a[174:175], v247 offset:23040
 v_mfma_f32_16x16x32_bf16 v[200:203], a[156:159], a[80:83], v[200:203]
 s_waitcnt lgkmcnt(6)
 s_and_b32 s67, s67, 7
 s_lshl_b32 s68, s67, 3
 v_mfma_f32_16x16x32_bf16 v[176:179], a[160:163], a[88:91], v[176:179]
 s_mul_i32 s67, s67, 147456
 s_barrier
 ds_read_b64_tr_b16 a[144:145], v246 offset:24576
 ds_read_b64_tr_b16 a[146:147], v246 offset:26624
 v_mfma_f32_16x16x32_bf16 v[180:183], a[160:163], a[92:95], v[180:183]
 s_waitcnt lgkmcnt(6)
 s_add_u32 s67, s67, s73
 v_mfma_f32_16x16x32_bf16 v[188:191], a[164:167], a[92:95], v[188:191]
 s_add_u32 m0, s64, 73728
 ds_read_b64_tr_b16 a[148:149], v247 offset:24576
 ds_read_b64_tr_b16 a[150:151], v247 offset:26624
 v_mfma_f32_16x16x32_bf16 v[184:187], a[164:167], a[88:91], v[184:187]
 s_waitcnt lgkmcnt(6)
 v_mfma_f32_16x16x32_bf16 v[192:195], a[168:171], a[88:91], v[192:195]
 s_add_u32 s65, s88, 0
 ds_read_b64_tr_b16 a[152:153], v246 offset:25088
 ds_read_b64_tr_b16 a[154:155], v246 offset:27136
 v_mfma_f32_16x16x32_bf16 v[196:199], a[168:171], a[92:95], v[196:199]
 s_waitcnt lgkmcnt(6)
 buffer_load_dwordx4 v249, s[36:39], s65 offen lds
 v_mfma_f32_16x16x32_bf16 v[204:207], a[172:175], a[92:95], v[204:207]
 s_waitcnt vmcnt(8)
 ds_read_b64_tr_b16 a[156:157], v247 offset:25088
 ds_read_b64_tr_b16 a[158:159], v247 offset:27136
 v_mfma_f32_16x16x32_bf16 v[200:203], a[172:175], a[88:91], v[200:203]
 s_waitcnt lgkmcnt(6)
 s_lshl2_add_u32 s69, s85, s3
 v_mfma_f32_16x16x32_bf16 v[176:179], a[144:147], a[96:99], v[176:179]
 ds_read_b64_tr_b16 a[160:161], v246 offset:28672
 ds_read_b64_tr_b16 a[162:163], v246 offset:30720
 v_mfma_f32_16x16x32_bf16 v[180:183], a[144:147], a[100:103], v[180:183]
 s_waitcnt lgkmcnt(6)
 buffer_store_byte v252, v101, s[56:59], s69 offen sc1
 v_mfma_f32_16x16x32_bf16 v[188:191], a[148:151], a[100:103], v[188:191]
 s_add_u32 m0, s64, 77824
 ds_read_b64_tr_b16 a[164:165], v247 offset:28672
 ds_read_b64_tr_b16 a[166:167], v247 offset:30720
 v_mfma_f32_16x16x32_bf16 v[184:187], a[148:151], a[96:99], v[184:187]
 s_waitcnt lgkmcnt(6)
 v_readfirstlane_b32 s26, v102
 v_readfirstlane_b32 s27, v103
 v_mfma_f32_16x16x32_bf16 v[192:195], a[152:155], a[96:99], v[192:195]
 s_add_u32 s65, s88, 36864
 ds_read_b64_tr_b16 a[168:169], v246 offset:29184
 ds_read_b64_tr_b16 a[170:171], v246 offset:31232
 v_mfma_f32_16x16x32_bf16 v[196:199], a[152:155], a[100:103], v[196:199]
 s_waitcnt lgkmcnt(6)
 buffer_load_dwordx4 v249, s[36:39], s65 offen lds
 v_mfma_f32_16x16x32_bf16 v[204:207], a[156:159], a[100:103], v[204:207]
 ds_read_b64_tr_b16 a[172:173], v247 offset:29184
 ds_read_b64_tr_b16 a[174:175], v247 offset:31232
 v_mfma_f32_16x16x32_bf16 v[200:203], a[156:159], a[96:99], v[200:203]
 s_waitcnt lgkmcnt(6)
 s_lshr_b64 s[26:27], s[26:27], s68
 s_and_b32 s26, s26, 0xff
 s_cbranch_scc0 L_chk3
L_chk3_ok:
 v_mfma_f32_16x16x32_bf16 v[176:179], a[160:163], a[104:107], v[176:179]
 ds_read_b64_tr_b16 a[144:145], v246 offset:32768
 ds_read_b64_tr_b16 a[146:147], v246 offset:34816
 v_mfma_f32_16x16x32_bf16 v[180:183], a[160:163], a[108:111], v[180:183]
 s_waitcnt lgkmcnt(6)
 buffer_load_dwordx4 v[64:67], v250, s[56:59], s67 offen offset:0 sc1
 v_mfma_f32_16x16x32_bf16 v[188:191], a[164:167], a[108:111], v[188:191]
 s_add_u32 m0, s64, 81920
 ds_read_b64_tr_b16 a[148:149], v247 offset:32768
 ds_read_b64_tr_b16 a[150:151], v247 offset:34816
 v_mfma_f32_16x16x32_bf16 v[184:187], a[164:167], a[104:107], v[184:187]
 s_waitcnt lgkmcnt(6)
 buffer_load_dwordx4 v[68:71], v250, s[56:59], s67 offen offset:1024 sc1
 v_mfma_f32_16x16x32_bf16 v[192:195], a[168:171], a[104:107], v[192:195]
 s_add_u32 s65, s88, 73728
 ds_read_b64_tr_b16 a[152:153], v246 offset:33280
 ds_read_b64_tr_b16 a[154:155], v246 offset:35328
 v_mfma_f32_16x16x32_bf16 v[196:199], a[168:171], a[108:111], v[196:199]
 s_waitcnt lgkmcnt(6)
 buffer_load_dwordx4 v249, s[36:39], s65 offen lds
 v_mfma_f32_16x16x32_bf16 v[204:207], a[172:175], a[108:111], v[204:207]
 ds_read_b64_tr_b16 a[156:157], v247 offset:33280
 ds_read_b64_tr_b16 a[158:159], v247 offset:35328
 v_mfma_f32_16x16x32_bf16 v[200:203], a[172:175], a[104:107], v[200:203]
 s_waitcnt lgkmcnt(6)
 buffer_load_dwordx4 v[72:75], v250, s[56:59], s67 offen offset:2048 sc1
 v_mfma_f32_16x16x32_bf16 v[176:179], a[144:147], v[208:211], v[176:179]
 ds_read_b64_tr_b16 a[160:161], v246 offset:36864
 ds_read_b64_tr_b16 a[162:163], v246 offset:38912
 v_mfma_f32_16x16x32_bf16 v[180:183], a[144:147], v[212:215], v[180:183]
 s_waitcnt lgkmcnt(6)
 buffer_load_dwordx4 v[76:79], v250, s[56:59], s67 offen offset:3072 sc1
 v_mfma_f32_16x16x32_bf16 v[188:191], a[148:151], v[212:215], v[188:191]
 s_add_u32 m0, s64, 86016
 ds_read_b64_tr_b16 a[164:165], v247 offset:36864
 ds_read_b64_tr_b16 a[166:167], v247 offset:38912
 v_mfma_f32_16x16x32_bf16 v[184:187], a[148:151], v[208:211], v[184:187]
 s_waitcnt lgkmcnt(6)
 v_lshlrev_b32 v226, 16, v57
 v_and_b32 v227, s97, v57
 v_mfma_f32_16x16x32_bf16 v[192:195], a[152:155], v[208:211], v[192:195]
 s_add_u32 s65, s88, 110592
 ds_read_b64_tr_b16 a[168:169], v246 offset:37376
 ds_read_b64_tr_b16 a[170:171], v246 offset:39424
 v_mfma_f32_16x16x32_bf16 v[196:199], a[152:155], v[212:215], v[196:199]
 s_waitcnt lgkmcnt(6)
 buffer_load_dwordx4 v249, s[36:39], s65 offen lds
 v_mfma_f32_16x16x32_bf16 v[204:207], a[156:159], v[212:215], v[204:207]
 ds_read_b64_tr_b16 a[172:173], v247 offset:37376
 ds_read_b64_tr_b16 a[174:175], v247 offset:39424
 v_mfma_f32_16x16x32_bf16 v[200:203], a[156:159], v[208:211], v[200:203]
 s_waitcnt lgkmcnt(6)
 v_add_f32 v34, v34, v226
 v_add_f32 v35, v35, v227
 v_mfma_f32_16x16x32_bf16 v[176:179], a[160:163], v[216:219], v[176:179]
 ds_read_b64_tr_b16 a[144:145], v246 offset:40960
 ds_read_b64_tr_b16 a[146:147], v246 offset:43008
 v_mfma_f32_16x16x32_bf16 v[180:183], a[160:163], v[220:223], v[180:183]
 s_waitcnt lgkmcnt(6)
 v_lshlrev_b32 v224, 16, v58
 v_and_b32 v225, s97, v58
 v_mfma_f32_16x16x32_bf16 v[188:191], a[164:167], v[220:223], v[188:191]
 s_add_u32 m0, s64, 90112
 ds_read_b64_tr_b16 a[148:149], v247 offset:40960
 ds_read_b64_tr_b16 a[150:151], v247 offset:43008
 v_mfma_f32_16x16x32_bf16 v[184:187], a[164:167], v[216:219], v[184:187]
 s_waitcnt lgkmcnt(6)
 v_add_f32 v36, v36, v224
 v_add_f32 v37, v37, v225
 v_mfma_f32_16x16x32_bf16 v[192:195], a[168:171], v[216:219], v[192:195]
 s_add_u32 s65, s88, 147456
 ds_read_b64_tr_b16 a[152:153], v246 offset:41472
 ds_read_b64_tr_b16 a[154:155], v246 offset:43520
 v_mfma_f32_16x16x32_bf16 v[196:199], a[168:171], v[220:223], v[196:199]
 s_waitcnt lgkmcnt(6)
 buffer_load_dwordx4 v249, s[36:39], s65 offen lds
 v_mfma_f32_16x16x32_bf16 v[204:207], a[172:175], v[220:223], v[204:207]
 ds_read_b64_tr_b16 a[156:157], v247 offset:41472
 ds_read_b64_tr_b16 a[158:159], v247 offset:43520
 v_mfma_f32_16x16x32_bf16 v[200:203], a[172:175], v[216:219], v[200:203]
 s_waitcnt lgkmcnt(6)
 v_lshlrev_b32 v226, 16, v59
 v_and_b32 v227, s97, v59
 v_mfma_f32_16x16x32_bf16 v[176:179], a[144:147], v[0:3], v[176:179]
 ds_read_b64_tr_b16 a[160:161], v246 offset:45056
 ds_read_b64_tr_b16 a[162:163], v246 offset:47104
 v_mfma_f32_16x16x32_bf16 v[180:183], a[144:147], v[4:7], v[180:183]
 s_waitcnt lgkmcnt(6)
 v_add_f32 v38, v38, v226
 v_add_f32 v39, v39, v227
 v_mfma_f32_16x16x32_bf16 v[188:191], a[148:151], v[4:7], v[188:191]
 s_add_u32 m0, s64, 94208
 ds_read_b64_tr_b16 a[164:165], v247 offset:45056
 ds_read_b64_tr_b16 a[166:167], v247 offset:47104
 v_mfma_f32_16x16x32_bf16 v[184:187], a[148:151], v[0:3], v[184:187]
 s_waitcnt lgkmcnt(6)
 v_lshlrev_b32 v224, 16, v60
 v_and_b32 v225, s97, v60
 v_mfma_f32_16x16x32_bf16 v[192:195], a[152:155], v[0:3], v[192:195]
 s_add_u32 s65, s88, 184320
 ds_read_b64_tr_b16 a[168:169], v246 offset:45568
 ds_read_b64_tr_b16 a[170:171], v246 offset:47616
 v_mfma_f32_16x16x32_bf16 v[196:199], a[152:155], v[4:7], v[196:199]
 s_waitcnt lgkmcnt(6)
 buffer_load_dwordx4 v249, s[36:39], s65 offen lds
 v_mfma_f32_16x16x32_bf16 v[204:207], a[156:159], v[4:7], v[204:207]
 ds_read_b64_tr_b16 a[172:173], v247 offset:45568
 ds_read_b64_tr_b16 a[174:175], v247 offset:47616
 v_mfma_f32_16x16x32_bf16 v[200:203], a[156:159], v[0:3], v[200:203]
 s_waitcnt lgkmcnt(6)
 v_add_f32 v40, v40, v224
 v_add_f32 v41, v41, v225
 v_mfma_f32_16x16x32_bf16 v[176:179], a[160:163], v[8:11], v[176:179]
 s_barrier
 ds_read_b64_tr_b16 a[144:145], v242 offset:0
 ds_read_b64_tr_b16 a[146:147], v242 offset:2048
 v_mfma_f32_16x16x32_bf16 v[180:183], a[160:163], v[12:15], v[180:183]
 s_waitcnt lgkmcnt(6)
 v_lshlrev_b32 v226, 16, v61
 v_and_b32 v227, s97, v61
 v_mfma_f32_16x16x32_bf16 v[188:191], a[164:167], v[12:15], v[188:191]
 s_add_u32 m0, s64, 98304
 ds_read_b64_tr_b16 a[148:149], v243 offset:0
 ds_read_b64_tr_b16 a[150:151], v243 offset:2048
 v_mfma_f32_16x16x32_bf16 v[184:187], a[164:167], v[8:11], v[184:187]
 s_waitcnt lgkmcnt(6)
 v_add_f32 v42, v42, v226
 v_add_f32 v43, v43, v227
 v_mfma_f32_16x16x32_bf16 v[192:195], a[168:171], v[8:11], v[192:195]
 s_add_u32 s65, s88, 221184
 ds_read_b64_tr_b16 a[152:153], v242 offset:512
 ds_read_b64_tr_b16 a[154:155], v242 offset:2560
 v_mfma_f32_16x16x32_bf16 v[196:199], a[168:171], v[12:15], v[196:199]
 s_waitcnt lgkmcnt(6)
 buffer_load_dwordx4 v249, s[36:39], s65 offen lds
 v_mfma_f32_16x16x32_bf16 v[204:207], a[172:175], v[12:15], v[204:207]
 ds_read_b64_tr_b16 a[156:157], v243 offset:512
 ds_read_b64_tr_b16 a[158:159], v243 offset:2560
 v_mfma_f32_16x16x32_bf16 v[200:203], a[172:175], v[8:11], v[200:203]
 s_waitcnt lgkmcnt(6)
 v_lshlrev_b32 v224, 16, v62
 v_and_b32 v225, s97, v62
 v_add_f32 v44, v44, v224
 v_add_f32 v45, v45, v225
 v_lshlrev_b32 v226, 16, v63
 v_and_b32 v227, s97, v63
 v_add_f32 v46, v46, v226
 v_add_f32 v47, v47, v227
 v_mfma_f32_16x16x32_bf16 v[144:147], a[144:147], a[0:3], 0
 ds_read_b64_tr_b16 a[160:161], v242 offset:4096
 ds_read_b64_tr_b16 a[162:163], v242 offset:6144
 v_mfma_f32_16x16x32_bf16 v[148:151], a[144:147], a[4:7], 0
 s_waitcnt lgkmcnt(6)
 v_mfma_f32_16x16x32_bf16 v[156:159], a[148:151], a[4:7], 0
 s_add_u32 m0, s64, 102400
 ds_read_b64_tr_b16 a[164:165], v243 offset:4096
 ds_read_b64_tr_b16 a[166:167], v243 offset:6144
 v_mfma_f32_16x16x32_bf16 v[152:155], a[148:151], a[0:3], 0
 s_waitcnt lgkmcnt(6)
 v_cvt_pk_bf16_f32 v224, v176, v177
 v_cvt_pk_bf16_f32 v225, v178, v179
 v_mfma_f32_16x16x32_bf16 v[160:163], a[152:155], a[0:3], 0
 s_add_u32 s65, s88, 258048
 ds_read_b64_tr_b16 a[168:169], v242 offset:4608
 ds_read_b64_tr_b16 a[170:171], v242 offset:6656
 v_mfma_f32_16x16x32_bf16 v[164:167], a[152:155], a[4:7], 0
 s_waitcnt lgkmcnt(6)
 buffer_load_dwordx4 v249, s[36:39], s65 offen lds
 v_mfma_f32_16x16x32_bf16 v[172:175], a[156:159], a[4:7], 0
 ds_read_b64_tr_b16 a[172:173], v243 offset:4608
 ds_read_b64_tr_b16 a[174:175], v243 offset:6656
 v_mfma_f32_16x16x32_bf16 v[168:171], a[156:159], a[0:3], 0
 s_waitcnt lgkmcnt(6)
 v_cvt_pk_bf16_f32 v226, v180, v181
 v_cvt_pk_bf16_f32 v227, v182, v183
 v_mfma_f32_16x16x32_bf16 v[144:147], a[160:163], a[8:11], v[144:147]
 ds_read_b64_tr_b16 a[144:145], v242 offset:8192
 ds_read_b64_tr_b16 a[146:147], v242 offset:10240
 v_mfma_f32_16x16x32_bf16 v[148:151], a[160:163], a[12:15], v[148:151]
 s_waitcnt lgkmcnt(6)
 buffer_store_dwordx4 v[224:227], v250, s[56:59], s95 offen offset:0 sc1
 v_mfma_f32_16x16x32_bf16 v[156:159], a[164:167], a[12:15], v[156:159]
 s_add_u32 m0, s64, 106496
 ds_read_b64_tr_b16 a[148:149], v243 offset:8192
 ds_read_b64_tr_b16 a[150:151], v243 offset:10240
 v_mfma_f32_16x16x32_bf16 v[152:155], a[164:167], a[8:11], v[152:155]
 s_waitcnt lgkmcnt(6)
 v_cvt_pk_bf16_f32 v228, v184, v185
 v_cvt_pk_bf16_f32 v229, v186, v187
 v_mfma_f32_16x16x32_bf16 v[160:163], a[168:171], a[8:11], v[160:163]
 s_add_u32 s65, s88, 294912
 ds_read_b64_tr_b16 a[152:153], v242 offset:8704
 ds_read_b64_tr_b16 a[154:155], v242 offset:10752
 v_mfma_f32_16x16x32_bf16 v[164:167], a[168:171], a[12:15], v[164:167]
 s_waitcnt lgkmcnt(6)
 buffer_load_dwordx4 v249, s[36:39], s65 offen lds
 v_mfma_f32_16x16x32_bf16 v[172:175], a[172:175], a[12:15], v[172:175]
 ds_read_b64_tr_b16 a[156:157], v243 offset:8704
 ds_read_b64_tr_b16 a[158:159], v243 offset:10752
 v_mfma_f32_16x16x32_bf16 v[168:171], a[172:175], a[8:11], v[168:171]
 s_waitcnt lgkmcnt(6)
 v_cvt_pk_bf16_f32 v230, v188, v189
 v_cvt_pk_bf16_f32 v231, v190, v191
 v_mfma_f32_16x16x32_bf16 v[144:147], a[144:147], a[16:19], v[144:147]
 ds_read_b64_tr_b16 a[160:161], v242 offset:12288
 ds_read_b64_tr_b16 a[162:163], v242 offset:14336
 v_mfma_f32_16x16x32_bf16 v[148:151], a[144:147], a[20:23], v[148:151]
 s_waitcnt lgkmcnt(6)
 buffer_store_dwordx4 v[228:231], v250, s[56:59], s95 offen offset:1024 sc1
 v_mfma_f32_16x16x32_bf16 v[156:159], a[148:151], a[20:23], v[156:159]
 s_add_u32 m0, s64, 110592
 ds_read_b64_tr_b16 a[164:165], v243 offset:12288
 ds_read_b64_tr_b16 a[166:167], v243 offset:14336
 v_mfma_f32_16x16x32_bf16 v[152:155], a[148:151], a[16:19], v[152:155]
 s_waitcnt lgkmcnt(6)
 v_cvt_pk_bf16_f32 v232, v192, v193
 v_cvt_pk_bf16_f32 v233, v194, v195
 v_mfma_f32_16x16x32_bf16 v[160:163], a[152:155], a[16:19], v[160:163]
 s_add_u32 s65, s88, 331776
 ds_read_b64_tr_b16 a[168:169], v242 offset:12800
 ds_read_b64_tr_b16 a[170:171], v242 offset:14848
 v_mfma_f32_16x16x32_bf16 v[164:167], a[152:155], a[20:23], v[164:167]
 s_waitcnt lgkmcnt(6)
 buffer_load_dwordx4 v249, s[36:39], s65 offen lds
 v_mfma_f32_16x16x32_bf16 v[172:175], a[156:159], a[20:23], v[172:175]
 ds_read_b64_tr_b16 a[172:173], v243 offset:12800
 ds_read_b64_tr_b16 a[174:175], v243 offset:14848
 v_mfma_f32_16x16x32_bf16 v[168:171], a[156:159], a[16:19], v[168:171]
 s_waitcnt lgkmcnt(6)
 v_cvt_pk_bf16_f32 v234, v196, v197
 v_cvt_pk_bf16_f32 v235, v198, v199
 v_mfma_f32_16x16x32_bf16 v[144:147], a[160:163], a[24:27], v[144:147]
 ds_read_b64_tr_b16 a[144:145], v242 offset:16384
 ds_read_b64_tr_b16 a[146:147], v242 offset:18432
 v_mfma_f32_16x16x32_bf16 v[148:151], a[160:163], a[28:31], v[148:151]
 s_waitcnt lgkmcnt(6)
 buffer_store_dwordx4 v[232:235], v250, s[56:59], s95 offen offset:2048 sc1
 v_mfma_f32_16x16x32_bf16 v[156:159], a[164:167], a[28:31], v[156:159]
 s_add_u32 m0, s64, 114688
 ds_read_b64_tr_b16 a[148:149], v243 offset:16384
 ds_read_b64_tr_b16 a[150:151], v243 offset:18432
 v_mfma_f32_16x16x32_bf16 v[152:155], a[164:167], a[24:27], v[152:155]
 s_waitcnt lgkmcnt(6)
 v_cvt_pk_bf16_f32 v224, v200, v201
 v_cvt_pk_bf16_f32 v225, v202, v203
 v_mfma_f32_16x16x32_bf16 v[160:163], a[168:171], a[24:27], v[160:163]
 s_add_u32 s65, s88, 368640
 ds_read_b64_tr_b16 a[152:153], v242 offset:16896
 ds_read_b64_tr_b16 a[154:155], v242 offset:18944
 v_mfma_f32_16x16x32_bf16 v[164:167], a[168:171], a[28:31], v[164:167]
 s_waitcnt lgkmcnt(6)
 buffer_load_dwordx4 v249, s[36:39], s65 offen lds
 v_mfma_f32_16x16x32_bf16 v[172:175], a[172:175], a[28:31], v[172:175]
 ds_read_b64_tr_b16 a[156:157], v243 offset:16896
 ds_read_b64_tr_b16 a[158:159], v243 offset:18944
 v_mfma_f32_16x16x32_bf16 v[168:171], a[172:175], a[24:27], v[168:171]
 s_waitcnt lgkmcnt(6)
 v_cvt_pk_bf16_f32 v226, v204, v205
 v_cvt_pk_bf16_f32 v227, v206, v207
 v_mfma_f32_16x16x32_bf16 v[144:147], a[144:147], a[32:35], v[144:147]
 ds_read_b64_tr_b16 a[160:161], v242 offset:20480
 ds_read_b64_tr_b16 a[162:163], v242 offset:22528
 v_mfma_f32_16x16x32_bf16 v[148:151], a[144:147], a[36:39], v[148:151]
 s_waitcnt lgkmcnt(6)
 buffer_store_dwordx4 v[224:227], v250, s[56:59], s95 offen offset:3072 sc1
 v_mfma_f32_16x16x32_bf16 v[156:159], a[148:151], a[36:39], v[156:159]
 s_add_u32 m0, s64, 118784
 ds_read_b64_tr_b16 a[164:165], v243 offset:20480
 ds_read_b64_tr_b16 a[166:167], v243 offset:22528
 v_mfma_f32_16x16x32_bf16 v[152:155], a[148:151], a[32:35], v[152:155]
 s_waitcnt lgkmcnt(6)
 buffer_load_dwordx2 v[102:103], v98, s[56:59], 0 offen sc1
 v_mfma_f32_16x16x32_bf16 v[160:163], a[152:155], a[32:35], v[160:163]
 s_add_u32 s65, s88, 405504
 ds_read_b64_tr_b16 a[168:169], v242 offset:20992
 ds_read_b64_tr_b16 a[170:171], v242 offset:23040
 v_mfma_f32_16x16x32_bf16 v[164:167], a[152:155], a[36:39], v[164:167]
 s_waitcnt lgkmcnt(6)
 buffer_load_dwordx4 v249, s[36:39], s65 offen lds
 v_mfma_f32_16x16x32_bf16 v[172:175], a[156:159], a[36:39], v[172:175]
 s_waitcnt vmcnt(14)
 ds_read_b64_tr_b16 a[172:173], v243 offset:20992
 ds_read_b64_tr_b16 a[174:175], v243 offset:23040
 v_mfma_f32_16x16x32_bf16 v[168:171], a[156:159], a[32:35], v[168:171]
 s_waitcnt lgkmcnt(6)
 v_lshlrev_b32 v224, 16, v64
 v_and_b32 v225, s97, v64
 v_mfma_f32_16x16x32_bf16 v[144:147], a[160:163], a[40:43], v[144:147]
 s_barrier
 ds_read_b64_tr_b16 a[144:145], v242 offset:24576
 ds_read_b64_tr_b16 a[146:147], v242 offset:26624
 v_mfma_f32_16x16x32_bf16 v[148:151], a[160:163], a[44:47], v[148:151]
 s_waitcnt lgkmcnt(6)
 v_add_f32 v16, v16, v224
 v_add_f32 v17, v17, v225
 v_mfma_f32_16x16x32_bf16 v[156:159], a[164:167], a[44:47], v[156:159]
 s_add_u32 m0, s64, 122880
 ds_read_b64_tr_b16 a[148:149], v243 offset:24576
 ds_read_b64_tr_b16 a[150:151], v243 offset:26624
 v_mfma_f32_16x16x32_bf16 v[152:155], a[164:167], a[40:43], v[152:155]
 s_waitcnt lgkmcnt(6)
 v_lshlrev_b32 v226, 16, v65
 v_and_b32 v227, s97, v65
 v_mfma_f32_16x16x32_bf16 v[160:163], a[168:171], a[40:43], v[160:163]
 s_add_u32 s65, s88, 442368
 ds_read_b64_tr_b16 a[152:153], v242 offset:25088
 ds_read_b64_tr_b16 a[154:155], v242 offset:27136
 v_mfma_f32_16x16x32_bf16 v[164:167], a[168:171], a[44:47], v[164:167]
 s_waitcnt lgkmcnt(6)
 buffer_load_dwordx4 v249, s[36:39], s65 offen lds
 v_mfma_f32_16x16x32_bf16 v[172:175], a[172:175], a[44:47], v[172:175]
 ds_read_b64_tr_b16 a[156:157], v243 offset:25088
 ds_read_b64_tr_b16 a[158:159], v243 offset:27136
 v_mfma_f32_16x16x32_bf16 v[168:171], a[172:175], a[40:43], v[168:171]
 s_waitcnt lgkmcnt(6)
 v_add_f32 v18, v18, v226
 v_add_f32 v19, v19, v227
 v_mfma_f32_16x16x32_bf16 v[144:147], a[144:147], a[48:51], v[144:147]
 ds_read_b64_tr_b16 a[160:161], v242 offset:28672
 ds_read_b64_tr_b16 a[162:163], v242 offset:30720
 v_mfma_f32_16x16x32_bf16 v[148:151], a[144:147], a[52:55], v[148:151]
 s_waitcnt lgkmcnt(6)
 v_lshlrev_b32 v224, 16, v66
 v_and_b32 v225, s97, v66
 v_mfma_f32_16x16x32_bf16 v[156:159], a[148:151], a[52:55], v[156:159]
 s_add_u32 m0, s64, 126976
 ds_read_b64_tr_b16 a[164:165], v243 offset:28672
 ds_read_b64_tr_b16 a[166:167], v243 offset:30720
 v_mfma_f32_16x16x32_bf16 v[152:155], a[148:151], a[48:51], v[152:155]
 s_waitcnt lgkmcnt(6)
 v_add_f32 v20, v20, v224
 v_add_f32 v21, v21, v225
 v_mfma_f32_16x16x32_bf16 v[160:163], a[152:155], a[48:51], v[160:163]
 s_add_u32 s65, s88, 479232
 ds_read_b64_tr_b16 a[168:169], v242 offset:29184
 ds_read_b64_tr_b16 a[170:171], v242 offset:31232
 v_mfma_f32_16x16x32_bf16 v[164:167], a[152:155], a[52:55], v[164:167]
 s_waitcnt lgkmcnt(6)
 buffer_load_dwordx4 v249, s[36:39], s65 offen lds
 v_mfma_f32_16x16x32_bf16 v[172:175], a[156:159], a[52:55], v[172:175]
 ds_read_b64_tr_b16 a[172:173], v243 offset:29184
 ds_read_b64_tr_b16 a[174:175], v243 offset:31232
 v_mfma_f32_16x16x32_bf16 v[168:171], a[156:159], a[48:51], v[168:171]
 s_waitcnt lgkmcnt(6)
 v_lshlrev_b32 v226, 16, v67
 v_and_b32 v227, s97, v67
 v_mfma_f32_16x16x32_bf16 v[144:147], a[160:163], a[56:59], v[144:147]
 ds_read_b64_tr_b16 a[144:145], v242 offset:32768
 ds_read_b64_tr_b16 a[146:147], v242 offset:34816
 v_mfma_f32_16x16x32_bf16 v[148:151], a[160:163], a[60:63], v[148:151]
 s_waitcnt lgkmcnt(6)
 v_add_f32 v22, v22, v226
 v_add_f32 v23, v23, v227
 v_mfma_f32_16x16x32_bf16 v[156:159], a[164:167], a[60:63], v[156:159]
 s_add_u32 m0, s64, 131072
 ds_read_b64_tr_b16 a[148:149], v243 offset:32768
 ds_read_b64_tr_b16 a[150:151], v243 offset:34816
 v_mfma_f32_16x16x32_bf16 v[152:155], a[164:167], a[56:59], v[152:155]
 s_waitcnt lgkmcnt(6)
 v_lshlrev_b32 v224, 16, v68
 v_and_b32 v225, s97, v68
 v_mfma_f32_16x16x32_bf16 v[160:163], a[168:171], a[56:59], v[160:163]
 s_add_u32 s65, s88, 516096
 ds_read_b64_tr_b16 a[152:153], v242 offset:33280
 ds_read_b64_tr_b16 a[154:155], v242 offset:35328
 v_mfma_f32_16x16x32_bf16 v[164:167], a[168:171], a[60:63], v[164:167]
 s_waitcnt lgkmcnt(6)
 buffer_load_dwordx4 v249, s[36:39], s65 offen lds
 v_mfma_f32_16x16x32_bf16 v[172:175], a[172:175], a[60:63], v[172:175]
 ds_read_b64_tr_b16 a[156:157], v243 offset:33280
 ds_read_b64_tr_b16 a[158:159], v243 offset:35328
 v_mfma_f32_16x16x32_bf16 v[168:171], a[172:175], a[56:59], v[168:171]
 s_waitcnt lgkmcnt(6)
 v_add_f32 v24, v24, v224
 v_add_f32 v25, v25, v225
 v_mfma_f32_16x16x32_bf16 v[144:147], a[144:147], a[64:67], v[144:147]
 ds_read_b64_tr_b16 a[160:161], v242 offset:36864
 ds_read_b64_tr_b16 a[162:163], v242 offset:38912
 v_mfma_f32_16x16x32_bf16 v[148:151], a[144:147], a[68:71], v[148:151]
 s_waitcnt lgkmcnt(6)
 v_lshlrev_b32 v226, 16, v69
 v_and_b32 v227, s97, v69
 v_mfma_f32_16x16x32_bf16 v[156:159], a[148:151], a[68:71], v[156:159]
 s_add_u32 m0, s64, 135168
 ds_read_b64_tr_b16 a[164:165], v243 offset:36864
 ds_read_b64_tr_b16 a[166:167], v243 offset:38912
 v_mfma_f32_16x16x32_bf16 v[152:155], a[148:151], a[64:67], v[152:155]
 s_waitcnt lgkmcnt(6)
 v_add_f32 v26, v26, v226
 v_add_f32 v27, v27, v227
 v_mfma_f32_16x16x32_bf16 v[160:163], a[152:155], a[64:67], v[160:163]
 s_add_u32 s65, s88, 552960
 ds_read_b64_tr_b16 a[168:169], v242 offset:37376
 ds_read_b64_tr_b16 a[170:171], v242 offset:39424
 v_mfma_f32_16x16x32_bf16 v[164:167], a[152:155], a[68:71], v[164:167]
 s_waitcnt lgkmcnt(6)
 buffer_load_dwordx4 v249, s[36:39], s65 offen lds
 v_mfma_f32_16x16x32_bf16 v[172:175], a[156:159], a[68:71], v[172:175]
 ds_read_b64_tr_b16 a[172:173], v243 offset:37376
 ds_read_b64_tr_b16 a[174:175], v243 offset:39424
 v_mfma_f32_16x16x32_bf16 v[168:171], a[156:159], a[64:67], v[168:171]
 s_waitcnt lgkmcnt(6)
 v_lshlrev_b32 v224, 16, v70
 v_and_b32 v225, s97, v70
 v_mfma_f32_16x16x32_bf16 v[144:147], a[160:163], a[72:75], v[144:147]
 ds_read_b64_tr_b16 a[144:145], v242 offset:40960
 ds_read_b64_tr_b16 a[146:147], v242 offset:43008
 v_mfma_f32_16x16x32_bf16 v[148:151], a[160:163], a[76:79], v[148:151]
 s_waitcnt lgkmcnt(6)
 v_add_f32 v28, v28, v224
 v_add_f32 v29, v29, v225
 v_mfma_f32_16x16x32_bf16 v[156:159], a[164:167], a[76:79], v[156:159]
 s_add_u32 m0, s64, 139264
 ds_read_b64_tr_b16 a[148:149], v243 offset:40960
 ds_read_b64_tr_b16 a[150:151], v243 offset:43008
 v_mfma_f32_16x16x32_bf16 v[152:155], a[164:167], a[72:75], v[152:155]
 s_waitcnt lgkmcnt(6)
 v_lshlrev_b32 v226, 16, v71
 v_and_b32 v227, s97, v71
 v_mfma_f32_16x16x32_bf16 v[160:163], a[168:171], a[72:75], v[160:163]
 s_add_u32 s65, s88, 589824
 ds_read_b64_tr_b16 a[152:153], v242 offset:41472
 ds_read_b64_tr_b16 a[154:155], v242 offset:43520
 v_mfma_f32_16x16x32_bf16 v[164:167], a[168:171], a[76:79], v[164:167]
 s_waitcnt lgkmcnt(6)
 buffer_load_dwordx4 v249, s[36:39], s65 offen lds
 v_mfma_f32_16x16x32_bf16 v[172:175], a[172:175], a[76:79], v[172:175]
 ds_read_b64_tr_b16 a[156:157], v243 offset:41472
 ds_read_b64_tr_b16 a[158:159], v243 offset:43520
 v_mfma_f32_16x16x32_bf16 v[168:171], a[172:175], a[72:75], v[168:171]
 s_waitcnt lgkmcnt(6)
 v_add_f32 v30, v30, v226
 v_add_f32 v31, v31, v227
 v_mfma_f32_16x16x32_bf16 v[144:147], a[144:147], a[80:83], v[144:147]
 ds_read_b64_tr_b16 a[160:161], v242 offset:45056
 ds_read_b64_tr_b16 a[162:163], v242 offset:47104
 v_mfma_f32_16x16x32_bf16 v[148:151], a[144:147], a[84:87], v[148:151]
 s_waitcnt lgkmcnt(6)
 v_lshlrev_b32 v224, 16, v72
 v_and_b32 v225, s97, v72
 v_mfma_f32_16x16x32_bf16 v[156:159], a[148:151], a[84:87], v[156:159]
 s_add_u32 m0, s64, 143360
 ds_read_b64_tr_b16 a[164:165], v243 offset:45056
 ds_read_b64_tr_b16 a[166:167], v243 offset:47104
 v_mfma_f32_16x16x32_bf16 v[152:155], a[148:151], a[80:83], v[152:155]
 s_waitcnt lgkmcnt(6)
 v_add_f32 v32, v32, v224
 v_add_f32 v33, v33, v225
 v_mfma_f32_16x16x32_bf16 v[160:163], a[152:155], a[80:83], v[160:163]
 s_add_u32 s65, s88, 626688
 ds_read_b64_tr_b16 a[168:169], v242 offset:45568
 ds_read_b64_tr_b16 a[170:171], v242 offset:47616
 v_mfma_f32_16x16x32_bf16 v[164:167], a[152:155], a[84:87], v[164:167]
 s_waitcnt lgkmcnt(6)
 buffer_load_dwordx4 v249, s[36:39], s65 offen lds
 v_mfma_f32_16x16x32_bf16 v[172:175], a[156:159], a[84:87], v[172:175]
 s_sub_u32 s67, s61, 5
 ds_read_b64_tr_b16 a[172:173], v243 offset:45568
 ds_read_b64_tr_b16 a[174:175], v243 offset:47616
 v_mfma_f32_16x16x32_bf16 v[168:171], a[156:159], a[80:83], v[168:171]
 s_waitcnt lgkmcnt(6)
 s_and_b32 s67, s67, 7
 s_lshl_b32 s68, s67, 3
 v_mfma_f32_16x16x32_bf16 v[144:147], a[160:163], a[88:91], v[144:147]
 s_mul_i32 s67, s67, 147456
 s_barrier
 ds_read_b64_tr_b16 a[144:145], v244 offset:0
 ds_read_b64_tr_b16 a[146:147], v244 offset:2048
 v_mfma_f32_16x16x32_bf16 v[148:151], a[160:163], a[92:95], v[148:151]
 s_waitcnt lgkmcnt(6)
 s_add_u32 s67, s67, s73
 v_mfma_f32_16x16x32_bf16 v[156:159], a[164:167], a[92:95], v[156:159]
 ds_read_b64_tr_b16 a[148:149], v245 offset:0
 ds_read_b64_tr_b16 a[150:151], v245 offset:2048
 v_mfma_f32_16x16x32_bf16 v[152:155], a[164:167], a[88:91], v[152:155]
 s_waitcnt lgkmcnt(6)
 v_mfma_f32_16x16x32_bf16 v[160:163], a[168:171], a[88:91], v[160:163]
 ds_read_b64_tr_b16 a[152:153], v244 offset:512
 ds_read_b64_tr_b16 a[154:155], v244 offset:2560
 v_mfma_f32_16x16x32_bf16 v[164:167], a[168:171], a[92:95], v[164:167]
 s_waitcnt lgkmcnt(6)
 v_mfma_f32_16x16x32_bf16 v[172:175], a[172:175], a[92:95], v[172:175]
 s_waitcnt vmcnt(7)
 ds_read_b64_tr_b16 a[156:157], v245 offset:512
 ds_read_b64_tr_b16 a[158:159], v245 offset:2560
 v_mfma_f32_16x16x32_bf16 v[168:171], a[172:175], a[88:91], v[168:171]
 s_waitcnt lgkmcnt(6)
 s_lshl2_add_u32 s69, s86, s3
 v_mfma_f32_16x16x32_bf16 v[144:147], a[144:147], a[96:99], v[144:147]
 ds_read_b64_tr_b16 a[160:161], v244 offset:4096
 ds_read_b64_tr_b16 a[162:163], v244 offset:6144
 v_mfma_f32_16x16x32_bf16 v[148:151], a[144:147], a[100:103], v[148:151]
 s_waitcnt lgkmcnt(6)
 buffer_store_byte v252, v101, s[56:59], s69 offen sc1
 v_mfma_f32_16x16x32_bf16 v[156:159], a[148:151], a[100:103], v[156:159]
 ds_read_b64_tr_b16 a[164:165], v245 offset:4096
 ds_read_b64_tr_b16 a[166:167], v245 offset:6144
 v_mfma_f32_16x16x32_bf16 v[152:155], a[148:151], a[96:99], v[152:155]
 s_waitcnt lgkmcnt(6)
 v_readfirstlane_b32 s26, v102
 v_readfirstlane_b32 s27, v103
 v_mfma_f32_16x16x32_bf16 v[160:163], a[152:155], a[96:99], v[160:163]
 ds_read_b64_tr_b16 a[168:169], v244 offset:4608
 ds_read_b64_tr_b16 a[170:171], v244 offset:6656
 v_mfma_f32_16x16x32_bf16 v[164:167], a[152:155], a[100:103], v[164:167]
 s_waitcnt lgkmcnt(6)
 s_lshr_b64 s[26:27], s[26:27], s68
 s_and_b32 s26, s26, 0xff
 s_cbranch_scc0 L_chk4
L_chk4_ok:
 v_mfma_f32_16x16x32_bf16 v[172:175], a[156:159], a[100:103], v[172:175]
 ds_read_b64_tr_b16 a[172:173], v245 offset:4608
 ds_read_b64_tr_b16 a[174:175], v245 offset:6656
 v_mfma_f32_16x16x32_bf16 v[168:171], a[156:159], a[96:99], v[168:171]
 s_waitcnt lgkmcnt(6)
 buffer_load_dwordx4 v[48:51], v250, s[56:59], s67 offen offset:0 sc1
 v_mfma_f32_16x16x32_bf16 v[144:147], a[160:163], a[104:107], v[144:147]
 ds_read_b64_tr_b16 a[144:145], v244 offset:8192
 ds_read_b64_tr_b16 a[146:147], v244 offset:10240
 v_mfma_f32_16x16x32_bf16 v[148:151], a[160:163], a[108:111], v[148:151]
 s_waitcnt lgkmcnt(6)
 buffer_load_dwordx4 v[52:55], v250, s[56:59], s67 offen offset:1024 sc1
 v_mfma_f32_16x16x32_bf16 v[156:159], a[164:167], a[108:111], v[156:159]
 ds_read_b64_tr_b16 a[148:149], v245 offset:8192
 ds_read_b64_tr_b16 a[150:151], v245 offset:10240
 v_mfma_f32_16x16x32_bf16 v[152:155], a[164:167], a[104:107], v[152:155]
 s_waitcnt lgkmcnt(6)
 buffer_load_dwordx4 v[56:59], v250, s[56:59], s67 offen offset:2048 sc1
 v_mfma_f32_16x16x32_bf16 v[160:163], a[168:171], a[104:107], v[160:163]
 ds_read_b64_tr_b16 a[152:153], v244 offset:8704
 ds_read_b64_tr_b16 a[154:155], v244 offset:10752
 v_mfma_f32_16x16x32_bf16 v[164:167], a[168:171], a[108:111], v[164:167]
 s_waitcnt lgkmcnt(6)
 buffer_load_dwordx4 v[60:63], v250, s[56:59], s67 offen offset:3072 sc1
 v_mfma_f32_16x16x32_bf16 v[172:175], a[172:175], a[108:111], v[172:175]
 ds_read_b64_tr_b16 a[156:157], v245 offset:8704
 ds_read_b64_tr_b16 a[158:159], v245 offset:10752
 v_mfma_f32_16x16x32_bf16 v[168:171], a[172:175], a[104:107], v[168:171]
 s_waitcnt lgkmcnt(6)
 v_lshlrev_b32 v226, 16, v73
 v_and_b32 v227, s97, v73
 v_mfma_f32_16x16x32_bf16 v[144:147], a[144:147], v[208:211], v[144:147]
 ds_read_b64_tr_b16 a[160:161], v244 offset:12288
 ds_read_b64_tr_b16 a[162:163], v244 offset:14336
 v_mfma_f32_16x16x32_bf16 v[148:151], a[144:147], v[212:215], v[148:151]
 s_waitcnt lgkmcnt(6)
 v_add_f32 v34, v34, v226
 v_add_f32 v35, v35, v227
 v_mfma_f32_16x16x32_bf16 v[156:159], a[148:151], v[212:215], v[156:159]
 ds_read_b64_tr_b16 a[164:165], v245 offset:12288
 ds_read_b64_tr_b16 a[166:167], v245 offset:14336
 v_mfma_f32_16x16x32_bf16 v[152:155], a[148:151], v[208:211], v[152:155]
 s_waitcnt lgkmcnt(6)
 v_lshlrev_b32 v224, 16, v74
 v_and_b32 v225, s97, v74
 v_mfma_f32_16x16x32_bf16 v[160:163], a[152:155], v[208:211], v[160:163]
 ds_read_b64_tr_b16 a[168:169], v244 offset:12800
 ds_read_b64_tr_b16 a[170:171], v244 offset:14848
 v_mfma_f32_16x16x32_bf16 v[164:167], a[152:155], v[212:215], v[164:167]
 s_waitcnt lgkmcnt(6)
 v_add_f32 v36, v36, v224
 v_add_f32 v37, v37, v225
 v_mfma_f32_16x16x32_bf16 v[172:175], a[156:159], v[212:215], v[172:175]
 ds_read_b64_tr_b16 a[172:173], v245 offset:12800
 ds_read_b64_tr_b16 a[174:175], v245 offset:14848
 v_mfma_f32_16x16x32_bf16 v[168:171], a[156:159], v[208:211], v[168:171]
 s_waitcnt lgkmcnt(6)
 v_lshlrev_b32 v226, 16, v75
 v_and_b32 v227, s97, v75
 v_mfma_f32_16x16x32_bf16 v[144:147], a[160:163], v[216:219], v[144:147]
 ds_read_b64_tr_b16 a[144:145], v244 offset:16384
 ds_read_b64_tr_b16 a[146:147], v244 offset:18432
 v_mfma_f32_16x16x32_bf16 v[148:151], a[160:163], v[220:223], v[148:151]
 s_waitcnt lgkmcnt(6)
 v_add_f32 v38, v38, v226
 v_add_f32 v39, v39, v227
 v_mfma_f32_16x16x32_bf16 v[156:159], a[164:167], v[220:223], v[156:159]
 ds_read_b64_tr_b16 a[148:149], v245 offset:16384
 ds_read_b64_tr_b16 a[150:151], v245 offset:18432
 v_mfma_f32_16x16x32_bf16 v[152:155], a[164:167], v[216:219], v[152:155]
 s_waitcnt lgkmcnt(6)
 v_lshlrev_b32 v224, 16, v76
 v_and_b32 v225, s97, v76
 v_mfma_f32_16x16x32_bf16 v[160:163], a[168:171], v[216:219], v[160:163]
 ds_read_b64_tr_b16 a[152:153], v244 offset:16896
 ds_read_b64_tr_b16 a[154:155], v244 offset:18944
 v_mfma_f32_16x16x32_bf16 v[164:167], a[168:171], v[220:223], v[164:167]
 s_waitcnt lgkmcnt(6)
 v_add_f32 v40, v40, v224
 v_add_f32 v41, v41, v225
 v_mfma_f32_16x16x32_bf16 v[172:175], a[172:175], v[220:223], v[172:175]
 ds_read_b64_tr_b16 a[156:157], v245 offset:16896
 ds_read_b64_tr_b16 a[158:159], v245 offset:18944
 v_mfma_f32_16x16x32_bf16 v[168:171], a[172:175], v[216:219], v[168:171]
 s_waitcnt lgkmcnt(6)
 v_lshlrev_b32 v226, 16, v77
 v_and_b32 v227, s97, v77
 v_mfma_f32_16x16x32_bf16 v[144:147], a[144:147], v[0:3], v[144:147]
 ds_read_b64_tr_b16 a[160:161], v244 offset:20480
 ds_read_b64_tr_b16 a[162:163], v244 offset:22528
 v_mfma_f32_16x16x32_bf16 v[148:151], a[144:147], v[4:7], v[148:151]
 s_waitcnt lgkmcnt(6)
 v_add_f32 v42, v42, v226
 v_add_f32 v43, v43, v227
 v_mfma_f32_16x16x32_bf16 v[156:159], a[148:151], v[4:7], v[156:159]
 ds_read_b64_tr_b16 a[164:165], v245 offset:20480
 ds_read_b64_tr_b16 a[166:167], v245 offset:22528
 v_mfma_f32_16x16x32_bf16 v[152:155], a[148:151], v[0:3], v[152:155]
 s_waitcnt lgkmcnt(6)
 v_lshlrev_b32 v224, 16, v78
 v_and_b32 v225, s97, v78
 v_mfma_f32_16x16x32_bf16 v[160:163], a[152:155], v[0:3], v[160:163]
 ds_read_b64_tr_b16 a[168:169], v244 offset:20992
 ds_read_b64_tr_b16 a[170:171], v244 offset:23040
 v_mfma_f32_16x16x32_bf16 v[164:167], a[152:155], v[4:7], v[164:167]
 s_waitcnt lgkmcnt(6)
 v_add_f32 v44, v44, v224
 v_add_f32 v45, v45, v225
 v_mfma_f32_16x16x32_bf16 v[172:175], a[156:159], v[4:7], v[172:175]
 ds_read_b64_tr_b16 a[172:173], v245 offset:20992
 ds_read_b64_tr_b16 a[174:175], v245 offset:23040
 v_mfma_f32_16x16x32_bf16 v[168:171], a[156:159], v[0:3], v[168:171]
 s_waitcnt lgkmcnt(6)
 v_lshlrev_b32 v226, 16, v79
 v_and_b32 v227, s97, v79
 v_mfma_f32_16x16x32_bf16 v[144:147], a[160:163], v[8:11], v[144:147]
 s_barrier
 ds_read_b64_tr_b16 a[144:145], v244 offset:24576
 ds_read_b64_tr_b16 a[146:147], v244 offset:26624
 v_mfma_f32_16x16x32_bf16 v[148:151], a[160:163], v[12:15], v[148:151]
 s_waitcnt lgkmcnt(6)
 v_add_f32 v46, v46, v226
 v_add_f32 v47, v47, v227
 v_mfma_f32_16x16x32_bf16 v[156:159], a[164:167], v[12:15], v[156:159]
 ds_read_b64_tr_b16 a[148:149], v245 offset:24576
 ds_read_b64_tr_b16 a[150:151], v245 offset:26624
 v_mfma_f32_16x16x32_bf16 v[152:155], a[164:167], v[8:11], v[152:155]
 s_waitcnt lgkmcnt(6)
 v_mfma_f32_16x16x32_bf16 v[160:163], a[168:171], v[8:11], v[160:163]
 ds_read_b64_tr_b16 a[152:153], v244 offset:25088
 ds_read_b64_tr_b16 a[154:155], v244 offset:27136
 v_mfma_f32_16x16x32_bf16 v[164:167], a[168:171], v[12:15], v[164:167]
 s_waitcnt lgkmcnt(6)
 v_mfma_f32_16x16x32_bf16 v[172:175], a[172:175], v[12:15], v[172:175]
 ds_read_b64_tr_b16 a[156:157], v245 offset:25088
 ds_read_b64_tr_b16 a[158:159], v245 offset:27136
 v_mfma_f32_16x16x32_bf16 v[168:171], a[172:175], v[8:11], v[168:171]
 s_waitcnt lgkmcnt(6)
 v_mfma_f32_16x16x32_bf16 v[176:179], a[144:147], a[0:3], 0
 ds_read_b64_tr_b16 a[160:161], v244 offset:28672
 ds_read_b64_tr_b16 a[162:163], v244 offset:30720
 v_mfma_f32_16x16x32_bf16 v[180:183], a[144:147], a[4:7], 0
 s_waitcnt lgkmcnt(6)
 v_mfma_f32_16x16x32_bf16 v[188:191], a[148:151], a[4:7], 0
 ds_read_b64_tr_b16 a[164:165], v245 offset:28672
 ds_read_b64_tr_b16 a[166:167], v245 offset:30720
 v_mfma_f32_16x16x32_bf16 v[184:187], a[148:151], a[0:3], 0
 s_waitcnt lgkmcnt(6)
 v_cvt_pk_bf16_f32 v224, v144, v145
 v_cvt_pk_bf16_f32 v225, v146, v147
 v_mfma_f32_16x16x32_bf16 v[192:195], a[152:155], a[0:3], 0
 ds_read_b64_tr_b16 a[168:169], v244 offset:29184
 ds_read_b64_tr_b16 a[170:171], v244 offset:31232
 v_mfma_f32_16x16x32_bf16 v[196:199], a[152:155], a[4:7], 0
 s_waitcnt lgkmcnt(6)
 v_cvt_pk_bf16_f32 v226, v148, v149
 v_cvt_pk_bf16_f32 v227, v150, v151
 v_mfma_f32_16x16x32_bf16 v[204:207], a[156:159], a[4:7], 0
 ds_read_b64_tr_b16 a[172:173], v245 offset:29184
 ds_read_b64_tr_b16 a[174:175], v245 offset:31232
 v_mfma_f32_16x16x32_bf16 v[200:203], a[156:159], a[0:3], 0
 s_waitcnt lgkmcnt(6)
 buffer_store_dwordx4 v[224:227], v250, s[56:59], s96 offen offset:0 sc1
 v_mfma_f32_16x16x32_bf16 v[176:179], a[160:163], a[8:11], v[176:179]
 ds_read_b64_tr_b16 a[144:145], v244 offset:32768
 ds_read_b64_tr_b16 a[146:147], v244 offset:34816
 v_mfma_f32_16x16x32_bf16 v[180:183], a[160:163], a[12:15], v[180:183]
 s_waitcnt lgkmcnt(6)
 v_cvt_pk_bf16_f32 v228, v152, v153
 v_cvt_pk_bf16_f32 v229, v154, v155
 v_mfma_f32_16x16x32_bf16 v[188:191], a[164:167], a[12:15], v[188:191]
 ds_read_b64_tr_b16 a[148:149], v245 offset:32768
 ds_read_b64_tr_b16 a[150:151], v245 offset:34816
 v_mfma_f32_16x16x32_bf16 v[184:187], a[164:167], a[8:11], v[184:187]
 s_waitcnt lgkmcnt(6)
 v_cvt_pk_bf16_f32 v230, v156, v157
 v_cvt_pk_bf16_f32 v231, v158, v159
 v_mfma_f32_16x16x32_bf16 v[192:195], a[168:171], a[8:11], v[192:195]
 ds_read_b64_tr_b16 a[152:153], v244 offset:33280
 ds_read_b64_tr_b16 a[154:155], v244 offset:35328
 v_mfma_f32_16x16x32_bf16 v[196:199], a[168:171], a[12:15], v[196:199]
 s_waitcnt lgkmcnt(6)
 buffer_store_dwordx4 v[228:231], v250, s[56:59], s96 offen offset:1024 sc1
 v_mfma_f32_16x16x32_bf16 v[204:207], a[172:175], a[12:15], v[204:207]
 ds_read_b64_tr_b16 a[156:157], v245 offset:33280
 ds_read_b64_tr_b16 a[158:159], v245 offset:35328
 v_mfma_f32_16x16x32_bf16 v[200:203], a[172:175], a[8:11], v[200:203]
 s_waitcnt lgkmcnt(6)
 v_cvt_pk_bf16_f32 v232, v160, v161
 v_cvt_pk_bf16_f32 v233, v162, v163
 v_mfma_f32_16x16x32_bf16 v[176:179], a[144:147], a[16:19], v[176:179]
 ds_read_b64_tr_b16 a[160:161], v244 offset:36864
 ds_read_b64_tr_b16 a[162:163], v244 offset:38912
 v_mfma_f32_16x16x32_bf16 v[180:183], a[144:147], a[20:23], v[180:183]
 s_waitcnt lgkmcnt(6)
 v_cvt_pk_bf16_f32 v234, v164, v165
 v_cvt_pk_bf16_f32 v235, v166, v167
 v_mfma_f32_16x16x32_bf16 v[188:191], a[148:151], a[20:23], v[188:191]
 ds_read_b64_tr_b16 a[164:165], v245 offset:36864
 ds_read_b64_tr_b16 a[166:167], v245 offset:38912
 v_mfma_f32_16x16x32_bf16 v[184:187], a[148:151], a[16:19], v[184:187]
 s_waitcnt lgkmcnt(6)
 buffer_store_dwordx4 v[232:235], v250, s[56:59], s96 offen offset:2048 sc1
 v_mfma_f32_16x16x32_bf16 v[192:195], a[152:155], a[16:19], v[192:195]
 ds_read_b64_tr_b16 a[168:169], v244 offset:37376
 ds_read_b64_tr_b16 a[170:171], v244 offset:39424
 v_mfma_f32_16x16x32_bf16 v[196:199], a[152:155], a[20:23], v[196:199]
 s_waitcnt lgkmcnt(6)
 v_cvt_pk_bf16_f32 v224, v168, v169
 v_cvt_pk_bf16_f32 v225, v170, v171
 v_mfma_f32_16x16x32_bf16 v[204:207], a[156:159], a[20:23], v[204:207]
 ds_read_b64_tr_b16 a[172:173], v245 offset:37376
 ds_read_b64_tr_b16 a[174:175], v245 offset:39424
 v_mfma_f32_16x16x32_bf16 v[200:203], a[156:159], a[16:19], v[200:203]
 s_waitcnt lgkmcnt(6)
 v_cvt_pk_bf16_f32 v226, v172, v173
 v_cvt_pk_bf16_f32 v227, v174, v175
 v_mfma_f32_16x16x32_bf16 v[176:179], a[160:163], a[24:27], v[176:179]
 ds_read_b64_tr_b16 a[144:145], v244 offset:40960
 ds_read_b64_tr_b16 a[146:147], v244 offset:43008
 v_mfma_f32_16x16x32_bf16 v[180:183], a[160:163], a[28:31], v[180:183]
 s_waitcnt lgkmcnt(6)
 buffer_store_dwordx4 v[224:227], v250, s[56:59], s96 offen offset:3072 sc1
 v_mfma_f32_16x16x32_bf16 v[188:191], a[164:167], a[28:31], v[188:191]
 ds_read_b64_tr_b16 a[148:149], v245 offset:40960
 ds_read_b64_tr_b16 a[150:151], v245 offset:43008
 v_mfma_f32_16x16x32_bf16 v[184:187], a[164:167], a[24:27], v[184:187]
 s_waitcnt lgkmcnt(6)
 buffer_load_dwordx2 v[102:103], v98, s[56:59], 0 offen sc1
 v_mfma_f32_16x16x32_bf16 v[192:195], a[168:171], a[24:27], v[192:195]
 s_waitcnt vmcnt(5)
 ds_read_b64_tr_b16 a[152:153], v244 offset:41472
 ds_read_b64_tr_b16 a[154:155], v244 offset:43520
 v_mfma_f32_16x16x32_bf16 v[196:199], a[168:171], a[28:31], v[196:199]
 s_waitcnt lgkmcnt(6)
 v_lshlrev_b32 v224, 16, v48
 v_and_b32 v225, s97, v48
 v_mfma_f32_16x16x32_bf16 v[204:207], a[172:175], a[28:31], v[204:207]
 ds_read_b64_tr_b16 a[156:157], v245 offset:41472
 ds_read_b64_tr_b16 a[158:159], v245 offset:43520
 v_mfma_f32_16x16x32_bf16 v[200:203], a[172:175], a[24:27], v[200:203]
 s_waitcnt lgkmcnt(6)
 v_add_f32 v16, v16, v224
 v_add_f32 v17, v17, v225
 v_mfma_f32_16x16x32_bf16 v[176:179], a[144:147], a[32:35], v[176:179]
 ds_read_b64_tr_b16 a[160:161], v244 offset:45056
 ds_read_b64_tr_b16 a[162:163], v244 offset:47104
 v_mfma_f32_16x16x32_bf16 v[180:183], a[144:147], a[36:39], v[180:183]
 s_waitcnt lgkmcnt(6)
 v_lshlrev_b32 v226, 16, v49
 v_and_b32 v227, s97, v49
 v_mfma_f32_16x16x32_bf16 v[188:191], a[148:151], a[36:39], v[188:191]
 ds_read_b64_tr_b16 a[164:165], v245 offset:45056
 ds_read_b64_tr_b16 a[166:167], v245 offset:47104
 v_mfma_f32_16x16x32_bf16 v[184:187], a[148:151], a[32:35], v[184:187]
 s_waitcnt lgkmcnt(6)
 v_add_f32 v18, v18, v226
 v_add_f32 v19, v19, v227
 v_mfma_f32_16x16x32_bf16 v[192:195], a[152:155], a[32:35], v[192:195]
 ds_read_b64_tr_b16 a[168:169], v244 offset:45568
 ds_read_b64_tr_b16 a[170:171], v244 offset:47616
 v_mfma_f32_16x16x32_bf16 v[196:199], a[152:155], a[36:39], v[196:199]
 s_waitcnt lgkmcnt(6)
 v_lshlrev_b32 v224, 16, v50
 v_and_b32 v225, s97, v50
 v_mfma_f32_16x16x32_bf16 v[204:207], a[156:159], a[36:39], v[204:207]
 ds_read_b64_tr_b16 a[172:173], v245 offset:45568
 ds_read_b64_tr_b16 a[174:175], v245 offset:47616
 v_mfma_f32_16x16x32_bf16 v[200:203], a[156:159], a[32:35], v[200:203]
 s_waitcnt lgkmcnt(6)
 v_add_f32 v20, v20, v224
 v_add_f32 v21, v21, v225
 v_mfma_f32_16x16x32_bf16 v[176:179], a[160:163], a[40:43], v[176:179]
 s_barrier
 ds_read_b64_tr_b16 a[144:145], v246 offset:0
 ds_read_b64_tr_b16 a[146:147], v246 offset:2048
 v_mfma_f32_16x16x32_bf16 v[180:183], a[160:163], a[44:47], v[180:183]
 s_waitcnt lgkmcnt(6)
 v_lshlrev_b32 v226, 16, v51
 v_and_b32 v227, s97, v51
 v_mfma_f32_16x16x32_bf16 v[188:191], a[164:167], a[44:47], v[188:191]
 ds_read_b64_tr_b16 a[148:149], v247 offset:0
 ds_read_b64_tr_b16 a[150:151], v247 offset:2048
 v_mfma_f32_16x16x32_bf16 v[184:187], a[164:167], a[40:43], v[184:187]
 s_waitcnt lgkmcnt(6)
 v_add_f32 v22, v22, v226
 v_add_f32 v23, v23, v227
 v_mfma_f32_16x16x32_bf16 v[192:195], a[168:171], a[40:43], v[192:195]
 ds_read_b64_tr_b16 a[152:153], v246 offset:512
 ds_read_b64_tr_b16 a[154:155], v246 offset:2560
 v_mfma_f32_16x16x32_bf16 v[196:199], a[168:171], a[44:47], v[196:199]
 s_waitcnt lgkmcnt(6)
 v_lshlrev_b32 v224, 16, v52
 v_and_b32 v225, s97, v52
 v_mfma_f32_16x16x32_bf16 v[204:207], a[172:175], a[44:47], v[204:207]
 ds_read_b64_tr_b16 a[156:157], v247 offset:512
 ds_read_b64_tr_b16 a[158:159], v247 offset:2560
 v_mfma_f32_16x16x32_bf16 v[200:203], a[172:175], a[40:43], v[200:203]
 s_waitcnt lgkmcnt(6)
 v_add_f32 v24, v24, v224
 v_add_f32 v25, v25, v225
 v_mfma_f32_16x16x32_bf16 v[176:179], a[144:147], a[48:51], v[176:179]
 ds_read_b64_tr_b16 a[160:161], v246 offset:4096
 ds_read_b64_tr_b16 a[162:163], v246 offset:6144
 v_mfma_f32_16x16x32_bf16 v[180:183], a[144:147], a[52:55], v[180:183]
 s_waitcnt lgkmcnt(6)
 v_lshlrev_b32 v226, 16, v53
 v_and_b32 v227, s97, v53
 v_mfma_f32_16x16x32_bf16 v[188:191], a[148:151], a[52:55], v[188:191]
 ds_read_b64_tr_b16 a[164:165], v247 offset:4096
 ds_read_b64_tr_b16 a[166:167], v247 offset:6144
 v_mfma_f32_16x16x32_bf16 v[184:187], a[148:151], a[48:51], v[184:187]
 s_waitcnt lgkmcnt(6)
 v_add_f32 v26, v26, v226
 v_add_f32 v27, v27, v227
 v_mfma_f32_16x16x32_bf16 v[192:195], a[152:155], a[48:51], v[192:195]
 ds_read_b64_tr_b16 a[168:169], v246 offset:4608
 ds_read_b64_tr_b16 a[170:171], v246 offset:6656
 v_mfma_f32_16x16x32_bf16 v[196:199], a[152:155], a[52:55], v[196:199]
 s_waitcnt lgkmcnt(6)
 v_mfma_f32_16x16x32_bf16 v[204:207], a[156:159], a[52:55], v[204:207]
 ds_read_b64_tr_b16 a[172:173], v247 offset:4608
 ds_read_b64_tr_b16 a[174:175], v247 offset:6656
 v_mfma_f32_16x16x32_bf16 v[200:203], a[156:159], a[48:51], v[200:203]
 s_waitcnt lgkmcnt(6)
 v_mfma_f32_16x16x32_bf16 v[176:179], a[160:163], a[56:59], v[176:179]
 ds_read_b64_tr_b16 a[144:145], v246 offset:8192
 ds_read_b64_tr_b16 a[146:147], v246 offset:10240
 v_mfma_f32_16x16x32_bf16 v[180:183], a[160:163], a[60:63], v[180:183]
 s_waitcnt lgkmcnt(6)
 v_mfma_f32_16x16x32_bf16 v[188:191], a[164:167], a[60:63], v[188:191]
 ds_read_b64_tr_b16 a[148:149], v247 offset:8192
 ds_read_b64_tr_b16 a[150:151], v247 offset:10240
 v_mfma_f32_16x16x32_bf16 v[184:187], a[164:167], a[56:59], v[184:187]
 s_waitcnt lgkmcnt(6)
 v_mfma_f32_16x16x32_bf16 v[192:195], a[168:171], a[56:59], v[192:195]
 ds_read_b64_tr_b16 a[152:153], v246 offset:8704
 ds_read_b64_tr_b16 a[154:155], v246 offset:10752
 v_mfma_f32_16x16x32_bf16 v[196:199], a[168:171], a[60:63], v[196:199]
 s_waitcnt lgkmcnt(6)
 v_mfma_f32_16x16x32_bf16 v[204:207], a[172:175], a[60:63], v[204:207]
 s_sub_u32 s67, s61, 6
 ds_read_b64_tr_b16 a[156:157], v247 offset:8704
 ds_read_b64_tr_b16 a[158:159], v247 offset:10752
 v_mfma_f32_16x16x32_bf16 v[200:203], a[172:175], a[56:59], v[200:203]
 s_waitcnt lgkmcnt(6)
 s_and_b32 s67, s67, 7
 s_lshl_b32 s68, s67, 3
 v_mfma_f32_16x16x32_bf16 v[176:179], a[144:147], a[64:67], v[176:179]
 s_mul_i32 s67, s67, 147456
 ds_read_b64_tr_b16 a[160:161], v246 offset:12288
 ds_read_b64_tr_b16 a[162:163], v246 offset:14336
 v_mfma_f32_16x16x32_bf16 v[180:183], a[144:147], a[68:71], v[180:183]
 s_waitcnt lgkmcnt(6)
 s_add_u32 s67, s67, s73
 v_mfma_f32_16x16x32_bf16 v[188:191], a[148:151], a[68:71], v[188:191]
 ds_read_b64_tr_b16 a[164:165], v247 offset:12288
 ds_read_b64_tr_b16 a[166:167], v247 offset:14336
 v_mfma_f32_16x16x32_bf16 v[184:187], a[148:151], a[64:67], v[184:187]
 s_waitcnt lgkmcnt(6)
 v_mfma_f32_16x16x32_bf16 v[192:195], a[152:155], a[64:67], v[192:195]
 ds_read_b64_tr_b16 a[168:169], v246 offset:12800
 ds_read_b64_tr_b16 a[170:171], v246 offset:14848
 v_mfma_f32_16x16x32_bf16 v[196:199], a[152:155], a[68:71], v[196:199]
 s_waitcnt lgkmcnt(6)
 v_mfma_f32_16x16x32_bf16 v[204:207], a[156:159], a[68:71], v[204:207]
 ds_read_b64_tr_b16 a[172:173], v247 offset:12800
 ds_read_b64_tr_b16 a[174:175], v247 offset:14848
 v_mfma_f32_16x16x32_bf16 v[200:203], a[156:159], a[64:67], v[200:203]
 s_waitcnt lgkmcnt(6)
 v_mfma_f32_16x16x32_bf16 v[176:179], a[160:163], a[72:75], v[176:179]
 s_waitcnt vmcnt(0)
 ds_read_b64_tr_b16 a[144:145], v246 offset:16384
 ds_read_b64_tr_b16 a[146:147], v246 offset:18432
 v_mfma_f32_16x16x32_bf16 v[180:183], a[160:163], a[76:79], v[180:183]
 s_waitcnt lgkmcnt(6)
 buffer_store_byte v252, v104, s[56:59], s3 offen sc1
 v_mfma_f32_16x16x32_bf16 v[188:191], a[164:167], a[76:79], v[188:191]
 ds_read_b64_tr_b16 a[148:149], v247 offset:16384
 ds_read_b64_tr_b16 a[150:151], v247 offset:18432
 v_mfma_f32_16x16x32_bf16 v[184:187], a[164:167], a[72:75], v[184:187]
 s_waitcnt lgkmcnt(6)
 v_readfirstlane_b32 s26, v102
 v_readfirstlane_b32 s27, v103
 v_mfma_f32_16x16x32_bf16 v[192:195], a[168:171], a[72:75], v[192:195]
 ds_read_b64_tr_b16 a[152:153], v246 offset:16896
 ds_read_b64_tr_b16 a[154:155], v246 offset:18944
 v_mfma_f32_16x16x32_bf16 v[196:199], a[168:171], a[76:79], v[196:199]
 s_waitcnt lgkmcnt(6)
 s_lshr_b64 s[26:27], s[26:27], s68
 s_and_b32 s26, s26, 0xff
 s_cbranch_scc0 L_chk5
L_chk5_ok:
 v_mfma_f32_16x16x32_bf16 v[204:207], a[172:175], a[76:79], v[204:207]
 ds_read_b64_tr_b16 a[156:157], v247 offset:16896
 ds_read_b64_tr_b16 a[158:159], v247 offset:18944
 v_mfma_f32_16x16x32_bf16 v[200:203], a[172:175], a[72:75], v[200:203]
 s_waitcnt lgkmcnt(6)
 buffer_load_dwordx4 v[64:67], v250, s[56:59], s67 offen offset:0 sc1
 v_mfma_f32_16x16x32_bf16 v[176:179], a[144:147], a[80:83], v[176:179]
 ds_read_b64_tr_b16 a[160:161], v246 offset:20480
 ds_read_b64_tr_b16 a[162:163], v246 offset:22528
 v_mfma_f32_16x16x32_bf16 v[180:183], a[144:147], a[84:87], v[180:183]
 s_waitcnt lgkmcnt(6)
 buffer_load_dwordx4 v[68:71], v250, s[56:59], s67 offen offset:1024 sc1
 v_mfma_f32_16x16x32_bf16 v[188:191], a[148:151], a[84:87], v[188:191]
 ds_read_b64_tr_b16 a[164:165], v247 offset:20480
 ds_read_b64_tr_b16 a[166:167], v247 offset:22528
 v_mfma_f32_16x16x32_bf16 v[184:187], a[148:151], a[80:83], v[184:187]
 s_waitcnt lgkmcnt(6)
 buffer_load_dwordx4 v[72:75], v250, s[56:59], s67 offen offset:2048 sc1
 v_mfma_f32_16x16x32_bf16 v[192:195], a[152:155], a[80:83], v[192:195]
 ds_read_b64_tr_b16 a[168:169], v246 offset:20992
 ds_read_b64_tr_b16 a[170:171], v246 offset:23040
 v_mfma_f32_16x16x32_bf16 v[196:199], a[152:155], a[84:87], v[196:199]
 s_waitcnt lgkmcnt(6)
 buffer_load_dwordx4 v[76:79], v250, s[56:59], s67 offen offset:3072 sc1
 v_mfma_f32_16x16x32_bf16 v[204:207], a[156:159], a[84:87], v[204:207]
 ds_read_b64_tr_b16 a[172:173], v247 offset:20992
 ds_read_b64_tr_b16 a[174:175], v247 offset:23040
 v_mfma_f32_16x16x32_bf16 v[200:203], a[156:159], a[80:83], v[200:203]
 s_waitcnt lgkmcnt(6)
 buffer_load_dwordx2 v[102:103], v98, s[56:59], 0 offen sc1
 v_mfma_f32_16x16x32_bf16 v[176:179], a[160:163], a[88:91], v[176:179]
 s_barrier
 ds_read_b64_tr_b16 a[144:145], v246 offset:24576
 ds_read_b64_tr_b16 a[146:147], v246 offset:26624
 v_mfma_f32_16x16x32_bf16 v[180:183], a[160:163], a[92:95], v[180:183]
 s_waitcnt lgkmcnt(6)
 buffer_load_ubyte v105, off, s[56:59], s74 offset:32 sc1
 v_mfma_f32_16x16x32_bf16 v[188:191], a[164:167], a[92:95], v[188:191]
 ds_read_b64_tr_b16 a[148:149], v247 offset:24576
 ds_read_b64_tr_b16 a[150:151], v247 offset:26624
 v_mfma_f32_16x16x32_bf16 v[184:187], a[164:167], a[88:91], v[184:187]
 s_waitcnt lgkmcnt(6)
 v_lshlrev_b32 v224, 16, v54
 v_and_b32 v225, s97, v54
 v_mfma_f32_16x16x32_bf16 v[192:195], a[168:171], a[88:91], v[192:195]
 ds_read_b64_tr_b16 a[152:153], v246 offset:25088
 ds_read_b64_tr_b16 a[154:155], v246 offset:27136
 v_mfma_f32_16x16x32_bf16 v[196:199], a[168:171], a[92:95], v[196:199]
 s_waitcnt lgkmcnt(6)
 v_add_f32 v28, v28, v224
 v_add_f32 v29, v29, v225
 v_mfma_f32_16x16x32_bf16 v[204:207], a[172:175], a[92:95], v[204:207]
 ds_read_b64_tr_b16 a[156:157], v247 offset:25088
 ds_read_b64_tr_b16 a[158:159], v247 offset:27136
 v_mfma_f32_16x16x32_bf16 v[200:203], a[172:175], a[88:91], v[200:203]
 s_waitcnt lgkmcnt(6)
 v_lshlrev_b32 v226, 16, v55
 v_and_b32 v227, s97, v55
 v_mfma_f32_16x16x32_bf16 v[176:179], a[144:147], a[96:99], v[176:179]
 ds_read_b64_tr_b16 a[160:161], v246 offset:28672
 ds_read_b64_tr_b16 a[162:163], v246 offset:30720
 v_mfma_f32_16x16x32_bf16 v[180:183], a[144:147], a[100:103], v[180:183]
 s_waitcnt lgkmcnt(6)
 v_add_f32 v30, v30, v226
 v_add_f32 v31, v31, v227
 v_mfma_f32_16x16x32_bf16 v[188:191], a[148:151], a[100:103], v[188:191]
 ds_read_b64_tr_b16 a[164:165], v247 offset:28672
 ds_read_b64_tr_b16 a[166:167], v247 offset:30720
 v_mfma_f32_16x16x32_bf16 v[184:187], a[148:151], a[96:99], v[184:187]
 s_waitcnt lgkmcnt(6)
 v_lshlrev_b32 v224, 16, v56
 v_and_b32 v225, s97, v56
 v_mfma_f32_16x16x32_bf16 v[192:195], a[152:155], a[96:99], v[192:195]
 ds_read_b64_tr_b16 a[168:169], v246 offset:29184
 ds_read_b64_tr_b16 a[170:171], v246 offset:31232
 v_mfma_f32_16x16x32_bf16 v[196:199], a[152:155], a[100:103], v[196:199]
 s_waitcnt lgkmcnt(6)
 v_add_f32 v32, v32, v224
 v_add_f32 v33, v33, v225
 v_mfma_f32_16x16x32_bf16 v[204:207], a[156:159], a[100:103], v[204:207]
 ds_read_b64_tr_b16 a[172:173], v247 offset:29184
 ds_read_b64_tr_b16 a[174:175], v247 offset:31232
 v_mfma_f32_16x16x32_bf16 v[200:203], a[156:159], a[96:99], v[200:203]
 s_waitcnt lgkmcnt(6)
 v_lshlrev_b32 v226, 16, v57
 v_and_b32 v227, s97, v57
 v_mfma_f32_16x16x32_bf16 v[176:179], a[160:163], a[104:107], v[176:179]
 ds_read_b64_tr_b16 a[144:145], v246 offset:32768
 ds_read_b64_tr_b16 a[146:147], v246 offset:34816
 v_mfma_f32_16x16x32_bf16 v[180:183], a[160:163], a[108:111], v[180:183]
 s_waitcnt lgkmcnt(6)
 v_add_f32 v34, v34, v226
 v_add_f32 v35, v35, v227
 v_mfma_f32_16x16x32_bf16 v[188:191], a[164:167], a[108:111], v[188:191]
 ds_read_b64_tr_b16 a[148:149], v247 offset:32768
 ds_read_b64_tr_b16 a[150:151], v247 offset:34816
 v_mfma_f32_16x16x32_bf16 v[184:187], a[164:167], a[104:107], v[184:187]
 s_waitcnt lgkmcnt(6)
 v_lshlrev_b32 v224, 16, v58
 v_and_b32 v225, s97, v58
 v_mfma_f32_16x16x32_bf16 v[192:195], a[168:171], a[104:107], v[192:195]
 ds_read_b64_tr_b16 a[152:153], v246 offset:33280
 ds_read_b64_tr_b16 a[154:155], v246 offset:35328
 v_mfma_f32_16x16x32_bf16 v[196:199], a[168:171], a[108:111], v[196:199]
 s_waitcnt lgkmcnt(6)
 v_add_f32 v36, v36, v224
 v_add_f32 v37, v37, v225
 v_mfma_f32_16x16x32_bf16 v[204:207], a[172:175], a[108:111], v[204:207]
 ds_read_b64_tr_b16 a[156:157], v247 offset:33280
 ds_read_b64_tr_b16 a[158:159], v247 offset:35328
 v_mfma_f32_16x16x32_bf16 v[200:203], a[172:175], a[104:107], v[200:203]
 s_waitcnt lgkmcnt(6)
 v_lshlrev_b32 v226, 16, v59
 v_and_b32 v227, s97, v59
 v_mfma_f32_16x16x32_bf16 v[176:179], a[144:147], v[208:211], v[176:179]
 ds_read_b64_tr_b16 a[160:161], v246 offset:36864
 ds_read_b64_tr_b16 a[162:163], v246 offset:38912
 v_mfma_f32_16x16x32_bf16 v[180:183], a[144:147], v[212:215], v[180:183]
 s_waitcnt lgkmcnt(6)
 v_add_f32 v38, v38, v226
 v_add_f32 v39, v39, v227
 v_mfma_f32_16x16x32_bf16 v[188:191], a[148:151], v[212:215], v[188:191]
 ds_read_b64_tr_b16 a[164:165], v247 offset:36864
 ds_read_b64_tr_b16 a[166:167], v247 offset:38912
 v_mfma_f32_16x16x32_bf16 v[184:187], a[148:151], v[208:211], v[184:187]
 s_waitcnt lgkmcnt(6)
 v_lshlrev_b32 v224, 16, v60
 v_and_b32 v225, s97, v60
 v_mfma_f32_16x16x32_bf16 v[192:195], a[152:155], v[208:211], v[192:195]
 ds_read_b64_tr_b16 a[168:169], v246 offset:37376
 ds_read_b64_tr_b16 a[170:171], v246 offset:39424
 v_mfma_f32_16x16x32_bf16 v[196:199], a[152:155], v[212:215], v[196:199]
 s_waitcnt lgkmcnt(6)
 v_add_f32 v40, v40, v224
 v_add_f32 v41, v41, v225
 v_mfma_f32_16x16x32_bf16 v[204:207], a[156:159], v[212:215], v[204:207]
 ds_read_b64_tr_b16 a[172:173], v247 offset:37376
 ds_read_b64_tr_b16 a[174:175], v247 offset:39424
 v_mfma_f32_16x16x32_bf16 v[200:203], a[156:159], v[208:211], v[200:203]
 s_waitcnt lgkmcnt(6)
 v_lshlrev_b32 v226, 16, v61
 v_and_b32 v227, s97, v61
 v_mfma_f32_16x16x32_bf16 v[176:179], a[160:163], v[216:219], v[176:179]
 ds_read_b64_tr_b16 a[144:145], v246 offset:40960
 ds_read_b64_tr_b16 a[146:147], v246 offset:43008
 v_mfma_f32_16x16x32_bf16 v[180:183], a[160:163], v[220:223], v[180:183]
 s_waitcnt lgkmcnt(6)
 v_add_f32 v42, v42, v226
 v_add_f32 v43, v43, v227
 v_mfma_f32_16x16x32_bf16 v[188:191], a[164:167], v[220:223], v[188:191]
 ds_read_b64_tr_b16 a[148:149], v247 offset:40960
 ds_read_b64_tr_b16 a[150:151], v247 offset:43008
 v_mfma_f32_16x16x32_bf16 v[184:187], a[164:167], v[216:219], v[184:187]
 s_waitcnt lgkmcnt(6)
 v_lshlrev_b32 v224, 16, v62
 v_and_b32 v225, s97, v62
 v_mfma_f32_16x16x32_bf16 v[192:195], a[168:171], v[216:219], v[192:195]
 ds_read_b64_tr_b16 a[152:153], v246 offset:41472
 ds_read_b64_tr_b16 a[154:155], v246 offset:43520
 v_mfma_f32_16x16x32_bf16 v[196:199], a[168:171], v[220:223], v[196:199]
 s_waitcnt lgkmcnt(6)
 v_add_f32 v44, v44, v224
 v_add_f32 v45, v45, v225
 v_mfma_f32_16x16x32_bf16 v[204:207], a[172:175], v[220:223], v[204:207]
 ds_read_b64_tr_b16 a[156:157], v247 offset:41472
 ds_read_b64_tr_b16 a[158:159], v247 offset:43520
 v_mfma_f32_16x16x32_bf16 v[200:203], a[172:175], v[216:219], v[200:203]
 s_waitcnt lgkmcnt(6)
 v_lshlrev_b32 v226, 16, v63
 v_and_b32 v227, s97, v63
 v_mfma_f32_16x16x32_bf16 v[176:179], a[144:147], v[0:3], v[176:179]
 ds_read_b64_tr_b16 a[160:161], v246 offset:45056
 ds_read_b64_tr_b16 a[162:163], v246 offset:47104
 v_mfma_f32_16x16x32_bf16 v[180:183], a[144:147], v[4:7], v[180:183]
 s_waitcnt lgkmcnt(6)
 v_add_f32 v46, v46, v226
 v_add_f32 v47, v47, v227
 v_mfma_f32_16x16x32_bf16 v[188:191], a[148:151], v[4:7], v[188:191]
 s_sub_u32 s67, s61, 7
 ds_read_b64_tr_b16 a[164:165], v247 offset:45056
 ds_read_b64_tr_b16 a[166:167], v247 offset:47104
 v_mfma_f32_16x16x32_bf16 v[184:187], a[148:151], v[0:3], v[184:187]
 s_waitcnt lgkmcnt(6)
 s_and_b32 s67, s67, 7
 s_lshl_b32 s68, s67, 3
 v_mfma_f32_16x16x32_bf16 v[192:195], a[152:155], v[0:3], v[192:195]
 s_mul_i32 s67, s67, 147456
 ds_read_b64_tr_b16 a[168:169], v246 offset:45568
 ds_read_b64_tr_b16 a[170:171], v246 offset:47616
 v_mfma_f32_16x16x32_bf16 v[196:199], a[152:155], v[4:7], v[196:199]
 s_waitcnt lgkmcnt(6)
 s_add_u32 s67, s67, s73
 s_waitcnt vmcnt(1)
 v_mfma_f32_16x16x32_bf16 v[204:207], a[156:159], v[4:7], v[204:207]
 ds_read_b64_tr_b16 a[172:173], v247 offset:45568
 ds_read_b64_tr_b16 a[174:175], v247 offset:47616
 v_mfma_f32_16x16x32_bf16 v[200:203], a[156:159], v[0:3], v[200:203]
 s_waitcnt lgkmcnt(6)
 v_readfirstlane_b32 s26, v102
 v_readfirstlane_b32 s27, v103
 v_mfma_f32_16x16x32_bf16 v[176:179], a[160:163], v[8:11], v[176:179]
 v_mfma_f32_16x16x32_bf16 v[180:183], a[160:163], v[12:15], v[180:183]
 s_waitcnt lgkmcnt(4)
 s_lshr_b64 s[26:27], s[26:27], s68
 s_and_b32 s26, s26, 0xff
 s_cbranch_scc0 L_chk6
L_chk6_ok:
 v_mfma_f32_16x16x32_bf16 v[188:191], a[164:167], v[12:15], v[188:191]
 v_mfma_f32_16x16x32_bf16 v[184:187], a[164:167], v[8:11], v[184:187]
 s_waitcnt lgkmcnt(2)
 buffer_load_dwordx4 v[48:51], v250, s[56:59], s67 offen offset:0 sc1
 v_mfma_f32_16x16x32_bf16 v[192:195], a[168:171], v[8:11], v[192:195]
 v_mfma_f32_16x16x32_bf16 v[196:199], a[168:171], v[12:15], v[196:199]
 s_waitcnt lgkmcnt(0)
 buffer_load_dwordx4 v[52:55], v250, s[56:59], s67 offen offset:1024 sc1
 v_mfma_f32_16x16x32_bf16 v[204:207], a[172:175], v[12:15], v[204:207]
 v_mfma_f32_16x16x32_bf16 v[200:203], a[172:175], v[8:11], v[200:203]
 buffer_load_dwordx4 v[56:59], v250, s[56:59], s67 offen offset:2048 sc1
 buffer_load_dwordx4 v[60:63], v250, s[56:59], s67 offen offset:3072 sc1
 s_waitcnt vmcnt(4)
 v_readfirstlane_b32 s68, v105
 s_mul_i32 s69, s61, 147456
 s_add_u32 s69, s69, s73
 s_cmp_eq_u32 s68, 2
 s_cselect_b32 s67, s69, 67108864
 buffer_load_dwordx4 v[112:115], v250, s[56:59], s67 offen offset:0 sc1
 buffer_load_dwordx4 v[116:119], v250, s[56:59], s67 offen offset:1024 sc1
 buffer_load_dwordx4 v[120:123], v250, s[56:59], s67 offen offset:2048 sc1
 buffer_load_dwordx4 v[124:127], v250, s[56:59], s67 offen offset:3072 sc1
 buffer_load_ubyte v105, off, s[56:59], s74 offset:32 sc1
 v_dot2_f32_bf16 v16, v64, s76, v16
 v_dot2_f32_bf16 v17, v64, s77, v17
 v_dot2_f32_bf16 v18, v65, s76, v18
 v_dot2_f32_bf16 v19, v65, s77, v19
 v_dot2_f32_bf16 v20, v66, s76, v20
 v_dot2_f32_bf16 v21, v66, s77, v21
 v_dot2_f32_bf16 v22, v67, s76, v22
 v_dot2_f32_bf16 v23, v67, s77, v23
 v_dot2_f32_bf16 v24, v68, s76, v24
 v_dot2_f32_bf16 v25, v68, s77, v25
 v_dot2_f32_bf16 v26, v69, s76, v26
 v_dot2_f32_bf16 v27, v69, s77, v27
 v_dot2_f32_bf16 v28, v70, s76, v28
 v_dot2_f32_bf16 v29, v70, s77, v29
 v_dot2_f32_bf16 v30, v71, s76, v30
 v_dot2_f32_bf16 v31, v71, s77, v31
 v_dot2_f32_bf16 v32, v72, s76, v32
 v_dot2_f32_bf16 v33, v72, s77, v33
 v_dot2_f32_bf16 v34, v73, s76, v34
 v_dot2_f32_bf16 v35, v73, s77, v35
 v_dot2_f32_bf16 v36, v74, s76, v36
 v_dot2_f32_bf16 v37, v74, s77, v37
 v_dot2_f32_bf16 v38, v75, s76, v38
 v_dot2_f32_bf16 v39, v75, s77, v39
 v_dot2_f32_bf16 v40, v76, s76, v40
 v_dot2_f32_bf16 v41, v76, s77, v41
 v_dot2_f32_bf16 v42, v77, s76, v42
 v_dot2_f32_bf16 v43, v77, s77, v43
 v_dot2_f32_bf16 v44, v78, s76, v44
 v_dot2_f32_bf16 v45, v78, s77, v45
 v_dot2_f32_bf16 v46, v79, s76, v46
 v_dot2_f32_bf16 v47, v79, s77, v47
 v_pk_add_f32 v[176:177], v[176:177], v[16:17]
 v_pk_add_f32 v[178:179], v[178:179], v[18:19]
 v_pk_add_f32 v[180:181], v[180:181], v[20:21]
 v_pk_add_f32 v[182:183], v[182:183], v[22:23]
 v_pk_add_f32 v[184:185], v[184:185], v[24:25]
 v_pk_add_f32 v[186:187], v[186:187], v[26:27]
 v_pk_add_f32 v[188:189], v[188:189], v[28:29]
 v_pk_add_f32 v[190:191], v[190:191], v[30:31]
 v_pk_add_f32 v[192:193], v[192:193], v[32:33]
 v_pk_add_f32 v[194:195], v[194:195], v[34:35]
 v_pk_add_f32 v[196:197], v[196:197], v[36:37]
 v_pk_add_f32 v[198:199], v[198:199], v[38:39]
 v_pk_add_f32 v[200:201], v[200:201], v[40:41]
 v_pk_add_f32 v[202:203], v[202:203], v[42:43]
 v_pk_add_f32 v[204:205], v[204:205], v[44:45]
 v_pk_add_f32 v[206:207], v[206:207], v[46:47]
 s_waitcnt vmcnt(5)
 v_dot2_f32_bf16 v176, v48, s76, v176
 v_dot2_f32_bf16 v177, v48, s77, v177
 v_dot2_f32_bf16 v178, v49, s76, v178
 v_dot2_f32_bf16 v179, v49, s77, v179
 v_dot2_f32_bf16 v180, v50, s76, v180
 v_dot2_f32_bf16 v181, v50, s77, v181
 v_dot2_f32_bf16 v182, v51, s76, v182
 v_dot2_f32_bf16 v183, v51, s77, v183
 v_dot2_f32_bf16 v184, v52, s76, v184
 v_dot2_f32_bf16 v185, v52, s77, v185
 v_dot2_f32_bf16 v186, v53, s76, v186
 v_dot2_f32_bf16 v187, v53, s77, v187
 v_dot2_f32_bf16 v188, v54, s76, v188
 v_dot2_f32_bf16 v189, v54, s77, v189
 v_dot2_f32_bf16 v190, v55, s76, v190
 v_dot2_f32_bf16 v191, v55, s77, v191
 v_dot2_f32_bf16 v192, v56, s76, v192
 v_dot2_f32_bf16 v193, v56, s77, v193
 v_dot2_f32_bf16 v194, v57, s76, v194
 v_dot2_f32_bf16 v195, v57, s77, v195
 v_dot2_f32_bf16 v196, v58, s76, v196
 v_dot2_f32_bf16 v197, v58, s77, v197
 v_dot2_f32_bf16 v198, v59, s76, v198
 v_dot2_f32_bf16 v199, v59, s77, v199
 v_dot2_f32_bf16 v200, v60, s76, v200
 v_dot2_f32_bf16 v201, v60, s77, v201
 v_dot2_f32_bf16 v202, v61, s76, v202
 v_dot2_f32_bf16 v203, v61, s77, v203
 v_dot2_f32_bf16 v204, v62, s76, v204
 v_dot2_f32_bf16 v205, v62, s77, v205
 v_dot2_f32_bf16 v206, v63, s76, v206
 v_dot2_f32_bf16 v207, v63, s77, v207
 s_mov_b32 s79, 0
 s_cmp_eq_u32 s68, 2
 s_cbranch_scc1 L_z_chk
 s_waitcnt vmcnt(0)
 v_cmp_eq_u32 vcc, 2, v105
 s_cbranch_vccnz L_pz_done
 s_mov_b32 s79, 0
L_pz_spin:
 buffer_load_ubyte v105, off, s[56:59], s74 offset:32 sc1
 s_waitcnt vmcnt(0)
 v_cmp_eq_u32 vcc, 2, v105
 s_cbranch_vccnz L_pz_done
 s_sleep 2
 s_add_u32 s79, s79, 1
 s_cmp_lt_u32 s79, 0x80000
 s_cbranch_scc1 L_pz_spin
L_pz_done:
 s_mov_b32 s79, 0
L_z_spin:
 buffer_load_dwordx4 v[112:115], v250, s[56:59], s69 offen offset:0 sc1
 buffer_load_dwordx4 v[116:119], v250, s[56:59], s69 offen offset:1024 sc1
 buffer_load_dwordx4 v[120:123], v250, s[56:59], s69 offen offset:2048 sc1
 buffer_load_dwordx4 v[124:127], v250, s[56:59], s69 offen offset:3072 sc1
L_z_chk:
 s_waitcnt vmcnt(0)
 v_max3_u32 v224, v112, v113, v114
 v_max3_u32 v224, v224, v115, v116
 v_max3_u32 v224, v224, v117, v118
 v_max3_u32 v224, v224, v119, v120
 v_max3_u32 v224, v224, v121, v122
 v_max3_u32 v224, v224, v123, v124
 v_max3_u32 v224, v224, v125, v126
 v_max_u32 v224, v224, v127
 v_cmp_eq_u32 vcc, -1, v224
 s_cbranch_vccz L_z_done
 s_add_u32 s79, s79, 1
 s_cmp_lt_u32 s79, 0x80000
 s_cbranch_scc1 L_z_spin
L_z_done:
 s_add_u32 s69, s72, 18432
 v_dot2_f32_bf16 v176, v112, s76, v176
 v_dot2_f32_bf16 v177, v112, s77, v177
 v_dot2_f32_bf16 v178, v113, s76, v178
 v_dot2_f32_bf16 v179, v113, s77, v179
 v_dot2_f32_bf16 v180, v114, s76, v180
 v_dot2_f32_bf16 v181, v114, s77, v181
 v_dot2_f32_bf16 v182, v115, s76, v182
 v_dot2_f32_bf16 v183, v115, s77, v183
 v_dot2_f32_bf16 v184, v116, s76, v184
 v_dot2_f32_bf16 v185, v116, s77, v185
 v_dot2_f32_bf16 v186, v117, s76, v186
 v_dot2_f32_bf16 v187, v117, s77, v187
 v_dot2_f32_bf16 v188, v118, s76, v188
 v_dot2_f32_bf16 v189, v118, s77, v189
 v_dot2_f32_bf16 v190, v119, s76, v190
 v_dot2_f32_bf16 v191, v119, s77, v191
 v_cvt_pk_bf16_f32 v0, v176, v177
 v_cvt_pk_bf16_f32 v1, v178, v179
 v_cvt_pk_bf16_f32 v2, v184, v185
 v_cvt_pk_bf16_f32 v3, v186, v187
 v_cvt_pk_bf16_f32 v4, v180, v181
 v_cvt_pk_bf16_f32 v5, v182, v183
 v_cvt_pk_bf16_f32 v6, v188, v189
 v_cvt_pk_bf16_f32 v7, v190, v191
 v_permlane16_swap_b32 v0, v2
 v_permlane16_swap_b32 v1, v3
 v_permlane16_swap_b32 v4, v6
 v_permlane16_swap_b32 v5, v7
 buffer_store_dwordx4 v[0:3], v100, s[48:51], s72 offen offset:0
 buffer_store_dwordx4 v[4:7], v100, s[48:51], s69 offen offset:0
 v_dot2_f32_bf16 v192, v120, s76, v192
 v_dot2_f32_bf16 v193, v120, s77, v193
 v_dot2_f32_bf16 v194, v121, s76, v194
 v_dot2_f32_bf16 v195, v121, s77, v195
 v_dot2_f32_bf16 v196, v122, s76, v196
 v_dot2_f32_bf16 v197, v122, s77, v197
 v_dot2_f32_bf16 v198, v123, s76, v198
 v_dot2_f32_bf16 v199, v123, s77, v199
 v_dot2_f32_bf16 v200, v124, s76, v200
 v_dot2_f32_bf16 v201, v124, s77, v201
 v_dot2_f32_bf16 v202, v125, s76, v202
 v_dot2_f32_bf16 v203, v125, s77, v203
 v_dot2_f32_bf16 v204, v126, s76, v204
 v_dot2_f32_bf16 v205, v126, s77, v205
 v_dot2_f32_bf16 v206, v127, s76, v206
 v_dot2_f32_bf16 v207, v127, s77, v207
 v_cvt_pk_bf16_f32 v8, v192, v193
 v_cvt_pk_bf16_f32 v9, v194, v195
 v_cvt_pk_bf16_f32 v10, v200, v201
 v_cvt_pk_bf16_f32 v11, v202, v203
 v_cvt_pk_bf16_f32 v12, v196, v197
 v_cvt_pk_bf16_f32 v13, v198, v199
 v_cvt_pk_bf16_f32 v14, v204, v205
 v_cvt_pk_bf16_f32 v15, v206, v207
 v_permlane16_swap_b32 v8, v10
 v_permlane16_swap_b32 v9, v11
 v_permlane16_swap_b32 v12, v14
 v_permlane16_swap_b32 v13, v15
 buffer_store_dwordx4 v[8:11], v100, s[48:51], s72 offen offset:64
 buffer_store_dwordx4 v[12:15], v100, s[48:51], s69 offen offset:64
L_ffn_end:
 s_endpgm
L_chk0:
 s_mov_b32 s79, 0
L_chk0_spin:
 buffer_load_dwordx2 v[102:103], v98, s[56:59], 0 offen sc1
 s_waitcnt vmcnt(0)
 v_readfirstlane_b32 s26, v102
 v_readfirstlane_b32 s27, v103
 s_nop 0
 s_lshr_b64 s[26:27], s[26:27], s68
 s_and_b32 s26, s26, 0xff
 s_cbranch_scc1 L_chk0_ok
 s_sleep 1
 s_add_u32 s79, s79, 1
 s_cmp_lt_u32 s79, 0x80000
 s_cbranch_scc1 L_chk0_spin
 s_branch L_chk0_ok
L_chk1:
 s_mov_b32 s79, 0
L_chk1_spin:
 buffer_load_dwordx2 v[102:103], v98, s[56:59], 0 offen sc1
 s_waitcnt vmcnt(0)
 v_readfirstlane_b32 s26, v102
 v_readfirstlane_b32 s27, v103
 s_nop 0
 s_lshr_b64 s[26:27], s[26:27], s68
 s_and_b32 s26, s26, 0xff
 s_cbranch_scc1 L_chk1_ok
 s_sleep 1
 s_add_u32 s79, s79, 1
 s_cmp_lt_u32 s79, 0x80000
 s_cbranch_scc1 L_chk1_spin
 s_branch L_chk1_ok
L_chk2:
 s_mov_b32 s79, 0
L_chk2_spin:
 buffer_load_dwordx2 v[102:103], v98, s[56:59], 0 offen sc1
 s_waitcnt vmcnt(0)
 v_readfirstlane_b32 s26, v102
 v_readfirstlane_b32 s27, v103
 s_nop 0
 s_lshr_b64 s[26:27], s[26:27], s68
 s_and_b32 s26, s26, 0xff
 s_cbranch_scc1 L_chk2_ok
 s_sleep 1
 s_add_u32 s79, s79, 1
 s_cmp_lt_u32 s79, 0x80000
 s_cbranch_scc1 L_chk2_spin
 s_branch L_chk2_ok
L_chk3:
 s_mov_b32 s79, 0
L_chk3_spin:
 buffer_load_dwordx2 v[102:103], v98, s[56:59], 0 offen sc1
 s_waitcnt vmcnt(0)
 v_readfirstlane_b32 s26, v102
 v_readfirstlane_b32 s27, v103
 s_nop 0
 s_lshr_b64 s[26:27], s[26:27], s68
 s_and_b32 s26, s26, 0xff
 s_cbranch_scc1 L_chk3_ok
 s_sleep 1
 s_add_u32 s79, s79, 1
 s_cmp_lt_u32 s79, 0x80000
 s_cbranch_scc1 L_chk3_spin
 s_branch L_chk3_ok
L_chk4:
 s_mov_b32 s79, 0
L_chk4_spin:
 buffer_load_dwordx2 v[102:103], v98, s[56:59], 0 offen sc1
 s_waitcnt vmcnt(0)
 v_readfirstlane_b32 s26, v102
 v_readfirstlane_b32 s27, v103
 s_nop 0
 s_lshr_b64 s[26:27], s[26:27], s68
 s_and_b32 s26, s26, 0xff
 s_cbranch_scc1 L_chk4_ok
 s_sleep 1
 s_add_u32 s79, s79, 1
 s_cmp_lt_u32 s79, 0x80000
 s_cbranch_scc1 L_chk4_spin
 s_branch L_chk4_ok
L_chk5:
 s_mov_b32 s79, 0
L_chk5_spin:
 buffer_load_dwordx2 v[102:103], v98, s[56:59], 0 offen sc1
 s_waitcnt vmcnt(0)
 v_readfirstlane_b32 s26, v102
 v_readfirstlane_b32 s27, v103
 s_nop 0
 s_lshr_b64 s[26:27], s[26:27], s68
 s_and_b32 s26, s26, 0xff
 s_cbranch_scc1 L_chk5_ok
 s_sleep 1
 s_add_u32 s79, s79, 1
 s_cmp_lt_u32 s79, 0x80000
 s_cbranch_scc1 L_chk5_spin
 s_branch L_chk5_ok
L_chk6:
 s_mov_b32 s79, 0
L_chk6_spin:
 buffer_load_dwordx2 v[102:103], v98, s[56:59], 0 offen sc1
 s_waitcnt vmcnt(0)
 v_readfirstlane_b32 s26, v102
 v_readfirstlane_b32 s27, v103
 s_nop 0
 s_lshr_b64 s[26:27], s[26:27], s68
 s_and_b32 s26, s26, 0xff
 s_cbranch_scc1 L_chk6_ok
 s_sleep 1
 s_add_u32 s79, s79, 1
 s_cmp_lt_u32 s79, 0x80000
 s_cbranch_scc1 L_chk6_spin
 s_branch L_chk6_ok
L_hsl1:
 buffer_load_ubyte a247, off, s[52:55], s14 sc1
 s_branch L_hsl1_ok
L_hsl2:
 buffer_load_ubyte a247, off, s[52:55], s14 sc1
 s_branch L_hsl2_ok
L_hsl3:
 buffer_load_ubyte a247, off, s[52:55], s14 sc1
 s_branch L_hsl3_ok
L_hsl4:
 buffer_load_ubyte a247, off, s[52:55], s14 sc1
 s_branch L_hsl4_ok
L_hsl5:
 buffer_load_ubyte a247, off, s[52:55], s14 sc1
 s_branch L_hsl5_ok
L_hsl6:
 buffer_load_ubyte a247, off, s[52:55], s14 sc1
 s_branch L_hsl6_ok
L_hsl7:
 buffer_load_ubyte a247, off, s[52:55], s14 sc1
 s_branch L_hsl7_ok
L_hsl8:
 buffer_load_ubyte a247, off, s[52:55], s14 sc1
 s_branch L_hsl8_ok
L_hs_sub:
 s_mov_b32 s79, 0
L_hs_spin:
 v_accvgpr_read_b32 v235, a247
 s_nop 0
 v_readfirstlane_b32 s67, v235
 s_nop 0
 s_cmp_eq_u32 s67, 1
 s_cbranch_scc1 L_hs_ret
 buffer_load_ubyte a247, off, s[52:55], s14 sc1
 s_waitcnt vmcnt(0)
 s_sleep 1
 s_add_u32 s79, s79, 1
 s_cmp_lt_u32 s79, 0x80000
 s_cbranch_scc1 L_hs_spin
L_hs_ret:
 s_cmp_eq_u32 s15, 0
 s_cbranch_scc1 L_hsc3_ok
 s_cmp_eq_u32 s15, 1
 s_cbranch_scc1 L_hsc4_ok
 s_cmp_eq_u32 s15, 2
 s_cbranch_scc1 L_hsc5_ok
 s_cmp_eq_u32 s15, 3
 s_cbranch_scc1 L_hsc6_ok
 s_cmp_eq_u32 s15, 4
 s_cbranch_scc1 L_hsc7_ok
 s_cmp_eq_u32 s15, 5
 s_cbranch_scc1 L_hsc8_ok
 s_cmp_eq_u32 s15, 6
 s_cbranch_scc1 L_hsc9_ok
 s_branch L_hsc10_ok
L_hsc3:
L_hsc4:
L_hsc5:
L_hsc6:
L_hsc7:
L_hsc8:
L_hsc9:
L_hsc10:
 s_branch L_hs_sub
L_att:
 s_add_u32 m0, s79, 8192
 s_add_u32 s65, s66, 256
 buffer_load_dwordx4 v144, s[28:31], s65 offen lds
 s_lshl_b32 s14, s60, 3
 s_add_u32 s14, s14, s61
 s_lshr_b32 s14, s14, 1
 s_lshl_b32 s14, s14, 7
 s_add_u32 s14, s14, 167936
 buffer_load_dword a204, off, s[56:59], s14 sc1
 s_mul_i32 s67, s61, 144
 s_and_b32 s69, s67, 63
 s_and_b32 s67, s67, 0xffc0
 s_add_u32 s32, s6, s67
 s_addc_u32 s33, s7, 0
 s_mov_b32 s34, 663552
 s_mov_b32 s35, 0x20000
 s_add_u32 m0, s79, 9216
 s_add_u32 s65, s66, 9472
 buffer_load_dwordx4 v145, s[28:31], s65 offen lds
 s_sub_u32 s34, s34, s67
 s_mul_i32 s67, s61, 1152
 s_add_u32 s44, s16, s67
 s_addc_u32 s45, s17, 0
 s_mov_b32 s46, 5308416
 s_mov_b32 s47, 0x20000
 s_sub_u32 s46, s46, s67
 v_lshrrev_b32 v156, 2, v255
 v_lshl_add_u32 v156, s63, 4, v156
 v_mul_u32_u24 v156, 1152, v156
 v_lshrrev_b32 v157, 5, v255
 v_lshlrev_b32 v158, 1, v157
 v_xor_b32 v158, v158, v255
 s_add_u32 m0, s79, 10240
 s_add_u32 s65, s66, 18688
 buffer_load_dwordx4 v144, s[28:31], s65 offen lds
 v_and_b32 v158, 3, v158
 v_lshl_add_u32 v168, v158, 4, v156
 v_mul_u32_u24 v156, 3072, v157
 v_bfe_u32 v157, v255, 2, 2
 v_lshl_add_u32 v156, v157, 6, v156
 v_bfe_u32 v157, v255, 4, 1
 v_lshl_add_u32 v156, v157, 9, v156
 v_lshlrev_b32 v157, 5, v157
 v_add_u32 v156, 53248, v156
 s_mul_i32 s68, s63, 3072
 s_add_u32 s68, s68, 53248
 v_and_b32 v158, 3, v255
 v_lshl_add_u32 v158, v158, 3, s69
 s_add_u32 m0, s79, 11264
 s_add_u32 s65, s66, 27904
 buffer_load_dwordx4 v145, s[28:31], s65 offen lds
 v_add_u32 v158, 0, v158
 v_lshrrev_b32 v159, 6, v158
 v_lshl_add_u32 v159, v159, 10, v156
 v_and_b32 v158, 63, v158
 v_xor_b32 v158, v158, v157
 v_add_u32 v248, v158, v159
 v_and_b32 v158, 3, v255
 v_lshl_add_u32 v158, v158, 3, s69
 v_add_u32 v158, 32, v158
 v_lshrrev_b32 v159, 6, v158
 v_lshl_add_u32 v159, v159, 10, v156
 v_and_b32 v158, 63, v158
 s_add_u32 m0, s79, 12288
 s_add_u32 s65, s66, 384
 buffer_load_dwordx4 v144, s[28:31], s65 offen lds
 v_xor_b32 v158, v158, v157
 v_add_u32 v249, v158, v159
 v_and_b32 v158, 3, v255
 v_lshl_add_u32 v158, v158, 3, s69
 v_add_u32 v158, 64, v158
 v_lshrrev_b32 v159, 6, v158
 v_lshl_add_u32 v159, v159, 10, v156
 v_and_b32 v158, 63, v158
 v_xor_b32 v158, v158, v157
 v_add_u32 v250, v158, v159
 v_and_b32 v158, 3, v255
 v_lshl_add_u32 v158, v158, 3, s69
 v_add_u32 v158, 96, v158
 s_add_u32 m0, s79, 13312
 s_add_u32 s65, s66, 9600
 buffer_load_dwordx4 v145, s[28:31], s65 offen lds
 v_lshrrev_b32 v159, 6, v158
 v_lshl_add_u32 v159, v159, 10, v156
 v_and_b32 v158, 63, v158
 v_xor_b32 v158, v158, v157
 v_add_u32 v251, v158, v159
 v_and_b32 v158, 1, v255
 v_lshl_add_u32 v158, v158, 3, s69
 v_add_u32 v158, 128, v158
 v_lshrrev_b32 v159, 6, v158
 v_lshl_add_u32 v159, v159, 10, v156
 v_and_b32 v158, 63, v158
 v_xor_b32 v158, v158, v157
 v_add_u32 v252, v158, v159
 s_add_u32 m0, s79, 14336
 s_add_u32 s65, s66, 18816
 buffer_load_dwordx4 v144, s[28:31], s65 offen lds
 s_mov_b32 s73, s68
 s_and_b32 s67, s60, 3
 s_lshl_b32 s67, s67, 2
 s_add_u32 s67, s67, s63
 s_mul_i32 s67, s67, 36
 v_add_u32 v254, s67, v255
 v_mov_b32 v157, 100000
 v_cmp_gt_u32 vcc, 36, v255
 s_nop 1
 v_cndmask_b32 v254, v157, v254, vcc
 s_and_b32 s67, s60, 3
 s_mul_i32 s67, s67, 9
 s_lshr_b32 s67, s67, 2
 s_mul_i32 s89, s67, 12288
 s_add_u32 m0, s79, 15360
 s_add_u32 s65, s66, 28032
 buffer_load_dwordx4 v145, s[28:31], s65 offen lds
 s_add_u32 s89, s89, s73
 s_mul_i32 s90, s67, 73728
 v_lshrrev_b32 v157, 4, v255
 v_lshrrev_b32 v160, 5, v255
 v_xor_b32 v160, v157, v160
 v_lshlrev_b32 v160, 4, v160
 v_xor_b32 v160, v146, v160
 v_and_b32 v157, 1, v157
 v_lshl_add_u32 v160, v157, 3, v160
 s_and_b32 s67, s61, 3
 s_lshl_b32 s67, s67, 5
 v_xor_b32 v160, s67, v160
 s_waitcnt vmcnt(12)
 s_add_u32 m0, s79, 16384
 s_add_u32 s65, s66, 512
 buffer_load_dwordx4 v144, s[28:31], s65 offen lds
 s_add_u32 m0, s79, 17408
 s_add_u32 s65, s66, 9728
 buffer_load_dwordx4 v145, s[28:31], s65 offen lds
 s_add_u32 m0, s79, 18432
 s_add_u32 s65, s66, 18944
 buffer_load_dwordx4 v144, s[28:31], s65 offen lds
 s_add_u32 m0, s79, 19456
 s_add_u32 s65, s66, 28160
 buffer_load_dwordx4 v145, s[28:31], s65 offen lds
 ds_read_b128 v[0:3], v146 offset:0
 ds_read_b128 v[4:7], v146 offset:2048
 ds_read_b128 v[8:11], v147 offset:0
 ds_read_b128 v[12:15], v147 offset:2048
 s_waitcnt vmcnt(12)
 s_add_u32 m0, s79, 20480
 s_add_u32 s65, s66, 640
 buffer_load_dwordx4 v144, s[28:31], s65 offen lds
 s_add_u32 m0, s79, 21504
 s_add_u32 s65, s66, 9856
 buffer_load_dwordx4 v145, s[28:31], s65 offen lds
 s_add_u32 m0, s79, 22528
 s_add_u32 s65, s66, 19072
 buffer_load_dwordx4 v144, s[28:31], s65 offen lds
 s_add_u32 m0, s79, 23552
 s_add_u32 s65, s66, 28288
 buffer_load_dwordx4 v145, s[28:31], s65 offen lds
 ds_read_b128 v[16:19], v146 offset:4096
 ds_read_b128 v[20:23], v146 offset:6144
 ds_read_b128 v[24:27], v147 offset:4096
 ds_read_b128 v[28:31], v147 offset:6144
 s_waitcnt lgkmcnt(4)
 v_dot2_f32_bf16 v152, v0, s78, 0
 v_dot2_f32_bf16 v154, v0, v0, 0
 v_dot2_f32_bf16 v153, v4, s78, 0
 v_dot2_f32_bf16 v155, v4, v4, 0
 v_dot2_f32_bf16 v152, v1, s78, v152
 v_dot2_f32_bf16 v154, v1, v1, v154
 v_dot2_f32_bf16 v153, v5, s78, v153
 v_dot2_f32_bf16 v155, v5, v5, v155
 v_dot2_f32_bf16 v152, v2, s78, v152
 v_dot2_f32_bf16 v154, v2, v2, v154
 v_dot2_f32_bf16 v153, v6, s78, v153
 v_dot2_f32_bf16 v155, v6, v6, v155
 v_dot2_f32_bf16 v152, v3, s78, v152
 v_dot2_f32_bf16 v154, v3, v3, v154
 v_dot2_f32_bf16 v153, v7, s78, v153
 v_dot2_f32_bf16 v155, v7, v7, v155
 v_dot2_f32_bf16 v152, v8, s78, v152
 v_dot2_f32_bf16 v154, v8, v8, v154
 v_dot2_f32_bf16 v153, v12, s78, v153
 v_dot2_f32_bf16 v155, v12, v12, v155
 v_dot2_f32_bf16 v152, v9, s78, v152
 v_dot2_f32_bf16 v154, v9, v9, v154
 v_dot2_f32_bf16 v153, v13, s78, v153
 v_dot2_f32_bf16 v155, v13, v13, v155
 v_dot2_f32_bf16 v152, v10, s78, v152
 v_dot2_f32_bf16 v154, v10, v10, v154
 v_dot2_f32_bf16 v153, v14, s78, v153
 v_dot2_f32_bf16 v155, v14, v14, v155
 v_dot2_f32_bf16 v152, v11, s78, v152
 v_dot2_f32_bf16 v154, v11, v11, v154
 v_dot2_f32_bf16 v153, v15, s78, v153
 v_dot2_f32_bf16 v155, v15, v15, v155
 s_waitcnt vmcnt(12)
 s_add_u32 m0, s79, 24576
 s_add_u32 s65, s66, 768
 buffer_load_dwordx4 v144, s[28:31], s65 offen lds
 s_add_u32 m0, s79, 25600
 s_add_u32 s65, s66, 9984
 buffer_load_dwordx4 v145, s[28:31], s65 offen lds
 s_add_u32 m0, s79, 26624
 s_add_u32 s65, s66, 19200
 buffer_load_dwordx4 v144, s[28:31], s65 offen lds
 s_add_u32 m0, s79, 27648
 s_add_u32 s65, s66, 28416
 buffer_load_dwordx4 v145, s[28:31], s65 offen lds
 ds_read_b128 v[32:35], v146 offset:8192
 ds_read_b128 v[36:39], v146 offset:10240
 ds_read_b128 v[40:43], v147 offset:8192
 ds_read_b128 v[44:47], v147 offset:10240
 s_waitcnt lgkmcnt(4)
 v_dot2_f32_bf16 v152, v16, s78, v152
 v_dot2_f32_bf16 v154, v16, v16, v154
 v_dot2_f32_bf16 v153, v20, s78, v153
 v_dot2_f32_bf16 v155, v20, v20, v155
 v_dot2_f32_bf16 v152, v17, s78, v152
 v_dot2_f32_bf16 v154, v17, v17, v154
 v_dot2_f32_bf16 v153, v21, s78, v153
 v_dot2_f32_bf16 v155, v21, v21, v155
 v_dot2_f32_bf16 v152, v18, s78, v152
 v_dot2_f32_bf16 v154, v18, v18, v154
 v_dot2_f32_bf16 v153, v22, s78, v153
 v_dot2_f32_bf16 v155, v22, v22, v155
 v_dot2_f32_bf16 v152, v19, s78, v152
 v_dot2_f32_bf16 v154, v19, v19, v154
 v_dot2_f32_bf16 v153, v23, s78, v153
 v_dot2_f32_bf16 v155, v23, v23, v155
 v_dot2_f32_bf16 v152, v24, s78, v152
 v_dot2_f32_bf16 v154, v24, v24, v154
 v_dot2_f32_bf16 v153, v28, s78, v153
 v_dot2_f32_bf16 v155, v28, v28, v155
 v_dot2_f32_bf16 v152, v25, s78, v152
 v_dot2_f32_bf16 v154, v25, v25, v154
 v_dot2_f32_bf16 v153, v29, s78, v153
 v_dot2_f32_bf16 v155, v29, v29, v155
 v_dot2_f32_bf16 v152, v26, s78, v152
 v_dot2_f32_bf16 v154, v26, v26, v154
 v_dot2_f32_bf16 v153, v30, s78, v153
 v_dot2_f32_bf16 v155, v30, v30, v155
 v_dot2_f32_bf16 v152, v27, s78, v152
 v_dot2_f32_bf16 v154, v27, v27, v154
 v_dot2_f32_bf16 v153, v31, s78, v153
 v_dot2_f32_bf16 v155, v31, v31, v155
 s_waitcnt vmcnt(12)
 s_add_u32 m0, s79, 28672
 s_add_u32 s65, s66, 896
 buffer_load_dwordx4 v144, s[28:31], s65 offen lds
 s_add_u32 m0, s79, 29696
 s_add_u32 s65, s66, 10112
 buffer_load_dwordx4 v145, s[28:31], s65 offen lds
 s_add_u32 m0, s79, 30720
 s_add_u32 s65, s66, 19328
 buffer_load_dwordx4 v144, s[28:31], s65 offen lds
 s_add_u32 m0, s79, 31744
 s_add_u32 s65, s66, 28544
 buffer_load_dwordx4 v145, s[28:31], s65 offen lds
 ds_read_b128 v[48:51], v146 offset:12288
 ds_read_b128 v[52:55], v146 offset:14336
 ds_read_b128 v[56:59], v147 offset:12288
 ds_read_b128 v[60:63], v147 offset:14336
 s_waitcnt lgkmcnt(4)
 v_dot2_f32_bf16 v152, v32, s78, v152
 v_dot2_f32_bf16 v154, v32, v32, v154
 v_dot2_f32_bf16 v153, v36, s78, v153
 v_dot2_f32_bf16 v155, v36, v36, v155
 v_dot2_f32_bf16 v152, v33, s78, v152
 v_dot2_f32_bf16 v154, v33, v33, v154
 v_dot2_f32_bf16 v153, v37, s78, v153
 v_dot2_f32_bf16 v155, v37, v37, v155
 v_dot2_f32_bf16 v152, v34, s78, v152
 v_dot2_f32_bf16 v154, v34, v34, v154
 v_dot2_f32_bf16 v153, v38, s78, v153
 v_dot2_f32_bf16 v155, v38, v38, v155
 v_dot2_f32_bf16 v152, v35, s78, v152
 v_dot2_f32_bf16 v154, v35, v35, v154
 v_dot2_f32_bf16 v153, v39, s78, v153
 v_dot2_f32_bf16 v155, v39, v39, v155
 v_dot2_f32_bf16 v152, v40, s78, v152
 v_dot2_f32_bf16 v154, v40, v40, v154
 v_dot2_f32_bf16 v153, v44, s78, v153
 v_dot2_f32_bf16 v155, v44, v44, v155
 v_dot2_f32_bf16 v152, v41, s78, v152
 v_dot2_f32_bf16 v154, v41, v41, v154
 v_dot2_f32_bf16 v153, v45, s78, v153
 v_dot2_f32_bf16 v155, v45, v45, v155
 v_dot2_f32_bf16 v152, v42, s78, v152
 v_dot2_f32_bf16 v154, v42, v42, v154
 v_dot2_f32_bf16 v153, v46, s78, v153
 v_dot2_f32_bf16 v155, v46, v46, v155
 v_dot2_f32_bf16 v152, v43, s78, v152
 v_dot2_f32_bf16 v154, v43, v43, v154
 v_dot2_f32_bf16 v153, v47, s78, v153
 v_dot2_f32_bf16 v155, v47, v47, v155
 s_waitcnt vmcnt(12)
 s_add_u32 m0, s79, 32768
 s_add_u32 s65, s66, 1024
 buffer_load_dwordx4 v144, s[28:31], s65 offen lds
 s_add_u32 m0, s79, 33792
 s_add_u32 s65, s66, 10240
 buffer_load_dwordx4 v145, s[28:31], s65 offen lds
 s_add_u32 m0, s79, 34816
 s_add_u32 s65, s66, 19456
 buffer_load_dwordx4 v144, s[28:31], s65 offen lds
 s_add_u32 m0, s79, 35840
 s_add_u32 s65, s66, 28672
 buffer_load_dwordx4 v145, s[28:31], s65 offen lds
 ds_read_b128 v[64:67], v146 offset:16384
 ds_read_b128 v[68:71], v146 offset:18432
 ds_read_b128 v[72:75], v147 offset:16384
 ds_read_b128 v[76:79], v147 offset:18432
 s_waitcnt lgkmcnt(4)
 v_dot2_f32_bf16 v152, v48, s78, v152
 v_dot2_f32_bf16 v154, v48, v48, v154
 v_dot2_f32_bf16 v153, v52, s78, v153
 v_dot2_f32_bf16 v155, v52, v52, v155
 v_dot2_f32_bf16 v152, v49, s78, v152
 v_dot2_f32_bf16 v154, v49, v49, v154
 v_dot2_f32_bf16 v153, v53, s78, v153
 v_dot2_f32_bf16 v155, v53, v53, v155
 v_dot2_f32_bf16 v152, v50, s78, v152
 v_dot2_f32_bf16 v154, v50, v50, v154
 v_dot2_f32_bf16 v153, v54, s78, v153
 v_dot2_f32_bf16 v155, v54, v54, v155
 v_dot2_f32_bf16 v152, v51, s78, v152
 v_dot2_f32_bf16 v154, v51, v51, v154
 v_dot2_f32_bf16 v153, v55, s78, v153
 v_dot2_f32_bf16 v155, v55, v55, v155
 v_dot2_f32_bf16 v152, v56, s78, v152
 v_dot2_f32_bf16 v154, v56, v56, v154
 v_dot2_f32_bf16 v153, v60, s78, v153
 v_dot2_f32_bf16 v155, v60, v60, v155
 v_dot2_f32_bf16 v152, v57, s78, v152
 v_dot2_f32_bf16 v154, v57, v57, v154
 v_dot2_f32_bf16 v153, v61, s78, v153
 v_dot2_f32_bf16 v155, v61, v61, v155
 v_dot2_f32_bf16 v152, v58, s78, v152
 v_dot2_f32_bf16 v154, v58, v58, v154
 v_dot2_f32_bf16 v153, v62, s78, v153
 v_dot2_f32_bf16 v155, v62, v62, v155
 v_dot2_f32_bf16 v152, v59, s78, v152
 v_dot2_f32_bf16 v154, v59, v59, v154
 v_dot2_f32_bf16 v153, v63, s78, v153
 v_dot2_f32_bf16 v155, v63, v63, v155
 s_waitcnt vmcnt(12)
 ds_read_b128 v[80:83], v146 offset:20480
 ds_read_b128 v[84:87], v146 offset:22528
 ds_read_b128 v[88:91], v147 offset:20480
 ds_read_b128 v[92:95], v147 offset:22528
 s_waitcnt lgkmcnt(4)
 v_dot2_f32_bf16 v152, v64, s78, v152
 v_dot2_f32_bf16 v154, v64, v64, v154
 v_dot2_f32_bf16 v153, v68, s78, v153
 v_dot2_f32_bf16 v155, v68, v68, v155
 v_dot2_f32_bf16 v152, v65, s78, v152
 v_dot2_f32_bf16 v154, v65, v65, v154
 v_dot2_f32_bf16 v153, v69, s78, v153
 v_dot2_f32_bf16 v155, v69, v69, v155
 v_dot2_f32_bf16 v152, v66, s78, v152
 v_dot2_f32_bf16 v154, v66, v66, v154
 v_dot2_f32_bf16 v153, v70, s78, v153
 v_dot2_f32_bf16 v155, v70, v70, v155
 v_dot2_f32_bf16 v152, v67, s78, v152
 v_dot2_f32_bf16 v154, v67, v67, v154
 v_dot2_f32_bf16 v153, v71, s78, v153
 v_dot2_f32_bf16 v155, v71, v71, v155
 v_dot2_f32_bf16 v152, v72, s78, v152
 v_dot2_f32_bf16 v154, v72, v72, v154
 v_dot2_f32_bf16 v153, v76, s78, v153
 v_dot2_f32_bf16 v155, v76, v76, v155
 v_dot2_f32_bf16 v152, v73, s78, v152
 v_dot2_f32_bf16 v154, v73, v73, v154
 v_dot2_f32_bf16 v153, v77, s78, v153
 v_dot2_f32_bf16 v155, v77, v77, v155
 v_dot2_f32_bf16 v152, v74, s78, v152
 v_dot2_f32_bf16 v154, v74, v74, v154
 v_dot2_f32_bf16 v153, v78, s78, v153
 v_dot2_f32_bf16 v155, v78, v78, v155
 v_dot2_f32_bf16 v152, v75, s78, v152
 v_dot2_f32_bf16 v154, v75, v75, v154
 v_dot2_f32_bf16 v153, v79, s78, v153
 v_dot2_f32_bf16 v155, v79, v79, v155
 s_waitcnt vmcnt(8)
 ds_read_b128 v[96:99], v146 offset:24576
 ds_read_b128 v[100:103], v146 offset:26624
 ds_read_b128 v[104:107], v147 offset:24576
 ds_read_b128 v[108:111], v147 offset:26624
 s_waitcnt lgkmcnt(4)
 v_dot2_f32_bf16 v152, v80, s78, v152
 v_dot2_f32_bf16 v154, v80, v80, v154
 v_dot2_f32_bf16 v153, v84, s78, v153
 v_dot2_f32_bf16 v155, v84, v84, v155
 v_dot2_f32_bf16 v152, v81, s78, v152
 v_dot2_f32_bf16 v154, v81, v81, v154
 v_dot2_f32_bf16 v153, v85, s78, v153
 v_dot2_f32_bf16 v155, v85, v85, v155
 v_dot2_f32_bf16 v152, v82, s78, v152
 v_dot2_f32_bf16 v154, v82, v82, v154
 v_dot2_f32_bf16 v153, v86, s78, v153
 v_dot2_f32_bf16 v155, v86, v86, v155
 v_dot2_f32_bf16 v152, v83, s78, v152
 v_dot2_f32_bf16 v154, v83, v83, v154
 v_dot2_f32_bf16 v153, v87, s78, v153
 v_dot2_f32_bf16 v155, v87, v87, v155
 v_dot2_f32_bf16 v152, v88, s78, v152
 v_dot2_f32_bf16 v154, v88, v88, v154
 v_dot2_f32_bf16 v153, v92, s78, v153
 v_dot2_f32_bf16 v155, v92, v92, v155
 v_dot2_f32_bf16 v152, v89, s78, v152
 v_dot2_f32_bf16 v154, v89, v89, v154
 v_dot2_f32_bf16 v153, v93, s78, v153
 v_dot2_f32_bf16 v155, v93, v93, v155
 v_dot2_f32_bf16 v152, v90, s78, v152
 v_dot2_f32_bf16 v154, v90, v90, v154
 v_dot2_f32_bf16 v153, v94, s78, v153
 v_dot2_f32_bf16 v155, v94, v94, v155
 v_dot2_f32_bf16 v152, v91, s78, v152
 v_dot2_f32_bf16 v154, v91, v91, v154
 v_dot2_f32_bf16 v153, v95, s78, v153
 v_dot2_f32_bf16 v155, v95, v95, v155
 s_waitcnt vmcnt(4)
 ds_read_b128 v[112:115], v146 offset:28672
 ds_read_b128 v[116:119], v146 offset:30720
 ds_read_b128 v[120:123], v147 offset:28672
 ds_read_b128 v[124:127], v147 offset:30720
 s_waitcnt lgkmcnt(4)
 v_dot2_f32_bf16 v152, v96, s78, v152
 v_dot2_f32_bf16 v154, v96, v96, v154
 v_dot2_f32_bf16 v153, v100, s78, v153
 v_dot2_f32_bf16 v155, v100, v100, v155
 v_dot2_f32_bf16 v152, v97, s78, v152
 v_dot2_f32_bf16 v154, v97, v97, v154
 v_dot2_f32_bf16 v153, v101, s78, v153
 v_dot2_f32_bf16 v155, v101, v101, v155
 v_dot2_f32_bf16 v152, v98, s78, v152
 v_dot2_f32_bf16 v154, v98, v98, v154
 v_dot2_f32_bf16 v153, v102, s78, v153
 v_dot2_f32_bf16 v155, v102, v102, v155
 v_dot2_f32_bf16 v152, v99, s78, v152
 v_dot2_f32_bf16 v154, v99, v99, v154
 v_dot2_f32_bf16 v153, v103, s78, v153
 v_dot2_f32_bf16 v155, v103, v103, v155
 v_dot2_f32_bf16 v152, v104, s78, v152
 v_dot2_f32_bf16 v154, v104, v104, v154
 v_dot2_f32_bf16 v153, v108, s78, v153
 v_dot2_f32_bf16 v155, v108, v108, v155
 v_dot2_f32_bf16 v152, v105, s78, v152
 v_dot2_f32_bf16 v154, v105, v105, v154
 v_dot2_f32_bf16 v153, v109, s78, v153
 v_dot2_f32_bf16 v155, v109, v109, v155
 v_dot2_f32_bf16 v152, v106, s78, v152
 v_dot2_f32_bf16 v154, v106, v106, v154
 v_dot2_f32_bf16 v153, v110, s78, v153
 v_dot2_f32_bf16 v155, v110, v110, v155
 v_dot2_f32_bf16 v152, v107, s78, v152
 v_dot2_f32_bf16 v154, v107, v107, v154
 v_dot2_f32_bf16 v153, v111, s78, v153
 v_dot2_f32_bf16 v155, v111, v111, v155
 s_waitcnt vmcnt(0)
 ds_read_b128 v[128:131], v146 offset:32768
 ds_read_b128 v[132:135], v146 offset:34816
 ds_read_b128 v[136:139], v147 offset:32768
 ds_read_b128 v[140:143], v147 offset:34816
 s_waitcnt lgkmcnt(4)
 v_dot2_f32_bf16 v152, v112, s78, v152
 v_dot2_f32_bf16 v154, v112, v112, v154
 v_dot2_f32_bf16 v153, v116, s78, v153
 v_dot2_f32_bf16 v155, v116, v116, v155
 v_dot2_f32_bf16 v152, v113, s78, v152
 v_dot2_f32_bf16 v154, v113, v113, v154
 v_dot2_f32_bf16 v153, v117, s78, v153
 v_dot2_f32_bf16 v155, v117, v117, v155
 v_dot2_f32_bf16 v152, v114, s78, v152
 v_dot2_f32_bf16 v154, v114, v114, v154
 v_dot2_f32_bf16 v153, v118, s78, v153
 v_dot2_f32_bf16 v155, v118, v118, v155
 v_dot2_f32_bf16 v152, v115, s78, v152
 v_dot2_f32_bf16 v154, v115, v115, v154
 v_dot2_f32_bf16 v153, v119, s78, v153
 v_dot2_f32_bf16 v155, v119, v119, v155
 v_dot2_f32_bf16 v152, v120, s78, v152
 v_dot2_f32_bf16 v154, v120, v120, v154
 v_dot2_f32_bf16 v153, v124, s78, v153
 v_dot2_f32_bf16 v155, v124, v124, v155
 v_dot2_f32_bf16 v152, v121, s78, v152
 v_dot2_f32_bf16 v154, v121, v121, v154
 v_dot2_f32_bf16 v153, v125, s78, v153
 v_dot2_f32_bf16 v155, v125, v125, v155
 v_dot2_f32_bf16 v152, v122, s78, v152
 v_dot2_f32_bf16 v154, v122, v122, v154
 v_dot2_f32_bf16 v153, v126, s78, v153
 v_dot2_f32_bf16 v155, v126, v126, v155
 v_dot2_f32_bf16 v152, v123, s78, v152
 v_dot2_f32_bf16 v154, v123, v123, v154
 v_dot2_f32_bf16 v153, v127, s78, v153
 v_dot2_f32_bf16 v155, v127, v127, v155
 ds_read_b64 a[216:217], v160 offset:32768
 ds_read_b64 a[218:219], v160 offset:34816
 s_waitcnt lgkmcnt(0) vmcnt(0)
 s_barrier
 s_add_u32 m0, s89, 0
 s_add_u32 s65, s90, 0
 buffer_load_dwordx4 v168, s[32:35], s65 offen lds
 s_add_u32 m0, s89, 1024
 s_add_u32 s65, s90, 64
 buffer_load_dwordx4 v168, s[32:35], s65 offen lds
 s_add_u32 m0, s89, 2048
 s_add_u32 s65, s90, 128
 buffer_load_dwordx4 v168, s[32:35], s65 offen lds
 s_add_u32 s89, s89, 12288
 s_add_u32 s90, s90, 73728
 s_cmp_eq_u32 s90, 663552
 s_cselect_b32 s89, s73, s89
 s_cselect_b32 s90, 0, s90
 s_add_u32 m0, s89, 0
 s_add_u32 s65, s90, 0
 buffer_load_dwordx4 v168, s[32:35], s65 offen lds
 s_add_u32 m0, s89, 1024
 s_add_u32 s65, s90, 64
 buffer_load_dwordx4 v168, s[32:35], s65 offen lds
 s_add_u32 m0, s89, 2048
 s_add_u32 s65, s90, 128
 buffer_load_dwordx4 v168, s[32:35], s65 offen lds
 s_add_u32 s89, s89, 12288
 s_add_u32 s90, s90, 73728
 s_cmp_eq_u32 s90, 663552
 s_cselect_b32 s89, s73, s89
 s_cselect_b32 s90, 0, s90
 s_add_u32 m0, s89, 0
 s_add_u32 s65, s90, 0
 buffer_load_dwordx4 v168, s[32:35], s65 offen lds
 s_add_u32 m0, s89, 1024
 s_add_u32 s65, s90, 64
 buffer_load_dwordx4 v168, s[32:35], s65 offen lds
 s_add_u32 m0, s89, 2048
 s_add_u32 s65, s90, 128
 buffer_load_dwordx4 v168, s[32:35], s65 offen lds
 s_add_u32 s89, s89, 12288
 s_add_u32 s90, s90, 73728
 s_cmp_eq_u32 s90, 663552
 s_cselect_b32 s89, s73, s89
 s_cselect_b32 s90, 0, s90
 s_waitcnt lgkmcnt(0)
 v_dot2_f32_bf16 v152, v128, s78, v152
 v_dot2_f32_bf16 v154, v128, v128, v154
 v_dot2_f32_bf16 v153, v132, s78, v153
 v_dot2_f32_bf16 v155, v132, v132, v155
 v_dot2_f32_bf16 v152, v129, s78, v152
 v_dot2_f32_bf16 v154, v129, v129, v154
 v_dot2_f32_bf16 v153, v133, s78, v153
 v_dot2_f32_bf16 v155, v133, v133, v155
 v_dot2_f32_bf16 v152, v130, s78, v152
 v_dot2_f32_bf16 v154, v130, v130, v154
 v_dot2_f32_bf16 v153, v134, s78, v153
 v_dot2_f32_bf16 v155, v134, v134, v155
 v_dot2_f32_bf16 v152, v131, s78, v152
 v_dot2_f32_bf16 v154, v131, v131, v154
 v_dot2_f32_bf16 v153, v135, s78, v153
 v_dot2_f32_bf16 v155, v135, v135, v155
 v_dot2_f32_bf16 v152, v136, s78, v152
 v_dot2_f32_bf16 v154, v136, v136, v154
 v_dot2_f32_bf16 v153, v140, s78, v153
 v_dot2_f32_bf16 v155, v140, v140, v155
 v_dot2_f32_bf16 v152, v137, s78, v152
 v_dot2_f32_bf16 v154, v137, v137, v154
 v_dot2_f32_bf16 v153, v141, s78, v153
 v_dot2_f32_bf16 v155, v141, v141, v155
 v_dot2_f32_bf16 v152, v138, s78, v152
 v_dot2_f32_bf16 v154, v138, v138, v154
 v_dot2_f32_bf16 v153, v142, s78, v153
 v_dot2_f32_bf16 v155, v142, v142, v155
 v_dot2_f32_bf16 v152, v139, s78, v152
 v_dot2_f32_bf16 v154, v139, v139, v154
 v_dot2_f32_bf16 v153, v143, s78, v153
 v_dot2_f32_bf16 v155, v143, v143, v155
 v_mov_b32 v164, v152
 s_nop 0
 v_mov_b32 v165, v153
 v_mov_b32 v166, v154
 v_mov_b32 v167, v155
 v_permlane16_swap_b32 v152, v164
 v_permlane16_swap_b32 v153, v165
 v_permlane16_swap_b32 v154, v166
 v_permlane16_swap_b32 v155, v167
 v_add_f32 v152, v152, v164
 v_add_f32 v153, v153, v165
 v_add_f32 v154, v154, v166
 v_add_f32 v155, v155, v167
 v_mov_b32 v164, v152
 v_mov_b32 v165, v153
 v_mov_b32 v166, v154
 v_mov_b32 v167, v155
 v_permlane32_swap_b32 v152, v164
 v_permlane32_swap_b32 v153, v165
 v_permlane32_swap_b32 v154, v166
 v_permlane32_swap_b32 v155, v167
 v_add_f32 v152, v152, v164
 v_add_f32 v153, v153, v165
 v_add_f32 v154, v154, v166
 v_add_f32 v155, v155, v167
 v_mul_f32 v152, 987991609, v152
 v_mul_f32 v153, 987991609, v153
 v_mul_f32 v154, 987991609, v154
 v_mul_f32 v155, 987991609, v155
 v_fma_f32 v154, -v152, v152, v154
 v_fma_f32 v155, -v153, v153, v155
 v_max_f32 v154, 0, v154
 v_max_f32 v155, 0, v155
 v_add_f32 v154, 925353388, v154
 v_add_f32 v155, 925353388, v155
 v_rsq_f32 v154, v154
 v_rsq_f32 v155, v155
 v_mul_f32 v156, 1051597459, v154
 v_mul_f32 v160, 1051597459, v155
 v_sub_f32 v152, 0, v152
 v_accvgpr_write_b32 a201, v156
 v_sub_f32 v153, 0, v153
 v_accvgpr_write_b32 a202, v160
 s_add_u32 m0, s89, 0
 s_add_u32 s65, s90, 0
 buffer_load_dwordx4 v168, s[32:35], s65 offen lds
 v_dot2_f32_bf16 v164, v0, s76, v152
 v_dot2_f32_bf16 v165, v0, s77, v152
 v_dot2_f32_bf16 v166, v1, s76, v152
 v_dot2_f32_bf16 v167, v1, s77, v152
 v_dot2_f32_bf16 v160, v2, s76, v152
 v_dot2_f32_bf16 v161, v2, s77, v152
 v_dot2_f32_bf16 v162, v3, s76, v152
 v_dot2_f32_bf16 v163, v3, s77, v152
 v_cvt_pk_bf16_f32 v0, v164, v165
 v_cvt_pk_bf16_f32 v1, v166, v167
 v_dot2_f32_bf16 v164, v4, s76, v153
 v_dot2_f32_bf16 v165, v4, s77, v153
 v_dot2_f32_bf16 v166, v5, s76, v153
 v_dot2_f32_bf16 v167, v5, s77, v153
 v_cvt_pk_bf16_f32 v2, v160, v161
 v_cvt_pk_bf16_f32 v3, v162, v163
 v_dot2_f32_bf16 v160, v6, s76, v153
 v_dot2_f32_bf16 v161, v6, s77, v153
 v_dot2_f32_bf16 v162, v7, s76, v153
 v_dot2_f32_bf16 v163, v7, s77, v153
 v_cvt_pk_bf16_f32 v4, v164, v165
 v_cvt_pk_bf16_f32 v5, v166, v167
 s_add_u32 m0, s89, 1024
 s_add_u32 s65, s90, 64
 buffer_load_dwordx4 v168, s[32:35], s65 offen lds
 v_dot2_f32_bf16 v164, v8, s76, v152
 v_dot2_f32_bf16 v165, v8, s77, v152
 v_dot2_f32_bf16 v166, v9, s76, v152
 v_dot2_f32_bf16 v167, v9, s77, v152
 v_cvt_pk_bf16_f32 v6, v160, v161
 v_cvt_pk_bf16_f32 v7, v162, v163
 v_dot2_f32_bf16 v160, v10, s76, v152
 v_dot2_f32_bf16 v161, v10, s77, v152
 v_dot2_f32_bf16 v162, v11, s76, v152
 v_dot2_f32_bf16 v163, v11, s77, v152
 v_cvt_pk_bf16_f32 v8, v164, v165
 v_cvt_pk_bf16_f32 v9, v166, v167
 v_dot2_f32_bf16 v164, v12, s76, v153
 v_dot2_f32_bf16 v165, v12, s77, v153
 v_dot2_f32_bf16 v166, v13, s76, v153
 v_dot2_f32_bf16 v167, v13, s77, v153
 v_cvt_pk_bf16_f32 v10, v160, v161
 v_cvt_pk_bf16_f32 v11, v162, v163
 s_add_u32 m0, s89, 2048
 s_add_u32 s65, s90, 128
 buffer_load_dwordx4 v168, s[32:35], s65 offen lds
 s_add_u32 s89, s89, 12288
 s_add_u32 s90, s90, 73728
 s_cmp_eq_u32 s90, 663552
 s_cselect_b32 s89, s73, s89
 s_cselect_b32 s90, 0, s90
 v_dot2_f32_bf16 v160, v14, s76, v153
 v_dot2_f32_bf16 v161, v14, s77, v153
 v_dot2_f32_bf16 v162, v15, s76, v153
 v_dot2_f32_bf16 v163, v15, s77, v153
 v_cvt_pk_bf16_f32 v12, v164, v165
 v_cvt_pk_bf16_f32 v13, v166, v167
 v_dot2_f32_bf16 v164, v16, s76, v152
 v_dot2_f32_bf16 v165, v16, s77, v152
 v_dot2_f32_bf16 v166, v17, s76, v152
 v_dot2_f32_bf16 v167, v17, s77, v152
 v_cvt_pk_bf16_f32 v14, v160, v161
 v_cvt_pk_bf16_f32 v15, v162, v163
 v_dot2_f32_bf16 v160, v18, s76, v152
 v_dot2_f32_bf16 v161, v18, s77, v152
 v_dot2_f32_bf16 v162, v19, s76, v152
 v_dot2_f32_bf16 v163, v19, s77, v152
 v_cvt_pk_bf16_f32 v16, v164, v165
 v_cvt_pk_bf16_f32 v17, v166, v167
 v_dot2_f32_bf16 v164, v20, s76, v153
 v_dot2_f32_bf16 v165, v20, s77, v153
 v_dot2_f32_bf16 v166, v21, s76, v153
 v_dot2_f32_bf16 v167, v21, s77, v153
 v_cvt_pk_bf16_f32 v18, v160, v161
 v_cvt_pk_bf16_f32 v19, v162, v163
 s_add_u32 m0, s89, 0
 s_add_u32 s65, s90, 0
 buffer_load_dwordx4 v168, s[32:35], s65 offen lds
 v_dot2_f32_bf16 v160, v22, s76, v153
 v_dot2_f32_bf16 v161, v22, s77, v153
 v_dot2_f32_bf16 v162, v23, s76, v153
 v_dot2_f32_bf16 v163, v23, s77, v153
 v_cvt_pk_bf16_f32 v20, v164, v165
 v_cvt_pk_bf16_f32 v21, v166, v167
 v_dot2_f32_bf16 v164, v24, s76, v152
 v_dot2_f32_bf16 v165, v24, s77, v152
 v_dot2_f32_bf16 v166, v25, s76, v152
 v_dot2_f32_bf16 v167, v25, s77, v152
 v_cvt_pk_bf16_f32 v22, v160, v161
 v_cvt_pk_bf16_f32 v23, v162, v163
 v_dot2_f32_bf16 v160, v26, s76, v152
 v_dot2_f32_bf16 v161, v26, s77, v152
 v_dot2_f32_bf16 v162, v27, s76, v152
 v_dot2_f32_bf16 v163, v27, s77, v152
 v_cvt_pk_bf16_f32 v24, v164, v165
 v_cvt_pk_bf16_f32 v25, v166, v167
 s_add_u32 m0, s89, 1024
 s_add_u32 s65, s90, 64
 buffer_load_dwordx4 v168, s[32:35], s65 offen lds
 v_dot2_f32_bf16 v164, v28, s76, v153
 v_dot2_f32_bf16 v165, v28, s77, v153
 v_dot2_f32_bf16 v166, v29, s76, v153
 v_dot2_f32_bf16 v167, v29, s77, v153
 v_cvt_pk_bf16_f32 v26, v160, v161
 v_cvt_pk_bf16_f32 v27, v162, v163
 v_dot2_f32_bf16 v160, v30, s76, v153
 v_dot2_f32_bf16 v161, v30, s77, v153
 v_dot2_f32_bf16 v162, v31, s76, v153
 v_dot2_f32_bf16 v163, v31, s77, v153
 v_cvt_pk_bf16_f32 v28, v164, v165
 v_cvt_pk_bf16_f32 v29, v166, v167
 v_dot2_f32_bf16 v164, v32, s76, v152
 v_dot2_f32_bf16 v165, v32, s77, v152
 v_dot2_f32_bf16 v166, v33, s76, v152
 v_dot2_f32_bf16 v167, v33, s77, v152
 v_cvt_pk_bf16_f32 v30, v160, v161
 v_cvt_pk_bf16_f32 v31, v162, v163
 v_dot2_f32_bf16 v160, v34, s76, v152
 v_dot2_f32_bf16 v161, v34, s77, v152
 v_dot2_f32_bf16 v162, v35, s76, v152
 v_dot2_f32_bf16 v163, v35, s77, v152
 v_cvt_pk_bf16_f32 v32, v164, v165
 v_cvt_pk_bf16_f32 v33, v166, v167
 s_add_u32 m0, s89, 2048
 s_add_u32 s65, s90, 128
 buffer_load_dwordx4 v168, s[32:35], s65 offen lds
 s_add_u32 s89, s89, 12288
 s_add_u32 s90, s90, 73728
 s_cmp_eq_u32 s90, 663552
 s_cselect_b32 s89, s73, s89
 s_cselect_b32 s90, 0, s90
 v_dot2_f32_bf16 v164, v36, s76, v153
 v_dot2_f32_bf16 v165, v36, s77, v153
 v_dot2_f32_bf16 v166, v37, s76, v153
 v_dot2_f32_bf16 v167, v37, s77, v153
 v_cvt_pk_bf16_f32 v34, v160, v161
 v_cvt_pk_bf16_f32 v35, v162, v163
 v_dot2_f32_bf16 v160, v38, s76, v153
 v_dot2_f32_bf16 v161, v38, s77, v153
 v_dot2_f32_bf16 v162, v39, s76, v153
 v_dot2_f32_bf16 v163, v39, s77, v153
 v_cvt_pk_bf16_f32 v36, v164, v165
 v_cvt_pk_bf16_f32 v37, v166, v167
 v_dot2_f32_bf16 v164, v40, s76, v152
 v_dot2_f32_bf16 v165, v40, s77, v152
 v_dot2_f32_bf16 v166, v41, s76, v152
 v_dot2_f32_bf16 v167, v41, s77, v152
 v_cvt_pk_bf16_f32 v38, v160, v161
 v_cvt_pk_bf16_f32 v39, v162, v163
 s_add_u32 m0, s89, 0
 s_add_u32 s65, s90, 0
 buffer_load_dwordx4 v168, s[32:35], s65 offen lds
 v_dot2_f32_bf16 v160, v42, s76, v152
 v_dot2_f32_bf16 v161, v42, s77, v152
 v_dot2_f32_bf16 v162, v43, s76, v152
 v_dot2_f32_bf16 v163, v43, s77, v152
 v_cvt_pk_bf16_f32 v40, v164, v165
 v_cvt_pk_bf16_f32 v41, v166, v167
 v_dot2_f32_bf16 v164, v44, s76, v153
 v_dot2_f32_bf16 v165, v44, s77, v153
 v_dot2_f32_bf16 v166, v45, s76, v153
 v_dot2_f32_bf16 v167, v45, s77, v153
 v_cvt_pk_bf16_f32 v42, v160, v161
 v_cvt_pk_bf16_f32 v43, v162, v163
 v_dot2_f32_bf16 v160, v46, s76, v153
 v_dot2_f32_bf16 v161, v46, s77, v153
 v_dot2_f32_bf16 v162, v47, s76, v153
 v_dot2_f32_bf16 v163, v47, s77, v153
 v_cvt_pk_bf16_f32 v44, v164, v165
 v_cvt_pk_bf16_f32 v45, v166, v167
 v_dot2_f32_bf16 v164, v48, s76, v152
 v_dot2_f32_bf16 v165, v48, s77, v152
 v_dot2_f32_bf16 v166, v49, s76, v152
 v_dot2_f32_bf16 v167, v49, s77, v152
 v_cvt_pk_bf16_f32 v46, v160, v161
 v_cvt_pk_bf16_f32 v47, v162, v163
 s_add_u32 m0, s89, 1024
 s_add_u32 s65, s90, 64
 buffer_load_dwordx4 v168, s[32:35], s65 offen lds
 v_dot2_f32_bf16 v160, v50, s76, v152
 v_dot2_f32_bf16 v161, v50, s77, v152
 v_dot2_f32_bf16 v162, v51, s76, v152
 v_dot2_f32_bf16 v163, v51, s77, v152
 v_cvt_pk_bf16_f32 v48, v164, v165
 v_cvt_pk_bf16_f32 v49, v166, v167
 v_dot2_f32_bf16 v164, v52, s76, v153
 v_dot2_f32_bf16 v165, v52, s77, v153
 v_dot2_f32_bf16 v166, v53, s76, v153
 v_dot2_f32_bf16 v167, v53, s77, v153
 v_cvt_pk_bf16_f32 v50, v160, v161
 v_cvt_pk_bf16_f32 v51, v162, v163
 v_dot2_f32_bf16 v160, v54, s76, v153
 v_dot2_f32_bf16 v161, v54, s77, v153
 v_dot2_f32_bf16 v162, v55, s76, v153
 v_dot2_f32_bf16 v163, v55, s77, v153
 v_cvt_pk_bf16_f32 v52, v164, v165
 v_cvt_pk_bf16_f32 v53, v166, v167
 s_add_u32 m0, s89, 2048
 s_add_u32 s65, s90, 128
 buffer_load_dwordx4 v168, s[32:35], s65 offen lds
 s_add_u32 s89, s89, 12288
 s_add_u32 s90, s90, 73728
 s_cmp_eq_u32 s90, 663552
 s_cselect_b32 s89, s73, s89
 s_cselect_b32 s90, 0, s90
 v_dot2_f32_bf16 v164, v56, s76, v152
 v_dot2_f32_bf16 v165, v56, s77, v152
 v_dot2_f32_bf16 v166, v57, s76, v152
 v_dot2_f32_bf16 v167, v57, s77, v152
 v_cvt_pk_bf16_f32 v54, v160, v161
 v_cvt_pk_bf16_f32 v55, v162, v163
 v_dot2_f32_bf16 v160, v58, s76, v152
 v_dot2_f32_bf16 v161, v58, s77, v152
 v_dot2_f32_bf16 v162, v59, s76, v152
 v_dot2_f32_bf16 v163, v59, s77, v152
 v_cvt_pk_bf16_f32 v56, v164, v165
 v_cvt_pk_bf16_f32 v57, v166, v167
 v_dot2_f32_bf16 v164, v60, s76, v153
 v_dot2_f32_bf16 v165, v60, s77, v153
 v_dot2_f32_bf16 v166, v61, s76, v153
 v_dot2_f32_bf16 v167, v61, s77, v153
 v_cvt_pk_bf16_f32 v58, v160, v161
 v_cvt_pk_bf16_f32 v59, v162, v163
 v_dot2_f32_bf16 v160, v62, s76, v153
 v_dot2_f32_bf16 v161, v62, s77, v153
 v_dot2_f32_bf16 v162, v63, s76, v153
 v_dot2_f32_bf16 v163, v63, s77, v153
 v_cvt_pk_bf16_f32 v60, v164, v165
 v_cvt_pk_bf16_f32 v61, v166, v167
 s_add_u32 m0, s89, 0
 s_add_u32 s65, s90, 0
 buffer_load_dwordx4 v168, s[32:35], s65 offen lds
 v_dot2_f32_bf16 v164, v64, s76, v152
 v_dot2_f32_bf16 v165, v64, s77, v152
 v_dot2_f32_bf16 v166, v65, s76, v152
 v_dot2_f32_bf16 v167, v65, s77, v152
 v_cvt_pk_bf16_f32 v62, v160, v161
 v_cvt_pk_bf16_f32 v63, v162, v163
 v_dot2_f32_bf16 v160, v66, s76, v152
 v_dot2_f32_bf16 v161, v66, s77, v152
 v_dot2_f32_bf16 v162, v67, s76, v152
 v_dot2_f32_bf16 v163, v67, s77, v152
 v_cvt_pk_bf16_f32 v64, v164, v165
 v_cvt_pk_bf16_f32 v65, v166, v167
 v_dot2_f32_bf16 v164, v68, s76, v153
 v_dot2_f32_bf16 v165, v68, s77, v153
 v_dot2_f32_bf16 v166, v69, s76, v153
 v_dot2_f32_bf16 v167, v69, s77, v153
 v_cvt_pk_bf16_f32 v66, v160, v161
 v_cvt_pk_bf16_f32 v67, v162, v163
 s_add_u32 m0, s89, 1024
 s_add_u32 s65, s90, 64
 buffer_load_dwordx4 v168, s[32:35], s65 offen lds
 v_dot2_f32_bf16 v160, v70, s76, v153
 v_dot2_f32_bf16 v161, v70, s77, v153
 v_dot2_f32_bf16 v162, v71, s76, v153
 v_dot2_f32_bf16 v163, v71, s77, v153
 v_cvt_pk_bf16_f32 v68, v164, v165
 v_cvt_pk_bf16_f32 v69, v166, v167
 v_dot2_f32_bf16 v164, v72, s76, v152
 v_dot2_f32_bf16 v165, v72, s77, v152
 v_dot2_f32_bf16 v166, v73, s76, v152
 v_dot2_f32_bf16 v167, v73, s77, v152
 v_cvt_pk_bf16_f32 v70, v160, v161
 v_cvt_pk_bf16_f32 v71, v162, v163
 v_dot2_f32_bf16 v160, v74, s76, v152
 v_dot2_f32_bf16 v161, v74, s77, v152
 v_dot2_f32_bf16 v162, v75, s76, v152
 v_dot2_f32_bf16 v163, v75, s77, v152
 v_cvt_pk_bf16_f32 v72, v164, v165
 v_cvt_pk_bf16_f32 v73, v166, v167
 v_dot2_f32_bf16 v164, v76, s76, v153
 v_dot2_f32_bf16 v165, v76, s77, v153
 v_dot2_f32_bf16 v166, v77, s76, v153
 v_dot2_f32_bf16 v167, v77, s77, v153
 v_cvt_pk_bf16_f32 v74, v160, v161
 v_cvt_pk_bf16_f32 v75, v162, v163
 s_add_u32 m0, s89, 2048
 s_add_u32 s65, s90, 128
 buffer_load_dwordx4 v168, s[32:35], s65 offen lds
 s_add_u32 s89, s89, 12288
 s_add_u32 s90, s90, 73728
 s_cmp_eq_u32 s90, 663552
 s_cselect_b32 s89, s73, s89
 s_cselect_b32 s90, 0, s90
 v_dot2_f32_bf16 v160, v78, s76, v153
 v_dot2_f32_bf16 v161, v78, s77, v153
 v_dot2_f32_bf16 v162, v79, s76, v153
 v_dot2_f32_bf16 v163, v79, s77, v153
 v_cvt_pk_bf16_f32 v76, v164, v165
 v_cvt_pk_bf16_f32 v77, v166, v167
 v_dot2_f32_bf16 v164, v80, s76, v152
 v_dot2_f32_bf16 v165, v80, s77, v152
 v_dot2_f32_bf16 v166, v81, s76, v152
 v_dot2_f32_bf16 v167, v81, s77, v152
 v_cvt_pk_bf16_f32 v78, v160, v161
 v_cvt_pk_bf16_f32 v79, v162, v163
 v_dot2_f32_bf16 v160, v82, s76, v152
 v_dot2_f32_bf16 v161, v82, s77, v152
 v_dot2_f32_bf16 v162, v83, s76, v152
 v_dot2_f32_bf16 v163, v83, s77, v152
 v_cvt_pk_bf16_f32 v80, v164, v165
 v_cvt_pk_bf16_f32 v81, v166, v167
 s_add_u32 m0, s89, 0
 s_add_u32 s65, s90, 0
 buffer_load_dwordx4 v168, s[32:35], s65 offen lds
 v_dot2_f32_bf16 v164, v84, s76, v153
 v_dot2_f32_bf16 v165, v84, s77, v153
 v_dot2_f32_bf16 v166, v85, s76, v153
 v_dot2_f32_bf16 v167, v85, s77, v153
 v_cvt_pk_bf16_f32 v82, v160, v161
 v_cvt_pk_bf16_f32 v83, v162, v163
 v_dot2_f32_bf16 v160, v86, s76, v153
 v_dot2_f32_bf16 v161, v86, s77, v153
 v_dot2_f32_bf16 v162, v87, s76, v153
 v_dot2_f32_bf16 v163, v87, s77, v153
 v_cvt_pk_bf16_f32 v84, v164, v165
 v_cvt_pk_bf16_f32 v85, v166, v167
 v_dot2_f32_bf16 v164, v88, s76, v152
 v_dot2_f32_bf16 v165, v88, s77, v152
 v_dot2_f32_bf16 v166, v89, s76, v152
 v_dot2_f32_bf16 v167, v89, s77, v152
 v_cvt_pk_bf16_f32 v86, v160, v161
 v_cvt_pk_bf16_f32 v87, v162, v163
 v_dot2_f32_bf16 v160, v90, s76, v152
 v_dot2_f32_bf16 v161, v90, s77, v152
 v_dot2_f32_bf16 v162, v91, s76, v152
 v_dot2_f32_bf16 v163, v91, s77, v152
 v_cvt_pk_bf16_f32 v88, v164, v165
 v_cvt_pk_bf16_f32 v89, v166, v167
 s_add_u32 m0, s89, 1024
 s_add_u32 s65, s90, 64
 buffer_load_dwordx4 v168, s[32:35], s65 offen lds
 v_dot2_f32_bf16 v164, v92, s76, v153
 v_dot2_f32_bf16 v165, v92, s77, v153
 v_dot2_f32_bf16 v166, v93, s76, v153
 v_dot2_f32_bf16 v167, v93, s77, v153
 v_cvt_pk_bf16_f32 v90, v160, v161
 v_cvt_pk_bf16_f32 v91, v162, v163
 v_dot2_f32_bf16 v160, v94, s76, v153
 v_dot2_f32_bf16 v161, v94, s77, v153
 v_dot2_f32_bf16 v162, v95, s76, v153
 v_dot2_f32_bf16 v163, v95, s77, v153
 v_cvt_pk_bf16_f32 v92, v164, v165
 v_cvt_pk_bf16_f32 v93, v166, v167
 v_dot2_f32_bf16 v164, v96, s76, v152
 v_dot2_f32_bf16 v165, v96, s77, v152
 v_dot2_f32_bf16 v166, v97, s76, v152
 v_dot2_f32_bf16 v167, v97, s77, v152
 v_cvt_pk_bf16_f32 v94, v160, v161
 v_cvt_pk_bf16_f32 v95, v162, v163
 s_add_u32 m0, s89, 2048
 s_add_u32 s65, s90, 128
 buffer_load_dwordx4 v168, s[32:35], s65 offen lds
 s_add_u32 s89, s89, 12288
 s_add_u32 s90, s90, 73728
 s_cmp_eq_u32 s90, 663552
 s_cselect_b32 s89, s73, s89
 s_cselect_b32 s90, 0, s90
 v_dot2_f32_bf16 v160, v98, s76, v152
 v_dot2_f32_bf16 v161, v98, s77, v152
 v_dot2_f32_bf16 v162, v99, s76, v152
 v_dot2_f32_bf16 v163, v99, s77, v152
 v_cvt_pk_bf16_f32 v96, v164, v165
 v_cvt_pk_bf16_f32 v97, v166, v167
 v_dot2_f32_bf16 v164, v100, s76, v153
 v_dot2_f32_bf16 v165, v100, s77, v153
 v_dot2_f32_bf16 v166, v101, s76, v153
 v_dot2_f32_bf16 v167, v101, s77, v153
 v_cvt_pk_bf16_f32 v98, v160, v161
 v_cvt_pk_bf16_f32 v99, v162, v163
 v_dot2_f32_bf16 v160, v102, s76, v153
 v_dot2_f32_bf16 v161, v102, s77, v153
 v_dot2_f32_bf16 v162, v103, s76, v153
 v_dot2_f32_bf16 v163, v103, s77, v153
 v_cvt_pk_bf16_f32 v100, v164, v165
 v_cvt_pk_bf16_f32 v101, v166, v167
 v_dot2_f32_bf16 v164, v104, s76, v152
 v_dot2_f32_bf16 v165, v104, s77, v152
 v_dot2_f32_bf16 v166, v105, s76, v152
 v_dot2_f32_bf16 v167, v105, s77, v152
 v_cvt_pk_bf16_f32 v102, v160, v161
 v_cvt_pk_bf16_f32 v103, v162, v163
 s_add_u32 m0, s89, 0
 s_add_u32 s65, s90, 0
 buffer_load_dwordx4 v168, s[32:35], s65 offen lds
 v_dot2_f32_bf16 v160, v106, s76, v152
 v_dot2_f32_bf16 v161, v106, s77, v152
 v_dot2_f32_bf16 v162, v107, s76, v152
 v_dot2_f32_bf16 v163, v107, s77, v152
 v_cvt_pk_bf16_f32 v104, v164, v165
 v_cvt_pk_bf16_f32 v105, v166, v167
 v_dot2_f32_bf16 v164, v108, s76, v153
 v_dot2_f32_bf16 v165, v108, s77, v153
 v_dot2_f32_bf16 v166, v109, s76, v153
 v_dot2_f32_bf16 v167, v109, s77, v153
 v_cvt_pk_bf16_f32 v106, v160, v161
 v_cvt_pk_bf16_f32 v107, v162, v163
 v_dot2_f32_bf16 v160, v110, s76, v153
 v_dot2_f32_bf16 v161, v110, s77, v153
 v_dot2_f32_bf16 v162, v111, s76, v153
 v_dot2_f32_bf16 v163, v111, s77, v153
 v_cvt_pk_bf16_f32 v108, v164, v165
 v_cvt_pk_bf16_f32 v109, v166, v167
 s_add_u32 m0, s89, 1024
 s_add_u32 s65, s90, 64
 buffer_load_dwordx4 v168, s[32:35], s65 offen lds
 v_dot2_f32_bf16 v164, v112, s76, v152
 v_dot2_f32_bf16 v165, v112, s77, v152
 v_dot2_f32_bf16 v166, v113, s76, v152
 v_dot2_f32_bf16 v167, v113, s77, v152
 v_cvt_pk_bf16_f32 v110, v160, v161
 v_cvt_pk_bf16_f32 v111, v162, v163
 v_dot2_f32_bf16 v160, v114, s76, v152
 v_dot2_f32_bf16 v161, v114, s77, v152
 v_dot2_f32_bf16 v162, v115, s76, v152
 v_dot2_f32_bf16 v163, v115, s77, v152
 v_cvt_pk_bf16_f32 v112, v164, v165
 v_cvt_pk_bf16_f32 v113, v166, v167
 v_dot2_f32_bf16 v164, v116, s76, v153
 v_dot2_f32_bf16 v165, v116, s77, v153
 v_dot2_f32_bf16 v166, v117, s76, v153
 v_dot2_f32_bf16 v167, v117, s77, v153
 v_cvt_pk_bf16_f32 v114, v160, v161
 v_cvt_pk_bf16_f32 v115, v162, v163
 v_dot2_f32_bf16 v160, v118, s76, v153
 v_dot2_f32_bf16 v161, v118, s77, v153
 v_dot2_f32_bf16 v162, v119, s76, v153
 v_dot2_f32_bf16 v163, v119, s77, v153
 v_cvt_pk_bf16_f32 v116, v164, v165
 v_cvt_pk_bf16_f32 v117, v166, v167
 s_add_u32 m0, s89, 2048
 s_add_u32 s65, s90, 128
 buffer_load_dwordx4 v168, s[32:35], s65 offen lds
 v_dot2_f32_bf16 v164, v120, s76, v152
 v_dot2_f32_bf16 v165, v120, s77, v152
 v_dot2_f32_bf16 v166, v121, s76, v152
 v_dot2_f32_bf16 v167, v121, s77, v152
 v_cvt_pk_bf16_f32 v118, v160, v161
 v_cvt_pk_bf16_f32 v119, v162, v163
 v_dot2_f32_bf16 v160, v122, s76, v152
 v_dot2_f32_bf16 v161, v122, s77, v152
 v_dot2_f32_bf16 v162, v123, s76, v152
 v_dot2_f32_bf16 v163, v123, s77, v152
 v_cvt_pk_bf16_f32 v120, v164, v165
 v_cvt_pk_bf16_f32 v121, v166, v167
 v_dot2_f32_bf16 v164, v124, s76, v153
 v_dot2_f32_bf16 v165, v124, s77, v153
 v_dot2_f32_bf16 v166, v125, s76, v153
 v_dot2_f32_bf16 v167, v125, s77, v153
 v_cvt_pk_bf16_f32 v122, v160, v161
 v_cvt_pk_bf16_f32 v123, v162, v163
 v_dot2_f32_bf16 v160, v126, s76, v153
 v_dot2_f32_bf16 v161, v126, s77, v153
 v_dot2_f32_bf16 v162, v127, s76, v153
 v_dot2_f32_bf16 v163, v127, s77, v153
 v_cvt_pk_bf16_f32 v124, v164, v165
 v_cvt_pk_bf16_f32 v125, v166, v167
 v_dot2_f32_bf16 v164, v128, s76, v152
 v_dot2_f32_bf16 v165, v128, s77, v152
 v_dot2_f32_bf16 v166, v129, s76, v152
 v_dot2_f32_bf16 v167, v129, s77, v152
 v_cvt_pk_bf16_f32 v126, v160, v161
 v_cvt_pk_bf16_f32 v127, v162, v163
 v_dot2_f32_bf16 v160, v130, s76, v152
 v_dot2_f32_bf16 v161, v130, s77, v152
 v_dot2_f32_bf16 v162, v131, s76, v152
 v_dot2_f32_bf16 v163, v131, s77, v152
 v_cvt_pk_bf16_f32 v128, v164, v165
 v_cvt_pk_bf16_f32 v129, v166, v167
 v_dot2_f32_bf16 v164, v132, s76, v153
 v_dot2_f32_bf16 v165, v132, s77, v153
 v_dot2_f32_bf16 v166, v133, s76, v153
 v_dot2_f32_bf16 v167, v133, s77, v153
 v_cvt_pk_bf16_f32 v130, v160, v161
 v_cvt_pk_bf16_f32 v131, v162, v163
 v_dot2_f32_bf16 v160, v134, s76, v153
 v_dot2_f32_bf16 v161, v134, s77, v153
 v_dot2_f32_bf16 v162, v135, s76, v153
 v_dot2_f32_bf16 v163, v135, s77, v153
 v_cvt_pk_bf16_f32 v132, v164, v165
 v_cvt_pk_bf16_f32 v133, v166, v167
 v_dot2_f32_bf16 v164, v136, s76, v152
 v_dot2_f32_bf16 v165, v136, s77, v152
 v_dot2_f32_bf16 v166, v137, s76, v152
 v_dot2_f32_bf16 v167, v137, s77, v152
 v_cvt_pk_bf16_f32 v134, v160, v161
 v_cvt_pk_bf16_f32 v135, v162, v163
 v_dot2_f32_bf16 v160, v138, s76, v152
 v_dot2_f32_bf16 v161, v138, s77, v152
 v_dot2_f32_bf16 v162, v139, s76, v152
 v_dot2_f32_bf16 v163, v139, s77, v152
 v_cvt_pk_bf16_f32 v136, v164, v165
 v_cvt_pk_bf16_f32 v137, v166, v167
 v_dot2_f32_bf16 v164, v140, s76, v153
 v_dot2_f32_bf16 v165, v140, s77, v153
 v_dot2_f32_bf16 v166, v141, s76, v153
 v_dot2_f32_bf16 v167, v141, s77, v153
 v_cvt_pk_bf16_f32 v138, v160, v161
 v_cvt_pk_bf16_f32 v139, v162, v163
 v_dot2_f32_bf16 v160, v142, s76, v153
 v_dot2_f32_bf16 v161, v142, s77, v153
 v_dot2_f32_bf16 v162, v143, s76, v153
 v_dot2_f32_bf16 v163, v143, s77, v153
 v_cvt_pk_bf16_f32 v140, v164, v165
 v_cvt_pk_bf16_f32 v141, v166, v167
 v_cvt_pk_bf16_f32 v142, v160, v161
 v_cvt_pk_bf16_f32 v143, v162, v163
 s_waitcnt vmcnt(0)
 s_barrier
 v_accvgpr_write_b32 a203, v254
 v_mul_u32_u24 v254, 9216, v254
 ds_read_b64_tr_b16 a[144:145], v248 offset:0
 ds_read_b64_tr_b16 a[146:147], v248 offset:256
 ds_read_b64_tr_b16 a[148:149], v249 offset:0
 ds_read_b64_tr_b16 a[150:151], v249 offset:256
 ds_read_b64_tr_b16 a[152:153], v250 offset:0
 ds_read_b64_tr_b16 a[154:155], v250 offset:256
 ds_read_b64_tr_b16 a[156:157], v251 offset:0
 ds_read_b64_tr_b16 a[158:159], v251 offset:256
 s_waitcnt lgkmcnt(6)
 v_mfma_f32_16x16x32_bf16 v[144:147], a[144:147], v[0:3], 0
 ds_read_b64_tr_b16 a[160:161], v252 offset:0
 v_mov_b32 v184, 0
 v_mov_b32 v185, 0
 v_mfma_f32_16x16x32_bf16 v[148:151], a[144:147], v[4:7], 0
 s_waitcnt lgkmcnt(5)
 ds_read_b64_tr_b16 a[162:163], v252 offset:256
 v_mov_b32 v186, 0
 v_mfma_f32_16x16x32_bf16 v[156:159], a[148:151], v[4:7], 0
 ds_read_b64_tr_b16 a[164:165], v248 offset:6144
 v_mov_b32 v187, 0
 v_mov_b32 v188, 0
 v_mfma_f32_16x16x32_bf16 v[152:155], a[148:151], v[0:3], 0
 s_waitcnt lgkmcnt(5)
 ds_read_b64_tr_b16 a[166:167], v248 offset:6400
 v_mov_b32 v189, 0
 v_mfma_f32_16x16x32_bf16 v[160:163], a[152:155], v[0:3], 0
 ds_read_b64_tr_b16 a[168:169], v249 offset:6144
 v_mov_b32 v190, 0
 v_mov_b32 v191, 0
 v_mfma_f32_16x16x32_bf16 v[164:167], a[152:155], v[4:7], 0
 s_waitcnt lgkmcnt(5)
 ds_read_b64_tr_b16 a[170:171], v249 offset:6400
 v_mov_b32 v192, 0
 v_mfma_f32_16x16x32_bf16 v[172:175], a[156:159], v[4:7], 0
 buffer_load_dword a200, v254, s[44:47], 0 offen offset:256
 ds_read_b64_tr_b16 a[172:173], v250 offset:6144
 v_mov_b32 v193, 0
 v_mov_b32 v194, 0
 v_mfma_f32_16x16x32_bf16 v[168:171], a[156:159], v[0:3], 0
 s_waitcnt lgkmcnt(5)
 ds_read_b64_tr_b16 a[174:175], v250 offset:6400
 v_mov_b32 v195, 0
 v_mfma_f32_16x16x32_bf16 v[176:179], a[160:163], v[0:3], 0
 ds_read_b64_tr_b16 a[144:145], v251 offset:6144
 v_mov_b32 v196, 0
 v_mov_b32 v197, 0
 v_mfma_f32_16x16x32_bf16 v[180:183], a[160:163], v[4:7], 0
 s_waitcnt lgkmcnt(5)
 ds_read_b64_tr_b16 a[146:147], v251 offset:6400
 v_mov_b32 v198, 0
 v_mfma_f32_16x16x32_bf16 v[148:151], a[164:167], v[12:15], v[148:151]
 ds_read_b64_tr_b16 a[148:149], v252 offset:6144
 v_mov_b32 v199, 0
 v_mov_b32 v200, 0
 v_mfma_f32_16x16x32_bf16 v[144:147], a[164:167], v[8:11], v[144:147]
 s_waitcnt lgkmcnt(5)
 ds_read_b64_tr_b16 a[150:151], v252 offset:6400
 v_mov_b32 v201, 0
 v_mfma_f32_16x16x32_bf16 v[152:155], a[168:171], v[8:11], v[152:155]
 ds_read_b64_tr_b16 a[152:153], v248 offset:12288
 v_mov_b32 v202, 0
 v_mov_b32 v203, 0
 v_mfma_f32_16x16x32_bf16 v[156:159], a[168:171], v[12:15], v[156:159]
 s_waitcnt lgkmcnt(5)
 ds_read_b64_tr_b16 a[154:155], v248 offset:12544
 v_mov_b32 v204, 0
 v_mfma_f32_16x16x32_bf16 v[164:167], a[172:175], v[12:15], v[164:167]
 ds_read_b64_tr_b16 a[156:157], v249 offset:12288
 v_mov_b32 v205, 0
 v_mov_b32 v206, 0
 v_mfma_f32_16x16x32_bf16 v[160:163], a[172:175], v[8:11], v[160:163]
 s_waitcnt lgkmcnt(5)
 ds_read_b64_tr_b16 a[158:159], v249 offset:12544
 v_mov_b32 v207, 0
 v_mfma_f32_16x16x32_bf16 v[168:171], a[144:147], v[8:11], v[168:171]
 ds_read_b64_tr_b16 a[160:161], v250 offset:12288
 v_mov_b32 v208, 0
 v_mov_b32 v209, 0
 v_mfma_f32_16x16x32_bf16 v[172:175], a[144:147], v[12:15], v[172:175]
 s_waitcnt lgkmcnt(5)
 ds_read_b64_tr_b16 a[162:163], v250 offset:12544
 v_mov_b32 v210, 0
 v_mfma_f32_16x16x32_bf16 v[180:183], a[148:151], v[12:15], v[180:183]
 ds_read_b64_tr_b16 a[164:165], v251 offset:12288
 v_mov_b32 v211, 0
 v_mov_b32 v212, 0
 v_mfma_f32_16x16x32_bf16 v[176:179], a[148:151], v[8:11], v[176:179]
 s_waitcnt lgkmcnt(5)
 ds_read_b64_tr_b16 a[166:167], v251 offset:12544
 v_mov_b32 v213, 0
 v_mfma_f32_16x16x32_bf16 v[144:147], a[152:155], v[16:19], v[144:147]
 ds_read_b64_tr_b16 a[168:169], v252 offset:12288
 v_mov_b32 v214, 0
 v_mov_b32 v215, 0
 v_mfma_f32_16x16x32_bf16 v[148:151], a[152:155], v[20:23], v[148:151]
 s_waitcnt lgkmcnt(5)
 ds_read_b64_tr_b16 a[170:171], v252 offset:12544
 v_mov_b32 v216, 0
 v_mfma_f32_16x16x32_bf16 v[156:159], a[156:159], v[20:23], v[156:159]
 ds_read_b64_tr_b16 a[172:173], v248 offset:18432
 v_mov_b32 v217, 0
 v_mov_b32 v218, 0
 v_mfma_f32_16x16x32_bf16 v[152:155], a[156:159], v[16:19], v[152:155]
 s_waitcnt lgkmcnt(5)
 ds_read_b64_tr_b16 a[174:175], v248 offset:18688
 v_mov_b32 v219, 0
 v_mfma_f32_16x16x32_bf16 v[160:163], a[160:163], v[16:19], v[160:163]
 ds_read_b64_tr_b16 a[144:145], v249 offset:18432
 v_mov_b32 v220, 0
 v_mov_b32 v221, 0
 v_mfma_f32_16x16x32_bf16 v[164:167], a[160:163], v[20:23], v[164:167]
 s_waitcnt lgkmcnt(5)
 ds_read_b64_tr_b16 a[146:147], v249 offset:18688
 v_mov_b32 v222, 0
 v_mfma_f32_16x16x32_bf16 v[172:175], a[164:167], v[20:23], v[172:175]
 ds_read_b64_tr_b16 a[148:149], v250 offset:18432
 v_mov_b32 v223, 0
 v_mov_b32 v224, 0
 v_mfma_f32_16x16x32_bf16 v[168:171], a[164:167], v[16:19], v[168:171]
 s_waitcnt lgkmcnt(5)
 ds_read_b64_tr_b16 a[150:151], v250 offset:18688
 v_mov_b32 v225, 0
 v_mfma_f32_16x16x32_bf16 v[176:179], a[168:171], v[16:19], v[176:179]
 ds_read_b64_tr_b16 a[152:153], v251 offset:18432
 v_mov_b32 v226, 0
 v_mov_b32 v227, 0
 v_mfma_f32_16x16x32_bf16 v[180:183], a[168:171], v[20:23], v[180:183]
 s_waitcnt lgkmcnt(5)
 ds_read_b64_tr_b16 a[154:155], v251 offset:18688
 v_mov_b32 v228, 0
 v_mfma_f32_16x16x32_bf16 v[148:151], a[172:175], v[28:31], v[148:151]
 ds_read_b64_tr_b16 a[156:157], v252 offset:18432
 v_mov_b32 v229, 0
 v_mov_b32 v230, 0
 v_mfma_f32_16x16x32_bf16 v[144:147], a[172:175], v[24:27], v[144:147]
 s_waitcnt lgkmcnt(5)
 ds_read_b64_tr_b16 a[158:159], v252 offset:18688
 v_mov_b32 v231, 0
 v_mfma_f32_16x16x32_bf16 v[152:155], a[144:147], v[24:27], v[152:155]
 ds_read_b64_tr_b16 a[160:161], v248 offset:24576
 v_mov_b32 v232, 0
 v_mov_b32 v233, 0
 v_mfma_f32_16x16x32_bf16 v[156:159], a[144:147], v[28:31], v[156:159]
 s_waitcnt lgkmcnt(5)
 ds_read_b64_tr_b16 a[162:163], v248 offset:24832
 v_mov_b32 v234, 0
 v_mfma_f32_16x16x32_bf16 v[164:167], a[148:151], v[28:31], v[164:167]
 buffer_load_dword a200, v254, s[44:47], 0 offen offset:384
 ds_read_b64_tr_b16 a[164:165], v249 offset:24576
 v_mov_b32 v235, 0
 v_mov_b32 v236, 0
 v_mfma_f32_16x16x32_bf16 v[160:163], a[148:151], v[24:27], v[160:163]
 s_waitcnt lgkmcnt(5)
 ds_read_b64_tr_b16 a[166:167], v249 offset:24832
 v_mov_b32 v237, 0
 v_mfma_f32_16x16x32_bf16 v[168:171], a[152:155], v[24:27], v[168:171]
 ds_read_b64_tr_b16 a[168:169], v250 offset:24576
 v_mov_b32 v238, 0
 v_mov_b32 v239, 0
 v_mfma_f32_16x16x32_bf16 v[172:175], a[152:155], v[28:31], v[172:175]
 s_waitcnt lgkmcnt(5)
 ds_read_b64_tr_b16 a[170:171], v250 offset:24832
 v_mov_b32 v240, 0
 v_mfma_f32_16x16x32_bf16 v[180:183], a[156:159], v[28:31], v[180:183]
 ds_read_b64_tr_b16 a[172:173], v251 offset:24576
 v_mov_b32 v241, 0
 v_mov_b32 v242, 0
 v_mfma_f32_16x16x32_bf16 v[176:179], a[156:159], v[24:27], v[176:179]
 s_waitcnt lgkmcnt(5)
 ds_read_b64_tr_b16 a[174:175], v251 offset:24832
 v_mov_b32 v243, 0
 v_mfma_f32_16x16x32_bf16 v[144:147], a[160:163], v[32:35], v[144:147]
 ds_read_b64_tr_b16 a[144:145], v252 offset:24576
 v_mov_b32 v244, 0
 v_mov_b32 v245, 0
 v_mfma_f32_16x16x32_bf16 v[148:151], a[160:163], v[36:39], v[148:151]
 s_waitcnt lgkmcnt(5)
 ds_read_b64_tr_b16 a[146:147], v252 offset:24832
 v_mov_b32 v246, 0
 v_mfma_f32_16x16x32_bf16 v[156:159], a[164:167], v[36:39], v[156:159]
 ds_read_b64_tr_b16 a[148:149], v248 offset:30720
 v_mov_b32 v247, 0
 s_mov_b32 s48, s20
 v_mfma_f32_16x16x32_bf16 v[152:155], a[164:167], v[32:35], v[152:155]
 s_waitcnt lgkmcnt(5)
 ds_read_b64_tr_b16 a[150:151], v248 offset:30976
 s_mov_b32 s49, s21
 v_mfma_f32_16x16x32_bf16 v[160:163], a[168:171], v[32:35], v[160:163]
 ds_read_b64_tr_b16 a[152:153], v249 offset:30720
 s_mov_b32 s50, 2359296
 s_mov_b32 s51, 0x20000
 v_mfma_f32_16x16x32_bf16 v[164:167], a[168:171], v[36:39], v[164:167]
 s_waitcnt lgkmcnt(5)
 ds_read_b64_tr_b16 a[154:155], v249 offset:30976
 s_mov_b32 s40, s12
 v_mfma_f32_16x16x32_bf16 v[172:175], a[172:175], v[36:39], v[172:175]
 ds_read_b64_tr_b16 a[156:157], v250 offset:30720
 s_mov_b32 s41, s13
 s_mov_b32 s42, 663552
 v_mfma_f32_16x16x32_bf16 v[168:171], a[172:175], v[32:35], v[168:171]
 s_waitcnt lgkmcnt(5)
 ds_read_b64_tr_b16 a[158:159], v250 offset:30976
 s_mov_b32 s43, 0x20000
 v_mfma_f32_16x16x32_bf16 v[176:179], a[144:147], v[32:35], v[176:179]
 ds_read_b64_tr_b16 a[160:161], v251 offset:30720
 s_mul_i32 s67, s61, 663552
 s_add_u32 s36, s18, s67
 s_addc_u32 s37, s19, 0
 v_mfma_f32_16x16x32_bf16 v[180:183], a[144:147], v[36:39], v[180:183]
 s_waitcnt lgkmcnt(5)
 ds_read_b64_tr_b16 a[162:163], v251 offset:30976
 s_mov_b32 s38, 663552
 v_mfma_f32_16x16x32_bf16 v[148:151], a[148:151], v[44:47], v[148:151]
 ds_read_b64_tr_b16 a[164:165], v252 offset:30720
 s_mov_b32 s39, 0x20000
 s_add_u32 s67, s61, 1
 v_mfma_f32_16x16x32_bf16 v[144:147], a[148:151], v[40:43], v[144:147]
 s_waitcnt lgkmcnt(5)
 ds_read_b64_tr_b16 a[166:167], v252 offset:30976
 s_and_b32 s67, s67, 7
 v_mfma_f32_16x16x32_bf16 v[152:155], a[152:155], v[40:43], v[152:155]
 ds_read_b64_tr_b16 a[168:169], v248 offset:36864
 s_lshl_b32 s80, s67, 7
 s_add_u32 s67, s61, 2
 v_mfma_f32_16x16x32_bf16 v[156:159], a[152:155], v[44:47], v[156:159]
 s_waitcnt lgkmcnt(5)
 ds_read_b64_tr_b16 a[170:171], v248 offset:37120
 s_and_b32 s67, s67, 7
 v_mfma_f32_16x16x32_bf16 v[164:167], a[156:159], v[44:47], v[164:167]
 ds_read_b64_tr_b16 a[172:173], v249 offset:36864
 s_lshl_b32 s81, s67, 7
 s_add_u32 s67, s61, 3
 v_mfma_f32_16x16x32_bf16 v[160:163], a[156:159], v[40:43], v[160:163]
 s_waitcnt lgkmcnt(5)
 ds_read_b64_tr_b16 a[174:175], v249 offset:37120
 s_and_b32 s67, s67, 7
 v_mfma_f32_16x16x32_bf16 v[168:171], a[160:163], v[40:43], v[168:171]
 ds_read_b64_tr_b16 a[144:145], v250 offset:36864
 s_lshl_b32 s82, s67, 7
 s_add_u32 s67, s61, 4
 v_mfma_f32_16x16x32_bf16 v[172:175], a[160:163], v[44:47], v[172:175]
 s_waitcnt lgkmcnt(5)
 ds_read_b64_tr_b16 a[146:147], v250 offset:37120
 s_and_b32 s67, s67, 7
 v_mfma_f32_16x16x32_bf16 v[180:183], a[164:167], v[44:47], v[180:183]
 ds_read_b64_tr_b16 a[148:149], v251 offset:36864
 s_lshl_b32 s83, s67, 7
 s_add_u32 s67, s61, 5
 v_mfma_f32_16x16x32_bf16 v[176:179], a[164:167], v[40:43], v[176:179]
 s_waitcnt lgkmcnt(5)
 ds_read_b64_tr_b16 a[150:151], v251 offset:37120
 s_and_b32 s67, s67, 7
 v_mfma_f32_16x16x32_bf16 v[144:147], a[168:171], v[48:51], v[144:147]
 ds_read_b64_tr_b16 a[152:153], v252 offset:36864
 s_lshl_b32 s84, s67, 7
 s_add_u32 s67, s61, 6
 v_mfma_f32_16x16x32_bf16 v[148:151], a[168:171], v[52:55], v[148:151]
 s_waitcnt lgkmcnt(5)
 ds_read_b64_tr_b16 a[154:155], v252 offset:37120
 s_and_b32 s67, s67, 7
 v_mfma_f32_16x16x32_bf16 v[156:159], a[172:175], v[52:55], v[156:159]
 buffer_load_dword a200, v254, s[44:47], 0 offen offset:512
 ds_read_b64_tr_b16 a[156:157], v248 offset:43008
 s_lshl_b32 s85, s67, 7
 s_add_u32 s67, s61, 7
 v_mfma_f32_16x16x32_bf16 v[152:155], a[172:175], v[48:51], v[152:155]
 s_waitcnt lgkmcnt(5)
 ds_read_b64_tr_b16 a[158:159], v248 offset:43264
 s_and_b32 s67, s67, 7
 v_mfma_f32_16x16x32_bf16 v[160:163], a[144:147], v[48:51], v[160:163]
 ds_read_b64_tr_b16 a[160:161], v249 offset:43008
 s_lshl_b32 s86, s67, 7
 s_mov_b32 s87, 1024
 v_mfma_f32_16x16x32_bf16 v[164:167], a[144:147], v[52:55], v[164:167]
 s_waitcnt lgkmcnt(5)
 ds_read_b64_tr_b16 a[162:163], v249 offset:43264
 s_mov_b32 s88, s72
 v_mfma_f32_16x16x32_bf16 v[172:175], a[148:151], v[52:55], v[172:175]
 ds_read_b64_tr_b16 a[164:165], v250 offset:43008
 v_bfe_u32 v0, v255, 2, 3
 s_and_b32 s67, s63, 1
 v_mfma_f32_16x16x32_bf16 v[168:171], a[148:151], v[48:51], v[168:171]
 s_waitcnt lgkmcnt(5)
 ds_read_b64_tr_b16 a[166:167], v250 offset:43264
 s_lshr_b32 s68, s63, 1
 v_mfma_f32_16x16x32_bf16 v[176:179], a[152:155], v[48:51], v[176:179]
 ds_read_b64_tr_b16 a[168:169], v251 offset:43008
 s_mul_i32 s69, s67, 18
 s_lshl_b32 s70, s68, 3
 v_mfma_f32_16x16x32_bf16 v[180:183], a[152:155], v[52:55], v[180:183]
 s_waitcnt lgkmcnt(5)
 ds_read_b64_tr_b16 a[170:171], v251 offset:43264
 s_add_u32 s69, s69, s70
 v_mfma_f32_16x16x32_bf16 v[148:151], a[156:159], v[60:63], v[148:151]
 ds_read_b64_tr_b16 a[172:173], v252 offset:43008
 v_add_u32 v1, s69, v0
 v_mul_u32_u24 v3, 1152, v1
 v_mfma_f32_16x16x32_bf16 v[144:147], a[156:159], v[56:59], v[144:147]
 s_waitcnt lgkmcnt(5)
 ds_read_b64_tr_b16 a[174:175], v252 offset:43264
 v_lshrrev_b32 v2, 5, v255
 v_mfma_f32_16x16x32_bf16 v[152:155], a[160:163], v[56:59], v[152:155]
 ds_read_b64_tr_b16 a[144:145], v248 offset:49152
 v_lshl_add_u32 v3, v2, 6, v3
 v_and_b32 v2, 3, v255
 v_mfma_f32_16x16x32_bf16 v[156:159], a[160:163], v[60:63], v[156:159]
 s_waitcnt lgkmcnt(5)
 ds_read_b64_tr_b16 a[146:147], v248 offset:49408
 v_add_u32 v248, 55296, v248
 v_lshl_add_u32 v3, v2, 4, v3
 v_mfma_f32_16x16x32_bf16 v[164:167], a[164:167], v[60:63], v[164:167]
 ds_read_b64_tr_b16 a[148:149], v249 offset:49152
 v_and_b32 v2, 16, v255
 v_lshlrev_b32 v2, 1, v2
 v_mfma_f32_16x16x32_bf16 v[160:163], a[164:167], v[56:59], v[160:163]
 s_waitcnt lgkmcnt(5)
 ds_read_b64_tr_b16 a[150:151], v249 offset:49408
 v_add_u32 v249, 55296, v249
 v_xor_b32 v3, v3, v2
 v_mfma_f32_16x16x32_bf16 v[168:171], a[168:171], v[56:59], v[168:171]
 ds_read_b64_tr_b16 a[152:153], v250 offset:49152
 v_accvgpr_write_b32 a205, v3
 v_lshrrev_b32 v1, 2, v0
 v_mfma_f32_16x16x32_bf16 v[172:175], a[168:171], v[60:63], v[172:175]
 s_waitcnt lgkmcnt(5)
 ds_read_b64_tr_b16 a[154:155], v250 offset:49408
 v_add_u32 v250, 55296, v250
 v_mul_u32_u24 v1, 72, v1
 v_mfma_f32_16x16x32_bf16 v[180:183], a[172:175], v[60:63], v[180:183]
 ds_read_b64_tr_b16 a[156:157], v251 offset:49152
 v_bfe_u32 v2, v0, 1, 1
 v_mul_u32_u24 v2, 18, v2
 v_mfma_f32_16x16x32_bf16 v[176:179], a[172:175], v[56:59], v[176:179]
 s_waitcnt lgkmcnt(5)
 ds_read_b64_tr_b16 a[158:159], v251 offset:49408
 v_add_u32 v251, 55296, v251
 v_add_u32 v1, v1, v2
 v_mfma_f32_16x16x32_bf16 v[144:147], a[144:147], v[64:67], v[144:147]
 ds_read_b64_tr_b16 a[160:161], v252 offset:49152
 v_and_b32 v2, 1, v0
 v_add3_u32 v4, v1, v2, 16
 v_mfma_f32_16x16x32_bf16 v[148:151], a[144:147], v[68:71], v[148:151]
 s_waitcnt lgkmcnt(5)
 ds_read_b64_tr_b16 a[162:163], v252 offset:49408
 v_add_u32 v252, 55296, v252
 s_mul_i32 s69, s67, 144
 v_mfma_f32_16x16x32_bf16 v[156:159], a[148:151], v[68:71], v[156:159]
 ds_read_b64_tr_b16 a[164:165], v248 offset:0
 s_mul_i32 s70, s68, 36
 s_add_u32 s69, s69, s70
 v_mfma_f32_16x16x32_bf16 v[152:155], a[148:151], v[64:67], v[152:155]
 s_waitcnt lgkmcnt(5)
 ds_read_b64_tr_b16 a[166:167], v248 offset:256
 v_add_u32 v1, s69, v4
 v_mfma_f32_16x16x32_bf16 v[160:163], a[152:155], v[64:67], v[160:163]
 ds_read_b64_tr_b16 a[168:169], v249 offset:0
 v_mul_u32_u24 v3, 1152, v1
 v_lshrrev_b32 v2, 5, v255
 v_mfma_f32_16x16x32_bf16 v[164:167], a[152:155], v[68:71], v[164:167]
 s_waitcnt lgkmcnt(5)
 ds_read_b64_tr_b16 a[170:171], v249 offset:256
 v_lshl_add_u32 v3, v2, 6, v3
 v_mfma_f32_16x16x32_bf16 v[172:175], a[156:159], v[68:71], v[172:175]
 ds_read_b64_tr_b16 a[172:173], v250 offset:0
 v_and_b32 v2, 3, v255
 v_lshl_add_u32 v3, v2, 4, v3
 v_mfma_f32_16x16x32_bf16 v[168:171], a[156:159], v[64:67], v[168:171]
 s_waitcnt lgkmcnt(5)
 ds_read_b64_tr_b16 a[174:175], v250 offset:256
 v_and_b32 v2, 16, v255
 v_mfma_f32_16x16x32_bf16 v[176:179], a[160:163], v[64:67], v[176:179]
 ds_read_b64_tr_b16 a[144:145], v251 offset:0
 v_lshlrev_b32 v2, 1, v2
 v_mfma_f32_16x16x32_bf16 v[180:183], a[160:163], v[68:71], v[180:183]
 s_waitcnt lgkmcnt(5)
 ds_read_b64_tr_b16 a[146:147], v251 offset:256
 v_xor_b32 v3, v3, v2
 v_accvgpr_write_b32 a206, v3
 v_mfma_f32_16x16x32_bf16 v[148:151], a[164:167], v[76:79], v[148:151]
 buffer_load_dword a200, v254, s[44:47], 0 offen offset:640
 ds_read_b64_tr_b16 a[148:149], v252 offset:0
 v_lshrrev_b32 v5, 5, v255
 v_mfma_f32_16x16x32_bf16 v[144:147], a[164:167], v[72:75], v[144:147]
 s_waitcnt lgkmcnt(5)
 ds_read_b64_tr_b16 a[150:151], v252 offset:256
 s_mul_i32 s69, s68, 36
 s_lshl_b32 s70, s67, 3
 v_mfma_f32_16x16x32_bf16 v[152:155], a[168:171], v[72:75], v[152:155]
 ds_read_b64_tr_b16 a[152:153], v248 offset:6144
 s_add_u32 s69, s69, s70
 v_mfma_f32_16x16x32_bf16 v[156:159], a[168:171], v[76:79], v[156:159]
 s_waitcnt lgkmcnt(5)
 ds_read_b64_tr_b16 a[154:155], v248 offset:6400
 v_mul_u32_u24 v1, 18, v5
 v_add3_u32 v1, v1, v0, s69
 v_mfma_f32_16x16x32_bf16 v[164:167], a[172:175], v[76:79], v[164:167]
 ds_read_b64_tr_b16 a[156:157], v249 offset:6144
 v_lshlrev_b32 v6, 6, v5
 v_mfma_f32_16x16x32_bf16 v[160:163], a[172:175], v[72:75], v[160:163]
 s_waitcnt lgkmcnt(5)
 ds_read_b64_tr_b16 a[158:159], v249 offset:6400
 v_mul_u32_u24 v3, 1152, v1
 v_lshrrev_b32 v2, 5, v255
 v_mfma_f32_16x16x32_bf16 v[168:171], a[144:147], v[72:75], v[168:171]
 ds_read_b64_tr_b16 a[160:161], v250 offset:6144
 v_lshl_add_u32 v3, v2, 6, v3
 v_mfma_f32_16x16x32_bf16 v[172:175], a[144:147], v[76:79], v[172:175]
 s_waitcnt lgkmcnt(5)
 ds_read_b64_tr_b16 a[162:163], v250 offset:6400
 v_and_b32 v2, 3, v255
 v_lshl_add_u32 v3, v2, 4, v3
 v_mfma_f32_16x16x32_bf16 v[180:183], a[148:151], v[76:79], v[180:183]
 ds_read_b64_tr_b16 a[164:165], v251 offset:6144
 v_and_b32 v2, 16, v255
 v_mfma_f32_16x16x32_bf16 v[176:179], a[148:151], v[72:75], v[176:179]
 s_waitcnt lgkmcnt(5)
 ds_read_b64_tr_b16 a[166:167], v251 offset:6400
 v_lshlrev_b32 v2, 1, v2
 v_xor_b32 v3, v3, v2
 v_mfma_f32_16x16x32_bf16 v[144:147], a[152:155], v[80:83], v[144:147]
 ds_read_b64_tr_b16 a[168:169], v252 offset:6144
 v_sub_u32 v3, v3, v6
 v_mfma_f32_16x16x32_bf16 v[148:151], a[152:155], v[84:87], v[148:151]
 s_waitcnt lgkmcnt(5)
 ds_read_b64_tr_b16 a[170:171], v252 offset:6400
 v_accvgpr_write_b32 a207, v3
 s_mul_i32 s69, s68, 288
 v_mfma_f32_16x16x32_bf16 v[156:159], a[156:159], v[84:87], v[156:159]
 ds_read_b64_tr_b16 a[172:173], v248 offset:12288
 s_mul_i32 s70, s67, 36
 v_mfma_f32_16x16x32_bf16 v[152:155], a[156:159], v[80:83], v[152:155]
 s_waitcnt lgkmcnt(5)
 ds_read_b64_tr_b16 a[174:175], v248 offset:12544
 s_add_u32 s69, s69, s70
 v_mul_u32_u24 v1, 144, v5
 v_mfma_f32_16x16x32_bf16 v[160:163], a[160:163], v[80:83], v[160:163]
 ds_read_b64_tr_b16 a[144:145], v249 offset:12288
 v_add3_u32 v1, v1, v4, s69
 v_mfma_f32_16x16x32_bf16 v[164:167], a[160:163], v[84:87], v[164:167]
 s_waitcnt lgkmcnt(5)
 ds_read_b64_tr_b16 a[146:147], v249 offset:12544
 v_mul_u32_u24 v3, 1152, v1
 v_lshrrev_b32 v2, 5, v255
 v_mfma_f32_16x16x32_bf16 v[172:175], a[164:167], v[84:87], v[172:175]
 ds_read_b64_tr_b16 a[148:149], v250 offset:12288
 v_lshl_add_u32 v3, v2, 6, v3
 v_mfma_f32_16x16x32_bf16 v[168:171], a[164:167], v[80:83], v[168:171]
 s_waitcnt lgkmcnt(5)
 ds_read_b64_tr_b16 a[150:151], v250 offset:12544
 v_and_b32 v2, 3, v255
 v_lshl_add_u32 v3, v2, 4, v3
 v_mfma_f32_16x16x32_bf16 v[176:179], a[168:171], v[80:83], v[176:179]
 ds_read_b64_tr_b16 a[152:153], v251 offset:12288
 v_and_b32 v2, 16, v255
 v_mfma_f32_16x16x32_bf16 v[180:183], a[168:171], v[84:87], v[180:183]
 s_waitcnt lgkmcnt(5)
 ds_read_b64_tr_b16 a[154:155], v251 offset:12544
 v_lshlrev_b32 v2, 1, v2
 v_xor_b32 v3, v3, v2
 v_mfma_f32_16x16x32_bf16 v[148:151], a[172:175], v[92:95], v[148:151]
 ds_read_b64_tr_b16 a[156:157], v252 offset:12288
 v_sub_u32 v3, v3, v6
 v_mfma_f32_16x16x32_bf16 v[144:147], a[172:175], v[88:91], v[144:147]
 s_waitcnt lgkmcnt(5)
 ds_read_b64_tr_b16 a[158:159], v252 offset:12544
 v_accvgpr_write_b32 a208, v3
 v_bfe_u32 v2, v255, 2, 2
 v_mfma_f32_16x16x32_bf16 v[152:155], a[144:147], v[88:91], v[152:155]
 ds_read_b64_tr_b16 a[160:161], v248 offset:18432
 v_lshlrev_b32 v3, 6, v2
 v_mfma_f32_16x16x32_bf16 v[156:159], a[144:147], v[92:95], v[156:159]
 s_waitcnt lgkmcnt(5)
 ds_read_b64_tr_b16 a[162:163], v248 offset:18688
 v_and_b32 v2, 3, v255
 v_lshl_add_u32 v3, v2, 3, v3
 v_mfma_f32_16x16x32_bf16 v[164:167], a[148:151], v[92:95], v[164:167]
 ds_read_b64_tr_b16 a[164:165], v249 offset:18432
 v_bfe_u32 v2, v255, 4, 1
 v_mfma_f32_16x16x32_bf16 v[160:163], a[148:151], v[88:91], v[160:163]
 s_waitcnt lgkmcnt(5)
 ds_read_b64_tr_b16 a[166:167], v249 offset:18688
 v_mul_u32_u24 v2, 288, v2
 v_add_u32 v3, v3, v2
 v_mfma_f32_16x16x32_bf16 v[168:171], a[152:155], v[88:91], v[168:171]
 ds_read_b64_tr_b16 a[168:169], v250 offset:18432
 v_lshrrev_b32 v2, 5, v255
 v_mfma_f32_16x16x32_bf16 v[172:175], a[152:155], v[92:95], v[172:175]
 s_waitcnt lgkmcnt(5)
 ds_read_b64_tr_b16 a[170:171], v250 offset:18688
 v_lshl_add_u32 v3, v2, 10, v3
 v_accvgpr_write_b32 a209, v3
 v_mfma_f32_16x16x32_bf16 v[180:183], a[156:159], v[92:95], v[180:183]
 buffer_load_dword a200, v254, s[44:47], 0 offen offset:768
 ds_read_b64_tr_b16 a[172:173], v251 offset:18432
 v_lshlrev_b32 v2, 9, v5
 v_mfma_f32_16x16x32_bf16 v[176:179], a[156:159], v[88:91], v[176:179]
 s_waitcnt lgkmcnt(5)
 ds_read_b64_tr_b16 a[174:175], v251 offset:18688
 v_sub_u32 v3, v3, v2
 s_and_b32 s67, s61, 1
 v_mfma_f32_16x16x32_bf16 v[144:147], a[160:163], v[96:99], v[144:147]
 ds_read_b64_tr_b16 a[144:145], v252 offset:18432
 s_lshl_b32 s67, s67, 5
 v_mfma_f32_16x16x32_bf16 v[148:151], a[160:163], v[100:103], v[148:151]
 s_waitcnt lgkmcnt(5)
 ds_read_b64_tr_b16 a[146:147], v252 offset:18688
 v_xor_b32 v3, s67, v3
 v_add_u32 v3, 73728, v3
 v_mfma_f32_16x16x32_bf16 v[156:159], a[164:167], v[100:103], v[156:159]
 ds_read_b64_tr_b16 a[148:149], v248 offset:24576
 v_accvgpr_write_b32 a210, v3
 v_mfma_f32_16x16x32_bf16 v[152:155], a[164:167], v[96:99], v[152:155]
 s_waitcnt lgkmcnt(5)
 ds_read_b64_tr_b16 a[150:151], v248 offset:24832
 v_and_b32 v1, 15, v255
 v_mul_u32_u24 v1, 1152, v1
 v_mfma_f32_16x16x32_bf16 v[160:163], a[168:171], v[96:99], v[160:163]
 ds_read_b64_tr_b16 a[152:153], v249 offset:24576
 v_lshrrev_b32 v2, 4, v255
 v_mfma_f32_16x16x32_bf16 v[164:167], a[168:171], v[100:103], v[164:167]
 s_waitcnt lgkmcnt(5)
 ds_read_b64_tr_b16 a[154:155], v249 offset:24832
 v_lshl_add_u32 v1, v2, 3, v1
 v_add_u32 v1, s66, v1
 v_mfma_f32_16x16x32_bf16 v[172:175], a[172:175], v[100:103], v[172:175]
 ds_read_b64_tr_b16 a[156:157], v250 offset:24576
 v_accvgpr_write_b32 a211, v1
 v_mfma_f32_16x16x32_bf16 v[168:171], a[172:175], v[96:99], v[168:171]
 s_waitcnt lgkmcnt(5)
 ds_read_b64_tr_b16 a[158:159], v250 offset:24832
 s_lshl_b32 s91, s60, 2
 s_add_u32 s91, s91, s63
 v_mfma_f32_16x16x32_bf16 v[176:179], a[144:147], v[96:99], v[176:179]
 ds_read_b64_tr_b16 a[160:161], v251 offset:24576
 s_mul_i32 s91, s91, 36864
 v_mfma_f32_16x16x32_bf16 v[180:183], a[144:147], v[100:103], v[180:183]
 s_waitcnt lgkmcnt(5)
 ds_read_b64_tr_b16 a[162:163], v251 offset:24832
 s_add_u32 s91, s91, 229376
 s_lshl_b32 s92, s61, 12
 v_mfma_f32_16x16x32_bf16 v[148:151], a[148:151], v[108:111], v[148:151]
 ds_read_b64_tr_b16 a[164:165], v252 offset:24576
 s_add_u32 s92, s92, s91
 v_mfma_f32_16x16x32_bf16 v[144:147], a[148:151], v[104:107], v[144:147]
 s_waitcnt lgkmcnt(5)
 ds_read_b64_tr_b16 a[166:167], v252 offset:24832
 s_lshr_b32 s93, s61, 2
 s_lshl_b32 s93, s93, 11
 v_mfma_f32_16x16x32_bf16 v[152:155], a[152:155], v[104:107], v[152:155]
 ds_read_b64_tr_b16 a[168:169], v248 offset:30720
 s_add_u32 s93, s93, s91
 v_mfma_f32_16x16x32_bf16 v[156:159], a[152:155], v[108:111], v[156:159]
 s_waitcnt lgkmcnt(5)
 ds_read_b64_tr_b16 a[170:171], v248 offset:30976
 s_and_b32 s67, s61, 3
 s_lshl_b32 s67, s67, 8
 v_mfma_f32_16x16x32_bf16 v[164:167], a[156:159], v[108:111], v[164:167]
 ds_read_b64_tr_b16 a[172:173], v249 offset:30720
 s_add_u32 s93, s93, s67
 v_mfma_f32_16x16x32_bf16 v[160:163], a[156:159], v[104:107], v[160:163]
 s_waitcnt lgkmcnt(5)
 ds_read_b64_tr_b16 a[174:175], v249 offset:30976
 s_add_u32 s93, s93, 32768
 s_mul_i32 s94, s60, 1179648
 v_mfma_f32_16x16x32_bf16 v[168:171], a[160:163], v[104:107], v[168:171]
 ds_read_b64_tr_b16 a[144:145], v250 offset:30720
 s_mul_i32 s67, s61, 163840
 v_mfma_f32_16x16x32_bf16 v[172:175], a[160:163], v[108:111], v[172:175]
 s_waitcnt lgkmcnt(5)
 ds_read_b64_tr_b16 a[146:147], v250 offset:30976
 s_add_u32 s94, s94, s67
 s_add_u32 s94, s94, 2621440
 v_mfma_f32_16x16x32_bf16 v[180:183], a[164:167], v[108:111], v[180:183]
 ds_read_b64_tr_b16 a[148:149], v251 offset:30720
 s_lshl_b32 s68, s61, 9
 v_mfma_f32_16x16x32_bf16 v[176:179], a[164:167], v[104:107], v[176:179]
 s_waitcnt lgkmcnt(5)
 ds_read_b64_tr_b16 a[150:151], v251 offset:30976
 s_lshl_b32 s67, s63, 7
 s_add_u32 s67, s67, s68
 v_mfma_f32_16x16x32_bf16 v[144:147], a[168:171], v[112:115], v[144:147]
 ds_read_b64_tr_b16 a[152:153], v252 offset:30720
 s_add_u32 s67, s67, 32
 v_mfma_f32_16x16x32_bf16 v[148:151], a[168:171], v[116:119], v[148:151]
 s_waitcnt lgkmcnt(5)
 ds_read_b64_tr_b16 a[154:155], v252 offset:30976
 v_lshl_add_u32 v3, v255, 9, s67
 v_mov_b32 v1, 67108864
 v_mfma_f32_16x16x32_bf16 v[156:159], a[172:175], v[116:119], v[156:159]
 ds_read_b64_tr_b16 a[156:157], v248 offset:36864
 v_cmp_gt_u32 vcc, 1, v255
 v_mfma_f32_16x16x32_bf16 v[152:155], a[172:175], v[112:115], v[152:155]
 s_waitcnt lgkmcnt(5)
 ds_read_b64_tr_b16 a[158:159], v248 offset:37120
 v_cndmask_b32 v3, v1, v3, vcc
 v_accvgpr_write_b32 a212, v3
 v_mfma_f32_16x16x32_bf16 v[160:163], a[144:147], v[112:115], v[160:163]
 ds_read_b64_tr_b16 a[160:161], v249 offset:36864
 v_bfe_u32 v1, v255, 4, 1
 v_mfma_f32_16x16x32_bf16 v[164:167], a[144:147], v[116:119], v[164:167]
 s_waitcnt lgkmcnt(5)
 ds_read_b64_tr_b16 a[162:163], v249 offset:37120
 v_lshlrev_b32 v1, 10, v1
 v_lshrrev_b32 v2, 5, v255
 v_mfma_f32_16x16x32_bf16 v[172:175], a[148:151], v[116:119], v[172:175]
 ds_read_b64_tr_b16 a[164:165], v250 offset:36864
 v_lshl_add_u32 v1, v2, 8, v1
 v_mfma_f32_16x16x32_bf16 v[168:171], a[148:151], v[112:115], v[168:171]
 s_waitcnt lgkmcnt(5)
 ds_read_b64_tr_b16 a[166:167], v250 offset:37120
 v_and_b32 v2, 15, v255
 v_lshl_add_u32 v3, v2, 4, v1
 v_mfma_f32_16x16x32_bf16 v[176:179], a[152:155], v[112:115], v[176:179]
 ds_read_b64_tr_b16 a[168:169], v251 offset:36864
 v_accvgpr_write_b32 a214, v3
 v_mfma_f32_16x16x32_bf16 v[180:183], a[152:155], v[116:119], v[180:183]
 s_waitcnt lgkmcnt(5)
 ds_read_b64_tr_b16 a[170:171], v251 offset:37120
 v_accvgpr_write_b32 a222, -1
 v_accvgpr_write_b32 a223, -1
 v_mfma_f32_16x16x32_bf16 v[148:151], a[156:159], v[124:127], v[148:151]
 ds_read_b64_tr_b16 a[172:173], v252 offset:36864
 v_accvgpr_write_b32 a224, -1
 v_mfma_f32_16x16x32_bf16 v[144:147], a[156:159], v[120:123], v[144:147]
 s_waitcnt lgkmcnt(5)
 ds_read_b64_tr_b16 a[174:175], v252 offset:37120
 v_accvgpr_write_b32 a225, -1
 s_mov_b32 s26, 0x87
 v_mfma_f32_16x16x32_bf16 v[152:155], a[160:163], v[120:123], v[152:155]
 ds_read_b64_tr_b16 a[144:145], v248 offset:43008
 s_mov_b32 s27, 0x800000
 v_mfma_f32_16x16x32_bf16 v[156:159], a[160:163], v[124:127], v[156:159]
 s_waitcnt lgkmcnt(5)
 ds_read_b64_tr_b16 a[146:147], v248 offset:43264
 s_lshr_b32 s67, s80, 7
 s_lshl_b32 s67, s67, 8
 v_mfma_f32_16x16x32_bf16 v[164:167], a[164:167], v[124:127], v[164:167]
 ds_read_b64_tr_b16 a[148:149], v249 offset:43008
 s_or_b32 s26, s26, s67
 v_mfma_f32_16x16x32_bf16 v[160:163], a[164:167], v[120:123], v[160:163]
 s_waitcnt lgkmcnt(5)
 ds_read_b64_tr_b16 a[150:151], v249 offset:43264
 s_lshr_b32 s67, s81, 7
 s_lshl_b32 s67, s67, 12
 v_mfma_f32_16x16x32_bf16 v[168:171], a[168:171], v[120:123], v[168:171]
 ds_read_b64_tr_b16 a[152:153], v250 offset:43008
 s_or_b32 s26, s26, s67
 v_mfma_f32_16x16x32_bf16 v[172:175], a[168:171], v[124:127], v[172:175]
 s_waitcnt lgkmcnt(5)
 ds_read_b64_tr_b16 a[154:155], v250 offset:43264
 s_lshr_b32 s67, s82, 7
 s_lshl_b32 s67, s67, 16
 v_mfma_f32_16x16x32_bf16 v[180:183], a[172:175], v[124:127], v[180:183]
 buffer_load_dword a220, off, s[56:59], s14 sc1
 ds_read_b64_tr_b16 a[156:157], v251 offset:43008
 s_or_b32 s26, s26, s67
 v_mfma_f32_16x16x32_bf16 v[176:179], a[172:175], v[120:123], v[176:179]
 s_waitcnt lgkmcnt(5)
 ds_read_b64_tr_b16 a[158:159], v251 offset:43264
 s_lshr_b32 s67, s83, 7
 s_lshl_b32 s67, s67, 20
 v_mfma_f32_16x16x32_bf16 v[144:147], a[144:147], v[128:131], v[144:147]
 ds_read_b64_tr_b16 a[160:161], v252 offset:43008
 s_or_b32 s26, s26, s67
 v_mfma_f32_16x16x32_bf16 v[148:151], a[144:147], v[132:135], v[148:151]
 s_waitcnt lgkmcnt(5)
 ds_read_b64_tr_b16 a[162:163], v252 offset:43264
 s_lshr_b32 s67, s84, 7
 s_lshl_b32 s67, s67, 24
 v_mfma_f32_16x16x32_bf16 v[156:159], a[148:151], v[132:135], v[156:159]
 ds_read_b64_tr_b16 a[164:165], v248 offset:49152
 s_or_b32 s26, s26, s67
 v_mfma_f32_16x16x32_bf16 v[152:155], a[148:151], v[128:131], v[152:155]
 s_waitcnt lgkmcnt(5)
 ds_read_b64_tr_b16 a[166:167], v248 offset:49408
 s_lshr_b32 s67, s85, 7
 s_lshl_b32 s67, s67, 28
 v_mfma_f32_16x16x32_bf16 v[160:163], a[152:155], v[128:131], v[160:163]
 ds_read_b64_tr_b16 a[168:169], v249 offset:49152
 s_or_b32 s26, s26, s67
 v_mfma_f32_16x16x32_bf16 v[164:167], a[152:155], v[132:135], v[164:167]
 s_waitcnt lgkmcnt(5)
 ds_read_b64_tr_b16 a[170:171], v249 offset:49408
 s_lshr_b32 s67, s86, 7
 s_lshl_b32 s67, s67, 0
 v_mfma_f32_16x16x32_bf16 v[172:175], a[156:159], v[132:135], v[172:175]
 ds_read_b64_tr_b16 a[172:173], v250 offset:49152
 s_or_b32 s27, s27, s67
 v_mfma_f32_16x16x32_bf16 v[168:171], a[156:159], v[128:131], v[168:171]
 s_waitcnt lgkmcnt(5)
 ds_read_b64_tr_b16 a[174:175], v250 offset:49408
 s_lshr_b32 s67, s87, 7
 s_lshl_b32 s67, s67, 4
 v_mfma_f32_16x16x32_bf16 v[176:179], a[160:163], v[128:131], v[176:179]
 ds_read_b64_tr_b16 a[144:145], v251 offset:49152
 s_or_b32 s27, s27, s67
 v_mfma_f32_16x16x32_bf16 v[180:183], a[160:163], v[132:135], v[180:183]
 s_waitcnt lgkmcnt(5)
 ds_read_b64_tr_b16 a[146:147], v251 offset:49408
 s_lshr_b32 s67, s88, 7
 s_lshl_b32 s67, s67, 8
 v_mfma_f32_16x16x32_bf16 v[148:151], a[164:167], v[140:143], v[148:151]
 ds_read_b64_tr_b16 a[148:149], v252 offset:49152
 s_or_b32 s27, s27, s67
 v_mfma_f32_16x16x32_bf16 v[144:147], a[164:167], v[136:139], v[144:147]
 s_waitcnt lgkmcnt(5)
 ds_read_b64_tr_b16 a[150:151], v252 offset:49408
 s_mul_i32 s67, s61, 0x11000
 s_or_b32 s27, s27, s67
 v_mfma_f32_16x16x32_bf16 v[152:155], a[168:171], v[136:139], v[152:155]
 s_mul_i32 s95, s63, 4864
 v_mfma_f32_16x16x32_bf16 v[156:159], a[168:171], v[140:143], v[156:159]
 s_waitcnt lgkmcnt(4)
 s_add_u32 s95, s95, 33792
 s_lshl_b32 s64, s63, 12
 v_mfma_f32_16x16x32_bf16 v[164:167], a[172:175], v[140:143], v[164:167]
 s_lshl_b32 s96, s61, 2
 v_mfma_f32_16x16x32_bf16 v[160:163], a[172:175], v[136:139], v[160:163]
 s_waitcnt lgkmcnt(2)
 s_add_u32 s96, s96, s63
 s_lshl_b32 s96, s96, 7
 v_mfma_f32_16x16x32_bf16 v[168:171], a[144:147], v[136:139], v[168:171]
 s_add_u32 s96, s96, s3
 v_mfma_f32_16x16x32_bf16 v[172:175], a[144:147], v[140:143], v[172:175]
 s_waitcnt lgkmcnt(0)
 s_add_u32 s96, s96, 4096
 v_mfma_f32_16x16x32_bf16 v[180:183], a[148:151], v[140:143], v[180:183]
 v_mfma_f32_16x16x32_bf16 v[176:179], a[148:151], v[136:139], v[176:179]
 v_and_b32 v100, 15, v255
 v_mul_u32_u24 v100, 152, v100
 v_lshrrev_b32 v101, 4, v255
 v_lshl_add_u32 v100, v101, 3, v100
 v_add_u32 v96, s95, v100
 v_and_b32 v100, 31, v255
 v_mul_u32_u24 v100, 152, v100
 v_add_u32 v98, s95, v100
 v_lshrrev_b32 v101, 5, v255
 v_lshl_add_u32 v97, v101, 4, v98
 v_accvgpr_read_b32 v102, a201
 v_accvgpr_read_b32 v103, a201
 v_accvgpr_read_b32 v104, a202
 v_accvgpr_read_b32 v105, a202
 v_pk_mul_f32 v[144:145], v[144:145], v[102:103]
 v_pk_mul_f32 v[146:147], v[146:147], v[102:103]
 v_pk_mul_f32 v[148:149], v[148:149], v[104:105]
 v_pk_mul_f32 v[150:151], v[150:151], v[104:105]
 v_pk_mul_f32 v[152:153], v[152:153], v[102:103]
 v_pk_mul_f32 v[154:155], v[154:155], v[102:103]
 v_pk_mul_f32 v[156:157], v[156:157], v[104:105]
 v_pk_mul_f32 v[158:159], v[158:159], v[104:105]
 v_pk_mul_f32 v[160:161], v[160:161], v[102:103]
 v_pk_mul_f32 v[162:163], v[162:163], v[102:103]
 v_pk_mul_f32 v[164:165], v[164:165], v[104:105]
 v_pk_mul_f32 v[166:167], v[166:167], v[104:105]
 v_pk_mul_f32 v[168:169], v[168:169], v[102:103]
 v_pk_mul_f32 v[170:171], v[170:171], v[102:103]
 v_pk_mul_f32 v[172:173], v[172:173], v[104:105]
 v_pk_mul_f32 v[174:175], v[174:175], v[104:105]
 v_pk_mul_f32 v[176:177], v[176:177], v[102:103]
 v_pk_mul_f32 v[178:179], v[178:179], v[102:103]
 v_pk_mul_f32 v[180:181], v[180:181], v[104:105]
 v_pk_mul_f32 v[182:183], v[182:183], v[104:105]
 v_cvt_pk_bf16_f32 v0, v144, v145
 v_cvt_pk_bf16_f32 v1, v146, v147
 v_cvt_pk_bf16_f32 v2, v148, v149
 v_cvt_pk_bf16_f32 v3, v150, v151
 ds_write_b64 v96, v[0:1] offset:0
 ds_write_b64 v96, v[2:3] offset:2432
 v_cvt_pk_bf16_f32 v4, v152, v153
 v_cvt_pk_bf16_f32 v5, v154, v155
 v_cvt_pk_bf16_f32 v6, v156, v157
 v_cvt_pk_bf16_f32 v7, v158, v159
 ds_write_b64 v96, v[4:5] offset:32
 ds_write_b64 v96, v[6:7] offset:2464
 v_cvt_pk_bf16_f32 v8, v160, v161
 v_cvt_pk_bf16_f32 v9, v162, v163
 v_cvt_pk_bf16_f32 v10, v164, v165
 v_cvt_pk_bf16_f32 v11, v166, v167
 ds_write_b64 v96, v[8:9] offset:64
 ds_write_b64 v96, v[10:11] offset:2496
 v_cvt_pk_bf16_f32 v12, v168, v169
 v_cvt_pk_bf16_f32 v13, v170, v171
 v_cvt_pk_bf16_f32 v14, v172, v173
 v_cvt_pk_bf16_f32 v15, v174, v175
 ds_write_b64 v96, v[12:13] offset:96
 ds_write_b64 v96, v[14:15] offset:2528
 v_cvt_pk_bf16_f32 v16, v176, v177
 v_cvt_pk_bf16_f32 v17, v178, v179
 v_cvt_pk_bf16_f32 v18, v180, v181
 v_cvt_pk_bf16_f32 v19, v182, v183
 s_mov_b32 exec_hi, 0
 ds_write_b64 v96, v[16:17] offset:128
 ds_write_b64 v96, v[18:19] offset:2560
 s_mov_b64 exec, -1
 v_accvgpr_read_b32 v113, a204
 v_lshlrev_b32 v114, 4, v255
 v_lshlrev_b32 v115, 2, v255
 v_add_u32 v113, 64, v113
 s_waitcnt vmcnt(0)
 v_accvgpr_read_b32 v112, a220
 v_cmp_eq_u32 vcc, v112, v113
 s_nop 0
 s_mov_b64 s[70:71], vcc
 s_cbranch_vccz L_kv_late
 s_mov_b32 s65, 163840
 buffer_load_dword v116, v115, s[56:59], s65 offen sc1
 buffer_load_dword v117, v115, s[56:59], s65 offen offset:256 sc1
 s_add_u32 m0, s64, 0
 s_add_u32 s65, s64, 0
 buffer_load_dwordx4 v114, s[56:59], s65 offen offset:0 sc1 lds
 buffer_load_dwordx4 v114, s[56:59], s65 offen offset:1024 sc1 lds
 buffer_load_dwordx4 v114, s[56:59], s65 offen offset:2048 sc1 lds
 buffer_load_dwordx4 v114, s[56:59], s65 offen offset:3072 sc1 lds
 s_add_u32 m0, s64, 16384
 s_add_u32 s65, s64, 16384
 buffer_load_dwordx4 v114, s[56:59], s65 offen offset:0 sc1 lds
 buffer_load_dwordx4 v114, s[56:59], s65 offen offset:1024 sc1 lds
 buffer_load_dwordx4 v114, s[56:59], s65 offen offset:2048 sc1 lds
 buffer_load_dwordx4 v114, s[56:59], s65 offen offset:3072 sc1 lds
L_kv_late:
 s_waitcnt lgkmcnt(0)
 ds_read2_b32 v[144:145], v97 offset0:0 offset1:1
 ds_read2_b32 v[146:147], v97 offset0:2 offset1:3
 ds_read_b32 v32, v98 offset:32
 ds_read2_b32 v[148:149], v97 offset0:9 offset1:10
 ds_read2_b32 v[150:151], v97 offset0:11 offset1:12
 ds_read_b32 v33, v98 offset:68
 ds_read2_b32 v[152:153], v97 offset0:18 offset1:19
 ds_read2_b32 v[154:155], v97 offset0:20 offset1:21
 ds_read_b32 v34, v98 offset:104
 ds_read2_b32 v[156:157], v97 offset0:27 offset1:28
 ds_read2_b32 v[158:159], v97 offset0:29 offset1:30
 ds_read_b32 v35, v98 offset:140
 v_lshlrev_b32 v160, 4, v255
 v_mov_b32 v165, v160
 v_and_b32 v162, 0x1f0, v160
 v_and_b32 v100, 31, v255
 v_subrev_u32 v101, 20, v100
 v_cmp_gt_u32 vcc, 8, v101
 v_min_u32 v100, 19, v100
 s_nop 0
 v_addc_co_u32 v100, vcc, 0, v100, vcc
 v_lshrrev_b32 v101, 5, v255
 v_mul_u32_u24 v101, 336, v101
 v_lshl_add_u32 v161, v100, 4, v101
 v_mov_b32 v163, 0xdddddddd
 v_cmp_gt_u32 vcc, 32, v255
 v_mov_b32 v129, 0
 v_mov_b32 v130, 0
 v_mov_b32 v133, 0
 v_mov_b32 v134, 0
 s_waitcnt lgkmcnt(0)
 v_cndmask_b32 v128, v33, v32, vcc
 v_cndmask_b32 v131, v33, v32, vcc
 v_cndmask_b32 v132, v35, v34, vcc
 v_cndmask_b32 v135, v35, v34, vcc
 v_cndmask_b32 v32, 0, v32, vcc
 v_cndmask_b32 v33, 0, v33, vcc
 v_cndmask_b32 v34, 0, v34, vcc
 v_cndmask_b32 v35, 0, v35, vcc
 v_dot2_f32_bf16 v104, v32, v32, 0
 v_dot2_f32_bf16 v105, v33, v33, 0
 v_dot2_f32_bf16 v106, v34, v34, 0
 v_dot2_f32_bf16 v107, v35, v35, 0
 v_dot2_f32_bf16 v104, v144, v144, v104
 v_dot2_f32_bf16 v105, v148, v148, v105
 v_dot2_f32_bf16 v106, v152, v152, v106
 v_dot2_f32_bf16 v107, v156, v156, v107
 v_dot2_f32_bf16 v104, v145, v145, v104
 v_dot2_f32_bf16 v105, v149, v149, v105
 v_dot2_f32_bf16 v106, v153, v153, v106
 v_dot2_f32_bf16 v107, v157, v157, v107
 v_dot2_f32_bf16 v104, v146, v146, v104
 v_dot2_f32_bf16 v105, v150, v150, v105
 v_dot2_f32_bf16 v106, v154, v154, v106
 v_dot2_f32_bf16 v107, v158, v158, v107
 v_dot2_f32_bf16 v104, v147, v147, v104
 v_dot2_f32_bf16 v105, v151, v151, v105
 v_dot2_f32_bf16 v106, v155, v155, v106
 v_dot2_f32_bf16 v107, v159, v159, v107
 v_mov_b32 v108, v104
 v_mov_b32 v109, v105
 v_mov_b32 v110, v106
 v_mov_b32 v111, v107
 v_permlane32_swap_b32 v104, v108
 v_permlane32_swap_b32 v105, v109
 v_permlane32_swap_b32 v106, v110
 v_permlane32_swap_b32 v107, v111
 v_add_f32 v104, v104, v108
 v_add_f32 v105, v105, v109
 v_add_f32 v106, v106, v110
 v_add_f32 v107, v107, v111
 v_max_f32 v104, v104, v105
 v_max3_f32 v104, v104, v106, v107
 v_accvgpr_read_b32 v170, a203
 v_mov_b32 v171, v254
 s_lshl_b32 s67, s63, 7
 s_add_u32 s67, s67, s61
 s_add_u32 s67, s67, 4096
 v_lshl_add_u32 v166, v255, 9, s67
 v_mov_b32 v101, 67108864
 v_cmp_gt_u32 vcc, 8, v255
 s_nop 1
 v_cndmask_b32 v166, v101, v166, vcc
 v_accvgpr_read_b32 v140, a214
 v_add_u32 v141, s64, v160
 v_mov_b32 v167, s96
 s_cmp_eq_u64 s[70:71], 0
 s_cbranch_scc1 L_pk
L_pk_ret:
 s_waitcnt vmcnt(8)
 v_add_f32 v116, v116, v117
 s_nop 1
 v_max_f32_dpp v116, v116, v116 row_shr:1 row_mask:0xf bank_mask:0xf
 s_nop 1
 v_max_f32_dpp v116, v116, v116 row_shr:2 row_mask:0xf bank_mask:0xf
 s_nop 1
 v_max_f32_dpp v116, v116, v116 row_shr:4 row_mask:0xf bank_mask:0xf
 s_nop 1
 v_max_f32_dpp v116, v116, v116 row_shr:8 row_mask:0xf bank_mask:0xf
 s_nop 1
 v_max_f32_dpp v116, v116, v116 row_bcast:15 row_mask:0xa bank_mask:0xf
 s_nop 1
 v_max_f32_dpp v116, v116, v116 row_bcast:31 row_mask:0xc bank_mask:0xf
 v_mov_b32 v101, 1166016512
 v_readlane_b32 s67, v116, 63
 s_nop 1
 v_mul_f32 v104, s67, v104
 v_cmp_nle_f32 vcc, v104, v101
 s_waitcnt vmcnt(4)
 s_barrier
 s_cbranch_vccnz L_att_fb
 ds_read_b128 a[40:43], v162
 ds_read_b128 a[16:19], v160 offset:512
 s_mov_b32 s74, 1
 s_waitcnt lgkmcnt(1)
 v_mfma_f32_32x32x4_2b_bf16 v[0:31], a[40:41], v[128:129], 0
 s_waitcnt lgkmcnt(0)
 s_nop 15
 s_nop 0
 v_mfma_f32_32x32x16_bf16 v[0:15], a[16:19], v[144:147], v[0:15]
 s_add_u32 m0, s64, 32768
 s_add_u32 s65, s64, 32768
 ds_read_b128 a[24:27], v161 offset:4608
 buffer_load_dwordx4 v165, s[56:59], s65 offen offset:0 sc1 lds
 ds_read_b128 a[28:31], v161 offset:5280
 buffer_load_dwordx4 v165, s[56:59], s65 offen offset:1024 sc1 lds
 v_mfma_f32_32x32x4_2b_bf16 v[32:63], a[40:41], v[132:133], 0
 s_nop 4
 v_exp_f32 v0, v0
 v_exp_f32 v1, v1
 v_exp_f32 v2, v2
 v_exp_f32 v3, v3
 v_mfma_f32_32x32x16_bf16 v[16:31], a[16:19], v[148:151], v[16:31]
 v_exp_f32 v4, v4
 v_exp_f32 v5, v5
 v_exp_f32 v6, v6
 v_exp_f32 v7, v7
 buffer_load_dwordx4 v165, s[56:59], s65 offen offset:2048 sc1 lds
 v_exp_f32 v8, v8
 v_exp_f32 v9, v9
 v_exp_f32 v10, v10
 v_exp_f32 v11, v11
 buffer_load_dwordx4 v165, s[56:59], s65 offen offset:3072 sc1 lds
 v_exp_f32 v12, v12
 v_exp_f32 v13, v13
 v_exp_f32 v14, v14
 v_exp_f32 v15, v15
 v_mfma_f32_32x32x16_bf16 v[32:47], a[16:19], v[152:155], v[32:47]
 s_waitcnt lgkmcnt(0)
 v_exp_f32 v16, v16
 v_exp_f32 v17, v17
 v_exp_f32 v18, v18
 v_exp_f32 v19, v19
 v_smfmac_f32_32x32x32_bf16 v[184:199], a[24:27], v[0:7], v163
 s_add_u32 m0, s64, 49152
 s_add_u32 s65, s64, 49152
 ds_read_b128 a[20:23], v160 offset:1536
 buffer_load_dwordx4 v165, s[56:59], s65 offen offset:0 sc1 lds
 v_exp_f32 v20, v20
 v_exp_f32 v21, v21
 v_exp_f32 v22, v22
 v_exp_f32 v23, v23
 v_smfmac_f32_32x32x32_bf16 v[184:199], a[28:31], v[8:15], v163
 buffer_load_dwordx4 v165, s[56:59], s65 offen offset:1024 sc1 lds
 v_exp_f32 v24, v24
 v_exp_f32 v25, v25
 v_exp_f32 v26, v26
 v_exp_f32 v27, v27
 v_mfma_f32_32x32x4_2b_bf16 v[64:95], a[40:41], v[130:131], 0
 v_exp_f32 v28, v28
 v_exp_f32 v29, v29
 v_exp_f32 v30, v30
 v_exp_f32 v31, v31
 v_exp_f32 v32, v32
 v_exp_f32 v33, v33
 v_exp_f32 v34, v34
 v_exp_f32 v35, v35
 v_mfma_f32_32x32x16_bf16 v[48:63], a[16:19], v[156:159], v[48:63]
 v_exp_f32 v36, v36
 v_exp_f32 v37, v37
 v_exp_f32 v38, v38
 v_exp_f32 v39, v39
 v_smfmac_f32_32x32x32_bf16 v[200:215], a[24:27], v[16:23], v163
 buffer_load_dwordx4 v165, s[56:59], s65 offen offset:2048 sc1 lds
 v_exp_f32 v40, v40
 v_exp_f32 v41, v41
 v_exp_f32 v42, v42
 v_exp_f32 v43, v43
 v_smfmac_f32_32x32x32_bf16 v[200:215], a[28:31], v[24:31], v163
 s_waitcnt lgkmcnt(0)
 buffer_load_dwordx4 v165, s[56:59], s65 offen offset:3072 sc1 lds
 v_exp_f32 v44, v44
 v_exp_f32 v45, v45
 v_exp_f32 v46, v46
 v_exp_f32 v47, v47
 v_mfma_f32_32x32x16_bf16 v[64:79], a[20:23], v[144:147], v[64:79]
 v_exp_f32 v48, v48
 v_exp_f32 v49, v49
 v_exp_f32 v50, v50
 v_exp_f32 v51, v51
 v_smfmac_f32_32x32x32_bf16 v[216:231], a[24:27], v[32:39], v163
 s_add_u32 m0, s64, 65536
 s_add_u32 s65, s64, 65536
 s_and_b32 s67, s26, 15
 s_lshl_b32 s67, s67, 7
 ds_read_b128 a[32:35], v161 offset:5952
 buffer_load_dwordx4 v165, s[56:59], s65 offen offset:0 sc1 lds
 v_exp_f32 v52, v52
 v_exp_f32 v53, v53
 v_exp_f32 v54, v54
 v_exp_f32 v55, v55
 v_smfmac_f32_32x32x32_bf16 v[216:231], a[28:31], v[40:47], v163
 ds_read_b128 a[36:39], v161 offset:6624
 buffer_load_dwordx4 v165, s[56:59], s65 offen offset:1024 sc1 lds
 v_exp_f32 v56, v56
 v_exp_f32 v57, v57
 v_exp_f32 v58, v58
 v_exp_f32 v59, v59
 v_mfma_f32_32x32x4_2b_bf16 v[96:127], a[40:41], v[134:135], 0
 v_exp_f32 v60, v60
 v_exp_f32 v61, v61
 v_exp_f32 v62, v62
 v_exp_f32 v63, v63
 v_exp_f32 v64, v64
 v_exp_f32 v65, v65
 v_exp_f32 v66, v66
 v_exp_f32 v67, v67
 v_mfma_f32_32x32x16_bf16 v[80:95], a[20:23], v[148:151], v[80:95]
 v_exp_f32 v68, v68
 v_exp_f32 v69, v69
 v_exp_f32 v70, v70
 v_exp_f32 v71, v71
 v_smfmac_f32_32x32x32_bf16 v[232:247], a[24:27], v[48:55], v163
 buffer_load_dwordx4 v165, s[56:59], s65 offen offset:2048 sc1 lds
 v_exp_f32 v72, v72
 v_exp_f32 v73, v73
 v_exp_f32 v74, v74
 v_exp_f32 v75, v75
 v_smfmac_f32_32x32x32_bf16 v[232:247], a[28:31], v[56:63], v163
 buffer_load_dwordx4 v165, s[56:59], s65 offen offset:3072 sc1 lds
 v_exp_f32 v76, v76
 v_exp_f32 v77, v77
 v_exp_f32 v78, v78
 v_exp_f32 v79, v79
 v_mfma_f32_32x32x16_bf16 v[96:111], a[20:23], v[152:155], v[96:111]
 s_waitcnt lgkmcnt(0)
 v_exp_f32 v80, v80
 v_exp_f32 v81, v81
 v_exp_f32 v82, v82
 v_exp_f32 v83, v83
 v_smfmac_f32_32x32x32_bf16 v[184:199], a[32:35], v[64:71], v163
 s_add_u32 m0, s64, 81920
 s_add_u32 s65, s64, 81920
 ds_read_b128 a[16:19], v160 offset:2560
 buffer_load_dwordx4 v165, s[56:59], s65 offen offset:0 sc1 lds
 v_exp_f32 v84, v84
 v_exp_f32 v85, v85
 v_exp_f32 v86, v86
 v_exp_f32 v87, v87
 v_smfmac_f32_32x32x32_bf16 v[184:199], a[36:39], v[72:79], v163
 s_lshr_b64 s[26:27], s[26:27], 4
 buffer_load_dword a200, v171, s[44:47], s67 offen
 buffer_load_dwordx4 v165, s[56:59], s65 offen offset:1024 sc1 lds
 v_exp_f32 v88, v88
 v_exp_f32 v89, v89
 v_exp_f32 v90, v90
 v_exp_f32 v91, v91
 v_mfma_f32_32x32x4_2b_bf16 v[0:31], a[42:43], v[128:129], 0
 v_exp_f32 v92, v92
 v_exp_f32 v93, v93
 v_exp_f32 v94, v94
 v_exp_f32 v95, v95
 v_exp_f32 v96, v96
 v_exp_f32 v97, v97
 v_exp_f32 v98, v98
 v_exp_f32 v99, v99
 v_mfma_f32_32x32x16_bf16 v[112:127], a[20:23], v[156:159], v[112:127]
 v_exp_f32 v100, v100
 v_exp_f32 v101, v101
 v_exp_f32 v102, v102
 v_exp_f32 v103, v103
 v_smfmac_f32_32x32x32_bf16 v[200:215], a[32:35], v[80:87], v163
 buffer_load_dwordx4 v165, s[56:59], s65 offen offset:2048 sc1 lds
 v_exp_f32 v104, v104
 v_exp_f32 v105, v105
 v_exp_f32 v106, v106
 v_exp_f32 v107, v107
 v_smfmac_f32_32x32x32_bf16 v[200:215], a[36:39], v[88:95], v163
 s_waitcnt lgkmcnt(0)
 buffer_load_dwordx4 v165, s[56:59], s65 offen offset:3072 sc1 lds
 v_exp_f32 v108, v108
 v_exp_f32 v109, v109
 v_exp_f32 v110, v110
 v_exp_f32 v111, v111
 v_mfma_f32_32x32x16_bf16 v[0:15], a[16:19], v[144:147], v[0:15]
 v_exp_f32 v112, v112
 v_exp_f32 v113, v113
 v_exp_f32 v114, v114
 v_exp_f32 v115, v115
 v_smfmac_f32_32x32x32_bf16 v[216:231], a[32:35], v[96:103], v163
 s_add_u32 m0, s64, 98304
 s_add_u32 s65, s64, 98304
 ds_read_b128 a[24:27], v161 offset:7296
 buffer_load_dwordx4 v165, s[56:59], s65 offen offset:0 sc1 lds
 v_exp_f32 v116, v116
 v_exp_f32 v117, v117
 v_exp_f32 v118, v118
 v_exp_f32 v119, v119
 v_smfmac_f32_32x32x32_bf16 v[216:231], a[36:39], v[104:111], v163
 ds_read_b128 a[28:31], v161 offset:7968
 buffer_load_dwordx4 v165, s[56:59], s65 offen offset:1024 sc1 lds
 v_exp_f32 v120, v120
 v_exp_f32 v121, v121
 v_exp_f32 v122, v122
 v_exp_f32 v123, v123
 v_mfma_f32_32x32x4_2b_bf16 v[32:63], a[42:43], v[132:133], 0
 v_exp_f32 v124, v124
 v_exp_f32 v125, v125
 v_exp_f32 v126, v126
 v_exp_f32 v127, v127
 v_exp_f32 v0, v0
 v_exp_f32 v1, v1
 v_exp_f32 v2, v2
 v_exp_f32 v3, v3
 v_mfma_f32_32x32x16_bf16 v[16:31], a[16:19], v[148:151], v[16:31]
 v_exp_f32 v4, v4
 v_exp_f32 v5, v5
 v_exp_f32 v6, v6
 v_exp_f32 v7, v7
 v_smfmac_f32_32x32x32_bf16 v[232:247], a[32:35], v[112:119], v163
 buffer_load_dwordx4 v165, s[56:59], s65 offen offset:2048 sc1 lds
 v_exp_f32 v8, v8
 v_exp_f32 v9, v9
 v_exp_f32 v10, v10
 v_exp_f32 v11, v11
 v_smfmac_f32_32x32x32_bf16 v[232:247], a[36:39], v[120:127], v163
 buffer_load_dwordx4 v165, s[56:59], s65 offen offset:3072 sc1 lds
 v_exp_f32 v12, v12
 v_exp_f32 v13, v13
 v_exp_f32 v14, v14
 v_exp_f32 v15, v15
 v_mfma_f32_32x32x16_bf16 v[32:47], a[16:19], v[152:155], v[32:47]
 s_waitcnt lgkmcnt(0)
 v_exp_f32 v16, v16
 v_exp_f32 v17, v17
 v_exp_f32 v18, v18
 v_exp_f32 v19, v19
 v_smfmac_f32_32x32x32_bf16 v[184:199], a[24:27], v[0:7], v163
 s_add_u32 m0, s64, 114688
 s_add_u32 s65, s64, 114688
 ds_read_b128 a[20:23], v160 offset:3584
 buffer_load_dwordx4 v165, s[56:59], s65 offen offset:0 sc1 lds
 v_exp_f32 v20, v20
 v_exp_f32 v21, v21
 v_exp_f32 v22, v22
 v_exp_f32 v23, v23
 v_smfmac_f32_32x32x32_bf16 v[184:199], a[28:31], v[8:15], v163
 ds_read_b128 a[44:47], v162 offset:9984
 buffer_load_dwordx4 v165, s[56:59], s65 offen offset:1024 sc1 lds
 v_exp_f32 v24, v24
 v_exp_f32 v25, v25
 v_exp_f32 v26, v26
 v_exp_f32 v27, v27
 v_mfma_f32_32x32x4_2b_bf16 v[64:95], a[42:43], v[130:131], 0
 v_exp_f32 v28, v28
 v_exp_f32 v29, v29
 v_exp_f32 v30, v30
 v_exp_f32 v31, v31
 v_exp_f32 v32, v32
 v_exp_f32 v33, v33
 v_exp_f32 v34, v34
 v_exp_f32 v35, v35
 v_mfma_f32_32x32x16_bf16 v[48:63], a[16:19], v[156:159], v[48:63]
 v_exp_f32 v36, v36
 v_exp_f32 v37, v37
 v_exp_f32 v38, v38
 v_exp_f32 v39, v39
 v_smfmac_f32_32x32x32_bf16 v[200:215], a[24:27], v[16:23], v163
 buffer_load_dwordx4 v165, s[56:59], s65 offen offset:2048 sc1 lds
 v_exp_f32 v40, v40
 v_exp_f32 v41, v41
 v_exp_f32 v42, v42
 v_exp_f32 v43, v43
 v_smfmac_f32_32x32x32_bf16 v[200:215], a[28:31], v[24:31], v163
 s_waitcnt lgkmcnt(0)
 buffer_load_dwordx4 v165, s[56:59], s65 offen offset:3072 sc1 lds
 v_exp_f32 v44, v44
 v_exp_f32 v45, v45
 v_exp_f32 v46, v46
 v_exp_f32 v47, v47
 v_mfma_f32_32x32x16_bf16 v[64:79], a[20:23], v[144:147], v[64:79]
 v_exp_f32 v48, v48
 v_exp_f32 v49, v49
 v_exp_f32 v50, v50
 v_exp_f32 v51, v51
 v_smfmac_f32_32x32x32_bf16 v[216:231], a[24:27], v[32:39], v163
 s_add_u32 m0, s64, 131072
 s_add_u32 s65, s64, 131072
 ds_read_b128 a[32:35], v161 offset:8640
 buffer_load_dwordx4 v165, s[56:59], s65 offen offset:0 sc1 lds
 v_exp_f32 v52, v52
 v_exp_f32 v53, v53
 v_exp_f32 v54, v54
 v_exp_f32 v55, v55
 v_smfmac_f32_32x32x32_bf16 v[216:231], a[28:31], v[40:47], v163
 ds_read_b128 a[36:39], v161 offset:9312
 buffer_load_dwordx4 v165, s[56:59], s65 offen offset:1024 sc1 lds
 v_exp_f32 v56, v56
 v_exp_f32 v57, v57
 v_exp_f32 v58, v58
 v_exp_f32 v59, v59
 v_mfma_f32_32x32x4_2b_bf16 v[96:127], a[42:43], v[134:135], 0
 v_exp_f32 v60, v60
 v_exp_f32 v61, v61
 v_exp_f32 v62, v62
 v_exp_f32 v63, v63
 v_exp_f32 v64, v64
 v_exp_f32 v65, v65
 v_exp_f32 v66, v66
 v_exp_f32 v67, v67
 v_mfma_f32_32x32x16_bf16 v[80:95], a[20:23], v[148:151], v[80:95]
 v_exp_f32 v68, v68
 v_exp_f32 v69, v69
 v_exp_f32 v70, v70
 v_exp_f32 v71, v71
 v_smfmac_f32_32x32x32_bf16 v[232:247], a[24:27], v[48:55], v163
 buffer_load_dwordx4 v165, s[56:59], s65 offen offset:2048 sc1 lds
 v_exp_f32 v72, v72
 v_exp_f32 v73, v73
 v_exp_f32 v74, v74
 v_exp_f32 v75, v75
 v_smfmac_f32_32x32x32_bf16 v[232:247], a[28:31], v[56:63], v163
 buffer_load_dwordx4 v165, s[56:59], s65 offen offset:3072 sc1 lds
 v_exp_f32 v76, v76
 v_exp_f32 v77, v77
 v_exp_f32 v78, v78
 v_exp_f32 v79, v79
 v_mfma_f32_32x32x16_bf16 v[96:111], a[20:23], v[152:155], v[96:111]
 s_waitcnt lgkmcnt(0)
 v_exp_f32 v80, v80
 v_exp_f32 v81, v81
 v_exp_f32 v82, v82
 v_exp_f32 v83, v83
 v_smfmac_f32_32x32x32_bf16 v[184:199], a[32:35], v[64:71], v163
 s_add_u32 m0, s64, 147456
 s_add_u32 s65, s64, 147456
 ds_read_b128 a[16:19], v160 offset:10496
 buffer_load_dwordx4 v165, s[56:59], s65 offen offset:0 sc1 lds
 v_exp_f32 v84, v84
 v_exp_f32 v85, v85
 v_exp_f32 v86, v86
 v_exp_f32 v87, v87
 v_smfmac_f32_32x32x32_bf16 v[184:199], a[36:39], v[72:79], v163
 buffer_load_dwordx4 v165, s[56:59], s65 offen offset:1024 sc1 lds
 v_exp_f32 v88, v88
 v_exp_f32 v89, v89
 v_exp_f32 v90, v90
 v_exp_f32 v91, v91
 v_mfma_f32_32x32x4_2b_bf16 v[0:31], a[44:45], v[128:129], 0
 v_exp_f32 v92, v92
 v_exp_f32 v93, v93
 v_exp_f32 v94, v94
 v_exp_f32 v95, v95
 v_exp_f32 v96, v96
 v_exp_f32 v97, v97
 v_exp_f32 v98, v98
 v_exp_f32 v99, v99
 v_mfma_f32_32x32x16_bf16 v[112:127], a[20:23], v[156:159], v[112:127]
 v_exp_f32 v100, v100
 v_exp_f32 v101, v101
 v_exp_f32 v102, v102
 v_exp_f32 v103, v103
 v_smfmac_f32_32x32x32_bf16 v[200:215], a[32:35], v[80:87], v163
 buffer_load_dwordx4 v165, s[56:59], s65 offen offset:2048 sc1 lds
 v_exp_f32 v104, v104
 v_exp_f32 v105, v105
 v_exp_f32 v106, v106
 v_exp_f32 v107, v107
 v_smfmac_f32_32x32x32_bf16 v[200:215], a[36:39], v[88:95], v163
 s_waitcnt lgkmcnt(0)
 buffer_load_dwordx4 v165, s[56:59], s65 offen offset:3072 sc1 lds
 v_exp_f32 v108, v108
 v_exp_f32 v109, v109
 v_exp_f32 v110, v110
 v_exp_f32 v111, v111
 v_mfma_f32_32x32x16_bf16 v[0:15], a[16:19], v[144:147], v[0:15]
 v_exp_f32 v112, v112
 v_exp_f32 v113, v113
 v_exp_f32 v114, v114
 v_exp_f32 v115, v115
 v_smfmac_f32_32x32x32_bf16 v[216:231], a[32:35], v[96:103], v163
 s_waitcnt vmcnt(33)
 s_barrier
 ds_read_b128 a[24:27], v161 offset:14592
 v_exp_f32 v116, v116
 v_exp_f32 v117, v117
 v_exp_f32 v118, v118
 v_exp_f32 v119, v119
 v_smfmac_f32_32x32x32_bf16 v[216:231], a[36:39], v[104:111], v163
 ds_read_b128 a[28:31], v161 offset:15264
 v_exp_f32 v120, v120
 v_exp_f32 v121, v121
 v_exp_f32 v122, v122
 v_exp_f32 v123, v123
 v_mfma_f32_32x32x4_2b_bf16 v[32:63], a[44:45], v[132:133], 0
 v_exp_f32 v124, v124
 v_exp_f32 v125, v125
 v_exp_f32 v126, v126
 v_exp_f32 v127, v127
 v_exp_f32 v0, v0
 v_exp_f32 v1, v1
 v_exp_f32 v2, v2
 v_exp_f32 v3, v3
 v_mfma_f32_32x32x16_bf16 v[16:31], a[16:19], v[148:151], v[16:31]
 v_exp_f32 v4, v4
 v_exp_f32 v5, v5
 v_exp_f32 v6, v6
 v_exp_f32 v7, v7
 v_smfmac_f32_32x32x32_bf16 v[232:247], a[32:35], v[112:119], v163
 buffer_store_dwordx4 a[222:225], v140, s[56:59], s92 offen offset:0 sc1
 v_exp_f32 v8, v8
 v_exp_f32 v9, v9
 v_exp_f32 v10, v10
 v_exp_f32 v11, v11
 v_smfmac_f32_32x32x32_bf16 v[232:247], a[36:39], v[120:127], v163
 v_exp_f32 v12, v12
 v_exp_f32 v13, v13
 v_exp_f32 v14, v14
 v_exp_f32 v15, v15
 v_mfma_f32_32x32x16_bf16 v[32:47], a[16:19], v[152:155], v[32:47]
 s_waitcnt lgkmcnt(0)
 v_exp_f32 v16, v16
 v_exp_f32 v17, v17
 v_exp_f32 v18, v18
 v_exp_f32 v19, v19
 v_smfmac_f32_32x32x32_bf16 v[184:199], a[24:27], v[0:7], v163
 ds_read_b128 a[20:23], v160 offset:11520
 v_exp_f32 v20, v20
 v_exp_f32 v21, v21
 v_exp_f32 v22, v22
 v_exp_f32 v23, v23
 v_smfmac_f32_32x32x32_bf16 v[184:199], a[28:31], v[8:15], v163
 v_exp_f32 v24, v24
 v_exp_f32 v25, v25
 v_exp_f32 v26, v26
 v_exp_f32 v27, v27
 v_mfma_f32_32x32x4_2b_bf16 v[64:95], a[44:45], v[130:131], 0
 v_exp_f32 v28, v28
 v_exp_f32 v29, v29
 v_exp_f32 v30, v30
 v_exp_f32 v31, v31
 v_exp_f32 v32, v32
 v_exp_f32 v33, v33
 v_exp_f32 v34, v34
 v_exp_f32 v35, v35
 v_mfma_f32_32x32x16_bf16 v[48:63], a[16:19], v[156:159], v[48:63]
 v_exp_f32 v36, v36
 v_exp_f32 v37, v37
 v_exp_f32 v38, v38
 v_exp_f32 v39, v39
 v_smfmac_f32_32x32x32_bf16 v[200:215], a[24:27], v[16:23], v163
 buffer_store_dwordx4 a[222:225], v140, s[56:59], s92 offen offset:512 sc1
 v_exp_f32 v40, v40
 v_exp_f32 v41, v41
 v_exp_f32 v42, v42
 v_exp_f32 v43, v43
 v_smfmac_f32_32x32x32_bf16 v[200:215], a[28:31], v[24:31], v163
 s_waitcnt lgkmcnt(0)
 v_exp_f32 v44, v44
 v_exp_f32 v45, v45
 v_exp_f32 v46, v46
 v_exp_f32 v47, v47
 v_mfma_f32_32x32x16_bf16 v[64:79], a[20:23], v[144:147], v[64:79]
 v_exp_f32 v48, v48
 v_exp_f32 v49, v49
 v_exp_f32 v50, v50
 v_exp_f32 v51, v51
 v_smfmac_f32_32x32x32_bf16 v[216:231], a[24:27], v[32:39], v163
 s_and_b32 s67, s26, 15
 s_lshl_b32 s67, s67, 7
 ds_read_b128 a[32:35], v161 offset:15936
 v_exp_f32 v52, v52
 v_exp_f32 v53, v53
 v_exp_f32 v54, v54
 v_exp_f32 v55, v55
 v_smfmac_f32_32x32x32_bf16 v[216:231], a[28:31], v[40:47], v163
 ds_read_b128 a[36:39], v161 offset:16608
 v_exp_f32 v56, v56
 v_exp_f32 v57, v57
 v_exp_f32 v58, v58
 v_exp_f32 v59, v59
 v_mfma_f32_32x32x4_2b_bf16 v[96:127], a[44:45], v[134:135], 0
 v_exp_f32 v60, v60
 v_exp_f32 v61, v61
 v_exp_f32 v62, v62
 v_exp_f32 v63, v63
 v_exp_f32 v64, v64
 v_exp_f32 v65, v65
 v_exp_f32 v66, v66
 v_exp_f32 v67, v67
 v_mfma_f32_32x32x16_bf16 v[80:95], a[20:23], v[148:151], v[80:95]
 v_exp_f32 v68, v68
 v_exp_f32 v69, v69
 v_exp_f32 v70, v70
 v_exp_f32 v71, v71
 v_smfmac_f32_32x32x32_bf16 v[232:247], a[24:27], v[48:55], v163
 buffer_store_dwordx4 a[222:225], v140, s[56:59], s92 offen offset:2048 sc1
 v_exp_f32 v72, v72
 v_exp_f32 v73, v73
 v_exp_f32 v74, v74
 v_exp_f32 v75, v75
 v_smfmac_f32_32x32x32_bf16 v[232:247], a[28:31], v[56:63], v163
 v_exp_f32 v76, v76
 v_exp_f32 v77, v77
 v_exp_f32 v78, v78
 v_exp_f32 v79, v79
 v_mfma_f32_32x32x16_bf16 v[96:111], a[20:23], v[152:155], v[96:111]
 s_waitcnt lgkmcnt(0)
 v_exp_f32 v80, v80
 v_exp_f32 v81, v81
 v_exp_f32 v82, v82
 v_exp_f32 v83, v83
 v_smfmac_f32_32x32x32_bf16 v[184:199], a[32:35], v[64:71], v163
 ds_read_b128 a[16:19], v160 offset:12544
 v_exp_f32 v84, v84
 v_exp_f32 v85, v85
 v_exp_f32 v86, v86
 v_exp_f32 v87, v87
 v_smfmac_f32_32x32x32_bf16 v[184:199], a[36:39], v[72:79], v163
 s_lshr_b64 s[26:27], s[26:27], 4
 buffer_load_dword a200, v171, s[44:47], s67 offen
 v_exp_f32 v88, v88
 v_exp_f32 v89, v89
 v_exp_f32 v90, v90
 v_exp_f32 v91, v91
 v_mfma_f32_32x32x4_2b_bf16 v[0:31], a[46:47], v[128:129], 0
 v_exp_f32 v92, v92
 v_exp_f32 v93, v93
 v_exp_f32 v94, v94
 v_exp_f32 v95, v95
 v_exp_f32 v96, v96
 v_exp_f32 v97, v97
 v_exp_f32 v98, v98
 v_exp_f32 v99, v99
 v_mfma_f32_32x32x16_bf16 v[112:127], a[20:23], v[156:159], v[112:127]
 v_exp_f32 v100, v100
 v_exp_f32 v101, v101
 v_exp_f32 v102, v102
 v_exp_f32 v103, v103
 v_smfmac_f32_32x32x32_bf16 v[200:215], a[32:35], v[80:87], v163
 buffer_store_dwordx4 a[222:225], v140, s[56:59], s92 offen offset:2560 sc1
 v_exp_f32 v104, v104
 v_exp_f32 v105, v105
 v_exp_f32 v106, v106
 v_exp_f32 v107, v107
 v_smfmac_f32_32x32x32_bf16 v[200:215], a[36:39], v[88:95], v163
 s_waitcnt lgkmcnt(0)
 v_exp_f32 v108, v108
 v_exp_f32 v109, v109
 v_exp_f32 v110, v110
 v_exp_f32 v111, v111
 v_mfma_f32_32x32x16_bf16 v[0:15], a[16:19], v[144:147], v[0:15]
 v_exp_f32 v112, v112
 v_exp_f32 v113, v113
 v_exp_f32 v114, v114
 v_exp_f32 v115, v115
 v_smfmac_f32_32x32x32_bf16 v[216:231], a[32:35], v[96:103], v163
 ds_read_b128 a[24:27], v161 offset:17280
 v_exp_f32 v116, v116
 v_exp_f32 v117, v117
 v_exp_f32 v118, v118
 v_exp_f32 v119, v119
 v_smfmac_f32_32x32x32_bf16 v[216:231], a[36:39], v[104:111], v163
 ds_read_b128 a[28:31], v161 offset:17952
 v_exp_f32 v120, v120
 v_exp_f32 v121, v121
 v_exp_f32 v122, v122
 v_exp_f32 v123, v123
 v_mfma_f32_32x32x4_2b_bf16 v[32:63], a[46:47], v[132:133], 0
 v_exp_f32 v124, v124
 v_exp_f32 v125, v125
 v_exp_f32 v126, v126
 v_exp_f32 v127, v127
 v_exp_f32 v0, v0
 v_exp_f32 v1, v1
 v_exp_f32 v2, v2
 v_exp_f32 v3, v3
 v_mfma_f32_32x32x16_bf16 v[16:31], a[16:19], v[148:151], v[16:31]
 v_exp_f32 v4, v4
 v_exp_f32 v5, v5
 v_exp_f32 v6, v6
 v_exp_f32 v7, v7
 v_smfmac_f32_32x32x32_bf16 v[232:247], a[32:35], v[112:119], v163
 s_mov_b32 exec_hi, 0
 buffer_store_dwordx4 a[222:225], v140, s[56:59], s93 offen sc1
 s_mov_b64 exec, -1
 v_exp_f32 v8, v8
 v_exp_f32 v9, v9
 v_exp_f32 v10, v10
 v_exp_f32 v11, v11
 v_smfmac_f32_32x32x32_bf16 v[232:247], a[36:39], v[120:127], v163
 v_exp_f32 v12, v12
 v_exp_f32 v13, v13
 v_exp_f32 v14, v14
 v_exp_f32 v15, v15
 v_mfma_f32_32x32x16_bf16 v[32:47], a[16:19], v[152:155], v[32:47]
 s_waitcnt lgkmcnt(0)
 v_exp_f32 v16, v16
 v_exp_f32 v17, v17
 v_exp_f32 v18, v18
 v_exp_f32 v19, v19
 v_smfmac_f32_32x32x32_bf16 v[184:199], a[24:27], v[0:7], v163
 ds_read_b128 a[20:23], v160 offset:13568
 v_exp_f32 v20, v20
 v_exp_f32 v21, v21
 v_exp_f32 v22, v22
 v_exp_f32 v23, v23
 v_smfmac_f32_32x32x32_bf16 v[184:199], a[28:31], v[8:15], v163
 ds_read_b128 a[40:43], v162 offset:19968
 v_exp_f32 v24, v24
 v_exp_f32 v25, v25
 v_exp_f32 v26, v26
 v_exp_f32 v27, v27
 v_mfma_f32_32x32x4_2b_bf16 v[64:95], a[46:47], v[130:131], 0
 v_exp_f32 v28, v28
 v_exp_f32 v29, v29
 v_exp_f32 v30, v30
 v_exp_f32 v31, v31
 v_exp_f32 v32, v32
 v_exp_f32 v33, v33
 v_exp_f32 v34, v34
 v_exp_f32 v35, v35
 v_mfma_f32_32x32x16_bf16 v[48:63], a[16:19], v[156:159], v[48:63]
 v_exp_f32 v36, v36
 v_exp_f32 v37, v37
 v_exp_f32 v38, v38
 v_exp_f32 v39, v39
 v_smfmac_f32_32x32x32_bf16 v[200:215], a[24:27], v[16:23], v163
 buffer_store_dwordx4 a[222:225], v141, s[56:59], s94 offen offset:0 sc1
 v_exp_f32 v40, v40
 v_exp_f32 v41, v41
 v_exp_f32 v42, v42
 v_exp_f32 v43, v43
 v_smfmac_f32_32x32x32_bf16 v[200:215], a[28:31], v[24:31], v163
 s_waitcnt lgkmcnt(0)
 v_exp_f32 v44, v44
 v_exp_f32 v45, v45
 v_exp_f32 v46, v46
 v_exp_f32 v47, v47
 v_mfma_f32_32x32x16_bf16 v[64:79], a[20:23], v[144:147], v[64:79]
 v_exp_f32 v48, v48
 v_exp_f32 v49, v49
 v_exp_f32 v50, v50
 v_exp_f32 v51, v51
 v_smfmac_f32_32x32x32_bf16 v[216:231], a[24:27], v[32:39], v163
 ds_read_b128 a[32:35], v161 offset:18624
 v_exp_f32 v52, v52
 v_exp_f32 v53, v53
 v_exp_f32 v54, v54
 v_exp_f32 v55, v55
 v_smfmac_f32_32x32x32_bf16 v[216:231], a[28:31], v[40:47], v163
 ds_read_b128 a[36:39], v161 offset:19296
 v_exp_f32 v56, v56
 v_exp_f32 v57, v57
 v_exp_f32 v58, v58
 v_exp_f32 v59, v59
 v_mfma_f32_32x32x4_2b_bf16 v[96:127], a[46:47], v[134:135], 0
 v_exp_f32 v60, v60
 v_exp_f32 v61, v61
 v_exp_f32 v62, v62
 v_exp_f32 v63, v63
 v_exp_f32 v64, v64
 v_exp_f32 v65, v65
 v_exp_f32 v66, v66
 v_exp_f32 v67, v67
 v_mfma_f32_32x32x16_bf16 v[80:95], a[20:23], v[148:151], v[80:95]
 v_exp_f32 v68, v68
 v_exp_f32 v69, v69
 v_exp_f32 v70, v70
 v_exp_f32 v71, v71
 v_smfmac_f32_32x32x32_bf16 v[232:247], a[24:27], v[48:55], v163
 buffer_store_dwordx4 a[222:225], v141, s[56:59], s94 offen offset:1024 sc1
 v_exp_f32 v72, v72
 v_exp_f32 v73, v73
 v_exp_f32 v74, v74
 v_exp_f32 v75, v75
 v_smfmac_f32_32x32x32_bf16 v[232:247], a[28:31], v[56:63], v163
 v_exp_f32 v76, v76
 v_exp_f32 v77, v77
 v_exp_f32 v78, v78
 v_exp_f32 v79, v79
 v_mfma_f32_32x32x16_bf16 v[96:111], a[20:23], v[152:155], v[96:111]
 s_waitcnt lgkmcnt(0)
 v_exp_f32 v80, v80
 v_exp_f32 v81, v81
 v_exp_f32 v82, v82
 v_exp_f32 v83, v83
 v_smfmac_f32_32x32x32_bf16 v[184:199], a[32:35], v[64:71], v163
 ds_read_b128 a[16:19], v160 offset:20480
 v_exp_f32 v84, v84
 v_exp_f32 v85, v85
 v_exp_f32 v86, v86
 v_exp_f32 v87, v87
 v_smfmac_f32_32x32x32_bf16 v[184:199], a[36:39], v[72:79], v163
 v_exp_f32 v88, v88
 v_exp_f32 v89, v89
 v_exp_f32 v90, v90
 v_exp_f32 v91, v91
 v_mfma_f32_32x32x4_2b_bf16 v[0:31], a[40:41], v[128:129], 0
 v_exp_f32 v92, v92
 v_exp_f32 v93, v93
 v_exp_f32 v94, v94
 v_exp_f32 v95, v95
 v_exp_f32 v96, v96
 v_exp_f32 v97, v97
 v_exp_f32 v98, v98
 v_exp_f32 v99, v99
 v_mfma_f32_32x32x16_bf16 v[112:127], a[20:23], v[156:159], v[112:127]
 v_exp_f32 v100, v100
 v_exp_f32 v101, v101
 v_exp_f32 v102, v102
 v_exp_f32 v103, v103
 v_smfmac_f32_32x32x32_bf16 v[200:215], a[32:35], v[80:87], v163
 buffer_store_dwordx4 a[222:225], v141, s[56:59], s94 offen offset:2048 sc1
 buffer_store_dwordx4 a[222:225], v141, s[56:59], s94 offen offset:3072 sc1
 v_add_u32 v160, 19968, v160
 v_add_u32 v161, 19968, v161
 v_add_u32 v162, 19968, v162
 v_exp_f32 v104, v104
 v_exp_f32 v105, v105
 v_exp_f32 v106, v106
 v_exp_f32 v107, v107
 v_smfmac_f32_32x32x32_bf16 v[200:215], a[36:39], v[88:95], v163
 s_waitcnt lgkmcnt(0)
 v_exp_f32 v108, v108
 v_exp_f32 v109, v109
 v_exp_f32 v110, v110
 v_exp_f32 v111, v111
 s_waitcnt vmcnt(10)
 s_barrier
 s_mov_b32 s44, s36
 s_mov_b32 s45, s37
 s_mov_b32 s46, s38
 v_mul_u32_u24 v171, 1152, v170
.p2align 6
L_att_loop:
 v_mfma_f32_32x32x16_bf16 v[0:15], a[16:19], v[144:147], v[0:15]
 v_exp_f32 v112, v112
 v_exp_f32 v113, v113
 v_exp_f32 v114, v114
 v_exp_f32 v115, v115
 v_smfmac_f32_32x32x32_bf16 v[216:231], a[32:35], v[96:103], v163
 s_cmp_ge_u32 s74, 6
 s_cselect_b32 s44, s40, s44
 ds_read_b128 a[24:27], v161 offset:4608
 v_exp_f32 v116, v116
 v_exp_f32 v117, v117
 v_exp_f32 v118, v118
 v_exp_f32 v119, v119
 v_smfmac_f32_32x32x32_bf16 v[216:231], a[36:39], v[104:111], v163
 s_cselect_b32 s45, s41, s45
 ds_read_b128 a[28:31], v161 offset:5280
 v_exp_f32 v120, v120
 v_exp_f32 v121, v121
 v_exp_f32 v122, v122
 v_exp_f32 v123, v123
 v_mfma_f32_32x32x4_2b_bf16 v[32:63], a[40:41], v[132:133], 0
 v_exp_f32 v124, v124
 v_exp_f32 v125, v125
 v_exp_f32 v126, v126
 v_exp_f32 v127, v127
 v_exp_f32 v0, v0
 v_exp_f32 v1, v1
 v_exp_f32 v2, v2
 v_exp_f32 v3, v3
 v_mfma_f32_32x32x16_bf16 v[16:31], a[16:19], v[148:151], v[16:31]
 v_exp_f32 v4, v4
 v_exp_f32 v5, v5
 v_exp_f32 v6, v6
 v_exp_f32 v7, v7
 v_smfmac_f32_32x32x32_bf16 v[232:247], a[32:35], v[112:119], v163
 v_exp_f32 v8, v8
 v_exp_f32 v9, v9
 v_exp_f32 v10, v10
 v_exp_f32 v11, v11
 v_smfmac_f32_32x32x32_bf16 v[232:247], a[36:39], v[120:127], v163
 v_exp_f32 v12, v12
 v_exp_f32 v13, v13
 v_exp_f32 v14, v14
 v_exp_f32 v15, v15
 v_mfma_f32_32x32x16_bf16 v[32:47], a[16:19], v[152:155], v[32:47]
 s_waitcnt lgkmcnt(0)
 v_exp_f32 v16, v16
 v_exp_f32 v17, v17
 v_exp_f32 v18, v18
 v_exp_f32 v19, v19
 v_smfmac_f32_32x32x32_bf16 v[184:199], a[24:27], v[0:7], v163
 ds_read_b128 a[20:23], v160 offset:1536
 v_exp_f32 v20, v20
 v_exp_f32 v21, v21
 v_exp_f32 v22, v22
 v_exp_f32 v23, v23
 v_smfmac_f32_32x32x32_bf16 v[184:199], a[28:31], v[8:15], v163
 v_exp_f32 v24, v24
 v_exp_f32 v25, v25
 v_exp_f32 v26, v26
 v_exp_f32 v27, v27
 v_mfma_f32_32x32x4_2b_bf16 v[64:95], a[40:41], v[130:131], 0
 v_exp_f32 v28, v28
 v_exp_f32 v29, v29
 v_exp_f32 v30, v30
 v_exp_f32 v31, v31
 v_exp_f32 v32, v32
 v_exp_f32 v33, v33
 v_exp_f32 v34, v34
 v_exp_f32 v35, v35
 v_mfma_f32_32x32x16_bf16 v[48:63], a[16:19], v[156:159], v[48:63]
 v_exp_f32 v36, v36
 v_exp_f32 v37, v37
 v_exp_f32 v38, v38
 v_exp_f32 v39, v39
 v_smfmac_f32_32x32x32_bf16 v[200:215], a[24:27], v[16:23], v163
 v_exp_f32 v40, v40
 v_exp_f32 v41, v41
 v_exp_f32 v42, v42
 v_exp_f32 v43, v43
 v_smfmac_f32_32x32x32_bf16 v[200:215], a[28:31], v[24:31], v163
 s_waitcnt lgkmcnt(0)
 v_exp_f32 v44, v44
 v_exp_f32 v45, v45
 v_exp_f32 v46, v46
 v_exp_f32 v47, v47
 v_mfma_f32_32x32x16_bf16 v[64:79], a[20:23], v[144:147], v[64:79]
 v_exp_f32 v48, v48
 v_exp_f32 v49, v49
 v_exp_f32 v50, v50
 v_exp_f32 v51, v51
 v_smfmac_f32_32x32x32_bf16 v[216:231], a[24:27], v[32:39], v163
 s_and_b32 s67, s26, 15
 s_lshl_b32 s67, s67, 7
 ds_read_b128 a[32:35], v161 offset:5952
 v_exp_f32 v52, v52
 v_exp_f32 v53, v53
 v_exp_f32 v54, v54
 v_exp_f32 v55, v55
 v_smfmac_f32_32x32x32_bf16 v[216:231], a[28:31], v[40:47], v163
 ds_read_b128 a[36:39], v161 offset:6624
 v_exp_f32 v56, v56
 v_exp_f32 v57, v57
 v_exp_f32 v58, v58
 v_exp_f32 v59, v59
 v_mfma_f32_32x32x4_2b_bf16 v[96:127], a[40:41], v[134:135], 0
 v_exp_f32 v60, v60
 v_exp_f32 v61, v61
 v_exp_f32 v62, v62
 v_exp_f32 v63, v63
 v_exp_f32 v64, v64
 v_exp_f32 v65, v65
 v_exp_f32 v66, v66
 v_exp_f32 v67, v67
 v_mfma_f32_32x32x16_bf16 v[80:95], a[20:23], v[148:151], v[80:95]
 v_exp_f32 v68, v68
 v_exp_f32 v69, v69
 v_exp_f32 v70, v70
 v_exp_f32 v71, v71
 v_smfmac_f32_32x32x32_bf16 v[232:247], a[24:27], v[48:55], v163
 v_exp_f32 v72, v72
 v_exp_f32 v73, v73
 v_exp_f32 v74, v74
 v_exp_f32 v75, v75
 v_smfmac_f32_32x32x32_bf16 v[232:247], a[28:31], v[56:63], v163
 v_exp_f32 v76, v76
 v_exp_f32 v77, v77
 v_exp_f32 v78, v78
 v_exp_f32 v79, v79
 v_mfma_f32_32x32x16_bf16 v[96:111], a[20:23], v[152:155], v[96:111]
 s_waitcnt lgkmcnt(0)
 v_exp_f32 v80, v80
 v_exp_f32 v81, v81
 v_exp_f32 v82, v82
 v_exp_f32 v83, v83
 v_smfmac_f32_32x32x32_bf16 v[184:199], a[32:35], v[64:71], v163
 ds_read_b128 a[16:19], v160 offset:2560
 v_exp_f32 v84, v84
 v_exp_f32 v85, v85
 v_exp_f32 v86, v86
 v_exp_f32 v87, v87
 v_smfmac_f32_32x32x32_bf16 v[184:199], a[36:39], v[72:79], v163
 s_lshr_b64 s[26:27], s[26:27], 4
 buffer_load_dword a200, v171, s[44:47], s67 offen
 v_exp_f32 v88, v88
 v_exp_f32 v89, v89
 v_exp_f32 v90, v90
 v_exp_f32 v91, v91
 v_mfma_f32_32x32x4_2b_bf16 v[0:31], a[42:43], v[128:129], 0
 v_exp_f32 v92, v92
 v_exp_f32 v93, v93
 v_exp_f32 v94, v94
 v_exp_f32 v95, v95
 v_exp_f32 v96, v96
 v_exp_f32 v97, v97
 v_exp_f32 v98, v98
 v_exp_f32 v99, v99
 v_mfma_f32_32x32x16_bf16 v[112:127], a[20:23], v[156:159], v[112:127]
 v_exp_f32 v100, v100
 v_exp_f32 v101, v101
 v_exp_f32 v102, v102
 v_exp_f32 v103, v103
 v_smfmac_f32_32x32x32_bf16 v[200:215], a[32:35], v[80:87], v163
 v_exp_f32 v104, v104
 v_exp_f32 v105, v105
 v_exp_f32 v106, v106
 v_exp_f32 v107, v107
 v_smfmac_f32_32x32x32_bf16 v[200:215], a[36:39], v[88:95], v163
 s_waitcnt lgkmcnt(0)
 v_exp_f32 v108, v108
 v_exp_f32 v109, v109
 v_exp_f32 v110, v110
 v_exp_f32 v111, v111
 v_mfma_f32_32x32x16_bf16 v[0:15], a[16:19], v[144:147], v[0:15]
 v_exp_f32 v112, v112
 v_exp_f32 v113, v113
 v_exp_f32 v114, v114
 v_exp_f32 v115, v115
 v_smfmac_f32_32x32x32_bf16 v[216:231], a[32:35], v[96:103], v163
 ds_read_b128 a[24:27], v161 offset:7296
 v_exp_f32 v116, v116
 v_exp_f32 v117, v117
 v_exp_f32 v118, v118
 v_exp_f32 v119, v119
 v_smfmac_f32_32x32x32_bf16 v[216:231], a[36:39], v[104:111], v163
 ds_read_b128 a[28:31], v161 offset:7968
 v_exp_f32 v120, v120
 v_exp_f32 v121, v121
 v_exp_f32 v122, v122
 v_exp_f32 v123, v123
 v_mfma_f32_32x32x4_2b_bf16 v[32:63], a[42:43], v[132:133], 0
 v_exp_f32 v124, v124
 v_exp_f32 v125, v125
 v_exp_f32 v126, v126
 v_exp_f32 v127, v127
 v_exp_f32 v0, v0
 v_exp_f32 v1, v1
 v_exp_f32 v2, v2
 v_exp_f32 v3, v3
 v_mfma_f32_32x32x16_bf16 v[16:31], a[16:19], v[148:151], v[16:31]
 v_exp_f32 v4, v4
 v_exp_f32 v5, v5
 v_exp_f32 v6, v6
 v_exp_f32 v7, v7
 v_smfmac_f32_32x32x32_bf16 v[232:247], a[32:35], v[112:119], v163
 v_exp_f32 v8, v8
 v_exp_f32 v9, v9
 v_exp_f32 v10, v10
 v_exp_f32 v11, v11
 v_smfmac_f32_32x32x32_bf16 v[232:247], a[36:39], v[120:127], v163
 v_exp_f32 v12, v12
 v_exp_f32 v13, v13
 v_exp_f32 v14, v14
 v_exp_f32 v15, v15
 v_mfma_f32_32x32x16_bf16 v[32:47], a[16:19], v[152:155], v[32:47]
 s_waitcnt lgkmcnt(0)
 v_exp_f32 v16, v16
 v_exp_f32 v17, v17
 v_exp_f32 v18, v18
 v_exp_f32 v19, v19
 v_smfmac_f32_32x32x32_bf16 v[184:199], a[24:27], v[0:7], v163
 ds_read_b128 a[20:23], v160 offset:3584
 v_exp_f32 v20, v20
 v_exp_f32 v21, v21
 v_exp_f32 v22, v22
 v_exp_f32 v23, v23
 v_smfmac_f32_32x32x32_bf16 v[184:199], a[28:31], v[8:15], v163
 ds_read_b128 a[44:47], v162 offset:9984
 v_exp_f32 v24, v24
 v_exp_f32 v25, v25
 v_exp_f32 v26, v26
 v_exp_f32 v27, v27
 v_mfma_f32_32x32x4_2b_bf16 v[64:95], a[42:43], v[130:131], 0
 v_exp_f32 v28, v28
 v_exp_f32 v29, v29
 v_exp_f32 v30, v30
 v_exp_f32 v31, v31
 v_exp_f32 v32, v32
 v_exp_f32 v33, v33
 v_exp_f32 v34, v34
 v_exp_f32 v35, v35
 v_mfma_f32_32x32x16_bf16 v[48:63], a[16:19], v[156:159], v[48:63]
 v_exp_f32 v36, v36
 v_exp_f32 v37, v37
 v_exp_f32 v38, v38
 v_exp_f32 v39, v39
 v_smfmac_f32_32x32x32_bf16 v[200:215], a[24:27], v[16:23], v163
 v_exp_f32 v40, v40
 v_exp_f32 v41, v41
 v_exp_f32 v42, v42
 v_exp_f32 v43, v43
 v_smfmac_f32_32x32x32_bf16 v[200:215], a[28:31], v[24:31], v163
 s_waitcnt lgkmcnt(0)
 v_exp_f32 v44, v44
 v_exp_f32 v45, v45
 v_exp_f32 v46, v46
 v_exp_f32 v47, v47
 v_mfma_f32_32x32x16_bf16 v[64:79], a[20:23], v[144:147], v[64:79]
 v_exp_f32 v48, v48
 v_exp_f32 v49, v49
 v_exp_f32 v50, v50
 v_exp_f32 v51, v51
 v_smfmac_f32_32x32x32_bf16 v[216:231], a[24:27], v[32:39], v163
 ds_read_b128 a[32:35], v161 offset:8640
 v_exp_f32 v52, v52
 v_exp_f32 v53, v53
 v_exp_f32 v54, v54
 v_exp_f32 v55, v55
 v_smfmac_f32_32x32x32_bf16 v[216:231], a[28:31], v[40:47], v163
 ds_read_b128 a[36:39], v161 offset:9312
 v_exp_f32 v56, v56
 v_exp_f32 v57, v57
 v_exp_f32 v58, v58
 v_exp_f32 v59, v59
 v_mfma_f32_32x32x4_2b_bf16 v[96:127], a[42:43], v[134:135], 0
 v_exp_f32 v60, v60
 v_exp_f32 v61, v61
 v_exp_f32 v62, v62
 v_exp_f32 v63, v63
 v_exp_f32 v64, v64
 v_exp_f32 v65, v65
 v_exp_f32 v66, v66
 v_exp_f32 v67, v67
 v_mfma_f32_32x32x16_bf16 v[80:95], a[20:23], v[148:151], v[80:95]
 v_exp_f32 v68, v68
 v_exp_f32 v69, v69
 v_exp_f32 v70, v70
 v_exp_f32 v71, v71
 v_smfmac_f32_32x32x32_bf16 v[232:247], a[24:27], v[48:55], v163
 v_exp_f32 v72, v72
 v_exp_f32 v73, v73
 v_exp_f32 v74, v74
 v_exp_f32 v75, v75
 v_smfmac_f32_32x32x32_bf16 v[232:247], a[28:31], v[56:63], v163
 v_exp_f32 v76, v76
 v_exp_f32 v77, v77
 v_exp_f32 v78, v78
 v_exp_f32 v79, v79
 v_mfma_f32_32x32x16_bf16 v[96:111], a[20:23], v[152:155], v[96:111]
 s_waitcnt lgkmcnt(0)
 v_exp_f32 v80, v80
 v_exp_f32 v81, v81
 v_exp_f32 v82, v82
 v_exp_f32 v83, v83
 v_smfmac_f32_32x32x32_bf16 v[184:199], a[32:35], v[64:71], v163
 ds_read_b128 a[16:19], v160 offset:10496
 v_exp_f32 v84, v84
 v_exp_f32 v85, v85
 v_exp_f32 v86, v86
 v_exp_f32 v87, v87
 v_smfmac_f32_32x32x32_bf16 v[184:199], a[36:39], v[72:79], v163
 v_exp_f32 v88, v88
 v_exp_f32 v89, v89
 v_exp_f32 v90, v90
 v_exp_f32 v91, v91
 v_mfma_f32_32x32x4_2b_bf16 v[0:31], a[44:45], v[128:129], 0
 v_exp_f32 v92, v92
 v_exp_f32 v93, v93
 v_exp_f32 v94, v94
 v_exp_f32 v95, v95
 v_exp_f32 v96, v96
 v_exp_f32 v97, v97
 v_exp_f32 v98, v98
 v_exp_f32 v99, v99
 v_mfma_f32_32x32x16_bf16 v[112:127], a[20:23], v[156:159], v[112:127]
 v_exp_f32 v100, v100
 v_exp_f32 v101, v101
 v_exp_f32 v102, v102
 v_exp_f32 v103, v103
 v_smfmac_f32_32x32x32_bf16 v[200:215], a[32:35], v[80:87], v163
 v_exp_f32 v104, v104
 v_exp_f32 v105, v105
 v_exp_f32 v106, v106
 v_exp_f32 v107, v107
 v_smfmac_f32_32x32x32_bf16 v[200:215], a[36:39], v[88:95], v163
 s_waitcnt lgkmcnt(0)
 v_exp_f32 v108, v108
 v_exp_f32 v109, v109
 v_exp_f32 v110, v110
 v_exp_f32 v111, v111
 v_mfma_f32_32x32x16_bf16 v[0:15], a[16:19], v[144:147], v[0:15]
 v_exp_f32 v112, v112
 v_exp_f32 v113, v113
 v_exp_f32 v114, v114
 v_exp_f32 v115, v115
 v_smfmac_f32_32x32x32_bf16 v[216:231], a[32:35], v[96:103], v163
 ds_read_b128 a[24:27], v161 offset:14592
 v_exp_f32 v116, v116
 v_exp_f32 v117, v117
 v_exp_f32 v118, v118
 v_exp_f32 v119, v119
 v_smfmac_f32_32x32x32_bf16 v[216:231], a[36:39], v[104:111], v163
 ds_read_b128 a[28:31], v161 offset:15264
 v_exp_f32 v120, v120
 v_exp_f32 v121, v121
 v_exp_f32 v122, v122
 v_exp_f32 v123, v123
 v_mfma_f32_32x32x4_2b_bf16 v[32:63], a[44:45], v[132:133], 0
 v_exp_f32 v124, v124
 v_exp_f32 v125, v125
 v_exp_f32 v126, v126
 v_exp_f32 v127, v127
 v_exp_f32 v0, v0
 v_exp_f32 v1, v1
 v_exp_f32 v2, v2
 v_exp_f32 v3, v3
 v_mfma_f32_32x32x16_bf16 v[16:31], a[16:19], v[148:151], v[16:31]
 v_exp_f32 v4, v4
 v_exp_f32 v5, v5
 v_exp_f32 v6, v6
 v_exp_f32 v7, v7
 v_smfmac_f32_32x32x32_bf16 v[232:247], a[32:35], v[112:119], v163
 v_exp_f32 v8, v8
 v_exp_f32 v9, v9
 v_exp_f32 v10, v10
 v_exp_f32 v11, v11
 v_smfmac_f32_32x32x32_bf16 v[232:247], a[36:39], v[120:127], v163
 v_exp_f32 v12, v12
 v_exp_f32 v13, v13
 v_exp_f32 v14, v14
 v_exp_f32 v15, v15
 v_mfma_f32_32x32x16_bf16 v[32:47], a[16:19], v[152:155], v[32:47]
 s_waitcnt lgkmcnt(0)
 v_exp_f32 v16, v16
 v_exp_f32 v17, v17
 v_exp_f32 v18, v18
 v_exp_f32 v19, v19
 v_smfmac_f32_32x32x32_bf16 v[184:199], a[24:27], v[0:7], v163
 ds_read_b128 a[20:23], v160 offset:11520
 v_exp_f32 v20, v20
 v_exp_f32 v21, v21
 v_exp_f32 v22, v22
 v_exp_f32 v23, v23
 v_smfmac_f32_32x32x32_bf16 v[184:199], a[28:31], v[8:15], v163
 s_add_u32 s74, s74, 1
 v_exp_f32 v24, v24
 v_exp_f32 v25, v25
 v_exp_f32 v26, v26
 v_exp_f32 v27, v27
 v_mfma_f32_32x32x4_2b_bf16 v[64:95], a[44:45], v[130:131], 0
 v_exp_f32 v28, v28
 v_exp_f32 v29, v29
 v_exp_f32 v30, v30
 v_exp_f32 v31, v31
 v_exp_f32 v32, v32
 v_exp_f32 v33, v33
 v_exp_f32 v34, v34
 v_exp_f32 v35, v35
 v_mfma_f32_32x32x16_bf16 v[48:63], a[16:19], v[156:159], v[48:63]
 v_exp_f32 v36, v36
 v_exp_f32 v37, v37
 v_exp_f32 v38, v38
 v_exp_f32 v39, v39
 v_smfmac_f32_32x32x32_bf16 v[200:215], a[24:27], v[16:23], v163
 v_exp_f32 v40, v40
 v_exp_f32 v41, v41
 v_exp_f32 v42, v42
 v_exp_f32 v43, v43
 v_smfmac_f32_32x32x32_bf16 v[200:215], a[28:31], v[24:31], v163
 s_waitcnt lgkmcnt(0)
 v_exp_f32 v44, v44
 v_exp_f32 v45, v45
 v_exp_f32 v46, v46
 v_exp_f32 v47, v47
 v_mfma_f32_32x32x16_bf16 v[64:79], a[20:23], v[144:147], v[64:79]
 v_exp_f32 v48, v48
 v_exp_f32 v49, v49
 v_exp_f32 v50, v50
 v_exp_f32 v51, v51
 v_smfmac_f32_32x32x32_bf16 v[216:231], a[24:27], v[32:39], v163
 s_and_b32 s67, s26, 15
 s_lshl_b32 s67, s67, 7
 ds_read_b128 a[32:35], v161 offset:15936
 v_exp_f32 v52, v52
 v_exp_f32 v53, v53
 v_exp_f32 v54, v54
 v_exp_f32 v55, v55
 v_smfmac_f32_32x32x32_bf16 v[216:231], a[28:31], v[40:47], v163
 ds_read_b128 a[36:39], v161 offset:16608
 v_exp_f32 v56, v56
 v_exp_f32 v57, v57
 v_exp_f32 v58, v58
 v_exp_f32 v59, v59
 v_mfma_f32_32x32x4_2b_bf16 v[96:127], a[44:45], v[134:135], 0
 v_exp_f32 v60, v60
 v_exp_f32 v61, v61
 v_exp_f32 v62, v62
 v_exp_f32 v63, v63
 v_exp_f32 v64, v64
 v_exp_f32 v65, v65
 v_exp_f32 v66, v66
 v_exp_f32 v67, v67
 v_mfma_f32_32x32x16_bf16 v[80:95], a[20:23], v[148:151], v[80:95]
 v_exp_f32 v68, v68
 v_exp_f32 v69, v69
 v_exp_f32 v70, v70
 v_exp_f32 v71, v71
 v_smfmac_f32_32x32x32_bf16 v[232:247], a[24:27], v[48:55], v163
 v_exp_f32 v72, v72
 v_exp_f32 v73, v73
 v_exp_f32 v74, v74
 v_exp_f32 v75, v75
 v_smfmac_f32_32x32x32_bf16 v[232:247], a[28:31], v[56:63], v163
 v_exp_f32 v76, v76
 v_exp_f32 v77, v77
 v_exp_f32 v78, v78
 v_exp_f32 v79, v79
 v_mfma_f32_32x32x16_bf16 v[96:111], a[20:23], v[152:155], v[96:111]
 s_waitcnt lgkmcnt(0)
 v_exp_f32 v80, v80
 v_exp_f32 v81, v81
 v_exp_f32 v82, v82
 v_exp_f32 v83, v83
 v_smfmac_f32_32x32x32_bf16 v[184:199], a[32:35], v[64:71], v163
 ds_read_b128 a[16:19], v160 offset:12544
 v_exp_f32 v84, v84
 v_exp_f32 v85, v85
 v_exp_f32 v86, v86
 v_exp_f32 v87, v87
 v_smfmac_f32_32x32x32_bf16 v[184:199], a[36:39], v[72:79], v163
 s_lshr_b64 s[26:27], s[26:27], 4
 buffer_load_dword a200, v171, s[44:47], s67 offen
 v_exp_f32 v88, v88
 v_exp_f32 v89, v89
 v_exp_f32 v90, v90
 v_exp_f32 v91, v91
 v_mfma_f32_32x32x4_2b_bf16 v[0:31], a[46:47], v[128:129], 0
 v_exp_f32 v92, v92
 v_exp_f32 v93, v93
 v_exp_f32 v94, v94
 v_exp_f32 v95, v95
 v_exp_f32 v96, v96
 v_exp_f32 v97, v97
 v_exp_f32 v98, v98
 v_exp_f32 v99, v99
 v_mfma_f32_32x32x16_bf16 v[112:127], a[20:23], v[156:159], v[112:127]
 v_exp_f32 v100, v100
 v_exp_f32 v101, v101
 v_exp_f32 v102, v102
 v_exp_f32 v103, v103
 v_smfmac_f32_32x32x32_bf16 v[200:215], a[32:35], v[80:87], v163
 v_exp_f32 v104, v104
 v_exp_f32 v105, v105
 v_exp_f32 v106, v106
 v_exp_f32 v107, v107
 v_smfmac_f32_32x32x32_bf16 v[200:215], a[36:39], v[88:95], v163
 s_waitcnt lgkmcnt(0)
 v_exp_f32 v108, v108
 v_exp_f32 v109, v109
 v_exp_f32 v110, v110
 v_exp_f32 v111, v111
 v_mfma_f32_32x32x16_bf16 v[0:15], a[16:19], v[144:147], v[0:15]
 v_exp_f32 v112, v112
 v_exp_f32 v113, v113
 v_exp_f32 v114, v114
 v_exp_f32 v115, v115
 v_smfmac_f32_32x32x32_bf16 v[216:231], a[32:35], v[96:103], v163
 ds_read_b128 a[24:27], v161 offset:17280
 v_exp_f32 v116, v116
 v_exp_f32 v117, v117
 v_exp_f32 v118, v118
 v_exp_f32 v119, v119
 v_smfmac_f32_32x32x32_bf16 v[216:231], a[36:39], v[104:111], v163
 ds_read_b128 a[28:31], v161 offset:17952
 v_exp_f32 v120, v120
 v_exp_f32 v121, v121
 v_exp_f32 v122, v122
 v_exp_f32 v123, v123
 v_mfma_f32_32x32x4_2b_bf16 v[32:63], a[46:47], v[132:133], 0
 v_exp_f32 v124, v124
 v_exp_f32 v125, v125
 v_exp_f32 v126, v126
 v_exp_f32 v127, v127
 v_exp_f32 v0, v0
 v_exp_f32 v1, v1
 v_exp_f32 v2, v2
 v_exp_f32 v3, v3
 v_mfma_f32_32x32x16_bf16 v[16:31], a[16:19], v[148:151], v[16:31]
 v_exp_f32 v4, v4
 v_exp_f32 v5, v5
 v_exp_f32 v6, v6
 v_exp_f32 v7, v7
 v_smfmac_f32_32x32x32_bf16 v[232:247], a[32:35], v[112:119], v163
 v_exp_f32 v8, v8
 v_exp_f32 v9, v9
 v_exp_f32 v10, v10
 v_exp_f32 v11, v11
 v_smfmac_f32_32x32x32_bf16 v[232:247], a[36:39], v[120:127], v163
 v_exp_f32 v12, v12
 v_exp_f32 v13, v13
 v_exp_f32 v14, v14
 v_exp_f32 v15, v15
 v_mfma_f32_32x32x16_bf16 v[32:47], a[16:19], v[152:155], v[32:47]
 s_waitcnt lgkmcnt(0)
 v_exp_f32 v16, v16
 v_exp_f32 v17, v17
 v_exp_f32 v18, v18
 v_exp_f32 v19, v19
 v_smfmac_f32_32x32x32_bf16 v[184:199], a[24:27], v[0:7], v163
 ds_read_b128 a[20:23], v160 offset:13568
 v_exp_f32 v20, v20
 v_exp_f32 v21, v21
 v_exp_f32 v22, v22
 v_exp_f32 v23, v23
 v_smfmac_f32_32x32x32_bf16 v[184:199], a[28:31], v[8:15], v163
 ds_read_b128 a[40:43], v162 offset:19968
 v_exp_f32 v24, v24
 v_exp_f32 v25, v25
 v_exp_f32 v26, v26
 v_exp_f32 v27, v27
 v_mfma_f32_32x32x4_2b_bf16 v[64:95], a[46:47], v[130:131], 0
 v_exp_f32 v28, v28
 v_exp_f32 v29, v29
 v_exp_f32 v30, v30
 v_exp_f32 v31, v31
 v_exp_f32 v32, v32
 v_exp_f32 v33, v33
 v_exp_f32 v34, v34
 v_exp_f32 v35, v35
 v_mfma_f32_32x32x16_bf16 v[48:63], a[16:19], v[156:159], v[48:63]
 v_exp_f32 v36, v36
 v_exp_f32 v37, v37
 v_exp_f32 v38, v38
 v_exp_f32 v39, v39
 v_smfmac_f32_32x32x32_bf16 v[200:215], a[24:27], v[16:23], v163
 v_exp_f32 v40, v40
 v_exp_f32 v41, v41
 v_exp_f32 v42, v42
 v_exp_f32 v43, v43
 v_smfmac_f32_32x32x32_bf16 v[200:215], a[28:31], v[24:31], v163
 s_waitcnt lgkmcnt(0)
 v_exp_f32 v44, v44
 v_exp_f32 v45, v45
 v_exp_f32 v46, v46
 v_exp_f32 v47, v47
 v_mfma_f32_32x32x16_bf16 v[64:79], a[20:23], v[144:147], v[64:79]
 v_exp_f32 v48, v48
 v_exp_f32 v49, v49
 v_exp_f32 v50, v50
 v_exp_f32 v51, v51
 v_smfmac_f32_32x32x32_bf16 v[216:231], a[24:27], v[32:39], v163
 ds_read_b128 a[32:35], v161 offset:18624
 v_exp_f32 v52, v52
 v_exp_f32 v53, v53
 v_exp_f32 v54, v54
 v_exp_f32 v55, v55
 v_smfmac_f32_32x32x32_bf16 v[216:231], a[28:31], v[40:47], v163
 ds_read_b128 a[36:39], v161 offset:19296
 v_exp_f32 v56, v56
 v_exp_f32 v57, v57
 v_exp_f32 v58, v58
 v_exp_f32 v59, v59
 v_mfma_f32_32x32x4_2b_bf16 v[96:127], a[46:47], v[134:135], 0
 v_exp_f32 v60, v60
 v_exp_f32 v61, v61
 v_exp_f32 v62, v62
 v_exp_f32 v63, v63
 v_exp_f32 v64, v64
 v_exp_f32 v65, v65
 v_exp_f32 v66, v66
 v_exp_f32 v67, v67
 v_mfma_f32_32x32x16_bf16 v[80:95], a[20:23], v[148:151], v[80:95]
 v_exp_f32 v68, v68
 v_exp_f32 v69, v69
 v_exp_f32 v70, v70
 v_exp_f32 v71, v71
 v_smfmac_f32_32x32x32_bf16 v[232:247], a[24:27], v[48:55], v163
 v_exp_f32 v72, v72
 v_exp_f32 v73, v73
 v_exp_f32 v74, v74
 v_exp_f32 v75, v75
 v_smfmac_f32_32x32x32_bf16 v[232:247], a[28:31], v[56:63], v163
 v_exp_f32 v76, v76
 v_exp_f32 v77, v77
 v_exp_f32 v78, v78
 v_exp_f32 v79, v79
 v_mfma_f32_32x32x16_bf16 v[96:111], a[20:23], v[152:155], v[96:111]
 s_waitcnt lgkmcnt(0)
 v_exp_f32 v80, v80
 v_exp_f32 v81, v81
 v_exp_f32 v82, v82
 v_exp_f32 v83, v83
 v_smfmac_f32_32x32x32_bf16 v[184:199], a[32:35], v[64:71], v163
 ds_read_b128 a[16:19], v160 offset:20480
 v_exp_f32 v84, v84
 v_exp_f32 v85, v85
 v_exp_f32 v86, v86
 v_exp_f32 v87, v87
 v_smfmac_f32_32x32x32_bf16 v[184:199], a[36:39], v[72:79], v163
 v_exp_f32 v88, v88
 v_exp_f32 v89, v89
 v_exp_f32 v90, v90
 v_exp_f32 v91, v91
 v_mfma_f32_32x32x4_2b_bf16 v[0:31], a[40:41], v[128:129], 0
 v_exp_f32 v92, v92
 v_exp_f32 v93, v93
 v_exp_f32 v94, v94
 v_exp_f32 v95, v95
 v_exp_f32 v96, v96
 v_exp_f32 v97, v97
 v_exp_f32 v98, v98
 v_exp_f32 v99, v99
 v_mfma_f32_32x32x16_bf16 v[112:127], a[20:23], v[156:159], v[112:127]
 s_cmp_lt_u32 s74, 7
 v_exp_f32 v100, v100
 v_exp_f32 v101, v101
 v_exp_f32 v102, v102
 v_exp_f32 v103, v103
 v_smfmac_f32_32x32x32_bf16 v[200:215], a[32:35], v[80:87], v163
 v_add_u32 v160, 19968, v160
 v_add_u32 v161, 19968, v161
 v_add_u32 v162, 19968, v162
 v_exp_f32 v104, v104
 v_exp_f32 v105, v105
 v_exp_f32 v106, v106
 v_exp_f32 v107, v107
 v_smfmac_f32_32x32x32_bf16 v[200:215], a[36:39], v[88:95], v163
 s_waitcnt lgkmcnt(0)
 v_exp_f32 v108, v108
 v_exp_f32 v109, v109
 v_exp_f32 v110, v110
 v_exp_f32 v111, v111
 s_cbranch_scc1 L_att_loop
 s_waitcnt vmcnt(0)
 s_barrier
 v_mov_b32 v143, 1
 buffer_store_byte v143, v166, s[56:59], s3 offen sc1
 v_accvgpr_read_b32 v172, a205
 v_accvgpr_read_b32 v173, a206
 v_accvgpr_read_b32 v174, a207
 v_accvgpr_read_b32 v175, a208
 s_lshl_b32 s69, s63, 10
 s_and_b32 s68, s61, 2
 s_lshl_b32 s68, s68, 5
 s_add_u32 s68, s68, 1024
 v_mfma_f32_32x32x16_bf16 v[0:15], a[16:19], v[144:147], v[0:15]
 v_exp_f32 v112, v112
 v_exp_f32 v113, v113
 v_exp_f32 v114, v114
 v_exp_f32 v115, v115
 v_smfmac_f32_32x32x32_bf16 v[216:231], a[32:35], v[96:103], v163
 ds_read_b128 a[24:27], v161 offset:4608
 v_exp_f32 v116, v116
 v_exp_f32 v117, v117
 v_exp_f32 v118, v118
 v_exp_f32 v119, v119
 v_smfmac_f32_32x32x32_bf16 v[216:231], a[36:39], v[104:111], v163
 ds_read_b128 a[28:31], v161 offset:5280
 v_exp_f32 v120, v120
 v_exp_f32 v121, v121
 v_exp_f32 v122, v122
 v_exp_f32 v123, v123
 v_mfma_f32_32x32x4_2b_bf16 v[32:63], a[40:41], v[132:133], 0
 v_exp_f32 v124, v124
 v_exp_f32 v125, v125
 v_exp_f32 v126, v126
 v_exp_f32 v127, v127
 v_exp_f32 v0, v0
 v_exp_f32 v1, v1
 v_exp_f32 v2, v2
 v_exp_f32 v3, v3
 v_mfma_f32_32x32x16_bf16 v[16:31], a[16:19], v[148:151], v[16:31]
 v_exp_f32 v4, v4
 v_exp_f32 v5, v5
 v_exp_f32 v6, v6
 v_exp_f32 v7, v7
 v_smfmac_f32_32x32x32_bf16 v[232:247], a[32:35], v[112:119], v163
 v_exp_f32 v8, v8
 v_exp_f32 v9, v9
 v_exp_f32 v10, v10
 v_exp_f32 v11, v11
 v_smfmac_f32_32x32x32_bf16 v[232:247], a[36:39], v[120:127], v163
 v_exp_f32 v12, v12
 v_exp_f32 v13, v13
 v_exp_f32 v14, v14
 v_exp_f32 v15, v15
 v_mfma_f32_32x32x16_bf16 v[32:47], a[16:19], v[152:155], v[32:47]
 s_waitcnt lgkmcnt(0)
 v_exp_f32 v16, v16
 v_exp_f32 v17, v17
 v_exp_f32 v18, v18
 v_exp_f32 v19, v19
 v_smfmac_f32_32x32x32_bf16 v[184:199], a[24:27], v[0:7], v163
 s_add_u32 m0, s69, 0
 s_add_u32 s65, s72, 0
 ds_read_b128 a[20:23], v160 offset:1536
 buffer_load_dwordx4 v172, s[40:43], s65 offen lds
 v_exp_f32 v20, v20
 v_exp_f32 v21, v21
 v_exp_f32 v22, v22
 v_exp_f32 v23, v23
 v_smfmac_f32_32x32x32_bf16 v[184:199], a[28:31], v[8:15], v163
 v_exp_f32 v24, v24
 v_exp_f32 v25, v25
 v_exp_f32 v26, v26
 v_exp_f32 v27, v27
 v_mfma_f32_32x32x4_2b_bf16 v[64:95], a[40:41], v[130:131], 0
 v_exp_f32 v28, v28
 v_exp_f32 v29, v29
 v_exp_f32 v30, v30
 v_exp_f32 v31, v31
 v_exp_f32 v32, v32
 v_exp_f32 v33, v33
 v_exp_f32 v34, v34
 v_exp_f32 v35, v35
 v_mfma_f32_32x32x16_bf16 v[48:63], a[16:19], v[156:159], v[48:63]
 v_exp_f32 v36, v36
 v_exp_f32 v37, v37
 v_exp_f32 v38, v38
 v_exp_f32 v39, v39
 v_smfmac_f32_32x32x32_bf16 v[200:215], a[24:27], v[16:23], v163
 s_add_u32 m0, s69, 4096
 s_add_u32 s65, s72, 41472
 buffer_load_dwordx4 v172, s[40:43], s65 offen lds
 v_exp_f32 v40, v40
 v_exp_f32 v41, v41
 v_exp_f32 v42, v42
 v_exp_f32 v43, v43
 v_smfmac_f32_32x32x32_bf16 v[200:215], a[28:31], v[24:31], v163
 s_waitcnt lgkmcnt(0)
 v_exp_f32 v44, v44
 v_exp_f32 v45, v45
 v_exp_f32 v46, v46
 v_exp_f32 v47, v47
 v_mfma_f32_32x32x16_bf16 v[64:79], a[20:23], v[144:147], v[64:79]
 v_exp_f32 v48, v48
 v_exp_f32 v49, v49
 v_exp_f32 v50, v50
 v_exp_f32 v51, v51
 v_smfmac_f32_32x32x32_bf16 v[216:231], a[24:27], v[32:39], v163
 s_add_u32 m0, s69, 8192
 s_add_u32 s65, s72, 82944
 ds_read_b128 a[32:35], v161 offset:5952
 buffer_load_dwordx4 v172, s[40:43], s65 offen lds
 v_exp_f32 v52, v52
 v_exp_f32 v53, v53
 v_exp_f32 v54, v54
 v_exp_f32 v55, v55
 v_smfmac_f32_32x32x32_bf16 v[216:231], a[28:31], v[40:47], v163
 ds_read_b128 a[36:39], v161 offset:6624
 v_exp_f32 v56, v56
 v_exp_f32 v57, v57
 v_exp_f32 v58, v58
 v_exp_f32 v59, v59
 v_mfma_f32_32x32x4_2b_bf16 v[96:127], a[40:41], v[134:135], 0
 v_exp_f32 v60, v60
 v_exp_f32 v61, v61
 v_exp_f32 v62, v62
 v_exp_f32 v63, v63
 v_exp_f32 v64, v64
 v_exp_f32 v65, v65
 v_exp_f32 v66, v66
 v_exp_f32 v67, v67
 v_mfma_f32_32x32x16_bf16 v[80:95], a[20:23], v[148:151], v[80:95]
 v_exp_f32 v68, v68
 v_exp_f32 v69, v69
 v_exp_f32 v70, v70
 v_exp_f32 v71, v71
 v_smfmac_f32_32x32x32_bf16 v[232:247], a[24:27], v[48:55], v163
 s_add_u32 m0, s69, 12288
 s_add_u32 s65, s72, 124416
 buffer_load_dwordx4 v172, s[40:43], s65 offen lds
 v_exp_f32 v72, v72
 v_exp_f32 v73, v73
 v_exp_f32 v74, v74
 v_exp_f32 v75, v75
 v_smfmac_f32_32x32x32_bf16 v[232:247], a[28:31], v[56:63], v163
 v_exp_f32 v76, v76
 v_exp_f32 v77, v77
 v_exp_f32 v78, v78
 v_exp_f32 v79, v79
 v_mfma_f32_32x32x16_bf16 v[96:111], a[20:23], v[152:155], v[96:111]
 s_waitcnt lgkmcnt(0)
 v_exp_f32 v80, v80
 v_exp_f32 v81, v81
 v_exp_f32 v82, v82
 v_exp_f32 v83, v83
 v_smfmac_f32_32x32x32_bf16 v[184:199], a[32:35], v[64:71], v163
 s_add_u32 m0, s69, 16384
 s_add_u32 s65, s72, 165888
 ds_read_b128 a[16:19], v160 offset:2560
 buffer_load_dwordx4 v172, s[40:43], s65 offen lds
 v_exp_f32 v84, v84
 v_exp_f32 v85, v85
 v_exp_f32 v86, v86
 v_exp_f32 v87, v87
 v_smfmac_f32_32x32x32_bf16 v[184:199], a[36:39], v[72:79], v163
 v_exp_f32 v88, v88
 v_exp_f32 v89, v89
 v_exp_f32 v90, v90
 v_exp_f32 v91, v91
 v_mfma_f32_32x32x4_2b_bf16 v[0:31], a[42:43], v[128:129], 0
 v_exp_f32 v92, v92
 v_exp_f32 v93, v93
 v_exp_f32 v94, v94
 v_exp_f32 v95, v95
 v_exp_f32 v96, v96
 v_exp_f32 v97, v97
 v_exp_f32 v98, v98
 v_exp_f32 v99, v99
 v_mfma_f32_32x32x16_bf16 v[112:127], a[20:23], v[156:159], v[112:127]
 v_exp_f32 v100, v100
 v_exp_f32 v101, v101
 v_exp_f32 v102, v102
 v_exp_f32 v103, v103
 v_smfmac_f32_32x32x32_bf16 v[200:215], a[32:35], v[80:87], v163
 s_add_u32 m0, s69, 20480
 s_add_u32 s65, s72, 207360
 buffer_load_dwordx4 v172, s[40:43], s65 offen lds
 v_exp_f32 v104, v104
 v_exp_f32 v105, v105
 v_exp_f32 v106, v106
 v_exp_f32 v107, v107
 v_smfmac_f32_32x32x32_bf16 v[200:215], a[36:39], v[88:95], v163
 s_waitcnt lgkmcnt(0)
 v_exp_f32 v108, v108
 v_exp_f32 v109, v109
 v_exp_f32 v110, v110
 v_exp_f32 v111, v111
 v_mfma_f32_32x32x16_bf16 v[0:15], a[16:19], v[144:147], v[0:15]
 v_exp_f32 v112, v112
 v_exp_f32 v113, v113
 v_exp_f32 v114, v114
 v_exp_f32 v115, v115
 v_smfmac_f32_32x32x32_bf16 v[216:231], a[32:35], v[96:103], v163
 s_add_u32 m0, s69, 24576
 s_add_u32 s65, s72, 248832
 ds_read_b128 a[24:27], v161 offset:7296
 buffer_load_dwordx4 v172, s[40:43], s65 offen lds
 v_exp_f32 v116, v116
 v_exp_f32 v117, v117
 v_exp_f32 v118, v118
 v_exp_f32 v119, v119
 v_smfmac_f32_32x32x32_bf16 v[216:231], a[36:39], v[104:111], v163
 ds_read_b128 a[28:31], v161 offset:7968
 v_exp_f32 v120, v120
 v_exp_f32 v121, v121
 v_exp_f32 v122, v122
 v_exp_f32 v123, v123
 v_mfma_f32_32x32x4_2b_bf16 v[32:63], a[42:43], v[132:133], 0
 v_exp_f32 v124, v124
 v_exp_f32 v125, v125
 v_exp_f32 v126, v126
 v_exp_f32 v127, v127
 v_exp_f32 v0, v0
 v_exp_f32 v1, v1
 v_exp_f32 v2, v2
 v_exp_f32 v3, v3
 v_mfma_f32_32x32x16_bf16 v[16:31], a[16:19], v[148:151], v[16:31]
 v_exp_f32 v4, v4
 v_exp_f32 v5, v5
 v_exp_f32 v6, v6
 v_exp_f32 v7, v7
 v_smfmac_f32_32x32x32_bf16 v[232:247], a[32:35], v[112:119], v163
 s_add_u32 m0, s69, 28672
 s_add_u32 s65, s72, 290304
 buffer_load_dwordx4 v172, s[40:43], s65 offen lds
 v_exp_f32 v8, v8
 v_exp_f32 v9, v9
 v_exp_f32 v10, v10
 v_exp_f32 v11, v11
 v_smfmac_f32_32x32x32_bf16 v[232:247], a[36:39], v[120:127], v163
 v_exp_f32 v12, v12
 v_exp_f32 v13, v13
 v_exp_f32 v14, v14
 v_exp_f32 v15, v15
 v_mfma_f32_32x32x16_bf16 v[32:47], a[16:19], v[152:155], v[32:47]
 s_waitcnt lgkmcnt(0)
 v_exp_f32 v16, v16
 v_exp_f32 v17, v17
 v_exp_f32 v18, v18
 v_exp_f32 v19, v19
 v_smfmac_f32_32x32x32_bf16 v[184:199], a[24:27], v[0:7], v163
 s_add_u32 m0, s69, 32768
 s_add_u32 s65, s72, 331776
 ds_read_b128 a[20:23], v160 offset:3584
 buffer_load_dwordx4 v172, s[40:43], s65 offen lds
 v_exp_f32 v20, v20
 v_exp_f32 v21, v21
 v_exp_f32 v22, v22
 v_exp_f32 v23, v23
 v_smfmac_f32_32x32x32_bf16 v[184:199], a[28:31], v[8:15], v163
 ds_read_b128 a[44:47], v162 offset:9984
 v_exp_f32 v24, v24
 v_exp_f32 v25, v25
 v_exp_f32 v26, v26
 v_exp_f32 v27, v27
 v_mfma_f32_32x32x4_2b_bf16 v[64:95], a[42:43], v[130:131], 0
 v_exp_f32 v28, v28
 v_exp_f32 v29, v29
 v_exp_f32 v30, v30
 v_exp_f32 v31, v31
 v_exp_f32 v32, v32
 v_exp_f32 v33, v33
 v_exp_f32 v34, v34
 v_exp_f32 v35, v35
 v_mfma_f32_32x32x16_bf16 v[48:63], a[16:19], v[156:159], v[48:63]
 v_exp_f32 v36, v36
 v_exp_f32 v37, v37
 v_exp_f32 v38, v38
 v_exp_f32 v39, v39
 v_smfmac_f32_32x32x32_bf16 v[200:215], a[24:27], v[16:23], v163
 s_add_u32 m0, s69, 36864
 s_add_u32 s65, s72, 373248
 buffer_load_dwordx4 v172, s[40:43], s65 offen lds
 v_exp_f32 v40, v40
 v_exp_f32 v41, v41
 v_exp_f32 v42, v42
 v_exp_f32 v43, v43
 v_smfmac_f32_32x32x32_bf16 v[200:215], a[28:31], v[24:31], v163
 s_waitcnt lgkmcnt(0)
 v_exp_f32 v44, v44
 v_exp_f32 v45, v45
 v_exp_f32 v46, v46
 v_exp_f32 v47, v47
 v_mfma_f32_32x32x16_bf16 v[64:79], a[20:23], v[144:147], v[64:79]
 v_exp_f32 v48, v48
 v_exp_f32 v49, v49
 v_exp_f32 v50, v50
 v_exp_f32 v51, v51
 v_smfmac_f32_32x32x32_bf16 v[216:231], a[24:27], v[32:39], v163
 s_add_u32 m0, s69, 40960
 s_add_u32 s65, s72, 414720
 ds_read_b128 a[32:35], v161 offset:8640
 buffer_load_dwordx4 v172, s[40:43], s65 offen lds
 v_exp_f32 v52, v52
 v_exp_f32 v53, v53
 v_exp_f32 v54, v54
 v_exp_f32 v55, v55
 v_smfmac_f32_32x32x32_bf16 v[216:231], a[28:31], v[40:47], v163
 ds_read_b128 a[36:39], v161 offset:9312
 v_exp_f32 v56, v56
 v_exp_f32 v57, v57
 v_exp_f32 v58, v58
 v_exp_f32 v59, v59
 v_mfma_f32_32x32x4_2b_bf16 v[96:127], a[42:43], v[134:135], 0
 v_exp_f32 v60, v60
 v_exp_f32 v61, v61
 v_exp_f32 v62, v62
 v_exp_f32 v63, v63
 v_exp_f32 v64, v64
 v_exp_f32 v65, v65
 v_exp_f32 v66, v66
 v_exp_f32 v67, v67
 v_mfma_f32_32x32x16_bf16 v[80:95], a[20:23], v[148:151], v[80:95]
 v_exp_f32 v68, v68
 v_exp_f32 v69, v69
 v_exp_f32 v70, v70
 v_exp_f32 v71, v71
 v_smfmac_f32_32x32x32_bf16 v[232:247], a[24:27], v[48:55], v163
 s_add_u32 m0, s69, 45056
 s_add_u32 s65, s72, 456192
 buffer_load_dwordx4 v172, s[40:43], s65 offen lds
 v_exp_f32 v72, v72
 v_exp_f32 v73, v73
 v_exp_f32 v74, v74
 v_exp_f32 v75, v75
 v_smfmac_f32_32x32x32_bf16 v[232:247], a[28:31], v[56:63], v163
 v_exp_f32 v76, v76
 v_exp_f32 v77, v77
 v_exp_f32 v78, v78
 v_exp_f32 v79, v79
 v_mfma_f32_32x32x16_bf16 v[96:111], a[20:23], v[152:155], v[96:111]
 s_waitcnt lgkmcnt(0)
 v_exp_f32 v80, v80
 v_exp_f32 v81, v81
 v_exp_f32 v82, v82
 v_exp_f32 v83, v83
 v_smfmac_f32_32x32x32_bf16 v[184:199], a[32:35], v[64:71], v163
 s_add_u32 m0, s69, 49152
 s_add_u32 s65, s72, 497664
 ds_read_b128 a[16:19], v160 offset:10496
 buffer_load_dwordx4 v172, s[40:43], s65 offen lds
 v_exp_f32 v84, v84
 v_exp_f32 v85, v85
 v_exp_f32 v86, v86
 v_exp_f32 v87, v87
 v_smfmac_f32_32x32x32_bf16 v[184:199], a[36:39], v[72:79], v163
 v_exp_f32 v88, v88
 v_exp_f32 v89, v89
 v_exp_f32 v90, v90
 v_exp_f32 v91, v91
 v_mfma_f32_32x32x4_2b_bf16 v[0:31], a[44:45], v[128:129], 0
 v_exp_f32 v92, v92
 v_exp_f32 v93, v93
 v_exp_f32 v94, v94
 v_exp_f32 v95, v95
 v_exp_f32 v96, v96
 v_exp_f32 v97, v97
 v_exp_f32 v98, v98
 v_exp_f32 v99, v99
 v_mfma_f32_32x32x16_bf16 v[112:127], a[20:23], v[156:159], v[112:127]
 v_exp_f32 v100, v100
 v_exp_f32 v101, v101
 v_exp_f32 v102, v102
 v_exp_f32 v103, v103
 v_smfmac_f32_32x32x32_bf16 v[200:215], a[32:35], v[80:87], v163
 s_add_u32 m0, s69, 53248
 s_add_u32 s65, s72, 539136
 buffer_load_dwordx4 v172, s[40:43], s65 offen lds
 v_exp_f32 v104, v104
 v_exp_f32 v105, v105
 v_exp_f32 v106, v106
 v_exp_f32 v107, v107
 v_smfmac_f32_32x32x32_bf16 v[200:215], a[36:39], v[88:95], v163
 s_waitcnt lgkmcnt(0)
 v_exp_f32 v108, v108
 v_exp_f32 v109, v109
 v_exp_f32 v110, v110
 v_exp_f32 v111, v111
 v_mfma_f32_32x32x16_bf16 v[0:15], a[16:19], v[144:147], v[0:15]
 v_exp_f32 v112, v112
 v_exp_f32 v113, v113
 v_exp_f32 v114, v114
 v_exp_f32 v115, v115
 v_smfmac_f32_32x32x32_bf16 v[216:231], a[32:35], v[96:103], v163
 s_add_u32 m0, s69, 57344
 s_add_u32 s65, s72, 580608
 ds_read_b128 a[24:27], v161 offset:14592
 buffer_load_dwordx4 v172, s[40:43], s65 offen lds
 v_exp_f32 v116, v116
 v_exp_f32 v117, v117
 v_exp_f32 v118, v118
 v_exp_f32 v119, v119
 v_smfmac_f32_32x32x32_bf16 v[216:231], a[36:39], v[104:111], v163
 ds_read_b128 a[28:31], v161 offset:15264
 v_exp_f32 v120, v120
 v_exp_f32 v121, v121
 v_exp_f32 v122, v122
 v_exp_f32 v123, v123
 v_mfma_f32_32x32x4_2b_bf16 v[32:63], a[44:45], v[132:133], 0
 v_exp_f32 v124, v124
 v_exp_f32 v125, v125
 v_exp_f32 v126, v126
 v_exp_f32 v127, v127
 v_exp_f32 v0, v0
 v_exp_f32 v1, v1
 v_exp_f32 v2, v2
 v_exp_f32 v3, v3
 v_mfma_f32_32x32x16_bf16 v[16:31], a[16:19], v[148:151], v[16:31]
 v_exp_f32 v4, v4
 v_exp_f32 v5, v5
 v_exp_f32 v6, v6
 v_exp_f32 v7, v7
 v_smfmac_f32_32x32x32_bf16 v[232:247], a[32:35], v[112:119], v163
 s_add_u32 m0, s69, 61440
 s_add_u32 s65, s72, 622080
 buffer_load_dwordx4 v172, s[40:43], s65 offen lds
 v_exp_f32 v8, v8
 v_exp_f32 v9, v9
 v_exp_f32 v10, v10
 v_exp_f32 v11, v11
 v_smfmac_f32_32x32x32_bf16 v[232:247], a[36:39], v[120:127], v163
 v_exp_f32 v12, v12
 v_exp_f32 v13, v13
 v_exp_f32 v14, v14
 v_exp_f32 v15, v15
 v_mfma_f32_32x32x16_bf16 v[32:47], a[16:19], v[152:155], v[32:47]
 s_waitcnt lgkmcnt(0)
 v_exp_f32 v16, v16
 v_exp_f32 v17, v17
 v_exp_f32 v18, v18
 v_exp_f32 v19, v19
 v_smfmac_f32_32x32x32_bf16 v[184:199], a[24:27], v[0:7], v163
 s_add_u32 m0, s69, 65536
 s_add_u32 s65, s72, 0
 ds_read_b128 a[20:23], v160 offset:11520
 buffer_load_dwordx4 v173, s[40:43], s65 offen lds
 v_exp_f32 v20, v20
 v_exp_f32 v21, v21
 v_exp_f32 v22, v22
 v_exp_f32 v23, v23
 v_smfmac_f32_32x32x32_bf16 v[184:199], a[28:31], v[8:15], v163
 v_exp_f32 v24, v24
 v_exp_f32 v25, v25
 v_exp_f32 v26, v26
 v_exp_f32 v27, v27
 v_mfma_f32_32x32x4_2b_bf16 v[64:95], a[44:45], v[130:131], 0
 v_exp_f32 v28, v28
 v_exp_f32 v29, v29
 v_exp_f32 v30, v30
 v_exp_f32 v31, v31
 v_exp_f32 v32, v32
 v_exp_f32 v33, v33
 v_exp_f32 v34, v34
 v_exp_f32 v35, v35
 v_mfma_f32_32x32x16_bf16 v[48:63], a[16:19], v[156:159], v[48:63]
 v_exp_f32 v36, v36
 v_exp_f32 v37, v37
 v_exp_f32 v38, v38
 v_exp_f32 v39, v39
 v_smfmac_f32_32x32x32_bf16 v[200:215], a[24:27], v[16:23], v163
 s_add_u32 m0, s69, 69632
 s_add_u32 s65, s72, 331776
 buffer_load_dwordx4 v173, s[40:43], s65 offen lds
 v_exp_f32 v40, v40
 v_exp_f32 v41, v41
 v_exp_f32 v42, v42
 v_exp_f32 v43, v43
 v_smfmac_f32_32x32x32_bf16 v[200:215], a[28:31], v[24:31], v163
 s_waitcnt lgkmcnt(0)
 v_exp_f32 v44, v44
 v_exp_f32 v45, v45
 v_exp_f32 v46, v46
 v_exp_f32 v47, v47
 v_mfma_f32_32x32x16_bf16 v[64:79], a[20:23], v[144:147], v[64:79]
 v_exp_f32 v48, v48
 v_exp_f32 v49, v49
 v_exp_f32 v50, v50
 v_exp_f32 v51, v51
 v_smfmac_f32_32x32x32_bf16 v[216:231], a[24:27], v[32:39], v163
 s_add_u32 m0, s69, 73728
 s_add_u32 s65, s68, 0
 ds_read_b128 a[32:35], v161 offset:15936
 buffer_load_dwordx4 v174, s[40:43], s65 offen lds
 v_exp_f32 v52, v52
 v_exp_f32 v53, v53
 v_exp_f32 v54, v54
 v_exp_f32 v55, v55
 v_smfmac_f32_32x32x32_bf16 v[216:231], a[28:31], v[40:47], v163
 ds_read_b128 a[36:39], v161 offset:16608
 v_exp_f32 v56, v56
 v_exp_f32 v57, v57
 v_exp_f32 v58, v58
 v_exp_f32 v59, v59
 v_mfma_f32_32x32x4_2b_bf16 v[96:127], a[44:45], v[134:135], 0
 v_exp_f32 v60, v60
 v_exp_f32 v61, v61
 v_exp_f32 v62, v62
 v_exp_f32 v63, v63
 v_exp_f32 v64, v64
 v_exp_f32 v65, v65
 v_exp_f32 v66, v66
 v_exp_f32 v67, v67
 v_mfma_f32_32x32x16_bf16 v[80:95], a[20:23], v[148:151], v[80:95]
 v_exp_f32 v68, v68
 v_exp_f32 v69, v69
 v_exp_f32 v70, v70
 v_exp_f32 v71, v71
 v_smfmac_f32_32x32x32_bf16 v[232:247], a[24:27], v[48:55], v163
 s_add_u32 m0, s69, 77824
 s_add_u32 s65, s68, 82944
 buffer_load_dwordx4 v174, s[40:43], s65 offen lds
 v_exp_f32 v72, v72
 v_exp_f32 v73, v73
 v_exp_f32 v74, v74
 v_exp_f32 v75, v75
 v_smfmac_f32_32x32x32_bf16 v[232:247], a[28:31], v[56:63], v163
 v_exp_f32 v76, v76
 v_exp_f32 v77, v77
 v_exp_f32 v78, v78
 v_exp_f32 v79, v79
 v_mfma_f32_32x32x16_bf16 v[96:111], a[20:23], v[152:155], v[96:111]
 s_waitcnt lgkmcnt(0)
 v_exp_f32 v80, v80
 v_exp_f32 v81, v81
 v_exp_f32 v82, v82
 v_exp_f32 v83, v83
 v_smfmac_f32_32x32x32_bf16 v[184:199], a[32:35], v[64:71], v163
 s_add_u32 m0, s69, 81920
 s_add_u32 s65, s68, 165888
 ds_read_b128 a[16:19], v160 offset:12544
 buffer_load_dwordx4 v174, s[40:43], s65 offen lds
 v_exp_f32 v84, v84
 v_exp_f32 v85, v85
 v_exp_f32 v86, v86
 v_exp_f32 v87, v87
 v_smfmac_f32_32x32x32_bf16 v[184:199], a[36:39], v[72:79], v163
 v_exp_f32 v88, v88
 v_exp_f32 v89, v89
 v_exp_f32 v90, v90
 v_exp_f32 v91, v91
 v_mfma_f32_32x32x4_2b_bf16 v[0:31], a[46:47], v[128:129], 0
 v_exp_f32 v92, v92
 v_exp_f32 v93, v93
 v_exp_f32 v94, v94
 v_exp_f32 v95, v95
 v_exp_f32 v96, v96
 v_exp_f32 v97, v97
 v_exp_f32 v98, v98
 v_exp_f32 v99, v99
 v_mfma_f32_32x32x16_bf16 v[112:127], a[20:23], v[156:159], v[112:127]
 v_exp_f32 v100, v100
 v_exp_f32 v101, v101
 v_exp_f32 v102, v102
 v_exp_f32 v103, v103
 v_smfmac_f32_32x32x32_bf16 v[200:215], a[32:35], v[80:87], v163
 s_add_u32 m0, s69, 86016
 s_add_u32 s65, s68, 248832
 buffer_load_dwordx4 v174, s[40:43], s65 offen lds
 v_exp_f32 v104, v104
 v_exp_f32 v105, v105
 v_exp_f32 v106, v106
 v_exp_f32 v107, v107
 v_smfmac_f32_32x32x32_bf16 v[200:215], a[36:39], v[88:95], v163
 s_waitcnt lgkmcnt(0)
 v_exp_f32 v108, v108
 v_exp_f32 v109, v109
 v_exp_f32 v110, v110
 v_exp_f32 v111, v111
 v_mfma_f32_32x32x16_bf16 v[0:15], a[16:19], v[144:147], v[0:15]
 v_exp_f32 v112, v112
 v_exp_f32 v113, v113
 v_exp_f32 v114, v114
 v_exp_f32 v115, v115
 v_smfmac_f32_32x32x32_bf16 v[216:231], a[32:35], v[96:103], v163
 s_add_u32 m0, s69, 90112
 s_add_u32 s65, s68, 331776
 ds_read_b128 a[24:27], v161 offset:17280
 buffer_load_dwordx4 v174, s[40:43], s65 offen lds
 v_exp_f32 v116, v116
 v_exp_f32 v117, v117
 v_exp_f32 v118, v118
 v_exp_f32 v119, v119
 v_smfmac_f32_32x32x32_bf16 v[216:231], a[36:39], v[104:111], v163
 ds_read_b128 a[28:31], v161 offset:17952
 v_exp_f32 v120, v120
 v_exp_f32 v121, v121
 v_exp_f32 v122, v122
 v_exp_f32 v123, v123
 v_mfma_f32_32x32x4_2b_bf16 v[32:63], a[46:47], v[132:133], 0
 v_exp_f32 v124, v124
 v_exp_f32 v125, v125
 v_exp_f32 v126, v126
 v_exp_f32 v127, v127
 v_exp_f32 v0, v0
 v_exp_f32 v1, v1
 v_exp_f32 v2, v2
 v_exp_f32 v3, v3
 v_mfma_f32_32x32x16_bf16 v[16:31], a[16:19], v[148:151], v[16:31]
 v_exp_f32 v4, v4
 v_exp_f32 v5, v5
 v_exp_f32 v6, v6
 v_exp_f32 v7, v7
 v_smfmac_f32_32x32x32_bf16 v[232:247], a[32:35], v[112:119], v163
 s_add_u32 m0, s69, 94208
 s_add_u32 s65, s68, 414720
 buffer_load_dwordx4 v174, s[40:43], s65 offen lds
 v_exp_f32 v8, v8
 v_exp_f32 v9, v9
 v_exp_f32 v10, v10
 v_exp_f32 v11, v11
 v_smfmac_f32_32x32x32_bf16 v[232:247], a[36:39], v[120:127], v163
 v_exp_f32 v12, v12
 v_exp_f32 v13, v13
 v_exp_f32 v14, v14
 v_exp_f32 v15, v15
 v_mfma_f32_32x32x16_bf16 v[32:47], a[16:19], v[152:155], v[32:47]
 s_waitcnt lgkmcnt(0)
 v_exp_f32 v16, v16
 v_exp_f32 v17, v17
 v_exp_f32 v18, v18
 v_exp_f32 v19, v19
 v_smfmac_f32_32x32x32_bf16 v[184:199], a[24:27], v[0:7], v163
 s_add_u32 m0, s69, 98304
 s_add_u32 s65, s68, 497664
 ds_read_b128 a[20:23], v160 offset:13568
 buffer_load_dwordx4 v174, s[40:43], s65 offen lds
 v_exp_f32 v20, v20
 v_exp_f32 v21, v21
 v_exp_f32 v22, v22
 v_exp_f32 v23, v23
 v_smfmac_f32_32x32x32_bf16 v[184:199], a[28:31], v[8:15], v163
 ds_read_b128 a[40:43], v162 offset:19968
 v_exp_f32 v24, v24
 v_exp_f32 v25, v25
 v_exp_f32 v26, v26
 v_exp_f32 v27, v27
 v_mfma_f32_32x32x4_2b_bf16 v[64:95], a[46:47], v[130:131], 0
 v_exp_f32 v28, v28
 v_exp_f32 v29, v29
 v_exp_f32 v30, v30
 v_exp_f32 v31, v31
 v_exp_f32 v32, v32
 v_exp_f32 v33, v33
 v_exp_f32 v34, v34
 v_exp_f32 v35, v35
 v_mfma_f32_32x32x16_bf16 v[48:63], a[16:19], v[156:159], v[48:63]
 v_exp_f32 v36, v36
 v_exp_f32 v37, v37
 v_exp_f32 v38, v38
 v_exp_f32 v39, v39
 v_smfmac_f32_32x32x32_bf16 v[200:215], a[24:27], v[16:23], v163
 s_add_u32 m0, s69, 102400
 s_add_u32 s65, s68, 580608
 buffer_load_dwordx4 v174, s[40:43], s65 offen lds
 buffer_load_dwordx2 v[142:143], v167, s[56:59], 0 offen sc1
 v_exp_f32 v40, v40
 v_exp_f32 v41, v41
 v_exp_f32 v42, v42
 v_exp_f32 v43, v43
 v_smfmac_f32_32x32x32_bf16 v[200:215], a[28:31], v[24:31], v163
 s_waitcnt lgkmcnt(0)
 v_exp_f32 v44, v44
 v_exp_f32 v45, v45
 v_exp_f32 v46, v46
 v_exp_f32 v47, v47
 v_mfma_f32_32x32x16_bf16 v[64:79], a[20:23], v[144:147], v[64:79]
 v_exp_f32 v48, v48
 v_exp_f32 v49, v49
 v_exp_f32 v50, v50
 v_exp_f32 v51, v51
 v_smfmac_f32_32x32x32_bf16 v[216:231], a[24:27], v[32:39], v163
 s_add_u32 m0, s69, 106496
 s_add_u32 s65, s68, 0
 ds_read_b128 a[32:35], v161 offset:18624
 buffer_load_dwordx4 v175, s[40:43], s65 offen lds
 v_exp_f32 v52, v52
 v_exp_f32 v53, v53
 v_exp_f32 v54, v54
 v_exp_f32 v55, v55
 v_smfmac_f32_32x32x32_bf16 v[216:231], a[28:31], v[40:47], v163
 ds_read_b128 a[36:39], v161 offset:19296
 v_exp_f32 v56, v56
 v_exp_f32 v57, v57
 v_exp_f32 v58, v58
 v_exp_f32 v59, v59
 v_mfma_f32_32x32x4_2b_bf16 v[96:127], a[46:47], v[134:135], 0
 v_exp_f32 v60, v60
 v_exp_f32 v61, v61
 v_exp_f32 v62, v62
 v_exp_f32 v63, v63
 v_exp_f32 v64, v64
 v_exp_f32 v65, v65
 v_exp_f32 v66, v66
 v_exp_f32 v67, v67
 v_mfma_f32_32x32x16_bf16 v[80:95], a[20:23], v[148:151], v[80:95]
 v_exp_f32 v68, v68
 v_exp_f32 v69, v69
 v_exp_f32 v70, v70
 v_exp_f32 v71, v71
 v_smfmac_f32_32x32x32_bf16 v[232:247], a[24:27], v[48:55], v163
 v_exp_f32 v72, v72
 v_exp_f32 v73, v73
 v_exp_f32 v74, v74
 v_exp_f32 v75, v75
 v_smfmac_f32_32x32x32_bf16 v[232:247], a[28:31], v[56:63], v163
 v_exp_f32 v76, v76
 v_exp_f32 v77, v77
 v_exp_f32 v78, v78
 v_exp_f32 v79, v79
 v_mfma_f32_32x32x16_bf16 v[96:111], a[20:23], v[152:155], v[96:111]
 s_waitcnt lgkmcnt(0)
 v_exp_f32 v80, v80
 v_exp_f32 v81, v81
 v_exp_f32 v82, v82
 v_exp_f32 v83, v83
 v_smfmac_f32_32x32x32_bf16 v[184:199], a[32:35], v[64:71], v163
 ds_read_b128 a[16:19], v160 offset:20480
 v_exp_f32 v84, v84
 v_exp_f32 v85, v85
 v_exp_f32 v86, v86
 v_exp_f32 v87, v87
 v_smfmac_f32_32x32x32_bf16 v[184:199], a[36:39], v[72:79], v163
 v_exp_f32 v88, v88
 v_exp_f32 v89, v89
 v_exp_f32 v90, v90
 v_exp_f32 v91, v91
 v_exp_f32 v92, v92
 v_exp_f32 v93, v93
 v_exp_f32 v94, v94
 v_exp_f32 v95, v95
 v_exp_f32 v96, v96
 v_exp_f32 v97, v97
 v_exp_f32 v98, v98
 v_exp_f32 v99, v99
 v_mfma_f32_32x32x16_bf16 v[112:127], a[20:23], v[156:159], v[112:127]
 v_exp_f32 v100, v100
 v_exp_f32 v101, v101
 v_exp_f32 v102, v102
 v_exp_f32 v103, v103
 v_smfmac_f32_32x32x32_bf16 v[200:215], a[32:35], v[80:87], v163
 v_add_u32 v160, 19968, v160
 v_add_u32 v161, 19968, v161
 v_add_u32 v162, 19968, v162
 v_exp_f32 v104, v104
 v_exp_f32 v105, v105
 v_exp_f32 v106, v106
 v_exp_f32 v107, v107
 v_smfmac_f32_32x32x32_bf16 v[200:215], a[36:39], v[88:95], v163
 s_waitcnt lgkmcnt(0)
 v_exp_f32 v108, v108
 v_exp_f32 v109, v109
 v_exp_f32 v110, v110
 v_exp_f32 v111, v111
L_att_tail:
 v_smfmac_f32_32x32x32_bf16 v[216:231], a[32:35], v[96:103], v163
 v_exp_f32 v112, v112
 v_exp_f32 v113, v113
 v_exp_f32 v114, v114
 v_exp_f32 v115, v115
 v_exp_f32 v116, v116
 v_exp_f32 v117, v117
 v_exp_f32 v118, v118
 v_exp_f32 v119, v119
 v_smfmac_f32_32x32x32_bf16 v[216:231], a[36:39], v[104:111], v163
 v_exp_f32 v120, v120
 v_exp_f32 v121, v121
 v_exp_f32 v122, v122
 v_exp_f32 v123, v123
 v_exp_f32 v124, v124
 v_exp_f32 v125, v125
 v_exp_f32 v126, v126
 v_exp_f32 v127, v127
 v_smfmac_f32_32x32x32_bf16 v[232:247], a[32:35], v[112:119], v163
 v_mov_b32 v128, v194
 v_mov_b32 v129, v194
 v_mov_b32 v130, v210
 v_mov_b32 v131, v210
 v_permlane32_swap_b32 v128, v129
 v_smfmac_f32_32x32x32_bf16 v[232:247], a[36:39], v[120:127], v163
 v_permlane32_swap_b32 v130, v131
 v_rcp_f32 v128, v128
 v_rcp_f32 v130, v130
 v_mul_f32 v184, v184, v128
 v_mul_f32 v185, v185, v128
 v_mul_f32 v186, v186, v128
 v_mul_f32 v187, v187, v128
 v_mul_f32 v188, v188, v128
 v_mul_f32 v189, v189, v128
 v_mul_f32 v190, v190, v128
 v_mul_f32 v191, v191, v128
 v_mul_f32 v192, v192, v128
 v_mul_f32 v193, v193, v128
 v_cvt_pk_bf16_f32 v40, v184, v185
 v_cvt_pk_bf16_f32 v41, v186, v187
 v_cvt_pk_bf16_f32 v42, v188, v189
 v_cvt_pk_bf16_f32 v43, v190, v191
 v_cvt_pk_bf16_f32 v168, v192, v193
 v_min_u32 v40, -2, v40
 v_min_u32 v41, -2, v41
 v_min_u32 v42, -2, v42
 v_min_u32 v43, -2, v43
 v_min_u32 v168, -2, v168
 buffer_store_dwordx4 v[40:43], v140, s[56:59], s92 offen offset:0 sc1
 v_mul_f32 v200, v200, v130
 v_mul_f32 v201, v201, v130
 v_mul_f32 v202, v202, v130
 v_mul_f32 v203, v203, v130
 v_mul_f32 v204, v204, v130
 v_mul_f32 v205, v205, v130
 v_mul_f32 v206, v206, v130
 v_mul_f32 v207, v207, v130
 v_mul_f32 v208, v208, v130
 v_mul_f32 v209, v209, v130
 v_cvt_pk_bf16_f32 v44, v200, v201
 v_cvt_pk_bf16_f32 v45, v202, v203
 v_cvt_pk_bf16_f32 v46, v204, v205
 v_cvt_pk_bf16_f32 v47, v206, v207
 v_cvt_pk_bf16_f32 v169, v208, v209
 v_min_u32 v44, -2, v44
 v_min_u32 v45, -2, v45
 v_min_u32 v46, -2, v46
 v_min_u32 v47, -2, v47
 v_min_u32 v169, -2, v169
 buffer_store_dwordx4 v[44:47], v140, s[56:59], s92 offen offset:512 sc1
 v_mov_b32 v132, v226
 v_mov_b32 v133, v226
 v_mov_b32 v134, v242
 v_mov_b32 v135, v242
 v_permlane32_swap_b32 v132, v133
 s_nop 0
 v_permlane32_swap_b32 v134, v135
 v_rcp_f32 v132, v132
 v_rcp_f32 v134, v134
 v_mul_f32 v216, v216, v132
 v_mul_f32 v217, v217, v132
 v_mul_f32 v218, v218, v132
 v_mul_f32 v219, v219, v132
 v_mul_f32 v220, v220, v132
 v_mul_f32 v221, v221, v132
 v_mul_f32 v222, v222, v132
 v_mul_f32 v223, v223, v132
 v_mul_f32 v224, v224, v132
 v_mul_f32 v225, v225, v132
 v_cvt_pk_bf16_f32 v48, v216, v217
 v_cvt_pk_bf16_f32 v49, v218, v219
 v_cvt_pk_bf16_f32 v50, v220, v221
 v_cvt_pk_bf16_f32 v51, v222, v223
 v_cvt_pk_bf16_f32 v170, v224, v225
 v_min_u32 v48, -2, v48
 v_min_u32 v49, -2, v49
 v_min_u32 v50, -2, v50
 v_min_u32 v51, -2, v51
 v_min_u32 v170, -2, v170
 buffer_store_dwordx4 v[48:51], v140, s[56:59], s92 offen offset:2048 sc1
 v_mul_f32 v232, v232, v134
 v_mul_f32 v233, v233, v134
 v_mul_f32 v234, v234, v134
 v_mul_f32 v235, v235, v134
 v_mul_f32 v236, v236, v134
 v_mul_f32 v237, v237, v134
 v_mul_f32 v238, v238, v134
 v_mul_f32 v239, v239, v134
 v_mul_f32 v240, v240, v134
 v_mul_f32 v241, v241, v134
 v_cvt_pk_bf16_f32 v52, v232, v233
 v_cvt_pk_bf16_f32 v53, v234, v235
 v_cvt_pk_bf16_f32 v54, v236, v237
 v_cvt_pk_bf16_f32 v55, v238, v239
 v_cvt_pk_bf16_f32 v171, v240, v241
 v_min_u32 v52, -2, v52
 v_min_u32 v53, -2, v53
 v_min_u32 v54, -2, v54
 v_min_u32 v55, -2, v55
 v_min_u32 v171, -2, v171
 buffer_store_dwordx4 v[52:55], v140, s[56:59], s92 offen offset:2560 sc1
 s_mov_b32 exec_hi, 0
 buffer_store_dwordx4 v[168:171], v140, s[56:59], s93 offen sc1
 s_mov_b64 exec, -1
 v_accvgpr_read_b32 v248, a209
 v_accvgpr_read_b32 v192, a210
 v_accvgpr_read_b32 v194, a211
 v_mov_b32 v195, v141
 v_mov_b32 v196, v167
 v_mov_b32 v193, v165
 v_accvgpr_read_b32 v198, a212
 v_mov_b32 v199, 2
 v_xor_b32 v249, 32, v248
 v_add_u32 v250, 65536, v248
 v_add_u32 v251, 65536, v249
 s_mul_i32 s73, s60, 1179648
 s_add_u32 s73, s73, 2621440
 s_add_u32 s95, s61, 0
 s_and_b32 s95, s95, 7
 s_lshl_b32 s95, s95, 13
 v_add_u32 v188, s95, v248
 v_add_u32 v189, s95, v249
 s_add_u32 s95, s61, 1
 s_and_b32 s95, s95, 7
 s_lshl_b32 s95, s95, 13
 v_add_u32 v190, s95, v248
 v_add_u32 v191, s95, v249
 v_permlane32_swap_b32 v40, v44
 v_permlane32_swap_b32 v41, v45
 v_permlane32_swap_b32 v42, v46
 v_permlane32_swap_b32 v43, v47
 v_permlane32_swap_b32 v48, v52
 v_permlane32_swap_b32 v49, v53
 v_permlane32_swap_b32 v50, v54
 v_permlane32_swap_b32 v51, v55
 v_permlane16_swap_b32 v40, v44
 v_permlane16_swap_b32 v41, v45
 v_permlane16_swap_b32 v42, v46
 v_permlane16_swap_b32 v43, v47
 v_permlane16_swap_b32 v48, v52
 v_permlane16_swap_b32 v49, v53
 v_permlane16_swap_b32 v50, v54
 v_permlane16_swap_b32 v51, v55
 s_waitcnt vmcnt(5)
 s_barrier
 ds_read_b64_tr_b16 a[144:145], v188 offset:0
 ds_read_b64_tr_b16 a[146:147], v188 offset:2048
 ds_read_b64_tr_b16 a[148:149], v189 offset:0
 ds_read_b64_tr_b16 a[150:151], v189 offset:2048
 ds_read_b64_tr_b16 a[152:153], v188 offset:512
 ds_read_b64_tr_b16 a[154:155], v188 offset:2560
 ds_read_b64_tr_b16 a[156:157], v189 offset:512
 ds_read_b64_tr_b16 a[158:159], v189 offset:2560
 s_waitcnt lgkmcnt(6)
 v_mfma_f32_16x16x32_bf16 v[0:3], a[144:147], v[40:43], 0
 ds_read_b64_tr_b16 a[160:161], v188 offset:4096
 v_mfma_f32_16x16x32_bf16 v[4:7], a[144:147], v[44:47], 0
 s_waitcnt lgkmcnt(5)
 ds_read_b64_tr_b16 a[162:163], v188 offset:6144
 v_mfma_f32_16x16x32_bf16 v[12:15], a[148:151], v[44:47], 0
 ds_read_b64_tr_b16 a[164:165], v189 offset:4096
 v_mfma_f32_16x16x32_bf16 v[8:11], a[148:151], v[40:43], 0
 s_waitcnt lgkmcnt(5)
 ds_read_b64_tr_b16 a[166:167], v189 offset:6144
 v_mfma_f32_16x16x32_bf16 v[16:19], a[152:155], v[40:43], 0
 ds_read_b64_tr_b16 a[168:169], v188 offset:4608
 v_mfma_f32_16x16x32_bf16 v[20:23], a[152:155], v[44:47], 0
 s_waitcnt lgkmcnt(5)
 ds_read_b64_tr_b16 a[170:171], v188 offset:6656
 v_mfma_f32_16x16x32_bf16 v[28:31], a[156:159], v[44:47], 0
 ds_read_b64_tr_b16 a[172:173], v189 offset:4608
 v_mfma_f32_16x16x32_bf16 v[24:27], a[156:159], v[40:43], 0
 s_waitcnt lgkmcnt(5)
 ds_read_b64_tr_b16 a[174:175], v189 offset:6656
 v_mfma_f32_16x16x32_bf16 v[0:3], a[160:163], v[48:51], v[0:3]
 v_mfma_f32_16x16x32_bf16 v[4:7], a[160:163], v[52:55], v[4:7]
 s_waitcnt lgkmcnt(4)
 v_mfma_f32_16x16x32_bf16 v[12:15], a[164:167], v[52:55], v[12:15]
 v_mfma_f32_16x16x32_bf16 v[8:11], a[164:167], v[48:51], v[8:11]
 s_waitcnt lgkmcnt(2)
 v_mfma_f32_16x16x32_bf16 v[16:19], a[168:171], v[48:51], v[16:19]
 v_mfma_f32_16x16x32_bf16 v[20:23], a[168:171], v[52:55], v[20:23]
 s_waitcnt lgkmcnt(0)
 v_mfma_f32_16x16x32_bf16 v[28:31], a[172:175], v[52:55], v[28:31]
 v_mfma_f32_16x16x32_bf16 v[24:27], a[172:175], v[48:51], v[24:27]
 s_waitcnt vmcnt(0)
 v_readfirstlane_b32 s67, v142
 v_readfirstlane_b32 s68, v143
 s_nop 0
 s_and_b32 s67, s67, s68
 s_cmp_lg_u32 s67, 0x1010101
 s_cbranch_scc1 L_po
L_po_done:
 s_add_u32 s65, s61, 1
 s_and_b32 s65, s65, 7
 s_lshl_b32 s65, s65, 12
 s_add_u32 s65, s65, s91
 buffer_load_dwordx4 v[56:59], v193, s[56:59], s65 offen offset:0 sc1
 buffer_load_dwordx4 v[60:63], v193, s[56:59], s65 offen offset:1024 sc1
 buffer_load_dwordx4 v[64:67], v193, s[56:59], s65 offen offset:2048 sc1
 buffer_load_dwordx4 v[68:71], v193, s[56:59], s65 offen offset:3072 sc1
 s_add_u32 s65, s61, 2
 s_and_b32 s65, s65, 7
 s_lshl_b32 s65, s65, 12
 s_add_u32 s65, s65, s91
 buffer_load_dwordx4 v[72:75], v193, s[56:59], s65 offen offset:0 sc1
 buffer_load_dwordx4 v[76:79], v193, s[56:59], s65 offen offset:1024 sc1
 buffer_load_dwordx4 v[80:83], v193, s[56:59], s65 offen offset:2048 sc1
 buffer_load_dwordx4 v[84:87], v193, s[56:59], s65 offen offset:3072 sc1
 s_add_u32 s65, s61, 3
 s_and_b32 s65, s65, 7
 s_lshl_b32 s65, s65, 12
 s_add_u32 s65, s65, s91
 buffer_load_dwordx4 v[88:91], v193, s[56:59], s65 offen offset:0 sc1
 buffer_load_dwordx4 v[92:95], v193, s[56:59], s65 offen offset:1024 sc1
 buffer_load_dwordx4 v[96:99], v193, s[56:59], s65 offen offset:2048 sc1
 buffer_load_dwordx4 v[100:103], v193, s[56:59], s65 offen offset:3072 sc1
 ds_read_b64_tr_b16 a[144:145], v190 offset:0
 ds_read_b64_tr_b16 a[146:147], v190 offset:2048
 ds_read_b64_tr_b16 a[148:149], v191 offset:0
 ds_read_b64_tr_b16 a[150:151], v191 offset:2048
 ds_read_b64_tr_b16 a[152:153], v190 offset:512
 ds_read_b64_tr_b16 a[154:155], v190 offset:2560
 ds_read_b64_tr_b16 a[156:157], v191 offset:512
 ds_read_b64_tr_b16 a[158:159], v191 offset:2560
 s_waitcnt lgkmcnt(6)
 s_waitcnt vmcnt(10)
 v_max3_u32 v197, v56, v57, v58
 v_max3_u32 v197, v197, v59, v60
 v_max3_u32 v197, v197, v61, v62
 v_max_u32 v197, v197, v63
 v_cmp_eq_u32 vcc, -1, v197
 s_cbranch_vccnz L_ok2
L_ok2_ret:
 v_mfma_f32_16x16x32_bf16 v[0:3], a[144:147], v[56:59], v[0:3]
 ds_read_b64_tr_b16 a[160:161], v190 offset:4096
 s_add_u32 s65, s61, 4
 s_and_b32 s65, s65, 7
 s_lshl_b32 s65, s65, 12
 s_add_u32 s65, s65, s91
 buffer_load_dwordx4 v[104:107], v193, s[56:59], s65 offen offset:0 sc1
 v_mfma_f32_16x16x32_bf16 v[4:7], a[144:147], v[60:63], v[4:7]
 s_waitcnt lgkmcnt(5)
 ds_read_b64_tr_b16 a[162:163], v190 offset:6144
 buffer_load_dwordx4 v[108:111], v193, s[56:59], s65 offen offset:1024 sc1
 s_add_u32 s95, s61, 2
 s_and_b32 s95, s95, 7
 s_lshl_b32 s95, s95, 13
 v_add_u32 v188, s95, v248
 v_add_u32 v189, s95, v249
 v_mfma_f32_16x16x32_bf16 v[12:15], a[148:151], v[60:63], v[12:15]
 ds_read_b64_tr_b16 a[164:165], v191 offset:4096
 s_waitcnt vmcnt(10)
 v_max3_u32 v197, v64, v65, v66
 v_mfma_f32_16x16x32_bf16 v[8:11], a[148:151], v[56:59], v[8:11]
 s_waitcnt lgkmcnt(5)
 ds_read_b64_tr_b16 a[166:167], v191 offset:6144
 v_max3_u32 v197, v197, v67, v68
 v_mfma_f32_16x16x32_bf16 v[16:19], a[152:155], v[56:59], v[16:19]
 ds_read_b64_tr_b16 a[168:169], v190 offset:4608
 v_max3_u32 v197, v197, v69, v70
 v_mfma_f32_16x16x32_bf16 v[20:23], a[152:155], v[60:63], v[20:23]
 s_waitcnt lgkmcnt(5)
 ds_read_b64_tr_b16 a[170:171], v190 offset:6656
 v_max_u32 v197, v197, v71
 v_mfma_f32_16x16x32_bf16 v[28:31], a[156:159], v[60:63], v[28:31]
 ds_read_b64_tr_b16 a[172:173], v191 offset:4608
 v_cmp_eq_u32 vcc, -1, v197
 v_mfma_f32_16x16x32_bf16 v[24:27], a[156:159], v[56:59], v[24:27]
 s_waitcnt lgkmcnt(5)
 ds_read_b64_tr_b16 a[174:175], v191 offset:6656
 s_cbranch_vccnz L_ok3
L_ok3_ret:
 v_mfma_f32_16x16x32_bf16 v[0:3], a[160:163], v[64:67], v[0:3]
 ds_read_b64_tr_b16 a[144:145], v188 offset:0
 buffer_load_dwordx4 v[112:115], v193, s[56:59], s65 offen offset:2048 sc1
 v_mfma_f32_16x16x32_bf16 v[4:7], a[160:163], v[68:71], v[4:7]
 s_waitcnt lgkmcnt(5)
 ds_read_b64_tr_b16 a[146:147], v188 offset:2048
 buffer_load_dwordx4 v[116:119], v193, s[56:59], s65 offen offset:3072 sc1
 v_mfma_f32_16x16x32_bf16 v[12:15], a[164:167], v[68:71], v[12:15]
 ds_read_b64_tr_b16 a[148:149], v189 offset:0
 s_waitcnt vmcnt(10)
 v_max3_u32 v197, v72, v73, v74
 v_mfma_f32_16x16x32_bf16 v[8:11], a[164:167], v[64:67], v[8:11]
 s_waitcnt lgkmcnt(5)
 ds_read_b64_tr_b16 a[150:151], v189 offset:2048
 v_max3_u32 v197, v197, v75, v76
 v_mfma_f32_16x16x32_bf16 v[16:19], a[168:171], v[64:67], v[16:19]
 ds_read_b64_tr_b16 a[152:153], v188 offset:512
 v_max3_u32 v197, v197, v77, v78
 v_mfma_f32_16x16x32_bf16 v[20:23], a[168:171], v[68:71], v[20:23]
 s_waitcnt lgkmcnt(5)
 ds_read_b64_tr_b16 a[154:155], v188 offset:2560
 v_max_u32 v197, v197, v79
 v_mfma_f32_16x16x32_bf16 v[28:31], a[172:175], v[68:71], v[28:31]
 ds_read_b64_tr_b16 a[156:157], v189 offset:512
 v_cmp_eq_u32 vcc, -1, v197
 v_mfma_f32_16x16x32_bf16 v[24:27], a[172:175], v[64:67], v[24:27]
 s_waitcnt lgkmcnt(5)
 ds_read_b64_tr_b16 a[158:159], v189 offset:2560
 s_cbranch_vccnz L_ok4
L_ok4_ret:
 v_mfma_f32_16x16x32_bf16 v[0:3], a[144:147], v[72:75], v[0:3]
 ds_read_b64_tr_b16 a[160:161], v188 offset:4096
 s_add_u32 s65, s61, 5
 s_and_b32 s65, s65, 7
 s_lshl_b32 s65, s65, 12
 s_add_u32 s65, s65, s91
 buffer_load_dwordx4 v[120:123], v193, s[56:59], s65 offen offset:0 sc1
 v_mfma_f32_16x16x32_bf16 v[4:7], a[144:147], v[76:79], v[4:7]
 s_waitcnt lgkmcnt(5)
 ds_read_b64_tr_b16 a[162:163], v188 offset:6144
 buffer_load_dwordx4 v[124:127], v193, s[56:59], s65 offen offset:1024 sc1
 s_add_u32 s95, s61, 3
 s_and_b32 s95, s95, 7
 s_lshl_b32 s95, s95, 13
 v_add_u32 v190, s95, v248
 v_add_u32 v191, s95, v249
 v_mfma_f32_16x16x32_bf16 v[12:15], a[148:151], v[76:79], v[12:15]
 ds_read_b64_tr_b16 a[164:165], v189 offset:4096
 s_waitcnt vmcnt(10)
 v_max3_u32 v197, v80, v81, v82
 v_mfma_f32_16x16x32_bf16 v[8:11], a[148:151], v[72:75], v[8:11]
 s_waitcnt lgkmcnt(5)
 ds_read_b64_tr_b16 a[166:167], v189 offset:6144
 v_max3_u32 v197, v197, v83, v84
 v_mfma_f32_16x16x32_bf16 v[16:19], a[152:155], v[72:75], v[16:19]
 ds_read_b64_tr_b16 a[168:169], v188 offset:4608
 v_max3_u32 v197, v197, v85, v86
 v_mfma_f32_16x16x32_bf16 v[20:23], a[152:155], v[76:79], v[20:23]
 s_waitcnt lgkmcnt(5)
 ds_read_b64_tr_b16 a[170:171], v188 offset:6656
 v_max_u32 v197, v197, v87
 v_mfma_f32_16x16x32_bf16 v[28:31], a[156:159], v[76:79], v[28:31]
 ds_read_b64_tr_b16 a[172:173], v189 offset:4608
 v_cmp_eq_u32 vcc, -1, v197
 v_mfma_f32_16x16x32_bf16 v[24:27], a[156:159], v[72:75], v[24:27]
 s_waitcnt lgkmcnt(5)
 ds_read_b64_tr_b16 a[174:175], v189 offset:6656
 s_cbranch_vccnz L_ok5
L_ok5_ret:
 v_mfma_f32_16x16x32_bf16 v[0:3], a[160:163], v[80:83], v[0:3]
 ds_read_b64_tr_b16 a[144:145], v190 offset:0
 buffer_load_dwordx4 v[128:131], v193, s[56:59], s65 offen offset:2048 sc1
 v_mfma_f32_16x16x32_bf16 v[4:7], a[160:163], v[84:87], v[4:7]
 s_waitcnt lgkmcnt(5)
 ds_read_b64_tr_b16 a[146:147], v190 offset:2048
 buffer_load_dwordx4 v[132:135], v193, s[56:59], s65 offen offset:3072 sc1
 v_mfma_f32_16x16x32_bf16 v[12:15], a[164:167], v[84:87], v[12:15]
 ds_read_b64_tr_b16 a[148:149], v191 offset:0
 s_waitcnt vmcnt(10)
 v_max3_u32 v197, v88, v89, v90
 v_mfma_f32_16x16x32_bf16 v[8:11], a[164:167], v[80:83], v[8:11]
 s_waitcnt lgkmcnt(5)
 ds_read_b64_tr_b16 a[150:151], v191 offset:2048
 v_max3_u32 v197, v197, v91, v92
 v_mfma_f32_16x16x32_bf16 v[16:19], a[168:171], v[80:83], v[16:19]
 ds_read_b64_tr_b16 a[152:153], v190 offset:512
 v_max3_u32 v197, v197, v93, v94
 v_mfma_f32_16x16x32_bf16 v[20:23], a[168:171], v[84:87], v[20:23]
 s_waitcnt lgkmcnt(5)
 ds_read_b64_tr_b16 a[154:155], v190 offset:2560
 v_max_u32 v197, v197, v95
 v_mfma_f32_16x16x32_bf16 v[28:31], a[172:175], v[84:87], v[28:31]
 ds_read_b64_tr_b16 a[156:157], v191 offset:512
 v_cmp_eq_u32 vcc, -1, v197
 v_mfma_f32_16x16x32_bf16 v[24:27], a[172:175], v[80:83], v[24:27]
 s_waitcnt lgkmcnt(5)
 ds_read_b64_tr_b16 a[158:159], v191 offset:2560
 s_cbranch_vccnz L_ok6
L_ok6_ret:
 v_mfma_f32_16x16x32_bf16 v[0:3], a[144:147], v[88:91], v[0:3]
 ds_read_b64_tr_b16 a[160:161], v190 offset:4096
 s_add_u32 s65, s61, 6
 s_and_b32 s65, s65, 7
 s_lshl_b32 s65, s65, 12
 s_add_u32 s65, s65, s91
 buffer_load_dwordx4 v[136:139], v193, s[56:59], s65 offen offset:0 sc1
 v_mfma_f32_16x16x32_bf16 v[4:7], a[144:147], v[92:95], v[4:7]
 s_waitcnt lgkmcnt(5)
 ds_read_b64_tr_b16 a[162:163], v190 offset:6144
 buffer_load_dwordx4 v[140:143], v193, s[56:59], s65 offen offset:1024 sc1
 s_add_u32 s95, s61, 4
 s_and_b32 s95, s95, 7
 s_lshl_b32 s95, s95, 13
 v_add_u32 v188, s95, v248
 v_add_u32 v189, s95, v249
 v_mfma_f32_16x16x32_bf16 v[12:15], a[148:151], v[92:95], v[12:15]
 ds_read_b64_tr_b16 a[164:165], v191 offset:4096
 s_waitcnt vmcnt(10)
 v_max3_u32 v197, v96, v97, v98
 v_mfma_f32_16x16x32_bf16 v[8:11], a[148:151], v[88:91], v[8:11]
 s_waitcnt lgkmcnt(5)
 ds_read_b64_tr_b16 a[166:167], v191 offset:6144
 v_max3_u32 v197, v197, v99, v100
 v_mfma_f32_16x16x32_bf16 v[16:19], a[152:155], v[88:91], v[16:19]
 ds_read_b64_tr_b16 a[168:169], v190 offset:4608
 v_max3_u32 v197, v197, v101, v102
 v_mfma_f32_16x16x32_bf16 v[20:23], a[152:155], v[92:95], v[20:23]
 s_waitcnt lgkmcnt(5)
 ds_read_b64_tr_b16 a[170:171], v190 offset:6656
 v_max_u32 v197, v197, v103
 v_mfma_f32_16x16x32_bf16 v[28:31], a[156:159], v[92:95], v[28:31]
 ds_read_b64_tr_b16 a[172:173], v191 offset:4608
 v_cmp_eq_u32 vcc, -1, v197
 v_mfma_f32_16x16x32_bf16 v[24:27], a[156:159], v[88:91], v[24:27]
 s_waitcnt lgkmcnt(5)
 ds_read_b64_tr_b16 a[174:175], v191 offset:6656
 s_cbranch_vccnz L_ok7
L_ok7_ret:
 v_mfma_f32_16x16x32_bf16 v[0:3], a[160:163], v[96:99], v[0:3]
 ds_read_b64_tr_b16 a[144:145], v188 offset:0
 buffer_load_dwordx4 v[144:147], v193, s[56:59], s65 offen offset:2048 sc1
 v_mfma_f32_16x16x32_bf16 v[4:7], a[160:163], v[100:103], v[4:7]
 s_waitcnt lgkmcnt(5)
 ds_read_b64_tr_b16 a[146:147], v188 offset:2048
 buffer_load_dwordx4 v[148:151], v193, s[56:59], s65 offen offset:3072 sc1
 v_mfma_f32_16x16x32_bf16 v[12:15], a[164:167], v[100:103], v[12:15]
 ds_read_b64_tr_b16 a[148:149], v189 offset:0
 s_waitcnt vmcnt(10)
 v_max3_u32 v197, v104, v105, v106
 v_mfma_f32_16x16x32_bf16 v[8:11], a[164:167], v[96:99], v[8:11]
 s_waitcnt lgkmcnt(5)
 ds_read_b64_tr_b16 a[150:151], v189 offset:2048
 v_max3_u32 v197, v197, v107, v108
 v_mfma_f32_16x16x32_bf16 v[16:19], a[168:171], v[96:99], v[16:19]
 ds_read_b64_tr_b16 a[152:153], v188 offset:512
 v_max3_u32 v197, v197, v109, v110
 v_mfma_f32_16x16x32_bf16 v[20:23], a[168:171], v[100:103], v[20:23]
 s_waitcnt lgkmcnt(5)
 ds_read_b64_tr_b16 a[154:155], v188 offset:2560
 v_max_u32 v197, v197, v111
 v_mfma_f32_16x16x32_bf16 v[28:31], a[172:175], v[100:103], v[28:31]
 ds_read_b64_tr_b16 a[156:157], v189 offset:512
 v_cmp_eq_u32 vcc, -1, v197
 v_mfma_f32_16x16x32_bf16 v[24:27], a[172:175], v[96:99], v[24:27]
 s_waitcnt lgkmcnt(5)
 ds_read_b64_tr_b16 a[158:159], v189 offset:2560
 s_cbranch_vccnz L_ok8
L_ok8_ret:
 v_mfma_f32_16x16x32_bf16 v[0:3], a[144:147], v[104:107], v[0:3]
 ds_read_b64_tr_b16 a[160:161], v188 offset:4096
 s_add_u32 s65, s61, 7
 s_and_b32 s65, s65, 7
 s_lshl_b32 s65, s65, 12
 s_add_u32 s65, s65, s91
 buffer_load_dwordx4 v[152:155], v193, s[56:59], s65 offen offset:0 sc1
 v_mfma_f32_16x16x32_bf16 v[4:7], a[144:147], v[108:111], v[4:7]
 s_waitcnt lgkmcnt(5)
 ds_read_b64_tr_b16 a[162:163], v188 offset:6144
 buffer_load_dwordx4 v[156:159], v193, s[56:59], s65 offen offset:1024 sc1
 s_add_u32 s95, s61, 5
 s_and_b32 s95, s95, 7
 s_lshl_b32 s95, s95, 13
 v_add_u32 v190, s95, v248
 v_add_u32 v191, s95, v249
 v_mfma_f32_16x16x32_bf16 v[12:15], a[148:151], v[108:111], v[12:15]
 ds_read_b64_tr_b16 a[164:165], v189 offset:4096
 s_waitcnt vmcnt(10)
 v_max3_u32 v197, v112, v113, v114
 v_mfma_f32_16x16x32_bf16 v[8:11], a[148:151], v[104:107], v[8:11]
 s_waitcnt lgkmcnt(5)
 ds_read_b64_tr_b16 a[166:167], v189 offset:6144
 v_max3_u32 v197, v197, v115, v116
 v_mfma_f32_16x16x32_bf16 v[16:19], a[152:155], v[104:107], v[16:19]
 ds_read_b64_tr_b16 a[168:169], v188 offset:4608
 v_max3_u32 v197, v197, v117, v118
 v_mfma_f32_16x16x32_bf16 v[20:23], a[152:155], v[108:111], v[20:23]
 s_waitcnt lgkmcnt(5)
 ds_read_b64_tr_b16 a[170:171], v188 offset:6656
 v_max_u32 v197, v197, v119
 v_mfma_f32_16x16x32_bf16 v[28:31], a[156:159], v[108:111], v[28:31]
 ds_read_b64_tr_b16 a[172:173], v189 offset:4608
 v_cmp_eq_u32 vcc, -1, v197
 v_mfma_f32_16x16x32_bf16 v[24:27], a[156:159], v[104:107], v[24:27]
 s_waitcnt lgkmcnt(5)
 ds_read_b64_tr_b16 a[174:175], v189 offset:6656
 s_cbranch_vccnz L_ok9
L_ok9_ret:
 v_mfma_f32_16x16x32_bf16 v[0:3], a[160:163], v[112:115], v[0:3]
 ds_read_b64_tr_b16 a[144:145], v190 offset:0
 buffer_load_dwordx4 v[160:163], v193, s[56:59], s65 offen offset:2048 sc1
 v_mfma_f32_16x16x32_bf16 v[4:7], a[160:163], v[116:119], v[4:7]
 s_waitcnt lgkmcnt(5)
 ds_read_b64_tr_b16 a[146:147], v190 offset:2048
 buffer_load_dwordx4 v[164:167], v193, s[56:59], s65 offen offset:3072 sc1
 v_mfma_f32_16x16x32_bf16 v[12:15], a[164:167], v[116:119], v[12:15]
 ds_read_b64_tr_b16 a[148:149], v191 offset:0
 s_waitcnt vmcnt(10)
 v_max3_u32 v197, v120, v121, v122
 v_mfma_f32_16x16x32_bf16 v[8:11], a[164:167], v[112:115], v[8:11]
 s_waitcnt lgkmcnt(5)
 ds_read_b64_tr_b16 a[150:151], v191 offset:2048
 v_max3_u32 v197, v197, v123, v124
 v_mfma_f32_16x16x32_bf16 v[16:19], a[168:171], v[112:115], v[16:19]
 ds_read_b64_tr_b16 a[152:153], v190 offset:512
 v_max3_u32 v197, v197, v125, v126
 v_mfma_f32_16x16x32_bf16 v[20:23], a[168:171], v[116:119], v[20:23]
 s_waitcnt lgkmcnt(5)
 ds_read_b64_tr_b16 a[154:155], v190 offset:2560
 v_max_u32 v197, v197, v127
 v_mfma_f32_16x16x32_bf16 v[28:31], a[172:175], v[116:119], v[28:31]
 ds_read_b64_tr_b16 a[156:157], v191 offset:512
 v_cmp_eq_u32 vcc, -1, v197
 v_mfma_f32_16x16x32_bf16 v[24:27], a[172:175], v[112:115], v[24:27]
 s_waitcnt lgkmcnt(5)
 ds_read_b64_tr_b16 a[158:159], v191 offset:2560
 s_cbranch_vccnz L_ok10
L_ok10_ret:
 v_mfma_f32_16x16x32_bf16 v[0:3], a[144:147], v[120:123], v[0:3]
 ds_read_b64_tr_b16 a[160:161], v190 offset:4096
 s_add_u32 s65, s91, 32768
 buffer_load_dwordx4 v[168:171], v193, s[56:59], s65 offen offset:0 sc1
 v_mfma_f32_16x16x32_bf16 v[4:7], a[144:147], v[124:127], v[4:7]
 s_waitcnt lgkmcnt(5)
 ds_read_b64_tr_b16 a[162:163], v190 offset:6144
 buffer_load_dwordx4 v[172:175], v193, s[56:59], s65 offen offset:1024 sc1
 s_add_u32 s95, s61, 6
 s_and_b32 s95, s95, 7
 s_lshl_b32 s95, s95, 13
 v_add_u32 v188, s95, v248
 v_add_u32 v189, s95, v249
 v_mfma_f32_16x16x32_bf16 v[12:15], a[148:151], v[124:127], v[12:15]
 ds_read_b64_tr_b16 a[164:165], v191 offset:4096
 s_waitcnt vmcnt(10)
 v_max3_u32 v197, v128, v129, v130
 v_mfma_f32_16x16x32_bf16 v[8:11], a[148:151], v[120:123], v[8:11]
 s_waitcnt lgkmcnt(5)
 ds_read_b64_tr_b16 a[166:167], v191 offset:6144
 v_max3_u32 v197, v197, v131, v132
 v_mfma_f32_16x16x32_bf16 v[16:19], a[152:155], v[120:123], v[16:19]
 ds_read_b64_tr_b16 a[168:169], v190 offset:4608
 v_max3_u32 v197, v197, v133, v134
 v_mfma_f32_16x16x32_bf16 v[20:23], a[152:155], v[124:127], v[20:23]
 s_waitcnt lgkmcnt(5)
 ds_read_b64_tr_b16 a[170:171], v190 offset:6656
 v_max_u32 v197, v197, v135
 v_mfma_f32_16x16x32_bf16 v[28:31], a[156:159], v[124:127], v[28:31]
 ds_read_b64_tr_b16 a[172:173], v191 offset:4608
 v_cmp_eq_u32 vcc, -1, v197
 v_mfma_f32_16x16x32_bf16 v[24:27], a[156:159], v[120:123], v[24:27]
 s_waitcnt lgkmcnt(5)
 ds_read_b64_tr_b16 a[174:175], v191 offset:6656
 s_cbranch_vccnz L_ok11
L_ok11_ret:
 v_mfma_f32_16x16x32_bf16 v[0:3], a[160:163], v[128:131], v[0:3]
 ds_read_b64_tr_b16 a[144:145], v188 offset:0
 buffer_load_dwordx4 v[176:179], v193, s[56:59], s65 offen offset:2048 sc1
 v_mfma_f32_16x16x32_bf16 v[4:7], a[160:163], v[132:135], v[4:7]
 s_waitcnt lgkmcnt(5)
 ds_read_b64_tr_b16 a[146:147], v188 offset:2048
 buffer_load_dwordx4 v[180:183], v193, s[56:59], s65 offen offset:3072 sc1
 v_mfma_f32_16x16x32_bf16 v[12:15], a[164:167], v[132:135], v[12:15]
 ds_read_b64_tr_b16 a[148:149], v189 offset:0
 s_waitcnt vmcnt(10)
 v_max3_u32 v197, v136, v137, v138
 v_mfma_f32_16x16x32_bf16 v[8:11], a[164:167], v[128:131], v[8:11]
 s_waitcnt lgkmcnt(5)
 ds_read_b64_tr_b16 a[150:151], v189 offset:2048
 v_max3_u32 v197, v197, v139, v140
 v_mfma_f32_16x16x32_bf16 v[16:19], a[168:171], v[128:131], v[16:19]
 ds_read_b64_tr_b16 a[152:153], v188 offset:512
 v_max3_u32 v197, v197, v141, v142
 v_mfma_f32_16x16x32_bf16 v[20:23], a[168:171], v[132:135], v[20:23]
 s_waitcnt lgkmcnt(5)
 ds_read_b64_tr_b16 a[154:155], v188 offset:2560
 v_max_u32 v197, v197, v143
 v_mfma_f32_16x16x32_bf16 v[28:31], a[172:175], v[132:135], v[28:31]
 ds_read_b64_tr_b16 a[156:157], v189 offset:512
 v_cmp_eq_u32 vcc, -1, v197
 v_mfma_f32_16x16x32_bf16 v[24:27], a[172:175], v[128:131], v[24:27]
 s_waitcnt lgkmcnt(5)
 ds_read_b64_tr_b16 a[158:159], v189 offset:2560
 s_cbranch_vccnz L_ok12
L_ok12_ret:
 v_mfma_f32_16x16x32_bf16 v[0:3], a[144:147], v[136:139], v[0:3]
 ds_read_b64_tr_b16 a[160:161], v188 offset:4096
 v_mfma_f32_16x16x32_bf16 v[4:7], a[144:147], v[140:143], v[4:7]
 s_waitcnt lgkmcnt(5)
 ds_read_b64_tr_b16 a[162:163], v188 offset:6144
 s_add_u32 s95, s61, 7
 s_and_b32 s95, s95, 7
 s_lshl_b32 s95, s95, 13
 v_add_u32 v190, s95, v248
 v_add_u32 v191, s95, v249
 v_mfma_f32_16x16x32_bf16 v[12:15], a[148:151], v[140:143], v[12:15]
 ds_read_b64_tr_b16 a[164:165], v189 offset:4096
 s_waitcnt vmcnt(8)
 v_max3_u32 v197, v144, v145, v146
 v_mfma_f32_16x16x32_bf16 v[8:11], a[148:151], v[136:139], v[8:11]
 s_waitcnt lgkmcnt(5)
 ds_read_b64_tr_b16 a[166:167], v189 offset:6144
 v_max3_u32 v197, v197, v147, v148
 v_mfma_f32_16x16x32_bf16 v[16:19], a[152:155], v[136:139], v[16:19]
 ds_read_b64_tr_b16 a[168:169], v188 offset:4608
 v_max3_u32 v197, v197, v149, v150
 v_mfma_f32_16x16x32_bf16 v[20:23], a[152:155], v[140:143], v[20:23]
 s_waitcnt lgkmcnt(5)
 ds_read_b64_tr_b16 a[170:171], v188 offset:6656
 v_max_u32 v197, v197, v151
 v_mfma_f32_16x16x32_bf16 v[28:31], a[156:159], v[140:143], v[28:31]
 ds_read_b64_tr_b16 a[172:173], v189 offset:4608
 v_cmp_eq_u32 vcc, -1, v197
 v_mfma_f32_16x16x32_bf16 v[24:27], a[156:159], v[136:139], v[24:27]
 s_waitcnt lgkmcnt(5)
 ds_read_b64_tr_b16 a[174:175], v189 offset:6656
 s_cbranch_vccnz L_ok13
L_ok13_ret:
 v_mfma_f32_16x16x32_bf16 v[0:3], a[160:163], v[144:147], v[0:3]
 ds_read_b64_tr_b16 a[144:145], v190 offset:0
 v_mfma_f32_16x16x32_bf16 v[4:7], a[160:163], v[148:151], v[4:7]
 s_waitcnt lgkmcnt(5)
 ds_read_b64_tr_b16 a[146:147], v190 offset:2048
 v_mfma_f32_16x16x32_bf16 v[12:15], a[164:167], v[148:151], v[12:15]
 ds_read_b64_tr_b16 a[148:149], v191 offset:0
 s_waitcnt vmcnt(6)
 v_max3_u32 v197, v152, v153, v154
 v_mfma_f32_16x16x32_bf16 v[8:11], a[164:167], v[144:147], v[8:11]
 s_waitcnt lgkmcnt(5)
 ds_read_b64_tr_b16 a[150:151], v191 offset:2048
 v_max3_u32 v197, v197, v155, v156
 v_mfma_f32_16x16x32_bf16 v[16:19], a[168:171], v[144:147], v[16:19]
 ds_read_b64_tr_b16 a[152:153], v190 offset:512
 v_max3_u32 v197, v197, v157, v158
 v_mfma_f32_16x16x32_bf16 v[20:23], a[168:171], v[148:151], v[20:23]
 s_waitcnt lgkmcnt(5)
 ds_read_b64_tr_b16 a[154:155], v190 offset:2560
 v_max_u32 v197, v197, v159
 v_mfma_f32_16x16x32_bf16 v[28:31], a[172:175], v[148:151], v[28:31]
 ds_read_b64_tr_b16 a[156:157], v191 offset:512
 v_cmp_eq_u32 vcc, -1, v197
 v_mfma_f32_16x16x32_bf16 v[24:27], a[172:175], v[144:147], v[24:27]
 s_waitcnt lgkmcnt(5)
 ds_read_b64_tr_b16 a[158:159], v191 offset:2560
 s_cbranch_vccnz L_ok14
L_ok14_ret:
 v_mfma_f32_16x16x32_bf16 v[0:3], a[144:147], v[152:155], v[0:3]
 ds_read_b64_tr_b16 a[160:161], v190 offset:4096
 v_mfma_f32_16x16x32_bf16 v[4:7], a[144:147], v[156:159], v[4:7]
 s_waitcnt lgkmcnt(5)
 ds_read_b64_tr_b16 a[162:163], v190 offset:6144
 v_mfma_f32_16x16x32_bf16 v[12:15], a[148:151], v[156:159], v[12:15]
 ds_read_b64_tr_b16 a[164:165], v191 offset:4096
 s_waitcnt vmcnt(4)
 v_max3_u32 v197, v160, v161, v162
 v_mfma_f32_16x16x32_bf16 v[8:11], a[148:151], v[152:155], v[8:11]
 s_waitcnt lgkmcnt(5)
 ds_read_b64_tr_b16 a[166:167], v191 offset:6144
 v_max3_u32 v197, v197, v163, v164
 v_mfma_f32_16x16x32_bf16 v[16:19], a[152:155], v[152:155], v[16:19]
 ds_read_b64_tr_b16 a[168:169], v190 offset:4608
 v_max3_u32 v197, v197, v165, v166
 v_mfma_f32_16x16x32_bf16 v[20:23], a[152:155], v[156:159], v[20:23]
 s_waitcnt lgkmcnt(5)
 ds_read_b64_tr_b16 a[170:171], v190 offset:6656
 v_max_u32 v197, v197, v167
 v_mfma_f32_16x16x32_bf16 v[28:31], a[156:159], v[156:159], v[28:31]
 ds_read_b64_tr_b16 a[172:173], v191 offset:4608
 v_cmp_eq_u32 vcc, -1, v197
 v_mfma_f32_16x16x32_bf16 v[24:27], a[156:159], v[152:155], v[24:27]
 s_waitcnt lgkmcnt(5)
 ds_read_b64_tr_b16 a[174:175], v191 offset:6656
 s_cbranch_vccnz L_ok15
L_ok15_ret:
 v_mfma_f32_16x16x32_bf16 v[0:3], a[160:163], v[160:163], v[0:3]
 ds_read_b64_tr_b16 a[144:145], v250 offset:0
 v_mfma_f32_16x16x32_bf16 v[4:7], a[160:163], v[164:167], v[4:7]
 s_waitcnt lgkmcnt(5)
 ds_read_b64_tr_b16 a[146:147], v250 offset:2048
 v_mfma_f32_16x16x32_bf16 v[12:15], a[164:167], v[164:167], v[12:15]
 ds_read_b64_tr_b16 a[148:149], v251 offset:0
 s_waitcnt vmcnt(2)
 v_max3_u32 v197, v168, v169, v170
 v_mfma_f32_16x16x32_bf16 v[8:11], a[164:167], v[160:163], v[8:11]
 s_waitcnt lgkmcnt(5)
 ds_read_b64_tr_b16 a[150:151], v251 offset:2048
 v_max3_u32 v197, v197, v171, v172
 v_mfma_f32_16x16x32_bf16 v[16:19], a[168:171], v[160:163], v[16:19]
 ds_read_b64_tr_b16 a[152:153], v250 offset:512
 v_max3_u32 v197, v197, v173, v174
 v_mfma_f32_16x16x32_bf16 v[20:23], a[168:171], v[164:167], v[20:23]
 s_waitcnt lgkmcnt(5)
 ds_read_b64_tr_b16 a[154:155], v250 offset:2560
 v_max_u32 v197, v197, v175
 v_mfma_f32_16x16x32_bf16 v[28:31], a[172:175], v[164:167], v[28:31]
 ds_read_b64_tr_b16 a[156:157], v251 offset:512
 v_cmp_eq_u32 vcc, -1, v197
 v_mfma_f32_16x16x32_bf16 v[24:27], a[172:175], v[160:163], v[24:27]
 s_waitcnt lgkmcnt(5)
 ds_read_b64_tr_b16 a[158:159], v251 offset:2560
 s_cbranch_vccnz L_ok16
L_ok16_ret:
 v_mfma_f32_16x16x32_bf16 v[0:3], a[144:147], v[168:171], v[0:3]
 ds_read_b64_tr_b16 a[160:161], v250 offset:4096
 v_mfma_f32_16x16x32_bf16 v[4:7], a[144:147], v[172:175], v[4:7]
 s_waitcnt lgkmcnt(5)
 ds_read_b64_tr_b16 a[162:163], v250 offset:6144
 v_mfma_f32_16x16x32_bf16 v[12:15], a[148:151], v[172:175], v[12:15]
 ds_read_b64_tr_b16 a[164:165], v251 offset:4096
 s_waitcnt vmcnt(0)
 v_max3_u32 v197, v176, v177, v178
 v_mfma_f32_16x16x32_bf16 v[8:11], a[148:151], v[168:171], v[8:11]
 s_waitcnt lgkmcnt(5)
 ds_read_b64_tr_b16 a[166:167], v251 offset:6144
 v_max3_u32 v197, v197, v179, v180
 v_mfma_f32_16x16x32_bf16 v[16:19], a[152:155], v[168:171], v[16:19]
 ds_read_b64_tr_b16 a[168:169], v250 offset:4608
 v_max3_u32 v197, v197, v181, v182
 v_mfma_f32_16x16x32_bf16 v[20:23], a[152:155], v[172:175], v[20:23]
 s_waitcnt lgkmcnt(5)
 ds_read_b64_tr_b16 a[170:171], v250 offset:6656
 v_max_u32 v197, v197, v183
 v_mfma_f32_16x16x32_bf16 v[28:31], a[156:159], v[172:175], v[28:31]
 ds_read_b64_tr_b16 a[172:173], v251 offset:4608
 v_cmp_eq_u32 vcc, -1, v197
 v_mfma_f32_16x16x32_bf16 v[24:27], a[156:159], v[168:171], v[24:27]
 s_waitcnt lgkmcnt(5)
 ds_read_b64_tr_b16 a[174:175], v251 offset:6656
 s_cbranch_vccnz L_ok17
L_ok17_ret:
 v_mfma_f32_16x16x32_bf16 v[0:3], a[160:163], v[176:179], v[0:3]
 v_mfma_f32_16x16x32_bf16 v[4:7], a[160:163], v[180:183], v[4:7]
 s_waitcnt lgkmcnt(4)
 v_mfma_f32_16x16x32_bf16 v[12:15], a[164:167], v[180:183], v[12:15]
 v_mfma_f32_16x16x32_bf16 v[8:11], a[164:167], v[176:179], v[8:11]
 s_waitcnt lgkmcnt(2)
 v_mfma_f32_16x16x32_bf16 v[16:19], a[168:171], v[176:179], v[16:19]
 v_mfma_f32_16x16x32_bf16 v[20:23], a[168:171], v[180:183], v[20:23]
 s_waitcnt lgkmcnt(0)
 v_mfma_f32_16x16x32_bf16 v[28:31], a[172:175], v[180:183], v[28:31]
 v_mfma_f32_16x16x32_bf16 v[24:27], a[172:175], v[176:179], v[24:27]
 v_cvt_pk_bf16_f32 v200, v0, v1
 v_cvt_pk_bf16_f32 v201, v2, v3
 v_cvt_pk_bf16_f32 v202, v4, v5
 v_cvt_pk_bf16_f32 v203, v6, v7
 v_min_u32 v200, -2, v200
 v_min_u32 v201, -2, v201
 v_min_u32 v202, -2, v202
 v_min_u32 v203, -2, v203
 buffer_store_dwordx4 v[200:203], v195, s[56:59], s94 offen offset:0 sc1
 v_cvt_pk_bf16_f32 v204, v8, v9
 v_cvt_pk_bf16_f32 v205, v10, v11
 v_cvt_pk_bf16_f32 v206, v12, v13
 v_cvt_pk_bf16_f32 v207, v14, v15
 v_min_u32 v204, -2, v204
 v_min_u32 v205, -2, v205
 v_min_u32 v206, -2, v206
 v_min_u32 v207, -2, v207
 buffer_store_dwordx4 v[204:207], v195, s[56:59], s94 offen offset:1024 sc1
 v_cvt_pk_bf16_f32 v208, v16, v17
 v_cvt_pk_bf16_f32 v209, v18, v19
 v_cvt_pk_bf16_f32 v210, v20, v21
 v_cvt_pk_bf16_f32 v211, v22, v23
 v_min_u32 v208, -2, v208
 v_min_u32 v209, -2, v209
 v_min_u32 v210, -2, v210
 v_min_u32 v211, -2, v211
 buffer_store_dwordx4 v[208:211], v195, s[56:59], s94 offen offset:2048 sc1
 v_cvt_pk_bf16_f32 v212, v24, v25
 v_cvt_pk_bf16_f32 v213, v26, v27
 v_cvt_pk_bf16_f32 v214, v28, v29
 v_cvt_pk_bf16_f32 v215, v30, v31
 v_min_u32 v212, -2, v212
 v_min_u32 v213, -2, v213
 v_min_u32 v214, -2, v214
 v_min_u32 v215, -2, v215
 buffer_store_dwordx4 v[212:215], v195, s[56:59], s94 offen offset:3072 sc1
 buffer_store_byte v199, v198, s[56:59], s3 offen sc1
 s_lshr_b32 s67, s61, 2
 s_lshr_b32 s68, s63, 1
 s_cmp_lg_u32 s67, s68
 s_cbranch_scc1 L_att_end
 s_add_u32 s95, s61, 0
 s_and_b32 s95, s95, 7
 s_lshl_b32 s95, s95, 12
 v_add_u32 v224, s95, v192
 s_add_u32 s95, s61, 1
 s_and_b32 s95, s95, 7
 s_lshl_b32 s95, s95, 12
 v_add_u32 v225, s95, v192
 s_add_u32 s95, s61, 2
 s_and_b32 s95, s95, 7
 s_lshl_b32 s95, s95, 12
 v_add_u32 v226, s95, v192
 s_add_u32 s95, s61, 3
 s_and_b32 s95, s95, 7
 s_lshl_b32 s95, s95, 12
 v_add_u32 v227, s95, v192
 s_add_u32 s95, s61, 4
 s_and_b32 s95, s95, 7
 s_lshl_b32 s95, s95, 12
 v_add_u32 v228, s95, v192
 s_add_u32 s95, s61, 5
 s_and_b32 s95, s95, 7
 s_lshl_b32 s95, s95, 12
 v_add_u32 v229, s95, v192
 s_add_u32 s95, s61, 6
 s_and_b32 s95, s95, 7
 s_lshl_b32 s95, s95, 12
 v_add_u32 v230, s95, v192
 s_add_u32 s95, s61, 7
 s_and_b32 s95, s95, 7
 s_lshl_b32 s95, s95, 12
 v_add_u32 v231, s95, v192
 ds_read_b64_tr_b16 a[144:145], v224 offset:0
 ds_read_b64_tr_b16 a[146:147], v224 offset:1024
 ds_read_b64_tr_b16 a[148:149], v224 offset:2048
 ds_read_b64_tr_b16 a[150:151], v224 offset:3072
 ds_read_b64_tr_b16 a[152:153], v225 offset:0
 ds_read_b64_tr_b16 a[154:155], v225 offset:1024
 ds_read_b64_tr_b16 a[156:157], v225 offset:2048
 ds_read_b64_tr_b16 a[158:159], v225 offset:3072
 s_waitcnt lgkmcnt(6)
 v_mfma_f32_16x16x32_bf16 v[32:35], a[144:147], v[40:43], 0
 ds_read_b64_tr_b16 a[160:161], v226 offset:0
 v_mfma_f32_16x16x32_bf16 v[36:39], a[144:147], v[44:47], 0
 s_waitcnt lgkmcnt(5)
 ds_read_b64_tr_b16 a[162:163], v226 offset:1024
 v_mfma_f32_16x16x32_bf16 v[36:39], a[148:151], v[52:55], v[36:39]
 ds_read_b64_tr_b16 a[164:165], v226 offset:2048
 v_mfma_f32_16x16x32_bf16 v[32:35], a[148:151], v[48:51], v[32:35]
 s_waitcnt lgkmcnt(5)
 ds_read_b64_tr_b16 a[166:167], v226 offset:3072
 v_mfma_f32_16x16x32_bf16 v[32:35], a[152:155], v[56:59], v[32:35]
 ds_read_b64_tr_b16 a[168:169], v227 offset:0
 v_mfma_f32_16x16x32_bf16 v[36:39], a[152:155], v[60:63], v[36:39]
 s_waitcnt lgkmcnt(5)
 ds_read_b64_tr_b16 a[170:171], v227 offset:1024
 v_mfma_f32_16x16x32_bf16 v[36:39], a[156:159], v[68:71], v[36:39]
 ds_read_b64_tr_b16 a[172:173], v227 offset:2048
 v_mfma_f32_16x16x32_bf16 v[32:35], a[156:159], v[64:67], v[32:35]
 s_waitcnt lgkmcnt(5)
 ds_read_b64_tr_b16 a[174:175], v227 offset:3072
 v_mfma_f32_16x16x32_bf16 v[32:35], a[160:163], v[72:75], v[32:35]
 ds_read_b64_tr_b16 a[144:145], v228 offset:0
 v_mfma_f32_16x16x32_bf16 v[36:39], a[160:163], v[76:79], v[36:39]
 s_waitcnt lgkmcnt(5)
 ds_read_b64_tr_b16 a[146:147], v228 offset:1024
 v_mfma_f32_16x16x32_bf16 v[36:39], a[164:167], v[84:87], v[36:39]
 ds_read_b64_tr_b16 a[148:149], v228 offset:2048
 v_mfma_f32_16x16x32_bf16 v[32:35], a[164:167], v[80:83], v[32:35]
 s_waitcnt lgkmcnt(5)
 ds_read_b64_tr_b16 a[150:151], v228 offset:3072
 v_mfma_f32_16x16x32_bf16 v[32:35], a[168:171], v[88:91], v[32:35]
 ds_read_b64_tr_b16 a[152:153], v229 offset:0
 v_mfma_f32_16x16x32_bf16 v[36:39], a[168:171], v[92:95], v[36:39]
 s_waitcnt lgkmcnt(5)
 ds_read_b64_tr_b16 a[154:155], v229 offset:1024
 v_mfma_f32_16x16x32_bf16 v[36:39], a[172:175], v[100:103], v[36:39]
 ds_read_b64_tr_b16 a[156:157], v229 offset:2048
 v_mfma_f32_16x16x32_bf16 v[32:35], a[172:175], v[96:99], v[32:35]
 s_waitcnt lgkmcnt(5)
 ds_read_b64_tr_b16 a[158:159], v229 offset:3072
 v_mfma_f32_16x16x32_bf16 v[32:35], a[144:147], v[104:107], v[32:35]
 ds_read_b64_tr_b16 a[160:161], v230 offset:0
 v_mfma_f32_16x16x32_bf16 v[36:39], a[144:147], v[108:111], v[36:39]
 s_waitcnt lgkmcnt(5)
 ds_read_b64_tr_b16 a[162:163], v230 offset:1024
 v_mfma_f32_16x16x32_bf16 v[36:39], a[148:151], v[116:119], v[36:39]
 ds_read_b64_tr_b16 a[164:165], v230 offset:2048
 v_mfma_f32_16x16x32_bf16 v[32:35], a[148:151], v[112:115], v[32:35]
 s_waitcnt lgkmcnt(5)
 ds_read_b64_tr_b16 a[166:167], v230 offset:3072
 v_mfma_f32_16x16x32_bf16 v[32:35], a[152:155], v[120:123], v[32:35]
 ds_read_b64_tr_b16 a[168:169], v231 offset:0
 v_mfma_f32_16x16x32_bf16 v[36:39], a[152:155], v[124:127], v[36:39]
 s_waitcnt lgkmcnt(5)
 ds_read_b64_tr_b16 a[170:171], v231 offset:1024
 v_mfma_f32_16x16x32_bf16 v[36:39], a[156:159], v[132:135], v[36:39]
 ds_read_b64_tr_b16 a[172:173], v231 offset:2048
 v_mfma_f32_16x16x32_bf16 v[32:35], a[156:159], v[128:131], v[32:35]
 s_waitcnt lgkmcnt(5)
 ds_read_b64_tr_b16 a[174:175], v231 offset:3072
 v_mfma_f32_16x16x32_bf16 v[32:35], a[160:163], v[136:139], v[32:35]
 ds_read_b64_tr_b16 a[144:145], v192 offset:32768
 v_mfma_f32_16x16x32_bf16 v[36:39], a[160:163], v[140:143], v[36:39]
 s_waitcnt lgkmcnt(5)
 ds_read_b64_tr_b16 a[146:147], v192 offset:33792
 v_mfma_f32_16x16x32_bf16 v[36:39], a[164:167], v[148:151], v[36:39]
 ds_read_b64_tr_b16 a[148:149], v192 offset:34816
 v_mfma_f32_16x16x32_bf16 v[32:35], a[164:167], v[144:147], v[32:35]
 s_waitcnt lgkmcnt(5)
 ds_read_b64_tr_b16 a[150:151], v192 offset:35840
 v_mfma_f32_16x16x32_bf16 v[32:35], a[168:171], v[152:155], v[32:35]
 v_mfma_f32_16x16x32_bf16 v[36:39], a[168:171], v[156:159], v[36:39]
 s_waitcnt lgkmcnt(4)
 v_mfma_f32_16x16x32_bf16 v[36:39], a[172:175], v[164:167], v[36:39]
 v_mfma_f32_16x16x32_bf16 v[32:35], a[172:175], v[160:163], v[32:35]
 s_waitcnt lgkmcnt(2)
 v_mfma_f32_16x16x32_bf16 v[32:35], a[144:147], v[168:171], v[32:35]
 v_mfma_f32_16x16x32_bf16 v[36:39], a[144:147], v[172:175], v[36:39]
 s_waitcnt lgkmcnt(0)
 v_mfma_f32_16x16x32_bf16 v[36:39], a[148:151], v[180:183], v[36:39]
 v_mfma_f32_16x16x32_bf16 v[32:35], a[148:151], v[176:179], v[32:35]
 v_accvgpr_read_b32 v220, a216
 v_accvgpr_read_b32 v221, a217
 v_accvgpr_read_b32 v222, a218
 v_accvgpr_read_b32 v223, a219
 s_nop 3
 v_dot2_f32_bf16 v32, v220, s76, v32
 v_dot2_f32_bf16 v33, v220, s77, v33
 v_dot2_f32_bf16 v34, v221, s76, v34
 v_dot2_f32_bf16 v35, v221, s77, v35
 v_dot2_f32_bf16 v36, v222, s76, v36
 v_dot2_f32_bf16 v37, v222, s77, v37
 v_dot2_f32_bf16 v38, v223, s76, v38
 v_dot2_f32_bf16 v39, v223, s77, v39
 s_mov_b32 s79, 0
L_p8_spin:
 buffer_load_dwordx2 v[232:233], v196, s[56:59], 0 offen offset:32 sc1
 s_waitcnt vmcnt(0)
 v_readfirstlane_b32 s67, v232
 v_readfirstlane_b32 s68, v233
 s_nop 0
 s_and_b32 s67, s67, s68
 s_cmp_eq_u32 s67, 0x1010101
 s_cbranch_scc1 L_p8_done
 s_sleep 1
 s_add_u32 s79, s79, 1
 s_cmp_lt_u32 s79, 0x80000
 s_cbranch_scc1 L_p8_spin
L_p8_done:
 s_and_b32 s67, s61, 3
 s_lshl_b32 s68, s67, 10
 s_add_u32 s73, s73, s68
 s_add_u32 s73, s73, 131072
 buffer_load_dwordx4 v[64:67], v195, s[56:59], s73 offen sc1
 s_add_u32 s73, s73, 147456
 buffer_load_dwordx4 v[68:71], v195, s[56:59], s73 offen sc1
 s_add_u32 s73, s73, 147456
 buffer_load_dwordx4 v[72:75], v195, s[56:59], s73 offen sc1
 s_add_u32 s73, s73, 147456
 buffer_load_dwordx4 v[76:79], v195, s[56:59], s73 offen sc1
 s_add_u32 s73, s73, 147456
 buffer_load_dwordx4 v[80:83], v195, s[56:59], s73 offen sc1
 s_add_u32 s73, s73, 147456
 buffer_load_dwordx4 v[84:87], v195, s[56:59], s73 offen sc1
 s_add_u32 s73, s73, 147456
 buffer_load_dwordx4 v[88:91], v195, s[56:59], s73 offen sc1
 s_add_u32 s73, s73, 147456
 buffer_load_dwordx4 v[92:95], v195, s[56:59], s73 offen sc1
 s_lshl_b32 s67, s67, 5
 s_add_u32 s67, s67, 1024
 s_add_u32 s68, s67, 18432
 s_waitcnt vmcnt(7)
 v_dot2_f32_bf16 v32, v64, s76, v32
 v_dot2_f32_bf16 v33, v64, s77, v33
 v_dot2_f32_bf16 v34, v65, s76, v34
 v_dot2_f32_bf16 v35, v65, s77, v35
 v_dot2_f32_bf16 v36, v66, s76, v36
 v_dot2_f32_bf16 v37, v66, s77, v37
 v_dot2_f32_bf16 v38, v67, s76, v38
 v_dot2_f32_bf16 v39, v67, s77, v39
 s_waitcnt vmcnt(6)
 v_dot2_f32_bf16 v32, v68, s76, v32
 v_dot2_f32_bf16 v33, v68, s77, v33
 v_dot2_f32_bf16 v34, v69, s76, v34
 v_dot2_f32_bf16 v35, v69, s77, v35
 v_dot2_f32_bf16 v36, v70, s76, v36
 v_dot2_f32_bf16 v37, v70, s77, v37
 v_dot2_f32_bf16 v38, v71, s76, v38
 v_dot2_f32_bf16 v39, v71, s77, v39
 s_waitcnt vmcnt(5)
 v_dot2_f32_bf16 v32, v72, s76, v32
 v_dot2_f32_bf16 v33, v72, s77, v33
 v_dot2_f32_bf16 v34, v73, s76, v34
 v_dot2_f32_bf16 v35, v73, s77, v35
 v_dot2_f32_bf16 v36, v74, s76, v36
 v_dot2_f32_bf16 v37, v74, s77, v37
 v_dot2_f32_bf16 v38, v75, s76, v38
 v_dot2_f32_bf16 v39, v75, s77, v39
 s_waitcnt vmcnt(4)
 v_dot2_f32_bf16 v32, v76, s76, v32
 v_dot2_f32_bf16 v33, v76, s77, v33
 v_dot2_f32_bf16 v34, v77, s76, v34
 v_dot2_f32_bf16 v35, v77, s77, v35
 v_dot2_f32_bf16 v36, v78, s76, v36
 v_dot2_f32_bf16 v37, v78, s77, v37
 v_dot2_f32_bf16 v38, v79, s76, v38
 v_dot2_f32_bf16 v39, v79, s77, v39
 s_waitcnt vmcnt(3)
 v_dot2_f32_bf16 v32, v80, s76, v32
 v_dot2_f32_bf16 v33, v80, s77, v33
 v_dot2_f32_bf16 v34, v81, s76, v34
 v_dot2_f32_bf16 v35, v81, s77, v35
 v_dot2_f32_bf16 v36, v82, s76, v36
 v_dot2_f32_bf16 v37, v82, s77, v37
 v_dot2_f32_bf16 v38, v83, s76, v38
 v_dot2_f32_bf16 v39, v83, s77, v39
 s_waitcnt vmcnt(2)
 v_dot2_f32_bf16 v32, v84, s76, v32
 v_dot2_f32_bf16 v33, v84, s77, v33
 v_dot2_f32_bf16 v34, v85, s76, v34
 v_dot2_f32_bf16 v35, v85, s77, v35
 v_dot2_f32_bf16 v36, v86, s76, v36
 v_dot2_f32_bf16 v37, v86, s77, v37
 v_dot2_f32_bf16 v38, v87, s76, v38
 v_dot2_f32_bf16 v39, v87, s77, v39
 s_waitcnt vmcnt(1)
 v_dot2_f32_bf16 v32, v88, s76, v32
 v_dot2_f32_bf16 v33, v88, s77, v33
 v_dot2_f32_bf16 v34, v89, s76, v34
 v_dot2_f32_bf16 v35, v89, s77, v35
 v_dot2_f32_bf16 v36, v90, s76, v36
 v_dot2_f32_bf16 v37, v90, s77, v37
 v_dot2_f32_bf16 v38, v91, s76, v38
 v_dot2_f32_bf16 v39, v91, s77, v39
 s_waitcnt vmcnt(0)
 v_dot2_f32_bf16 v32, v92, s76, v32
 v_dot2_f32_bf16 v33, v92, s77, v33
 v_dot2_f32_bf16 v34, v93, s76, v34
 v_dot2_f32_bf16 v35, v93, s77, v35
 v_dot2_f32_bf16 v36, v94, s76, v36
 v_dot2_f32_bf16 v37, v94, s77, v37
 v_dot2_f32_bf16 v38, v95, s76, v38
 v_dot2_f32_bf16 v39, v95, s77, v39
 v_cvt_pk_bf16_f32 v40, v32, v33
 v_cvt_pk_bf16_f32 v41, v34, v35
 v_cvt_pk_bf16_f32 v42, v36, v37
 v_cvt_pk_bf16_f32 v43, v38, v39
 buffer_store_dwordx2 v[40:41], v194, s[48:51], s67 offen
 buffer_store_dwordx2 v[42:43], v194, s[48:51], s68 offen
L_att_end:
 s_endpgm
L_att_fb:
 s_add_u32 m0, s64, 32768
 s_add_u32 s65, s64, 32768
 buffer_load_dwordx4 v165, s[56:59], s65 offen offset:0 sc1 lds
 buffer_load_dwordx4 v165, s[56:59], s65 offen offset:1024 sc1 lds
 buffer_load_dwordx4 v165, s[56:59], s65 offen offset:2048 sc1 lds
 buffer_load_dwordx4 v165, s[56:59], s65 offen offset:3072 sc1 lds
 s_add_u32 m0, s64, 49152
 s_add_u32 s65, s64, 49152
 buffer_load_dwordx4 v165, s[56:59], s65 offen offset:0 sc1 lds
 buffer_load_dwordx4 v165, s[56:59], s65 offen offset:1024 sc1 lds
 buffer_load_dwordx4 v165, s[56:59], s65 offen offset:2048 sc1 lds
 buffer_load_dwordx4 v165, s[56:59], s65 offen offset:3072 sc1 lds
 s_add_u32 m0, s64, 65536
 s_add_u32 s65, s64, 65536
 buffer_load_dwordx4 v165, s[56:59], s65 offen offset:0 sc1 lds
 buffer_load_dwordx4 v165, s[56:59], s65 offen offset:1024 sc1 lds
 buffer_load_dwordx4 v165, s[56:59], s65 offen offset:2048 sc1 lds
 buffer_load_dwordx4 v165, s[56:59], s65 offen offset:3072 sc1 lds
 s_add_u32 m0, s64, 81920
 s_add_u32 s65, s64, 81920
 buffer_load_dwordx4 v165, s[56:59], s65 offen offset:0 sc1 lds
 buffer_load_dwordx4 v165, s[56:59], s65 offen offset:1024 sc1 lds
 buffer_load_dwordx4 v165, s[56:59], s65 offen offset:2048 sc1 lds
 buffer_load_dwordx4 v165, s[56:59], s65 offen offset:3072 sc1 lds
 s_add_u32 m0, s64, 98304
 s_add_u32 s65, s64, 98304
 buffer_load_dwordx4 v165, s[56:59], s65 offen offset:0 sc1 lds
 buffer_load_dwordx4 v165, s[56:59], s65 offen offset:1024 sc1 lds
 buffer_load_dwordx4 v165, s[56:59], s65 offen offset:2048 sc1 lds
 buffer_load_dwordx4 v165, s[56:59], s65 offen offset:3072 sc1 lds
 s_add_u32 m0, s64, 114688
 s_add_u32 s65, s64, 114688
 buffer_load_dwordx4 v165, s[56:59], s65 offen offset:0 sc1 lds
 buffer_load_dwordx4 v165, s[56:59], s65 offen offset:1024 sc1 lds
 buffer_load_dwordx4 v165, s[56:59], s65 offen offset:2048 sc1 lds
 buffer_load_dwordx4 v165, s[56:59], s65 offen offset:3072 sc1 lds
 s_add_u32 m0, s64, 131072
 s_add_u32 s65, s64, 131072
 buffer_load_dwordx4 v165, s[56:59], s65 offen offset:0 sc1 lds
 buffer_load_dwordx4 v165, s[56:59], s65 offen offset:1024 sc1 lds
 buffer_load_dwordx4 v165, s[56:59], s65 offen offset:2048 sc1 lds
 buffer_load_dwordx4 v165, s[56:59], s65 offen offset:3072 sc1 lds
 s_add_u32 m0, s64, 147456
 s_add_u32 s65, s64, 147456
 buffer_load_dwordx4 v165, s[56:59], s65 offen offset:0 sc1 lds
 buffer_load_dwordx4 v165, s[56:59], s65 offen offset:1024 sc1 lds
 buffer_load_dwordx4 v165, s[56:59], s65 offen offset:2048 sc1 lds
 buffer_load_dwordx4 v165, s[56:59], s65 offen offset:3072 sc1 lds
 buffer_store_dwordx4 a[222:225], v140, s[56:59], s92 offen offset:0 sc1
 buffer_store_dwordx4 a[222:225], v140, s[56:59], s92 offen offset:512 sc1
 buffer_store_dwordx4 a[222:225], v140, s[56:59], s92 offen offset:2048 sc1
 buffer_store_dwordx4 a[222:225], v140, s[56:59], s92 offen offset:2560 sc1
 s_mov_b32 exec_hi, 0
 buffer_store_dwordx4 a[222:225], v140, s[56:59], s93 offen sc1
 s_mov_b64 exec, -1
 buffer_store_dwordx4 a[222:225], v141, s[56:59], s94 offen offset:0 sc1
 buffer_store_dwordx4 a[222:225], v141, s[56:59], s94 offen offset:1024 sc1
 buffer_store_dwordx4 a[222:225], v141, s[56:59], s94 offen offset:2048 sc1
 buffer_store_dwordx4 a[222:225], v141, s[56:59], s94 offen offset:3072 sc1
 s_waitcnt vmcnt(0)
 v_mov_b32 v143, 1
 buffer_store_byte v143, v166, s[56:59], s3 offen sc1
 s_barrier
 s_barrier
 s_mov_b32 s74, 0
 v_cmp_gt_u32 vcc, 32, v255
 v_mov_b32 v172, 0
 s_nop 0
 v_cndmask_b32 v173, 0, v128, vcc
 v_accvgpr_write_b32 a64, v173
 v_cndmask_b32 v173, 0, v129, vcc
 v_accvgpr_write_b32 a65, v173
 v_cndmask_b32 v173, 0, v130, vcc
 v_accvgpr_write_b32 a66, v173
 v_cndmask_b32 v173, 0, v131, vcc
 v_accvgpr_write_b32 a67, v173
 v_cndmask_b32 v173, v128, v172, vcc
 v_accvgpr_write_b32 a68, v173
 v_cndmask_b32 v173, v129, v172, vcc
 v_accvgpr_write_b32 a69, v173
 v_cndmask_b32 v173, v130, v172, vcc
 v_accvgpr_write_b32 a70, v173
 v_cndmask_b32 v173, v131, v172, vcc
 v_accvgpr_write_b32 a71, v173
 v_cndmask_b32 v173, 0, v132, vcc
 v_accvgpr_write_b32 a72, v173
 v_cndmask_b32 v173, 0, v133, vcc
 v_accvgpr_write_b32 a73, v173
 v_cndmask_b32 v173, 0, v134, vcc
 v_accvgpr_write_b32 a74, v173
 v_cndmask_b32 v173, 0, v135, vcc
 v_accvgpr_write_b32 a75, v173
 v_cndmask_b32 v173, v132, v172, vcc
 v_accvgpr_write_b32 a76, v173
 v_cndmask_b32 v173, v133, v172, vcc
 v_accvgpr_write_b32 a77, v173
 v_cndmask_b32 v173, v134, v172, vcc
 v_accvgpr_write_b32 a78, v173
 v_cndmask_b32 v173, v135, v172, vcc
 v_accvgpr_write_b32 a79, v173
 v_mov_b32 v172, 0xff800000
 v_mov_b32 v173, 0xff800000
 v_mov_b32 v174, 0xff800000
 v_mov_b32 v175, 0xff800000
 v_mov_b32 v176, v160
 v_mov_b32 v177, v162
L_att_fb_max:
 ds_read_b128 a[40:43], v177
 ds_read_b128 a[48:51], v176 offset:512
 ds_read_b128 a[52:55], v176 offset:1536
 ds_read_b128 a[56:59], v176 offset:2560
 ds_read_b128 a[60:63], v176 offset:3584
 v_add_u32 v176, 9984, v176
 v_add_u32 v177, 9984, v177
 s_waitcnt lgkmcnt(0)
 v_mfma_f32_32x32x16_bf16 v[64:79], a[48:51], v[144:147], 0
 v_mfma_f32_32x32x8_bf16 v[64:79], a[40:41], a[64:65], v[64:79]
 v_mfma_f32_32x32x16_bf16 v[80:95], a[48:51], v[148:151], 0
 v_mfma_f32_32x32x8_bf16 v[80:95], a[40:41], a[68:69], v[80:95]
 v_mfma_f32_32x32x16_bf16 v[96:111], a[48:51], v[152:155], 0
 v_mfma_f32_32x32x8_bf16 v[96:111], a[40:41], a[72:73], v[96:111]
 v_mfma_f32_32x32x16_bf16 v[112:127], a[48:51], v[156:159], 0
 v_mfma_f32_32x32x8_bf16 v[112:127], a[40:41], a[76:77], v[112:127]
 s_nop 5
 v_max3_f32 v172, v64, v65, v172
 v_max3_f32 v172, v66, v67, v172
 v_max3_f32 v172, v68, v69, v172
 v_max3_f32 v172, v70, v71, v172
 v_max3_f32 v172, v72, v73, v172
 v_max3_f32 v172, v74, v75, v172
 v_max3_f32 v172, v76, v77, v172
 v_max3_f32 v172, v78, v79, v172
 v_max3_f32 v173, v80, v81, v173
 v_max3_f32 v173, v82, v83, v173
 v_max3_f32 v173, v84, v85, v173
 v_max3_f32 v173, v86, v87, v173
 v_max3_f32 v173, v88, v89, v173
 v_max3_f32 v173, v90, v91, v173
 v_max3_f32 v173, v92, v93, v173
 v_max3_f32 v173, v94, v95, v173
 v_max3_f32 v174, v96, v97, v174
 v_max3_f32 v174, v98, v99, v174
 v_max3_f32 v174, v100, v101, v174
 v_max3_f32 v174, v102, v103, v174
 v_max3_f32 v174, v104, v105, v174
 v_max3_f32 v174, v106, v107, v174
 v_max3_f32 v174, v108, v109, v174
 v_max3_f32 v174, v110, v111, v174
 v_max3_f32 v175, v112, v113, v175
 v_max3_f32 v175, v114, v115, v175
 v_max3_f32 v175, v116, v117, v175
 v_max3_f32 v175, v118, v119, v175
 v_max3_f32 v175, v120, v121, v175
 v_max3_f32 v175, v122, v123, v175
 v_max3_f32 v175, v124, v125, v175
 v_max3_f32 v175, v126, v127, v175
 v_mfma_f32_32x32x16_bf16 v[64:79], a[52:55], v[144:147], 0
 v_mfma_f32_32x32x8_bf16 v[64:79], a[40:41], a[66:67], v[64:79]
 v_mfma_f32_32x32x16_bf16 v[80:95], a[52:55], v[148:151], 0
 v_mfma_f32_32x32x8_bf16 v[80:95], a[40:41], a[70:71], v[80:95]
 v_mfma_f32_32x32x16_bf16 v[96:111], a[52:55], v[152:155], 0
 v_mfma_f32_32x32x8_bf16 v[96:111], a[40:41], a[74:75], v[96:111]
 v_mfma_f32_32x32x16_bf16 v[112:127], a[52:55], v[156:159], 0
 v_mfma_f32_32x32x8_bf16 v[112:127], a[40:41], a[78:79], v[112:127]
 s_nop 5
 v_max3_f32 v172, v64, v65, v172
 v_max3_f32 v172, v66, v67, v172
 v_max3_f32 v172, v68, v69, v172
 v_max3_f32 v172, v70, v71, v172
 v_max3_f32 v172, v72, v73, v172
 v_max3_f32 v172, v74, v75, v172
 v_max3_f32 v172, v76, v77, v172
 v_max3_f32 v172, v78, v79, v172
 v_max3_f32 v173, v80, v81, v173
 v_max3_f32 v173, v82, v83, v173
 v_max3_f32 v173, v84, v85, v173
 v_max3_f32 v173, v86, v87, v173
 v_max3_f32 v173, v88, v89, v173
 v_max3_f32 v173, v90, v91, v173
 v_max3_f32 v173, v92, v93, v173
 v_max3_f32 v173, v94, v95, v173
 v_max3_f32 v174, v96, v97, v174
 v_max3_f32 v174, v98, v99, v174
 v_max3_f32 v174, v100, v101, v174
 v_max3_f32 v174, v102, v103, v174
 v_max3_f32 v174, v104, v105, v174
 v_max3_f32 v174, v106, v107, v174
 v_max3_f32 v174, v108, v109, v174
 v_max3_f32 v174, v110, v111, v174
 v_max3_f32 v175, v112, v113, v175
 v_max3_f32 v175, v114, v115, v175
 v_max3_f32 v175, v116, v117, v175
 v_max3_f32 v175, v118, v119, v175
 v_max3_f32 v175, v120, v121, v175
 v_max3_f32 v175, v122, v123, v175
 v_max3_f32 v175, v124, v125, v175
 v_max3_f32 v175, v126, v127, v175
 v_mfma_f32_32x32x16_bf16 v[64:79], a[56:59], v[144:147], 0
 v_mfma_f32_32x32x8_bf16 v[64:79], a[42:43], a[64:65], v[64:79]
 v_mfma_f32_32x32x16_bf16 v[80:95], a[56:59], v[148:151], 0
 v_mfma_f32_32x32x8_bf16 v[80:95], a[42:43], a[68:69], v[80:95]
 v_mfma_f32_32x32x16_bf16 v[96:111], a[56:59], v[152:155], 0
 v_mfma_f32_32x32x8_bf16 v[96:111], a[42:43], a[72:73], v[96:111]
 v_mfma_f32_32x32x16_bf16 v[112:127], a[56:59], v[156:159], 0
 v_mfma_f32_32x32x8_bf16 v[112:127], a[42:43], a[76:77], v[112:127]
 s_nop 5
 v_max3_f32 v172, v64, v65, v172
 v_max3_f32 v172, v66, v67, v172
 v_max3_f32 v172, v68, v69, v172
 v_max3_f32 v172, v70, v71, v172
 v_max3_f32 v172, v72, v73, v172
 v_max3_f32 v172, v74, v75, v172
 v_max3_f32 v172, v76, v77, v172
 v_max3_f32 v172, v78, v79, v172
 v_max3_f32 v173, v80, v81, v173
 v_max3_f32 v173, v82, v83, v173
 v_max3_f32 v173, v84, v85, v173
 v_max3_f32 v173, v86, v87, v173
 v_max3_f32 v173, v88, v89, v173
 v_max3_f32 v173, v90, v91, v173
 v_max3_f32 v173, v92, v93, v173
 v_max3_f32 v173, v94, v95, v173
 v_max3_f32 v174, v96, v97, v174
 v_max3_f32 v174, v98, v99, v174
 v_max3_f32 v174, v100, v101, v174
 v_max3_f32 v174, v102, v103, v174
 v_max3_f32 v174, v104, v105, v174
 v_max3_f32 v174, v106, v107, v174
 v_max3_f32 v174, v108, v109, v174
 v_max3_f32 v174, v110, v111, v174
 v_max3_f32 v175, v112, v113, v175
 v_max3_f32 v175, v114, v115, v175
 v_max3_f32 v175, v116, v117, v175
 v_max3_f32 v175, v118, v119, v175
 v_max3_f32 v175, v120, v121, v175
 v_max3_f32 v175, v122, v123, v175
 v_max3_f32 v175, v124, v125, v175
 v_max3_f32 v175, v126, v127, v175
 v_mfma_f32_32x32x16_bf16 v[64:79], a[60:63], v[144:147], 0
 v_mfma_f32_32x32x8_bf16 v[64:79], a[42:43], a[66:67], v[64:79]
 v_mfma_f32_32x32x16_bf16 v[80:95], a[60:63], v[148:151], 0
 v_mfma_f32_32x32x8_bf16 v[80:95], a[42:43], a[70:71], v[80:95]
 v_mfma_f32_32x32x16_bf16 v[96:111], a[60:63], v[152:155], 0
 v_mfma_f32_32x32x8_bf16 v[96:111], a[42:43], a[74:75], v[96:111]
 v_mfma_f32_32x32x16_bf16 v[112:127], a[60:63], v[156:159], 0
 v_mfma_f32_32x32x8_bf16 v[112:127], a[42:43], a[78:79], v[112:127]
 s_nop 5
 v_max3_f32 v172, v64, v65, v172
 v_max3_f32 v172, v66, v67, v172
 v_max3_f32 v172, v68, v69, v172
 v_max3_f32 v172, v70, v71, v172
 v_max3_f32 v172, v72, v73, v172
 v_max3_f32 v172, v74, v75, v172
 v_max3_f32 v172, v76, v77, v172
 v_max3_f32 v172, v78, v79, v172
 v_max3_f32 v173, v80, v81, v173
 v_max3_f32 v173, v82, v83, v173
 v_max3_f32 v173, v84, v85, v173
 v_max3_f32 v173, v86, v87, v173
 v_max3_f32 v173, v88, v89, v173
 v_max3_f32 v173, v90, v91, v173
 v_max3_f32 v173, v92, v93, v173
 v_max3_f32 v173, v94, v95, v173
 v_max3_f32 v174, v96, v97, v174
 v_max3_f32 v174, v98, v99, v174
 v_max3_f32 v174, v100, v101, v174
 v_max3_f32 v174, v102, v103, v174
 v_max3_f32 v174, v104, v105, v174
 v_max3_f32 v174, v106, v107, v174
 v_max3_f32 v174, v108, v109, v174
 v_max3_f32 v174, v110, v111, v174
 v_max3_f32 v175, v112, v113, v175
 v_max3_f32 v175, v114, v115, v175
 v_max3_f32 v175, v116, v117, v175
 v_max3_f32 v175, v118, v119, v175
 v_max3_f32 v175, v120, v121, v175
 v_max3_f32 v175, v122, v123, v175
 v_max3_f32 v175, v124, v125, v175
 v_max3_f32 v175, v126, v127, v175
 s_add_u32 s74, s74, 1
 s_cmp_lt_u32 s74, 16
 s_cbranch_scc1 L_att_fb_max
 v_mov_b32 v176, v172
 s_nop 1
 v_permlane32_swap_b32 v172, v176
 v_max_f32 v172, v172, v176
 v_sub_f32 v0, 0, v172
 v_sub_f32 v1, 0, v172
 v_sub_f32 v2, 0, v172
 v_sub_f32 v3, 0, v172
 v_sub_f32 v4, 0, v172
 v_sub_f32 v5, 0, v172
 v_sub_f32 v6, 0, v172
 v_sub_f32 v7, 0, v172
 v_sub_f32 v8, 0, v172
 v_sub_f32 v9, 0, v172
 v_sub_f32 v10, 0, v172
 v_sub_f32 v11, 0, v172
 v_sub_f32 v12, 0, v172
 v_sub_f32 v13, 0, v172
 v_sub_f32 v14, 0, v172
 v_sub_f32 v15, 0, v172
 v_mov_b32 v176, v173
 s_nop 1
 v_permlane32_swap_b32 v173, v176
 v_max_f32 v173, v173, v176
 v_sub_f32 v16, 0, v173
 v_sub_f32 v17, 0, v173
 v_sub_f32 v18, 0, v173
 v_sub_f32 v19, 0, v173
 v_sub_f32 v20, 0, v173
 v_sub_f32 v21, 0, v173
 v_sub_f32 v22, 0, v173
 v_sub_f32 v23, 0, v173
 v_sub_f32 v24, 0, v173
 v_sub_f32 v25, 0, v173
 v_sub_f32 v26, 0, v173
 v_sub_f32 v27, 0, v173
 v_sub_f32 v28, 0, v173
 v_sub_f32 v29, 0, v173
 v_sub_f32 v30, 0, v173
 v_sub_f32 v31, 0, v173
 v_mov_b32 v176, v174
 s_nop 1
 v_permlane32_swap_b32 v174, v176
 v_max_f32 v174, v174, v176
 v_sub_f32 v32, 0, v174
 v_sub_f32 v33, 0, v174
 v_sub_f32 v34, 0, v174
 v_sub_f32 v35, 0, v174
 v_sub_f32 v36, 0, v174
 v_sub_f32 v37, 0, v174
 v_sub_f32 v38, 0, v174
 v_sub_f32 v39, 0, v174
 v_sub_f32 v40, 0, v174
 v_sub_f32 v41, 0, v174
 v_sub_f32 v42, 0, v174
 v_sub_f32 v43, 0, v174
 v_sub_f32 v44, 0, v174
 v_sub_f32 v45, 0, v174
 v_sub_f32 v46, 0, v174
 v_sub_f32 v47, 0, v174
 v_mov_b32 v176, v175
 s_nop 1
 v_permlane32_swap_b32 v175, v176
 v_max_f32 v175, v175, v176
 v_sub_f32 v48, 0, v175
 v_sub_f32 v49, 0, v175
 v_sub_f32 v50, 0, v175
 v_sub_f32 v51, 0, v175
 v_sub_f32 v52, 0, v175
 v_sub_f32 v53, 0, v175
 v_sub_f32 v54, 0, v175
 v_sub_f32 v55, 0, v175
 v_sub_f32 v56, 0, v175
 v_sub_f32 v57, 0, v175
 v_sub_f32 v58, 0, v175
 v_sub_f32 v59, 0, v175
 v_sub_f32 v60, 0, v175
 v_sub_f32 v61, 0, v175
 v_sub_f32 v62, 0, v175
 v_sub_f32 v63, 0, v175
 v_mov_b32 v96, 0
 v_mov_b32 v97, 0
 v_mov_b32 v98, 0
 v_mov_b32 v99, 0
 v_mov_b32 v100, 0
 v_mov_b32 v101, 0
 v_mov_b32 v102, 0
 v_mov_b32 v103, 0
 v_mov_b32 v104, 0
 v_mov_b32 v105, 0
 v_mov_b32 v106, 0
 v_mov_b32 v107, 0
 v_mov_b32 v108, 0
 v_mov_b32 v109, 0
 v_mov_b32 v110, 0
 v_mov_b32 v111, 0
 v_mov_b32 v112, 0
 v_mov_b32 v113, 0
 v_mov_b32 v114, 0
 v_mov_b32 v115, 0
 v_mov_b32 v116, 0
 v_mov_b32 v117, 0
 v_mov_b32 v118, 0
 v_mov_b32 v119, 0
 v_mov_b32 v120, 0
 v_mov_b32 v121, 0
 v_mov_b32 v122, 0
 v_mov_b32 v123, 0
 v_mov_b32 v124, 0
 v_mov_b32 v125, 0
 v_mov_b32 v126, 0
 v_mov_b32 v127, 0
 v_accvgpr_write_b32 a32, 0
 v_accvgpr_write_b32 a33, 0
 v_accvgpr_write_b32 a34, 0
 v_accvgpr_write_b32 a35, 0
 v_accvgpr_write_b32 a36, 0
 v_accvgpr_write_b32 a37, 0
 v_accvgpr_write_b32 a38, 0
 v_accvgpr_write_b32 a39, 0
 ds_read_b128 a[40:43], v162
 ds_read_b128 a[16:19], v160 offset:512
 s_mov_b32 s74, 0
 s_waitcnt lgkmcnt(0)
L_att_fb_loop:
 v_mfma_f32_32x32x16_bf16 v[64:79], a[16:19], v[144:147], v[0:15]
 v_exp_f32 v112, v112
 v_exp_f32 v113, v113
 v_exp_f32 v114, v114
 v_exp_f32 v115, v115
 v_mfma_f32_32x32x8_bf16 v[64:79], a[40:41], a[64:65], v[64:79]
 v_exp_f32 v116, v116
 v_exp_f32 v117, v117
 v_exp_f32 v118, v118
 v_exp_f32 v119, v119
 v_smfmac_f32_32x32x32_bf16 v[216:231], a[32:35], v[96:103], v163
 ds_read_b128 a[24:27], v161 offset:4608
 v_exp_f32 v120, v120
 v_exp_f32 v121, v121
 v_exp_f32 v122, v122
 v_exp_f32 v123, v123
 v_smfmac_f32_32x32x32_bf16 v[216:231], a[36:39], v[104:111], v163
 v_exp_f32 v124, v124
 v_exp_f32 v125, v125
 v_exp_f32 v126, v126
 v_exp_f32 v127, v127
 v_mfma_f32_32x32x16_bf16 v[80:95], a[16:19], v[148:151], v[16:31]
 v_exp_f32 v64, v64
 v_exp_f32 v65, v65
 v_exp_f32 v66, v66
 v_exp_f32 v67, v67
 v_mfma_f32_32x32x8_bf16 v[80:95], a[40:41], a[68:69], v[80:95]
 v_exp_f32 v68, v68
 v_exp_f32 v69, v69
 v_exp_f32 v70, v70
 v_exp_f32 v71, v71
 v_smfmac_f32_32x32x32_bf16 v[232:247], a[32:35], v[112:119], v163
 ds_read_b128 a[28:31], v161 offset:5280
 v_exp_f32 v72, v72
 v_exp_f32 v73, v73
 v_exp_f32 v74, v74
 v_exp_f32 v75, v75
 v_smfmac_f32_32x32x32_bf16 v[232:247], a[36:39], v[120:127], v163
 v_exp_f32 v76, v76
 v_exp_f32 v77, v77
 v_exp_f32 v78, v78
 v_exp_f32 v79, v79
 v_mfma_f32_32x32x16_bf16 v[96:111], a[16:19], v[152:155], v[32:47]
 s_waitcnt lgkmcnt(0)
 v_exp_f32 v80, v80
 v_exp_f32 v81, v81
 v_exp_f32 v82, v82
 v_exp_f32 v83, v83
 v_mfma_f32_32x32x8_bf16 v[96:111], a[40:41], a[72:73], v[96:111]
 v_exp_f32 v84, v84
 v_exp_f32 v85, v85
 v_exp_f32 v86, v86
 v_exp_f32 v87, v87
 v_smfmac_f32_32x32x32_bf16 v[184:199], a[24:27], v[64:71], v163
 ds_read_b128 a[20:23], v160 offset:1536
 v_exp_f32 v88, v88
 v_exp_f32 v89, v89
 v_exp_f32 v90, v90
 v_exp_f32 v91, v91
 v_smfmac_f32_32x32x32_bf16 v[184:199], a[28:31], v[72:79], v163
 v_exp_f32 v92, v92
 v_exp_f32 v93, v93
 v_exp_f32 v94, v94
 v_exp_f32 v95, v95
 v_mfma_f32_32x32x16_bf16 v[112:127], a[16:19], v[156:159], v[48:63]
 v_exp_f32 v96, v96
 v_exp_f32 v97, v97
 v_exp_f32 v98, v98
 v_exp_f32 v99, v99
 v_mfma_f32_32x32x8_bf16 v[112:127], a[40:41], a[76:77], v[112:127]
 v_exp_f32 v100, v100
 v_exp_f32 v101, v101
 v_exp_f32 v102, v102
 v_exp_f32 v103, v103
 v_smfmac_f32_32x32x32_bf16 v[200:215], a[24:27], v[80:87], v163
 v_exp_f32 v104, v104
 v_exp_f32 v105, v105
 v_exp_f32 v106, v106
 v_exp_f32 v107, v107
 v_smfmac_f32_32x32x32_bf16 v[200:215], a[28:31], v[88:95], v163
 s_waitcnt lgkmcnt(0)
 v_exp_f32 v108, v108
 v_exp_f32 v109, v109
 v_exp_f32 v110, v110
 v_exp_f32 v111, v111
 v_mfma_f32_32x32x16_bf16 v[64:79], a[20:23], v[144:147], v[0:15]
 v_exp_f32 v112, v112
 v_exp_f32 v113, v113
 v_exp_f32 v114, v114
 v_exp_f32 v115, v115
 v_mfma_f32_32x32x8_bf16 v[64:79], a[40:41], a[66:67], v[64:79]
 v_exp_f32 v116, v116
 v_exp_f32 v117, v117
 v_exp_f32 v118, v118
 v_exp_f32 v119, v119
 v_smfmac_f32_32x32x32_bf16 v[216:231], a[24:27], v[96:103], v163
 ds_read_b128 a[32:35], v161 offset:5952
 v_exp_f32 v120, v120
 v_exp_f32 v121, v121
 v_exp_f32 v122, v122
 v_exp_f32 v123, v123
 v_smfmac_f32_32x32x32_bf16 v[216:231], a[28:31], v[104:111], v163
 v_exp_f32 v124, v124
 v_exp_f32 v125, v125
 v_exp_f32 v126, v126
 v_exp_f32 v127, v127
 v_mfma_f32_32x32x16_bf16 v[80:95], a[20:23], v[148:151], v[16:31]
 v_exp_f32 v64, v64
 v_exp_f32 v65, v65
 v_exp_f32 v66, v66
 v_exp_f32 v67, v67
 v_mfma_f32_32x32x8_bf16 v[80:95], a[40:41], a[70:71], v[80:95]
 v_exp_f32 v68, v68
 v_exp_f32 v69, v69
 v_exp_f32 v70, v70
 v_exp_f32 v71, v71
 v_smfmac_f32_32x32x32_bf16 v[232:247], a[24:27], v[112:119], v163
 ds_read_b128 a[36:39], v161 offset:6624
 v_exp_f32 v72, v72
 v_exp_f32 v73, v73
 v_exp_f32 v74, v74
 v_exp_f32 v75, v75
 v_smfmac_f32_32x32x32_bf16 v[232:247], a[28:31], v[120:127], v163
 v_exp_f32 v76, v76
 v_exp_f32 v77, v77
 v_exp_f32 v78, v78
 v_exp_f32 v79, v79
 v_mfma_f32_32x32x16_bf16 v[96:111], a[20:23], v[152:155], v[32:47]
 s_waitcnt lgkmcnt(0)
 v_exp_f32 v80, v80
 v_exp_f32 v81, v81
 v_exp_f32 v82, v82
 v_exp_f32 v83, v83
 v_mfma_f32_32x32x8_bf16 v[96:111], a[40:41], a[74:75], v[96:111]
 v_exp_f32 v84, v84
 v_exp_f32 v85, v85
 v_exp_f32 v86, v86
 v_exp_f32 v87, v87
 v_smfmac_f32_32x32x32_bf16 v[184:199], a[32:35], v[64:71], v163
 ds_read_b128 a[16:19], v160 offset:2560
 v_exp_f32 v88, v88
 v_exp_f32 v89, v89
 v_exp_f32 v90, v90
 v_exp_f32 v91, v91
 v_smfmac_f32_32x32x32_bf16 v[184:199], a[36:39], v[72:79], v163
 v_exp_f32 v92, v92
 v_exp_f32 v93, v93
 v_exp_f32 v94, v94
 v_exp_f32 v95, v95
 v_mfma_f32_32x32x16_bf16 v[112:127], a[20:23], v[156:159], v[48:63]
 v_exp_f32 v96, v96
 v_exp_f32 v97, v97
 v_exp_f32 v98, v98
 v_exp_f32 v99, v99
 v_mfma_f32_32x32x8_bf16 v[112:127], a[40:41], a[78:79], v[112:127]
 v_exp_f32 v100, v100
 v_exp_f32 v101, v101
 v_exp_f32 v102, v102
 v_exp_f32 v103, v103
 v_smfmac_f32_32x32x32_bf16 v[200:215], a[32:35], v[80:87], v163
 v_exp_f32 v104, v104
 v_exp_f32 v105, v105
 v_exp_f32 v106, v106
 v_exp_f32 v107, v107
 v_smfmac_f32_32x32x32_bf16 v[200:215], a[36:39], v[88:95], v163
 s_waitcnt lgkmcnt(0)
 v_exp_f32 v108, v108
 v_exp_f32 v109, v109
 v_exp_f32 v110, v110
 v_exp_f32 v111, v111
 v_mfma_f32_32x32x16_bf16 v[64:79], a[16:19], v[144:147], v[0:15]
 v_exp_f32 v112, v112
 v_exp_f32 v113, v113
 v_exp_f32 v114, v114
 v_exp_f32 v115, v115
 v_mfma_f32_32x32x8_bf16 v[64:79], a[42:43], a[64:65], v[64:79]
 v_exp_f32 v116, v116
 v_exp_f32 v117, v117
 v_exp_f32 v118, v118
 v_exp_f32 v119, v119
 v_smfmac_f32_32x32x32_bf16 v[216:231], a[32:35], v[96:103], v163
 ds_read_b128 a[24:27], v161 offset:7296
 v_exp_f32 v120, v120
 v_exp_f32 v121, v121
 v_exp_f32 v122, v122
 v_exp_f32 v123, v123
 v_smfmac_f32_32x32x32_bf16 v[216:231], a[36:39], v[104:111], v163
 v_exp_f32 v124, v124
 v_exp_f32 v125, v125
 v_exp_f32 v126, v126
 v_exp_f32 v127, v127
 v_mfma_f32_32x32x16_bf16 v[80:95], a[16:19], v[148:151], v[16:31]
 v_exp_f32 v64, v64
 v_exp_f32 v65, v65
 v_exp_f32 v66, v66
 v_exp_f32 v67, v67
 v_mfma_f32_32x32x8_bf16 v[80:95], a[42:43], a[68:69], v[80:95]
 v_exp_f32 v68, v68
 v_exp_f32 v69, v69
 v_exp_f32 v70, v70
 v_exp_f32 v71, v71
 v_smfmac_f32_32x32x32_bf16 v[232:247], a[32:35], v[112:119], v163
 ds_read_b128 a[28:31], v161 offset:7968
 v_exp_f32 v72, v72
 v_exp_f32 v73, v73
 v_exp_f32 v74, v74
 v_exp_f32 v75, v75
 v_smfmac_f32_32x32x32_bf16 v[232:247], a[36:39], v[120:127], v163
 v_exp_f32 v76, v76
 v_exp_f32 v77, v77
 v_exp_f32 v78, v78
 v_exp_f32 v79, v79
 v_mfma_f32_32x32x16_bf16 v[96:111], a[16:19], v[152:155], v[32:47]
 s_waitcnt lgkmcnt(0)
 v_exp_f32 v80, v80
 v_exp_f32 v81, v81
 v_exp_f32 v82, v82
 v_exp_f32 v83, v83
 v_mfma_f32_32x32x8_bf16 v[96:111], a[42:43], a[72:73], v[96:111]
 v_exp_f32 v84, v84
 v_exp_f32 v85, v85
 v_exp_f32 v86, v86
 v_exp_f32 v87, v87
 v_smfmac_f32_32x32x32_bf16 v[184:199], a[24:27], v[64:71], v163
 ds_read_b128 a[20:23], v160 offset:3584
 ds_read_b128 a[44:47], v162 offset:9984
 v_exp_f32 v88, v88
 v_exp_f32 v89, v89
 v_exp_f32 v90, v90
 v_exp_f32 v91, v91
 v_smfmac_f32_32x32x32_bf16 v[184:199], a[28:31], v[72:79], v163
 v_exp_f32 v92, v92
 v_exp_f32 v93, v93
 v_exp_f32 v94, v94
 v_exp_f32 v95, v95
 v_mfma_f32_32x32x16_bf16 v[112:127], a[16:19], v[156:159], v[48:63]
 v_exp_f32 v96, v96
 v_exp_f32 v97, v97
 v_exp_f32 v98, v98
 v_exp_f32 v99, v99
 v_mfma_f32_32x32x8_bf16 v[112:127], a[42:43], a[76:77], v[112:127]
 v_exp_f32 v100, v100
 v_exp_f32 v101, v101
 v_exp_f32 v102, v102
 v_exp_f32 v103, v103
 v_smfmac_f32_32x32x32_bf16 v[200:215], a[24:27], v[80:87], v163
 v_exp_f32 v104, v104
 v_exp_f32 v105, v105
 v_exp_f32 v106, v106
 v_exp_f32 v107, v107
 v_smfmac_f32_32x32x32_bf16 v[200:215], a[28:31], v[88:95], v163
 s_waitcnt lgkmcnt(0)
 v_exp_f32 v108, v108
 v_exp_f32 v109, v109
 v_exp_f32 v110, v110
 v_exp_f32 v111, v111
 v_mfma_f32_32x32x16_bf16 v[64:79], a[20:23], v[144:147], v[0:15]
 v_exp_f32 v112, v112
 v_exp_f32 v113, v113
 v_exp_f32 v114, v114
 v_exp_f32 v115, v115
 v_mfma_f32_32x32x8_bf16 v[64:79], a[42:43], a[66:67], v[64:79]
 v_exp_f32 v116, v116
 v_exp_f32 v117, v117
 v_exp_f32 v118, v118
 v_exp_f32 v119, v119
 v_smfmac_f32_32x32x32_bf16 v[216:231], a[24:27], v[96:103], v163
 ds_read_b128 a[32:35], v161 offset:8640
 v_exp_f32 v120, v120
 v_exp_f32 v121, v121
 v_exp_f32 v122, v122
 v_exp_f32 v123, v123
 v_smfmac_f32_32x32x32_bf16 v[216:231], a[28:31], v[104:111], v163
 v_exp_f32 v124, v124
 v_exp_f32 v125, v125
 v_exp_f32 v126, v126
 v_exp_f32 v127, v127
 v_mfma_f32_32x32x16_bf16 v[80:95], a[20:23], v[148:151], v[16:31]
 v_exp_f32 v64, v64
 v_exp_f32 v65, v65
 v_exp_f32 v66, v66
 v_exp_f32 v67, v67
 v_mfma_f32_32x32x8_bf16 v[80:95], a[42:43], a[70:71], v[80:95]
 v_exp_f32 v68, v68
 v_exp_f32 v69, v69
 v_exp_f32 v70, v70
 v_exp_f32 v71, v71
 v_smfmac_f32_32x32x32_bf16 v[232:247], a[24:27], v[112:119], v163
 ds_read_b128 a[36:39], v161 offset:9312
 v_exp_f32 v72, v72
 v_exp_f32 v73, v73
 v_exp_f32 v74, v74
 v_exp_f32 v75, v75
 v_smfmac_f32_32x32x32_bf16 v[232:247], a[28:31], v[120:127], v163
 v_exp_f32 v76, v76
 v_exp_f32 v77, v77
 v_exp_f32 v78, v78
 v_exp_f32 v79, v79
 v_mfma_f32_32x32x16_bf16 v[96:111], a[20:23], v[152:155], v[32:47]
 s_waitcnt lgkmcnt(0)
 v_exp_f32 v80, v80
 v_exp_f32 v81, v81
 v_exp_f32 v82, v82
 v_exp_f32 v83, v83
 v_mfma_f32_32x32x8_bf16 v[96:111], a[42:43], a[74:75], v[96:111]
 v_exp_f32 v84, v84
 v_exp_f32 v85, v85
 v_exp_f32 v86, v86
 v_exp_f32 v87, v87
 v_smfmac_f32_32x32x32_bf16 v[184:199], a[32:35], v[64:71], v163
 ds_read_b128 a[16:19], v160 offset:10496
 v_exp_f32 v88, v88
 v_exp_f32 v89, v89
 v_exp_f32 v90, v90
 v_exp_f32 v91, v91
 v_smfmac_f32_32x32x32_bf16 v[184:199], a[36:39], v[72:79], v163
 v_exp_f32 v92, v92
 v_exp_f32 v93, v93
 v_exp_f32 v94, v94
 v_exp_f32 v95, v95
 v_mfma_f32_32x32x16_bf16 v[112:127], a[20:23], v[156:159], v[48:63]
 v_exp_f32 v96, v96
 v_exp_f32 v97, v97
 v_exp_f32 v98, v98
 v_exp_f32 v99, v99
 v_mfma_f32_32x32x8_bf16 v[112:127], a[42:43], a[78:79], v[112:127]
 v_exp_f32 v100, v100
 v_exp_f32 v101, v101
 v_exp_f32 v102, v102
 v_exp_f32 v103, v103
 v_smfmac_f32_32x32x32_bf16 v[200:215], a[32:35], v[80:87], v163
 v_exp_f32 v104, v104
 v_exp_f32 v105, v105
 v_exp_f32 v106, v106
 v_exp_f32 v107, v107
 v_smfmac_f32_32x32x32_bf16 v[200:215], a[36:39], v[88:95], v163
 s_waitcnt lgkmcnt(0)
 v_exp_f32 v108, v108
 v_exp_f32 v109, v109
 v_exp_f32 v110, v110
 v_exp_f32 v111, v111
 v_mfma_f32_32x32x16_bf16 v[64:79], a[16:19], v[144:147], v[0:15]
 v_exp_f32 v112, v112
 v_exp_f32 v113, v113
 v_exp_f32 v114, v114
 v_exp_f32 v115, v115
 v_mfma_f32_32x32x8_bf16 v[64:79], a[44:45], a[64:65], v[64:79]
 v_exp_f32 v116, v116
 v_exp_f32 v117, v117
 v_exp_f32 v118, v118
 v_exp_f32 v119, v119
 v_smfmac_f32_32x32x32_bf16 v[216:231], a[32:35], v[96:103], v163
 ds_read_b128 a[24:27], v161 offset:14592
 v_exp_f32 v120, v120
 v_exp_f32 v121, v121
 v_exp_f32 v122, v122
 v_exp_f32 v123, v123
 v_smfmac_f32_32x32x32_bf16 v[216:231], a[36:39], v[104:111], v163
 v_exp_f32 v124, v124
 v_exp_f32 v125, v125
 v_exp_f32 v126, v126
 v_exp_f32 v127, v127
 v_mfma_f32_32x32x16_bf16 v[80:95], a[16:19], v[148:151], v[16:31]
 s_add_u32 s74, s74, 1
 v_exp_f32 v64, v64
 v_exp_f32 v65, v65
 v_exp_f32 v66, v66
 v_exp_f32 v67, v67
 v_mfma_f32_32x32x8_bf16 v[80:95], a[44:45], a[68:69], v[80:95]
 v_exp_f32 v68, v68
 v_exp_f32 v69, v69
 v_exp_f32 v70, v70
 v_exp_f32 v71, v71
 v_smfmac_f32_32x32x32_bf16 v[232:247], a[32:35], v[112:119], v163
 ds_read_b128 a[28:31], v161 offset:15264
 v_exp_f32 v72, v72
 v_exp_f32 v73, v73
 v_exp_f32 v74, v74
 v_exp_f32 v75, v75
 v_smfmac_f32_32x32x32_bf16 v[232:247], a[36:39], v[120:127], v163
 v_exp_f32 v76, v76
 v_exp_f32 v77, v77
 v_exp_f32 v78, v78
 v_exp_f32 v79, v79
 v_mfma_f32_32x32x16_bf16 v[96:111], a[16:19], v[152:155], v[32:47]
 s_waitcnt lgkmcnt(0)
 v_exp_f32 v80, v80
 v_exp_f32 v81, v81
 v_exp_f32 v82, v82
 v_exp_f32 v83, v83
 v_mfma_f32_32x32x8_bf16 v[96:111], a[44:45], a[72:73], v[96:111]
 v_exp_f32 v84, v84
 v_exp_f32 v85, v85
 v_exp_f32 v86, v86
 v_exp_f32 v87, v87
 v_smfmac_f32_32x32x32_bf16 v[184:199], a[24:27], v[64:71], v163
 ds_read_b128 a[20:23], v160 offset:11520
 v_exp_f32 v88, v88
 v_exp_f32 v89, v89
 v_exp_f32 v90, v90
 v_exp_f32 v91, v91
 v_smfmac_f32_32x32x32_bf16 v[184:199], a[28:31], v[72:79], v163
 v_exp_f32 v92, v92
 v_exp_f32 v93, v93
 v_exp_f32 v94, v94
 v_exp_f32 v95, v95
 v_mfma_f32_32x32x16_bf16 v[112:127], a[16:19], v[156:159], v[48:63]
 v_exp_f32 v96, v96
 v_exp_f32 v97, v97
 v_exp_f32 v98, v98
 v_exp_f32 v99, v99
 v_mfma_f32_32x32x8_bf16 v[112:127], a[44:45], a[76:77], v[112:127]
 v_exp_f32 v100, v100
 v_exp_f32 v101, v101
 v_exp_f32 v102, v102
 v_exp_f32 v103, v103
 v_smfmac_f32_32x32x32_bf16 v[200:215], a[24:27], v[80:87], v163
 v_exp_f32 v104, v104
 v_exp_f32 v105, v105
 v_exp_f32 v106, v106
 v_exp_f32 v107, v107
 v_smfmac_f32_32x32x32_bf16 v[200:215], a[28:31], v[88:95], v163
 s_waitcnt lgkmcnt(0)
 v_exp_f32 v108, v108
 v_exp_f32 v109, v109
 v_exp_f32 v110, v110
 v_exp_f32 v111, v111
 v_mfma_f32_32x32x16_bf16 v[64:79], a[20:23], v[144:147], v[0:15]
 v_exp_f32 v112, v112
 v_exp_f32 v113, v113
 v_exp_f32 v114, v114
 v_exp_f32 v115, v115
 v_mfma_f32_32x32x8_bf16 v[64:79], a[44:45], a[66:67], v[64:79]
 v_exp_f32 v116, v116
 v_exp_f32 v117, v117
 v_exp_f32 v118, v118
 v_exp_f32 v119, v119
 v_smfmac_f32_32x32x32_bf16 v[216:231], a[24:27], v[96:103], v163
 ds_read_b128 a[32:35], v161 offset:15936
 v_exp_f32 v120, v120
 v_exp_f32 v121, v121
 v_exp_f32 v122, v122
 v_exp_f32 v123, v123
 v_smfmac_f32_32x32x32_bf16 v[216:231], a[28:31], v[104:111], v163
 v_exp_f32 v124, v124
 v_exp_f32 v125, v125
 v_exp_f32 v126, v126
 v_exp_f32 v127, v127
 v_mfma_f32_32x32x16_bf16 v[80:95], a[20:23], v[148:151], v[16:31]
 v_exp_f32 v64, v64
 v_exp_f32 v65, v65
 v_exp_f32 v66, v66
 v_exp_f32 v67, v67
 v_mfma_f32_32x32x8_bf16 v[80:95], a[44:45], a[70:71], v[80:95]
 v_exp_f32 v68, v68
 v_exp_f32 v69, v69
 v_exp_f32 v70, v70
 v_exp_f32 v71, v71
 v_smfmac_f32_32x32x32_bf16 v[232:247], a[24:27], v[112:119], v163
 ds_read_b128 a[36:39], v161 offset:16608
 v_exp_f32 v72, v72
 v_exp_f32 v73, v73
 v_exp_f32 v74, v74
 v_exp_f32 v75, v75
 v_smfmac_f32_32x32x32_bf16 v[232:247], a[28:31], v[120:127], v163
 v_exp_f32 v76, v76
 v_exp_f32 v77, v77
 v_exp_f32 v78, v78
 v_exp_f32 v79, v79
 v_mfma_f32_32x32x16_bf16 v[96:111], a[20:23], v[152:155], v[32:47]
 s_waitcnt lgkmcnt(0)
 v_exp_f32 v80, v80
 v_exp_f32 v81, v81
 v_exp_f32 v82, v82
 v_exp_f32 v83, v83
 v_mfma_f32_32x32x8_bf16 v[96:111], a[44:45], a[74:75], v[96:111]
 v_exp_f32 v84, v84
 v_exp_f32 v85, v85
 v_exp_f32 v86, v86
 v_exp_f32 v87, v87
 v_smfmac_f32_32x32x32_bf16 v[184:199], a[32:35], v[64:71], v163
 ds_read_b128 a[16:19], v160 offset:12544
 v_exp_f32 v88, v88
 v_exp_f32 v89, v89
 v_exp_f32 v90, v90
 v_exp_f32 v91, v91
 v_smfmac_f32_32x32x32_bf16 v[184:199], a[36:39], v[72:79], v163
 v_exp_f32 v92, v92
 v_exp_f32 v93, v93
 v_exp_f32 v94, v94
 v_exp_f32 v95, v95
 v_mfma_f32_32x32x16_bf16 v[112:127], a[20:23], v[156:159], v[48:63]
 v_exp_f32 v96, v96
 v_exp_f32 v97, v97
 v_exp_f32 v98, v98
 v_exp_f32 v99, v99
 v_mfma_f32_32x32x8_bf16 v[112:127], a[44:45], a[78:79], v[112:127]
 v_exp_f32 v100, v100
 v_exp_f32 v101, v101
 v_exp_f32 v102, v102
 v_exp_f32 v103, v103
 v_smfmac_f32_32x32x32_bf16 v[200:215], a[32:35], v[80:87], v163
 v_exp_f32 v104, v104
 v_exp_f32 v105, v105
 v_exp_f32 v106, v106
 v_exp_f32 v107, v107
 v_smfmac_f32_32x32x32_bf16 v[200:215], a[36:39], v[88:95], v163
 s_waitcnt lgkmcnt(0)
 v_exp_f32 v108, v108
 v_exp_f32 v109, v109
 v_exp_f32 v110, v110
 v_exp_f32 v111, v111
 v_mfma_f32_32x32x16_bf16 v[64:79], a[16:19], v[144:147], v[0:15]
 v_exp_f32 v112, v112
 v_exp_f32 v113, v113
 v_exp_f32 v114, v114
 v_exp_f32 v115, v115
 v_mfma_f32_32x32x8_bf16 v[64:79], a[46:47], a[64:65], v[64:79]
 v_exp_f32 v116, v116
 v_exp_f32 v117, v117
 v_exp_f32 v118, v118
 v_exp_f32 v119, v119
 v_smfmac_f32_32x32x32_bf16 v[216:231], a[32:35], v[96:103], v163
 ds_read_b128 a[24:27], v161 offset:17280
 v_exp_f32 v120, v120
 v_exp_f32 v121, v121
 v_exp_f32 v122, v122
 v_exp_f32 v123, v123
 v_smfmac_f32_32x32x32_bf16 v[216:231], a[36:39], v[104:111], v163
 v_exp_f32 v124, v124
 v_exp_f32 v125, v125
 v_exp_f32 v126, v126
 v_exp_f32 v127, v127
 v_mfma_f32_32x32x16_bf16 v[80:95], a[16:19], v[148:151], v[16:31]
 v_exp_f32 v64, v64
 v_exp_f32 v65, v65
 v_exp_f32 v66, v66
 v_exp_f32 v67, v67
 v_mfma_f32_32x32x8_bf16 v[80:95], a[46:47], a[68:69], v[80:95]
 v_exp_f32 v68, v68
 v_exp_f32 v69, v69
 v_exp_f32 v70, v70
 v_exp_f32 v71, v71
 v_smfmac_f32_32x32x32_bf16 v[232:247], a[32:35], v[112:119], v163
 ds_read_b128 a[28:31], v161 offset:17952
 v_exp_f32 v72, v72
 v_exp_f32 v73, v73
 v_exp_f32 v74, v74
 v_exp_f32 v75, v75
 v_smfmac_f32_32x32x32_bf16 v[232:247], a[36:39], v[120:127], v163
 v_exp_f32 v76, v76
 v_exp_f32 v77, v77
 v_exp_f32 v78, v78
 v_exp_f32 v79, v79
 v_mfma_f32_32x32x16_bf16 v[96:111], a[16:19], v[152:155], v[32:47]
 s_waitcnt lgkmcnt(0)
 v_exp_f32 v80, v80
 v_exp_f32 v81, v81
 v_exp_f32 v82, v82
 v_exp_f32 v83, v83
 v_mfma_f32_32x32x8_bf16 v[96:111], a[46:47], a[72:73], v[96:111]
 v_exp_f32 v84, v84
 v_exp_f32 v85, v85
 v_exp_f32 v86, v86
 v_exp_f32 v87, v87
 v_smfmac_f32_32x32x32_bf16 v[184:199], a[24:27], v[64:71], v163
 ds_read_b128 a[20:23], v160 offset:13568
 ds_read_b128 a[40:43], v162 offset:19968
 v_exp_f32 v88, v88
 v_exp_f32 v89, v89
 v_exp_f32 v90, v90
 v_exp_f32 v91, v91
 v_smfmac_f32_32x32x32_bf16 v[184:199], a[28:31], v[72:79], v163
 v_exp_f32 v92, v92
 v_exp_f32 v93, v93
 v_exp_f32 v94, v94
 v_exp_f32 v95, v95
 v_mfma_f32_32x32x16_bf16 v[112:127], a[16:19], v[156:159], v[48:63]
 v_exp_f32 v96, v96
 v_exp_f32 v97, v97
 v_exp_f32 v98, v98
 v_exp_f32 v99, v99
 v_mfma_f32_32x32x8_bf16 v[112:127], a[46:47], a[76:77], v[112:127]
 v_exp_f32 v100, v100
 v_exp_f32 v101, v101
 v_exp_f32 v102, v102
 v_exp_f32 v103, v103
 v_smfmac_f32_32x32x32_bf16 v[200:215], a[24:27], v[80:87], v163
 v_exp_f32 v104, v104
 v_exp_f32 v105, v105
 v_exp_f32 v106, v106
 v_exp_f32 v107, v107
 v_smfmac_f32_32x32x32_bf16 v[200:215], a[28:31], v[88:95], v163
 s_waitcnt lgkmcnt(0)
 v_exp_f32 v108, v108
 v_exp_f32 v109, v109
 v_exp_f32 v110, v110
 v_exp_f32 v111, v111
 v_mfma_f32_32x32x16_bf16 v[64:79], a[20:23], v[144:147], v[0:15]
 v_exp_f32 v112, v112
 v_exp_f32 v113, v113
 v_exp_f32 v114, v114
 v_exp_f32 v115, v115
 v_mfma_f32_32x32x8_bf16 v[64:79], a[46:47], a[66:67], v[64:79]
 v_exp_f32 v116, v116
 v_exp_f32 v117, v117
 v_exp_f32 v118, v118
 v_exp_f32 v119, v119
 v_smfmac_f32_32x32x32_bf16 v[216:231], a[24:27], v[96:103], v163
 ds_read_b128 a[32:35], v161 offset:18624
 v_exp_f32 v120, v120
 v_exp_f32 v121, v121
 v_exp_f32 v122, v122
 v_exp_f32 v123, v123
 v_smfmac_f32_32x32x32_bf16 v[216:231], a[28:31], v[104:111], v163
 v_exp_f32 v124, v124
 v_exp_f32 v125, v125
 v_exp_f32 v126, v126
 v_exp_f32 v127, v127
 v_mfma_f32_32x32x16_bf16 v[80:95], a[20:23], v[148:151], v[16:31]
 v_exp_f32 v64, v64
 v_exp_f32 v65, v65
 v_exp_f32 v66, v66
 v_exp_f32 v67, v67
 v_mfma_f32_32x32x8_bf16 v[80:95], a[46:47], a[70:71], v[80:95]
 v_exp_f32 v68, v68
 v_exp_f32 v69, v69
 v_exp_f32 v70, v70
 v_exp_f32 v71, v71
 v_smfmac_f32_32x32x32_bf16 v[232:247], a[24:27], v[112:119], v163
 ds_read_b128 a[36:39], v161 offset:19296
 v_exp_f32 v72, v72
 v_exp_f32 v73, v73
 v_exp_f32 v74, v74
 v_exp_f32 v75, v75
 v_smfmac_f32_32x32x32_bf16 v[232:247], a[28:31], v[120:127], v163
 v_exp_f32 v76, v76
 v_exp_f32 v77, v77
 v_exp_f32 v78, v78
 v_exp_f32 v79, v79
 v_mfma_f32_32x32x16_bf16 v[96:111], a[20:23], v[152:155], v[32:47]
 s_waitcnt lgkmcnt(0)
 v_exp_f32 v80, v80
 v_exp_f32 v81, v81
 v_exp_f32 v82, v82
 v_exp_f32 v83, v83
 v_mfma_f32_32x32x8_bf16 v[96:111], a[46:47], a[74:75], v[96:111]
 v_exp_f32 v84, v84
 v_exp_f32 v85, v85
 v_exp_f32 v86, v86
 v_exp_f32 v87, v87
 v_smfmac_f32_32x32x32_bf16 v[184:199], a[32:35], v[64:71], v163
 ds_read_b128 a[16:19], v160 offset:20480
 v_exp_f32 v88, v88
 v_exp_f32 v89, v89
 v_exp_f32 v90, v90
 v_exp_f32 v91, v91
 v_smfmac_f32_32x32x32_bf16 v[184:199], a[36:39], v[72:79], v163
 v_exp_f32 v92, v92
 v_exp_f32 v93, v93
 v_exp_f32 v94, v94
 v_exp_f32 v95, v95
 v_mfma_f32_32x32x16_bf16 v[112:127], a[20:23], v[156:159], v[48:63]
 s_cmp_lt_u32 s74, 8
 v_exp_f32 v96, v96
 v_exp_f32 v97, v97
 v_exp_f32 v98, v98
 v_exp_f32 v99, v99
 v_mfma_f32_32x32x8_bf16 v[112:127], a[46:47], a[78:79], v[112:127]
 v_exp_f32 v100, v100
 v_exp_f32 v101, v101
 v_exp_f32 v102, v102
 v_exp_f32 v103, v103
 v_smfmac_f32_32x32x32_bf16 v[200:215], a[32:35], v[80:87], v163
 v_add_u32 v160, 19968, v160
 v_add_u32 v161, 19968, v161
 v_add_u32 v162, 19968, v162
 v_exp_f32 v104, v104
 v_exp_f32 v105, v105
 v_exp_f32 v106, v106
 v_exp_f32 v107, v107
 v_smfmac_f32_32x32x32_bf16 v[200:215], a[36:39], v[88:95], v163
 s_waitcnt lgkmcnt(0)
 v_exp_f32 v108, v108
 v_exp_f32 v109, v109
 v_exp_f32 v110, v110
 v_exp_f32 v111, v111
 s_cbranch_scc1 L_att_fb_loop
 s_barrier
 v_accvgpr_read_b32 v172, a205
 v_accvgpr_read_b32 v173, a206
 v_accvgpr_read_b32 v174, a207
 v_accvgpr_read_b32 v175, a208
 s_lshl_b32 s69, s63, 10
 s_and_b32 s68, s61, 2
 s_lshl_b32 s68, s68, 5
 s_add_u32 s68, s68, 1024
 s_add_u32 m0, s69, 0
 s_add_u32 s65, s72, 0
 buffer_load_dwordx4 v172, s[40:43], s65 offen lds
 s_add_u32 m0, s69, 4096
 s_add_u32 s65, s72, 41472
 buffer_load_dwordx4 v172, s[40:43], s65 offen lds
 s_add_u32 m0, s69, 8192
 s_add_u32 s65, s72, 82944
 buffer_load_dwordx4 v172, s[40:43], s65 offen lds
 s_add_u32 m0, s69, 12288
 s_add_u32 s65, s72, 124416
 buffer_load_dwordx4 v172, s[40:43], s65 offen lds
 s_add_u32 m0, s69, 16384
 s_add_u32 s65, s72, 165888
 buffer_load_dwordx4 v172, s[40:43], s65 offen lds
 s_add_u32 m0, s69, 20480
 s_add_u32 s65, s72, 207360
 buffer_load_dwordx4 v172, s[40:43], s65 offen lds
 s_add_u32 m0, s69, 24576
 s_add_u32 s65, s72, 248832
 buffer_load_dwordx4 v172, s[40:43], s65 offen lds
 s_add_u32 m0, s69, 28672
 s_add_u32 s65, s72, 290304
 buffer_load_dwordx4 v172, s[40:43], s65 offen lds
 s_add_u32 m0, s69, 32768
 s_add_u32 s65, s72, 331776
 buffer_load_dwordx4 v172, s[40:43], s65 offen lds
 s_add_u32 m0, s69, 36864
 s_add_u32 s65, s72, 373248
 buffer_load_dwordx4 v172, s[40:43], s65 offen lds
 s_add_u32 m0, s69, 40960
 s_add_u32 s65, s72, 414720
 buffer_load_dwordx4 v172, s[40:43], s65 offen lds
 s_add_u32 m0, s69, 45056
 s_add_u32 s65, s72, 456192
 buffer_load_dwordx4 v172, s[40:43], s65 offen lds
 s_add_u32 m0, s69, 49152
 s_add_u32 s65, s72, 497664
 buffer_load_dwordx4 v172, s[40:43], s65 offen lds
 s_add_u32 m0, s69, 53248
 s_add_u32 s65, s72, 539136
 buffer_load_dwordx4 v172, s[40:43], s65 offen lds
 s_add_u32 m0, s69, 57344
 s_add_u32 s65, s72, 580608
 buffer_load_dwordx4 v172, s[40:43], s65 offen lds
 s_add_u32 m0, s69, 61440
 s_add_u32 s65, s72, 622080
 buffer_load_dwordx4 v172, s[40:43], s65 offen lds
 s_add_u32 m0, s69, 65536
 s_add_u32 s65, s72, 0
 buffer_load_dwordx4 v173, s[40:43], s65 offen lds
 s_add_u32 m0, s69, 69632
 s_add_u32 s65, s72, 331776
 buffer_load_dwordx4 v173, s[40:43], s65 offen lds
 s_add_u32 m0, s69, 73728
 s_add_u32 s65, s68, 0
 buffer_load_dwordx4 v174, s[40:43], s65 offen lds
 s_add_u32 m0, s69, 77824
 s_add_u32 s65, s68, 82944
 buffer_load_dwordx4 v174, s[40:43], s65 offen lds
 s_add_u32 m0, s69, 81920
 s_add_u32 s65, s68, 165888
 buffer_load_dwordx4 v174, s[40:43], s65 offen lds
 s_add_u32 m0, s69, 86016
 s_add_u32 s65, s68, 248832
 buffer_load_dwordx4 v174, s[40:43], s65 offen lds
 s_add_u32 m0, s69, 90112
 s_add_u32 s65, s68, 331776
 buffer_load_dwordx4 v174, s[40:43], s65 offen lds
 s_add_u32 m0, s69, 94208
 s_add_u32 s65, s68, 414720
 buffer_load_dwordx4 v174, s[40:43], s65 offen lds
 s_add_u32 m0, s69, 98304
 s_add_u32 s65, s68, 497664
 buffer_load_dwordx4 v174, s[40:43], s65 offen lds
 s_add_u32 m0, s69, 102400
 s_add_u32 s65, s68, 580608
 buffer_load_dwordx4 v174, s[40:43], s65 offen lds
 s_add_u32 m0, s69, 106496
 s_add_u32 s65, s68, 0
 buffer_load_dwordx4 v175, s[40:43], s65 offen lds
 buffer_load_dwordx2 v[142:143], v167, s[56:59], 0 offen sc1
 s_branch L_att_tail
L_po:
 s_mov_b32 s79, 0
L_po2_spin:
 buffer_load_dwordx2 v[142:143], v167, s[56:59], 0 offen offset:0 sc1
 s_waitcnt vmcnt(0)
 v_readfirstlane_b32 s67, v142
 v_readfirstlane_b32 s68, v143
 s_nop 0
 s_and_b32 s67, s67, s68
 s_cmp_eq_u32 s67, 0x1010101
 s_cbranch_scc1 L_po2_done
 s_sleep 1
 s_add_u32 s79, s79, 1
 s_cmp_lt_u32 s79, 0x80000
 s_cbranch_scc1 L_po2_spin
L_po2_done:
 s_branch L_po_done
L_ok2:
 s_add_u32 s67, s61, 1
 s_and_b32 s67, s67, 7
 s_lshl_b32 s67, s67, 12
 s_add_u32 s67, s67, s91
 s_mov_b32 s79, 0
L_ok2_spin:
 buffer_load_dwordx4 v[56:59], v193, s[56:59], s67 offen offset:0 sc1
 buffer_load_dwordx4 v[60:63], v193, s[56:59], s67 offen offset:1024 sc1
 buffer_load_dwordx4 v[64:67], v193, s[56:59], s67 offen offset:2048 sc1
 buffer_load_dwordx4 v[68:71], v193, s[56:59], s67 offen offset:3072 sc1
 s_waitcnt vmcnt(0)
 v_max3_u32 v197, v56, v57, v58
 v_max3_u32 v197, v197, v59, v60
 v_max3_u32 v197, v197, v61, v62
 v_max3_u32 v197, v197, v63, v64
 v_max3_u32 v197, v197, v65, v66
 v_max3_u32 v197, v197, v67, v68
 v_max3_u32 v197, v197, v69, v70
 v_max_u32 v197, v197, v71
 v_cmp_eq_u32 vcc, -1, v197
 s_cbranch_vccz L_ok2_got
 s_sleep 1
 s_add_u32 s79, s79, 1
 s_cmp_lt_u32 s79, 0x80000
 s_cbranch_scc1 L_ok2_spin
L_ok2_got:
 v_max3_u32 v197, v72, v73, v74
 v_max3_u32 v197, v197, v75, v76
 v_max3_u32 v197, v197, v77, v78
 v_max3_u32 v197, v197, v79, v80
 v_max3_u32 v197, v197, v81, v82
 v_max3_u32 v197, v197, v83, v84
 v_max3_u32 v197, v197, v85, v86
 v_max3_u32 v197, v197, v87, v88
 v_max3_u32 v197, v197, v89, v90
 v_max3_u32 v197, v197, v91, v92
 v_max3_u32 v197, v197, v93, v94
 v_max3_u32 v197, v197, v95, v96
 v_max3_u32 v197, v197, v97, v98
 v_max3_u32 v197, v197, v99, v100
 v_max3_u32 v197, v197, v101, v102
 v_max_u32 v197, v197, v103
 v_cmp_eq_u32 vcc, -1, v197
 s_cbranch_vccz L_ok2_ret
 s_add_u32 s67, s61, 2
 s_and_b32 s67, s67, 7
 s_lshl_b32 s67, s67, 12
 s_add_u32 s67, s67, s91
 buffer_load_dwordx4 v[72:75], v193, s[56:59], s67 offen offset:0 sc1
 buffer_load_dwordx4 v[76:79], v193, s[56:59], s67 offen offset:1024 sc1
 buffer_load_dwordx4 v[80:83], v193, s[56:59], s67 offen offset:2048 sc1
 buffer_load_dwordx4 v[84:87], v193, s[56:59], s67 offen offset:3072 sc1
 s_add_u32 s67, s61, 3
 s_and_b32 s67, s67, 7
 s_lshl_b32 s67, s67, 12
 s_add_u32 s67, s67, s91
 buffer_load_dwordx4 v[88:91], v193, s[56:59], s67 offen offset:0 sc1
 buffer_load_dwordx4 v[92:95], v193, s[56:59], s67 offen offset:1024 sc1
 buffer_load_dwordx4 v[96:99], v193, s[56:59], s67 offen offset:2048 sc1
 buffer_load_dwordx4 v[100:103], v193, s[56:59], s67 offen offset:3072 sc1
 s_branch L_ok2_ret
L_ok3:
 s_add_u32 s67, s61, 1
 s_and_b32 s67, s67, 7
 s_lshl_b32 s67, s67, 12
 s_add_u32 s67, s67, s91
 s_mov_b32 s79, 0
L_ok3_spin:
 buffer_load_dwordx4 v[64:67], v193, s[56:59], s67 offen offset:2048 sc1
 buffer_load_dwordx4 v[68:71], v193, s[56:59], s67 offen offset:3072 sc1
 s_waitcnt vmcnt(0)
 v_max3_u32 v197, v64, v65, v66
 v_max3_u32 v197, v197, v67, v68
 v_max3_u32 v197, v197, v69, v70
 v_max_u32 v197, v197, v71
 v_cmp_eq_u32 vcc, -1, v197
 s_cbranch_vccz L_ok3_got
 s_sleep 1
 s_add_u32 s79, s79, 1
 s_cmp_lt_u32 s79, 0x80000
 s_cbranch_scc1 L_ok3_spin
L_ok3_got:
 v_max3_u32 v197, v72, v73, v74
 v_max3_u32 v197, v197, v75, v76
 v_max3_u32 v197, v197, v77, v78
 v_max3_u32 v197, v197, v79, v80
 v_max3_u32 v197, v197, v81, v82
 v_max3_u32 v197, v197, v83, v84
 v_max3_u32 v197, v197, v85, v86
 v_max3_u32 v197, v197, v87, v88
 v_max3_u32 v197, v197, v89, v90
 v_max3_u32 v197, v197, v91, v92
 v_max3_u32 v197, v197, v93, v94
 v_max3_u32 v197, v197, v95, v96
 v_max3_u32 v197, v197, v97, v98
 v_max3_u32 v197, v197, v99, v100
 v_max3_u32 v197, v197, v101, v102
 v_max3_u32 v197, v197, v103, v104
 v_max3_u32 v197, v197, v105, v106
 v_max3_u32 v197, v197, v107, v108
 v_max3_u32 v197, v197, v109, v110
 v_max_u32 v197, v197, v111
 v_cmp_eq_u32 vcc, -1, v197
 s_cbranch_vccz L_ok3_ret
 s_add_u32 s67, s61, 2
 s_and_b32 s67, s67, 7
 s_lshl_b32 s67, s67, 12
 s_add_u32 s67, s67, s91
 buffer_load_dwordx4 v[72:75], v193, s[56:59], s67 offen offset:0 sc1
 buffer_load_dwordx4 v[76:79], v193, s[56:59], s67 offen offset:1024 sc1
 buffer_load_dwordx4 v[80:83], v193, s[56:59], s67 offen offset:2048 sc1
 buffer_load_dwordx4 v[84:87], v193, s[56:59], s67 offen offset:3072 sc1
 s_add_u32 s67, s61, 3
 s_and_b32 s67, s67, 7
 s_lshl_b32 s67, s67, 12
 s_add_u32 s67, s67, s91
 buffer_load_dwordx4 v[88:91], v193, s[56:59], s67 offen offset:0 sc1
 buffer_load_dwordx4 v[92:95], v193, s[56:59], s67 offen offset:1024 sc1
 buffer_load_dwordx4 v[96:99], v193, s[56:59], s67 offen offset:2048 sc1
 buffer_load_dwordx4 v[100:103], v193, s[56:59], s67 offen offset:3072 sc1
 s_add_u32 s67, s61, 4
 s_and_b32 s67, s67, 7
 s_lshl_b32 s67, s67, 12
 s_add_u32 s67, s67, s91
 buffer_load_dwordx4 v[104:107], v193, s[56:59], s67 offen offset:0 sc1
 buffer_load_dwordx4 v[108:111], v193, s[56:59], s67 offen offset:1024 sc1
 s_branch L_ok3_ret
L_ok4:
 s_add_u32 s67, s61, 2
 s_and_b32 s67, s67, 7
 s_lshl_b32 s67, s67, 12
 s_add_u32 s67, s67, s91
 s_mov_b32 s79, 0
L_ok4_spin:
 buffer_load_dwordx4 v[72:75], v193, s[56:59], s67 offen offset:0 sc1
 buffer_load_dwordx4 v[76:79], v193, s[56:59], s67 offen offset:1024 sc1
 buffer_load_dwordx4 v[80:83], v193, s[56:59], s67 offen offset:2048 sc1
 buffer_load_dwordx4 v[84:87], v193, s[56:59], s67 offen offset:3072 sc1
 s_waitcnt vmcnt(0)
 v_max3_u32 v197, v72, v73, v74
 v_max3_u32 v197, v197, v75, v76
 v_max3_u32 v197, v197, v77, v78
 v_max3_u32 v197, v197, v79, v80
 v_max3_u32 v197, v197, v81, v82
 v_max3_u32 v197, v197, v83, v84
 v_max3_u32 v197, v197, v85, v86
 v_max_u32 v197, v197, v87
 v_cmp_eq_u32 vcc, -1, v197
 s_cbranch_vccz L_ok4_got
 s_sleep 1
 s_add_u32 s79, s79, 1
 s_cmp_lt_u32 s79, 0x80000
 s_cbranch_scc1 L_ok4_spin
L_ok4_got:
 v_max3_u32 v197, v88, v89, v90
 v_max3_u32 v197, v197, v91, v92
 v_max3_u32 v197, v197, v93, v94
 v_max3_u32 v197, v197, v95, v96
 v_max3_u32 v197, v197, v97, v98
 v_max3_u32 v197, v197, v99, v100
 v_max3_u32 v197, v197, v101, v102
 v_max3_u32 v197, v197, v103, v104
 v_max3_u32 v197, v197, v105, v106
 v_max3_u32 v197, v197, v107, v108
 v_max3_u32 v197, v197, v109, v110
 v_max3_u32 v197, v197, v111, v112
 v_max3_u32 v197, v197, v113, v114
 v_max3_u32 v197, v197, v115, v116
 v_max3_u32 v197, v197, v117, v118
 v_max_u32 v197, v197, v119
 v_cmp_eq_u32 vcc, -1, v197
 s_cbranch_vccz L_ok4_ret
 s_add_u32 s67, s61, 3
 s_and_b32 s67, s67, 7
 s_lshl_b32 s67, s67, 12
 s_add_u32 s67, s67, s91
 buffer_load_dwordx4 v[88:91], v193, s[56:59], s67 offen offset:0 sc1
 buffer_load_dwordx4 v[92:95], v193, s[56:59], s67 offen offset:1024 sc1
 buffer_load_dwordx4 v[96:99], v193, s[56:59], s67 offen offset:2048 sc1
 buffer_load_dwordx4 v[100:103], v193, s[56:59], s67 offen offset:3072 sc1
 s_add_u32 s67, s61, 4
 s_and_b32 s67, s67, 7
 s_lshl_b32 s67, s67, 12
 s_add_u32 s67, s67, s91
 buffer_load_dwordx4 v[104:107], v193, s[56:59], s67 offen offset:0 sc1
 buffer_load_dwordx4 v[108:111], v193, s[56:59], s67 offen offset:1024 sc1
 buffer_load_dwordx4 v[112:115], v193, s[56:59], s67 offen offset:2048 sc1
 buffer_load_dwordx4 v[116:119], v193, s[56:59], s67 offen offset:3072 sc1
 s_branch L_ok4_ret
L_ok5:
 s_add_u32 s67, s61, 2
 s_and_b32 s67, s67, 7
 s_lshl_b32 s67, s67, 12
 s_add_u32 s67, s67, s91
 s_mov_b32 s79, 0
L_ok5_spin:
 buffer_load_dwordx4 v[80:83], v193, s[56:59], s67 offen offset:2048 sc1
 buffer_load_dwordx4 v[84:87], v193, s[56:59], s67 offen offset:3072 sc1
 s_waitcnt vmcnt(0)
 v_max3_u32 v197, v80, v81, v82
 v_max3_u32 v197, v197, v83, v84
 v_max3_u32 v197, v197, v85, v86
 v_max_u32 v197, v197, v87
 v_cmp_eq_u32 vcc, -1, v197
 s_cbranch_vccz L_ok5_got
 s_sleep 1
 s_add_u32 s79, s79, 1
 s_cmp_lt_u32 s79, 0x80000
 s_cbranch_scc1 L_ok5_spin
L_ok5_got:
 v_max3_u32 v197, v88, v89, v90
 v_max3_u32 v197, v197, v91, v92
 v_max3_u32 v197, v197, v93, v94
 v_max3_u32 v197, v197, v95, v96
 v_max3_u32 v197, v197, v97, v98
 v_max3_u32 v197, v197, v99, v100
 v_max3_u32 v197, v197, v101, v102
 v_max3_u32 v197, v197, v103, v104
 v_max3_u32 v197, v197, v105, v106
 v_max3_u32 v197, v197, v107, v108
 v_max3_u32 v197, v197, v109, v110
 v_max3_u32 v197, v197, v111, v112
 v_max3_u32 v197, v197, v113, v114
 v_max3_u32 v197, v197, v115, v116
 v_max3_u32 v197, v197, v117, v118
 v_max3_u32 v197, v197, v119, v120
 v_max3_u32 v197, v197, v121, v122
 v_max3_u32 v197, v197, v123, v124
 v_max3_u32 v197, v197, v125, v126
 v_max_u32 v197, v197, v127
 v_cmp_eq_u32 vcc, -1, v197
 s_cbranch_vccz L_ok5_ret
 s_add_u32 s67, s61, 3
 s_and_b32 s67, s67, 7
 s_lshl_b32 s67, s67, 12
 s_add_u32 s67, s67, s91
 buffer_load_dwordx4 v[88:91], v193, s[56:59], s67 offen offset:0 sc1
 buffer_load_dwordx4 v[92:95], v193, s[56:59], s67 offen offset:1024 sc1
 buffer_load_dwordx4 v[96:99], v193, s[56:59], s67 offen offset:2048 sc1
 buffer_load_dwordx4 v[100:103], v193, s[56:59], s67 offen offset:3072 sc1
 s_add_u32 s67, s61, 4
 s_and_b32 s67, s67, 7
 s_lshl_b32 s67, s67, 12
 s_add_u32 s67, s67, s91
 buffer_load_dwordx4 v[104:107], v193, s[56:59], s67 offen offset:0 sc1
 buffer_load_dwordx4 v[108:111], v193, s[56:59], s67 offen offset:1024 sc1
 buffer_load_dwordx4 v[112:115], v193, s[56:59], s67 offen offset:2048 sc1
 buffer_load_dwordx4 v[116:119], v193, s[56:59], s67 offen offset:3072 sc1
 s_add_u32 s67, s61, 5
 s_and_b32 s67, s67, 7
 s_lshl_b32 s67, s67, 12
 s_add_u32 s67, s67, s91
 buffer_load_dwordx4 v[120:123], v193, s[56:59], s67 offen offset:0 sc1
 buffer_load_dwordx4 v[124:127], v193, s[56:59], s67 offen offset:1024 sc1
 s_branch L_ok5_ret
L_ok6:
 s_add_u32 s67, s61, 3
 s_and_b32 s67, s67, 7
 s_lshl_b32 s67, s67, 12
 s_add_u32 s67, s67, s91
 s_mov_b32 s79, 0
L_ok6_spin:
 buffer_load_dwordx4 v[88:91], v193, s[56:59], s67 offen offset:0 sc1
 buffer_load_dwordx4 v[92:95], v193, s[56:59], s67 offen offset:1024 sc1
 buffer_load_dwordx4 v[96:99], v193, s[56:59], s67 offen offset:2048 sc1
 buffer_load_dwordx4 v[100:103], v193, s[56:59], s67 offen offset:3072 sc1
 s_waitcnt vmcnt(0)
 v_max3_u32 v197, v88, v89, v90
 v_max3_u32 v197, v197, v91, v92
 v_max3_u32 v197, v197, v93, v94
 v_max3_u32 v197, v197, v95, v96
 v_max3_u32 v197, v197, v97, v98
 v_max3_u32 v197, v197, v99, v100
 v_max3_u32 v197, v197, v101, v102
 v_max_u32 v197, v197, v103
 v_cmp_eq_u32 vcc, -1, v197
 s_cbranch_vccz L_ok6_got
 s_sleep 1
 s_add_u32 s79, s79, 1
 s_cmp_lt_u32 s79, 0x80000
 s_cbranch_scc1 L_ok6_spin
L_ok6_got:
 v_max3_u32 v197, v104, v105, v106
 v_max3_u32 v197, v197, v107, v108
 v_max3_u32 v197, v197, v109, v110
 v_max3_u32 v197, v197, v111, v112
 v_max3_u32 v197, v197, v113, v114
 v_max3_u32 v197, v197, v115, v116
 v_max3_u32 v197, v197, v117, v118
 v_max3_u32 v197, v197, v119, v120
 v_max3_u32 v197, v197, v121, v122
 v_max3_u32 v197, v197, v123, v124
 v_max3_u32 v197, v197, v125, v126
 v_max3_u32 v197, v197, v127, v128
 v_max3_u32 v197, v197, v129, v130
 v_max3_u32 v197, v197, v131, v132
 v_max3_u32 v197, v197, v133, v134
 v_max_u32 v197, v197, v135
 v_cmp_eq_u32 vcc, -1, v197
 s_cbranch_vccz L_ok6_ret
 s_add_u32 s67, s61, 4
 s_and_b32 s67, s67, 7
 s_lshl_b32 s67, s67, 12
 s_add_u32 s67, s67, s91
 buffer_load_dwordx4 v[104:107], v193, s[56:59], s67 offen offset:0 sc1
 buffer_load_dwordx4 v[108:111], v193, s[56:59], s67 offen offset:1024 sc1
 buffer_load_dwordx4 v[112:115], v193, s[56:59], s67 offen offset:2048 sc1
 buffer_load_dwordx4 v[116:119], v193, s[56:59], s67 offen offset:3072 sc1
 s_add_u32 s67, s61, 5
 s_and_b32 s67, s67, 7
 s_lshl_b32 s67, s67, 12
 s_add_u32 s67, s67, s91
 buffer_load_dwordx4 v[120:123], v193, s[56:59], s67 offen offset:0 sc1
 buffer_load_dwordx4 v[124:127], v193, s[56:59], s67 offen offset:1024 sc1
 buffer_load_dwordx4 v[128:131], v193, s[56:59], s67 offen offset:2048 sc1
 buffer_load_dwordx4 v[132:135], v193, s[56:59], s67 offen offset:3072 sc1
 s_branch L_ok6_ret
L_ok7:
 s_add_u32 s67, s61, 3
 s_and_b32 s67, s67, 7
 s_lshl_b32 s67, s67, 12
 s_add_u32 s67, s67, s91
 s_mov_b32 s79, 0
L_ok7_spin:
 buffer_load_dwordx4 v[96:99], v193, s[56:59], s67 offen offset:2048 sc1
 buffer_load_dwordx4 v[100:103], v193, s[56:59], s67 offen offset:3072 sc1
 s_waitcnt vmcnt(0)
 v_max3_u32 v197, v96, v97, v98
 v_max3_u32 v197, v197, v99, v100
 v_max3_u32 v197, v197, v101, v102
 v_max_u32 v197, v197, v103
 v_cmp_eq_u32 vcc, -1, v197
 s_cbranch_vccz L_ok7_got
 s_sleep 1
 s_add_u32 s79, s79, 1
 s_cmp_lt_u32 s79, 0x80000
 s_cbranch_scc1 L_ok7_spin
L_ok7_got:
 v_max3_u32 v197, v104, v105, v106
 v_max3_u32 v197, v197, v107, v108
 v_max3_u32 v197, v197, v109, v110
 v_max3_u32 v197, v197, v111, v112
 v_max3_u32 v197, v197, v113, v114
 v_max3_u32 v197, v197, v115, v116
 v_max3_u32 v197, v197, v117, v118
 v_max3_u32 v197, v197, v119, v120
 v_max3_u32 v197, v197, v121, v122
 v_max3_u32 v197, v197, v123, v124
 v_max3_u32 v197, v197, v125, v126
 v_max3_u32 v197, v197, v127, v128
 v_max3_u32 v197, v197, v129, v130
 v_max3_u32 v197, v197, v131, v132
 v_max3_u32 v197, v197, v133, v134
 v_max3_u32 v197, v197, v135, v136
 v_max3_u32 v197, v197, v137, v138
 v_max3_u32 v197, v197, v139, v140
 v_max3_u32 v197, v197, v141, v142
 v_max_u32 v197, v197, v143
 v_cmp_eq_u32 vcc, -1, v197
 s_cbranch_vccz L_ok7_ret
 s_add_u32 s67, s61, 4
 s_and_b32 s67, s67, 7
 s_lshl_b32 s67, s67, 12
 s_add_u32 s67, s67, s91
 buffer_load_dwordx4 v[104:107], v193, s[56:59], s67 offen offset:0 sc1
 buffer_load_dwordx4 v[108:111], v193, s[56:59], s67 offen offset:1024 sc1
 buffer_load_dwordx4 v[112:115], v193, s[56:59], s67 offen offset:2048 sc1
 buffer_load_dwordx4 v[116:119], v193, s[56:59], s67 offen offset:3072 sc1
 s_add_u32 s67, s61, 5
 s_and_b32 s67, s67, 7
 s_lshl_b32 s67, s67, 12
 s_add_u32 s67, s67, s91
 buffer_load_dwordx4 v[120:123], v193, s[56:59], s67 offen offset:0 sc1
 buffer_load_dwordx4 v[124:127], v193, s[56:59], s67 offen offset:1024 sc1
 buffer_load_dwordx4 v[128:131], v193, s[56:59], s67 offen offset:2048 sc1
 buffer_load_dwordx4 v[132:135], v193, s[56:59], s67 offen offset:3072 sc1
 s_add_u32 s67, s61, 6
 s_and_b32 s67, s67, 7
 s_lshl_b32 s67, s67, 12
 s_add_u32 s67, s67, s91
 buffer_load_dwordx4 v[136:139], v193, s[56:59], s67 offen offset:0 sc1
 buffer_load_dwordx4 v[140:143], v193, s[56:59], s67 offen offset:1024 sc1
 s_branch L_ok7_ret
L_ok8:
 s_add_u32 s67, s61, 4
 s_and_b32 s67, s67, 7
 s_lshl_b32 s67, s67, 12
 s_add_u32 s67, s67, s91
 s_mov_b32 s79, 0
L_ok8_spin:
 buffer_load_dwordx4 v[104:107], v193, s[56:59], s67 offen offset:0 sc1
 buffer_load_dwordx4 v[108:111], v193, s[56:59], s67 offen offset:1024 sc1
 buffer_load_dwordx4 v[112:115], v193, s[56:59], s67 offen offset:2048 sc1
 buffer_load_dwordx4 v[116:119], v193, s[56:59], s67 offen offset:3072 sc1
 s_waitcnt vmcnt(0)
 v_max3_u32 v197, v104, v105, v106
 v_max3_u32 v197, v197, v107, v108
 v_max3_u32 v197, v197, v109, v110
 v_max3_u32 v197, v197, v111, v112
 v_max3_u32 v197, v197, v113, v114
 v_max3_u32 v197, v197, v115, v116
 v_max3_u32 v197, v197, v117, v118
 v_max_u32 v197, v197, v119
 v_cmp_eq_u32 vcc, -1, v197
 s_cbranch_vccz L_ok8_got
 s_sleep 1
 s_add_u32 s79, s79, 1
 s_cmp_lt_u32 s79, 0x80000
 s_cbranch_scc1 L_ok8_spin
L_ok8_got:
 v_max3_u32 v197, v120, v121, v122
 v_max3_u32 v197, v197, v123, v124
 v_max3_u32 v197, v197, v125, v126
 v_max3_u32 v197, v197, v127, v128
 v_max3_u32 v197, v197, v129, v130
 v_max3_u32 v197, v197, v131, v132
 v_max3_u32 v197, v197, v133, v134
 v_max3_u32 v197, v197, v135, v136
 v_max3_u32 v197, v197, v137, v138
 v_max3_u32 v197, v197, v139, v140
 v_max3_u32 v197, v197, v141, v142
 v_max3_u32 v197, v197, v143, v144
 v_max3_u32 v197, v197, v145, v146
 v_max3_u32 v197, v197, v147, v148
 v_max3_u32 v197, v197, v149, v150
 v_max_u32 v197, v197, v151
 v_cmp_eq_u32 vcc, -1, v197
 s_cbranch_vccz L_ok8_ret
 s_add_u32 s67, s61, 5
 s_and_b32 s67, s67, 7
 s_lshl_b32 s67, s67, 12
 s_add_u32 s67, s67, s91
 buffer_load_dwordx4 v[120:123], v193, s[56:59], s67 offen offset:0 sc1
 buffer_load_dwordx4 v[124:127], v193, s[56:59], s67 offen offset:1024 sc1
 buffer_load_dwordx4 v[128:131], v193, s[56:59], s67 offen offset:2048 sc1
 buffer_load_dwordx4 v[132:135], v193, s[56:59], s67 offen offset:3072 sc1
 s_add_u32 s67, s61, 6
 s_and_b32 s67, s67, 7
 s_lshl_b32 s67, s67, 12
 s_add_u32 s67, s67, s91
 buffer_load_dwordx4 v[136:139], v193, s[56:59], s67 offen offset:0 sc1
 buffer_load_dwordx4 v[140:143], v193, s[56:59], s67 offen offset:1024 sc1
 buffer_load_dwordx4 v[144:147], v193, s[56:59], s67 offen offset:2048 sc1
 buffer_load_dwordx4 v[148:151], v193, s[56:59], s67 offen offset:3072 sc1
 s_branch L_ok8_ret
L_ok9:
 s_add_u32 s67, s61, 4
 s_and_b32 s67, s67, 7
 s_lshl_b32 s67, s67, 12
 s_add_u32 s67, s67, s91
 s_mov_b32 s79, 0
L_ok9_spin:
 buffer_load_dwordx4 v[112:115], v193, s[56:59], s67 offen offset:2048 sc1
 buffer_load_dwordx4 v[116:119], v193, s[56:59], s67 offen offset:3072 sc1
 s_waitcnt vmcnt(0)
 v_max3_u32 v197, v112, v113, v114
 v_max3_u32 v197, v197, v115, v116
 v_max3_u32 v197, v197, v117, v118
 v_max_u32 v197, v197, v119
 v_cmp_eq_u32 vcc, -1, v197
 s_cbranch_vccz L_ok9_got
 s_sleep 1
 s_add_u32 s79, s79, 1
 s_cmp_lt_u32 s79, 0x80000
 s_cbranch_scc1 L_ok9_spin
L_ok9_got:
 v_max3_u32 v197, v120, v121, v122
 v_max3_u32 v197, v197, v123, v124
 v_max3_u32 v197, v197, v125, v126
 v_max3_u32 v197, v197, v127, v128
 v_max3_u32 v197, v197, v129, v130
 v_max3_u32 v197, v197, v131, v132
 v_max3_u32 v197, v197, v133, v134
 v_max3_u32 v197, v197, v135, v136
 v_max3_u32 v197, v197, v137, v138
 v_max3_u32 v197, v197, v139, v140
 v_max3_u32 v197, v197, v141, v142
 v_max3_u32 v197, v197, v143, v144
 v_max3_u32 v197, v197, v145, v146
 v_max3_u32 v197, v197, v147, v148
 v_max3_u32 v197, v197, v149, v150
 v_max3_u32 v197, v197, v151, v152
 v_max3_u32 v197, v197, v153, v154
 v_max3_u32 v197, v197, v155, v156
 v_max3_u32 v197, v197, v157, v158
 v_max_u32 v197, v197, v159
 v_cmp_eq_u32 vcc, -1, v197
 s_cbranch_vccz L_ok9_ret
 s_add_u32 s67, s61, 5
 s_and_b32 s67, s67, 7
 s_lshl_b32 s67, s67, 12
 s_add_u32 s67, s67, s91
 buffer_load_dwordx4 v[120:123], v193, s[56:59], s67 offen offset:0 sc1
 buffer_load_dwordx4 v[124:127], v193, s[56:59], s67 offen offset:1024 sc1
 buffer_load_dwordx4 v[128:131], v193, s[56:59], s67 offen offset:2048 sc1
 buffer_load_dwordx4 v[132:135], v193, s[56:59], s67 offen offset:3072 sc1
 s_add_u32 s67, s61, 6
 s_and_b32 s67, s67, 7
 s_lshl_b32 s67, s67, 12
 s_add_u32 s67, s67, s91
 buffer_load_dwordx4 v[136:139], v193, s[56:59], s67 offen offset:0 sc1
 buffer_load_dwordx4 v[140:143], v193, s[56:59], s67 offen offset:1024 sc1
 buffer_load_dwordx4 v[144:147], v193, s[56:59], s67 offen offset:2048 sc1
 buffer_load_dwordx4 v[148:151], v193, s[56:59], s67 offen offset:3072 sc1
 s_add_u32 s67, s61, 7
 s_and_b32 s67, s67, 7
 s_lshl_b32 s67, s67, 12
 s_add_u32 s67, s67, s91
 buffer_load_dwordx4 v[152:155], v193, s[56:59], s67 offen offset:0 sc1
 buffer_load_dwordx4 v[156:159], v193, s[56:59], s67 offen offset:1024 sc1
 s_branch L_ok9_ret
L_ok10:
 s_add_u32 s67, s61, 5
 s_and_b32 s67, s67, 7
 s_lshl_b32 s67, s67, 12
 s_add_u32 s67, s67, s91
 s_mov_b32 s79, 0
L_ok10_spin:
 buffer_load_dwordx4 v[120:123], v193, s[56:59], s67 offen offset:0 sc1
 buffer_load_dwordx4 v[124:127], v193, s[56:59], s67 offen offset:1024 sc1
 buffer_load_dwordx4 v[128:131], v193, s[56:59], s67 offen offset:2048 sc1
 buffer_load_dwordx4 v[132:135], v193, s[56:59], s67 offen offset:3072 sc1
 s_waitcnt vmcnt(0)
 v_max3_u32 v197, v120, v121, v122
 v_max3_u32 v197, v197, v123, v124
 v_max3_u32 v197, v197, v125, v126
 v_max3_u32 v197, v197, v127, v128
 v_max3_u32 v197, v197, v129, v130
 v_max3_u32 v197, v197, v131, v132
 v_max3_u32 v197, v197, v133, v134
 v_max_u32 v197, v197, v135
 v_cmp_eq_u32 vcc, -1, v197
 s_cbranch_vccz L_ok10_got
 s_sleep 1
 s_add_u32 s79, s79, 1
 s_cmp_lt_u32 s79, 0x80000
 s_cbranch_scc1 L_ok10_spin
L_ok10_got:
 v_max3_u32 v197, v136, v137, v138
 v_max3_u32 v197, v197, v139, v140
 v_max3_u32 v197, v197, v141, v142
 v_max3_u32 v197, v197, v143, v144
 v_max3_u32 v197, v197, v145, v146
 v_max3_u32 v197, v197, v147, v148
 v_max3_u32 v197, v197, v149, v150
 v_max3_u32 v197, v197, v151, v152
 v_max3_u32 v197, v197, v153, v154
 v_max3_u32 v197, v197, v155, v156
 v_max3_u32 v197, v197, v157, v158
 v_max3_u32 v197, v197, v159, v160
 v_max3_u32 v197, v197, v161, v162
 v_max3_u32 v197, v197, v163, v164
 v_max3_u32 v197, v197, v165, v166
 v_max_u32 v197, v197, v167
 v_cmp_eq_u32 vcc, -1, v197
 s_cbranch_vccz L_ok10_ret
 s_add_u32 s67, s61, 6
 s_and_b32 s67, s67, 7
 s_lshl_b32 s67, s67, 12
 s_add_u32 s67, s67, s91
 buffer_load_dwordx4 v[136:139], v193, s[56:59], s67 offen offset:0 sc1
 buffer_load_dwordx4 v[140:143], v193, s[56:59], s67 offen offset:1024 sc1
 buffer_load_dwordx4 v[144:147], v193, s[56:59], s67 offen offset:2048 sc1
 buffer_load_dwordx4 v[148:151], v193, s[56:59], s67 offen offset:3072 sc1
 s_add_u32 s67, s61, 7
 s_and_b32 s67, s67, 7
 s_lshl_b32 s67, s67, 12
 s_add_u32 s67, s67, s91
 buffer_load_dwordx4 v[152:155], v193, s[56:59], s67 offen offset:0 sc1
 buffer_load_dwordx4 v[156:159], v193, s[56:59], s67 offen offset:1024 sc1
 buffer_load_dwordx4 v[160:163], v193, s[56:59], s67 offen offset:2048 sc1
 buffer_load_dwordx4 v[164:167], v193, s[56:59], s67 offen offset:3072 sc1
 s_branch L_ok10_ret
L_ok11:
 s_add_u32 s67, s61, 5
 s_and_b32 s67, s67, 7
 s_lshl_b32 s67, s67, 12
 s_add_u32 s67, s67, s91
 s_mov_b32 s79, 0
L_ok11_spin:
 buffer_load_dwordx4 v[128:131], v193, s[56:59], s67 offen offset:2048 sc1
 buffer_load_dwordx4 v[132:135], v193, s[56:59], s67 offen offset:3072 sc1
 s_waitcnt vmcnt(0)
 v_max3_u32 v197, v128, v129, v130
 v_max3_u32 v197, v197, v131, v132
 v_max3_u32 v197, v197, v133, v134
 v_max_u32 v197, v197, v135
 v_cmp_eq_u32 vcc, -1, v197
 s_cbranch_vccz L_ok11_got
 s_sleep 1
 s_add_u32 s79, s79, 1
 s_cmp_lt_u32 s79, 0x80000
 s_cbranch_scc1 L_ok11_spin
L_ok11_got:
 v_max3_u32 v197, v136, v137, v138
 v_max3_u32 v197, v197, v139, v140
 v_max3_u32 v197, v197, v141, v142
 v_max3_u32 v197, v197, v143, v144
 v_max3_u32 v197, v197, v145, v146
 v_max3_u32 v197, v197, v147, v148
 v_max3_u32 v197, v197, v149, v150
 v_max3_u32 v197, v197, v151, v152
 v_max3_u32 v197, v197, v153, v154
 v_max3_u32 v197, v197, v155, v156
 v_max3_u32 v197, v197, v157, v158
 v_max3_u32 v197, v197, v159, v160
 v_max3_u32 v197, v197, v161, v162
 v_max3_u32 v197, v197, v163, v164
 v_max3_u32 v197, v197, v165, v166
 v_max3_u32 v197, v197, v167, v168
 v_max3_u32 v197, v197, v169, v170
 v_max3_u32 v197, v197, v171, v172
 v_max3_u32 v197, v197, v173, v174
 v_max_u32 v197, v197, v175
 v_cmp_eq_u32 vcc, -1, v197
 s_cbranch_vccz L_ok11_ret
 s_add_u32 s67, s61, 6
 s_and_b32 s67, s67, 7
 s_lshl_b32 s67, s67, 12
 s_add_u32 s67, s67, s91
 buffer_load_dwordx4 v[136:139], v193, s[56:59], s67 offen offset:0 sc1
 buffer_load_dwordx4 v[140:143], v193, s[56:59], s67 offen offset:1024 sc1
 buffer_load_dwordx4 v[144:147], v193, s[56:59], s67 offen offset:2048 sc1
 buffer_load_dwordx4 v[148:151], v193, s[56:59], s67 offen offset:3072 sc1
 s_add_u32 s67, s61, 7
 s_and_b32 s67, s67, 7
 s_lshl_b32 s67, s67, 12
 s_add_u32 s67, s67, s91
 buffer_load_dwordx4 v[152:155], v193, s[56:59], s67 offen offset:0 sc1
 buffer_load_dwordx4 v[156:159], v193, s[56:59], s67 offen offset:1024 sc1
 buffer_load_dwordx4 v[160:163], v193, s[56:59], s67 offen offset:2048 sc1
 buffer_load_dwordx4 v[164:167], v193, s[56:59], s67 offen offset:3072 sc1
 s_add_u32 s67, s91, 32768
 buffer_load_dwordx4 v[168:171], v193, s[56:59], s67 offen offset:0 sc1
 buffer_load_dwordx4 v[172:175], v193, s[56:59], s67 offen offset:1024 sc1
 s_branch L_ok11_ret
L_ok12:
 s_add_u32 s67, s61, 6
 s_and_b32 s67, s67, 7
 s_lshl_b32 s67, s67, 12
 s_add_u32 s67, s67, s91
 s_mov_b32 s79, 0
L_ok12_spin:
 buffer_load_dwordx4 v[136:139], v193, s[56:59], s67 offen offset:0 sc1
 buffer_load_dwordx4 v[140:143], v193, s[56:59], s67 offen offset:1024 sc1
 buffer_load_dwordx4 v[144:147], v193, s[56:59], s67 offen offset:2048 sc1
 buffer_load_dwordx4 v[148:151], v193, s[56:59], s67 offen offset:3072 sc1
 s_waitcnt vmcnt(0)
 v_max3_u32 v197, v136, v137, v138
 v_max3_u32 v197, v197, v139, v140
 v_max3_u32 v197, v197, v141, v142
 v_max3_u32 v197, v197, v143, v144
 v_max3_u32 v197, v197, v145, v146
 v_max3_u32 v197, v197, v147, v148
 v_max3_u32 v197, v197, v149, v150
 v_max_u32 v197, v197, v151
 v_cmp_eq_u32 vcc, -1, v197
 s_cbranch_vccz L_ok12_got
 s_sleep 1
 s_add_u32 s79, s79, 1
 s_cmp_lt_u32 s79, 0x80000
 s_cbranch_scc1 L_ok12_spin
L_ok12_got:
 v_max3_u32 v197, v152, v153, v154
 v_max3_u32 v197, v197, v155, v156
 v_max3_u32 v197, v197, v157, v158
 v_max3_u32 v197, v197, v159, v160
 v_max3_u32 v197, v197, v161, v162
 v_max3_u32 v197, v197, v163, v164
 v_max3_u32 v197, v197, v165, v166
 v_max3_u32 v197, v197, v167, v168
 v_max3_u32 v197, v197, v169, v170
 v_max3_u32 v197, v197, v171, v172
 v_max3_u32 v197, v197, v173, v174
 v_max3_u32 v197, v197, v175, v176
 v_max3_u32 v197, v197, v177, v178
 v_max3_u32 v197, v197, v179, v180
 v_max3_u32 v197, v197, v181, v182
 v_max_u32 v197, v197, v183
 v_cmp_eq_u32 vcc, -1, v197
 s_cbranch_vccz L_ok12_ret
 s_add_u32 s67, s61, 7
 s_and_b32 s67, s67, 7
 s_lshl_b32 s67, s67, 12
 s_add_u32 s67, s67, s91
 buffer_load_dwordx4 v[152:155], v193, s[56:59], s67 offen offset:0 sc1
 buffer_load_dwordx4 v[156:159], v193, s[56:59], s67 offen offset:1024 sc1
 buffer_load_dwordx4 v[160:163], v193, s[56:59], s67 offen offset:2048 sc1
 buffer_load_dwordx4 v[164:167], v193, s[56:59], s67 offen offset:3072 sc1
 s_add_u32 s67, s91, 32768
 buffer_load_dwordx4 v[168:171], v193, s[56:59], s67 offen offset:0 sc1
 buffer_load_dwordx4 v[172:175], v193, s[56:59], s67 offen offset:1024 sc1
 buffer_load_dwordx4 v[176:179], v193, s[56:59], s67 offen offset:2048 sc1
 buffer_load_dwordx4 v[180:183], v193, s[56:59], s67 offen offset:3072 sc1
 s_branch L_ok12_ret
L_ok13:
 s_add_u32 s67, s61, 6
 s_and_b32 s67, s67, 7
 s_lshl_b32 s67, s67, 12
 s_add_u32 s67, s67, s91
 s_mov_b32 s79, 0
L_ok13_spin:
 buffer_load_dwordx4 v[144:147], v193, s[56:59], s67 offen offset:2048 sc1
 buffer_load_dwordx4 v[148:151], v193, s[56:59], s67 offen offset:3072 sc1
 s_waitcnt vmcnt(0)
 v_max3_u32 v197, v144, v145, v146
 v_max3_u32 v197, v197, v147, v148
 v_max3_u32 v197, v197, v149, v150
 v_max_u32 v197, v197, v151
 v_cmp_eq_u32 vcc, -1, v197
 s_cbranch_vccz L_ok13_got
 s_sleep 1
 s_add_u32 s79, s79, 1
 s_cmp_lt_u32 s79, 0x80000
 s_cbranch_scc1 L_ok13_spin
L_ok13_got:
 v_max3_u32 v197, v152, v153, v154
 v_max3_u32 v197, v197, v155, v156
 v_max3_u32 v197, v197, v157, v158
 v_max3_u32 v197, v197, v159, v160
 v_max3_u32 v197, v197, v161, v162
 v_max3_u32 v197, v197, v163, v164
 v_max3_u32 v197, v197, v165, v166
 v_max3_u32 v197, v197, v167, v168
 v_max3_u32 v197, v197, v169, v170
 v_max3_u32 v197, v197, v171, v172
 v_max3_u32 v197, v197, v173, v174
 v_max3_u32 v197, v197, v175, v176
 v_max3_u32 v197, v197, v177, v178
 v_max3_u32 v197, v197, v179, v180
 v_max3_u32 v197, v197, v181, v182
 v_max_u32 v197, v197, v183
 v_cmp_eq_u32 vcc, -1, v197
 s_cbranch_vccz L_ok13_ret
 s_add_u32 s67, s61, 7
 s_and_b32 s67, s67, 7
 s_lshl_b32 s67, s67, 12
 s_add_u32 s67, s67, s91
 buffer_load_dwordx4 v[152:155], v193, s[56:59], s67 offen offset:0 sc1
 buffer_load_dwordx4 v[156:159], v193, s[56:59], s67 offen offset:1024 sc1
 buffer_load_dwordx4 v[160:163], v193, s[56:59], s67 offen offset:2048 sc1
 buffer_load_dwordx4 v[164:167], v193, s[56:59], s67 offen offset:3072 sc1
 s_add_u32 s67, s91, 32768
 buffer_load_dwordx4 v[168:171], v193, s[56:59], s67 offen offset:0 sc1
 buffer_load_dwordx4 v[172:175], v193, s[56:59], s67 offen offset:1024 sc1
 buffer_load_dwordx4 v[176:179], v193, s[56:59], s67 offen offset:2048 sc1
 buffer_load_dwordx4 v[180:183], v193, s[56:59], s67 offen offset:3072 sc1
 s_branch L_ok13_ret
L_ok14:
 s_add_u32 s67, s61, 7
 s_and_b32 s67, s67, 7
 s_lshl_b32 s67, s67, 12
 s_add_u32 s67, s67, s91
 s_mov_b32 s79, 0
L_ok14_spin:
 buffer_load_dwordx4 v[152:155], v193, s[56:59], s67 offen offset:0 sc1
 buffer_load_dwordx4 v[156:159], v193, s[56:59], s67 offen offset:1024 sc1
 buffer_load_dwordx4 v[160:163], v193, s[56:59], s67 offen offset:2048 sc1
 buffer_load_dwordx4 v[164:167], v193, s[56:59], s67 offen offset:3072 sc1
 s_waitcnt vmcnt(0)
 v_max3_u32 v197, v152, v153, v154
 v_max3_u32 v197, v197, v155, v156
 v_max3_u32 v197, v197, v157, v158
 v_max3_u32 v197, v197, v159, v160
 v_max3_u32 v197, v197, v161, v162
 v_max3_u32 v197, v197, v163, v164
 v_max3_u32 v197, v197, v165, v166
 v_max_u32 v197, v197, v167
 v_cmp_eq_u32 vcc, -1, v197
 s_cbranch_vccz L_ok14_got
 s_sleep 1
 s_add_u32 s79, s79, 1
 s_cmp_lt_u32 s79, 0x80000
 s_cbranch_scc1 L_ok14_spin
L_ok14_got:
 v_max3_u32 v197, v168, v169, v170
 v_max3_u32 v197, v197, v171, v172
 v_max3_u32 v197, v197, v173, v174
 v_max3_u32 v197, v197, v175, v176
 v_max3_u32 v197, v197, v177, v178
 v_max3_u32 v197, v197, v179, v180
 v_max3_u32 v197, v197, v181, v182
 v_max_u32 v197, v197, v183
 v_cmp_eq_u32 vcc, -1, v197
 s_cbranch_vccz L_ok14_ret
 s_add_u32 s67, s91, 32768
 buffer_load_dwordx4 v[168:171], v193, s[56:59], s67 offen offset:0 sc1
 buffer_load_dwordx4 v[172:175], v193, s[56:59], s67 offen offset:1024 sc1
 buffer_load_dwordx4 v[176:179], v193, s[56:59], s67 offen offset:2048 sc1
 buffer_load_dwordx4 v[180:183], v193, s[56:59], s67 offen offset:3072 sc1
 s_branch L_ok14_ret
L_ok15:
 s_add_u32 s67, s61, 7
 s_and_b32 s67, s67, 7
 s_lshl_b32 s67, s67, 12
 s_add_u32 s67, s67, s91
 s_mov_b32 s79, 0
L_ok15_spin:
 buffer_load_dwordx4 v[160:163], v193, s[56:59], s67 offen offset:2048 sc1
 buffer_load_dwordx4 v[164:167], v193, s[56:59], s67 offen offset:3072 sc1
 s_waitcnt vmcnt(0)
 v_max3_u32 v197, v160, v161, v162
 v_max3_u32 v197, v197, v163, v164
 v_max3_u32 v197, v197, v165, v166
 v_max_u32 v197, v197, v167
 v_cmp_eq_u32 vcc, -1, v197
 s_cbranch_vccz L_ok15_got
 s_sleep 1
 s_add_u32 s79, s79, 1
 s_cmp_lt_u32 s79, 0x80000
 s_cbranch_scc1 L_ok15_spin
L_ok15_got:
 v_max3_u32 v197, v168, v169, v170
 v_max3_u32 v197, v197, v171, v172
 v_max3_u32 v197, v197, v173, v174
 v_max3_u32 v197, v197, v175, v176
 v_max3_u32 v197, v197, v177, v178
 v_max3_u32 v197, v197, v179, v180
 v_max3_u32 v197, v197, v181, v182
 v_max_u32 v197, v197, v183
 v_cmp_eq_u32 vcc, -1, v197
 s_cbranch_vccz L_ok15_ret
 s_add_u32 s67, s91, 32768
 buffer_load_dwordx4 v[168:171], v193, s[56:59], s67 offen offset:0 sc1
 buffer_load_dwordx4 v[172:175], v193, s[56:59], s67 offen offset:1024 sc1
 buffer_load_dwordx4 v[176:179], v193, s[56:59], s67 offen offset:2048 sc1
 buffer_load_dwordx4 v[180:183], v193, s[56:59], s67 offen offset:3072 sc1
 s_branch L_ok15_ret
L_ok16:
 s_add_u32 s67, s91, 32768
 s_mov_b32 s79, 0
L_ok16_spin:
 buffer_load_dwordx4 v[168:171], v193, s[56:59], s67 offen offset:0 sc1
 buffer_load_dwordx4 v[172:175], v193, s[56:59], s67 offen offset:1024 sc1
 buffer_load_dwordx4 v[176:179], v193, s[56:59], s67 offen offset:2048 sc1
 buffer_load_dwordx4 v[180:183], v193, s[56:59], s67 offen offset:3072 sc1
 s_waitcnt vmcnt(0)
 v_max3_u32 v197, v168, v169, v170
 v_max3_u32 v197, v197, v171, v172
 v_max3_u32 v197, v197, v173, v174
 v_max3_u32 v197, v197, v175, v176
 v_max3_u32 v197, v197, v177, v178
 v_max3_u32 v197, v197, v179, v180
 v_max3_u32 v197, v197, v181, v182
 v_max_u32 v197, v197, v183
 v_cmp_eq_u32 vcc, -1, v197
 s_cbranch_vccz L_ok16_got
 s_sleep 1
 s_add_u32 s79, s79, 1
 s_cmp_lt_u32 s79, 0x80000
 s_cbranch_scc1 L_ok16_spin
L_ok16_got:
 s_branch L_ok16_ret
L_ok17:
 s_add_u32 s67, s91, 32768
 s_mov_b32 s79, 0
L_ok17_spin:
 buffer_load_dwordx4 v[176:179], v193, s[56:59], s67 offen offset:2048 sc1
 buffer_load_dwordx4 v[180:183], v193, s[56:59], s67 offen offset:3072 sc1
 s_waitcnt vmcnt(0)
 v_max3_u32 v197, v176, v177, v178
 v_max3_u32 v197, v197, v179, v180
 v_max3_u32 v197, v197, v181, v182
 v_max_u32 v197, v197, v183
 v_cmp_eq_u32 vcc, -1, v197
 s_cbranch_vccz L_ok17_got
 s_sleep 1
 s_add_u32 s79, s79, 1
 s_cmp_lt_u32 s79, 0x80000
 s_cbranch_scc1 L_ok17_spin
L_ok17_got:
 s_branch L_ok17_ret
L_pk:
 v_and_b32 v99, 15, v255
 v_lshlrev_b32 v99, 2, v99
 s_mov_b32 s79, 0
L_pk_spin:
 buffer_load_dword v112, off, s[56:59], s14 sc1
 s_waitcnt vmcnt(0)
 v_cmp_eq_u32 vcc, v112, v113
 s_cbranch_vccnz L_pk_done
 s_and_b32 s67, s79, 15
 s_cmp_lg_u32 s67, 15
 s_cbranch_scc1 L_pk_next
 buffer_load_dword v112, v99, s[52:55], 0 offen sc1
 s_waitcnt vmcnt(0)
 v_cmp_ne_u32 vcc, 0x1010101, v112
 s_cbranch_vccz L_pk_done
L_pk_next:
 s_sleep 3
 s_add_u32 s79, s79, 1
 s_cmp_lt_u32 s79, 0x80000
 s_cbranch_scc1 L_pk_spin
L_pk_done:
 s_mov_b32 s65, 163840
 buffer_load_dword v116, v115, s[56:59], s65 offen sc1
 buffer_load_dword v117, v115, s[56:59], s65 offen offset:256 sc1
 s_add_u32 m0, s64, 0
 s_add_u32 s65, s64, 0
 buffer_load_dwordx4 v114, s[56:59], s65 offen offset:0 sc1 lds
 buffer_load_dwordx4 v114, s[56:59], s65 offen offset:1024 sc1 lds
 buffer_load_dwordx4 v114, s[56:59], s65 offen offset:2048 sc1 lds
 buffer_load_dwordx4 v114, s[56:59], s65 offen offset:3072 sc1 lds
 s_add_u32 m0, s64, 16384
 s_add_u32 s65, s64, 16384
 buffer_load_dwordx4 v114, s[56:59], s65 offen offset:0 sc1 lds
 buffer_load_dwordx4 v114, s[56:59], s65 offen offset:1024 sc1 lds
 buffer_load_dwordx4 v114, s[56:59], s65 offen offset:2048 sc1 lds
 buffer_load_dwordx4 v114, s[56:59], s65 offen offset:3072 sc1 lds
 s_branch L_pk_ret
L_exit:
 s_endpgm
.p2align 6
L_codeend:
.section .rodata,"a"
.p2align 6
.amdhsa_kernel parallel_sum__grouped_kv_mqa__dense_activation_silu__prompt_kernel
  .amdhsa_next_free_vgpr 512
  .amdhsa_next_free_sgpr 102
  .amdhsa_accum_offset 256
  .amdhsa_group_segment_fixed_size 0
  .amdhsa_kernarg_size 88
  .amdhsa_user_sgpr_count 2
  .amdhsa_user_sgpr_kernarg_segment_ptr 1
  .amdhsa_system_sgpr_workgroup_id_x 1
.end_amdhsa_kernel
```
